```python
import torch

def _softmax(x, axis=-1):
    return torch.softmax(x, dim=axis)

def _gelu(x):
    return torch.nn.functional.gelu(x, approximate='tanh')

def _silu(x):
    return torch.nn.functional.silu(x)

def _sigmoid(x):
    return torch.sigmoid(x)

def _layernorm(x, axis=-1, eps=1e-05):
    m = x.mean(dim=axis, keepdim=True)
    v = x.var(dim=axis, keepdim=True, unbiased=False)
    return (x - m) / torch.sqrt(v + eps)

def _scatter_add(tgt, idx, src, axis=0):
    return tgt.clone().index_add_(axis, idx, src)

def _segment_sum(src, seg, n):
    out = torch.zeros((n,) + src.shape[1:], dtype=src.dtype)
    return out.index_add_(0, seg, src)

def _pad(x, pw):
    flat = tuple((v for pair in reversed(pw) for v in pair))
    return torch.nn.functional.pad(x, flat)
kernel_name = 'concat_heads__grouped_kv_mqa__memory_aug_recurrent_mem_tr__prompt'

def setup_inputs():

    _w = lambda a: (lambda t: t.to(torch.bfloat16) if t.is_floating_point() else t)(torch.as_tensor(a))

    def _A_setup():
        B, S, D, H = (1, 2048, 640, 32)
        Dh = D // H
        return {'x': _w((lambda *s: torch.randn(*s, dtype=torch.bfloat16) * 0.05)(B, S, D)), 'wq': _w((lambda *s: torch.randn(*s, dtype=torch.bfloat16) * 0.8)(D, H * Dh)), 'wk': _w((lambda *s: torch.randn(*s, dtype=torch.bfloat16) * 0.8)(D, Dh)), 'wv': _w((lambda *s: torch.randn(*s, dtype=torch.bfloat16) * 0.05)(D, Dh)), 'wo': _w((lambda *s: torch.randn(*s, dtype=torch.bfloat16) * 0.05)(H * Dh, D))}
    _A_in = _A_setup()

    def _B_setup():
        B, S, Dm = (1, 2048, 640)
        H, Dh = (32, 128)
        M, seg = (8, 32)
        seg = min(seg, S)
        S = S // seg * seg
        return {'x': _w((lambda *s: torch.randn(*s, dtype=torch.bfloat16) * 0.05)(B, S, Dm)), 'mem0': _w((lambda *s: torch.randn(*s, dtype=torch.bfloat16) * 0.4)(B, M, Dm)), 'Wq': _w((lambda *s: torch.randn(*s, dtype=torch.bfloat16) * 6.4)(Dm, H, Dh) * Dm ** (-0.5)), 'Wk': _w((lambda *s: torch.randn(*s, dtype=torch.bfloat16) * 6.4)(Dm, H, Dh) * Dm ** (-0.5)), 'Wv': _w((lambda *s: torch.randn(*s, dtype=torch.bfloat16) * 0.4)(Dm, H, Dh) * Dm ** (-0.5)), 'Wo': _w((lambda *s: torch.randn(*s, dtype=torch.bfloat16) * 0.4)(H, Dh, Dm) * (H * Dh) ** (-0.5)), 'seg_len': seg}
    _B_in = _B_setup()
    return {'A_x': _A_in['x'], 'A_wq': _A_in['wq'], 'A_wk': _A_in['wk'], 'A_wv': _A_in['wv'], 'A_wo': _A_in['wo'], 'B_x': _B_in['x'], 'B_mem0': _B_in['mem0'], 'B_Wq': _B_in['Wq'], 'B_Wk': _B_in['Wk'], 'B_Wv': _B_in['Wv'], 'B_Wo': _B_in['Wo'], 'B_seg_len': _B_in['seg_len']}

def reference(A_x, A_wq, A_wk, A_wv, A_wo, B_x, B_mem0, B_Wq, B_Wk, B_Wv, B_Wo, B_seg_len):

    def _A_ref(x, wq, wk, wv, wo):
        B, S, D = x.shape
        H = 32
        Dh = D // H
        q = (lambda x, *d: x.permute(*d))((x @ wq).reshape(B, S, H, Dh), 0, 2, 1, 3)
        k = x @ wk
        v = x @ wv
        scores = torch.einsum('bhqd,bkd->bhqk', q, k) * Dh ** (-0.5)
        p = _softmax(scores, axis=-1)
        o = torch.einsum('bhqk,bkd->bhqd', p, v)
        return (lambda x, *d: x.permute(*d))(o, 0, 2, 1, 3).reshape(B, S, H * Dh) @ wo

    def _B_ref(x, mem0, Wq, Wk, Wv, Wo, seg_len):
        B, S, Dm = x.shape
        H, Dh = (Wq.shape[1], Wq.shape[2])
        M = mem0.shape[1]
        scale = Dh ** (-0.5)
        n_seg = S // seg_len
        L = M + seg_len
        idx = torch.arange(L)
        mask = (idx[:, None] < M) | (idx[:, None] >= idx[None, :])
        mem = mem0
        outs = []
        for s in range(n_seg):
            xs = x[:, s * seg_len:(s + 1) * seg_len, :].clone()
            h = torch.concatenate([mem, xs], axis=1)
            q = torch.einsum('btd,dhe->bhte', h, Wq)
            k = torch.einsum('btd,dhe->bhte', h, Wk)
            v = torch.einsum('btd,dhe->bhte', h, Wv)
            scores = torch.einsum('bhqe,bhke->bhqk', q, k) * scale
            scores = torch.where(mask[None, None], scores, -1000000000.0)
            p = _softmax(scores, axis=-1)
            o = torch.einsum('bhqk,bhke->bhqe', p, v)
            o = torch.einsum('bhte,hed->btd', o, Wo)
            mem = o[:, :M, :].clone()
            outs.append(o[:, M:, :])
        return torch.concatenate(outs, axis=1)
    a = _A_ref(A_x, A_wq, A_wk, A_wv, A_wo)
    b = _B_ref(B_x, B_mem0, B_Wq, B_Wk, B_Wv, B_Wo, B_seg_len)
    return torch.concatenate([a, b], axis=-1)
```

```asm
; @launch grid=(256,1,1) block=(256,1,1) lds=163840
.amdgcn_target "amdgcn-amd-amdhsa--gfx950"
.text
.globl concat_heads__grouped_kv_mqa__memory_aug_recurrent_mem_tr__prompt_kernel
.p2align 8
.type concat_heads__grouped_kv_mqa__memory_aug_recurrent_mem_tr__prompt_kernel,@function
concat_heads__grouped_kv_mqa__memory_aug_recurrent_mem_tr__prompt_kernel:
    s_cmp_ge_u32 s2, 256
    s_cbranch_scc1 L_end
    s_load_dwordx2 s[4:5], s[0:1], 112
    s_load_dwordx2 s[8:9], s[0:1], 104
    s_getreg_b32 s3, hwreg(HW_REG_XCC_ID, 0, 4)
    v_lshrrev_b32 v1, 6, v0
    v_and_b32 v0, 63, v0
    v_readfirstlane_b32 s17, v1
    s_mov_b32 s6, 0x10000000
    s_mov_b32 s7, 0x20000
    s_mov_b32 s10, 256
    s_mov_b32 s11, 0x20000
    s_mov_b32 s19, 0
    s_and_b32 s3, s3, 7
    s_cmp_lt_u32 s3, 2
    s_cselect_b32 s29, 32, 0
    s_add_u32 s29, s29, s3
    s_lshl_b32 s29, s29, 2
    s_waitcnt lgkmcnt(0)
    v_mov_b32 v4, 15360
    s_cmp_lg_u32 s17, 0
    s_cbranch_scc1 L_noticket
    v_mov_b32 v3, 1
    s_mov_b64 exec, 1
    buffer_atomic_add v3, off, s[8:11], s29 sc0
    s_waitcnt vmcnt(0)
    ds_write_b32 v4, v3
    s_waitcnt lgkmcnt(0)
    s_mov_b64 exec, -1
L_noticket:
    s_barrier
    ds_read_b32 v3, v4
    s_waitcnt lgkmcnt(0)
    v_readfirstlane_b32 s16, v3
    s_barrier
    s_cmp_ge_u32 s16, 32
    s_cbranch_scc1 L_end
    s_cmp_eq_u32 s3, 0
    s_cbranch_scc1 L_role0
    s_cmp_eq_u32 s3, 1
    s_cbranch_scc1 L_role1
    s_branch L_worker
L_end:
    s_endpgm
L_role0:
    s_load_dwordx2 s[60:61], s[0:1], 56
    s_load_dwordx2 s[62:63], s[0:1], 64
    s_load_dwordx2 s[64:65], s[0:1], 72
    s_load_dwordx2 s[66:67], s[0:1], 80
    s_load_dwordx2 s[68:69], s[0:1], 48
    v_mov_b32 v73, v0
    v_lshlrev_b32 v0, 4, v73
    v_and_b32 v76, 15, v73
    v_lshrrev_b32 v77, 4, v73
    v_lshrrev_b32 v78, 1, v77
    v_and_b32 v79, 1, v77
    v_lshlrev_b32 v74, 4, v76
    v_lshlrev_b32 v75, 6, v79
    v_xor_b32 v74, v74, v75
    s_lshr_b32 s33, s17, 1
    s_and_b32 s34, s17, 1
    s_lshl_b32 s70, s33, 6
    s_lshl_b32 s71, s34, 2
    s_add_u32 s70, s70, s71
    v_lshlrev_b32 v75, 5, v78
    v_lshl_add_u32 v75, v79, 3, v75
    v_add_u32 v75, s70, v75
    v_lshlrev_b32 v75, 13, v75
    s_lshl_b32 s71, s16, 8
    v_add3_u32 v48, v75, v74, s71
    v_add_u32 v49, 15360, v48
    s_lshl_b32 s70, s33, 4
    s_lshl_b32 s71, s34, 1
    s_add_u32 s70, s70, s71
    s_lshl_b32 s71, s16, 7
    s_add_u32 s70, s70, s71
    v_lshlrev_b32 v75, 3, v78
    v_lshl_add_u32 v75, v79, 2, v75
    v_add_u32 v75, s70, v75
    v_mul_u32_u24 v75, 1280, v75
    v_add_u32 v50, v75, v74
    v_add_u32 v51, 256, v50
    v_xor_b32 v75, s17, v79
    v_lshlrev_b32 v75, 6, v75
    v_lshl_add_u32 v75, v77, 8, v75
    v_lshl_add_u32 v52, v76, 2, v75
    v_add_u32 v52, 16384, v52
    v_add_u32 v53, 36864, v52
    v_add_u32 v54, 36864, v53
    v_add_u32 v55, 36864, v54
    s_mul_i32 s72, s17, 36864
    s_add_u32 s72, s72, 16384
    v_add_u32 v4, s72, v0
    s_lshl_b32 s33, s16, 2
    s_add_u32 s33, s33, s17
    s_lshl_b32 s34, s33, 12
    s_add_u32 s30, s34, 13631488
    s_mov_b32 s27, s30
    s_lshl_b32 s34, s33, 10
    s_add_u32 s31, s34, 4194304
    s_mov_b32 s14, 5242880
    s_mov_b32 s15, 0x20000
    s_waitcnt lgkmcnt(0)
    s_mov_b32 s12, s68
    s_mov_b32 s13, s69
    s_mov_b32 s14, 10240
    v_lshrrev_b32 v74, 2, v76
    v_lshlrev_b32 v74, 1, v74
    v_and_b32 v75, 1, v73
    v_add_u32 v74, v74, v75
    v_mul_u32_u24 v74, 1280, v74
    v_lshl_add_u32 v74, v77, 6, v74
    v_bfe_u32 v75, v73, 1, 1
    v_lshl_add_u32 v74, v75, 5, v74
    s_lshr_b32 s33, s17, 1
    s_lshl_b32 s33, s33, 8
    buffer_load_dwordx4 v[28:31], v74, s[12:15], s33 offen offset:0
    buffer_load_dwordx4 v[32:35], v74, s[12:15], s33 offen offset:16
    buffer_load_dwordx4 v[64:67], v74, s[12:15], s33 offen offset:768
    buffer_load_dwordx4 v[68:71], v74, s[12:15], s33 offen offset:784
    buffer_load_dwordx4 v[56:59], v74, s[12:15], s33 offen offset:512
    buffer_load_dwordx4 v[60:63], v74, s[12:15], s33 offen offset:528
    s_mov_b32 s14, 5242880
    s_mov_b32 s12, s60
    s_mov_b32 s13, s61
    s_add_u32 m0, s72, 0
    s_mov_b32 s33, 131072
    buffer_load_dwordx4 v48, s[12:15], s33 offen lds
    buffer_load_dwordx4 v49, s[12:15], s33 offen offset:1024 lds
    s_add_u32 m0, s72, 2048
    s_mov_b32 s33, 8192
    buffer_load_dwordx4 v48, s[12:15], s33 offen lds
    buffer_load_dwordx4 v49, s[12:15], s33 offen offset:1024 lds
    s_add_u32 m0, s72, 4096
    s_mov_b32 s33, 139264
    buffer_load_dwordx4 v48, s[12:15], s33 offen lds
    buffer_load_dwordx4 v49, s[12:15], s33 offen offset:1024 lds
    s_add_u32 m0, s72, 6144
    s_mov_b32 s33, 1179648
    buffer_load_dwordx4 v48, s[12:15], s33 offen lds
    buffer_load_dwordx4 v49, s[12:15], s33 offen offset:1024 lds
    s_add_u32 m0, s72, 8192
    s_mov_b32 s33, 1056768
    buffer_load_dwordx4 v48, s[12:15], s33 offen lds
    buffer_load_dwordx4 v49, s[12:15], s33 offen offset:1024 lds
    s_add_u32 m0, s72, 10240
    s_mov_b32 s33, 1187840
    buffer_load_dwordx4 v48, s[12:15], s33 offen lds
    buffer_load_dwordx4 v49, s[12:15], s33 offen offset:1024 lds
    s_add_u32 m0, s72, 12288
    s_mov_b32 s33, 2228224
    buffer_load_dwordx4 v48, s[12:15], s33 offen lds
    buffer_load_dwordx4 v49, s[12:15], s33 offen offset:1024 lds
    s_add_u32 m0, s72, 14336
    s_mov_b32 s33, 2105344
    buffer_load_dwordx4 v48, s[12:15], s33 offen lds
    buffer_load_dwordx4 v49, s[12:15], s33 offen offset:1024 lds
    s_add_u32 m0, s72, 16384
    s_mov_b32 s33, 2236416
    buffer_load_dwordx4 v48, s[12:15], s33 offen lds
    buffer_load_dwordx4 v49, s[12:15], s33 offen offset:1024 lds
    s_add_u32 m0, s72, 18432
    s_mov_b32 s33, 3276800
    buffer_load_dwordx4 v48, s[12:15], s33 offen lds
    buffer_load_dwordx4 v49, s[12:15], s33 offen offset:1024 lds
    s_add_u32 m0, s72, 20480
    s_mov_b32 s33, 3153920
    buffer_load_dwordx4 v48, s[12:15], s33 offen lds
    buffer_load_dwordx4 v49, s[12:15], s33 offen offset:1024 lds
    s_add_u32 m0, s72, 22528
    s_mov_b32 s33, 3284992
    buffer_load_dwordx4 v48, s[12:15], s33 offen lds
    buffer_load_dwordx4 v49, s[12:15], s33 offen offset:1024 lds
    s_add_u32 m0, s72, 24576
    s_mov_b32 s33, 4325376
    buffer_load_dwordx4 v48, s[12:15], s33 offen lds
    buffer_load_dwordx4 v49, s[12:15], s33 offen offset:1024 lds
    s_add_u32 m0, s72, 26624
    s_mov_b32 s33, 4333568
    buffer_load_dwordx4 v48, s[12:15], s33 offen lds
    buffer_load_dwordx4 v49, s[12:15], s33 offen offset:1024 lds
    s_mov_b32 s12, s62
    s_mov_b32 s13, s63
    s_add_u32 m0, s72, 28672
    s_mov_b32 s33, 131072
    buffer_load_dwordx4 v48, s[12:15], s33 offen lds
    buffer_load_dwordx4 v49, s[12:15], s33 offen offset:1024 lds
    s_add_u32 m0, s72, 30720
    s_mov_b32 s33, 8192
    buffer_load_dwordx4 v48, s[12:15], s33 offen lds
    buffer_load_dwordx4 v49, s[12:15], s33 offen offset:1024 lds
    s_add_u32 m0, s72, 32768
    s_mov_b32 s33, 139264
    buffer_load_dwordx4 v48, s[12:15], s33 offen lds
    buffer_load_dwordx4 v49, s[12:15], s33 offen offset:1024 lds
    s_add_u32 m0, s72, 34816
    s_mov_b32 s33, 1048576
    buffer_load_dwordx4 v48, s[12:15], s33 offen lds
    buffer_load_dwordx4 v49, s[12:15], s33 offen offset:1024 lds
    v_and_b32 v76, 15, v73
    v_lshrrev_b32 v77, 4, v73
    v_bfe_u32 v75, v73, 1, 1
    v_mov_b32 v74, 0x88888888
    v_mov_b32 v78, 0xdddddddd
    v_cmp_eq_u32 vcc, 1, v75
    s_nop 1
    v_cndmask_b32 v1, v74, v78, vcc
    v_and_b32 v79, 1, v73
    v_lshlrev_b32 v74, 4, v79
    v_mov_b32 v78, 0x3f80
    v_lshlrev_b32 v2, v74, v78
    v_and_b32 v3, 0x3d0, v0
    s_lshl_b32 s33, s17, 14
    s_lshl_b32 s34, s16, 6
    s_add_u32 s33, s33, s34
    v_lshlrev_b32 v74, 11, v77
    v_lshl_add_u32 v74, v76, 2, v74
    v_add_u32 v5, s33, v74
    v_lshlrev_b32 v7, 2, v73
    s_mov_b32 s28, 0
    s_mov_b32 s29, 8192
    s_mov_b32 s46, 65536
    s_mov_b32 s73, 73728
    s_mov_b32 s74, 131072
    s_mov_b32 s75, 139264
    s_min_u32 s70, s17, 2
    s_lshl_b32 s34, s16, 11
    s_lshl_b32 s33, s70, 16
    s_add_u32 s33, s33, s34
    s_add_u32 s21, s33, 0
    s_bfe_u32 s33, s16, 0x10002
    s_lshl_b32 s33, s33, 10
    s_lshr_b32 s34, s16, 3
    s_lshl_b32 s34, s34, 8
    s_add_u32 s33, s33, s34
    s_and_b32 s34, s16, 3
    s_lshl_b32 s34, s34, 6
    s_add_u32 s33, s33, s34
    v_lshrrev_b32 v74, 1, v77
    v_lshlrev_b32 v74, 5, v74
    v_lshl_add_u32 v74, v79, 4, v74
    v_and_b32 v78, 1, v77
    v_lshl_add_u32 v74, v78, 3, v74
    v_add_u32 v74, s33, v74
    v_cmp_gt_u32 vcc, 2, v76
    v_mov_b32 v78, 0x7ffffff0
    s_nop 0
    v_cndmask_b32 v6, v78, v74, vcc
    s_lshl_b32 s33, s70, 11
    s_add_u32 s25, s33, 327680
    s_add_u32 s26, s33, 2097152
    s_mov_b32 s20, 1040356334
    s_lshl_b32 s33, s17, 10
    s_add_u32 s22, s33, 327680
    s_add_u32 s23, s33, 2113536
    s_add_u32 s24, s22, 4096
    s_mov_b32 s48, s20
    s_mov_b32 s49, s20
    s_mov_b32 s47, 729808896
    s_mov_b32 s50, 671088640
    s_mov_b32 s51, 112
    s_mov_b32 s36, 0xcccccccc
    s_mov_b32 s37, 0xcccccccc
    s_mov_b32 s42, 0x00030003
    s_mov_b32 s43, 0x00030003
    v_mov_b32 v12, 1
    v_mov_b32 v13, 1
    v_mov_b32 v14, 1
    v_mov_b32 v15, 1
    buffer_store_dwordx4 v[12:15], v0, s[4:7], s21 offen
    buffer_store_dwordx4 v[12:15], v0, s[4:7], s21 offen offset:1024
    buffer_store_dwordx2 v[12:13], v6, s[4:7], s25 offen
    s_mov_b32 s38, 12582924
    s_mov_b32 s39, 3221228544
    s_mov_b32 s40, 3145731
    s_mov_b32 s41, 805307136
    s_waitcnt vmcnt(37)
    s_waitcnt lgkmcnt(0)
    s_barrier
    ds_read2st64_b32 v[88:89], v52 offset0:0 offset1:4
    ds_read2st64_b32 v[90:91], v53 offset0:0 offset1:4
    ds_read2st64_b32 v[92:93], v54 offset0:0 offset1:4
    ds_read2st64_b32 v[94:95], v55 offset0:0 offset1:4
    s_and_b32 s34, s17, 1
    s_mul_i32 s34, s34, 0x02020202
    s_add_u32 s34, s34, 0x05040100
    s_lshl_b32 s70, s17, 10
    v_add_u32 v75, s70, v0
    v_perm_b32 v24, v29, v28, s34
    v_perm_b32 v25, v31, v30, s34
    v_perm_b32 v26, v33, v32, s34
    v_perm_b32 v27, v35, v34, s34
    ds_write_b128 v75, v[24:27] offset:0
    v_perm_b32 v40, v65, v64, s34
    v_perm_b32 v41, v67, v66, s34
    v_perm_b32 v42, v69, v68, s34
    v_perm_b32 v43, v71, v70, s34
    ds_write_b128 v75, v[40:43] offset:6144
    v_perm_b32 v44, v57, v56, s34
    v_perm_b32 v45, v59, v58, s34
    v_perm_b32 v46, v61, v60, s34
    v_perm_b32 v47, v63, v62, s34
    ds_write_b128 v75, v[44:47] offset:4096
    s_waitcnt vmcnt(35)
    s_waitcnt lgkmcnt(0)
    s_barrier
    s_add_u32 m0, s72, 0
    s_mov_b32 s33, 1056768
    buffer_load_dwordx4 v48, s[12:15], s33 offen lds
    buffer_load_dwordx4 v49, s[12:15], s33 offen offset:1024 lds
    ds_read2st64_b32 v[112:113], v52 offset0:8 offset1:12
    ds_read2st64_b32 v[114:115], v53 offset0:8 offset1:12
    ds_read2st64_b32 v[116:117], v54 offset0:8 offset1:12
    ds_read2st64_b32 v[118:119], v55 offset0:8 offset1:12
    s_waitcnt vmcnt(35)
    s_waitcnt lgkmcnt(0)
    s_barrier
    s_add_u32 m0, s72, 2048
    s_mov_b32 s33, 1187840
    buffer_load_dwordx4 v48, s[12:15], s33 offen lds
    buffer_load_dwordx4 v49, s[12:15], s33 offen offset:1024 lds
    ds_read2st64_b32 v[128:129], v52 offset0:16 offset1:20
    ds_read2st64_b32 v[130:131], v53 offset0:16 offset1:20
    ds_read2st64_b32 v[132:133], v54 offset0:16 offset1:20
    ds_read2st64_b32 v[134:135], v55 offset0:16 offset1:20
    s_lshl_b32 s33, s16, 16
    s_lshr_b32 s34, s17, 1
    v_mov_b32 v16, s34
    v_mov_b32 v17, s34
    v_mov_b32 v18, s34
    v_mov_b32 v19, s34
    s_lshl_b32 s34, s34, 15
    s_add_u32 s33, s33, s34
    s_and_b32 s34, s17, 1
    s_mul_i32 s34, s34, 3072
    s_add_u32 s33, s33, s34
    s_add_u32 s33, s33, 2097152
    buffer_store_dwordx4 v[16:19], v0, s[4:7], s33 offen offset:0 sc1
    buffer_store_dwordx4 v[16:19], v0, s[4:7], s33 offen offset:1024 sc1
    buffer_store_dwordx4 v[16:19], v0, s[4:7], s33 offen offset:2048 sc1
    s_waitcnt vmcnt(38)
    s_waitcnt lgkmcnt(0)
    s_barrier
    s_add_u32 m0, s72, 4096
    s_mov_b32 s33, 2097152
    buffer_load_dwordx4 v48, s[12:15], s33 offen lds
    buffer_load_dwordx4 v49, s[12:15], s33 offen offset:1024 lds
    ds_read2st64_b32 v[168:169], v52 offset0:24 offset1:28
    ds_read2st64_b32 v[170:171], v53 offset0:24 offset1:28
    ds_read2st64_b32 v[172:173], v54 offset0:24 offset1:28
    ds_read2st64_b32 v[174:175], v55 offset0:24 offset1:28
    s_waitcnt vmcnt(38)
    s_waitcnt lgkmcnt(0)
    s_barrier
    s_add_u32 m0, s72, 6144
    s_mov_b32 s33, 2105344
    buffer_load_dwordx4 v48, s[12:15], s33 offen lds
    buffer_load_dwordx4 v49, s[12:15], s33 offen offset:1024 lds
    ds_read2st64_b32 v[184:185], v52 offset0:32 offset1:36
    ds_read2st64_b32 v[186:187], v53 offset0:32 offset1:36
    ds_read2st64_b32 v[188:189], v54 offset0:32 offset1:36
    ds_read2st64_b32 v[190:191], v55 offset0:32 offset1:36
    s_waitcnt vmcnt(38)
    s_waitcnt lgkmcnt(0)
    s_barrier
    s_add_u32 m0, s72, 8192
    s_mov_b32 s33, 2236416
    buffer_load_dwordx4 v48, s[12:15], s33 offen lds
    buffer_load_dwordx4 v49, s[12:15], s33 offen offset:1024 lds
    ds_read2st64_b32 v[200:201], v52 offset0:40 offset1:44
    ds_read2st64_b32 v[202:203], v53 offset0:40 offset1:44
    ds_read2st64_b32 v[204:205], v54 offset0:40 offset1:44
    ds_read2st64_b32 v[206:207], v55 offset0:40 offset1:44
    s_waitcnt vmcnt(38)
    s_waitcnt lgkmcnt(0)
    s_barrier
    s_add_u32 m0, s72, 10240
    s_mov_b32 s33, 3145728
    buffer_load_dwordx4 v48, s[12:15], s33 offen lds
    buffer_load_dwordx4 v49, s[12:15], s33 offen offset:1024 lds
    ds_read2st64_b32 v[240:241], v52 offset0:48 offset1:52
    ds_read2st64_b32 v[242:243], v53 offset0:48 offset1:52
    ds_read2st64_b32 v[244:245], v54 offset0:48 offset1:52
    ds_read2st64_b32 v[246:247], v55 offset0:48 offset1:52
    s_lshl_b32 s33, s16, 16
    s_lshr_b32 s34, s17, 1
    v_mov_b32 v16, s34
    v_mov_b32 v17, s34
    v_mov_b32 v18, s34
    v_mov_b32 v19, s34
    s_lshl_b32 s34, s34, 15
    s_add_u32 s33, s33, s34
    s_and_b32 s34, s17, 1
    s_mul_i32 s34, s34, 3072
    s_add_u32 s33, s33, s34
    s_add_u32 s33, s33, 2105344
    buffer_store_dwordx4 v[16:19], v0, s[4:7], s33 offen offset:0 sc1
    buffer_store_dwordx4 v[16:19], v0, s[4:7], s33 offen offset:1024 sc1
    buffer_store_dwordx4 v[16:19], v0, s[4:7], s33 offen offset:2048 sc1
    s_waitcnt vmcnt(41)
    s_waitcnt lgkmcnt(0)
    s_barrier
    s_add_u32 m0, s72, 12288
    s_mov_b32 s33, 3153920
    buffer_load_dwordx4 v48, s[12:15], s33 offen lds
    buffer_load_dwordx4 v49, s[12:15], s33 offen offset:1024 lds
    ds_read2st64_b32 a[0:1], v52 offset0:56 offset1:60
    ds_read2st64_b32 a[2:3], v53 offset0:56 offset1:60
    ds_read2st64_b32 a[4:5], v54 offset0:56 offset1:60
    ds_read2st64_b32 a[6:7], v55 offset0:56 offset1:60
    s_waitcnt vmcnt(41)
    s_waitcnt lgkmcnt(0)
    s_barrier
    s_add_u32 m0, s72, 14336
    s_mov_b32 s33, 3284992
    buffer_load_dwordx4 v48, s[12:15], s33 offen lds
    buffer_load_dwordx4 v49, s[12:15], s33 offen offset:1024 lds
    ds_read2st64_b32 a[16:17], v52 offset0:64 offset1:68
    ds_read2st64_b32 a[18:19], v53 offset0:64 offset1:68
    ds_read2st64_b32 a[20:21], v54 offset0:64 offset1:68
    ds_read2st64_b32 a[22:23], v55 offset0:64 offset1:68
    s_waitcnt vmcnt(41)
    s_waitcnt lgkmcnt(0)
    s_barrier
    s_add_u32 m0, s72, 16384
    s_mov_b32 s33, 4194304
    buffer_load_dwordx4 v48, s[12:15], s33 offen lds
    buffer_load_dwordx4 v49, s[12:15], s33 offen offset:1024 lds
    ds_read2st64_b32 a[56:57], v52 offset0:72 offset1:76
    ds_read2st64_b32 a[58:59], v53 offset0:72 offset1:76
    ds_read2st64_b32 a[60:61], v54 offset0:72 offset1:76
    ds_read2st64_b32 a[62:63], v55 offset0:72 offset1:76
    s_waitcnt vmcnt(41)
    s_waitcnt lgkmcnt(0)
    s_barrier
    s_add_u32 m0, s72, 18432
    s_mov_b32 s33, 4325376
    buffer_load_dwordx4 v48, s[12:15], s33 offen lds
    buffer_load_dwordx4 v49, s[12:15], s33 offen offset:1024 lds
    ds_read2st64_b32 a[72:73], v52 offset0:80 offset1:84
    ds_read2st64_b32 a[74:75], v53 offset0:80 offset1:84
    ds_read2st64_b32 a[76:77], v54 offset0:80 offset1:84
    ds_read2st64_b32 a[78:79], v55 offset0:80 offset1:84
    s_waitcnt vmcnt(41)
    s_waitcnt lgkmcnt(0)
    s_barrier
    s_add_u32 m0, s72, 20480
    s_mov_b32 s33, 4202496
    buffer_load_dwordx4 v48, s[12:15], s33 offen lds
    buffer_load_dwordx4 v49, s[12:15], s33 offen offset:1024 lds
    ds_read2st64_b32 a[88:89], v52 offset0:88 offset1:92
    ds_read2st64_b32 a[90:91], v53 offset0:88 offset1:92
    ds_read2st64_b32 a[92:93], v54 offset0:88 offset1:92
    ds_read2st64_b32 a[94:95], v55 offset0:88 offset1:92
    s_waitcnt vmcnt(41)
    s_waitcnt lgkmcnt(0)
    s_barrier
    s_add_u32 m0, s72, 22528
    s_mov_b32 s33, 4333568
    buffer_load_dwordx4 v48, s[12:15], s33 offen lds
    buffer_load_dwordx4 v49, s[12:15], s33 offen offset:1024 lds
    ds_read2st64_b32 a[120:121], v52 offset0:96 offset1:100
    ds_read2st64_b32 a[122:123], v53 offset0:96 offset1:100
    ds_read2st64_b32 a[124:125], v54 offset0:96 offset1:100
    ds_read2st64_b32 a[126:127], v55 offset0:96 offset1:100
    s_waitcnt vmcnt(41)
    s_waitcnt lgkmcnt(0)
    s_barrier
    s_mov_b32 s12, s64
    s_mov_b32 s13, s65
    s_add_u32 m0, s72, 24576
    s_mov_b32 s33, 0
    buffer_load_dwordx4 v48, s[12:15], s33 offen lds
    buffer_load_dwordx4 v49, s[12:15], s33 offen offset:1024 lds
    ds_read2st64_b32 a[144:145], v52 offset0:104 offset1:108
    ds_read2st64_b32 a[146:147], v53 offset0:104 offset1:108
    ds_read2st64_b32 a[148:149], v54 offset0:104 offset1:108
    ds_read2st64_b32 a[150:151], v55 offset0:104 offset1:108
    s_waitcnt vmcnt(41)
    s_waitcnt lgkmcnt(0)
    s_barrier
    s_add_u32 m0, s72, 26624
    s_mov_b32 s33, 131072
    buffer_load_dwordx4 v48, s[12:15], s33 offen lds
    buffer_load_dwordx4 v49, s[12:15], s33 offen offset:1024 lds
    ds_read2st64_b32 v[96:97], v52 offset0:112 offset1:116
    ds_read2st64_b32 v[98:99], v53 offset0:112 offset1:116
    ds_read2st64_b32 v[100:101], v54 offset0:112 offset1:116
    ds_read2st64_b32 v[102:103], v55 offset0:112 offset1:116
    s_waitcnt vmcnt(41)
    s_waitcnt lgkmcnt(0)
    s_barrier
    s_add_u32 m0, s72, 28672
    s_mov_b32 s33, 139264
    buffer_load_dwordx4 v48, s[12:15], s33 offen lds
    buffer_load_dwordx4 v49, s[12:15], s33 offen offset:1024 lds
    ds_read2st64_b32 v[120:121], v52 offset0:120 offset1:124
    ds_read2st64_b32 v[122:123], v53 offset0:120 offset1:124
    ds_read2st64_b32 v[124:125], v54 offset0:120 offset1:124
    ds_read2st64_b32 v[126:127], v55 offset0:120 offset1:124
    s_waitcnt vmcnt(41)
    s_waitcnt lgkmcnt(0)
    s_barrier
    s_add_u32 m0, s72, 30720
    s_mov_b32 s33, 1048576
    buffer_load_dwordx4 v48, s[12:15], s33 offen lds
    buffer_load_dwordx4 v49, s[12:15], s33 offen offset:1024 lds
    ds_read2st64_b32 v[136:137], v52 offset0:128 offset1:132
    ds_read2st64_b32 v[138:139], v53 offset0:128 offset1:132
    ds_read2st64_b32 v[140:141], v54 offset0:128 offset1:132
    ds_read2st64_b32 v[142:143], v55 offset0:128 offset1:132
    s_waitcnt vmcnt(41)
    s_waitcnt lgkmcnt(0)
    s_barrier
    s_add_u32 m0, s72, 32768
    s_mov_b32 s33, 1179648
    buffer_load_dwordx4 v48, s[12:15], s33 offen lds
    buffer_load_dwordx4 v49, s[12:15], s33 offen offset:1024 lds
    ds_read2st64_b32 v[152:153], v52 offset0:136 offset1:140
    ds_read2st64_b32 v[154:155], v53 offset0:136 offset1:140
    ds_read2st64_b32 v[156:157], v54 offset0:136 offset1:140
    ds_read2st64_b32 v[158:159], v55 offset0:136 offset1:140
    s_waitcnt vmcnt(38)
    s_waitcnt lgkmcnt(0)
    s_barrier
    s_add_u32 m0, s72, 34816
    s_mov_b32 s33, 1187840
    buffer_load_dwordx4 v48, s[12:15], s33 offen lds
    buffer_load_dwordx4 v49, s[12:15], s33 offen offset:1024 lds
    ds_read2st64_b32 v[192:193], v52 offset0:0 offset1:4
    ds_read2st64_b32 v[194:195], v53 offset0:0 offset1:4
    ds_read2st64_b32 v[196:197], v54 offset0:0 offset1:4
    ds_read2st64_b32 v[198:199], v55 offset0:0 offset1:4
    s_waitcnt vmcnt(38)
    s_waitcnt lgkmcnt(0)
    s_barrier
    s_add_u32 m0, s72, 0
    s_mov_b32 s33, 2097152
    buffer_load_dwordx4 v48, s[12:15], s33 offen lds
    buffer_load_dwordx4 v49, s[12:15], s33 offen offset:1024 lds
    ds_read2st64_b32 v[208:209], v52 offset0:8 offset1:12
    ds_read2st64_b32 v[210:211], v53 offset0:8 offset1:12
    ds_read2st64_b32 v[212:213], v54 offset0:8 offset1:12
    ds_read2st64_b32 v[214:215], v55 offset0:8 offset1:12
    s_waitcnt vmcnt(35)
    s_waitcnt lgkmcnt(0)
    s_barrier
    s_add_u32 m0, s72, 2048
    s_mov_b32 s33, 2228224
    buffer_load_dwordx4 v48, s[12:15], s33 offen lds
    buffer_load_dwordx4 v49, s[12:15], s33 offen offset:1024 lds
    ds_read2st64_b32 v[224:225], v52 offset0:16 offset1:20
    ds_read2st64_b32 v[226:227], v53 offset0:16 offset1:20
    ds_read2st64_b32 v[228:229], v54 offset0:16 offset1:20
    ds_read2st64_b32 v[230:231], v55 offset0:16 offset1:20
    s_waitcnt vmcnt(35)
    s_waitcnt lgkmcnt(0)
    s_barrier
    s_add_u32 m0, s72, 4096
    s_mov_b32 s33, 2236416
    buffer_load_dwordx4 v48, s[12:15], s33 offen lds
    buffer_load_dwordx4 v49, s[12:15], s33 offen offset:1024 lds
    ds_read2st64_b32 a[8:9], v52 offset0:24 offset1:28
    ds_read2st64_b32 a[10:11], v53 offset0:24 offset1:28
    ds_read2st64_b32 a[12:13], v54 offset0:24 offset1:28
    ds_read2st64_b32 a[14:15], v55 offset0:24 offset1:28
    s_waitcnt vmcnt(35)
    s_waitcnt lgkmcnt(0)
    s_barrier
    s_add_u32 m0, s72, 6144
    s_mov_b32 s33, 3145728
    buffer_load_dwordx4 v48, s[12:15], s33 offen lds
    buffer_load_dwordx4 v49, s[12:15], s33 offen offset:1024 lds
    ds_read2st64_b32 a[24:25], v52 offset0:32 offset1:36
    ds_read2st64_b32 a[26:27], v53 offset0:32 offset1:36
    ds_read2st64_b32 a[28:29], v54 offset0:32 offset1:36
    ds_read2st64_b32 a[30:31], v55 offset0:32 offset1:36
    s_waitcnt vmcnt(35)
    s_waitcnt lgkmcnt(0)
    s_barrier
    s_add_u32 m0, s72, 8192
    s_mov_b32 s33, 3276800
    buffer_load_dwordx4 v48, s[12:15], s33 offen lds
    buffer_load_dwordx4 v49, s[12:15], s33 offen offset:1024 lds
    ds_read2st64_b32 a[40:41], v52 offset0:40 offset1:44
    ds_read2st64_b32 a[42:43], v53 offset0:40 offset1:44
    ds_read2st64_b32 a[44:45], v54 offset0:40 offset1:44
    ds_read2st64_b32 a[46:47], v55 offset0:40 offset1:44
    s_waitcnt vmcnt(32)
    s_waitcnt lgkmcnt(0)
    s_barrier
    s_add_u32 m0, s72, 10240
    s_mov_b32 s33, 3284992
    buffer_load_dwordx4 v48, s[12:15], s33 offen lds
    buffer_load_dwordx4 v49, s[12:15], s33 offen offset:1024 lds
    ds_read2st64_b32 a[80:81], v52 offset0:48 offset1:52
    ds_read2st64_b32 a[82:83], v53 offset0:48 offset1:52
    ds_read2st64_b32 a[84:85], v54 offset0:48 offset1:52
    ds_read2st64_b32 a[86:87], v55 offset0:48 offset1:52
    s_waitcnt vmcnt(32)
    s_waitcnt lgkmcnt(0)
    s_barrier
    s_add_u32 m0, s72, 12288
    s_mov_b32 s33, 4194304
    buffer_load_dwordx4 v48, s[12:15], s33 offen lds
    buffer_load_dwordx4 v49, s[12:15], s33 offen offset:1024 lds
    ds_read2st64_b32 a[96:97], v52 offset0:56 offset1:60
    ds_read2st64_b32 a[98:99], v53 offset0:56 offset1:60
    ds_read2st64_b32 a[100:101], v54 offset0:56 offset1:60
    ds_read2st64_b32 a[102:103], v55 offset0:56 offset1:60
    s_waitcnt vmcnt(32)
    s_waitcnt lgkmcnt(0)
    s_barrier
    s_add_u32 m0, s72, 14336
    s_mov_b32 s33, 4325376
    buffer_load_dwordx4 v48, s[12:15], s33 offen lds
    buffer_load_dwordx4 v49, s[12:15], s33 offen offset:1024 lds
    ds_read2st64_b32 a[112:113], v52 offset0:64 offset1:68
    ds_read2st64_b32 a[114:115], v53 offset0:64 offset1:68
    ds_read2st64_b32 a[116:117], v54 offset0:64 offset1:68
    ds_read2st64_b32 a[118:119], v55 offset0:64 offset1:68
    s_cmp_lg_u32 s17, 0
    s_cbranch_scc1 L_nordy0
    v_mov_b32 v8, 1
    s_mov_b64 exec, 1
    buffer_atomic_add v8, off, s[8:11], 0 offset:32
    s_mov_b64 exec, -1
L_nordy0:
    s_waitcnt vmcnt(33)
    s_waitcnt lgkmcnt(0)
    s_barrier
    s_add_u32 m0, s72, 16384
    s_mov_b32 s33, 4202496
    buffer_load_dwordx4 v48, s[12:15], s33 offen lds
    buffer_load_dwordx4 v49, s[12:15], s33 offen offset:1024 lds
    ds_read2st64_b32 a[128:129], v52 offset0:72 offset1:76
    ds_read2st64_b32 a[130:131], v53 offset0:72 offset1:76
    ds_read2st64_b32 a[132:133], v54 offset0:72 offset1:76
    ds_read2st64_b32 a[134:135], v55 offset0:72 offset1:76
    s_waitcnt vmcnt(33)
    s_waitcnt lgkmcnt(0)
    s_barrier
    s_add_u32 m0, s72, 18432
    s_mov_b32 s33, 4333568
    buffer_load_dwordx4 v48, s[12:15], s33 offen lds
    buffer_load_dwordx4 v49, s[12:15], s33 offen offset:1024 lds
    ds_read2st64_b32 a[136:137], v52 offset0:80 offset1:84
    ds_read2st64_b32 a[138:139], v53 offset0:80 offset1:84
    ds_read2st64_b32 a[140:141], v54 offset0:80 offset1:84
    ds_read2st64_b32 a[142:143], v55 offset0:80 offset1:84
    s_waitcnt vmcnt(33)
    s_waitcnt lgkmcnt(0)
    s_barrier
    s_mov_b32 s12, s66
    s_mov_b32 s13, s67
    s_add_u32 m0, s72, 20480
    s_mov_b32 s33, 81920
    buffer_load_dwordx4 v50, s[12:15], s33 offen lds
    buffer_load_dwordx4 v51, s[12:15], s33 offen offset:1024 lds
    ds_read2st64_b32 a[152:153], v52 offset0:88 offset1:92
    ds_read2st64_b32 a[154:155], v53 offset0:88 offset1:92
    ds_read2st64_b32 a[156:157], v54 offset0:88 offset1:92
    ds_read2st64_b32 a[158:159], v55 offset0:88 offset1:92
    s_waitcnt vmcnt(33)
    s_waitcnt lgkmcnt(0)
    s_barrier
    s_add_u32 m0, s72, 22528
    s_mov_b32 s33, 122880
    buffer_load_dwordx4 v50, s[12:15], s33 offen lds
    buffer_load_dwordx4 v51, s[12:15], s33 offen offset:1024 lds
    ds_read2st64_b32 v[80:81], v52 offset0:96 offset1:100
    ds_read2st64_b32 v[82:83], v53 offset0:96 offset1:100
    ds_read2st64_b32 v[84:85], v54 offset0:96 offset1:100
    ds_read2st64_b32 v[86:87], v55 offset0:96 offset1:100
    s_waitcnt vmcnt(33)
    s_waitcnt lgkmcnt(0)
    s_barrier
    s_add_u32 m0, s72, 24576
    s_mov_b32 s33, 256
    buffer_load_dwordx4 v50, s[12:15], s33 offen lds
    buffer_load_dwordx4 v51, s[12:15], s33 offen offset:1024 lds
    ds_read2st64_b32 v[104:105], v52 offset0:104 offset1:108
    ds_read2st64_b32 v[106:107], v53 offset0:104 offset1:108
    ds_read2st64_b32 v[108:109], v54 offset0:104 offset1:108
    ds_read2st64_b32 v[110:111], v55 offset0:104 offset1:108
    s_waitcnt vmcnt(33)
    s_waitcnt lgkmcnt(0)
    s_barrier
    s_add_u32 m0, s72, 26624
    s_mov_b32 s33, 41216
    buffer_load_dwordx4 v50, s[12:15], s33 offen lds
    buffer_load_dwordx4 v51, s[12:15], s33 offen offset:1024 lds
    ds_read2st64_b32 v[144:145], v52 offset0:112 offset1:116
    ds_read2st64_b32 v[146:147], v53 offset0:112 offset1:116
    ds_read2st64_b32 v[148:149], v54 offset0:112 offset1:116
    ds_read2st64_b32 v[150:151], v55 offset0:112 offset1:116
    s_waitcnt vmcnt(33)
    s_waitcnt lgkmcnt(0)
    s_barrier
    s_add_u32 m0, s72, 28672
    s_mov_b32 s33, 123136
    buffer_load_dwordx4 v50, s[12:15], s33 offen lds
    buffer_load_dwordx4 v51, s[12:15], s33 offen offset:1024 lds
    ds_read2st64_b32 v[160:161], v52 offset0:120 offset1:124
    ds_read2st64_b32 v[162:163], v53 offset0:120 offset1:124
    ds_read2st64_b32 v[164:165], v54 offset0:120 offset1:124
    ds_read2st64_b32 v[166:167], v55 offset0:120 offset1:124
    s_waitcnt vmcnt(33)
    s_waitcnt lgkmcnt(0)
    s_barrier
    s_add_u32 m0, s72, 30720
    s_mov_b32 s33, 512
    buffer_load_dwordx4 v50, s[12:15], s33 offen lds
    buffer_load_dwordx4 v51, s[12:15], s33 offen offset:1024 lds
    ds_read2st64_b32 v[176:177], v52 offset0:128 offset1:132
    ds_read2st64_b32 v[178:179], v53 offset0:128 offset1:132
    ds_read2st64_b32 v[180:181], v54 offset0:128 offset1:132
    ds_read2st64_b32 v[182:183], v55 offset0:128 offset1:132
    s_waitcnt vmcnt(33)
    s_waitcnt lgkmcnt(0)
    s_barrier
    s_add_u32 m0, s72, 32768
    s_mov_b32 s33, 82432
    buffer_load_dwordx4 v50, s[12:15], s33 offen lds
    buffer_load_dwordx4 v51, s[12:15], s33 offen offset:1024 lds
    ds_read2st64_b32 v[216:217], v52 offset0:136 offset1:140
    ds_read2st64_b32 v[218:219], v53 offset0:136 offset1:140
    ds_read2st64_b32 v[220:221], v54 offset0:136 offset1:140
    ds_read2st64_b32 v[222:223], v55 offset0:136 offset1:140
    s_waitcnt vmcnt(33)
    s_waitcnt lgkmcnt(0)
    s_barrier
    s_add_u32 m0, s72, 34816
    s_mov_b32 s33, 123392
    buffer_load_dwordx4 v50, s[12:15], s33 offen lds
    buffer_load_dwordx4 v51, s[12:15], s33 offen offset:1024 lds
    ds_read2st64_b32 v[232:233], v52 offset0:0 offset1:4
    ds_read2st64_b32 v[234:235], v53 offset0:0 offset1:4
    ds_read2st64_b32 v[236:237], v54 offset0:0 offset1:4
    ds_read2st64_b32 v[238:239], v55 offset0:0 offset1:4
    s_waitcnt vmcnt(33)
    s_waitcnt lgkmcnt(0)
    s_barrier
    s_mov_b32 s12, s60
    s_mov_b32 s13, s61
    s_add_u32 m0, s72, 0
    s_mov_b32 s33, 0
    buffer_load_dwordx4 v48, s[12:15], s33 offen lds
    buffer_load_dwordx4 v49, s[12:15], s33 offen offset:1024 lds
    ds_read2st64_b32 v[248:249], v52 offset0:8 offset1:12
    ds_read2st64_b32 v[250:251], v53 offset0:8 offset1:12
    ds_read2st64_b32 v[252:253], v54 offset0:8 offset1:12
    ds_read2st64_b32 v[254:255], v55 offset0:8 offset1:12
    s_waitcnt vmcnt(33)
    s_waitcnt lgkmcnt(0)
    s_barrier
    s_mov_b32 s12, s64
    s_mov_b32 s13, s65
    s_add_u32 m0, s72, 2048
    s_mov_b32 s33, 8192
    buffer_load_dwordx4 v48, s[12:15], s33 offen lds
    buffer_load_dwordx4 v49, s[12:15], s33 offen offset:1024 lds
    ds_read2st64_b32 a[32:33], v52 offset0:16 offset1:20
    ds_read2st64_b32 a[34:35], v53 offset0:16 offset1:20
    ds_read2st64_b32 a[36:37], v54 offset0:16 offset1:20
    ds_read2st64_b32 a[38:39], v55 offset0:16 offset1:20
    s_waitcnt vmcnt(33)
    s_waitcnt lgkmcnt(0)
    s_barrier
    s_mov_b32 s12, s62
    s_mov_b32 s13, s63
    s_add_u32 m0, s72, 4096
    s_mov_b32 s33, 1179648
    buffer_load_dwordx4 v48, s[12:15], s33 offen lds
    buffer_load_dwordx4 v49, s[12:15], s33 offen offset:1024 lds
    ds_read2st64_b32 a[48:49], v52 offset0:24 offset1:28
    ds_read2st64_b32 a[50:51], v53 offset0:24 offset1:28
    ds_read2st64_b32 a[52:53], v54 offset0:24 offset1:28
    ds_read2st64_b32 a[54:55], v55 offset0:24 offset1:28
    s_waitcnt vmcnt(33)
    s_waitcnt lgkmcnt(0)
    s_barrier
    s_mov_b32 s12, s60
    s_mov_b32 s13, s61
    s_add_u32 m0, s72, 6144
    s_mov_b32 s33, 2097152
    buffer_load_dwordx4 v48, s[12:15], s33 offen lds
    buffer_load_dwordx4 v49, s[12:15], s33 offen offset:1024 lds
    ds_read2st64_b32 a[64:65], v52 offset0:32 offset1:36
    ds_read2st64_b32 a[66:67], v53 offset0:32 offset1:36
    ds_read2st64_b32 a[68:69], v54 offset0:32 offset1:36
    ds_read2st64_b32 a[70:71], v55 offset0:32 offset1:36
    s_waitcnt vmcnt(33)
    s_waitcnt lgkmcnt(0)
    s_barrier
    s_mov_b32 s12, s64
    s_mov_b32 s13, s65
    s_add_u32 m0, s72, 8192
    s_mov_b32 s33, 2105344
    buffer_load_dwordx4 v48, s[12:15], s33 offen lds
    buffer_load_dwordx4 v49, s[12:15], s33 offen offset:1024 lds
    ds_read2st64_b32 a[104:105], v52 offset0:40 offset1:44
    ds_read2st64_b32 a[106:107], v53 offset0:40 offset1:44
    ds_read2st64_b32 a[108:109], v54 offset0:40 offset1:44
    ds_read2st64_b32 a[110:111], v55 offset0:40 offset1:44
    s_waitcnt vmcnt(33)
    s_waitcnt lgkmcnt(0)
    s_barrier
    s_mov_b32 s12, s62
    s_mov_b32 s13, s63
    s_add_u32 m0, s72, 10240
    s_mov_b32 s33, 3276800
    buffer_load_dwordx4 v48, s[12:15], s33 offen lds
    buffer_load_dwordx4 v49, s[12:15], s33 offen offset:1024 lds
    ds_read2st64_b32 a[160:161], v52 offset0:48 offset1:52
    ds_read2st64_b32 a[162:163], v53 offset0:48 offset1:52
    ds_read2st64_b32 a[164:165], v54 offset0:48 offset1:52
    ds_read2st64_b32 a[166:167], v55 offset0:48 offset1:52
    s_waitcnt vmcnt(33)
    s_waitcnt lgkmcnt(0)
    s_barrier
    s_mov_b32 s12, s60
    s_mov_b32 s13, s61
    s_add_u32 m0, s72, 12288
    s_mov_b32 s33, 4194304
    buffer_load_dwordx4 v48, s[12:15], s33 offen lds
    buffer_load_dwordx4 v49, s[12:15], s33 offen offset:1024 lds
    ds_read2st64_b32 a[168:169], v52 offset0:56 offset1:60
    ds_read2st64_b32 a[170:171], v53 offset0:56 offset1:60
    ds_read2st64_b32 a[172:173], v54 offset0:56 offset1:60
    ds_read2st64_b32 a[174:175], v55 offset0:56 offset1:60
    s_waitcnt vmcnt(32)
    s_waitcnt lgkmcnt(0)
    s_barrier
    s_mov_b32 s12, s62
    s_mov_b32 s13, s63
    s_add_u32 m0, s72, 14336
    s_mov_b32 s33, 0
    buffer_load_dwordx4 v48, s[12:15], s33 offen lds
    buffer_load_dwordx4 v49, s[12:15], s33 offen offset:1024 lds
    ds_read2st64_b32 a[176:177], v52 offset0:64 offset1:68
    ds_read2st64_b32 a[178:179], v53 offset0:64 offset1:68
    ds_read2st64_b32 a[180:181], v54 offset0:64 offset1:68
    ds_read2st64_b32 a[182:183], v55 offset0:64 offset1:68
    s_waitcnt vmcnt(32)
    s_waitcnt lgkmcnt(0)
    s_barrier
    s_mov_b32 s12, s60
    s_mov_b32 s13, s61
    s_add_u32 m0, s72, 16384
    s_mov_b32 s33, 1048576
    buffer_load_dwordx4 v48, s[12:15], s33 offen lds
    buffer_load_dwordx4 v49, s[12:15], s33 offen offset:1024 lds
    ds_read2st64_b32 a[184:185], v52 offset0:72 offset1:76
    ds_read2st64_b32 a[186:187], v53 offset0:72 offset1:76
    ds_read2st64_b32 a[188:189], v54 offset0:72 offset1:76
    ds_read2st64_b32 a[190:191], v55 offset0:72 offset1:76
    s_waitcnt vmcnt(32)
    s_waitcnt lgkmcnt(0)
    s_barrier
    s_mov_b32 s12, s64
    s_mov_b32 s13, s65
    s_add_u32 m0, s72, 18432
    s_mov_b32 s33, 1056768
    buffer_load_dwordx4 v48, s[12:15], s33 offen lds
    buffer_load_dwordx4 v49, s[12:15], s33 offen offset:1024 lds
    ds_read2st64_b32 a[192:193], v52 offset0:80 offset1:84
    ds_read2st64_b32 a[194:195], v53 offset0:80 offset1:84
    ds_read2st64_b32 a[196:197], v54 offset0:80 offset1:84
    ds_read2st64_b32 a[198:199], v55 offset0:80 offset1:84
    s_waitcnt vmcnt(32)
    s_waitcnt lgkmcnt(0)
    s_barrier
    s_mov_b32 s12, s62
    s_mov_b32 s13, s63
    s_add_u32 m0, s72, 20480
    s_mov_b32 s33, 2228224
    buffer_load_dwordx4 v48, s[12:15], s33 offen lds
    buffer_load_dwordx4 v49, s[12:15], s33 offen offset:1024 lds
    ds_read2st64_b32 a[200:201], v52 offset0:88 offset1:92
    ds_read2st64_b32 a[202:203], v53 offset0:88 offset1:92
    ds_read2st64_b32 a[204:205], v54 offset0:88 offset1:92
    ds_read2st64_b32 a[206:207], v55 offset0:88 offset1:92
    s_waitcnt vmcnt(32)
    s_waitcnt lgkmcnt(0)
    s_barrier
    s_mov_b32 s12, s60
    s_mov_b32 s13, s61
    s_add_u32 m0, s72, 22528
    s_mov_b32 s33, 3145728
    buffer_load_dwordx4 v48, s[12:15], s33 offen lds
    buffer_load_dwordx4 v49, s[12:15], s33 offen offset:1024 lds
    ds_read2st64_b32 a[208:209], v52 offset0:96 offset1:100
    ds_read2st64_b32 a[210:211], v53 offset0:96 offset1:100
    ds_read2st64_b32 a[212:213], v54 offset0:96 offset1:100
    ds_read2st64_b32 a[214:215], v55 offset0:96 offset1:100
    s_waitcnt vmcnt(32)
    s_waitcnt lgkmcnt(0)
    s_barrier
    s_mov_b32 s12, s64
    s_mov_b32 s13, s65
    s_add_u32 m0, s72, 24576
    s_mov_b32 s33, 3153920
    buffer_load_dwordx4 v48, s[12:15], s33 offen lds
    buffer_load_dwordx4 v49, s[12:15], s33 offen offset:1024 lds
    ds_read2st64_b32 a[216:217], v52 offset0:104 offset1:108
    ds_read2st64_b32 a[218:219], v53 offset0:104 offset1:108
    ds_read2st64_b32 a[220:221], v54 offset0:104 offset1:108
    ds_read2st64_b32 a[222:223], v55 offset0:104 offset1:108
    s_waitcnt vmcnt(32)
    s_waitcnt lgkmcnt(0)
    s_barrier
    s_mov_b32 s12, s60
    s_mov_b32 s13, s61
    s_add_u32 m0, s72, 26624
    s_mov_b32 s33, 4202496
    buffer_load_dwordx4 v48, s[12:15], s33 offen lds
    buffer_load_dwordx4 v49, s[12:15], s33 offen offset:1024 lds
    ds_read2st64_b32 a[224:225], v52 offset0:112 offset1:116
    ds_read2st64_b32 a[226:227], v53 offset0:112 offset1:116
    ds_read2st64_b32 a[228:229], v54 offset0:112 offset1:116
    ds_read2st64_b32 a[230:231], v55 offset0:112 offset1:116
    s_waitcnt vmcnt(32)
    s_waitcnt lgkmcnt(0)
    s_barrier
    s_mov_b32 s12, s66
    s_mov_b32 s13, s67
    s_add_u32 m0, s72, 28672
    s_mov_b32 s33, 0
    buffer_load_dwordx4 v50, s[12:15], s33 offen lds
    buffer_load_dwordx4 v51, s[12:15], s33 offen offset:1024 lds
    ds_read2st64_b32 a[232:233], v52 offset0:120 offset1:124
    ds_read2st64_b32 a[234:235], v53 offset0:120 offset1:124
    ds_read2st64_b32 a[236:237], v54 offset0:120 offset1:124
    ds_read2st64_b32 a[238:239], v55 offset0:120 offset1:124
    s_waitcnt vmcnt(32)
    s_waitcnt lgkmcnt(0)
    s_barrier
    s_add_u32 m0, s72, 30720
    s_mov_b32 s33, 41472
    buffer_load_dwordx4 v50, s[12:15], s33 offen lds
    buffer_load_dwordx4 v51, s[12:15], s33 offen offset:1024 lds
    ds_read2st64_b32 a[240:241], v52 offset0:128 offset1:132
    ds_read2st64_b32 a[242:243], v53 offset0:128 offset1:132
    ds_read2st64_b32 a[244:245], v54 offset0:128 offset1:132
    ds_read2st64_b32 a[246:247], v55 offset0:128 offset1:132
    s_waitcnt vmcnt(32)
    s_waitcnt lgkmcnt(0)
    s_barrier
    s_add_u32 m0, s72, 32768
    s_mov_b32 s33, 40960
    buffer_load_dwordx4 v50, s[12:15], s33 offen lds
    buffer_load_dwordx4 v51, s[12:15], s33 offen offset:1024 lds
    ds_read2st64_b32 a[248:249], v52 offset0:136 offset1:140
    ds_read2st64_b32 a[250:251], v53 offset0:136 offset1:140
    ds_read2st64_b32 a[252:253], v54 offset0:136 offset1:140
    ds_read2st64_b32 a[254:255], v55 offset0:136 offset1:140
    s_waitcnt vmcnt(32)
    s_waitcnt lgkmcnt(0)
    s_barrier
    s_add_u32 m0, s72, 34816
    s_mov_b32 s33, 82176
    buffer_load_dwordx4 v50, s[12:15], s33 offen lds
    buffer_load_dwordx4 v51, s[12:15], s33 offen offset:1024 lds
    ds_read2st64_b32 v[12:13], v52 offset0:0 offset1:4
    ds_read2st64_b32 v[14:15], v53 offset0:0 offset1:4
    ds_read2st64_b32 v[16:17], v54 offset0:0 offset1:4
    ds_read2st64_b32 v[18:19], v55 offset0:0 offset1:4
    s_waitcnt vmcnt(32)
    s_waitcnt lgkmcnt(0)
    s_barrier
    ds_write_b128 v4, v[12:15] offset:0
    ds_write_b128 v4, v[16:19] offset:1024
    ds_read2st64_b32 v[56:57], v52 offset0:8 offset1:12
    ds_read2st64_b32 v[58:59], v53 offset0:8 offset1:12
    ds_read2st64_b32 v[60:61], v54 offset0:8 offset1:12
    ds_read2st64_b32 v[62:63], v55 offset0:8 offset1:12
    s_waitcnt vmcnt(30)
    s_waitcnt lgkmcnt(0)
    s_barrier
    ds_write_b128 v4, v[56:59] offset:2048
    ds_write_b128 v4, v[60:63] offset:3072
    ds_read2st64_b32 v[12:13], v52 offset0:16 offset1:20
    ds_read2st64_b32 v[14:15], v53 offset0:16 offset1:20
    ds_read2st64_b32 v[16:17], v54 offset0:16 offset1:20
    ds_read2st64_b32 v[18:19], v55 offset0:16 offset1:20
    s_waitcnt vmcnt(28)
    s_waitcnt lgkmcnt(0)
    s_barrier
    ds_write_b128 v4, v[12:15] offset:4096
    ds_write_b128 v4, v[16:19] offset:5120
    ds_read2st64_b32 v[56:57], v52 offset0:24 offset1:28
    ds_read2st64_b32 v[58:59], v53 offset0:24 offset1:28
    ds_read2st64_b32 v[60:61], v54 offset0:24 offset1:28
    ds_read2st64_b32 v[62:63], v55 offset0:24 offset1:28
    s_waitcnt vmcnt(26)
    s_waitcnt lgkmcnt(0)
    s_barrier
    ds_write_b128 v4, v[56:59] offset:6144
    ds_write_b128 v4, v[60:63] offset:7168
    ds_read2st64_b32 v[12:13], v52 offset0:32 offset1:36
    ds_read2st64_b32 v[14:15], v53 offset0:32 offset1:36
    ds_read2st64_b32 v[16:17], v54 offset0:32 offset1:36
    ds_read2st64_b32 v[18:19], v55 offset0:32 offset1:36
    s_waitcnt vmcnt(24)
    s_waitcnt lgkmcnt(0)
    s_barrier
    ds_write_b128 v4, v[12:15] offset:8192
    ds_write_b128 v4, v[16:19] offset:9216
    ds_read2st64_b32 v[56:57], v52 offset0:40 offset1:44
    ds_read2st64_b32 v[58:59], v53 offset0:40 offset1:44
    ds_read2st64_b32 v[60:61], v54 offset0:40 offset1:44
    ds_read2st64_b32 v[62:63], v55 offset0:40 offset1:44
    s_waitcnt vmcnt(22)
    s_waitcnt lgkmcnt(0)
    s_barrier
    ds_write_b128 v4, v[56:59] offset:10240
    ds_write_b128 v4, v[60:63] offset:11264
    ds_read2st64_b32 v[12:13], v52 offset0:48 offset1:52
    ds_read2st64_b32 v[14:15], v53 offset0:48 offset1:52
    ds_read2st64_b32 v[16:17], v54 offset0:48 offset1:52
    ds_read2st64_b32 v[18:19], v55 offset0:48 offset1:52
    s_waitcnt vmcnt(20)
    s_waitcnt lgkmcnt(0)
    s_barrier
    ds_write_b128 v4, v[12:15] offset:12288
    ds_write_b128 v4, v[16:19] offset:13312
    ds_read2st64_b32 v[56:57], v52 offset0:56 offset1:60
    ds_read2st64_b32 v[58:59], v53 offset0:56 offset1:60
    ds_read2st64_b32 v[60:61], v54 offset0:56 offset1:60
    ds_read2st64_b32 v[62:63], v55 offset0:56 offset1:60
    s_waitcnt vmcnt(18)
    s_waitcnt lgkmcnt(0)
    s_barrier
    ds_write_b128 v4, v[56:59] offset:14336
    ds_write_b128 v4, v[60:63] offset:15360
    ds_read2st64_b32 v[12:13], v52 offset0:64 offset1:68
    ds_read2st64_b32 v[14:15], v53 offset0:64 offset1:68
    ds_read2st64_b32 v[16:17], v54 offset0:64 offset1:68
    ds_read2st64_b32 v[18:19], v55 offset0:64 offset1:68
    s_waitcnt vmcnt(16)
    s_waitcnt lgkmcnt(0)
    s_barrier
    ds_write_b128 v4, v[12:15] offset:16384
    ds_write_b128 v4, v[16:19] offset:17408
    ds_read2st64_b32 v[56:57], v52 offset0:72 offset1:76
    ds_read2st64_b32 v[58:59], v53 offset0:72 offset1:76
    ds_read2st64_b32 v[60:61], v54 offset0:72 offset1:76
    ds_read2st64_b32 v[62:63], v55 offset0:72 offset1:76
    s_waitcnt vmcnt(14)
    s_waitcnt lgkmcnt(0)
    s_barrier
    ds_write_b128 v4, v[56:59] offset:18432
    ds_write_b128 v4, v[60:63] offset:19456
    ds_read2st64_b32 v[12:13], v52 offset0:80 offset1:84
    ds_read2st64_b32 v[14:15], v53 offset0:80 offset1:84
    ds_read2st64_b32 v[16:17], v54 offset0:80 offset1:84
    ds_read2st64_b32 v[18:19], v55 offset0:80 offset1:84
    s_waitcnt vmcnt(12)
    s_waitcnt lgkmcnt(0)
    s_barrier
    ds_write_b128 v4, v[12:15] offset:20480
    ds_write_b128 v4, v[16:19] offset:21504
    ds_read2st64_b32 v[56:57], v52 offset0:88 offset1:92
    ds_read2st64_b32 v[58:59], v53 offset0:88 offset1:92
    ds_read2st64_b32 v[60:61], v54 offset0:88 offset1:92
    ds_read2st64_b32 v[62:63], v55 offset0:88 offset1:92
    s_waitcnt vmcnt(10)
    s_waitcnt lgkmcnt(0)
    s_barrier
    ds_write_b128 v4, v[56:59] offset:22528
    ds_write_b128 v4, v[60:63] offset:23552
    ds_read2st64_b32 v[12:13], v52 offset0:96 offset1:100
    ds_read2st64_b32 v[14:15], v53 offset0:96 offset1:100
    ds_read2st64_b32 v[16:17], v54 offset0:96 offset1:100
    ds_read2st64_b32 v[18:19], v55 offset0:96 offset1:100
    s_waitcnt vmcnt(8)
    s_waitcnt lgkmcnt(0)
    s_barrier
    ds_write_b128 v4, v[12:15] offset:24576
    ds_write_b128 v4, v[16:19] offset:25600
    ds_read2st64_b32 v[56:57], v52 offset0:104 offset1:108
    ds_read2st64_b32 v[58:59], v53 offset0:104 offset1:108
    ds_read2st64_b32 v[60:61], v54 offset0:104 offset1:108
    ds_read2st64_b32 v[62:63], v55 offset0:104 offset1:108
    buffer_load_dwordx2 v[8:9], off, s[8:11], 0 offset:32 sc1
    buffer_load_dword v10, off, s[8:11], 0 offset:112 sc1
    s_waitcnt vmcnt(8)
    s_waitcnt lgkmcnt(0)
    s_barrier
    ds_write_b128 v4, v[56:59] offset:26624
    ds_write_b128 v4, v[60:63] offset:27648
    ds_read2st64_b32 v[12:13], v52 offset0:112 offset1:116
    ds_read2st64_b32 v[14:15], v53 offset0:112 offset1:116
    ds_read2st64_b32 v[16:17], v54 offset0:112 offset1:116
    ds_read2st64_b32 v[18:19], v55 offset0:112 offset1:116
    s_waitcnt vmcnt(6)
    s_waitcnt lgkmcnt(0)
    s_barrier
    ds_write_b128 v4, v[12:15] offset:28672
    ds_write_b128 v4, v[16:19] offset:29696
    ds_read2st64_b32 v[56:57], v52 offset0:120 offset1:124
    ds_read2st64_b32 v[58:59], v53 offset0:120 offset1:124
    ds_read2st64_b32 v[60:61], v54 offset0:120 offset1:124
    ds_read2st64_b32 v[62:63], v55 offset0:120 offset1:124
    s_waitcnt vmcnt(4)
    s_waitcnt lgkmcnt(0)
    s_barrier
    ds_write_b128 v4, v[56:59] offset:30720
    ds_write_b128 v4, v[60:63] offset:31744
    ds_read2st64_b32 v[12:13], v52 offset0:128 offset1:132
    ds_read2st64_b32 v[14:15], v53 offset0:128 offset1:132
    ds_read2st64_b32 v[16:17], v54 offset0:128 offset1:132
    ds_read2st64_b32 v[18:19], v55 offset0:128 offset1:132
    s_waitcnt vmcnt(2)
    s_waitcnt lgkmcnt(0)
    s_barrier
    ds_write_b128 v4, v[12:15] offset:32768
    ds_write_b128 v4, v[16:19] offset:33792
    ds_read2st64_b32 v[56:57], v52 offset0:136 offset1:140
    ds_read2st64_b32 v[58:59], v53 offset0:136 offset1:140
    ds_read2st64_b32 v[60:61], v54 offset0:136 offset1:140
    ds_read2st64_b32 v[62:63], v55 offset0:136 offset1:140
    s_waitcnt vmcnt(1)
    v_readfirstlane_b32 s70, v8
    s_waitcnt vmcnt(0)
    v_readfirstlane_b32 s71, v10
    v_readfirstlane_b32 s60, v9
    s_lshl_b32 s71, s71, 16
    s_or_b32 s70, s70, s71
    s_cmp_eq_u32 s60, 0
    s_cselect_b32 s70, 0, s70
    s_cmp_eq_u32 s70, 2097216
    s_cbranch_scc0 L_rdy0
L_rdy0_ok:
    buffer_load_dwordx4 v[64:67], v0, s[4:7], s30 offen offset:0 sc1
    buffer_load_dwordx4 v[68:71], v0, s[4:7], s30 offen offset:1024 sc1
    s_add_u32 s30, s30, 524288
    s_sub_u32 s60, s60, 1
    s_lshl_b32 s60, s60, 13
    s_add_u32 s26, s26, s60
    s_add_u32 s23, s23, s60
    s_waitcnt lgkmcnt(0)
    s_barrier
    ds_write_b128 v4, v[56:59] offset:34816
    ds_write_b128 v4, v[60:63] offset:35840
    s_waitcnt lgkmcnt(0)
    ds_read_b128 v[48:51], v4 offset:0
    ds_read_b128 v[52:55], v4 offset:1024
    ds_read_b128 v[56:59], v4 offset:14336
    ds_read_b128 v[60:63], v4 offset:15360
    v_mov_b64 v[28:29], 0
    v_mov_b64 v[30:31], 0
    v_mov_b64 v[32:33], 0
    v_mov_b64 v[34:35], 0
    v_mov_b64 v[36:37], 0
    v_mov_b64 v[38:39], 0
    s_mov_b32 s18, 0
    s_mov_b32 s19, 0
    s_mov_b32 s35, 1
    s_waitcnt lgkmcnt(0)
    s_waitcnt vmcnt(0)
    s_barrier
    s_cmp_eq_u32 s17, 0
    s_cbranch_scc1 L_ch0_w0
    s_cmp_eq_u32 s17, 1
    s_cbranch_scc1 L_ch0_w1
    s_cmp_eq_u32 s17, 2
    s_cbranch_scc1 L_ch0_w2
    s_branch L_ch0_w3
L_rdy0:
    s_add_u32 s19, s19, 1
    s_cmp_gt_u32 s19, 3000000
    s_cbranch_scc1 L_cend0
    s_sleep 8
    buffer_load_dwordx2 v[8:9], off, s[8:11], 0 offset:32 sc1
    buffer_load_dword v10, off, s[8:11], 0 offset:112 sc1
    s_waitcnt vmcnt(0)
    v_readfirstlane_b32 s70, v8
    v_readfirstlane_b32 s71, v10
    v_readfirstlane_b32 s60, v9
    s_lshl_b32 s71, s71, 16
    s_or_b32 s70, s70, s71
    s_cmp_eq_u32 s60, 0
    s_cselect_b32 s70, 0, s70
    s_cmp_eq_u32 s70, 2097216
    s_cbranch_scc0 L_rdy0
    s_branch L_rdy0_ok
    .p2align 6
L_ch0_w0:
    ds_read_b128 v[12:15], v3 offset:0
    s_waitcnt vmcnt(2)
    ds_read_b128 v[16:19], v3 offset:32
    s_waitcnt lgkmcnt(1)
    v_smfmac_f32_16x16x64_bf16 v[28:31], v[12:15], v[48:55], v1
    s_waitcnt vmcnt(1)
    ds_read_b128 v[20:23], v3 offset:1024
    v_smfmac_f32_16x16x64_bf16 v[32:35], v[12:15], v[56:63], v1
    ds_read_b128 v[48:51], v4 offset:2048
    v_smfmac_f32_16x16x64_bf16 v[36:39], v[12:15], v[80:87], v1
    ds_read_b128 v[24:27], v3 offset:1056
    s_waitcnt lgkmcnt(3)
    v_smfmac_f32_16x16x64_bf16 v[28:31], v[16:19], v[88:95], v1
    ds_read_b128 v[52:55], v4 offset:3072
    v_smfmac_f32_16x16x64_bf16 v[32:35], v[16:19], v[96:103], v1
    ds_read_b128 v[56:59], v4 offset:16384
    v_smfmac_f32_16x16x64_bf16 v[36:39], v[16:19], v[104:111], v1
    ds_read_b128 v[12:15], v3 offset:2048
    s_waitcnt lgkmcnt(5)
    v_smfmac_f32_16x16x64_bf16 v[28:31], v[20:23], v[112:119], v1
    ds_read_b128 v[60:63], v4 offset:17408
    v_smfmac_f32_16x16x64_bf16 v[32:35], v[20:23], v[120:127], v1
    s_waitcnt lgkmcnt(3)
    v_smfmac_f32_16x16x64_bf16 v[36:39], v[20:23], v[48:55], v1
    ds_read_b128 v[16:19], v3 offset:2080
    v_smfmac_f32_16x16x64_bf16 v[28:31], v[24:27], v[128:135], v1
    ds_read_b128 v[48:51], v4 offset:4096
    v_smfmac_f32_16x16x64_bf16 v[32:35], v[24:27], v[136:143], v1
    ds_read_b128 v[52:55], v4 offset:5120
    v_smfmac_f32_16x16x64_bf16 v[36:39], v[24:27], v[144:151], v1
    ds_read_b128 v[20:23], v3 offset:3072
    s_waitcnt lgkmcnt(4)
    v_smfmac_f32_16x16x64_bf16 v[28:31], v[12:15], v[56:63], v1
    ds_read_b128 v[56:59], v4 offset:18432
    v_smfmac_f32_16x16x64_bf16 v[32:35], v[12:15], v[152:159], v1
    ds_read_b128 v[60:63], v4 offset:19456
    v_smfmac_f32_16x16x64_bf16 v[36:39], v[12:15], v[160:167], v1
    ds_read_b128 v[24:27], v3 offset:3104
    s_waitcnt lgkmcnt(6)
    v_smfmac_f32_16x16x64_bf16 v[28:31], v[16:19], v[168:175], v1
    s_waitcnt lgkmcnt(4)
    v_smfmac_f32_16x16x64_bf16 v[32:35], v[16:19], v[48:55], v1
    ds_read_b128 v[48:51], v4 offset:6144
    v_smfmac_f32_16x16x64_bf16 v[36:39], v[16:19], v[176:183], v1
    ds_read_b128 v[12:15], v3 offset:4096
    s_waitcnt lgkmcnt(5)
    v_smfmac_f32_16x16x64_bf16 v[28:31], v[20:23], v[184:191], v1
    ds_read_b128 v[52:55], v4 offset:7168
    v_smfmac_f32_16x16x64_bf16 v[32:35], v[20:23], v[192:199], v1
    s_waitcnt lgkmcnt(4)
    v_smfmac_f32_16x16x64_bf16 v[36:39], v[20:23], v[56:63], v1
    ds_read_b128 v[16:19], v3 offset:4128
    s_waitcnt lgkmcnt(4)
    v_smfmac_f32_16x16x64_bf16 v[28:31], v[24:27], v[200:207], v1
    ds_read_b128 v[56:59], v4 offset:20480
    v_smfmac_f32_16x16x64_bf16 v[32:35], v[24:27], v[208:215], v1
    s_waitcnt vmcnt(0)
    ds_write_b128 v0, v[40:43] offset:6144
    v_bitop3_b32 v8, v40, v41, v42 bitop3:0x80
    v_smfmac_f32_16x16x64_bf16 v[36:39], v[24:27], v[216:223], v1
    ds_read_b128 v[20:23], v3 offset:5120
    v_and_b32 v8, v8, v43
    s_waitcnt lgkmcnt(4)
    v_smfmac_f32_16x16x64_bf16 v[28:31], v[12:15], v[48:55], v1
    ds_read_b128 v[60:63], v4 offset:21504
    v_and_or_b32 v8, v8, 1, s35
    v_smfmac_f32_16x16x64_bf16 v[32:35], v[12:15], v[224:231], v1
    ds_read_b128 v[48:51], v4 offset:8192
    v_cmp_ne_u32 vcc, 1, v8
    v_smfmac_f32_16x16x64_bf16 v[36:39], v[12:15], v[232:239], v1
    ds_read_b128 v[24:27], v3 offset:5152
    s_nop 0
    s_waitcnt lgkmcnt(6)
    v_smfmac_f32_16x16x64_bf16 v[28:31], v[16:19], v[240:247], v1
    ds_read_b128 v[52:55], v4 offset:9216
    s_cbranch_vccnz L_c2_L_ch00e_r
L_c2_L_ch00e:
    s_waitcnt lgkmcnt(3)
    v_smfmac_f32_16x16x64_bf16 v[32:35], v[16:19], v[56:63], v1
    ds_read_b128 v[56:59], v4 offset:22528
    v_smfmac_f32_16x16x64_bf16 v[36:39], v[16:19], v[248:255], v1
    ds_read_b128 v[60:63], v4 offset:23552
    buffer_load_dwordx4 v[72:75], v0, s[4:7], s27 offen offset:2048 sc1
    v_smfmac_f32_16x16x64_bf16 v[28:31], v[20:23], a[0:7], v1
    s_barrier
    s_mov_b64 vcc, s[36:37]
    s_mov_b32 s35, 0
    v_smfmac_f32_16x16x64_bf16 v[32:35], v[20:23], a[8:15], v1
    ds_read_b128 v[12:15], v3 offset:6144
    buffer_load_dwordx4 v[76:79], v0, s[4:7], s27 offen offset:3072 sc1
    v_cndmask_b32 v40, 0, v2, s[38:39]
    s_waitcnt lgkmcnt(3)
    v_smfmac_f32_16x16x64_bf16 v[36:39], v[20:23], v[48:55], v1
    ds_read_b128 v[16:19], v3 offset:6176
    v_cndmask_b32 v41, 0, v2, s[40:41]
    v_smfmac_f32_16x16x64_bf16 v[28:31], v[24:27], a[16:23], v1
    ds_read_b128 v[48:51], v4 offset:10240
    v_smfmac_f32_16x16x64_bf16 v[32:35], v[24:27], a[24:31], v1
    ds_read_b128 v[52:55], v4 offset:11264
    v_smfmac_f32_16x16x64_bf16 v[36:39], v[24:27], a[32:39], v1
    ds_read_b128 v[20:23], v3 offset:7168
    s_waitcnt lgkmcnt(4)
    v_smfmac_f32_16x16x64_bf16 v[28:31], v[12:15], v[56:63], v1
    ds_read_b128 v[56:59], v4 offset:24576
    v_smfmac_f32_16x16x64_bf16 v[32:35], v[12:15], a[40:47], v1
    ds_read_b128 v[60:63], v4 offset:25600
    v_smfmac_f32_16x16x64_bf16 v[36:39], v[12:15], a[48:55], v1
    ds_read_b128 v[24:27], v3 offset:7200
    s_waitcnt lgkmcnt(6)
    v_smfmac_f32_16x16x64_bf16 v[28:31], v[16:19], a[56:63], v1
    s_waitcnt lgkmcnt(4)
    v_smfmac_f32_16x16x64_bf16 v[32:35], v[16:19], v[48:55], v1
    ds_read_b128 v[48:51], v4 offset:12288
    v_smfmac_f32_16x16x64_bf16 v[36:39], v[16:19], a[64:71], v1
    ds_read_b128 v[12:15], v3 offset:8192
    s_waitcnt lgkmcnt(5)
    v_smfmac_f32_16x16x64_bf16 v[28:31], v[20:23], a[72:79], v1
    ds_read_b128 v[52:55], v4 offset:13312
    v_smfmac_f32_16x16x64_bf16 v[32:35], v[20:23], a[80:87], v1
    ds_read_b128 v[16:19], v3 offset:8224
    s_waitcnt lgkmcnt(5)
    v_smfmac_f32_16x16x64_bf16 v[36:39], v[20:23], v[56:63], v1
    ds_read_b128 v[56:59], v4 offset:26624
    s_waitcnt lgkmcnt(5)
    v_smfmac_f32_16x16x64_bf16 v[28:31], v[24:27], a[88:95], v1
    ds_read_b128 v[20:23], v3 offset:9216
    v_smfmac_f32_16x16x64_bf16 v[32:35], v[24:27], a[96:103], v1
    ds_read_b128 v[60:63], v4 offset:27648
    v_smfmac_f32_16x16x64_bf16 v[36:39], v[24:27], a[104:111], v1
    ds_read_b128 v[24:27], v3 offset:9248
    s_waitcnt lgkmcnt(5)
    v_smfmac_f32_16x16x64_bf16 v[28:31], v[12:15], v[48:55], v1
    v_smfmac_f32_16x16x64_bf16 v[32:35], v[12:15], a[112:119], v1
    s_waitcnt lgkmcnt(4)
    v_smfmac_f32_16x16x64_bf16 v[28:31], v[16:19], a[120:127], v1
    v_smfmac_f32_16x16x64_bf16 v[32:35], v[16:19], a[128:135], v1
    s_waitcnt lgkmcnt(1)
    v_smfmac_f32_16x16x64_bf16 v[28:31], v[20:23], v[56:63], v1
    v_smfmac_f32_16x16x64_bf16 v[32:35], v[20:23], a[136:143], v1
    s_waitcnt lgkmcnt(0)
    v_smfmac_f32_16x16x64_bf16 v[28:31], v[24:27], a[144:151], v1
    v_smfmac_f32_16x16x64_bf16 v[32:35], v[24:27], a[152:159], v1
    v_smfmac_f32_16x16x64_bf16 v[36:39], v[12:15], a[160:167], v1
    v_smfmac_f32_16x16x64_bf16 v[36:39], v[16:19], a[168:175], v1
    v_cvt_pk_bf16_f32 v44, v28, v29
    v_cvt_pk_bf16_f32 v45, v32, v33
    v_cvt_pk_bf16_f32 v46, v30, v31
    v_cvt_pk_bf16_f32 v47, v34, v35
    v_mfma_f32_16x16x16_bf16 v[28:31], v[44:45], v[40:41], 0
    v_mfma_f32_16x16x16_bf16 v[32:35], v[46:47], v[40:41], 0
    v_smfmac_f32_16x16x64_bf16 v[36:39], v[20:23], a[176:183], v1
    s_nop 3
    v_cvt_pk_bf16_f32 v44, v28, v32
    v_cvt_pk_bf16_f32 v45, v29, v33
    v_cvt_pk_bf16_f32 v46, v30, v34
    v_cvt_pk_bf16_f32 v47, v31, v35
    s_nop 1
    v_mfma_f32_16x16x32_bf16 v[32:35], v[68:71], v[44:47], 0
    v_mfma_f32_16x16x32_bf16 v[28:31], v[64:67], v[44:47], 0
    v_mfma_f32_16x16x32_bf16 v[12:15], v[44:47], v[44:47], 0
    v_smfmac_f32_16x16x64_bf16 v[36:39], v[24:27], a[184:191], v1
    v_cndmask_b32_dpp v28, v32, v28, vcc quad_perm:[2,3,2,3] row_mask:0xf bank_mask:0xf
    v_cndmask_b32_dpp v29, v33, v29, vcc quad_perm:[2,3,2,3] row_mask:0xf bank_mask:0xf
    v_cndmask_b32_dpp v30, v34, v30, vcc quad_perm:[2,3,2,3] row_mask:0xf bank_mask:0xf
    v_cndmask_b32_dpp v31, v35, v31, vcc quad_perm:[2,3,2,3] row_mask:0xf bank_mask:0xf
    ds_write_b128 v0, v[28:31] offset:10240
    v_cndmask_b32_dpp v11, v13, v12, vcc quad_perm:[2,3,2,3] row_mask:0xf bank_mask:0xf
    ds_write_b32 v0, v11 offset:14336
    buffer_load_dwordx4 v[64:67], v0, s[4:7], s30 offen offset:0 sc1
    buffer_load_dwordx4 v[68:71], v0, s[4:7], s30 offen offset:1024 sc1
    s_waitcnt lgkmcnt(0)
    s_barrier
    ds_read_b128 v[24:27], v0 offset:14336
    ds_read_b128 v[28:31], v0 offset:10240
    ds_read_b128 v[32:35], v0 offset:11264
    ds_read_b128 v[16:19], v0 offset:12288
    ds_read_b128 v[20:23], v0 offset:13312
    v_cvt_pk_bf16_f32 v42, v36, v37
    v_cvt_pk_bf16_f32 v43, v38, v39
    v_mov_b32 v13, 0
    v_mov_b32 v14, 0
    s_waitcnt lgkmcnt(4)
    v_pk_add_f32 v[24:25], v[24:25], v[26:27]
    v_add_f32 v24, v24, v25
    v_mul_f32 v40, s20, v24
    s_waitcnt lgkmcnt(3)
    v_pk_mul_f32 v[28:29], v[28:29], s[48:49]
    v_pk_mul_f32 v[30:31], v[30:31], s[48:49]
    v_exp_f32 v11, v40
    s_waitcnt lgkmcnt(2)
    v_pk_fma_f32 v[28:29], v[32:33], s[48:49], v[28:29]
    v_pk_fma_f32 v[30:31], v[34:35], s[48:49], v[30:31]
    s_waitcnt lgkmcnt(1)
    v_pk_fma_f32 v[28:29], v[16:17], s[48:49], v[28:29]
    v_pk_fma_f32 v[30:31], v[18:19], s[48:49], v[30:31]
    s_waitcnt lgkmcnt(0)
    v_pk_fma_f32 v[28:29], v[20:21], s[48:49], v[28:29]
    v_pk_fma_f32 v[30:31], v[22:23], s[48:49], v[30:31]
    v_mov_b32_dpp v9, v11 quad_perm:[0,1,0,1] row_mask:0xf bank_mask:0xf
    v_exp_f32 v16, v28
    v_exp_f32 v17, v29
    v_cvt_pk_bf16_f32 v12, v11, v9
    v_cvt_pk_bf16_f32 v15, v11, v9
    v_cvt_pk_bf16_f32 v32, v16, v17
    v_exp_f32 v18, v30
    v_mfma_f32_16x16x16_bf16 v[20:23], v[42:43], v[12:13], 0
    ds_read_b128 v[48:51], v4 offset:28672
    v_exp_f32 v19, v31
    v_mov_b32_dpp v34, v32 quad_perm:[0,1,0,1] row_mask:0xf bank_mask:0xf
    v_cvt_pk_bf16_f32 v33, v18, v19
    v_mfma_f32_16x16x16_bf16 v[24:27], v[42:43], v[14:15], 0
    ds_read_b128 v[52:55], v4 offset:29696
    v_add_f32 v8, v16, v17
    v_mov_b32_dpp v35, v33 quad_perm:[0,1,0,1] row_mask:0xf bank_mask:0xf
    v_add_f32 v10, v18, v19
    v_add_f32 v8, v8, v11
    s_waitcnt vmcnt(3)
    v_mfma_f32_16x16x32_bf16 v[20:23], v[72:75], v[32:35], v[20:23]
    ds_read_b128 v[56:59], v4 offset:32768
    v_add_f32 v8, v8, v10
    s_waitcnt vmcnt(2)
    v_mfma_f32_16x16x32_bf16 v[24:27], v[76:79], v[32:35], v[24:27]
    ds_read_b128 v[60:63], v4 offset:33792
    v_add_f32_dpp v9, v8, v8 quad_perm:[2,3,0,1] row_mask:0xf bank_mask:0xf
    v_add_f32_dpp v10, v8, v8 quad_perm:[2,3,0,1] row_mask:0xf bank_mask:0xf
    s_nop 1
    v_permlane16_swap_b32 v9, v10
    v_add_f32 v8, v9, v10
    v_add_f32 v9, v9, v10
    s_nop 1
    v_permlane32_swap_b32 v8, v9
    v_add_f32 v8, v8, v9
    v_rcp_f32 v10, v8
    v_subrev_u32 v8, s47, v8
    v_cmp_le_u32 s[44:45], s50, v8
    v_pk_mul_f32 v[20:21], v[20:21], v[10:11] op_sel_hi:[1,0]
    v_pk_mul_f32 v[22:23], v[22:23], v[10:11] op_sel_hi:[1,0]
    v_pk_mul_f32 v[24:25], v[24:25], v[10:11] op_sel_hi:[1,0]
    v_pk_mul_f32 v[26:27], v[26:27], v[10:11] op_sel_hi:[1,0]
    v_cvt_pk_bf16_f32 v32, v20, v24
    v_cvt_pk_bf16_f32 v33, v21, v25
    v_cvt_pk_bf16_f32 v34, v22, v26
    v_cvt_pk_bf16_f32 v35, v23, v27
    s_cmp_lg_u64 s[44:45], 0
    s_cbranch_scc1 L_sm_L_ch00e_r
L_sm_L_ch00e:
    s_mov_b64 exec, s[36:37]
    ds_write_b128 v3, v[32:35] offset:6144
    s_mov_b64 exec, -1
    v_mov_b64 v[36:37], 0
    v_mov_b64 v[38:39], 0
    v_mov_b64 v[40:41], 0
    v_mov_b64 v[42:43], 0
    v_mov_b64 v[44:45], 0
    v_mov_b64 v[46:47], 0
    s_waitcnt lgkmcnt(0)
    s_barrier
    ds_read_b128 v[12:15], v3 offset:6144
    ds_read_b128 v[16:19], v3 offset:6176
    ds_read_b128 v[20:23], v3 offset:7168
    ds_read_b128 v[24:27], v3 offset:7200
    s_waitcnt lgkmcnt(3)
    v_smfmac_f32_16x16x64_bf16 v[36:39], v[12:15], v[48:55], v1
    ds_read_b128 v[72:75], v4 offset:34816
    s_waitcnt lgkmcnt(3)
    v_smfmac_f32_16x16x64_bf16 v[36:39], v[16:19], v[56:63], v1
    ds_read_b128 v[76:79], v4 offset:35840
    s_waitcnt lgkmcnt(3)
    v_smfmac_f32_16x16x64_bf16 v[36:39], v[20:23], a[192:199], v1
    ds_read_b128 v[48:51], v4 offset:30720
    s_waitcnt lgkmcnt(3)
    v_smfmac_f32_16x16x64_bf16 v[36:39], v[24:27], a[200:207], v1
    ds_read_b128 v[52:55], v4 offset:31744
    v_smfmac_f32_16x16x64_bf16 v[40:43], v[12:15], a[208:215], v1
    v_smfmac_f32_16x16x64_bf16 v[40:43], v[16:19], a[216:223], v1
    v_cvt_pk_bf16_f32 v36, v36, v37
    s_waitcnt lgkmcnt(2)
    v_smfmac_f32_16x16x64_bf16 v[40:43], v[20:23], v[72:79], v1
    v_and_b32 v36, -2, v36
    v_smfmac_f32_16x16x64_bf16 v[40:43], v[24:27], a[224:231], v1
    buffer_store_dword v36, v5, s[4:7], s28 offen
    v_cvt_pk_bf16_f32 v37, v38, v39
    v_smfmac_f32_16x16x64_bf16 v[44:47], v[12:15], a[232:239], v1
    v_and_b32 v37, -2, v37
    s_waitcnt lgkmcnt(0)
    v_smfmac_f32_16x16x64_bf16 v[44:47], v[16:19], v[48:55], v1
    buffer_store_dword v37, v5, s[4:7], s29 offen
    v_cvt_pk_bf16_f32 v40, v40, v41
    v_smfmac_f32_16x16x64_bf16 v[44:47], v[20:23], a[240:247], v1
    v_and_b32 v40, -2, v40
    v_smfmac_f32_16x16x64_bf16 v[44:47], v[24:27], a[248:255], v1
    buffer_store_dword v40, v5, s[4:7], s46 offen
    v_cvt_pk_bf16_f32 v41, v42, v43
    v_and_b32 v41, -2, v41
    buffer_store_dword v41, v5, s[4:7], s73 offen
    s_nop 2
    v_cvt_pk_bf16_f32 v44, v44, v45
    v_cvt_pk_bf16_f32 v45, v46, v47
    v_and_b32 v44, -2, v44
    v_and_b32 v45, -2, v45
    buffer_store_dword v44, v5, s[4:7], s74 offen
    buffer_store_dword v45, v5, s[4:7], s75 offen
    ds_read_b128 v[48:51], v4 offset:0
    ds_read_b128 v[52:55], v4 offset:1024
    ds_read_b128 v[56:59], v4 offset:14336
    ds_read_b128 v[60:63], v4 offset:15360
    v_cndmask_b32 v20, 0, v2, s[42:43]
    v_cndmask_b32 v21, 0, v2, s[42:43]
    v_cndmask_b32 v22, 0, v2, s[42:43]
    v_cndmask_b32 v23, 0, v2, s[42:43]
    s_nop 9
    buffer_load_dword v12, v7, s[4:7], s21 offen offset:0 sc1
    buffer_load_dword v13, v7, s[4:7], s21 offen offset:256 sc1
    buffer_load_dword v14, v7, s[4:7], s21 offen offset:512 sc1
    buffer_load_dword v15, v7, s[4:7], s21 offen offset:768 sc1
    buffer_load_dword v16, v7, s[4:7], s21 offen offset:1024 sc1
    buffer_load_dword v17, v7, s[4:7], s21 offen offset:1280 sc1
    buffer_load_dword v18, v7, s[4:7], s21 offen offset:1536 sc1
    buffer_load_dword v19, v7, s[4:7], s21 offen offset:1792 sc1
    v_mov_b64 v[36:37], 0
    v_mov_b64 v[38:39], 0
    v_mov_b64 v[28:29], 0
    v_mov_b64 v[30:31], 0
    s_add_u32 s26, s26, 32768
    s_add_u32 s23, s23, 32768
    s_add_u32 s30, s30, 524288
    s_add_u32 s27, s27, 524288
    s_nop 14
    buffer_load_dword v40, v7, s[4:7], s21 offen offset:0 sc1
    buffer_load_dword v41, v7, s[4:7], s21 offen offset:256 sc1
    buffer_load_dword v42, v7, s[4:7], s21 offen offset:512 sc1
    buffer_load_dword v43, v7, s[4:7], s21 offen offset:768 sc1
    buffer_load_dword v44, v7, s[4:7], s21 offen offset:1024 sc1
    buffer_load_dword v45, v7, s[4:7], s21 offen offset:1280 sc1
    buffer_load_dword v46, v7, s[4:7], s21 offen offset:1536 sc1
    buffer_load_dword v47, v7, s[4:7], s21 offen offset:1792 sc1
    s_waitcnt vmcnt(12)
    v_mfma_f32_16x16x32_bf16 v[32:35], v[12:15], v[20:23], 0
    v_or3_b32 v8, v12, v13, v14
    s_waitcnt vmcnt(8)
    v_mfma_f32_16x16x32_bf16 v[32:35], v[16:19], v[20:23], v[32:35]
    v_or3_b32 v8, v8, v15, v16
    v_or3_b32 v8, v8, v17, v18
    v_or_b32 v8, v8, v19
    v_and_b32 v8, 1, v8
    v_cmp_ne_u32 vcc, 0, v8
    s_nop 1
    v_cvt_pk_bf16_f32 v10, v32, v33
    v_cvt_pk_bf16_f32 v11, v34, v35
    v_and_b32 v10, -2, v10
    v_and_b32 v11, -2, v11
    s_cbranch_vccnz L_c1_L_ch00e_r
L_c1_L_ch00e:
    buffer_store_dwordx2 v[10:11], v6, s[4:7], s25 offen
    s_barrier
    buffer_store_dwordx2 v[10:11], v6, s[4:7], s26 offen sc1
    s_add_u32 s18, s18, 1
    v_mov_b64 v[32:33], 0
    v_mov_b64 v[34:35], 0
    s_nop 15
    s_nop 15
    s_nop 15
    s_nop 6
    buffer_load_dwordx4 v[24:27], v0, s[4:7], s22 offen sc1
    buffer_load_dwordx4 v[44:47], v0, s[4:7], s24 offen sc1
    s_nop 15
    s_nop 3
    buffer_load_dwordx4 v[16:19], v0, s[4:7], s22 offen sc1
    buffer_load_dwordx4 v[20:23], v0, s[4:7], s24 offen sc1
    s_waitcnt vmcnt(3)
    v_or3_b32 v8, v24, v25, v26
    s_waitcnt vmcnt(2)
    v_or3_b32 v8, v8, v27, v44
    v_or3_b32 v8, v8, v45, v46
    v_or_b32 v8, v8, v47
    v_and_b32 v8, 1, v8
    v_cmp_ne_u32 vcc, 0, v8
    ds_write_b128 v0, v[24:27] offset:0
    ds_write_b128 v0, v[44:47] offset:4096
    s_cbranch_vccnz L_c3_L_ch00e_r
L_c3_L_ch00e:
    buffer_load_dwordx4 v[40:43], v0, s[4:7], s23 offen sc1
    s_waitcnt lgkmcnt(0)
    s_barrier
    ds_read_b128 v[12:15], v3 offset:0
    s_waitcnt vmcnt(2)
    ds_read_b128 v[16:19], v3 offset:32
    s_waitcnt lgkmcnt(1)
    v_smfmac_f32_16x16x64_bf16 v[28:31], v[12:15], v[48:55], v1
    s_waitcnt vmcnt(1)
    ds_read_b128 v[20:23], v3 offset:1024
    v_smfmac_f32_16x16x64_bf16 v[32:35], v[12:15], v[56:63], v1
    ds_read_b128 v[48:51], v4 offset:2048
    v_smfmac_f32_16x16x64_bf16 v[36:39], v[12:15], v[80:87], v1
    ds_read_b128 v[24:27], v3 offset:1056
    s_waitcnt lgkmcnt(3)
    v_smfmac_f32_16x16x64_bf16 v[28:31], v[16:19], v[88:95], v1
    ds_read_b128 v[52:55], v4 offset:3072
    v_smfmac_f32_16x16x64_bf16 v[32:35], v[16:19], v[96:103], v1
    ds_read_b128 v[56:59], v4 offset:16384
    v_smfmac_f32_16x16x64_bf16 v[36:39], v[16:19], v[104:111], v1
    ds_read_b128 v[12:15], v3 offset:2048
    s_waitcnt lgkmcnt(5)
    v_smfmac_f32_16x16x64_bf16 v[28:31], v[20:23], v[112:119], v1
    ds_read_b128 v[60:63], v4 offset:17408
    v_smfmac_f32_16x16x64_bf16 v[32:35], v[20:23], v[120:127], v1
    s_waitcnt lgkmcnt(3)
    v_smfmac_f32_16x16x64_bf16 v[36:39], v[20:23], v[48:55], v1
    ds_read_b128 v[16:19], v3 offset:2080
    v_smfmac_f32_16x16x64_bf16 v[28:31], v[24:27], v[128:135], v1
    ds_read_b128 v[48:51], v4 offset:4096
    v_smfmac_f32_16x16x64_bf16 v[32:35], v[24:27], v[136:143], v1
    ds_read_b128 v[52:55], v4 offset:5120
    v_smfmac_f32_16x16x64_bf16 v[36:39], v[24:27], v[144:151], v1
    ds_read_b128 v[20:23], v3 offset:3072
    s_waitcnt lgkmcnt(4)
    v_smfmac_f32_16x16x64_bf16 v[28:31], v[12:15], v[56:63], v1
    ds_read_b128 v[56:59], v4 offset:18432
    v_smfmac_f32_16x16x64_bf16 v[32:35], v[12:15], v[152:159], v1
    ds_read_b128 v[60:63], v4 offset:19456
    v_smfmac_f32_16x16x64_bf16 v[36:39], v[12:15], v[160:167], v1
    ds_read_b128 v[24:27], v3 offset:3104
    s_waitcnt lgkmcnt(6)
    v_smfmac_f32_16x16x64_bf16 v[28:31], v[16:19], v[168:175], v1
    s_waitcnt lgkmcnt(4)
    v_smfmac_f32_16x16x64_bf16 v[32:35], v[16:19], v[48:55], v1
    ds_read_b128 v[48:51], v4 offset:6144
    v_smfmac_f32_16x16x64_bf16 v[36:39], v[16:19], v[176:183], v1
    ds_read_b128 v[12:15], v3 offset:4096
    s_waitcnt lgkmcnt(5)
    v_smfmac_f32_16x16x64_bf16 v[28:31], v[20:23], v[184:191], v1
    ds_read_b128 v[52:55], v4 offset:7168
    v_smfmac_f32_16x16x64_bf16 v[32:35], v[20:23], v[192:199], v1
    s_waitcnt lgkmcnt(4)
    v_smfmac_f32_16x16x64_bf16 v[36:39], v[20:23], v[56:63], v1
    ds_read_b128 v[16:19], v3 offset:4128
    s_waitcnt lgkmcnt(4)
    v_smfmac_f32_16x16x64_bf16 v[28:31], v[24:27], v[200:207], v1
    ds_read_b128 v[56:59], v4 offset:20480
    v_smfmac_f32_16x16x64_bf16 v[32:35], v[24:27], v[208:215], v1
    s_waitcnt vmcnt(0)
    ds_write_b128 v0, v[40:43] offset:6144
    v_or3_b32 v8, v40, v41, v42
    v_smfmac_f32_16x16x64_bf16 v[36:39], v[24:27], v[216:223], v1
    ds_read_b128 v[20:23], v3 offset:5120
    v_or_b32 v8, v8, v43
    s_waitcnt lgkmcnt(4)
    v_smfmac_f32_16x16x64_bf16 v[28:31], v[12:15], v[48:55], v1
    ds_read_b128 v[60:63], v4 offset:21504
    v_and_b32 v8, 1, v8
    v_smfmac_f32_16x16x64_bf16 v[32:35], v[12:15], v[224:231], v1
    ds_read_b128 v[48:51], v4 offset:8192
    v_cmp_ne_u32 vcc, 0, v8
    v_smfmac_f32_16x16x64_bf16 v[36:39], v[12:15], v[232:239], v1
    ds_read_b128 v[24:27], v3 offset:5152
    s_nop 0
    s_waitcnt lgkmcnt(6)
    v_smfmac_f32_16x16x64_bf16 v[28:31], v[16:19], v[240:247], v1
    ds_read_b128 v[52:55], v4 offset:9216
    s_cbranch_vccnz L_c2_L_ch00o_r
L_c2_L_ch00o:
    s_waitcnt lgkmcnt(3)
    v_smfmac_f32_16x16x64_bf16 v[32:35], v[16:19], v[56:63], v1
    ds_read_b128 v[56:59], v4 offset:22528
    v_smfmac_f32_16x16x64_bf16 v[36:39], v[16:19], v[248:255], v1
    ds_read_b128 v[60:63], v4 offset:23552
    buffer_load_dwordx4 v[72:75], v0, s[4:7], s27 offen offset:2048 sc1
    v_smfmac_f32_16x16x64_bf16 v[28:31], v[20:23], a[0:7], v1
    s_barrier
    s_mov_b64 vcc, s[36:37]
    v_smfmac_f32_16x16x64_bf16 v[32:35], v[20:23], a[8:15], v1
    ds_read_b128 v[12:15], v3 offset:6144
    buffer_load_dwordx4 v[76:79], v0, s[4:7], s27 offen offset:3072 sc1
    v_cndmask_b32 v40, 0, v2, s[38:39]
    s_waitcnt lgkmcnt(3)
    v_smfmac_f32_16x16x64_bf16 v[36:39], v[20:23], v[48:55], v1
    ds_read_b128 v[16:19], v3 offset:6176
    v_cndmask_b32 v41, 0, v2, s[40:41]
    v_smfmac_f32_16x16x64_bf16 v[28:31], v[24:27], a[16:23], v1
    ds_read_b128 v[48:51], v4 offset:10240
    v_smfmac_f32_16x16x64_bf16 v[32:35], v[24:27], a[24:31], v1
    ds_read_b128 v[52:55], v4 offset:11264
    v_smfmac_f32_16x16x64_bf16 v[36:39], v[24:27], a[32:39], v1
    ds_read_b128 v[20:23], v3 offset:7168
    s_waitcnt lgkmcnt(4)
    v_smfmac_f32_16x16x64_bf16 v[28:31], v[12:15], v[56:63], v1
    ds_read_b128 v[56:59], v4 offset:24576
    v_smfmac_f32_16x16x64_bf16 v[32:35], v[12:15], a[40:47], v1
    ds_read_b128 v[60:63], v4 offset:25600
    v_smfmac_f32_16x16x64_bf16 v[36:39], v[12:15], a[48:55], v1
    ds_read_b128 v[24:27], v3 offset:7200
    s_waitcnt lgkmcnt(6)
    v_smfmac_f32_16x16x64_bf16 v[28:31], v[16:19], a[56:63], v1
    s_waitcnt lgkmcnt(4)
    v_smfmac_f32_16x16x64_bf16 v[32:35], v[16:19], v[48:55], v1
    ds_read_b128 v[48:51], v4 offset:12288
    v_smfmac_f32_16x16x64_bf16 v[36:39], v[16:19], a[64:71], v1
    ds_read_b128 v[12:15], v3 offset:8192
    s_waitcnt lgkmcnt(5)
    v_smfmac_f32_16x16x64_bf16 v[28:31], v[20:23], a[72:79], v1
    ds_read_b128 v[52:55], v4 offset:13312
    v_smfmac_f32_16x16x64_bf16 v[32:35], v[20:23], a[80:87], v1
    ds_read_b128 v[16:19], v3 offset:8224
    s_waitcnt lgkmcnt(5)
    v_smfmac_f32_16x16x64_bf16 v[36:39], v[20:23], v[56:63], v1
    ds_read_b128 v[56:59], v4 offset:26624
    s_waitcnt lgkmcnt(5)
    v_smfmac_f32_16x16x64_bf16 v[28:31], v[24:27], a[88:95], v1
    ds_read_b128 v[20:23], v3 offset:9216
    v_smfmac_f32_16x16x64_bf16 v[32:35], v[24:27], a[96:103], v1
    ds_read_b128 v[60:63], v4 offset:27648
    v_smfmac_f32_16x16x64_bf16 v[36:39], v[24:27], a[104:111], v1
    ds_read_b128 v[24:27], v3 offset:9248
    s_waitcnt lgkmcnt(5)
    v_smfmac_f32_16x16x64_bf16 v[28:31], v[12:15], v[48:55], v1
    v_smfmac_f32_16x16x64_bf16 v[32:35], v[12:15], a[112:119], v1
    s_waitcnt lgkmcnt(4)
    v_smfmac_f32_16x16x64_bf16 v[28:31], v[16:19], a[120:127], v1
    v_smfmac_f32_16x16x64_bf16 v[32:35], v[16:19], a[128:135], v1
    s_waitcnt lgkmcnt(1)
    v_smfmac_f32_16x16x64_bf16 v[28:31], v[20:23], v[56:63], v1
    v_smfmac_f32_16x16x64_bf16 v[32:35], v[20:23], a[136:143], v1
    s_waitcnt lgkmcnt(0)
    v_smfmac_f32_16x16x64_bf16 v[28:31], v[24:27], a[144:151], v1
    v_smfmac_f32_16x16x64_bf16 v[32:35], v[24:27], a[152:159], v1
    v_smfmac_f32_16x16x64_bf16 v[36:39], v[12:15], a[160:167], v1
    v_smfmac_f32_16x16x64_bf16 v[36:39], v[16:19], a[168:175], v1
    v_cvt_pk_bf16_f32 v44, v28, v29
    v_cvt_pk_bf16_f32 v45, v32, v33
    v_cvt_pk_bf16_f32 v46, v30, v31
    v_cvt_pk_bf16_f32 v47, v34, v35
    v_mfma_f32_16x16x16_bf16 v[28:31], v[44:45], v[40:41], 0
    v_mfma_f32_16x16x16_bf16 v[32:35], v[46:47], v[40:41], 0
    v_smfmac_f32_16x16x64_bf16 v[36:39], v[20:23], a[176:183], v1
    s_nop 3
    v_cvt_pk_bf16_f32 v44, v28, v32
    v_cvt_pk_bf16_f32 v45, v29, v33
    v_cvt_pk_bf16_f32 v46, v30, v34
    v_cvt_pk_bf16_f32 v47, v31, v35
    s_nop 1
    v_mfma_f32_16x16x32_bf16 v[32:35], v[68:71], v[44:47], 0
    v_mfma_f32_16x16x32_bf16 v[28:31], v[64:67], v[44:47], 0
    v_mfma_f32_16x16x32_bf16 v[12:15], v[44:47], v[44:47], 0
    v_smfmac_f32_16x16x64_bf16 v[36:39], v[24:27], a[184:191], v1
    v_cndmask_b32_dpp v28, v32, v28, vcc quad_perm:[2,3,2,3] row_mask:0xf bank_mask:0xf
    v_cndmask_b32_dpp v29, v33, v29, vcc quad_perm:[2,3,2,3] row_mask:0xf bank_mask:0xf
    v_cndmask_b32_dpp v30, v34, v30, vcc quad_perm:[2,3,2,3] row_mask:0xf bank_mask:0xf
    v_cndmask_b32_dpp v31, v35, v31, vcc quad_perm:[2,3,2,3] row_mask:0xf bank_mask:0xf
    ds_write_b128 v0, v[28:31] offset:10240
    v_cndmask_b32_dpp v11, v13, v12, vcc quad_perm:[2,3,2,3] row_mask:0xf bank_mask:0xf
    ds_write_b32 v0, v11 offset:14336
    buffer_load_dwordx4 v[64:67], v0, s[4:7], s30 offen offset:0 sc1
    buffer_load_dwordx4 v[68:71], v0, s[4:7], s30 offen offset:1024 sc1
    s_waitcnt lgkmcnt(0)
    s_barrier
    ds_read_b128 v[24:27], v0 offset:14336
    ds_read_b128 v[28:31], v0 offset:10240
    ds_read_b128 v[32:35], v0 offset:11264
    ds_read_b128 v[16:19], v0 offset:12288
    ds_read_b128 v[20:23], v0 offset:13312
    v_cvt_pk_bf16_f32 v42, v36, v37
    v_cvt_pk_bf16_f32 v43, v38, v39
    v_mov_b32 v13, 0
    v_mov_b32 v14, 0
    s_cmp_ge_u32 s18, 63
    s_cbranch_scc1 L_cdone0
    s_waitcnt lgkmcnt(4)
    v_pk_add_f32 v[24:25], v[24:25], v[26:27]
    v_add_f32 v24, v24, v25
    v_mul_f32 v40, s20, v24
    s_waitcnt lgkmcnt(3)
    v_pk_mul_f32 v[28:29], v[28:29], s[48:49]
    v_pk_mul_f32 v[30:31], v[30:31], s[48:49]
    v_exp_f32 v11, v40
    s_waitcnt lgkmcnt(2)
    v_pk_fma_f32 v[28:29], v[32:33], s[48:49], v[28:29]
    v_pk_fma_f32 v[30:31], v[34:35], s[48:49], v[30:31]
    s_waitcnt lgkmcnt(1)
    v_pk_fma_f32 v[28:29], v[16:17], s[48:49], v[28:29]
    v_pk_fma_f32 v[30:31], v[18:19], s[48:49], v[30:31]
    s_waitcnt lgkmcnt(0)
    v_pk_fma_f32 v[28:29], v[20:21], s[48:49], v[28:29]
    v_pk_fma_f32 v[30:31], v[22:23], s[48:49], v[30:31]
    v_mov_b32_dpp v9, v11 quad_perm:[0,1,0,1] row_mask:0xf bank_mask:0xf
    v_exp_f32 v16, v28
    v_exp_f32 v17, v29
    v_cvt_pk_bf16_f32 v12, v11, v9
    v_cvt_pk_bf16_f32 v15, v11, v9
    v_cvt_pk_bf16_f32 v32, v16, v17
    v_exp_f32 v18, v30
    v_mfma_f32_16x16x16_bf16 v[20:23], v[42:43], v[12:13], 0
    ds_read_b128 v[48:51], v4 offset:28672
    v_exp_f32 v19, v31
    v_mov_b32_dpp v34, v32 quad_perm:[0,1,0,1] row_mask:0xf bank_mask:0xf
    v_cvt_pk_bf16_f32 v33, v18, v19
    v_mfma_f32_16x16x16_bf16 v[24:27], v[42:43], v[14:15], 0
    ds_read_b128 v[52:55], v4 offset:29696
    v_add_f32 v8, v16, v17
    v_mov_b32_dpp v35, v33 quad_perm:[0,1,0,1] row_mask:0xf bank_mask:0xf
    v_add_f32 v10, v18, v19
    v_add_f32 v8, v8, v11
    s_waitcnt vmcnt(3)
    v_mfma_f32_16x16x32_bf16 v[20:23], v[72:75], v[32:35], v[20:23]
    ds_read_b128 v[56:59], v4 offset:32768
    v_add_f32 v8, v8, v10
    s_waitcnt vmcnt(2)
    v_mfma_f32_16x16x32_bf16 v[24:27], v[76:79], v[32:35], v[24:27]
    ds_read_b128 v[60:63], v4 offset:33792
    v_add_f32_dpp v9, v8, v8 quad_perm:[2,3,0,1] row_mask:0xf bank_mask:0xf
    v_add_f32_dpp v10, v8, v8 quad_perm:[2,3,0,1] row_mask:0xf bank_mask:0xf
    s_nop 1
    v_permlane16_swap_b32 v9, v10
    v_add_f32 v8, v9, v10
    v_add_f32 v9, v9, v10
    s_nop 1
    v_permlane32_swap_b32 v8, v9
    v_add_f32 v8, v8, v9
    v_rcp_f32 v10, v8
    v_subrev_u32 v8, s47, v8
    v_cmp_le_u32 s[44:45], s50, v8
    v_pk_mul_f32 v[20:21], v[20:21], v[10:11] op_sel_hi:[1,0]
    v_pk_mul_f32 v[22:23], v[22:23], v[10:11] op_sel_hi:[1,0]
    v_pk_mul_f32 v[24:25], v[24:25], v[10:11] op_sel_hi:[1,0]
    v_pk_mul_f32 v[26:27], v[26:27], v[10:11] op_sel_hi:[1,0]
    v_cvt_pk_bf16_f32 v32, v20, v24
    v_cvt_pk_bf16_f32 v33, v21, v25
    v_cvt_pk_bf16_f32 v34, v22, v26
    v_cvt_pk_bf16_f32 v35, v23, v27
    s_cmp_lg_u64 s[44:45], 0
    s_cbranch_scc1 L_sm_L_ch00o_r
L_sm_L_ch00o:
    s_mov_b64 exec, s[36:37]
    ds_write_b128 v3, v[32:35] offset:6144
    s_mov_b64 exec, -1
    v_mov_b64 v[36:37], 0
    v_mov_b64 v[38:39], 0
    v_mov_b64 v[40:41], 0
    v_mov_b64 v[42:43], 0
    v_mov_b64 v[44:45], 0
    v_mov_b64 v[46:47], 0
    s_waitcnt lgkmcnt(0)
    s_barrier
    ds_read_b128 v[12:15], v3 offset:6144
    ds_read_b128 v[16:19], v3 offset:6176
    ds_read_b128 v[20:23], v3 offset:7168
    ds_read_b128 v[24:27], v3 offset:7200
    s_waitcnt lgkmcnt(3)
    v_smfmac_f32_16x16x64_bf16 v[36:39], v[12:15], v[48:55], v1
    ds_read_b128 v[72:75], v4 offset:34816
    s_waitcnt lgkmcnt(3)
    v_smfmac_f32_16x16x64_bf16 v[36:39], v[16:19], v[56:63], v1
    ds_read_b128 v[76:79], v4 offset:35840
    s_waitcnt lgkmcnt(3)
    v_smfmac_f32_16x16x64_bf16 v[36:39], v[20:23], a[192:199], v1
    ds_read_b128 v[48:51], v4 offset:30720
    s_waitcnt lgkmcnt(3)
    v_smfmac_f32_16x16x64_bf16 v[36:39], v[24:27], a[200:207], v1
    ds_read_b128 v[52:55], v4 offset:31744
    v_smfmac_f32_16x16x64_bf16 v[40:43], v[12:15], a[208:215], v1
    v_smfmac_f32_16x16x64_bf16 v[40:43], v[16:19], a[216:223], v1
    v_cvt_pk_bf16_f32 v36, v36, v37
    s_waitcnt lgkmcnt(2)
    v_smfmac_f32_16x16x64_bf16 v[40:43], v[20:23], v[72:79], v1
    v_or_b32 v36, 1, v36
    v_smfmac_f32_16x16x64_bf16 v[40:43], v[24:27], a[224:231], v1
    buffer_store_dword v36, v5, s[4:7], s28 offen
    v_cvt_pk_bf16_f32 v37, v38, v39
    v_smfmac_f32_16x16x64_bf16 v[44:47], v[12:15], a[232:239], v1
    v_or_b32 v37, 1, v37
    s_waitcnt lgkmcnt(0)
    v_smfmac_f32_16x16x64_bf16 v[44:47], v[16:19], v[48:55], v1
    buffer_store_dword v37, v5, s[4:7], s29 offen
    v_cvt_pk_bf16_f32 v40, v40, v41
    v_smfmac_f32_16x16x64_bf16 v[44:47], v[20:23], a[240:247], v1
    v_or_b32 v40, 1, v40
    v_smfmac_f32_16x16x64_bf16 v[44:47], v[24:27], a[248:255], v1
    buffer_store_dword v40, v5, s[4:7], s46 offen
    v_cvt_pk_bf16_f32 v41, v42, v43
    v_or_b32 v41, 1, v41
    buffer_store_dword v41, v5, s[4:7], s73 offen
    s_nop 2
    v_cvt_pk_bf16_f32 v44, v44, v45
    v_cvt_pk_bf16_f32 v45, v46, v47
    v_or_b32 v44, 1, v44
    v_or_b32 v45, 1, v45
    buffer_store_dword v44, v5, s[4:7], s74 offen
    buffer_store_dword v45, v5, s[4:7], s75 offen
    ds_read_b128 v[48:51], v4 offset:0
    ds_read_b128 v[52:55], v4 offset:1024
    ds_read_b128 v[56:59], v4 offset:14336
    ds_read_b128 v[60:63], v4 offset:15360
    v_cndmask_b32 v20, 0, v2, s[42:43]
    v_cndmask_b32 v21, 0, v2, s[42:43]
    v_cndmask_b32 v22, 0, v2, s[42:43]
    v_cndmask_b32 v23, 0, v2, s[42:43]
    s_nop 9
    buffer_load_dword v12, v7, s[4:7], s21 offen offset:0 sc1
    buffer_load_dword v13, v7, s[4:7], s21 offen offset:256 sc1
    buffer_load_dword v14, v7, s[4:7], s21 offen offset:512 sc1
    buffer_load_dword v15, v7, s[4:7], s21 offen offset:768 sc1
    buffer_load_dword v16, v7, s[4:7], s21 offen offset:1024 sc1
    buffer_load_dword v17, v7, s[4:7], s21 offen offset:1280 sc1
    buffer_load_dword v18, v7, s[4:7], s21 offen offset:1536 sc1
    buffer_load_dword v19, v7, s[4:7], s21 offen offset:1792 sc1
    v_mov_b64 v[36:37], 0
    v_mov_b64 v[38:39], 0
    v_mov_b64 v[28:29], 0
    v_mov_b64 v[30:31], 0
    s_add_u32 s26, s26, 32768
    s_add_u32 s23, s23, 32768
    s_add_u32 s30, s30, 524288
    s_add_u32 s27, s27, 524288
    s_nop 14
    buffer_load_dword v40, v7, s[4:7], s21 offen offset:0 sc1
    buffer_load_dword v41, v7, s[4:7], s21 offen offset:256 sc1
    buffer_load_dword v42, v7, s[4:7], s21 offen offset:512 sc1
    buffer_load_dword v43, v7, s[4:7], s21 offen offset:768 sc1
    buffer_load_dword v44, v7, s[4:7], s21 offen offset:1024 sc1
    buffer_load_dword v45, v7, s[4:7], s21 offen offset:1280 sc1
    buffer_load_dword v46, v7, s[4:7], s21 offen offset:1536 sc1
    buffer_load_dword v47, v7, s[4:7], s21 offen offset:1792 sc1
    s_waitcnt vmcnt(12)
    v_mfma_f32_16x16x32_bf16 v[32:35], v[12:15], v[20:23], 0
    v_bitop3_b32 v8, v12, v13, v14 bitop3:0x80
    s_waitcnt vmcnt(8)
    v_mfma_f32_16x16x32_bf16 v[32:35], v[16:19], v[20:23], v[32:35]
    v_bitop3_b32 v8, v8, v15, v16 bitop3:0x80
    v_bitop3_b32 v8, v8, v17, v18 bitop3:0x80
    v_bitop3_b32 v8, v8, v19, 1 bitop3:0x80
    v_cmp_ne_u32 vcc, 1, v8
    s_nop 2
    v_cvt_pk_bf16_f32 v10, v32, v33
    v_cvt_pk_bf16_f32 v11, v34, v35
    v_or_b32 v10, 1, v10
    v_or_b32 v11, 1, v11
    s_cbranch_vccnz L_c1_L_ch00o_r
L_c1_L_ch00o:
    buffer_store_dwordx2 v[10:11], v6, s[4:7], s25 offen
    s_barrier
    buffer_store_dwordx2 v[10:11], v6, s[4:7], s26 offen sc1
    s_add_u32 s18, s18, 1
    v_mov_b64 v[32:33], 0
    v_mov_b64 v[34:35], 0
    s_nop 15
    s_nop 15
    s_nop 15
    s_nop 6
    buffer_load_dwordx4 v[24:27], v0, s[4:7], s22 offen sc1
    buffer_load_dwordx4 v[44:47], v0, s[4:7], s24 offen sc1
    s_nop 15
    s_nop 3
    buffer_load_dwordx4 v[16:19], v0, s[4:7], s22 offen sc1
    buffer_load_dwordx4 v[20:23], v0, s[4:7], s24 offen sc1
    s_waitcnt vmcnt(3)
    v_bitop3_b32 v8, v24, v25, v26 bitop3:0x80
    s_waitcnt vmcnt(2)
    v_bitop3_b32 v8, v8, v27, v44 bitop3:0x80
    v_bitop3_b32 v8, v8, v45, v46 bitop3:0x80
    v_bitop3_b32 v8, v8, v47, 1 bitop3:0x80
    v_cmp_ne_u32 vcc, 1, v8
    ds_write_b128 v0, v[24:27] offset:0
    ds_write_b128 v0, v[44:47] offset:4096
    s_cbranch_vccnz L_c3_L_ch00o_r
L_c3_L_ch00o:
    buffer_load_dwordx4 v[40:43], v0, s[4:7], s23 offen sc1
    s_waitcnt lgkmcnt(0)
    s_barrier
    s_branch L_ch0_w0
L_c2_L_ch00e_r:
    s_add_u32 s19, s19, 1
    s_cmp_gt_u32 s19, 4000000
    s_cbranch_scc1 L_cend0
    buffer_load_dwordx4 v[40:43], v0, s[4:7], s23 offen sc1
    s_waitcnt vmcnt(0)
    v_bitop3_b32 v8, v40, v41, v42 bitop3:0x80
    v_bitop3_b32 v8, v8, v43, 1 bitop3:0x80
    v_cmp_ne_u32 vcc, 1, v8
    s_cbranch_vccnz L_c2_L_ch00e_r
    ds_write_b128 v0, v[40:43] offset:6144
    s_nop 7
    s_waitcnt lgkmcnt(0)
    s_branch L_c2_L_ch00e
L_sm_L_ch00e_r:
    v_max3_f32 v8, v28, v29, v30
    v_max3_f32 v8, v8, v31, v40
    s_nop 1
    v_max_f32_dpp v9, v8, v8 quad_perm:[2,3,0,1] row_mask:0xf bank_mask:0xf
    v_max_f32_dpp v10, v8, v8 quad_perm:[2,3,0,1] row_mask:0xf bank_mask:0xf
    s_nop 1
    v_permlane16_swap_b32 v9, v10
    v_max_f32 v8, v9, v10
    v_max_f32 v11, v9, v10
    s_nop 1
    v_permlane32_swap_b32 v8, v11
    v_max_f32 v8, v8, v11
    v_sub_f32 v28, v28, v8
    v_sub_f32 v29, v29, v8
    v_sub_f32 v30, v30, v8
    v_sub_f32 v31, v31, v8
    v_sub_f32 v40, v40, v8
    v_exp_f32 v11, v40
    s_nop 1
    v_mov_b32_dpp v9, v11 quad_perm:[0,1,0,1] row_mask:0xf bank_mask:0xf
    v_exp_f32 v16, v28
    v_exp_f32 v17, v29
    v_cvt_pk_bf16_f32 v12, v11, v9
    v_cvt_pk_bf16_f32 v15, v11, v9
    v_cvt_pk_bf16_f32 v32, v16, v17
    v_exp_f32 v18, v30
    v_mfma_f32_16x16x16_bf16 v[20:23], v[42:43], v[12:13], 0
    v_exp_f32 v19, v31
    v_mov_b32_dpp v34, v32 quad_perm:[0,1,0,1] row_mask:0xf bank_mask:0xf
    v_cvt_pk_bf16_f32 v33, v18, v19
    v_mfma_f32_16x16x16_bf16 v[24:27], v[42:43], v[14:15], 0
    v_add_f32 v8, v16, v17
    v_mov_b32_dpp v35, v33 quad_perm:[0,1,0,1] row_mask:0xf bank_mask:0xf
    v_add_f32 v10, v18, v19
    v_add_f32 v8, v8, v11
    v_mfma_f32_16x16x32_bf16 v[20:23], v[72:75], v[32:35], v[20:23]
    v_add_f32 v8, v8, v10
    v_mfma_f32_16x16x32_bf16 v[24:27], v[76:79], v[32:35], v[24:27]
    v_add_f32_dpp v9, v8, v8 quad_perm:[2,3,0,1] row_mask:0xf bank_mask:0xf
    v_add_f32_dpp v10, v8, v8 quad_perm:[2,3,0,1] row_mask:0xf bank_mask:0xf
    s_nop 1
    v_permlane16_swap_b32 v9, v10
    v_add_f32 v8, v9, v10
    v_add_f32 v9, v9, v10
    s_nop 1
    v_permlane32_swap_b32 v8, v9
    v_add_f32 v8, v8, v9
    v_rcp_f32 v10, v8
    s_nop 0
    v_pk_mul_f32 v[20:21], v[20:21], v[10:11] op_sel_hi:[1,0]
    v_pk_mul_f32 v[22:23], v[22:23], v[10:11] op_sel_hi:[1,0]
    v_pk_mul_f32 v[24:25], v[24:25], v[10:11] op_sel_hi:[1,0]
    v_pk_mul_f32 v[26:27], v[26:27], v[10:11] op_sel_hi:[1,0]
    v_cvt_pk_bf16_f32 v32, v20, v24
    v_cvt_pk_bf16_f32 v33, v21, v25
    v_cvt_pk_bf16_f32 v34, v22, v26
    v_cvt_pk_bf16_f32 v35, v23, v27
    s_branch L_sm_L_ch00e
L_c1_L_ch00e_r:
    s_add_u32 s19, s19, 1
    s_cmp_gt_u32 s19, 4000000
    s_cbranch_scc1 L_cend0
    buffer_load_dword v12, v7, s[4:7], s21 offen offset:0 sc1
    buffer_load_dword v13, v7, s[4:7], s21 offen offset:256 sc1
    buffer_load_dword v14, v7, s[4:7], s21 offen offset:512 sc1
    buffer_load_dword v15, v7, s[4:7], s21 offen offset:768 sc1
    buffer_load_dword v16, v7, s[4:7], s21 offen offset:1024 sc1
    buffer_load_dword v17, v7, s[4:7], s21 offen offset:1280 sc1
    buffer_load_dword v18, v7, s[4:7], s21 offen offset:1536 sc1
    buffer_load_dword v19, v7, s[4:7], s21 offen offset:1792 sc1
    s_waitcnt vmcnt(8)
    v_mfma_f32_16x16x32_bf16 v[32:35], v[40:43], v[20:23], 0
    v_or3_b32 v8, v40, v41, v42
    v_mfma_f32_16x16x32_bf16 v[32:35], v[44:47], v[20:23], v[32:35]
    v_or3_b32 v8, v8, v43, v44
    v_or3_b32 v8, v8, v45, v46
    v_or_b32 v8, v8, v47
    v_and_b32 v8, 1, v8
    v_cmp_ne_u32 vcc, 0, v8
    s_nop 1
    v_cvt_pk_bf16_f32 v10, v32, v33
    v_cvt_pk_bf16_f32 v11, v34, v35
    v_and_b32 v10, -2, v10
    v_and_b32 v11, -2, v11
    s_cbranch_vccnz L_c1_L_ch00e_r2
    s_branch L_c1_L_ch00e
L_c1_L_ch00e_r2:
    s_add_u32 s19, s19, 1
    s_cmp_gt_u32 s19, 4000000
    s_cbranch_scc1 L_cend0
    buffer_load_dword v40, v7, s[4:7], s21 offen offset:0 sc1
    buffer_load_dword v41, v7, s[4:7], s21 offen offset:256 sc1
    buffer_load_dword v42, v7, s[4:7], s21 offen offset:512 sc1
    buffer_load_dword v43, v7, s[4:7], s21 offen offset:768 sc1
    buffer_load_dword v44, v7, s[4:7], s21 offen offset:1024 sc1
    buffer_load_dword v45, v7, s[4:7], s21 offen offset:1280 sc1
    buffer_load_dword v46, v7, s[4:7], s21 offen offset:1536 sc1
    buffer_load_dword v47, v7, s[4:7], s21 offen offset:1792 sc1
    s_waitcnt vmcnt(8)
    v_mfma_f32_16x16x32_bf16 v[32:35], v[12:15], v[20:23], 0
    v_or3_b32 v8, v12, v13, v14
    v_mfma_f32_16x16x32_bf16 v[32:35], v[16:19], v[20:23], v[32:35]
    v_or3_b32 v8, v8, v15, v16
    v_or3_b32 v8, v8, v17, v18
    v_or_b32 v8, v8, v19
    v_and_b32 v8, 1, v8
    v_cmp_ne_u32 vcc, 0, v8
    s_nop 1
    v_cvt_pk_bf16_f32 v10, v32, v33
    v_cvt_pk_bf16_f32 v11, v34, v35
    v_and_b32 v10, -2, v10
    v_and_b32 v11, -2, v11
    s_cbranch_vccnz L_c1_L_ch00e_r
    s_branch L_c1_L_ch00e
L_c3_L_ch00e_r:
    s_add_u32 s19, s19, 1
    s_cmp_gt_u32 s19, 4000000
    s_cbranch_scc1 L_cend0
    buffer_load_dwordx4 v[24:27], v0, s[4:7], s22 offen sc1
    buffer_load_dwordx4 v[44:47], v0, s[4:7], s24 offen sc1
    s_waitcnt vmcnt(2)
    v_or3_b32 v8, v16, v17, v18
    v_or3_b32 v8, v8, v19, v20
    v_or3_b32 v8, v8, v21, v22
    v_or_b32 v8, v8, v23
    v_and_b32 v8, 1, v8
    v_cmp_ne_u32 vcc, 0, v8
    s_cbranch_vccnz L_c3_L_ch00e_r2
    ds_write_b128 v0, v[16:19] offset:0
    ds_write_b128 v0, v[20:23] offset:4096
    s_branch L_c3_L_ch00e
L_c3_L_ch00e_r2:
    buffer_load_dwordx4 v[16:19], v0, s[4:7], s22 offen sc1
    buffer_load_dwordx4 v[20:23], v0, s[4:7], s24 offen sc1
    s_waitcnt vmcnt(2)
    v_or3_b32 v8, v24, v25, v26
    v_or3_b32 v8, v8, v27, v44
    v_or3_b32 v8, v8, v45, v46
    v_or_b32 v8, v8, v47
    v_and_b32 v8, 1, v8
    v_cmp_ne_u32 vcc, 0, v8
    s_cbranch_vccnz L_c3_L_ch00e_r
    ds_write_b128 v0, v[24:27] offset:0
    ds_write_b128 v0, v[44:47] offset:4096
    s_branch L_c3_L_ch00e
L_c2_L_ch00o_r:
    s_add_u32 s19, s19, 1
    s_cmp_gt_u32 s19, 4000000
    s_cbranch_scc1 L_cend0
    buffer_load_dwordx4 v[40:43], v0, s[4:7], s23 offen sc1
    s_waitcnt vmcnt(0)
    v_or3_b32 v8, v40, v41, v42
    v_or_b32 v8, v8, v43
    v_and_b32 v8, 1, v8
    v_cmp_ne_u32 vcc, 0, v8
    s_cbranch_vccnz L_c2_L_ch00o_r
    ds_write_b128 v0, v[40:43] offset:6144
    s_nop 7
    s_waitcnt lgkmcnt(0)
    s_branch L_c2_L_ch00o
L_sm_L_ch00o_r:
    v_max3_f32 v8, v28, v29, v30
    v_max3_f32 v8, v8, v31, v40
    s_nop 1
    v_max_f32_dpp v9, v8, v8 quad_perm:[2,3,0,1] row_mask:0xf bank_mask:0xf
    v_max_f32_dpp v10, v8, v8 quad_perm:[2,3,0,1] row_mask:0xf bank_mask:0xf
    s_nop 1
    v_permlane16_swap_b32 v9, v10
    v_max_f32 v8, v9, v10
    v_max_f32 v11, v9, v10
    s_nop 1
    v_permlane32_swap_b32 v8, v11
    v_max_f32 v8, v8, v11
    v_sub_f32 v28, v28, v8
    v_sub_f32 v29, v29, v8
    v_sub_f32 v30, v30, v8
    v_sub_f32 v31, v31, v8
    v_sub_f32 v40, v40, v8
    v_exp_f32 v11, v40
    s_nop 1
    v_mov_b32_dpp v9, v11 quad_perm:[0,1,0,1] row_mask:0xf bank_mask:0xf
    v_exp_f32 v16, v28
    v_exp_f32 v17, v29
    v_cvt_pk_bf16_f32 v12, v11, v9
    v_cvt_pk_bf16_f32 v15, v11, v9
    v_cvt_pk_bf16_f32 v32, v16, v17
    v_exp_f32 v18, v30
    v_mfma_f32_16x16x16_bf16 v[20:23], v[42:43], v[12:13], 0
    v_exp_f32 v19, v31
    v_mov_b32_dpp v34, v32 quad_perm:[0,1,0,1] row_mask:0xf bank_mask:0xf
    v_cvt_pk_bf16_f32 v33, v18, v19
    v_mfma_f32_16x16x16_bf16 v[24:27], v[42:43], v[14:15], 0
    v_add_f32 v8, v16, v17
    v_mov_b32_dpp v35, v33 quad_perm:[0,1,0,1] row_mask:0xf bank_mask:0xf
    v_add_f32 v10, v18, v19
    v_add_f32 v8, v8, v11
    v_mfma_f32_16x16x32_bf16 v[20:23], v[72:75], v[32:35], v[20:23]
    v_add_f32 v8, v8, v10
    v_mfma_f32_16x16x32_bf16 v[24:27], v[76:79], v[32:35], v[24:27]
    v_add_f32_dpp v9, v8, v8 quad_perm:[2,3,0,1] row_mask:0xf bank_mask:0xf
    v_add_f32_dpp v10, v8, v8 quad_perm:[2,3,0,1] row_mask:0xf bank_mask:0xf
    s_nop 1
    v_permlane16_swap_b32 v9, v10
    v_add_f32 v8, v9, v10
    v_add_f32 v9, v9, v10
    s_nop 1
    v_permlane32_swap_b32 v8, v9
    v_add_f32 v8, v8, v9
    v_rcp_f32 v10, v8
    s_nop 0
    v_pk_mul_f32 v[20:21], v[20:21], v[10:11] op_sel_hi:[1,0]
    v_pk_mul_f32 v[22:23], v[22:23], v[10:11] op_sel_hi:[1,0]
    v_pk_mul_f32 v[24:25], v[24:25], v[10:11] op_sel_hi:[1,0]
    v_pk_mul_f32 v[26:27], v[26:27], v[10:11] op_sel_hi:[1,0]
    v_cvt_pk_bf16_f32 v32, v20, v24
    v_cvt_pk_bf16_f32 v33, v21, v25
    v_cvt_pk_bf16_f32 v34, v22, v26
    v_cvt_pk_bf16_f32 v35, v23, v27
    s_branch L_sm_L_ch00o
L_c1_L_ch00o_r:
    s_add_u32 s19, s19, 1
    s_cmp_gt_u32 s19, 4000000
    s_cbranch_scc1 L_cend0
    buffer_load_dword v12, v7, s[4:7], s21 offen offset:0 sc1
    buffer_load_dword v13, v7, s[4:7], s21 offen offset:256 sc1
    buffer_load_dword v14, v7, s[4:7], s21 offen offset:512 sc1
    buffer_load_dword v15, v7, s[4:7], s21 offen offset:768 sc1
    buffer_load_dword v16, v7, s[4:7], s21 offen offset:1024 sc1
    buffer_load_dword v17, v7, s[4:7], s21 offen offset:1280 sc1
    buffer_load_dword v18, v7, s[4:7], s21 offen offset:1536 sc1
    buffer_load_dword v19, v7, s[4:7], s21 offen offset:1792 sc1
    s_waitcnt vmcnt(8)
    v_mfma_f32_16x16x32_bf16 v[32:35], v[40:43], v[20:23], 0
    v_bitop3_b32 v8, v40, v41, v42 bitop3:0x80
    v_mfma_f32_16x16x32_bf16 v[32:35], v[44:47], v[20:23], v[32:35]
    v_bitop3_b32 v8, v8, v43, v44 bitop3:0x80
    v_bitop3_b32 v8, v8, v45, v46 bitop3:0x80
    v_bitop3_b32 v8, v8, v47, 1 bitop3:0x80
    v_cmp_ne_u32 vcc, 1, v8
    s_nop 2
    v_cvt_pk_bf16_f32 v10, v32, v33
    v_cvt_pk_bf16_f32 v11, v34, v35
    v_or_b32 v10, 1, v10
    v_or_b32 v11, 1, v11
    s_cbranch_vccnz L_c1_L_ch00o_r2
    s_branch L_c1_L_ch00o
L_c1_L_ch00o_r2:
    s_add_u32 s19, s19, 1
    s_cmp_gt_u32 s19, 4000000
    s_cbranch_scc1 L_cend0
    buffer_load_dword v40, v7, s[4:7], s21 offen offset:0 sc1
    buffer_load_dword v41, v7, s[4:7], s21 offen offset:256 sc1
    buffer_load_dword v42, v7, s[4:7], s21 offen offset:512 sc1
    buffer_load_dword v43, v7, s[4:7], s21 offen offset:768 sc1
    buffer_load_dword v44, v7, s[4:7], s21 offen offset:1024 sc1
    buffer_load_dword v45, v7, s[4:7], s21 offen offset:1280 sc1
    buffer_load_dword v46, v7, s[4:7], s21 offen offset:1536 sc1
    buffer_load_dword v47, v7, s[4:7], s21 offen offset:1792 sc1
    s_waitcnt vmcnt(8)
    v_mfma_f32_16x16x32_bf16 v[32:35], v[12:15], v[20:23], 0
    v_bitop3_b32 v8, v12, v13, v14 bitop3:0x80
    v_mfma_f32_16x16x32_bf16 v[32:35], v[16:19], v[20:23], v[32:35]
    v_bitop3_b32 v8, v8, v15, v16 bitop3:0x80
    v_bitop3_b32 v8, v8, v17, v18 bitop3:0x80
    v_bitop3_b32 v8, v8, v19, 1 bitop3:0x80
    v_cmp_ne_u32 vcc, 1, v8
    s_nop 2
    v_cvt_pk_bf16_f32 v10, v32, v33
    v_cvt_pk_bf16_f32 v11, v34, v35
    v_or_b32 v10, 1, v10
    v_or_b32 v11, 1, v11
    s_cbranch_vccnz L_c1_L_ch00o_r
    s_branch L_c1_L_ch00o
L_c3_L_ch00o_r:
    s_add_u32 s19, s19, 1
    s_cmp_gt_u32 s19, 4000000
    s_cbranch_scc1 L_cend0
    buffer_load_dwordx4 v[24:27], v0, s[4:7], s22 offen sc1
    buffer_load_dwordx4 v[44:47], v0, s[4:7], s24 offen sc1
    s_waitcnt vmcnt(2)
    v_bitop3_b32 v8, v16, v17, v18 bitop3:0x80
    v_bitop3_b32 v8, v8, v19, v20 bitop3:0x80
    v_bitop3_b32 v8, v8, v21, v22 bitop3:0x80
    v_bitop3_b32 v8, v8, v23, 1 bitop3:0x80
    v_cmp_ne_u32 vcc, 1, v8
    s_cbranch_vccnz L_c3_L_ch00o_r2
    ds_write_b128 v0, v[16:19] offset:0
    ds_write_b128 v0, v[20:23] offset:4096
    s_branch L_c3_L_ch00o
L_c3_L_ch00o_r2:
    buffer_load_dwordx4 v[16:19], v0, s[4:7], s22 offen sc1
    buffer_load_dwordx4 v[20:23], v0, s[4:7], s24 offen sc1
    s_waitcnt vmcnt(2)
    v_bitop3_b32 v8, v24, v25, v26 bitop3:0x80
    v_bitop3_b32 v8, v8, v27, v44 bitop3:0x80
    v_bitop3_b32 v8, v8, v45, v46 bitop3:0x80
    v_bitop3_b32 v8, v8, v47, 1 bitop3:0x80
    v_cmp_ne_u32 vcc, 1, v8
    s_cbranch_vccnz L_c3_L_ch00o_r
    ds_write_b128 v0, v[24:27] offset:0
    ds_write_b128 v0, v[44:47] offset:4096
    s_branch L_c3_L_ch00o
    .p2align 6
L_ch0_w1:
    ds_read_b128 v[12:15], v3 offset:0
    s_waitcnt vmcnt(2)
    ds_read_b128 v[16:19], v3 offset:32
    s_waitcnt lgkmcnt(1)
    v_smfmac_f32_16x16x64_bf16 v[28:31], v[12:15], v[48:55], v1
    s_waitcnt vmcnt(1)
    ds_read_b128 v[20:23], v3 offset:1024
    v_smfmac_f32_16x16x64_bf16 v[32:35], v[12:15], v[56:63], v1
    ds_read_b128 v[48:51], v4 offset:2048
    v_smfmac_f32_16x16x64_bf16 v[36:39], v[12:15], v[80:87], v1
    ds_read_b128 v[24:27], v3 offset:1056
    s_waitcnt lgkmcnt(3)
    v_smfmac_f32_16x16x64_bf16 v[28:31], v[16:19], v[88:95], v1
    ds_read_b128 v[52:55], v4 offset:3072
    v_smfmac_f32_16x16x64_bf16 v[32:35], v[16:19], v[96:103], v1
    ds_read_b128 v[56:59], v4 offset:16384
    v_smfmac_f32_16x16x64_bf16 v[36:39], v[16:19], v[104:111], v1
    ds_read_b128 v[12:15], v3 offset:2048
    s_waitcnt lgkmcnt(5)
    v_smfmac_f32_16x16x64_bf16 v[28:31], v[20:23], v[112:119], v1
    ds_read_b128 v[60:63], v4 offset:17408
    v_smfmac_f32_16x16x64_bf16 v[32:35], v[20:23], v[120:127], v1
    s_waitcnt lgkmcnt(3)
    v_smfmac_f32_16x16x64_bf16 v[36:39], v[20:23], v[48:55], v1
    ds_read_b128 v[16:19], v3 offset:2080
    v_smfmac_f32_16x16x64_bf16 v[28:31], v[24:27], v[128:135], v1
    ds_read_b128 v[48:51], v4 offset:4096
    v_smfmac_f32_16x16x64_bf16 v[32:35], v[24:27], v[136:143], v1
    ds_read_b128 v[52:55], v4 offset:5120
    v_smfmac_f32_16x16x64_bf16 v[36:39], v[24:27], v[144:151], v1
    ds_read_b128 v[20:23], v3 offset:3072
    s_waitcnt lgkmcnt(4)
    v_smfmac_f32_16x16x64_bf16 v[28:31], v[12:15], v[56:63], v1
    ds_read_b128 v[56:59], v4 offset:18432
    v_smfmac_f32_16x16x64_bf16 v[32:35], v[12:15], v[152:159], v1
    ds_read_b128 v[60:63], v4 offset:19456
    v_smfmac_f32_16x16x64_bf16 v[36:39], v[12:15], v[160:167], v1
    ds_read_b128 v[24:27], v3 offset:3104
    s_waitcnt lgkmcnt(6)
    v_smfmac_f32_16x16x64_bf16 v[28:31], v[16:19], v[168:175], v1
    s_waitcnt lgkmcnt(4)
    v_smfmac_f32_16x16x64_bf16 v[32:35], v[16:19], v[48:55], v1
    ds_read_b128 v[48:51], v4 offset:6144
    v_smfmac_f32_16x16x64_bf16 v[36:39], v[16:19], v[176:183], v1
    ds_read_b128 v[12:15], v3 offset:4096
    s_waitcnt lgkmcnt(5)
    v_smfmac_f32_16x16x64_bf16 v[28:31], v[20:23], v[184:191], v1
    ds_read_b128 v[52:55], v4 offset:7168
    v_smfmac_f32_16x16x64_bf16 v[32:35], v[20:23], v[192:199], v1
    s_waitcnt lgkmcnt(4)
    v_smfmac_f32_16x16x64_bf16 v[36:39], v[20:23], v[56:63], v1
    ds_read_b128 v[16:19], v3 offset:4128
    s_waitcnt lgkmcnt(4)
    v_smfmac_f32_16x16x64_bf16 v[28:31], v[24:27], v[200:207], v1
    ds_read_b128 v[56:59], v4 offset:20480
    v_smfmac_f32_16x16x64_bf16 v[32:35], v[24:27], v[208:215], v1
    s_waitcnt vmcnt(0)
    ds_write_b128 v0, v[40:43] offset:7168
    v_bitop3_b32 v8, v40, v41, v42 bitop3:0x80
    v_smfmac_f32_16x16x64_bf16 v[36:39], v[24:27], v[216:223], v1
    ds_read_b128 v[20:23], v3 offset:5120
    v_and_b32 v8, v8, v43
    s_waitcnt lgkmcnt(4)
    v_smfmac_f32_16x16x64_bf16 v[28:31], v[12:15], v[48:55], v1
    ds_read_b128 v[60:63], v4 offset:21504
    v_and_or_b32 v8, v8, 1, s35
    v_smfmac_f32_16x16x64_bf16 v[32:35], v[12:15], v[224:231], v1
    ds_read_b128 v[48:51], v4 offset:8192
    v_cmp_ne_u32 vcc, 1, v8
    v_smfmac_f32_16x16x64_bf16 v[36:39], v[12:15], v[232:239], v1
    ds_read_b128 v[24:27], v3 offset:5152
    s_nop 0
    s_waitcnt lgkmcnt(6)
    v_smfmac_f32_16x16x64_bf16 v[28:31], v[16:19], v[240:247], v1
    ds_read_b128 v[52:55], v4 offset:9216
    s_cbranch_vccnz L_c2_L_ch01e_r
L_c2_L_ch01e:
    s_waitcnt lgkmcnt(3)
    v_smfmac_f32_16x16x64_bf16 v[32:35], v[16:19], v[56:63], v1
    ds_read_b128 v[56:59], v4 offset:22528
    v_smfmac_f32_16x16x64_bf16 v[36:39], v[16:19], v[248:255], v1
    ds_read_b128 v[60:63], v4 offset:23552
    buffer_load_dwordx4 v[72:75], v0, s[4:7], s27 offen offset:2048 sc1
    v_smfmac_f32_16x16x64_bf16 v[28:31], v[20:23], a[0:7], v1
    s_barrier
    s_mov_b64 vcc, s[36:37]
    s_mov_b32 s35, 0
    v_smfmac_f32_16x16x64_bf16 v[32:35], v[20:23], a[8:15], v1
    ds_read_b128 v[12:15], v3 offset:6144
    buffer_load_dwordx4 v[76:79], v0, s[4:7], s27 offen offset:3072 sc1
    v_cndmask_b32 v40, 0, v2, s[38:39]
    s_waitcnt lgkmcnt(3)
    v_smfmac_f32_16x16x64_bf16 v[36:39], v[20:23], v[48:55], v1
    ds_read_b128 v[16:19], v3 offset:6176
    v_cndmask_b32 v41, 0, v2, s[40:41]
    v_smfmac_f32_16x16x64_bf16 v[28:31], v[24:27], a[16:23], v1
    ds_read_b128 v[48:51], v4 offset:10240
    v_smfmac_f32_16x16x64_bf16 v[32:35], v[24:27], a[24:31], v1
    ds_read_b128 v[52:55], v4 offset:11264
    v_smfmac_f32_16x16x64_bf16 v[36:39], v[24:27], a[32:39], v1
    ds_read_b128 v[20:23], v3 offset:7168
    s_waitcnt lgkmcnt(4)
    v_smfmac_f32_16x16x64_bf16 v[28:31], v[12:15], v[56:63], v1
    ds_read_b128 v[56:59], v4 offset:24576
    v_smfmac_f32_16x16x64_bf16 v[32:35], v[12:15], a[40:47], v1
    ds_read_b128 v[60:63], v4 offset:25600
    v_smfmac_f32_16x16x64_bf16 v[36:39], v[12:15], a[48:55], v1
    ds_read_b128 v[24:27], v3 offset:7200
    s_waitcnt lgkmcnt(6)
    v_smfmac_f32_16x16x64_bf16 v[28:31], v[16:19], a[56:63], v1
    s_waitcnt lgkmcnt(4)
    v_smfmac_f32_16x16x64_bf16 v[32:35], v[16:19], v[48:55], v1
    ds_read_b128 v[48:51], v4 offset:12288
    v_smfmac_f32_16x16x64_bf16 v[36:39], v[16:19], a[64:71], v1
    ds_read_b128 v[12:15], v3 offset:8192
    s_waitcnt lgkmcnt(5)
    v_smfmac_f32_16x16x64_bf16 v[28:31], v[20:23], a[72:79], v1
    ds_read_b128 v[52:55], v4 offset:13312
    v_smfmac_f32_16x16x64_bf16 v[32:35], v[20:23], a[80:87], v1
    ds_read_b128 v[16:19], v3 offset:8224
    s_waitcnt lgkmcnt(5)
    v_smfmac_f32_16x16x64_bf16 v[36:39], v[20:23], v[56:63], v1
    ds_read_b128 v[56:59], v4 offset:26624
    s_waitcnt lgkmcnt(5)
    v_smfmac_f32_16x16x64_bf16 v[28:31], v[24:27], a[88:95], v1
    ds_read_b128 v[20:23], v3 offset:9216
    v_smfmac_f32_16x16x64_bf16 v[32:35], v[24:27], a[96:103], v1
    ds_read_b128 v[60:63], v4 offset:27648
    v_smfmac_f32_16x16x64_bf16 v[36:39], v[24:27], a[104:111], v1
    ds_read_b128 v[24:27], v3 offset:9248
    s_waitcnt lgkmcnt(5)
    v_smfmac_f32_16x16x64_bf16 v[28:31], v[12:15], v[48:55], v1
    v_smfmac_f32_16x16x64_bf16 v[32:35], v[12:15], a[112:119], v1
    s_waitcnt lgkmcnt(4)
    v_smfmac_f32_16x16x64_bf16 v[28:31], v[16:19], a[120:127], v1
    v_smfmac_f32_16x16x64_bf16 v[32:35], v[16:19], a[128:135], v1
    s_waitcnt lgkmcnt(1)
    v_smfmac_f32_16x16x64_bf16 v[28:31], v[20:23], v[56:63], v1
    v_smfmac_f32_16x16x64_bf16 v[32:35], v[20:23], a[136:143], v1
    s_waitcnt lgkmcnt(0)
    v_smfmac_f32_16x16x64_bf16 v[28:31], v[24:27], a[144:151], v1
    v_smfmac_f32_16x16x64_bf16 v[32:35], v[24:27], a[152:159], v1
    v_smfmac_f32_16x16x64_bf16 v[36:39], v[12:15], a[160:167], v1
    v_smfmac_f32_16x16x64_bf16 v[36:39], v[16:19], a[168:175], v1
    v_cvt_pk_bf16_f32 v44, v28, v29
    v_cvt_pk_bf16_f32 v45, v32, v33
    v_cvt_pk_bf16_f32 v46, v30, v31
    v_cvt_pk_bf16_f32 v47, v34, v35
    v_mfma_f32_16x16x16_bf16 v[28:31], v[44:45], v[40:41], 0
    v_mfma_f32_16x16x16_bf16 v[32:35], v[46:47], v[40:41], 0
    v_smfmac_f32_16x16x64_bf16 v[36:39], v[20:23], a[176:183], v1
    s_nop 3
    v_cvt_pk_bf16_f32 v44, v28, v32
    v_cvt_pk_bf16_f32 v45, v29, v33
    v_cvt_pk_bf16_f32 v46, v30, v34
    v_cvt_pk_bf16_f32 v47, v31, v35
    s_nop 1
    v_mfma_f32_16x16x32_bf16 v[32:35], v[68:71], v[44:47], 0
    v_mfma_f32_16x16x32_bf16 v[28:31], v[64:67], v[44:47], 0
    v_mfma_f32_16x16x32_bf16 v[12:15], v[44:47], v[44:47], 0
    v_smfmac_f32_16x16x64_bf16 v[36:39], v[24:27], a[184:191], v1
    v_cndmask_b32_dpp v28, v32, v28, vcc quad_perm:[2,3,2,3] row_mask:0xf bank_mask:0xf
    v_cndmask_b32_dpp v29, v33, v29, vcc quad_perm:[2,3,2,3] row_mask:0xf bank_mask:0xf
    v_cndmask_b32_dpp v30, v34, v30, vcc quad_perm:[2,3,2,3] row_mask:0xf bank_mask:0xf
    v_cndmask_b32_dpp v31, v35, v31, vcc quad_perm:[2,3,2,3] row_mask:0xf bank_mask:0xf
    ds_write_b128 v0, v[28:31] offset:11264
    v_cndmask_b32_dpp v11, v13, v12, vcc quad_perm:[2,3,2,3] row_mask:0xf bank_mask:0xf
    ds_write_b32 v0, v11 offset:14340
    buffer_load_dwordx4 v[64:67], v0, s[4:7], s30 offen offset:0 sc1
    buffer_load_dwordx4 v[68:71], v0, s[4:7], s30 offen offset:1024 sc1
    s_waitcnt lgkmcnt(0)
    s_barrier
    ds_read_b128 v[24:27], v0 offset:14336
    ds_read_b128 v[28:31], v0 offset:10240
    ds_read_b128 v[32:35], v0 offset:11264
    ds_read_b128 v[16:19], v0 offset:12288
    ds_read_b128 v[20:23], v0 offset:13312
    v_cvt_pk_bf16_f32 v42, v36, v37
    v_cvt_pk_bf16_f32 v43, v38, v39
    v_mov_b32 v13, 0
    v_mov_b32 v14, 0
    s_waitcnt lgkmcnt(4)
    v_pk_add_f32 v[24:25], v[24:25], v[26:27]
    v_add_f32 v24, v24, v25
    v_mul_f32 v40, s20, v24
    s_waitcnt lgkmcnt(3)
    v_pk_mul_f32 v[28:29], v[28:29], s[48:49]
    v_pk_mul_f32 v[30:31], v[30:31], s[48:49]
    v_exp_f32 v11, v40
    s_waitcnt lgkmcnt(2)
    v_pk_fma_f32 v[28:29], v[32:33], s[48:49], v[28:29]
    v_pk_fma_f32 v[30:31], v[34:35], s[48:49], v[30:31]
    s_waitcnt lgkmcnt(1)
    v_pk_fma_f32 v[28:29], v[16:17], s[48:49], v[28:29]
    v_pk_fma_f32 v[30:31], v[18:19], s[48:49], v[30:31]
    s_waitcnt lgkmcnt(0)
    v_pk_fma_f32 v[28:29], v[20:21], s[48:49], v[28:29]
    v_pk_fma_f32 v[30:31], v[22:23], s[48:49], v[30:31]
    v_mov_b32_dpp v9, v11 quad_perm:[0,1,0,1] row_mask:0xf bank_mask:0xf
    v_exp_f32 v16, v28
    v_exp_f32 v17, v29
    v_cvt_pk_bf16_f32 v12, v11, v9
    v_cvt_pk_bf16_f32 v15, v11, v9
    v_cvt_pk_bf16_f32 v32, v16, v17
    v_exp_f32 v18, v30
    v_mfma_f32_16x16x16_bf16 v[20:23], v[42:43], v[12:13], 0
    ds_read_b128 v[48:51], v4 offset:28672
    v_exp_f32 v19, v31
    v_mov_b32_dpp v34, v32 quad_perm:[0,1,0,1] row_mask:0xf bank_mask:0xf
    v_cvt_pk_bf16_f32 v33, v18, v19
    v_mfma_f32_16x16x16_bf16 v[24:27], v[42:43], v[14:15], 0
    ds_read_b128 v[52:55], v4 offset:29696
    v_add_f32 v8, v16, v17
    v_mov_b32_dpp v35, v33 quad_perm:[0,1,0,1] row_mask:0xf bank_mask:0xf
    v_add_f32 v10, v18, v19
    v_add_f32 v8, v8, v11
    s_waitcnt vmcnt(3)
    v_mfma_f32_16x16x32_bf16 v[20:23], v[72:75], v[32:35], v[20:23]
    ds_read_b128 v[56:59], v4 offset:32768
    v_add_f32 v8, v8, v10
    s_waitcnt vmcnt(2)
    v_mfma_f32_16x16x32_bf16 v[24:27], v[76:79], v[32:35], v[24:27]
    ds_read_b128 v[60:63], v4 offset:33792
    v_add_f32_dpp v9, v8, v8 quad_perm:[2,3,0,1] row_mask:0xf bank_mask:0xf
    v_add_f32_dpp v10, v8, v8 quad_perm:[2,3,0,1] row_mask:0xf bank_mask:0xf
    s_nop 1
    v_permlane16_swap_b32 v9, v10
    v_add_f32 v8, v9, v10
    v_add_f32 v9, v9, v10
    s_nop 1
    v_permlane32_swap_b32 v8, v9
    v_add_f32 v8, v8, v9
    v_rcp_f32 v10, v8
    v_subrev_u32 v8, s47, v8
    v_cmp_le_u32 s[44:45], s50, v8
    v_pk_mul_f32 v[20:21], v[20:21], v[10:11] op_sel_hi:[1,0]
    v_pk_mul_f32 v[22:23], v[22:23], v[10:11] op_sel_hi:[1,0]
    v_pk_mul_f32 v[24:25], v[24:25], v[10:11] op_sel_hi:[1,0]
    v_pk_mul_f32 v[26:27], v[26:27], v[10:11] op_sel_hi:[1,0]
    v_cvt_pk_bf16_f32 v32, v20, v24
    v_cvt_pk_bf16_f32 v33, v21, v25
    v_cvt_pk_bf16_f32 v34, v22, v26
    v_cvt_pk_bf16_f32 v35, v23, v27
    s_cmp_lg_u64 s[44:45], 0
    s_cbranch_scc1 L_sm_L_ch01e_r
L_sm_L_ch01e:
    s_mov_b64 exec, s[36:37]
    ds_write_b128 v3, v[32:35] offset:6176
    s_mov_b64 exec, -1
    v_mov_b64 v[36:37], 0
    v_mov_b64 v[38:39], 0
    v_mov_b64 v[40:41], 0
    v_mov_b64 v[42:43], 0
    v_mov_b64 v[44:45], 0
    v_mov_b64 v[46:47], 0
    s_waitcnt lgkmcnt(0)
    s_barrier
    ds_read_b128 v[12:15], v3 offset:6144
    ds_read_b128 v[16:19], v3 offset:6176
    ds_read_b128 v[20:23], v3 offset:7168
    ds_read_b128 v[24:27], v3 offset:7200
    s_waitcnt lgkmcnt(3)
    v_smfmac_f32_16x16x64_bf16 v[36:39], v[12:15], v[48:55], v1
    ds_read_b128 v[72:75], v4 offset:34816
    s_waitcnt lgkmcnt(3)
    v_smfmac_f32_16x16x64_bf16 v[36:39], v[16:19], v[56:63], v1
    ds_read_b128 v[76:79], v4 offset:35840
    s_waitcnt lgkmcnt(3)
    v_smfmac_f32_16x16x64_bf16 v[36:39], v[20:23], a[192:199], v1
    ds_read_b128 v[48:51], v4 offset:30720
    s_waitcnt lgkmcnt(3)
    v_smfmac_f32_16x16x64_bf16 v[36:39], v[24:27], a[200:207], v1
    ds_read_b128 v[52:55], v4 offset:31744
    v_smfmac_f32_16x16x64_bf16 v[40:43], v[12:15], a[208:215], v1
    v_smfmac_f32_16x16x64_bf16 v[40:43], v[16:19], a[216:223], v1
    v_cvt_pk_bf16_f32 v36, v36, v37
    s_waitcnt lgkmcnt(2)
    v_smfmac_f32_16x16x64_bf16 v[40:43], v[20:23], v[72:79], v1
    v_and_b32 v36, -2, v36
    v_smfmac_f32_16x16x64_bf16 v[40:43], v[24:27], a[224:231], v1
    buffer_store_dword v36, v5, s[4:7], s28 offen
    v_cvt_pk_bf16_f32 v37, v38, v39
    v_smfmac_f32_16x16x64_bf16 v[44:47], v[12:15], a[232:239], v1
    v_and_b32 v37, -2, v37
    s_waitcnt lgkmcnt(0)
    v_smfmac_f32_16x16x64_bf16 v[44:47], v[16:19], v[48:55], v1
    buffer_store_dword v37, v5, s[4:7], s29 offen
    v_cvt_pk_bf16_f32 v40, v40, v41
    v_smfmac_f32_16x16x64_bf16 v[44:47], v[20:23], a[240:247], v1
    v_and_b32 v40, -2, v40
    v_smfmac_f32_16x16x64_bf16 v[44:47], v[24:27], a[248:255], v1
    buffer_store_dword v40, v5, s[4:7], s46 offen
    v_cvt_pk_bf16_f32 v41, v42, v43
    v_and_b32 v41, -2, v41
    buffer_store_dword v41, v5, s[4:7], s73 offen
    s_nop 2
    v_cvt_pk_bf16_f32 v44, v44, v45
    v_cvt_pk_bf16_f32 v45, v46, v47
    v_and_b32 v44, -2, v44
    v_and_b32 v45, -2, v45
    buffer_store_dword v44, v5, s[4:7], s74 offen
    buffer_store_dword v45, v5, s[4:7], s75 offen
    ds_read_b128 v[48:51], v4 offset:0
    ds_read_b128 v[52:55], v4 offset:1024
    ds_read_b128 v[56:59], v4 offset:14336
    ds_read_b128 v[60:63], v4 offset:15360
    v_cndmask_b32 v20, 0, v2, s[42:43]
    v_cndmask_b32 v21, 0, v2, s[42:43]
    v_cndmask_b32 v22, 0, v2, s[42:43]
    v_cndmask_b32 v23, 0, v2, s[42:43]
    s_nop 15
    s_nop 3
    buffer_load_dword v12, v7, s[4:7], s21 offen offset:0 sc1
    buffer_load_dword v13, v7, s[4:7], s21 offen offset:256 sc1
    buffer_load_dword v14, v7, s[4:7], s21 offen offset:512 sc1
    buffer_load_dword v15, v7, s[4:7], s21 offen offset:768 sc1
    buffer_load_dword v16, v7, s[4:7], s21 offen offset:1024 sc1
    buffer_load_dword v17, v7, s[4:7], s21 offen offset:1280 sc1
    buffer_load_dword v18, v7, s[4:7], s21 offen offset:1536 sc1
    buffer_load_dword v19, v7, s[4:7], s21 offen offset:1792 sc1
    v_mov_b64 v[36:37], 0
    v_mov_b64 v[38:39], 0
    v_mov_b64 v[28:29], 0
    v_mov_b64 v[30:31], 0
    s_add_u32 s26, s26, 32768
    s_add_u32 s23, s23, 32768
    s_add_u32 s30, s30, 524288
    s_add_u32 s27, s27, 524288
    s_nop 14
    buffer_load_dword v40, v7, s[4:7], s21 offen offset:0 sc1
    buffer_load_dword v41, v7, s[4:7], s21 offen offset:256 sc1
    buffer_load_dword v42, v7, s[4:7], s21 offen offset:512 sc1
    buffer_load_dword v43, v7, s[4:7], s21 offen offset:768 sc1
    buffer_load_dword v44, v7, s[4:7], s21 offen offset:1024 sc1
    buffer_load_dword v45, v7, s[4:7], s21 offen offset:1280 sc1
    buffer_load_dword v46, v7, s[4:7], s21 offen offset:1536 sc1
    buffer_load_dword v47, v7, s[4:7], s21 offen offset:1792 sc1
    s_waitcnt vmcnt(12)
    v_mfma_f32_16x16x32_bf16 v[32:35], v[12:15], v[20:23], 0
    v_or3_b32 v8, v12, v13, v14
    s_waitcnt vmcnt(8)
    v_mfma_f32_16x16x32_bf16 v[32:35], v[16:19], v[20:23], v[32:35]
    v_or3_b32 v8, v8, v15, v16
    v_or3_b32 v8, v8, v17, v18
    v_or_b32 v8, v8, v19
    v_and_b32 v8, 1, v8
    v_cmp_ne_u32 vcc, 0, v8
    s_nop 1
    v_cvt_pk_bf16_f32 v10, v32, v33
    v_cvt_pk_bf16_f32 v11, v34, v35
    v_and_b32 v10, -2, v10
    v_and_b32 v11, -2, v11
    s_cbranch_vccnz L_c1_L_ch01e_r
L_c1_L_ch01e:
    buffer_store_dwordx2 v[10:11], v6, s[4:7], s25 offen
    s_barrier
    buffer_store_dwordx2 v[10:11], v6, s[4:7], s26 offen sc1
    s_add_u32 s18, s18, 1
    v_mov_b64 v[32:33], 0
    v_mov_b64 v[34:35], 0
    s_nop 15
    s_nop 15
    s_nop 15
    s_nop 6
    buffer_load_dwordx4 v[24:27], v0, s[4:7], s22 offen sc1
    buffer_load_dwordx4 v[44:47], v0, s[4:7], s24 offen sc1
    s_nop 15
    s_nop 3
    buffer_load_dwordx4 v[16:19], v0, s[4:7], s22 offen sc1
    buffer_load_dwordx4 v[20:23], v0, s[4:7], s24 offen sc1
    s_waitcnt vmcnt(3)
    v_or3_b32 v8, v24, v25, v26
    s_waitcnt vmcnt(2)
    v_or3_b32 v8, v8, v27, v44
    v_or3_b32 v8, v8, v45, v46
    v_or_b32 v8, v8, v47
    v_and_b32 v8, 1, v8
    v_cmp_ne_u32 vcc, 0, v8
    ds_write_b128 v0, v[24:27] offset:1024
    ds_write_b128 v0, v[44:47] offset:5120
    s_cbranch_vccnz L_c3_L_ch01e_r
L_c3_L_ch01e:
    buffer_load_dwordx4 v[40:43], v0, s[4:7], s23 offen sc1
    s_waitcnt lgkmcnt(0)
    s_barrier
    ds_read_b128 v[12:15], v3 offset:0
    s_waitcnt vmcnt(2)
    ds_read_b128 v[16:19], v3 offset:32
    s_waitcnt lgkmcnt(1)
    v_smfmac_f32_16x16x64_bf16 v[28:31], v[12:15], v[48:55], v1
    s_waitcnt vmcnt(1)
    ds_read_b128 v[20:23], v3 offset:1024
    v_smfmac_f32_16x16x64_bf16 v[32:35], v[12:15], v[56:63], v1
    ds_read_b128 v[48:51], v4 offset:2048
    v_smfmac_f32_16x16x64_bf16 v[36:39], v[12:15], v[80:87], v1
    ds_read_b128 v[24:27], v3 offset:1056
    s_waitcnt lgkmcnt(3)
    v_smfmac_f32_16x16x64_bf16 v[28:31], v[16:19], v[88:95], v1
    ds_read_b128 v[52:55], v4 offset:3072
    v_smfmac_f32_16x16x64_bf16 v[32:35], v[16:19], v[96:103], v1
    ds_read_b128 v[56:59], v4 offset:16384
    v_smfmac_f32_16x16x64_bf16 v[36:39], v[16:19], v[104:111], v1
    ds_read_b128 v[12:15], v3 offset:2048
    s_waitcnt lgkmcnt(5)
    v_smfmac_f32_16x16x64_bf16 v[28:31], v[20:23], v[112:119], v1
    ds_read_b128 v[60:63], v4 offset:17408
    v_smfmac_f32_16x16x64_bf16 v[32:35], v[20:23], v[120:127], v1
    s_waitcnt lgkmcnt(3)
    v_smfmac_f32_16x16x64_bf16 v[36:39], v[20:23], v[48:55], v1
    ds_read_b128 v[16:19], v3 offset:2080
    v_smfmac_f32_16x16x64_bf16 v[28:31], v[24:27], v[128:135], v1
    ds_read_b128 v[48:51], v4 offset:4096
    v_smfmac_f32_16x16x64_bf16 v[32:35], v[24:27], v[136:143], v1
    ds_read_b128 v[52:55], v4 offset:5120
    v_smfmac_f32_16x16x64_bf16 v[36:39], v[24:27], v[144:151], v1
    ds_read_b128 v[20:23], v3 offset:3072
    s_waitcnt lgkmcnt(4)
    v_smfmac_f32_16x16x64_bf16 v[28:31], v[12:15], v[56:63], v1
    ds_read_b128 v[56:59], v4 offset:18432
    v_smfmac_f32_16x16x64_bf16 v[32:35], v[12:15], v[152:159], v1
    ds_read_b128 v[60:63], v4 offset:19456
    v_smfmac_f32_16x16x64_bf16 v[36:39], v[12:15], v[160:167], v1
    ds_read_b128 v[24:27], v3 offset:3104
    s_waitcnt lgkmcnt(6)
    v_smfmac_f32_16x16x64_bf16 v[28:31], v[16:19], v[168:175], v1
    s_waitcnt lgkmcnt(4)
    v_smfmac_f32_16x16x64_bf16 v[32:35], v[16:19], v[48:55], v1
    ds_read_b128 v[48:51], v4 offset:6144
    v_smfmac_f32_16x16x64_bf16 v[36:39], v[16:19], v[176:183], v1
    ds_read_b128 v[12:15], v3 offset:4096
    s_waitcnt lgkmcnt(5)
    v_smfmac_f32_16x16x64_bf16 v[28:31], v[20:23], v[184:191], v1
    ds_read_b128 v[52:55], v4 offset:7168
    v_smfmac_f32_16x16x64_bf16 v[32:35], v[20:23], v[192:199], v1
    s_waitcnt lgkmcnt(4)
    v_smfmac_f32_16x16x64_bf16 v[36:39], v[20:23], v[56:63], v1
    ds_read_b128 v[16:19], v3 offset:4128
    s_waitcnt lgkmcnt(4)
    v_smfmac_f32_16x16x64_bf16 v[28:31], v[24:27], v[200:207], v1
    ds_read_b128 v[56:59], v4 offset:20480
    v_smfmac_f32_16x16x64_bf16 v[32:35], v[24:27], v[208:215], v1
    s_waitcnt vmcnt(0)
    ds_write_b128 v0, v[40:43] offset:7168
    v_or3_b32 v8, v40, v41, v42
    v_smfmac_f32_16x16x64_bf16 v[36:39], v[24:27], v[216:223], v1
    ds_read_b128 v[20:23], v3 offset:5120
    v_or_b32 v8, v8, v43
    s_waitcnt lgkmcnt(4)
    v_smfmac_f32_16x16x64_bf16 v[28:31], v[12:15], v[48:55], v1
    ds_read_b128 v[60:63], v4 offset:21504
    v_and_b32 v8, 1, v8
    v_smfmac_f32_16x16x64_bf16 v[32:35], v[12:15], v[224:231], v1
    ds_read_b128 v[48:51], v4 offset:8192
    v_cmp_ne_u32 vcc, 0, v8
    v_smfmac_f32_16x16x64_bf16 v[36:39], v[12:15], v[232:239], v1
    ds_read_b128 v[24:27], v3 offset:5152
    s_nop 0
    s_waitcnt lgkmcnt(6)
    v_smfmac_f32_16x16x64_bf16 v[28:31], v[16:19], v[240:247], v1
    ds_read_b128 v[52:55], v4 offset:9216
    s_cbranch_vccnz L_c2_L_ch01o_r
L_c2_L_ch01o:
    s_waitcnt lgkmcnt(3)
    v_smfmac_f32_16x16x64_bf16 v[32:35], v[16:19], v[56:63], v1
    ds_read_b128 v[56:59], v4 offset:22528
    v_smfmac_f32_16x16x64_bf16 v[36:39], v[16:19], v[248:255], v1
    ds_read_b128 v[60:63], v4 offset:23552
    buffer_load_dwordx4 v[72:75], v0, s[4:7], s27 offen offset:2048 sc1
    v_smfmac_f32_16x16x64_bf16 v[28:31], v[20:23], a[0:7], v1
    s_barrier
    s_mov_b64 vcc, s[36:37]
    v_smfmac_f32_16x16x64_bf16 v[32:35], v[20:23], a[8:15], v1
    ds_read_b128 v[12:15], v3 offset:6144
    buffer_load_dwordx4 v[76:79], v0, s[4:7], s27 offen offset:3072 sc1
    v_cndmask_b32 v40, 0, v2, s[38:39]
    s_waitcnt lgkmcnt(3)
    v_smfmac_f32_16x16x64_bf16 v[36:39], v[20:23], v[48:55], v1
    ds_read_b128 v[16:19], v3 offset:6176
    v_cndmask_b32 v41, 0, v2, s[40:41]
    v_smfmac_f32_16x16x64_bf16 v[28:31], v[24:27], a[16:23], v1
    ds_read_b128 v[48:51], v4 offset:10240
    v_smfmac_f32_16x16x64_bf16 v[32:35], v[24:27], a[24:31], v1
    ds_read_b128 v[52:55], v4 offset:11264
    v_smfmac_f32_16x16x64_bf16 v[36:39], v[24:27], a[32:39], v1
    ds_read_b128 v[20:23], v3 offset:7168
    s_waitcnt lgkmcnt(4)
    v_smfmac_f32_16x16x64_bf16 v[28:31], v[12:15], v[56:63], v1
    ds_read_b128 v[56:59], v4 offset:24576
    v_smfmac_f32_16x16x64_bf16 v[32:35], v[12:15], a[40:47], v1
    ds_read_b128 v[60:63], v4 offset:25600
    v_smfmac_f32_16x16x64_bf16 v[36:39], v[12:15], a[48:55], v1
    ds_read_b128 v[24:27], v3 offset:7200
    s_waitcnt lgkmcnt(6)
    v_smfmac_f32_16x16x64_bf16 v[28:31], v[16:19], a[56:63], v1
    s_waitcnt lgkmcnt(4)
    v_smfmac_f32_16x16x64_bf16 v[32:35], v[16:19], v[48:55], v1
    ds_read_b128 v[48:51], v4 offset:12288
    v_smfmac_f32_16x16x64_bf16 v[36:39], v[16:19], a[64:71], v1
    ds_read_b128 v[12:15], v3 offset:8192
    s_waitcnt lgkmcnt(5)
    v_smfmac_f32_16x16x64_bf16 v[28:31], v[20:23], a[72:79], v1
    ds_read_b128 v[52:55], v4 offset:13312
    v_smfmac_f32_16x16x64_bf16 v[32:35], v[20:23], a[80:87], v1
    ds_read_b128 v[16:19], v3 offset:8224
    s_waitcnt lgkmcnt(5)
    v_smfmac_f32_16x16x64_bf16 v[36:39], v[20:23], v[56:63], v1
    ds_read_b128 v[56:59], v4 offset:26624
    s_waitcnt lgkmcnt(5)
    v_smfmac_f32_16x16x64_bf16 v[28:31], v[24:27], a[88:95], v1
    ds_read_b128 v[20:23], v3 offset:9216
    v_smfmac_f32_16x16x64_bf16 v[32:35], v[24:27], a[96:103], v1
    ds_read_b128 v[60:63], v4 offset:27648
    v_smfmac_f32_16x16x64_bf16 v[36:39], v[24:27], a[104:111], v1
    ds_read_b128 v[24:27], v3 offset:9248
    s_waitcnt lgkmcnt(5)
    v_smfmac_f32_16x16x64_bf16 v[28:31], v[12:15], v[48:55], v1
    v_smfmac_f32_16x16x64_bf16 v[32:35], v[12:15], a[112:119], v1
    s_waitcnt lgkmcnt(4)
    v_smfmac_f32_16x16x64_bf16 v[28:31], v[16:19], a[120:127], v1
    v_smfmac_f32_16x16x64_bf16 v[32:35], v[16:19], a[128:135], v1
    s_waitcnt lgkmcnt(1)
    v_smfmac_f32_16x16x64_bf16 v[28:31], v[20:23], v[56:63], v1
    v_smfmac_f32_16x16x64_bf16 v[32:35], v[20:23], a[136:143], v1
    s_waitcnt lgkmcnt(0)
    v_smfmac_f32_16x16x64_bf16 v[28:31], v[24:27], a[144:151], v1
    v_smfmac_f32_16x16x64_bf16 v[32:35], v[24:27], a[152:159], v1
    v_smfmac_f32_16x16x64_bf16 v[36:39], v[12:15], a[160:167], v1
    v_smfmac_f32_16x16x64_bf16 v[36:39], v[16:19], a[168:175], v1
    v_cvt_pk_bf16_f32 v44, v28, v29
    v_cvt_pk_bf16_f32 v45, v32, v33
    v_cvt_pk_bf16_f32 v46, v30, v31
    v_cvt_pk_bf16_f32 v47, v34, v35
    v_mfma_f32_16x16x16_bf16 v[28:31], v[44:45], v[40:41], 0
    v_mfma_f32_16x16x16_bf16 v[32:35], v[46:47], v[40:41], 0
    v_smfmac_f32_16x16x64_bf16 v[36:39], v[20:23], a[176:183], v1
    s_nop 3
    v_cvt_pk_bf16_f32 v44, v28, v32
    v_cvt_pk_bf16_f32 v45, v29, v33
    v_cvt_pk_bf16_f32 v46, v30, v34
    v_cvt_pk_bf16_f32 v47, v31, v35
    s_nop 1
    v_mfma_f32_16x16x32_bf16 v[32:35], v[68:71], v[44:47], 0
    v_mfma_f32_16x16x32_bf16 v[28:31], v[64:67], v[44:47], 0
    v_mfma_f32_16x16x32_bf16 v[12:15], v[44:47], v[44:47], 0
    v_smfmac_f32_16x16x64_bf16 v[36:39], v[24:27], a[184:191], v1
    v_cndmask_b32_dpp v28, v32, v28, vcc quad_perm:[2,3,2,3] row_mask:0xf bank_mask:0xf
    v_cndmask_b32_dpp v29, v33, v29, vcc quad_perm:[2,3,2,3] row_mask:0xf bank_mask:0xf
    v_cndmask_b32_dpp v30, v34, v30, vcc quad_perm:[2,3,2,3] row_mask:0xf bank_mask:0xf
    v_cndmask_b32_dpp v31, v35, v31, vcc quad_perm:[2,3,2,3] row_mask:0xf bank_mask:0xf
    ds_write_b128 v0, v[28:31] offset:11264
    v_cndmask_b32_dpp v11, v13, v12, vcc quad_perm:[2,3,2,3] row_mask:0xf bank_mask:0xf
    ds_write_b32 v0, v11 offset:14340
    buffer_load_dwordx4 v[64:67], v0, s[4:7], s30 offen offset:0 sc1
    buffer_load_dwordx4 v[68:71], v0, s[4:7], s30 offen offset:1024 sc1
    s_waitcnt lgkmcnt(0)
    s_barrier
    ds_read_b128 v[24:27], v0 offset:14336
    ds_read_b128 v[28:31], v0 offset:10240
    ds_read_b128 v[32:35], v0 offset:11264
    ds_read_b128 v[16:19], v0 offset:12288
    ds_read_b128 v[20:23], v0 offset:13312
    v_cvt_pk_bf16_f32 v42, v36, v37
    v_cvt_pk_bf16_f32 v43, v38, v39
    v_mov_b32 v13, 0
    v_mov_b32 v14, 0
    s_cmp_ge_u32 s18, 63
    s_cbranch_scc1 L_cdone0
    s_waitcnt lgkmcnt(4)
    v_pk_add_f32 v[24:25], v[24:25], v[26:27]
    v_add_f32 v24, v24, v25
    v_mul_f32 v40, s20, v24
    s_waitcnt lgkmcnt(3)
    v_pk_mul_f32 v[28:29], v[28:29], s[48:49]
    v_pk_mul_f32 v[30:31], v[30:31], s[48:49]
    v_exp_f32 v11, v40
    s_waitcnt lgkmcnt(2)
    v_pk_fma_f32 v[28:29], v[32:33], s[48:49], v[28:29]
    v_pk_fma_f32 v[30:31], v[34:35], s[48:49], v[30:31]
    s_waitcnt lgkmcnt(1)
    v_pk_fma_f32 v[28:29], v[16:17], s[48:49], v[28:29]
    v_pk_fma_f32 v[30:31], v[18:19], s[48:49], v[30:31]
    s_waitcnt lgkmcnt(0)
    v_pk_fma_f32 v[28:29], v[20:21], s[48:49], v[28:29]
    v_pk_fma_f32 v[30:31], v[22:23], s[48:49], v[30:31]
    v_mov_b32_dpp v9, v11 quad_perm:[0,1,0,1] row_mask:0xf bank_mask:0xf
    v_exp_f32 v16, v28
    v_exp_f32 v17, v29
    v_cvt_pk_bf16_f32 v12, v11, v9
    v_cvt_pk_bf16_f32 v15, v11, v9
    v_cvt_pk_bf16_f32 v32, v16, v17
    v_exp_f32 v18, v30
    v_mfma_f32_16x16x16_bf16 v[20:23], v[42:43], v[12:13], 0
    ds_read_b128 v[48:51], v4 offset:28672
    v_exp_f32 v19, v31
    v_mov_b32_dpp v34, v32 quad_perm:[0,1,0,1] row_mask:0xf bank_mask:0xf
    v_cvt_pk_bf16_f32 v33, v18, v19
    v_mfma_f32_16x16x16_bf16 v[24:27], v[42:43], v[14:15], 0
    ds_read_b128 v[52:55], v4 offset:29696
    v_add_f32 v8, v16, v17
    v_mov_b32_dpp v35, v33 quad_perm:[0,1,0,1] row_mask:0xf bank_mask:0xf
    v_add_f32 v10, v18, v19
    v_add_f32 v8, v8, v11
    s_waitcnt vmcnt(3)
    v_mfma_f32_16x16x32_bf16 v[20:23], v[72:75], v[32:35], v[20:23]
    ds_read_b128 v[56:59], v4 offset:32768
    v_add_f32 v8, v8, v10
    s_waitcnt vmcnt(2)
    v_mfma_f32_16x16x32_bf16 v[24:27], v[76:79], v[32:35], v[24:27]
    ds_read_b128 v[60:63], v4 offset:33792
    v_add_f32_dpp v9, v8, v8 quad_perm:[2,3,0,1] row_mask:0xf bank_mask:0xf
    v_add_f32_dpp v10, v8, v8 quad_perm:[2,3,0,1] row_mask:0xf bank_mask:0xf
    s_nop 1
    v_permlane16_swap_b32 v9, v10
    v_add_f32 v8, v9, v10
    v_add_f32 v9, v9, v10
    s_nop 1
    v_permlane32_swap_b32 v8, v9
    v_add_f32 v8, v8, v9
    v_rcp_f32 v10, v8
    v_subrev_u32 v8, s47, v8
    v_cmp_le_u32 s[44:45], s50, v8
    v_pk_mul_f32 v[20:21], v[20:21], v[10:11] op_sel_hi:[1,0]
    v_pk_mul_f32 v[22:23], v[22:23], v[10:11] op_sel_hi:[1,0]
    v_pk_mul_f32 v[24:25], v[24:25], v[10:11] op_sel_hi:[1,0]
    v_pk_mul_f32 v[26:27], v[26:27], v[10:11] op_sel_hi:[1,0]
    v_cvt_pk_bf16_f32 v32, v20, v24
    v_cvt_pk_bf16_f32 v33, v21, v25
    v_cvt_pk_bf16_f32 v34, v22, v26
    v_cvt_pk_bf16_f32 v35, v23, v27
    s_cmp_lg_u64 s[44:45], 0
    s_cbranch_scc1 L_sm_L_ch01o_r
L_sm_L_ch01o:
    s_mov_b64 exec, s[36:37]
    ds_write_b128 v3, v[32:35] offset:6176
    s_mov_b64 exec, -1
    v_mov_b64 v[36:37], 0
    v_mov_b64 v[38:39], 0
    v_mov_b64 v[40:41], 0
    v_mov_b64 v[42:43], 0
    v_mov_b64 v[44:45], 0
    v_mov_b64 v[46:47], 0
    s_waitcnt lgkmcnt(0)
    s_barrier
    ds_read_b128 v[12:15], v3 offset:6144
    ds_read_b128 v[16:19], v3 offset:6176
    ds_read_b128 v[20:23], v3 offset:7168
    ds_read_b128 v[24:27], v3 offset:7200
    s_waitcnt lgkmcnt(3)
    v_smfmac_f32_16x16x64_bf16 v[36:39], v[12:15], v[48:55], v1
    ds_read_b128 v[72:75], v4 offset:34816
    s_waitcnt lgkmcnt(3)
    v_smfmac_f32_16x16x64_bf16 v[36:39], v[16:19], v[56:63], v1
    ds_read_b128 v[76:79], v4 offset:35840
    s_waitcnt lgkmcnt(3)
    v_smfmac_f32_16x16x64_bf16 v[36:39], v[20:23], a[192:199], v1
    ds_read_b128 v[48:51], v4 offset:30720
    s_waitcnt lgkmcnt(3)
    v_smfmac_f32_16x16x64_bf16 v[36:39], v[24:27], a[200:207], v1
    ds_read_b128 v[52:55], v4 offset:31744
    v_smfmac_f32_16x16x64_bf16 v[40:43], v[12:15], a[208:215], v1
    v_smfmac_f32_16x16x64_bf16 v[40:43], v[16:19], a[216:223], v1
    v_cvt_pk_bf16_f32 v36, v36, v37
    s_waitcnt lgkmcnt(2)
    v_smfmac_f32_16x16x64_bf16 v[40:43], v[20:23], v[72:79], v1
    v_or_b32 v36, 1, v36
    v_smfmac_f32_16x16x64_bf16 v[40:43], v[24:27], a[224:231], v1
    buffer_store_dword v36, v5, s[4:7], s28 offen
    v_cvt_pk_bf16_f32 v37, v38, v39
    v_smfmac_f32_16x16x64_bf16 v[44:47], v[12:15], a[232:239], v1
    v_or_b32 v37, 1, v37
    s_waitcnt lgkmcnt(0)
    v_smfmac_f32_16x16x64_bf16 v[44:47], v[16:19], v[48:55], v1
    buffer_store_dword v37, v5, s[4:7], s29 offen
    v_cvt_pk_bf16_f32 v40, v40, v41
    v_smfmac_f32_16x16x64_bf16 v[44:47], v[20:23], a[240:247], v1
    v_or_b32 v40, 1, v40
    v_smfmac_f32_16x16x64_bf16 v[44:47], v[24:27], a[248:255], v1
    buffer_store_dword v40, v5, s[4:7], s46 offen
    v_cvt_pk_bf16_f32 v41, v42, v43
    v_or_b32 v41, 1, v41
    buffer_store_dword v41, v5, s[4:7], s73 offen
    s_nop 2
    v_cvt_pk_bf16_f32 v44, v44, v45
    v_cvt_pk_bf16_f32 v45, v46, v47
    v_or_b32 v44, 1, v44
    v_or_b32 v45, 1, v45
    buffer_store_dword v44, v5, s[4:7], s74 offen
    buffer_store_dword v45, v5, s[4:7], s75 offen
    ds_read_b128 v[48:51], v4 offset:0
    ds_read_b128 v[52:55], v4 offset:1024
    ds_read_b128 v[56:59], v4 offset:14336
    ds_read_b128 v[60:63], v4 offset:15360
    v_cndmask_b32 v20, 0, v2, s[42:43]
    v_cndmask_b32 v21, 0, v2, s[42:43]
    v_cndmask_b32 v22, 0, v2, s[42:43]
    v_cndmask_b32 v23, 0, v2, s[42:43]
    s_nop 15
    s_nop 3
    buffer_load_dword v12, v7, s[4:7], s21 offen offset:0 sc1
    buffer_load_dword v13, v7, s[4:7], s21 offen offset:256 sc1
    buffer_load_dword v14, v7, s[4:7], s21 offen offset:512 sc1
    buffer_load_dword v15, v7, s[4:7], s21 offen offset:768 sc1
    buffer_load_dword v16, v7, s[4:7], s21 offen offset:1024 sc1
    buffer_load_dword v17, v7, s[4:7], s21 offen offset:1280 sc1
    buffer_load_dword v18, v7, s[4:7], s21 offen offset:1536 sc1
    buffer_load_dword v19, v7, s[4:7], s21 offen offset:1792 sc1
    v_mov_b64 v[36:37], 0
    v_mov_b64 v[38:39], 0
    v_mov_b64 v[28:29], 0
    v_mov_b64 v[30:31], 0
    s_add_u32 s26, s26, 32768
    s_add_u32 s23, s23, 32768
    s_add_u32 s30, s30, 524288
    s_add_u32 s27, s27, 524288
    s_nop 14
    buffer_load_dword v40, v7, s[4:7], s21 offen offset:0 sc1
    buffer_load_dword v41, v7, s[4:7], s21 offen offset:256 sc1
    buffer_load_dword v42, v7, s[4:7], s21 offen offset:512 sc1
    buffer_load_dword v43, v7, s[4:7], s21 offen offset:768 sc1
    buffer_load_dword v44, v7, s[4:7], s21 offen offset:1024 sc1
    buffer_load_dword v45, v7, s[4:7], s21 offen offset:1280 sc1
    buffer_load_dword v46, v7, s[4:7], s21 offen offset:1536 sc1
    buffer_load_dword v47, v7, s[4:7], s21 offen offset:1792 sc1
    s_waitcnt vmcnt(12)
    v_mfma_f32_16x16x32_bf16 v[32:35], v[12:15], v[20:23], 0
    v_bitop3_b32 v8, v12, v13, v14 bitop3:0x80
    s_waitcnt vmcnt(8)
    v_mfma_f32_16x16x32_bf16 v[32:35], v[16:19], v[20:23], v[32:35]
    v_bitop3_b32 v8, v8, v15, v16 bitop3:0x80
    v_bitop3_b32 v8, v8, v17, v18 bitop3:0x80
    v_bitop3_b32 v8, v8, v19, 1 bitop3:0x80
    v_cmp_ne_u32 vcc, 1, v8
    s_nop 2
    v_cvt_pk_bf16_f32 v10, v32, v33
    v_cvt_pk_bf16_f32 v11, v34, v35
    v_or_b32 v10, 1, v10
    v_or_b32 v11, 1, v11
    s_cbranch_vccnz L_c1_L_ch01o_r
L_c1_L_ch01o:
    buffer_store_dwordx2 v[10:11], v6, s[4:7], s25 offen
    s_barrier
    buffer_store_dwordx2 v[10:11], v6, s[4:7], s26 offen sc1
    s_add_u32 s18, s18, 1
    v_mov_b64 v[32:33], 0
    v_mov_b64 v[34:35], 0
    s_nop 15
    s_nop 15
    s_nop 15
    s_nop 6
    buffer_load_dwordx4 v[24:27], v0, s[4:7], s22 offen sc1
    buffer_load_dwordx4 v[44:47], v0, s[4:7], s24 offen sc1
    s_nop 15
    s_nop 3
    buffer_load_dwordx4 v[16:19], v0, s[4:7], s22 offen sc1
    buffer_load_dwordx4 v[20:23], v0, s[4:7], s24 offen sc1
    s_waitcnt vmcnt(3)
    v_bitop3_b32 v8, v24, v25, v26 bitop3:0x80
    s_waitcnt vmcnt(2)
    v_bitop3_b32 v8, v8, v27, v44 bitop3:0x80
    v_bitop3_b32 v8, v8, v45, v46 bitop3:0x80
    v_bitop3_b32 v8, v8, v47, 1 bitop3:0x80
    v_cmp_ne_u32 vcc, 1, v8
    ds_write_b128 v0, v[24:27] offset:1024
    ds_write_b128 v0, v[44:47] offset:5120
    s_cbranch_vccnz L_c3_L_ch01o_r
L_c3_L_ch01o:
    buffer_load_dwordx4 v[40:43], v0, s[4:7], s23 offen sc1
    s_waitcnt lgkmcnt(0)
    s_barrier
    s_branch L_ch0_w1
L_c2_L_ch01e_r:
    s_add_u32 s19, s19, 1
    s_cmp_gt_u32 s19, 4000000
    s_cbranch_scc1 L_cend0
    buffer_load_dwordx4 v[40:43], v0, s[4:7], s23 offen sc1
    s_waitcnt vmcnt(0)
    v_bitop3_b32 v8, v40, v41, v42 bitop3:0x80
    v_bitop3_b32 v8, v8, v43, 1 bitop3:0x80
    v_cmp_ne_u32 vcc, 1, v8
    s_cbranch_vccnz L_c2_L_ch01e_r
    ds_write_b128 v0, v[40:43] offset:7168
    s_nop 7
    s_waitcnt lgkmcnt(0)
    s_branch L_c2_L_ch01e
L_sm_L_ch01e_r:
    v_max3_f32 v8, v28, v29, v30
    v_max3_f32 v8, v8, v31, v40
    s_nop 1
    v_max_f32_dpp v9, v8, v8 quad_perm:[2,3,0,1] row_mask:0xf bank_mask:0xf
    v_max_f32_dpp v10, v8, v8 quad_perm:[2,3,0,1] row_mask:0xf bank_mask:0xf
    s_nop 1
    v_permlane16_swap_b32 v9, v10
    v_max_f32 v8, v9, v10
    v_max_f32 v11, v9, v10
    s_nop 1
    v_permlane32_swap_b32 v8, v11
    v_max_f32 v8, v8, v11
    v_sub_f32 v28, v28, v8
    v_sub_f32 v29, v29, v8
    v_sub_f32 v30, v30, v8
    v_sub_f32 v31, v31, v8
    v_sub_f32 v40, v40, v8
    v_exp_f32 v11, v40
    s_nop 1
    v_mov_b32_dpp v9, v11 quad_perm:[0,1,0,1] row_mask:0xf bank_mask:0xf
    v_exp_f32 v16, v28
    v_exp_f32 v17, v29
    v_cvt_pk_bf16_f32 v12, v11, v9
    v_cvt_pk_bf16_f32 v15, v11, v9
    v_cvt_pk_bf16_f32 v32, v16, v17
    v_exp_f32 v18, v30
    v_mfma_f32_16x16x16_bf16 v[20:23], v[42:43], v[12:13], 0
    v_exp_f32 v19, v31
    v_mov_b32_dpp v34, v32 quad_perm:[0,1,0,1] row_mask:0xf bank_mask:0xf
    v_cvt_pk_bf16_f32 v33, v18, v19
    v_mfma_f32_16x16x16_bf16 v[24:27], v[42:43], v[14:15], 0
    v_add_f32 v8, v16, v17
    v_mov_b32_dpp v35, v33 quad_perm:[0,1,0,1] row_mask:0xf bank_mask:0xf
    v_add_f32 v10, v18, v19
    v_add_f32 v8, v8, v11
    v_mfma_f32_16x16x32_bf16 v[20:23], v[72:75], v[32:35], v[20:23]
    v_add_f32 v8, v8, v10
    v_mfma_f32_16x16x32_bf16 v[24:27], v[76:79], v[32:35], v[24:27]
    v_add_f32_dpp v9, v8, v8 quad_perm:[2,3,0,1] row_mask:0xf bank_mask:0xf
    v_add_f32_dpp v10, v8, v8 quad_perm:[2,3,0,1] row_mask:0xf bank_mask:0xf
    s_nop 1
    v_permlane16_swap_b32 v9, v10
    v_add_f32 v8, v9, v10
    v_add_f32 v9, v9, v10
    s_nop 1
    v_permlane32_swap_b32 v8, v9
    v_add_f32 v8, v8, v9
    v_rcp_f32 v10, v8
    s_nop 0
    v_pk_mul_f32 v[20:21], v[20:21], v[10:11] op_sel_hi:[1,0]
    v_pk_mul_f32 v[22:23], v[22:23], v[10:11] op_sel_hi:[1,0]
    v_pk_mul_f32 v[24:25], v[24:25], v[10:11] op_sel_hi:[1,0]
    v_pk_mul_f32 v[26:27], v[26:27], v[10:11] op_sel_hi:[1,0]
    v_cvt_pk_bf16_f32 v32, v20, v24
    v_cvt_pk_bf16_f32 v33, v21, v25
    v_cvt_pk_bf16_f32 v34, v22, v26
    v_cvt_pk_bf16_f32 v35, v23, v27
    s_branch L_sm_L_ch01e
L_c1_L_ch01e_r:
    s_add_u32 s19, s19, 1
    s_cmp_gt_u32 s19, 4000000
    s_cbranch_scc1 L_cend0
    buffer_load_dword v12, v7, s[4:7], s21 offen offset:0 sc1
    buffer_load_dword v13, v7, s[4:7], s21 offen offset:256 sc1
    buffer_load_dword v14, v7, s[4:7], s21 offen offset:512 sc1
    buffer_load_dword v15, v7, s[4:7], s21 offen offset:768 sc1
    buffer_load_dword v16, v7, s[4:7], s21 offen offset:1024 sc1
    buffer_load_dword v17, v7, s[4:7], s21 offen offset:1280 sc1
    buffer_load_dword v18, v7, s[4:7], s21 offen offset:1536 sc1
    buffer_load_dword v19, v7, s[4:7], s21 offen offset:1792 sc1
    s_waitcnt vmcnt(8)
    v_mfma_f32_16x16x32_bf16 v[32:35], v[40:43], v[20:23], 0
    v_or3_b32 v8, v40, v41, v42
    v_mfma_f32_16x16x32_bf16 v[32:35], v[44:47], v[20:23], v[32:35]
    v_or3_b32 v8, v8, v43, v44
    v_or3_b32 v8, v8, v45, v46
    v_or_b32 v8, v8, v47
    v_and_b32 v8, 1, v8
    v_cmp_ne_u32 vcc, 0, v8
    s_nop 1
    v_cvt_pk_bf16_f32 v10, v32, v33
    v_cvt_pk_bf16_f32 v11, v34, v35
    v_and_b32 v10, -2, v10
    v_and_b32 v11, -2, v11
    s_cbranch_vccnz L_c1_L_ch01e_r2
    s_branch L_c1_L_ch01e
L_c1_L_ch01e_r2:
    s_add_u32 s19, s19, 1
    s_cmp_gt_u32 s19, 4000000
    s_cbranch_scc1 L_cend0
    buffer_load_dword v40, v7, s[4:7], s21 offen offset:0 sc1
    buffer_load_dword v41, v7, s[4:7], s21 offen offset:256 sc1
    buffer_load_dword v42, v7, s[4:7], s21 offen offset:512 sc1
    buffer_load_dword v43, v7, s[4:7], s21 offen offset:768 sc1
    buffer_load_dword v44, v7, s[4:7], s21 offen offset:1024 sc1
    buffer_load_dword v45, v7, s[4:7], s21 offen offset:1280 sc1
    buffer_load_dword v46, v7, s[4:7], s21 offen offset:1536 sc1
    buffer_load_dword v47, v7, s[4:7], s21 offen offset:1792 sc1
    s_waitcnt vmcnt(8)
    v_mfma_f32_16x16x32_bf16 v[32:35], v[12:15], v[20:23], 0
    v_or3_b32 v8, v12, v13, v14
    v_mfma_f32_16x16x32_bf16 v[32:35], v[16:19], v[20:23], v[32:35]
    v_or3_b32 v8, v8, v15, v16
    v_or3_b32 v8, v8, v17, v18
    v_or_b32 v8, v8, v19
    v_and_b32 v8, 1, v8
    v_cmp_ne_u32 vcc, 0, v8
    s_nop 1
    v_cvt_pk_bf16_f32 v10, v32, v33
    v_cvt_pk_bf16_f32 v11, v34, v35
    v_and_b32 v10, -2, v10
    v_and_b32 v11, -2, v11
    s_cbranch_vccnz L_c1_L_ch01e_r
    s_branch L_c1_L_ch01e
L_c3_L_ch01e_r:
    s_add_u32 s19, s19, 1
    s_cmp_gt_u32 s19, 4000000
    s_cbranch_scc1 L_cend0
    buffer_load_dwordx4 v[24:27], v0, s[4:7], s22 offen sc1
    buffer_load_dwordx4 v[44:47], v0, s[4:7], s24 offen sc1
    s_waitcnt vmcnt(2)
    v_or3_b32 v8, v16, v17, v18
    v_or3_b32 v8, v8, v19, v20
    v_or3_b32 v8, v8, v21, v22
    v_or_b32 v8, v8, v23
    v_and_b32 v8, 1, v8
    v_cmp_ne_u32 vcc, 0, v8
    s_cbranch_vccnz L_c3_L_ch01e_r2
    ds_write_b128 v0, v[16:19] offset:1024
    ds_write_b128 v0, v[20:23] offset:5120
    s_branch L_c3_L_ch01e
L_c3_L_ch01e_r2:
    buffer_load_dwordx4 v[16:19], v0, s[4:7], s22 offen sc1
    buffer_load_dwordx4 v[20:23], v0, s[4:7], s24 offen sc1
    s_waitcnt vmcnt(2)
    v_or3_b32 v8, v24, v25, v26
    v_or3_b32 v8, v8, v27, v44
    v_or3_b32 v8, v8, v45, v46
    v_or_b32 v8, v8, v47
    v_and_b32 v8, 1, v8
    v_cmp_ne_u32 vcc, 0, v8
    s_cbranch_vccnz L_c3_L_ch01e_r
    ds_write_b128 v0, v[24:27] offset:1024
    ds_write_b128 v0, v[44:47] offset:5120
    s_branch L_c3_L_ch01e
L_c2_L_ch01o_r:
    s_add_u32 s19, s19, 1
    s_cmp_gt_u32 s19, 4000000
    s_cbranch_scc1 L_cend0
    buffer_load_dwordx4 v[40:43], v0, s[4:7], s23 offen sc1
    s_waitcnt vmcnt(0)
    v_or3_b32 v8, v40, v41, v42
    v_or_b32 v8, v8, v43
    v_and_b32 v8, 1, v8
    v_cmp_ne_u32 vcc, 0, v8
    s_cbranch_vccnz L_c2_L_ch01o_r
    ds_write_b128 v0, v[40:43] offset:7168
    s_nop 7
    s_waitcnt lgkmcnt(0)
    s_branch L_c2_L_ch01o
L_sm_L_ch01o_r:
    v_max3_f32 v8, v28, v29, v30
    v_max3_f32 v8, v8, v31, v40
    s_nop 1
    v_max_f32_dpp v9, v8, v8 quad_perm:[2,3,0,1] row_mask:0xf bank_mask:0xf
    v_max_f32_dpp v10, v8, v8 quad_perm:[2,3,0,1] row_mask:0xf bank_mask:0xf
    s_nop 1
    v_permlane16_swap_b32 v9, v10
    v_max_f32 v8, v9, v10
    v_max_f32 v11, v9, v10
    s_nop 1
    v_permlane32_swap_b32 v8, v11
    v_max_f32 v8, v8, v11
    v_sub_f32 v28, v28, v8
    v_sub_f32 v29, v29, v8
    v_sub_f32 v30, v30, v8
    v_sub_f32 v31, v31, v8
    v_sub_f32 v40, v40, v8
    v_exp_f32 v11, v40
    s_nop 1
    v_mov_b32_dpp v9, v11 quad_perm:[0,1,0,1] row_mask:0xf bank_mask:0xf
    v_exp_f32 v16, v28
    v_exp_f32 v17, v29
    v_cvt_pk_bf16_f32 v12, v11, v9
    v_cvt_pk_bf16_f32 v15, v11, v9
    v_cvt_pk_bf16_f32 v32, v16, v17
    v_exp_f32 v18, v30
    v_mfma_f32_16x16x16_bf16 v[20:23], v[42:43], v[12:13], 0
    v_exp_f32 v19, v31
    v_mov_b32_dpp v34, v32 quad_perm:[0,1,0,1] row_mask:0xf bank_mask:0xf
    v_cvt_pk_bf16_f32 v33, v18, v19
    v_mfma_f32_16x16x16_bf16 v[24:27], v[42:43], v[14:15], 0
    v_add_f32 v8, v16, v17
    v_mov_b32_dpp v35, v33 quad_perm:[0,1,0,1] row_mask:0xf bank_mask:0xf
    v_add_f32 v10, v18, v19
    v_add_f32 v8, v8, v11
    v_mfma_f32_16x16x32_bf16 v[20:23], v[72:75], v[32:35], v[20:23]
    v_add_f32 v8, v8, v10
    v_mfma_f32_16x16x32_bf16 v[24:27], v[76:79], v[32:35], v[24:27]
    v_add_f32_dpp v9, v8, v8 quad_perm:[2,3,0,1] row_mask:0xf bank_mask:0xf
    v_add_f32_dpp v10, v8, v8 quad_perm:[2,3,0,1] row_mask:0xf bank_mask:0xf
    s_nop 1
    v_permlane16_swap_b32 v9, v10
    v_add_f32 v8, v9, v10
    v_add_f32 v9, v9, v10
    s_nop 1
    v_permlane32_swap_b32 v8, v9
    v_add_f32 v8, v8, v9
    v_rcp_f32 v10, v8
    s_nop 0
    v_pk_mul_f32 v[20:21], v[20:21], v[10:11] op_sel_hi:[1,0]
    v_pk_mul_f32 v[22:23], v[22:23], v[10:11] op_sel_hi:[1,0]
    v_pk_mul_f32 v[24:25], v[24:25], v[10:11] op_sel_hi:[1,0]
    v_pk_mul_f32 v[26:27], v[26:27], v[10:11] op_sel_hi:[1,0]
    v_cvt_pk_bf16_f32 v32, v20, v24
    v_cvt_pk_bf16_f32 v33, v21, v25
    v_cvt_pk_bf16_f32 v34, v22, v26
    v_cvt_pk_bf16_f32 v35, v23, v27
    s_branch L_sm_L_ch01o
L_c1_L_ch01o_r:
    s_add_u32 s19, s19, 1
    s_cmp_gt_u32 s19, 4000000
    s_cbranch_scc1 L_cend0
    buffer_load_dword v12, v7, s[4:7], s21 offen offset:0 sc1
    buffer_load_dword v13, v7, s[4:7], s21 offen offset:256 sc1
    buffer_load_dword v14, v7, s[4:7], s21 offen offset:512 sc1
    buffer_load_dword v15, v7, s[4:7], s21 offen offset:768 sc1
    buffer_load_dword v16, v7, s[4:7], s21 offen offset:1024 sc1
    buffer_load_dword v17, v7, s[4:7], s21 offen offset:1280 sc1
    buffer_load_dword v18, v7, s[4:7], s21 offen offset:1536 sc1
    buffer_load_dword v19, v7, s[4:7], s21 offen offset:1792 sc1
    s_waitcnt vmcnt(8)
    v_mfma_f32_16x16x32_bf16 v[32:35], v[40:43], v[20:23], 0
    v_bitop3_b32 v8, v40, v41, v42 bitop3:0x80
    v_mfma_f32_16x16x32_bf16 v[32:35], v[44:47], v[20:23], v[32:35]
    v_bitop3_b32 v8, v8, v43, v44 bitop3:0x80
    v_bitop3_b32 v8, v8, v45, v46 bitop3:0x80
    v_bitop3_b32 v8, v8, v47, 1 bitop3:0x80
    v_cmp_ne_u32 vcc, 1, v8
    s_nop 2
    v_cvt_pk_bf16_f32 v10, v32, v33
    v_cvt_pk_bf16_f32 v11, v34, v35
    v_or_b32 v10, 1, v10
    v_or_b32 v11, 1, v11
    s_cbranch_vccnz L_c1_L_ch01o_r2
    s_branch L_c1_L_ch01o
L_c1_L_ch01o_r2:
    s_add_u32 s19, s19, 1
    s_cmp_gt_u32 s19, 4000000
    s_cbranch_scc1 L_cend0
    buffer_load_dword v40, v7, s[4:7], s21 offen offset:0 sc1
    buffer_load_dword v41, v7, s[4:7], s21 offen offset:256 sc1
    buffer_load_dword v42, v7, s[4:7], s21 offen offset:512 sc1
    buffer_load_dword v43, v7, s[4:7], s21 offen offset:768 sc1
    buffer_load_dword v44, v7, s[4:7], s21 offen offset:1024 sc1
    buffer_load_dword v45, v7, s[4:7], s21 offen offset:1280 sc1
    buffer_load_dword v46, v7, s[4:7], s21 offen offset:1536 sc1
    buffer_load_dword v47, v7, s[4:7], s21 offen offset:1792 sc1
    s_waitcnt vmcnt(8)
    v_mfma_f32_16x16x32_bf16 v[32:35], v[12:15], v[20:23], 0
    v_bitop3_b32 v8, v12, v13, v14 bitop3:0x80
    v_mfma_f32_16x16x32_bf16 v[32:35], v[16:19], v[20:23], v[32:35]
    v_bitop3_b32 v8, v8, v15, v16 bitop3:0x80
    v_bitop3_b32 v8, v8, v17, v18 bitop3:0x80
    v_bitop3_b32 v8, v8, v19, 1 bitop3:0x80
    v_cmp_ne_u32 vcc, 1, v8
    s_nop 2
    v_cvt_pk_bf16_f32 v10, v32, v33
    v_cvt_pk_bf16_f32 v11, v34, v35
    v_or_b32 v10, 1, v10
    v_or_b32 v11, 1, v11
    s_cbranch_vccnz L_c1_L_ch01o_r
    s_branch L_c1_L_ch01o
L_c3_L_ch01o_r:
    s_add_u32 s19, s19, 1
    s_cmp_gt_u32 s19, 4000000
    s_cbranch_scc1 L_cend0
    buffer_load_dwordx4 v[24:27], v0, s[4:7], s22 offen sc1
    buffer_load_dwordx4 v[44:47], v0, s[4:7], s24 offen sc1
    s_waitcnt vmcnt(2)
    v_bitop3_b32 v8, v16, v17, v18 bitop3:0x80
    v_bitop3_b32 v8, v8, v19, v20 bitop3:0x80
    v_bitop3_b32 v8, v8, v21, v22 bitop3:0x80
    v_bitop3_b32 v8, v8, v23, 1 bitop3:0x80
    v_cmp_ne_u32 vcc, 1, v8
    s_cbranch_vccnz L_c3_L_ch01o_r2
    ds_write_b128 v0, v[16:19] offset:1024
    ds_write_b128 v0, v[20:23] offset:5120
    s_branch L_c3_L_ch01o
L_c3_L_ch01o_r2:
    buffer_load_dwordx4 v[16:19], v0, s[4:7], s22 offen sc1
    buffer_load_dwordx4 v[20:23], v0, s[4:7], s24 offen sc1
    s_waitcnt vmcnt(2)
    v_bitop3_b32 v8, v24, v25, v26 bitop3:0x80
    v_bitop3_b32 v8, v8, v27, v44 bitop3:0x80
    v_bitop3_b32 v8, v8, v45, v46 bitop3:0x80
    v_bitop3_b32 v8, v8, v47, 1 bitop3:0x80
    v_cmp_ne_u32 vcc, 1, v8
    s_cbranch_vccnz L_c3_L_ch01o_r
    ds_write_b128 v0, v[24:27] offset:1024
    ds_write_b128 v0, v[44:47] offset:5120
    s_branch L_c3_L_ch01o
    .p2align 6
L_ch0_w2:
    ds_read_b128 v[12:15], v3 offset:0
    s_waitcnt vmcnt(1)
    ds_read_b128 v[16:19], v3 offset:32
    s_waitcnt lgkmcnt(1)
    v_smfmac_f32_16x16x64_bf16 v[28:31], v[12:15], v[48:55], v1
    ds_read_b128 v[20:23], v3 offset:1024
    v_smfmac_f32_16x16x64_bf16 v[32:35], v[12:15], v[56:63], v1
    ds_read_b128 v[48:51], v4 offset:2048
    v_smfmac_f32_16x16x64_bf16 v[36:39], v[12:15], v[80:87], v1
    ds_read_b128 v[24:27], v3 offset:1056
    s_waitcnt lgkmcnt(3)
    v_smfmac_f32_16x16x64_bf16 v[28:31], v[16:19], v[88:95], v1
    ds_read_b128 v[52:55], v4 offset:3072
    v_smfmac_f32_16x16x64_bf16 v[32:35], v[16:19], v[96:103], v1
    ds_read_b128 v[56:59], v4 offset:16384
    v_smfmac_f32_16x16x64_bf16 v[36:39], v[16:19], v[104:111], v1
    ds_read_b128 v[12:15], v3 offset:2048
    s_waitcnt lgkmcnt(5)
    v_smfmac_f32_16x16x64_bf16 v[28:31], v[20:23], v[112:119], v1
    ds_read_b128 v[60:63], v4 offset:17408
    v_smfmac_f32_16x16x64_bf16 v[32:35], v[20:23], v[120:127], v1
    s_waitcnt lgkmcnt(3)
    v_smfmac_f32_16x16x64_bf16 v[36:39], v[20:23], v[48:55], v1
    ds_read_b128 v[16:19], v3 offset:2080
    v_smfmac_f32_16x16x64_bf16 v[28:31], v[24:27], v[128:135], v1
    ds_read_b128 v[48:51], v4 offset:4096
    v_smfmac_f32_16x16x64_bf16 v[32:35], v[24:27], v[136:143], v1
    ds_read_b128 v[52:55], v4 offset:5120
    v_smfmac_f32_16x16x64_bf16 v[36:39], v[24:27], v[144:151], v1
    ds_read_b128 v[20:23], v3 offset:3072
    s_waitcnt lgkmcnt(4)
    v_smfmac_f32_16x16x64_bf16 v[28:31], v[12:15], v[56:63], v1
    ds_read_b128 v[56:59], v4 offset:18432
    v_smfmac_f32_16x16x64_bf16 v[32:35], v[12:15], v[152:159], v1
    ds_read_b128 v[60:63], v4 offset:19456
    v_smfmac_f32_16x16x64_bf16 v[36:39], v[12:15], v[160:167], v1
    ds_read_b128 v[24:27], v3 offset:3104
    s_waitcnt lgkmcnt(6)
    v_smfmac_f32_16x16x64_bf16 v[28:31], v[16:19], v[168:175], v1
    s_waitcnt lgkmcnt(4)
    v_smfmac_f32_16x16x64_bf16 v[32:35], v[16:19], v[48:55], v1
    ds_read_b128 v[48:51], v4 offset:6144
    v_smfmac_f32_16x16x64_bf16 v[36:39], v[16:19], v[176:183], v1
    ds_read_b128 v[12:15], v3 offset:4096
    s_waitcnt lgkmcnt(5)
    v_smfmac_f32_16x16x64_bf16 v[28:31], v[20:23], v[184:191], v1
    ds_read_b128 v[52:55], v4 offset:7168
    v_smfmac_f32_16x16x64_bf16 v[32:35], v[20:23], v[192:199], v1
    s_waitcnt lgkmcnt(4)
    v_smfmac_f32_16x16x64_bf16 v[36:39], v[20:23], v[56:63], v1
    ds_read_b128 v[16:19], v3 offset:4128
    s_waitcnt lgkmcnt(4)
    v_smfmac_f32_16x16x64_bf16 v[28:31], v[24:27], v[200:207], v1
    ds_read_b128 v[56:59], v4 offset:20480
    v_smfmac_f32_16x16x64_bf16 v[32:35], v[24:27], v[208:215], v1
    s_waitcnt vmcnt(0)
    ds_write_b128 v0, v[40:43] offset:8192
    v_bitop3_b32 v8, v40, v41, v42 bitop3:0x80
    v_smfmac_f32_16x16x64_bf16 v[36:39], v[24:27], v[216:223], v1
    ds_read_b128 v[20:23], v3 offset:5120
    v_and_b32 v8, v8, v43
    s_waitcnt lgkmcnt(4)
    v_smfmac_f32_16x16x64_bf16 v[28:31], v[12:15], v[48:55], v1
    ds_read_b128 v[60:63], v4 offset:21504
    v_and_or_b32 v8, v8, 1, s35
    v_smfmac_f32_16x16x64_bf16 v[32:35], v[12:15], v[224:231], v1
    ds_read_b128 v[48:51], v4 offset:8192
    v_cmp_ne_u32 vcc, 1, v8
    v_smfmac_f32_16x16x64_bf16 v[36:39], v[12:15], v[232:239], v1
    ds_read_b128 v[24:27], v3 offset:5152
    s_nop 0
    s_waitcnt lgkmcnt(6)
    v_smfmac_f32_16x16x64_bf16 v[28:31], v[16:19], v[240:247], v1
    ds_read_b128 v[52:55], v4 offset:9216
    s_cbranch_vccnz L_c2_L_ch02e_r
L_c2_L_ch02e:
    s_waitcnt lgkmcnt(3)
    v_smfmac_f32_16x16x64_bf16 v[32:35], v[16:19], v[56:63], v1
    ds_read_b128 v[56:59], v4 offset:22528
    v_smfmac_f32_16x16x64_bf16 v[36:39], v[16:19], v[248:255], v1
    ds_read_b128 v[60:63], v4 offset:23552
    buffer_load_dwordx4 v[72:75], v0, s[4:7], s27 offen offset:2048 sc1
    v_smfmac_f32_16x16x64_bf16 v[28:31], v[20:23], a[0:7], v1
    s_barrier
    s_mov_b64 vcc, s[36:37]
    s_mov_b32 s35, 0
    v_smfmac_f32_16x16x64_bf16 v[32:35], v[20:23], a[8:15], v1
    ds_read_b128 v[12:15], v3 offset:6144
    buffer_load_dwordx4 v[76:79], v0, s[4:7], s27 offen offset:3072 sc1
    v_cndmask_b32 v40, 0, v2, s[38:39]
    s_waitcnt lgkmcnt(3)
    v_smfmac_f32_16x16x64_bf16 v[36:39], v[20:23], v[48:55], v1
    ds_read_b128 v[16:19], v3 offset:6176
    v_cndmask_b32 v41, 0, v2, s[40:41]
    v_smfmac_f32_16x16x64_bf16 v[28:31], v[24:27], a[16:23], v1
    ds_read_b128 v[48:51], v4 offset:10240
    v_smfmac_f32_16x16x64_bf16 v[32:35], v[24:27], a[24:31], v1
    ds_read_b128 v[52:55], v4 offset:11264
    v_smfmac_f32_16x16x64_bf16 v[36:39], v[24:27], a[32:39], v1
    ds_read_b128 v[20:23], v3 offset:7168
    s_waitcnt lgkmcnt(4)
    v_smfmac_f32_16x16x64_bf16 v[28:31], v[12:15], v[56:63], v1
    ds_read_b128 v[56:59], v4 offset:24576
    v_smfmac_f32_16x16x64_bf16 v[32:35], v[12:15], a[40:47], v1
    ds_read_b128 v[60:63], v4 offset:25600
    v_smfmac_f32_16x16x64_bf16 v[36:39], v[12:15], a[48:55], v1
    ds_read_b128 v[24:27], v3 offset:7200
    s_waitcnt lgkmcnt(6)
    v_smfmac_f32_16x16x64_bf16 v[28:31], v[16:19], a[56:63], v1
    s_waitcnt lgkmcnt(4)
    v_smfmac_f32_16x16x64_bf16 v[32:35], v[16:19], v[48:55], v1
    ds_read_b128 v[48:51], v4 offset:12288
    v_smfmac_f32_16x16x64_bf16 v[36:39], v[16:19], a[64:71], v1
    ds_read_b128 v[12:15], v3 offset:8192
    s_waitcnt lgkmcnt(5)
    v_smfmac_f32_16x16x64_bf16 v[28:31], v[20:23], a[72:79], v1
    ds_read_b128 v[52:55], v4 offset:13312
    v_smfmac_f32_16x16x64_bf16 v[32:35], v[20:23], a[80:87], v1
    ds_read_b128 v[16:19], v3 offset:8224
    s_waitcnt lgkmcnt(5)
    v_smfmac_f32_16x16x64_bf16 v[36:39], v[20:23], v[56:63], v1
    ds_read_b128 v[56:59], v4 offset:26624
    s_waitcnt lgkmcnt(5)
    v_smfmac_f32_16x16x64_bf16 v[28:31], v[24:27], a[88:95], v1
    ds_read_b128 v[20:23], v3 offset:9216
    v_smfmac_f32_16x16x64_bf16 v[32:35], v[24:27], a[96:103], v1
    ds_read_b128 v[60:63], v4 offset:27648
    v_smfmac_f32_16x16x64_bf16 v[36:39], v[24:27], a[104:111], v1
    ds_read_b128 v[24:27], v3 offset:9248
    s_waitcnt lgkmcnt(5)
    v_smfmac_f32_16x16x64_bf16 v[28:31], v[12:15], v[48:55], v1
    v_smfmac_f32_16x16x64_bf16 v[32:35], v[12:15], a[112:119], v1
    s_waitcnt lgkmcnt(4)
    v_smfmac_f32_16x16x64_bf16 v[28:31], v[16:19], a[120:127], v1
    v_smfmac_f32_16x16x64_bf16 v[32:35], v[16:19], a[128:135], v1
    s_waitcnt lgkmcnt(1)
    v_smfmac_f32_16x16x64_bf16 v[28:31], v[20:23], v[56:63], v1
    v_smfmac_f32_16x16x64_bf16 v[32:35], v[20:23], a[136:143], v1
    s_waitcnt lgkmcnt(0)
    v_smfmac_f32_16x16x64_bf16 v[28:31], v[24:27], a[144:151], v1
    v_smfmac_f32_16x16x64_bf16 v[32:35], v[24:27], a[152:159], v1
    v_smfmac_f32_16x16x64_bf16 v[36:39], v[12:15], a[160:167], v1
    v_smfmac_f32_16x16x64_bf16 v[36:39], v[16:19], a[168:175], v1
    v_cvt_pk_bf16_f32 v44, v28, v29
    v_cvt_pk_bf16_f32 v45, v32, v33
    v_cvt_pk_bf16_f32 v46, v30, v31
    v_cvt_pk_bf16_f32 v47, v34, v35
    v_mfma_f32_16x16x16_bf16 v[28:31], v[44:45], v[40:41], 0
    v_mfma_f32_16x16x16_bf16 v[32:35], v[46:47], v[40:41], 0
    v_smfmac_f32_16x16x64_bf16 v[36:39], v[20:23], a[176:183], v1
    s_nop 3
    v_cvt_pk_bf16_f32 v44, v28, v32
    v_cvt_pk_bf16_f32 v45, v29, v33
    v_cvt_pk_bf16_f32 v46, v30, v34
    v_cvt_pk_bf16_f32 v47, v31, v35
    s_nop 1
    v_mfma_f32_16x16x32_bf16 v[32:35], v[68:71], v[44:47], 0
    v_mfma_f32_16x16x32_bf16 v[28:31], v[64:67], v[44:47], 0
    v_mfma_f32_16x16x32_bf16 v[12:15], v[44:47], v[44:47], 0
    v_smfmac_f32_16x16x64_bf16 v[36:39], v[24:27], a[184:191], v1
    v_cndmask_b32_dpp v28, v32, v28, vcc quad_perm:[2,3,2,3] row_mask:0xf bank_mask:0xf
    v_cndmask_b32_dpp v29, v33, v29, vcc quad_perm:[2,3,2,3] row_mask:0xf bank_mask:0xf
    v_cndmask_b32_dpp v30, v34, v30, vcc quad_perm:[2,3,2,3] row_mask:0xf bank_mask:0xf
    v_cndmask_b32_dpp v31, v35, v31, vcc quad_perm:[2,3,2,3] row_mask:0xf bank_mask:0xf
    ds_write_b128 v0, v[28:31] offset:12288
    v_cndmask_b32_dpp v11, v13, v12, vcc quad_perm:[2,3,2,3] row_mask:0xf bank_mask:0xf
    ds_write_b32 v0, v11 offset:14344
    buffer_load_dwordx4 v[64:67], v0, s[4:7], s30 offen offset:0 sc1
    buffer_load_dwordx4 v[68:71], v0, s[4:7], s30 offen offset:1024 sc1
    s_waitcnt lgkmcnt(0)
    s_barrier
    ds_read_b128 v[24:27], v0 offset:14336
    ds_read_b128 v[28:31], v0 offset:10240
    ds_read_b128 v[32:35], v0 offset:11264
    ds_read_b128 v[16:19], v0 offset:12288
    ds_read_b128 v[20:23], v0 offset:13312
    v_cvt_pk_bf16_f32 v42, v36, v37
    v_cvt_pk_bf16_f32 v43, v38, v39
    v_mov_b32 v13, 0
    v_mov_b32 v14, 0
    s_waitcnt lgkmcnt(4)
    v_pk_add_f32 v[24:25], v[24:25], v[26:27]
    v_add_f32 v24, v24, v25
    v_mul_f32 v40, s20, v24
    s_waitcnt lgkmcnt(3)
    v_pk_mul_f32 v[28:29], v[28:29], s[48:49]
    v_pk_mul_f32 v[30:31], v[30:31], s[48:49]
    v_exp_f32 v11, v40
    s_waitcnt lgkmcnt(2)
    v_pk_fma_f32 v[28:29], v[32:33], s[48:49], v[28:29]
    v_pk_fma_f32 v[30:31], v[34:35], s[48:49], v[30:31]
    s_waitcnt lgkmcnt(1)
    v_pk_fma_f32 v[28:29], v[16:17], s[48:49], v[28:29]
    v_pk_fma_f32 v[30:31], v[18:19], s[48:49], v[30:31]
    s_waitcnt lgkmcnt(0)
    v_pk_fma_f32 v[28:29], v[20:21], s[48:49], v[28:29]
    v_pk_fma_f32 v[30:31], v[22:23], s[48:49], v[30:31]
    v_mov_b32_dpp v9, v11 quad_perm:[0,1,0,1] row_mask:0xf bank_mask:0xf
    v_exp_f32 v16, v28
    v_exp_f32 v17, v29
    v_cvt_pk_bf16_f32 v12, v11, v9
    v_cvt_pk_bf16_f32 v15, v11, v9
    v_cvt_pk_bf16_f32 v32, v16, v17
    v_exp_f32 v18, v30
    v_mfma_f32_16x16x16_bf16 v[20:23], v[42:43], v[12:13], 0
    ds_read_b128 v[48:51], v4 offset:28672
    v_exp_f32 v19, v31
    v_mov_b32_dpp v34, v32 quad_perm:[0,1,0,1] row_mask:0xf bank_mask:0xf
    v_cvt_pk_bf16_f32 v33, v18, v19
    v_mfma_f32_16x16x16_bf16 v[24:27], v[42:43], v[14:15], 0
    ds_read_b128 v[52:55], v4 offset:29696
    v_add_f32 v8, v16, v17
    v_mov_b32_dpp v35, v33 quad_perm:[0,1,0,1] row_mask:0xf bank_mask:0xf
    v_add_f32 v10, v18, v19
    v_add_f32 v8, v8, v11
    s_waitcnt vmcnt(3)
    v_mfma_f32_16x16x32_bf16 v[20:23], v[72:75], v[32:35], v[20:23]
    ds_read_b128 v[56:59], v4 offset:32768
    v_add_f32 v8, v8, v10
    s_waitcnt vmcnt(2)
    v_mfma_f32_16x16x32_bf16 v[24:27], v[76:79], v[32:35], v[24:27]
    ds_read_b128 v[60:63], v4 offset:33792
    v_add_f32_dpp v9, v8, v8 quad_perm:[2,3,0,1] row_mask:0xf bank_mask:0xf
    v_add_f32_dpp v10, v8, v8 quad_perm:[2,3,0,1] row_mask:0xf bank_mask:0xf
    s_nop 1
    v_permlane16_swap_b32 v9, v10
    v_add_f32 v8, v9, v10
    v_add_f32 v9, v9, v10
    s_nop 1
    v_permlane32_swap_b32 v8, v9
    v_add_f32 v8, v8, v9
    v_rcp_f32 v10, v8
    v_subrev_u32 v8, s47, v8
    v_cmp_le_u32 s[44:45], s50, v8
    v_pk_mul_f32 v[20:21], v[20:21], v[10:11] op_sel_hi:[1,0]
    v_pk_mul_f32 v[22:23], v[22:23], v[10:11] op_sel_hi:[1,0]
    v_pk_mul_f32 v[24:25], v[24:25], v[10:11] op_sel_hi:[1,0]
    v_pk_mul_f32 v[26:27], v[26:27], v[10:11] op_sel_hi:[1,0]
    v_cvt_pk_bf16_f32 v32, v20, v24
    v_cvt_pk_bf16_f32 v33, v21, v25
    v_cvt_pk_bf16_f32 v34, v22, v26
    v_cvt_pk_bf16_f32 v35, v23, v27
    s_cmp_lg_u64 s[44:45], 0
    s_cbranch_scc1 L_sm_L_ch02e_r
L_sm_L_ch02e:
    s_mov_b64 exec, s[36:37]
    ds_write_b128 v3, v[32:35] offset:7168
    s_mov_b64 exec, -1
    v_mov_b64 v[36:37], 0
    v_mov_b64 v[38:39], 0
    v_mov_b64 v[40:41], 0
    v_mov_b64 v[42:43], 0
    v_mov_b64 v[44:45], 0
    v_mov_b64 v[46:47], 0
    s_waitcnt lgkmcnt(0)
    s_barrier
    ds_read_b128 v[12:15], v3 offset:6144
    ds_read_b128 v[16:19], v3 offset:6176
    ds_read_b128 v[20:23], v3 offset:7168
    ds_read_b128 v[24:27], v3 offset:7200
    s_waitcnt lgkmcnt(3)
    v_smfmac_f32_16x16x64_bf16 v[36:39], v[12:15], v[48:55], v1
    ds_read_b128 v[72:75], v4 offset:34816
    s_waitcnt lgkmcnt(3)
    v_smfmac_f32_16x16x64_bf16 v[36:39], v[16:19], v[56:63], v1
    ds_read_b128 v[76:79], v4 offset:35840
    s_waitcnt lgkmcnt(3)
    v_smfmac_f32_16x16x64_bf16 v[36:39], v[20:23], a[192:199], v1
    ds_read_b128 v[48:51], v4 offset:30720
    s_waitcnt lgkmcnt(3)
    v_smfmac_f32_16x16x64_bf16 v[36:39], v[24:27], a[200:207], v1
    ds_read_b128 v[52:55], v4 offset:31744
    v_smfmac_f32_16x16x64_bf16 v[40:43], v[12:15], a[208:215], v1
    v_smfmac_f32_16x16x64_bf16 v[40:43], v[16:19], a[216:223], v1
    v_cvt_pk_bf16_f32 v36, v36, v37
    s_waitcnt lgkmcnt(2)
    v_smfmac_f32_16x16x64_bf16 v[40:43], v[20:23], v[72:79], v1
    v_and_b32 v36, -2, v36
    v_smfmac_f32_16x16x64_bf16 v[40:43], v[24:27], a[224:231], v1
    buffer_store_dword v36, v5, s[4:7], s28 offen
    v_cvt_pk_bf16_f32 v37, v38, v39
    v_smfmac_f32_16x16x64_bf16 v[44:47], v[12:15], a[232:239], v1
    v_and_b32 v37, -2, v37
    s_waitcnt lgkmcnt(0)
    v_smfmac_f32_16x16x64_bf16 v[44:47], v[16:19], v[48:55], v1
    buffer_store_dword v37, v5, s[4:7], s29 offen
    v_cvt_pk_bf16_f32 v40, v40, v41
    v_smfmac_f32_16x16x64_bf16 v[44:47], v[20:23], a[240:247], v1
    v_and_b32 v40, -2, v40
    v_smfmac_f32_16x16x64_bf16 v[44:47], v[24:27], a[248:255], v1
    buffer_store_dword v40, v5, s[4:7], s46 offen
    v_cvt_pk_bf16_f32 v41, v42, v43
    v_and_b32 v41, -2, v41
    buffer_store_dword v41, v5, s[4:7], s73 offen
    s_nop 2
    v_cvt_pk_bf16_f32 v44, v44, v45
    v_cvt_pk_bf16_f32 v45, v46, v47
    v_and_b32 v44, -2, v44
    v_and_b32 v45, -2, v45
    buffer_store_dword v44, v5, s[4:7], s74 offen
    buffer_store_dword v45, v5, s[4:7], s75 offen
    ds_read_b128 v[48:51], v4 offset:0
    ds_read_b128 v[52:55], v4 offset:1024
    ds_read_b128 v[56:59], v4 offset:14336
    ds_read_b128 v[60:63], v4 offset:15360
    v_cndmask_b32 v20, 0, v2, s[42:43]
    v_cndmask_b32 v21, 0, v2, s[42:43]
    v_cndmask_b32 v22, 0, v2, s[42:43]
    v_cndmask_b32 v23, 0, v2, s[42:43]
    s_nop 15
    s_nop 13
    buffer_load_dword v12, v7, s[4:7], s21 offen offset:0 sc1
    buffer_load_dword v13, v7, s[4:7], s21 offen offset:256 sc1
    buffer_load_dword v14, v7, s[4:7], s21 offen offset:512 sc1
    buffer_load_dword v15, v7, s[4:7], s21 offen offset:768 sc1
    buffer_load_dword v16, v7, s[4:7], s21 offen offset:1024 sc1
    buffer_load_dword v17, v7, s[4:7], s21 offen offset:1280 sc1
    buffer_load_dword v18, v7, s[4:7], s21 offen offset:1536 sc1
    buffer_load_dword v19, v7, s[4:7], s21 offen offset:1792 sc1
    v_mov_b64 v[36:37], 0
    v_mov_b64 v[38:39], 0
    v_mov_b64 v[28:29], 0
    v_mov_b64 v[30:31], 0
    s_add_u32 s26, s26, 32768
    s_add_u32 s23, s23, 32768
    s_add_u32 s30, s30, 524288
    s_add_u32 s27, s27, 524288
    s_nop 14
    buffer_load_dword v40, v7, s[4:7], s21 offen offset:0 sc1
    buffer_load_dword v41, v7, s[4:7], s21 offen offset:256 sc1
    buffer_load_dword v42, v7, s[4:7], s21 offen offset:512 sc1
    buffer_load_dword v43, v7, s[4:7], s21 offen offset:768 sc1
    buffer_load_dword v44, v7, s[4:7], s21 offen offset:1024 sc1
    buffer_load_dword v45, v7, s[4:7], s21 offen offset:1280 sc1
    buffer_load_dword v46, v7, s[4:7], s21 offen offset:1536 sc1
    buffer_load_dword v47, v7, s[4:7], s21 offen offset:1792 sc1
    s_waitcnt vmcnt(12)
    v_mfma_f32_16x16x32_bf16 v[32:35], v[12:15], v[20:23], 0
    v_or3_b32 v8, v12, v13, v14
    s_waitcnt vmcnt(8)
    v_mfma_f32_16x16x32_bf16 v[32:35], v[16:19], v[20:23], v[32:35]
    v_or3_b32 v8, v8, v15, v16
    v_or3_b32 v8, v8, v17, v18
    v_or_b32 v8, v8, v19
    v_and_b32 v8, 1, v8
    v_cmp_ne_u32 vcc, 0, v8
    s_nop 1
    v_cvt_pk_bf16_f32 v10, v32, v33
    v_cvt_pk_bf16_f32 v11, v34, v35
    v_and_b32 v10, -2, v10
    v_and_b32 v11, -2, v11
    s_cbranch_vccnz L_c1_L_ch02e_r
L_c1_L_ch02e:
    buffer_store_dwordx2 v[10:11], v6, s[4:7], s25 offen
    s_barrier
    buffer_store_dwordx2 v[10:11], v6, s[4:7], s26 offen sc1
    s_add_u32 s18, s18, 1
    v_mov_b64 v[32:33], 0
    v_mov_b64 v[34:35], 0
    s_nop 15
    s_nop 15
    s_nop 15
    s_nop 6
    buffer_load_dwordx4 v[24:27], v0, s[4:7], s22 offen sc1
    s_nop 15
    s_nop 3
    buffer_load_dwordx4 v[16:19], v0, s[4:7], s22 offen sc1
    s_waitcnt vmcnt(1)
    v_or3_b32 v8, v24, v25, v26
    v_or_b32 v8, v8, v27
    v_and_b32 v8, 1, v8
    v_cmp_ne_u32 vcc, 0, v8
    ds_write_b128 v0, v[24:27] offset:2048
    s_cbranch_vccnz L_c3_L_ch02e_r
L_c3_L_ch02e:
    buffer_load_dwordx4 v[40:43], v0, s[4:7], s23 offen sc1
    s_waitcnt lgkmcnt(0)
    s_barrier
    ds_read_b128 v[12:15], v3 offset:0
    s_waitcnt vmcnt(1)
    ds_read_b128 v[16:19], v3 offset:32
    s_waitcnt lgkmcnt(1)
    v_smfmac_f32_16x16x64_bf16 v[28:31], v[12:15], v[48:55], v1
    ds_read_b128 v[20:23], v3 offset:1024
    v_smfmac_f32_16x16x64_bf16 v[32:35], v[12:15], v[56:63], v1
    ds_read_b128 v[48:51], v4 offset:2048
    v_smfmac_f32_16x16x64_bf16 v[36:39], v[12:15], v[80:87], v1
    ds_read_b128 v[24:27], v3 offset:1056
    s_waitcnt lgkmcnt(3)
    v_smfmac_f32_16x16x64_bf16 v[28:31], v[16:19], v[88:95], v1
    ds_read_b128 v[52:55], v4 offset:3072
    v_smfmac_f32_16x16x64_bf16 v[32:35], v[16:19], v[96:103], v1
    ds_read_b128 v[56:59], v4 offset:16384
    v_smfmac_f32_16x16x64_bf16 v[36:39], v[16:19], v[104:111], v1
    ds_read_b128 v[12:15], v3 offset:2048
    s_waitcnt lgkmcnt(5)
    v_smfmac_f32_16x16x64_bf16 v[28:31], v[20:23], v[112:119], v1
    ds_read_b128 v[60:63], v4 offset:17408
    v_smfmac_f32_16x16x64_bf16 v[32:35], v[20:23], v[120:127], v1
    s_waitcnt lgkmcnt(3)
    v_smfmac_f32_16x16x64_bf16 v[36:39], v[20:23], v[48:55], v1
    ds_read_b128 v[16:19], v3 offset:2080
    v_smfmac_f32_16x16x64_bf16 v[28:31], v[24:27], v[128:135], v1
    ds_read_b128 v[48:51], v4 offset:4096
    v_smfmac_f32_16x16x64_bf16 v[32:35], v[24:27], v[136:143], v1
    ds_read_b128 v[52:55], v4 offset:5120
    v_smfmac_f32_16x16x64_bf16 v[36:39], v[24:27], v[144:151], v1
    ds_read_b128 v[20:23], v3 offset:3072
    s_waitcnt lgkmcnt(4)
    v_smfmac_f32_16x16x64_bf16 v[28:31], v[12:15], v[56:63], v1
    ds_read_b128 v[56:59], v4 offset:18432
    v_smfmac_f32_16x16x64_bf16 v[32:35], v[12:15], v[152:159], v1
    ds_read_b128 v[60:63], v4 offset:19456
    v_smfmac_f32_16x16x64_bf16 v[36:39], v[12:15], v[160:167], v1
    ds_read_b128 v[24:27], v3 offset:3104
    s_waitcnt lgkmcnt(6)
    v_smfmac_f32_16x16x64_bf16 v[28:31], v[16:19], v[168:175], v1
    s_waitcnt lgkmcnt(4)
    v_smfmac_f32_16x16x64_bf16 v[32:35], v[16:19], v[48:55], v1
    ds_read_b128 v[48:51], v4 offset:6144
    v_smfmac_f32_16x16x64_bf16 v[36:39], v[16:19], v[176:183], v1
    ds_read_b128 v[12:15], v3 offset:4096
    s_waitcnt lgkmcnt(5)
    v_smfmac_f32_16x16x64_bf16 v[28:31], v[20:23], v[184:191], v1
    ds_read_b128 v[52:55], v4 offset:7168
    v_smfmac_f32_16x16x64_bf16 v[32:35], v[20:23], v[192:199], v1
    s_waitcnt lgkmcnt(4)
    v_smfmac_f32_16x16x64_bf16 v[36:39], v[20:23], v[56:63], v1
    ds_read_b128 v[16:19], v3 offset:4128
    s_waitcnt lgkmcnt(4)
    v_smfmac_f32_16x16x64_bf16 v[28:31], v[24:27], v[200:207], v1
    ds_read_b128 v[56:59], v4 offset:20480
    v_smfmac_f32_16x16x64_bf16 v[32:35], v[24:27], v[208:215], v1
    s_waitcnt vmcnt(0)
    ds_write_b128 v0, v[40:43] offset:8192
    v_or3_b32 v8, v40, v41, v42
    v_smfmac_f32_16x16x64_bf16 v[36:39], v[24:27], v[216:223], v1
    ds_read_b128 v[20:23], v3 offset:5120
    v_or_b32 v8, v8, v43
    s_waitcnt lgkmcnt(4)
    v_smfmac_f32_16x16x64_bf16 v[28:31], v[12:15], v[48:55], v1
    ds_read_b128 v[60:63], v4 offset:21504
    v_and_b32 v8, 1, v8
    v_smfmac_f32_16x16x64_bf16 v[32:35], v[12:15], v[224:231], v1
    ds_read_b128 v[48:51], v4 offset:8192
    v_cmp_ne_u32 vcc, 0, v8
    v_smfmac_f32_16x16x64_bf16 v[36:39], v[12:15], v[232:239], v1
    ds_read_b128 v[24:27], v3 offset:5152
    s_nop 0
    s_waitcnt lgkmcnt(6)
    v_smfmac_f32_16x16x64_bf16 v[28:31], v[16:19], v[240:247], v1
    ds_read_b128 v[52:55], v4 offset:9216
    s_cbranch_vccnz L_c2_L_ch02o_r
L_c2_L_ch02o:
    s_waitcnt lgkmcnt(3)
    v_smfmac_f32_16x16x64_bf16 v[32:35], v[16:19], v[56:63], v1
    ds_read_b128 v[56:59], v4 offset:22528
    v_smfmac_f32_16x16x64_bf16 v[36:39], v[16:19], v[248:255], v1
    ds_read_b128 v[60:63], v4 offset:23552
    buffer_load_dwordx4 v[72:75], v0, s[4:7], s27 offen offset:2048 sc1
    v_smfmac_f32_16x16x64_bf16 v[28:31], v[20:23], a[0:7], v1
    s_barrier
    s_mov_b64 vcc, s[36:37]
    v_smfmac_f32_16x16x64_bf16 v[32:35], v[20:23], a[8:15], v1
    ds_read_b128 v[12:15], v3 offset:6144
    buffer_load_dwordx4 v[76:79], v0, s[4:7], s27 offen offset:3072 sc1
    v_cndmask_b32 v40, 0, v2, s[38:39]
    s_waitcnt lgkmcnt(3)
    v_smfmac_f32_16x16x64_bf16 v[36:39], v[20:23], v[48:55], v1
    ds_read_b128 v[16:19], v3 offset:6176
    v_cndmask_b32 v41, 0, v2, s[40:41]
    v_smfmac_f32_16x16x64_bf16 v[28:31], v[24:27], a[16:23], v1
    ds_read_b128 v[48:51], v4 offset:10240
    v_smfmac_f32_16x16x64_bf16 v[32:35], v[24:27], a[24:31], v1
    ds_read_b128 v[52:55], v4 offset:11264
    v_smfmac_f32_16x16x64_bf16 v[36:39], v[24:27], a[32:39], v1
    ds_read_b128 v[20:23], v3 offset:7168
    s_waitcnt lgkmcnt(4)
    v_smfmac_f32_16x16x64_bf16 v[28:31], v[12:15], v[56:63], v1
    ds_read_b128 v[56:59], v4 offset:24576
    v_smfmac_f32_16x16x64_bf16 v[32:35], v[12:15], a[40:47], v1
    ds_read_b128 v[60:63], v4 offset:25600
    v_smfmac_f32_16x16x64_bf16 v[36:39], v[12:15], a[48:55], v1
    ds_read_b128 v[24:27], v3 offset:7200
    s_waitcnt lgkmcnt(6)
    v_smfmac_f32_16x16x64_bf16 v[28:31], v[16:19], a[56:63], v1
    s_waitcnt lgkmcnt(4)
    v_smfmac_f32_16x16x64_bf16 v[32:35], v[16:19], v[48:55], v1
    ds_read_b128 v[48:51], v4 offset:12288
    v_smfmac_f32_16x16x64_bf16 v[36:39], v[16:19], a[64:71], v1
    ds_read_b128 v[12:15], v3 offset:8192
    s_waitcnt lgkmcnt(5)
    v_smfmac_f32_16x16x64_bf16 v[28:31], v[20:23], a[72:79], v1
    ds_read_b128 v[52:55], v4 offset:13312
    v_smfmac_f32_16x16x64_bf16 v[32:35], v[20:23], a[80:87], v1
    ds_read_b128 v[16:19], v3 offset:8224
    s_waitcnt lgkmcnt(5)
    v_smfmac_f32_16x16x64_bf16 v[36:39], v[20:23], v[56:63], v1
    ds_read_b128 v[56:59], v4 offset:26624
    s_waitcnt lgkmcnt(5)
    v_smfmac_f32_16x16x64_bf16 v[28:31], v[24:27], a[88:95], v1
    ds_read_b128 v[20:23], v3 offset:9216
    v_smfmac_f32_16x16x64_bf16 v[32:35], v[24:27], a[96:103], v1
    ds_read_b128 v[60:63], v4 offset:27648
    v_smfmac_f32_16x16x64_bf16 v[36:39], v[24:27], a[104:111], v1
    ds_read_b128 v[24:27], v3 offset:9248
    s_waitcnt lgkmcnt(5)
    v_smfmac_f32_16x16x64_bf16 v[28:31], v[12:15], v[48:55], v1
    v_smfmac_f32_16x16x64_bf16 v[32:35], v[12:15], a[112:119], v1
    s_waitcnt lgkmcnt(4)
    v_smfmac_f32_16x16x64_bf16 v[28:31], v[16:19], a[120:127], v1
    v_smfmac_f32_16x16x64_bf16 v[32:35], v[16:19], a[128:135], v1
    s_waitcnt lgkmcnt(1)
    v_smfmac_f32_16x16x64_bf16 v[28:31], v[20:23], v[56:63], v1
    v_smfmac_f32_16x16x64_bf16 v[32:35], v[20:23], a[136:143], v1
    s_waitcnt lgkmcnt(0)
    v_smfmac_f32_16x16x64_bf16 v[28:31], v[24:27], a[144:151], v1
    v_smfmac_f32_16x16x64_bf16 v[32:35], v[24:27], a[152:159], v1
    v_smfmac_f32_16x16x64_bf16 v[36:39], v[12:15], a[160:167], v1
    v_smfmac_f32_16x16x64_bf16 v[36:39], v[16:19], a[168:175], v1
    v_cvt_pk_bf16_f32 v44, v28, v29
    v_cvt_pk_bf16_f32 v45, v32, v33
    v_cvt_pk_bf16_f32 v46, v30, v31
    v_cvt_pk_bf16_f32 v47, v34, v35
    v_mfma_f32_16x16x16_bf16 v[28:31], v[44:45], v[40:41], 0
    v_mfma_f32_16x16x16_bf16 v[32:35], v[46:47], v[40:41], 0
    v_smfmac_f32_16x16x64_bf16 v[36:39], v[20:23], a[176:183], v1
    s_nop 3
    v_cvt_pk_bf16_f32 v44, v28, v32
    v_cvt_pk_bf16_f32 v45, v29, v33
    v_cvt_pk_bf16_f32 v46, v30, v34
    v_cvt_pk_bf16_f32 v47, v31, v35
    s_nop 1
    v_mfma_f32_16x16x32_bf16 v[32:35], v[68:71], v[44:47], 0
    v_mfma_f32_16x16x32_bf16 v[28:31], v[64:67], v[44:47], 0
    v_mfma_f32_16x16x32_bf16 v[12:15], v[44:47], v[44:47], 0
    v_smfmac_f32_16x16x64_bf16 v[36:39], v[24:27], a[184:191], v1
    v_cndmask_b32_dpp v28, v32, v28, vcc quad_perm:[2,3,2,3] row_mask:0xf bank_mask:0xf
    v_cndmask_b32_dpp v29, v33, v29, vcc quad_perm:[2,3,2,3] row_mask:0xf bank_mask:0xf
    v_cndmask_b32_dpp v30, v34, v30, vcc quad_perm:[2,3,2,3] row_mask:0xf bank_mask:0xf
    v_cndmask_b32_dpp v31, v35, v31, vcc quad_perm:[2,3,2,3] row_mask:0xf bank_mask:0xf
    ds_write_b128 v0, v[28:31] offset:12288
    v_cndmask_b32_dpp v11, v13, v12, vcc quad_perm:[2,3,2,3] row_mask:0xf bank_mask:0xf
    ds_write_b32 v0, v11 offset:14344
    buffer_load_dwordx4 v[64:67], v0, s[4:7], s30 offen offset:0 sc1
    buffer_load_dwordx4 v[68:71], v0, s[4:7], s30 offen offset:1024 sc1
    s_waitcnt lgkmcnt(0)
    s_barrier
    ds_read_b128 v[24:27], v0 offset:14336
    ds_read_b128 v[28:31], v0 offset:10240
    ds_read_b128 v[32:35], v0 offset:11264
    ds_read_b128 v[16:19], v0 offset:12288
    ds_read_b128 v[20:23], v0 offset:13312
    v_cvt_pk_bf16_f32 v42, v36, v37
    v_cvt_pk_bf16_f32 v43, v38, v39
    v_mov_b32 v13, 0
    v_mov_b32 v14, 0
    s_cmp_ge_u32 s18, 63
    s_cbranch_scc1 L_cdone0
    s_waitcnt lgkmcnt(4)
    v_pk_add_f32 v[24:25], v[24:25], v[26:27]
    v_add_f32 v24, v24, v25
    v_mul_f32 v40, s20, v24
    s_waitcnt lgkmcnt(3)
    v_pk_mul_f32 v[28:29], v[28:29], s[48:49]
    v_pk_mul_f32 v[30:31], v[30:31], s[48:49]
    v_exp_f32 v11, v40
    s_waitcnt lgkmcnt(2)
    v_pk_fma_f32 v[28:29], v[32:33], s[48:49], v[28:29]
    v_pk_fma_f32 v[30:31], v[34:35], s[48:49], v[30:31]
    s_waitcnt lgkmcnt(1)
    v_pk_fma_f32 v[28:29], v[16:17], s[48:49], v[28:29]
    v_pk_fma_f32 v[30:31], v[18:19], s[48:49], v[30:31]
    s_waitcnt lgkmcnt(0)
    v_pk_fma_f32 v[28:29], v[20:21], s[48:49], v[28:29]
    v_pk_fma_f32 v[30:31], v[22:23], s[48:49], v[30:31]
    v_mov_b32_dpp v9, v11 quad_perm:[0,1,0,1] row_mask:0xf bank_mask:0xf
    v_exp_f32 v16, v28
    v_exp_f32 v17, v29
    v_cvt_pk_bf16_f32 v12, v11, v9
    v_cvt_pk_bf16_f32 v15, v11, v9
    v_cvt_pk_bf16_f32 v32, v16, v17
    v_exp_f32 v18, v30
    v_mfma_f32_16x16x16_bf16 v[20:23], v[42:43], v[12:13], 0
    ds_read_b128 v[48:51], v4 offset:28672
    v_exp_f32 v19, v31
    v_mov_b32_dpp v34, v32 quad_perm:[0,1,0,1] row_mask:0xf bank_mask:0xf
    v_cvt_pk_bf16_f32 v33, v18, v19
    v_mfma_f32_16x16x16_bf16 v[24:27], v[42:43], v[14:15], 0
    ds_read_b128 v[52:55], v4 offset:29696
    v_add_f32 v8, v16, v17
    v_mov_b32_dpp v35, v33 quad_perm:[0,1,0,1] row_mask:0xf bank_mask:0xf
    v_add_f32 v10, v18, v19
    v_add_f32 v8, v8, v11
    s_waitcnt vmcnt(3)
    v_mfma_f32_16x16x32_bf16 v[20:23], v[72:75], v[32:35], v[20:23]
    ds_read_b128 v[56:59], v4 offset:32768
    v_add_f32 v8, v8, v10
    s_waitcnt vmcnt(2)
    v_mfma_f32_16x16x32_bf16 v[24:27], v[76:79], v[32:35], v[24:27]
    ds_read_b128 v[60:63], v4 offset:33792
    v_add_f32_dpp v9, v8, v8 quad_perm:[2,3,0,1] row_mask:0xf bank_mask:0xf
    v_add_f32_dpp v10, v8, v8 quad_perm:[2,3,0,1] row_mask:0xf bank_mask:0xf
    s_nop 1
    v_permlane16_swap_b32 v9, v10
    v_add_f32 v8, v9, v10
    v_add_f32 v9, v9, v10
    s_nop 1
    v_permlane32_swap_b32 v8, v9
    v_add_f32 v8, v8, v9
    v_rcp_f32 v10, v8
    v_subrev_u32 v8, s47, v8
    v_cmp_le_u32 s[44:45], s50, v8
    v_pk_mul_f32 v[20:21], v[20:21], v[10:11] op_sel_hi:[1,0]
    v_pk_mul_f32 v[22:23], v[22:23], v[10:11] op_sel_hi:[1,0]
    v_pk_mul_f32 v[24:25], v[24:25], v[10:11] op_sel_hi:[1,0]
    v_pk_mul_f32 v[26:27], v[26:27], v[10:11] op_sel_hi:[1,0]
    v_cvt_pk_bf16_f32 v32, v20, v24
    v_cvt_pk_bf16_f32 v33, v21, v25
    v_cvt_pk_bf16_f32 v34, v22, v26
    v_cvt_pk_bf16_f32 v35, v23, v27
    s_cmp_lg_u64 s[44:45], 0
    s_cbranch_scc1 L_sm_L_ch02o_r
L_sm_L_ch02o:
    s_mov_b64 exec, s[36:37]
    ds_write_b128 v3, v[32:35] offset:7168
    s_mov_b64 exec, -1
    v_mov_b64 v[36:37], 0
    v_mov_b64 v[38:39], 0
    v_mov_b64 v[40:41], 0
    v_mov_b64 v[42:43], 0
    v_mov_b64 v[44:45], 0
    v_mov_b64 v[46:47], 0
    s_waitcnt lgkmcnt(0)
    s_barrier
    ds_read_b128 v[12:15], v3 offset:6144
    ds_read_b128 v[16:19], v3 offset:6176
    ds_read_b128 v[20:23], v3 offset:7168
    ds_read_b128 v[24:27], v3 offset:7200
    s_waitcnt lgkmcnt(3)
    v_smfmac_f32_16x16x64_bf16 v[36:39], v[12:15], v[48:55], v1
    ds_read_b128 v[72:75], v4 offset:34816
    s_waitcnt lgkmcnt(3)
    v_smfmac_f32_16x16x64_bf16 v[36:39], v[16:19], v[56:63], v1
    ds_read_b128 v[76:79], v4 offset:35840
    s_waitcnt lgkmcnt(3)
    v_smfmac_f32_16x16x64_bf16 v[36:39], v[20:23], a[192:199], v1
    ds_read_b128 v[48:51], v4 offset:30720
    s_waitcnt lgkmcnt(3)
    v_smfmac_f32_16x16x64_bf16 v[36:39], v[24:27], a[200:207], v1
    ds_read_b128 v[52:55], v4 offset:31744
    v_smfmac_f32_16x16x64_bf16 v[40:43], v[12:15], a[208:215], v1
    v_smfmac_f32_16x16x64_bf16 v[40:43], v[16:19], a[216:223], v1
    v_cvt_pk_bf16_f32 v36, v36, v37
    s_waitcnt lgkmcnt(2)
    v_smfmac_f32_16x16x64_bf16 v[40:43], v[20:23], v[72:79], v1
    v_or_b32 v36, 1, v36
    v_smfmac_f32_16x16x64_bf16 v[40:43], v[24:27], a[224:231], v1
    buffer_store_dword v36, v5, s[4:7], s28 offen
    v_cvt_pk_bf16_f32 v37, v38, v39
    v_smfmac_f32_16x16x64_bf16 v[44:47], v[12:15], a[232:239], v1
    v_or_b32 v37, 1, v37
    s_waitcnt lgkmcnt(0)
    v_smfmac_f32_16x16x64_bf16 v[44:47], v[16:19], v[48:55], v1
    buffer_store_dword v37, v5, s[4:7], s29 offen
    v_cvt_pk_bf16_f32 v40, v40, v41
    v_smfmac_f32_16x16x64_bf16 v[44:47], v[20:23], a[240:247], v1
    v_or_b32 v40, 1, v40
    v_smfmac_f32_16x16x64_bf16 v[44:47], v[24:27], a[248:255], v1
    buffer_store_dword v40, v5, s[4:7], s46 offen
    v_cvt_pk_bf16_f32 v41, v42, v43
    v_or_b32 v41, 1, v41
    buffer_store_dword v41, v5, s[4:7], s73 offen
    s_nop 2
    v_cvt_pk_bf16_f32 v44, v44, v45
    v_cvt_pk_bf16_f32 v45, v46, v47
    v_or_b32 v44, 1, v44
    v_or_b32 v45, 1, v45
    buffer_store_dword v44, v5, s[4:7], s74 offen
    buffer_store_dword v45, v5, s[4:7], s75 offen
    ds_read_b128 v[48:51], v4 offset:0
    ds_read_b128 v[52:55], v4 offset:1024
    ds_read_b128 v[56:59], v4 offset:14336
    ds_read_b128 v[60:63], v4 offset:15360
    v_cndmask_b32 v20, 0, v2, s[42:43]
    v_cndmask_b32 v21, 0, v2, s[42:43]
    v_cndmask_b32 v22, 0, v2, s[42:43]
    v_cndmask_b32 v23, 0, v2, s[42:43]
    s_nop 15
    s_nop 13
    buffer_load_dword v12, v7, s[4:7], s21 offen offset:0 sc1
    buffer_load_dword v13, v7, s[4:7], s21 offen offset:256 sc1
    buffer_load_dword v14, v7, s[4:7], s21 offen offset:512 sc1
    buffer_load_dword v15, v7, s[4:7], s21 offen offset:768 sc1
    buffer_load_dword v16, v7, s[4:7], s21 offen offset:1024 sc1
    buffer_load_dword v17, v7, s[4:7], s21 offen offset:1280 sc1
    buffer_load_dword v18, v7, s[4:7], s21 offen offset:1536 sc1
    buffer_load_dword v19, v7, s[4:7], s21 offen offset:1792 sc1
    v_mov_b64 v[36:37], 0
    v_mov_b64 v[38:39], 0
    v_mov_b64 v[28:29], 0
    v_mov_b64 v[30:31], 0
    s_add_u32 s26, s26, 32768
    s_add_u32 s23, s23, 32768
    s_add_u32 s30, s30, 524288
    s_add_u32 s27, s27, 524288
    s_nop 14
    buffer_load_dword v40, v7, s[4:7], s21 offen offset:0 sc1
    buffer_load_dword v41, v7, s[4:7], s21 offen offset:256 sc1
    buffer_load_dword v42, v7, s[4:7], s21 offen offset:512 sc1
    buffer_load_dword v43, v7, s[4:7], s21 offen offset:768 sc1
    buffer_load_dword v44, v7, s[4:7], s21 offen offset:1024 sc1
    buffer_load_dword v45, v7, s[4:7], s21 offen offset:1280 sc1
    buffer_load_dword v46, v7, s[4:7], s21 offen offset:1536 sc1
    buffer_load_dword v47, v7, s[4:7], s21 offen offset:1792 sc1
    s_waitcnt vmcnt(12)
    v_mfma_f32_16x16x32_bf16 v[32:35], v[12:15], v[20:23], 0
    v_bitop3_b32 v8, v12, v13, v14 bitop3:0x80
    s_waitcnt vmcnt(8)
    v_mfma_f32_16x16x32_bf16 v[32:35], v[16:19], v[20:23], v[32:35]
    v_bitop3_b32 v8, v8, v15, v16 bitop3:0x80
    v_bitop3_b32 v8, v8, v17, v18 bitop3:0x80
    v_bitop3_b32 v8, v8, v19, 1 bitop3:0x80
    v_cmp_ne_u32 vcc, 1, v8
    s_nop 2
    v_cvt_pk_bf16_f32 v10, v32, v33
    v_cvt_pk_bf16_f32 v11, v34, v35
    v_or_b32 v10, 1, v10
    v_or_b32 v11, 1, v11
    s_cbranch_vccnz L_c1_L_ch02o_r
L_c1_L_ch02o:
    buffer_store_dwordx2 v[10:11], v6, s[4:7], s25 offen
    s_barrier
    buffer_store_dwordx2 v[10:11], v6, s[4:7], s26 offen sc1
    s_add_u32 s18, s18, 1
    v_mov_b64 v[32:33], 0
    v_mov_b64 v[34:35], 0
    s_nop 15
    s_nop 15
    s_nop 15
    s_nop 6
    buffer_load_dwordx4 v[24:27], v0, s[4:7], s22 offen sc1
    s_nop 15
    s_nop 3
    buffer_load_dwordx4 v[16:19], v0, s[4:7], s22 offen sc1
    s_waitcnt vmcnt(1)
    v_bitop3_b32 v8, v24, v25, v26 bitop3:0x80
    v_bitop3_b32 v8, v8, v27, 1 bitop3:0x80
    v_cmp_ne_u32 vcc, 1, v8
    ds_write_b128 v0, v[24:27] offset:2048
    s_cbranch_vccnz L_c3_L_ch02o_r
L_c3_L_ch02o:
    buffer_load_dwordx4 v[40:43], v0, s[4:7], s23 offen sc1
    s_waitcnt lgkmcnt(0)
    s_barrier
    s_branch L_ch0_w2
L_c2_L_ch02e_r:
    s_add_u32 s19, s19, 1
    s_cmp_gt_u32 s19, 4000000
    s_cbranch_scc1 L_cend0
    buffer_load_dwordx4 v[40:43], v0, s[4:7], s23 offen sc1
    s_waitcnt vmcnt(0)
    v_bitop3_b32 v8, v40, v41, v42 bitop3:0x80
    v_bitop3_b32 v8, v8, v43, 1 bitop3:0x80
    v_cmp_ne_u32 vcc, 1, v8
    s_cbranch_vccnz L_c2_L_ch02e_r
    ds_write_b128 v0, v[40:43] offset:8192
    s_nop 7
    s_waitcnt lgkmcnt(0)
    s_branch L_c2_L_ch02e
L_sm_L_ch02e_r:
    v_max3_f32 v8, v28, v29, v30
    v_max3_f32 v8, v8, v31, v40
    s_nop 1
    v_max_f32_dpp v9, v8, v8 quad_perm:[2,3,0,1] row_mask:0xf bank_mask:0xf
    v_max_f32_dpp v10, v8, v8 quad_perm:[2,3,0,1] row_mask:0xf bank_mask:0xf
    s_nop 1
    v_permlane16_swap_b32 v9, v10
    v_max_f32 v8, v9, v10
    v_max_f32 v11, v9, v10
    s_nop 1
    v_permlane32_swap_b32 v8, v11
    v_max_f32 v8, v8, v11
    v_sub_f32 v28, v28, v8
    v_sub_f32 v29, v29, v8
    v_sub_f32 v30, v30, v8
    v_sub_f32 v31, v31, v8
    v_sub_f32 v40, v40, v8
    v_exp_f32 v11, v40
    s_nop 1
    v_mov_b32_dpp v9, v11 quad_perm:[0,1,0,1] row_mask:0xf bank_mask:0xf
    v_exp_f32 v16, v28
    v_exp_f32 v17, v29
    v_cvt_pk_bf16_f32 v12, v11, v9
    v_cvt_pk_bf16_f32 v15, v11, v9
    v_cvt_pk_bf16_f32 v32, v16, v17
    v_exp_f32 v18, v30
    v_mfma_f32_16x16x16_bf16 v[20:23], v[42:43], v[12:13], 0
    v_exp_f32 v19, v31
    v_mov_b32_dpp v34, v32 quad_perm:[0,1,0,1] row_mask:0xf bank_mask:0xf
    v_cvt_pk_bf16_f32 v33, v18, v19
    v_mfma_f32_16x16x16_bf16 v[24:27], v[42:43], v[14:15], 0
    v_add_f32 v8, v16, v17
    v_mov_b32_dpp v35, v33 quad_perm:[0,1,0,1] row_mask:0xf bank_mask:0xf
    v_add_f32 v10, v18, v19
    v_add_f32 v8, v8, v11
    v_mfma_f32_16x16x32_bf16 v[20:23], v[72:75], v[32:35], v[20:23]
    v_add_f32 v8, v8, v10
    v_mfma_f32_16x16x32_bf16 v[24:27], v[76:79], v[32:35], v[24:27]
    v_add_f32_dpp v9, v8, v8 quad_perm:[2,3,0,1] row_mask:0xf bank_mask:0xf
    v_add_f32_dpp v10, v8, v8 quad_perm:[2,3,0,1] row_mask:0xf bank_mask:0xf
    s_nop 1
    v_permlane16_swap_b32 v9, v10
    v_add_f32 v8, v9, v10
    v_add_f32 v9, v9, v10
    s_nop 1
    v_permlane32_swap_b32 v8, v9
    v_add_f32 v8, v8, v9
    v_rcp_f32 v10, v8
    s_nop 0
    v_pk_mul_f32 v[20:21], v[20:21], v[10:11] op_sel_hi:[1,0]
    v_pk_mul_f32 v[22:23], v[22:23], v[10:11] op_sel_hi:[1,0]
    v_pk_mul_f32 v[24:25], v[24:25], v[10:11] op_sel_hi:[1,0]
    v_pk_mul_f32 v[26:27], v[26:27], v[10:11] op_sel_hi:[1,0]
    v_cvt_pk_bf16_f32 v32, v20, v24
    v_cvt_pk_bf16_f32 v33, v21, v25
    v_cvt_pk_bf16_f32 v34, v22, v26
    v_cvt_pk_bf16_f32 v35, v23, v27
    s_branch L_sm_L_ch02e
L_c1_L_ch02e_r:
    s_add_u32 s19, s19, 1
    s_cmp_gt_u32 s19, 4000000
    s_cbranch_scc1 L_cend0
    buffer_load_dword v12, v7, s[4:7], s21 offen offset:0 sc1
    buffer_load_dword v13, v7, s[4:7], s21 offen offset:256 sc1
    buffer_load_dword v14, v7, s[4:7], s21 offen offset:512 sc1
    buffer_load_dword v15, v7, s[4:7], s21 offen offset:768 sc1
    buffer_load_dword v16, v7, s[4:7], s21 offen offset:1024 sc1
    buffer_load_dword v17, v7, s[4:7], s21 offen offset:1280 sc1
    buffer_load_dword v18, v7, s[4:7], s21 offen offset:1536 sc1
    buffer_load_dword v19, v7, s[4:7], s21 offen offset:1792 sc1
    s_waitcnt vmcnt(8)
    v_mfma_f32_16x16x32_bf16 v[32:35], v[40:43], v[20:23], 0
    v_or3_b32 v8, v40, v41, v42
    v_mfma_f32_16x16x32_bf16 v[32:35], v[44:47], v[20:23], v[32:35]
    v_or3_b32 v8, v8, v43, v44
    v_or3_b32 v8, v8, v45, v46
    v_or_b32 v8, v8, v47
    v_and_b32 v8, 1, v8
    v_cmp_ne_u32 vcc, 0, v8
    s_nop 1
    v_cvt_pk_bf16_f32 v10, v32, v33
    v_cvt_pk_bf16_f32 v11, v34, v35
    v_and_b32 v10, -2, v10
    v_and_b32 v11, -2, v11
    s_cbranch_vccnz L_c1_L_ch02e_r2
    s_branch L_c1_L_ch02e
L_c1_L_ch02e_r2:
    s_add_u32 s19, s19, 1
    s_cmp_gt_u32 s19, 4000000
    s_cbranch_scc1 L_cend0
    buffer_load_dword v40, v7, s[4:7], s21 offen offset:0 sc1
    buffer_load_dword v41, v7, s[4:7], s21 offen offset:256 sc1
    buffer_load_dword v42, v7, s[4:7], s21 offen offset:512 sc1
    buffer_load_dword v43, v7, s[4:7], s21 offen offset:768 sc1
    buffer_load_dword v44, v7, s[4:7], s21 offen offset:1024 sc1
    buffer_load_dword v45, v7, s[4:7], s21 offen offset:1280 sc1
    buffer_load_dword v46, v7, s[4:7], s21 offen offset:1536 sc1
    buffer_load_dword v47, v7, s[4:7], s21 offen offset:1792 sc1
    s_waitcnt vmcnt(8)
    v_mfma_f32_16x16x32_bf16 v[32:35], v[12:15], v[20:23], 0
    v_or3_b32 v8, v12, v13, v14
    v_mfma_f32_16x16x32_bf16 v[32:35], v[16:19], v[20:23], v[32:35]
    v_or3_b32 v8, v8, v15, v16
    v_or3_b32 v8, v8, v17, v18
    v_or_b32 v8, v8, v19
    v_and_b32 v8, 1, v8
    v_cmp_ne_u32 vcc, 0, v8
    s_nop 1
    v_cvt_pk_bf16_f32 v10, v32, v33
    v_cvt_pk_bf16_f32 v11, v34, v35
    v_and_b32 v10, -2, v10
    v_and_b32 v11, -2, v11
    s_cbranch_vccnz L_c1_L_ch02e_r
    s_branch L_c1_L_ch02e
L_c3_L_ch02e_r:
    s_add_u32 s19, s19, 1
    s_cmp_gt_u32 s19, 4000000
    s_cbranch_scc1 L_cend0
    buffer_load_dwordx4 v[24:27], v0, s[4:7], s22 offen sc1
    s_waitcnt vmcnt(1)
    v_or3_b32 v8, v16, v17, v18
    v_or_b32 v8, v8, v19
    v_and_b32 v8, 1, v8
    v_cmp_ne_u32 vcc, 0, v8
    s_cbranch_vccnz L_c3_L_ch02e_r2
    ds_write_b128 v0, v[16:19] offset:2048
    s_branch L_c3_L_ch02e
L_c3_L_ch02e_r2:
    buffer_load_dwordx4 v[16:19], v0, s[4:7], s22 offen sc1
    s_waitcnt vmcnt(1)
    v_or3_b32 v8, v24, v25, v26
    v_or_b32 v8, v8, v27
    v_and_b32 v8, 1, v8
    v_cmp_ne_u32 vcc, 0, v8
    s_cbranch_vccnz L_c3_L_ch02e_r
    ds_write_b128 v0, v[24:27] offset:2048
    s_branch L_c3_L_ch02e
L_c2_L_ch02o_r:
    s_add_u32 s19, s19, 1
    s_cmp_gt_u32 s19, 4000000
    s_cbranch_scc1 L_cend0
    buffer_load_dwordx4 v[40:43], v0, s[4:7], s23 offen sc1
    s_waitcnt vmcnt(0)
    v_or3_b32 v8, v40, v41, v42
    v_or_b32 v8, v8, v43
    v_and_b32 v8, 1, v8
    v_cmp_ne_u32 vcc, 0, v8
    s_cbranch_vccnz L_c2_L_ch02o_r
    ds_write_b128 v0, v[40:43] offset:8192
    s_nop 7
    s_waitcnt lgkmcnt(0)
    s_branch L_c2_L_ch02o
L_sm_L_ch02o_r:
    v_max3_f32 v8, v28, v29, v30
    v_max3_f32 v8, v8, v31, v40
    s_nop 1
    v_max_f32_dpp v9, v8, v8 quad_perm:[2,3,0,1] row_mask:0xf bank_mask:0xf
    v_max_f32_dpp v10, v8, v8 quad_perm:[2,3,0,1] row_mask:0xf bank_mask:0xf
    s_nop 1
    v_permlane16_swap_b32 v9, v10
    v_max_f32 v8, v9, v10
    v_max_f32 v11, v9, v10
    s_nop 1
    v_permlane32_swap_b32 v8, v11
    v_max_f32 v8, v8, v11
    v_sub_f32 v28, v28, v8
    v_sub_f32 v29, v29, v8
    v_sub_f32 v30, v30, v8
    v_sub_f32 v31, v31, v8
    v_sub_f32 v40, v40, v8
    v_exp_f32 v11, v40
    s_nop 1
    v_mov_b32_dpp v9, v11 quad_perm:[0,1,0,1] row_mask:0xf bank_mask:0xf
    v_exp_f32 v16, v28
    v_exp_f32 v17, v29
    v_cvt_pk_bf16_f32 v12, v11, v9
    v_cvt_pk_bf16_f32 v15, v11, v9
    v_cvt_pk_bf16_f32 v32, v16, v17
    v_exp_f32 v18, v30
    v_mfma_f32_16x16x16_bf16 v[20:23], v[42:43], v[12:13], 0
    v_exp_f32 v19, v31
    v_mov_b32_dpp v34, v32 quad_perm:[0,1,0,1] row_mask:0xf bank_mask:0xf
    v_cvt_pk_bf16_f32 v33, v18, v19
    v_mfma_f32_16x16x16_bf16 v[24:27], v[42:43], v[14:15], 0
    v_add_f32 v8, v16, v17
    v_mov_b32_dpp v35, v33 quad_perm:[0,1,0,1] row_mask:0xf bank_mask:0xf
    v_add_f32 v10, v18, v19
    v_add_f32 v8, v8, v11
    v_mfma_f32_16x16x32_bf16 v[20:23], v[72:75], v[32:35], v[20:23]
    v_add_f32 v8, v8, v10
    v_mfma_f32_16x16x32_bf16 v[24:27], v[76:79], v[32:35], v[24:27]
    v_add_f32_dpp v9, v8, v8 quad_perm:[2,3,0,1] row_mask:0xf bank_mask:0xf
    v_add_f32_dpp v10, v8, v8 quad_perm:[2,3,0,1] row_mask:0xf bank_mask:0xf
    s_nop 1
    v_permlane16_swap_b32 v9, v10
    v_add_f32 v8, v9, v10
    v_add_f32 v9, v9, v10
    s_nop 1
    v_permlane32_swap_b32 v8, v9
    v_add_f32 v8, v8, v9
    v_rcp_f32 v10, v8
    s_nop 0
    v_pk_mul_f32 v[20:21], v[20:21], v[10:11] op_sel_hi:[1,0]
    v_pk_mul_f32 v[22:23], v[22:23], v[10:11] op_sel_hi:[1,0]
    v_pk_mul_f32 v[24:25], v[24:25], v[10:11] op_sel_hi:[1,0]
    v_pk_mul_f32 v[26:27], v[26:27], v[10:11] op_sel_hi:[1,0]
    v_cvt_pk_bf16_f32 v32, v20, v24
    v_cvt_pk_bf16_f32 v33, v21, v25
    v_cvt_pk_bf16_f32 v34, v22, v26
    v_cvt_pk_bf16_f32 v35, v23, v27
    s_branch L_sm_L_ch02o
L_c1_L_ch02o_r:
    s_add_u32 s19, s19, 1
    s_cmp_gt_u32 s19, 4000000
    s_cbranch_scc1 L_cend0
    buffer_load_dword v12, v7, s[4:7], s21 offen offset:0 sc1
    buffer_load_dword v13, v7, s[4:7], s21 offen offset:256 sc1
    buffer_load_dword v14, v7, s[4:7], s21 offen offset:512 sc1
    buffer_load_dword v15, v7, s[4:7], s21 offen offset:768 sc1
    buffer_load_dword v16, v7, s[4:7], s21 offen offset:1024 sc1
    buffer_load_dword v17, v7, s[4:7], s21 offen offset:1280 sc1
    buffer_load_dword v18, v7, s[4:7], s21 offen offset:1536 sc1
    buffer_load_dword v19, v7, s[4:7], s21 offen offset:1792 sc1
    s_waitcnt vmcnt(8)
    v_mfma_f32_16x16x32_bf16 v[32:35], v[40:43], v[20:23], 0
    v_bitop3_b32 v8, v40, v41, v42 bitop3:0x80
    v_mfma_f32_16x16x32_bf16 v[32:35], v[44:47], v[20:23], v[32:35]
    v_bitop3_b32 v8, v8, v43, v44 bitop3:0x80
    v_bitop3_b32 v8, v8, v45, v46 bitop3:0x80
    v_bitop3_b32 v8, v8, v47, 1 bitop3:0x80
    v_cmp_ne_u32 vcc, 1, v8
    s_nop 2
    v_cvt_pk_bf16_f32 v10, v32, v33
    v_cvt_pk_bf16_f32 v11, v34, v35
    v_or_b32 v10, 1, v10
    v_or_b32 v11, 1, v11
    s_cbranch_vccnz L_c1_L_ch02o_r2
    s_branch L_c1_L_ch02o
L_c1_L_ch02o_r2:
    s_add_u32 s19, s19, 1
    s_cmp_gt_u32 s19, 4000000
    s_cbranch_scc1 L_cend0
    buffer_load_dword v40, v7, s[4:7], s21 offen offset:0 sc1
    buffer_load_dword v41, v7, s[4:7], s21 offen offset:256 sc1
    buffer_load_dword v42, v7, s[4:7], s21 offen offset:512 sc1
    buffer_load_dword v43, v7, s[4:7], s21 offen offset:768 sc1
    buffer_load_dword v44, v7, s[4:7], s21 offen offset:1024 sc1
    buffer_load_dword v45, v7, s[4:7], s21 offen offset:1280 sc1
    buffer_load_dword v46, v7, s[4:7], s21 offen offset:1536 sc1
    buffer_load_dword v47, v7, s[4:7], s21 offen offset:1792 sc1
    s_waitcnt vmcnt(8)
    v_mfma_f32_16x16x32_bf16 v[32:35], v[12:15], v[20:23], 0
    v_bitop3_b32 v8, v12, v13, v14 bitop3:0x80
    v_mfma_f32_16x16x32_bf16 v[32:35], v[16:19], v[20:23], v[32:35]
    v_bitop3_b32 v8, v8, v15, v16 bitop3:0x80
    v_bitop3_b32 v8, v8, v17, v18 bitop3:0x80
    v_bitop3_b32 v8, v8, v19, 1 bitop3:0x80
    v_cmp_ne_u32 vcc, 1, v8
    s_nop 2
    v_cvt_pk_bf16_f32 v10, v32, v33
    v_cvt_pk_bf16_f32 v11, v34, v35
    v_or_b32 v10, 1, v10
    v_or_b32 v11, 1, v11
    s_cbranch_vccnz L_c1_L_ch02o_r
    s_branch L_c1_L_ch02o
L_c3_L_ch02o_r:
    s_add_u32 s19, s19, 1
    s_cmp_gt_u32 s19, 4000000
    s_cbranch_scc1 L_cend0
    buffer_load_dwordx4 v[24:27], v0, s[4:7], s22 offen sc1
    s_waitcnt vmcnt(1)
    v_bitop3_b32 v8, v16, v17, v18 bitop3:0x80
    v_bitop3_b32 v8, v8, v19, 1 bitop3:0x80
    v_cmp_ne_u32 vcc, 1, v8
    s_cbranch_vccnz L_c3_L_ch02o_r2
    ds_write_b128 v0, v[16:19] offset:2048
    s_branch L_c3_L_ch02o
L_c3_L_ch02o_r2:
    buffer_load_dwordx4 v[16:19], v0, s[4:7], s22 offen sc1
    s_waitcnt vmcnt(1)
    v_bitop3_b32 v8, v24, v25, v26 bitop3:0x80
    v_bitop3_b32 v8, v8, v27, 1 bitop3:0x80
    v_cmp_ne_u32 vcc, 1, v8
    s_cbranch_vccnz L_c3_L_ch02o_r
    ds_write_b128 v0, v[24:27] offset:2048
    s_branch L_c3_L_ch02o
    .p2align 6
L_ch0_w3:
    ds_read_b128 v[12:15], v3 offset:0
    s_waitcnt vmcnt(1)
    ds_read_b128 v[16:19], v3 offset:32
    s_waitcnt lgkmcnt(1)
    v_smfmac_f32_16x16x64_bf16 v[28:31], v[12:15], v[48:55], v1
    ds_read_b128 v[20:23], v3 offset:1024
    v_smfmac_f32_16x16x64_bf16 v[32:35], v[12:15], v[56:63], v1
    ds_read_b128 v[48:51], v4 offset:2048
    v_smfmac_f32_16x16x64_bf16 v[36:39], v[12:15], v[80:87], v1
    ds_read_b128 v[24:27], v3 offset:1056
    s_waitcnt lgkmcnt(3)
    v_smfmac_f32_16x16x64_bf16 v[28:31], v[16:19], v[88:95], v1
    ds_read_b128 v[52:55], v4 offset:3072
    v_smfmac_f32_16x16x64_bf16 v[32:35], v[16:19], v[96:103], v1
    ds_read_b128 v[56:59], v4 offset:16384
    v_smfmac_f32_16x16x64_bf16 v[36:39], v[16:19], v[104:111], v1
    ds_read_b128 v[12:15], v3 offset:2048
    s_waitcnt lgkmcnt(5)
    v_smfmac_f32_16x16x64_bf16 v[28:31], v[20:23], v[112:119], v1
    ds_read_b128 v[60:63], v4 offset:17408
    v_smfmac_f32_16x16x64_bf16 v[32:35], v[20:23], v[120:127], v1
    s_waitcnt lgkmcnt(3)
    v_smfmac_f32_16x16x64_bf16 v[36:39], v[20:23], v[48:55], v1
    ds_read_b128 v[16:19], v3 offset:2080
    v_smfmac_f32_16x16x64_bf16 v[28:31], v[24:27], v[128:135], v1
    ds_read_b128 v[48:51], v4 offset:4096
    v_smfmac_f32_16x16x64_bf16 v[32:35], v[24:27], v[136:143], v1
    ds_read_b128 v[52:55], v4 offset:5120
    v_smfmac_f32_16x16x64_bf16 v[36:39], v[24:27], v[144:151], v1
    ds_read_b128 v[20:23], v3 offset:3072
    s_waitcnt lgkmcnt(4)
    v_smfmac_f32_16x16x64_bf16 v[28:31], v[12:15], v[56:63], v1
    ds_read_b128 v[56:59], v4 offset:18432
    v_smfmac_f32_16x16x64_bf16 v[32:35], v[12:15], v[152:159], v1
    ds_read_b128 v[60:63], v4 offset:19456
    v_smfmac_f32_16x16x64_bf16 v[36:39], v[12:15], v[160:167], v1
    ds_read_b128 v[24:27], v3 offset:3104
    s_waitcnt lgkmcnt(6)
    v_smfmac_f32_16x16x64_bf16 v[28:31], v[16:19], v[168:175], v1
    s_waitcnt lgkmcnt(4)
    v_smfmac_f32_16x16x64_bf16 v[32:35], v[16:19], v[48:55], v1
    ds_read_b128 v[48:51], v4 offset:6144
    v_smfmac_f32_16x16x64_bf16 v[36:39], v[16:19], v[176:183], v1
    ds_read_b128 v[12:15], v3 offset:4096
    s_waitcnt lgkmcnt(5)
    v_smfmac_f32_16x16x64_bf16 v[28:31], v[20:23], v[184:191], v1
    ds_read_b128 v[52:55], v4 offset:7168
    v_smfmac_f32_16x16x64_bf16 v[32:35], v[20:23], v[192:199], v1
    s_waitcnt lgkmcnt(4)
    v_smfmac_f32_16x16x64_bf16 v[36:39], v[20:23], v[56:63], v1
    ds_read_b128 v[16:19], v3 offset:4128
    s_waitcnt lgkmcnt(4)
    v_smfmac_f32_16x16x64_bf16 v[28:31], v[24:27], v[200:207], v1
    ds_read_b128 v[56:59], v4 offset:20480
    v_smfmac_f32_16x16x64_bf16 v[32:35], v[24:27], v[208:215], v1
    s_waitcnt vmcnt(0)
    ds_write_b128 v0, v[40:43] offset:9216
    v_bitop3_b32 v8, v40, v41, v42 bitop3:0x80
    v_smfmac_f32_16x16x64_bf16 v[36:39], v[24:27], v[216:223], v1
    ds_read_b128 v[20:23], v3 offset:5120
    v_and_b32 v8, v8, v43
    s_waitcnt lgkmcnt(4)
    v_smfmac_f32_16x16x64_bf16 v[28:31], v[12:15], v[48:55], v1
    ds_read_b128 v[60:63], v4 offset:21504
    v_and_or_b32 v8, v8, 1, s35
    v_smfmac_f32_16x16x64_bf16 v[32:35], v[12:15], v[224:231], v1
    ds_read_b128 v[48:51], v4 offset:8192
    v_cmp_ne_u32 vcc, 1, v8
    v_smfmac_f32_16x16x64_bf16 v[36:39], v[12:15], v[232:239], v1
    ds_read_b128 v[24:27], v3 offset:5152
    s_nop 0
    s_waitcnt lgkmcnt(6)
    v_smfmac_f32_16x16x64_bf16 v[28:31], v[16:19], v[240:247], v1
    ds_read_b128 v[52:55], v4 offset:9216
    s_cbranch_vccnz L_c2_L_ch03e_r
L_c2_L_ch03e:
    s_waitcnt lgkmcnt(3)
    v_smfmac_f32_16x16x64_bf16 v[32:35], v[16:19], v[56:63], v1
    ds_read_b128 v[56:59], v4 offset:22528
    v_smfmac_f32_16x16x64_bf16 v[36:39], v[16:19], v[248:255], v1
    ds_read_b128 v[60:63], v4 offset:23552
    buffer_load_dwordx4 v[72:75], v0, s[4:7], s27 offen offset:2048 sc1
    v_smfmac_f32_16x16x64_bf16 v[28:31], v[20:23], a[0:7], v1
    s_barrier
    s_mov_b64 vcc, s[36:37]
    s_mov_b32 s35, 0
    v_smfmac_f32_16x16x64_bf16 v[32:35], v[20:23], a[8:15], v1
    ds_read_b128 v[12:15], v3 offset:6144
    buffer_load_dwordx4 v[76:79], v0, s[4:7], s27 offen offset:3072 sc1
    v_cndmask_b32 v40, 0, v2, s[38:39]
    s_waitcnt lgkmcnt(3)
    v_smfmac_f32_16x16x64_bf16 v[36:39], v[20:23], v[48:55], v1
    ds_read_b128 v[16:19], v3 offset:6176
    v_cndmask_b32 v41, 0, v2, s[40:41]
    v_smfmac_f32_16x16x64_bf16 v[28:31], v[24:27], a[16:23], v1
    ds_read_b128 v[48:51], v4 offset:10240
    v_smfmac_f32_16x16x64_bf16 v[32:35], v[24:27], a[24:31], v1
    ds_read_b128 v[52:55], v4 offset:11264
    v_smfmac_f32_16x16x64_bf16 v[36:39], v[24:27], a[32:39], v1
    ds_read_b128 v[20:23], v3 offset:7168
    s_waitcnt lgkmcnt(4)
    v_smfmac_f32_16x16x64_bf16 v[28:31], v[12:15], v[56:63], v1
    ds_read_b128 v[56:59], v4 offset:24576
    v_smfmac_f32_16x16x64_bf16 v[32:35], v[12:15], a[40:47], v1
    ds_read_b128 v[60:63], v4 offset:25600
    v_smfmac_f32_16x16x64_bf16 v[36:39], v[12:15], a[48:55], v1
    ds_read_b128 v[24:27], v3 offset:7200
    s_waitcnt lgkmcnt(6)
    v_smfmac_f32_16x16x64_bf16 v[28:31], v[16:19], a[56:63], v1
    s_waitcnt lgkmcnt(4)
    v_smfmac_f32_16x16x64_bf16 v[32:35], v[16:19], v[48:55], v1
    ds_read_b128 v[48:51], v4 offset:12288
    v_smfmac_f32_16x16x64_bf16 v[36:39], v[16:19], a[64:71], v1
    ds_read_b128 v[12:15], v3 offset:8192
    s_waitcnt lgkmcnt(5)
    v_smfmac_f32_16x16x64_bf16 v[28:31], v[20:23], a[72:79], v1
    ds_read_b128 v[52:55], v4 offset:13312
    v_smfmac_f32_16x16x64_bf16 v[32:35], v[20:23], a[80:87], v1
    ds_read_b128 v[16:19], v3 offset:8224
    s_waitcnt lgkmcnt(5)
    v_smfmac_f32_16x16x64_bf16 v[36:39], v[20:23], v[56:63], v1
    ds_read_b128 v[56:59], v4 offset:26624
    s_waitcnt lgkmcnt(5)
    v_smfmac_f32_16x16x64_bf16 v[28:31], v[24:27], a[88:95], v1
    ds_read_b128 v[20:23], v3 offset:9216
    v_smfmac_f32_16x16x64_bf16 v[32:35], v[24:27], a[96:103], v1
    ds_read_b128 v[60:63], v4 offset:27648
    v_smfmac_f32_16x16x64_bf16 v[36:39], v[24:27], a[104:111], v1
    ds_read_b128 v[24:27], v3 offset:9248
    s_waitcnt lgkmcnt(5)
    v_smfmac_f32_16x16x64_bf16 v[28:31], v[12:15], v[48:55], v1
    v_smfmac_f32_16x16x64_bf16 v[32:35], v[12:15], a[112:119], v1
    s_waitcnt lgkmcnt(4)
    v_smfmac_f32_16x16x64_bf16 v[28:31], v[16:19], a[120:127], v1
    v_smfmac_f32_16x16x64_bf16 v[32:35], v[16:19], a[128:135], v1
    s_waitcnt lgkmcnt(1)
    v_smfmac_f32_16x16x64_bf16 v[28:31], v[20:23], v[56:63], v1
    v_smfmac_f32_16x16x64_bf16 v[32:35], v[20:23], a[136:143], v1
    s_waitcnt lgkmcnt(0)
    v_smfmac_f32_16x16x64_bf16 v[28:31], v[24:27], a[144:151], v1
    v_smfmac_f32_16x16x64_bf16 v[32:35], v[24:27], a[152:159], v1
    v_smfmac_f32_16x16x64_bf16 v[36:39], v[12:15], a[160:167], v1
    v_smfmac_f32_16x16x64_bf16 v[36:39], v[16:19], a[168:175], v1
    v_cvt_pk_bf16_f32 v44, v28, v29
    v_cvt_pk_bf16_f32 v45, v32, v33
    v_cvt_pk_bf16_f32 v46, v30, v31
    v_cvt_pk_bf16_f32 v47, v34, v35
    v_mfma_f32_16x16x16_bf16 v[28:31], v[44:45], v[40:41], 0
    v_mfma_f32_16x16x16_bf16 v[32:35], v[46:47], v[40:41], 0
    v_smfmac_f32_16x16x64_bf16 v[36:39], v[20:23], a[176:183], v1
    s_nop 3
    v_cvt_pk_bf16_f32 v44, v28, v32
    v_cvt_pk_bf16_f32 v45, v29, v33
    v_cvt_pk_bf16_f32 v46, v30, v34
    v_cvt_pk_bf16_f32 v47, v31, v35
    s_nop 1
    v_mfma_f32_16x16x32_bf16 v[32:35], v[68:71], v[44:47], 0
    v_mfma_f32_16x16x32_bf16 v[28:31], v[64:67], v[44:47], 0
    v_mfma_f32_16x16x32_bf16 v[12:15], v[44:47], v[44:47], 0
    v_smfmac_f32_16x16x64_bf16 v[36:39], v[24:27], a[184:191], v1
    v_cndmask_b32_dpp v28, v32, v28, vcc quad_perm:[2,3,2,3] row_mask:0xf bank_mask:0xf
    v_cndmask_b32_dpp v29, v33, v29, vcc quad_perm:[2,3,2,3] row_mask:0xf bank_mask:0xf
    v_cndmask_b32_dpp v30, v34, v30, vcc quad_perm:[2,3,2,3] row_mask:0xf bank_mask:0xf
    v_cndmask_b32_dpp v31, v35, v31, vcc quad_perm:[2,3,2,3] row_mask:0xf bank_mask:0xf
    ds_write_b128 v0, v[28:31] offset:13312
    v_cndmask_b32_dpp v11, v13, v12, vcc quad_perm:[2,3,2,3] row_mask:0xf bank_mask:0xf
    ds_write_b32 v0, v11 offset:14348
    buffer_load_dwordx4 v[64:67], v0, s[4:7], s30 offen offset:0 sc1
    buffer_load_dwordx4 v[68:71], v0, s[4:7], s30 offen offset:1024 sc1
    buffer_load_dword v6, off, s[8:11], s51 sc1
    s_waitcnt lgkmcnt(0)
    s_barrier
    ds_read_b128 v[24:27], v0 offset:14336
    ds_read_b128 v[28:31], v0 offset:10240
    ds_read_b128 v[32:35], v0 offset:11264
    ds_read_b128 v[16:19], v0 offset:12288
    ds_read_b128 v[20:23], v0 offset:13312
    v_cvt_pk_bf16_f32 v42, v36, v37
    v_cvt_pk_bf16_f32 v43, v38, v39
    v_mov_b32 v13, 0
    v_mov_b32 v14, 0
    s_waitcnt lgkmcnt(4)
    v_pk_add_f32 v[24:25], v[24:25], v[26:27]
    v_add_f32 v24, v24, v25
    v_mul_f32 v40, s20, v24
    s_waitcnt lgkmcnt(3)
    v_pk_mul_f32 v[28:29], v[28:29], s[48:49]
    v_pk_mul_f32 v[30:31], v[30:31], s[48:49]
    v_exp_f32 v11, v40
    s_waitcnt lgkmcnt(2)
    v_pk_fma_f32 v[28:29], v[32:33], s[48:49], v[28:29]
    v_pk_fma_f32 v[30:31], v[34:35], s[48:49], v[30:31]
    s_waitcnt lgkmcnt(1)
    v_pk_fma_f32 v[28:29], v[16:17], s[48:49], v[28:29]
    v_pk_fma_f32 v[30:31], v[18:19], s[48:49], v[30:31]
    s_waitcnt lgkmcnt(0)
    v_pk_fma_f32 v[28:29], v[20:21], s[48:49], v[28:29]
    v_pk_fma_f32 v[30:31], v[22:23], s[48:49], v[30:31]
    v_mov_b32_dpp v9, v11 quad_perm:[0,1,0,1] row_mask:0xf bank_mask:0xf
    v_exp_f32 v16, v28
    v_exp_f32 v17, v29
    v_cvt_pk_bf16_f32 v12, v11, v9
    v_cvt_pk_bf16_f32 v15, v11, v9
    v_cvt_pk_bf16_f32 v32, v16, v17
    v_exp_f32 v18, v30
    v_mfma_f32_16x16x16_bf16 v[20:23], v[42:43], v[12:13], 0
    ds_read_b128 v[48:51], v4 offset:28672
    v_exp_f32 v19, v31
    v_mov_b32_dpp v34, v32 quad_perm:[0,1,0,1] row_mask:0xf bank_mask:0xf
    v_cvt_pk_bf16_f32 v33, v18, v19
    v_mfma_f32_16x16x16_bf16 v[24:27], v[42:43], v[14:15], 0
    ds_read_b128 v[52:55], v4 offset:29696
    v_add_f32 v8, v16, v17
    v_mov_b32_dpp v35, v33 quad_perm:[0,1,0,1] row_mask:0xf bank_mask:0xf
    v_add_f32 v10, v18, v19
    v_add_f32 v8, v8, v11
    s_waitcnt vmcnt(4)
    v_mfma_f32_16x16x32_bf16 v[20:23], v[72:75], v[32:35], v[20:23]
    ds_read_b128 v[56:59], v4 offset:32768
    v_add_f32 v8, v8, v10
    s_waitcnt vmcnt(3)
    v_mfma_f32_16x16x32_bf16 v[24:27], v[76:79], v[32:35], v[24:27]
    ds_read_b128 v[60:63], v4 offset:33792
    v_add_f32_dpp v9, v8, v8 quad_perm:[2,3,0,1] row_mask:0xf bank_mask:0xf
    v_add_f32_dpp v10, v8, v8 quad_perm:[2,3,0,1] row_mask:0xf bank_mask:0xf
    s_nop 1
    v_permlane16_swap_b32 v9, v10
    v_add_f32 v8, v9, v10
    v_add_f32 v9, v9, v10
    s_nop 1
    v_permlane32_swap_b32 v8, v9
    v_add_f32 v8, v8, v9
    v_rcp_f32 v10, v8
    v_subrev_u32 v8, s47, v8
    v_cmp_le_u32 s[44:45], s50, v8
    v_pk_mul_f32 v[20:21], v[20:21], v[10:11] op_sel_hi:[1,0]
    v_pk_mul_f32 v[22:23], v[22:23], v[10:11] op_sel_hi:[1,0]
    v_pk_mul_f32 v[24:25], v[24:25], v[10:11] op_sel_hi:[1,0]
    v_pk_mul_f32 v[26:27], v[26:27], v[10:11] op_sel_hi:[1,0]
    v_cvt_pk_bf16_f32 v32, v20, v24
    v_cvt_pk_bf16_f32 v33, v21, v25
    v_cvt_pk_bf16_f32 v34, v22, v26
    v_cvt_pk_bf16_f32 v35, v23, v27
    s_cmp_lg_u64 s[44:45], 0
    s_cbranch_scc1 L_sm_L_ch03e_r
L_sm_L_ch03e:
    s_mov_b64 exec, s[36:37]
    ds_write_b128 v3, v[32:35] offset:7200
    s_mov_b64 exec, -1
    v_mov_b64 v[36:37], 0
    v_mov_b64 v[38:39], 0
    v_mov_b64 v[40:41], 0
    v_mov_b64 v[42:43], 0
    v_mov_b64 v[44:45], 0
    v_mov_b64 v[46:47], 0
    s_waitcnt lgkmcnt(0)
    s_barrier
    ds_read_b128 v[12:15], v3 offset:6144
    ds_read_b128 v[16:19], v3 offset:6176
    ds_read_b128 v[20:23], v3 offset:7168
    ds_read_b128 v[24:27], v3 offset:7200
    s_waitcnt lgkmcnt(3)
    v_smfmac_f32_16x16x64_bf16 v[36:39], v[12:15], v[48:55], v1
    ds_read_b128 v[72:75], v4 offset:34816
    s_waitcnt lgkmcnt(3)
    v_smfmac_f32_16x16x64_bf16 v[36:39], v[16:19], v[56:63], v1
    ds_read_b128 v[76:79], v4 offset:35840
    s_waitcnt lgkmcnt(3)
    v_smfmac_f32_16x16x64_bf16 v[36:39], v[20:23], a[192:199], v1
    ds_read_b128 v[48:51], v4 offset:30720
    s_waitcnt lgkmcnt(3)
    v_smfmac_f32_16x16x64_bf16 v[36:39], v[24:27], a[200:207], v1
    ds_read_b128 v[52:55], v4 offset:31744
    v_smfmac_f32_16x16x64_bf16 v[40:43], v[12:15], a[208:215], v1
    v_smfmac_f32_16x16x64_bf16 v[40:43], v[16:19], a[216:223], v1
    v_cvt_pk_bf16_f32 v36, v36, v37
    s_waitcnt lgkmcnt(2)
    v_smfmac_f32_16x16x64_bf16 v[40:43], v[20:23], v[72:79], v1
    v_and_b32 v36, -2, v36
    v_smfmac_f32_16x16x64_bf16 v[40:43], v[24:27], a[224:231], v1
    buffer_store_dword v36, v5, s[4:7], s28 offen
    v_cvt_pk_bf16_f32 v37, v38, v39
    v_smfmac_f32_16x16x64_bf16 v[44:47], v[12:15], a[232:239], v1
    v_and_b32 v37, -2, v37
    s_waitcnt lgkmcnt(0)
    v_smfmac_f32_16x16x64_bf16 v[44:47], v[16:19], v[48:55], v1
    buffer_store_dword v37, v5, s[4:7], s29 offen
    v_cvt_pk_bf16_f32 v40, v40, v41
    v_smfmac_f32_16x16x64_bf16 v[44:47], v[20:23], a[240:247], v1
    v_and_b32 v40, -2, v40
    v_smfmac_f32_16x16x64_bf16 v[44:47], v[24:27], a[248:255], v1
    buffer_store_dword v40, v5, s[4:7], s46 offen
    v_cvt_pk_bf16_f32 v41, v42, v43
    v_and_b32 v41, -2, v41
    buffer_store_dword v41, v5, s[4:7], s73 offen
    s_nop 2
    v_cvt_pk_bf16_f32 v44, v44, v45
    v_cvt_pk_bf16_f32 v45, v46, v47
    v_and_b32 v44, -2, v44
    v_and_b32 v45, -2, v45
    buffer_store_dword v44, v5, s[4:7], s74 offen
    buffer_store_dword v45, v5, s[4:7], s75 offen
    ds_read_b128 v[48:51], v4 offset:0
    ds_read_b128 v[52:55], v4 offset:1024
    ds_read_b128 v[56:59], v4 offset:14336
    ds_read_b128 v[60:63], v4 offset:15360
    v_mov_b64 v[28:29], 0
    v_mov_b64 v[30:31], 0
    v_mov_b64 v[36:37], 0
    v_mov_b64 v[38:39], 0
    s_add_u32 s26, s26, 32768
    s_add_u32 s23, s23, 32768
    s_add_u32 s30, s30, 524288
    s_add_u32 s27, s27, 524288
    s_waitcnt vmcnt(6)
    v_readfirstlane_b32 s33, v6
    s_nop 0
    s_and_b32 s33, s33, 0xffff
    s_cmp_lg_u32 s33, 32
    s_cbranch_scc1 L_fl_L_ch03e_r
L_fl_L_ch03e:
    s_add_u32 s51, s18, 3
    s_min_u32 s51, s51, 63
    s_lshr_b32 s33, s51, 3
    s_add_u32 s33, s33, 10
    s_cmp_lt_u32 s51, 4
    s_cselect_b32 s51, 28, s33
    s_lshl_b32 s51, s51, 2
    s_barrier
    s_add_u32 s18, s18, 1
    v_mov_b64 v[32:33], 0
    v_mov_b64 v[34:35], 0
    s_nop 15
    s_nop 15
    s_nop 15
    s_nop 6
    buffer_load_dwordx4 v[24:27], v0, s[4:7], s22 offen sc1
    s_nop 15
    s_nop 3
    buffer_load_dwordx4 v[16:19], v0, s[4:7], s22 offen sc1
    s_waitcnt vmcnt(1)
    v_or3_b32 v8, v24, v25, v26
    v_or_b32 v8, v8, v27
    v_and_b32 v8, 1, v8
    v_cmp_ne_u32 vcc, 0, v8
    ds_write_b128 v0, v[24:27] offset:3072
    s_cbranch_vccnz L_c3_L_ch03e_r
L_c3_L_ch03e:
    buffer_load_dwordx4 v[40:43], v0, s[4:7], s23 offen sc1
    s_waitcnt lgkmcnt(0)
    s_barrier
    ds_read_b128 v[12:15], v3 offset:0
    s_waitcnt vmcnt(1)
    ds_read_b128 v[16:19], v3 offset:32
    s_waitcnt lgkmcnt(1)
    v_smfmac_f32_16x16x64_bf16 v[28:31], v[12:15], v[48:55], v1
    ds_read_b128 v[20:23], v3 offset:1024
    v_smfmac_f32_16x16x64_bf16 v[32:35], v[12:15], v[56:63], v1
    ds_read_b128 v[48:51], v4 offset:2048
    v_smfmac_f32_16x16x64_bf16 v[36:39], v[12:15], v[80:87], v1
    ds_read_b128 v[24:27], v3 offset:1056
    s_waitcnt lgkmcnt(3)
    v_smfmac_f32_16x16x64_bf16 v[28:31], v[16:19], v[88:95], v1
    ds_read_b128 v[52:55], v4 offset:3072
    v_smfmac_f32_16x16x64_bf16 v[32:35], v[16:19], v[96:103], v1
    ds_read_b128 v[56:59], v4 offset:16384
    v_smfmac_f32_16x16x64_bf16 v[36:39], v[16:19], v[104:111], v1
    ds_read_b128 v[12:15], v3 offset:2048
    s_waitcnt lgkmcnt(5)
    v_smfmac_f32_16x16x64_bf16 v[28:31], v[20:23], v[112:119], v1
    ds_read_b128 v[60:63], v4 offset:17408
    v_smfmac_f32_16x16x64_bf16 v[32:35], v[20:23], v[120:127], v1
    s_waitcnt lgkmcnt(3)
    v_smfmac_f32_16x16x64_bf16 v[36:39], v[20:23], v[48:55], v1
    ds_read_b128 v[16:19], v3 offset:2080
    v_smfmac_f32_16x16x64_bf16 v[28:31], v[24:27], v[128:135], v1
    ds_read_b128 v[48:51], v4 offset:4096
    v_smfmac_f32_16x16x64_bf16 v[32:35], v[24:27], v[136:143], v1
    ds_read_b128 v[52:55], v4 offset:5120
    v_smfmac_f32_16x16x64_bf16 v[36:39], v[24:27], v[144:151], v1
    ds_read_b128 v[20:23], v3 offset:3072
    s_waitcnt lgkmcnt(4)
    v_smfmac_f32_16x16x64_bf16 v[28:31], v[12:15], v[56:63], v1
    ds_read_b128 v[56:59], v4 offset:18432
    v_smfmac_f32_16x16x64_bf16 v[32:35], v[12:15], v[152:159], v1
    ds_read_b128 v[60:63], v4 offset:19456
    v_smfmac_f32_16x16x64_bf16 v[36:39], v[12:15], v[160:167], v1
    ds_read_b128 v[24:27], v3 offset:3104
    s_waitcnt lgkmcnt(6)
    v_smfmac_f32_16x16x64_bf16 v[28:31], v[16:19], v[168:175], v1
    s_waitcnt lgkmcnt(4)
    v_smfmac_f32_16x16x64_bf16 v[32:35], v[16:19], v[48:55], v1
    ds_read_b128 v[48:51], v4 offset:6144
    v_smfmac_f32_16x16x64_bf16 v[36:39], v[16:19], v[176:183], v1
    ds_read_b128 v[12:15], v3 offset:4096
    s_waitcnt lgkmcnt(5)
    v_smfmac_f32_16x16x64_bf16 v[28:31], v[20:23], v[184:191], v1
    ds_read_b128 v[52:55], v4 offset:7168
    v_smfmac_f32_16x16x64_bf16 v[32:35], v[20:23], v[192:199], v1
    s_waitcnt lgkmcnt(4)
    v_smfmac_f32_16x16x64_bf16 v[36:39], v[20:23], v[56:63], v1
    ds_read_b128 v[16:19], v3 offset:4128
    s_waitcnt lgkmcnt(4)
    v_smfmac_f32_16x16x64_bf16 v[28:31], v[24:27], v[200:207], v1
    ds_read_b128 v[56:59], v4 offset:20480
    v_smfmac_f32_16x16x64_bf16 v[32:35], v[24:27], v[208:215], v1
    s_waitcnt vmcnt(0)
    ds_write_b128 v0, v[40:43] offset:9216
    v_or3_b32 v8, v40, v41, v42
    v_smfmac_f32_16x16x64_bf16 v[36:39], v[24:27], v[216:223], v1
    ds_read_b128 v[20:23], v3 offset:5120
    v_or_b32 v8, v8, v43
    s_waitcnt lgkmcnt(4)
    v_smfmac_f32_16x16x64_bf16 v[28:31], v[12:15], v[48:55], v1
    ds_read_b128 v[60:63], v4 offset:21504
    v_and_b32 v8, 1, v8
    v_smfmac_f32_16x16x64_bf16 v[32:35], v[12:15], v[224:231], v1
    ds_read_b128 v[48:51], v4 offset:8192
    v_cmp_ne_u32 vcc, 0, v8
    v_smfmac_f32_16x16x64_bf16 v[36:39], v[12:15], v[232:239], v1
    ds_read_b128 v[24:27], v3 offset:5152
    s_nop 0
    s_waitcnt lgkmcnt(6)
    v_smfmac_f32_16x16x64_bf16 v[28:31], v[16:19], v[240:247], v1
    ds_read_b128 v[52:55], v4 offset:9216
    s_cbranch_vccnz L_c2_L_ch03o_r
L_c2_L_ch03o:
    s_waitcnt lgkmcnt(3)
    v_smfmac_f32_16x16x64_bf16 v[32:35], v[16:19], v[56:63], v1
    ds_read_b128 v[56:59], v4 offset:22528
    v_smfmac_f32_16x16x64_bf16 v[36:39], v[16:19], v[248:255], v1
    ds_read_b128 v[60:63], v4 offset:23552
    buffer_load_dwordx4 v[72:75], v0, s[4:7], s27 offen offset:2048 sc1
    v_smfmac_f32_16x16x64_bf16 v[28:31], v[20:23], a[0:7], v1
    s_barrier
    s_mov_b64 vcc, s[36:37]
    v_smfmac_f32_16x16x64_bf16 v[32:35], v[20:23], a[8:15], v1
    ds_read_b128 v[12:15], v3 offset:6144
    buffer_load_dwordx4 v[76:79], v0, s[4:7], s27 offen offset:3072 sc1
    v_cndmask_b32 v40, 0, v2, s[38:39]
    s_waitcnt lgkmcnt(3)
    v_smfmac_f32_16x16x64_bf16 v[36:39], v[20:23], v[48:55], v1
    ds_read_b128 v[16:19], v3 offset:6176
    v_cndmask_b32 v41, 0, v2, s[40:41]
    v_smfmac_f32_16x16x64_bf16 v[28:31], v[24:27], a[16:23], v1
    ds_read_b128 v[48:51], v4 offset:10240
    v_smfmac_f32_16x16x64_bf16 v[32:35], v[24:27], a[24:31], v1
    ds_read_b128 v[52:55], v4 offset:11264
    v_smfmac_f32_16x16x64_bf16 v[36:39], v[24:27], a[32:39], v1
    ds_read_b128 v[20:23], v3 offset:7168
    s_waitcnt lgkmcnt(4)
    v_smfmac_f32_16x16x64_bf16 v[28:31], v[12:15], v[56:63], v1
    ds_read_b128 v[56:59], v4 offset:24576
    v_smfmac_f32_16x16x64_bf16 v[32:35], v[12:15], a[40:47], v1
    ds_read_b128 v[60:63], v4 offset:25600
    v_smfmac_f32_16x16x64_bf16 v[36:39], v[12:15], a[48:55], v1
    ds_read_b128 v[24:27], v3 offset:7200
    s_waitcnt lgkmcnt(6)
    v_smfmac_f32_16x16x64_bf16 v[28:31], v[16:19], a[56:63], v1
    s_waitcnt lgkmcnt(4)
    v_smfmac_f32_16x16x64_bf16 v[32:35], v[16:19], v[48:55], v1
    ds_read_b128 v[48:51], v4 offset:12288
    v_smfmac_f32_16x16x64_bf16 v[36:39], v[16:19], a[64:71], v1
    ds_read_b128 v[12:15], v3 offset:8192
    s_waitcnt lgkmcnt(5)
    v_smfmac_f32_16x16x64_bf16 v[28:31], v[20:23], a[72:79], v1
    ds_read_b128 v[52:55], v4 offset:13312
    v_smfmac_f32_16x16x64_bf16 v[32:35], v[20:23], a[80:87], v1
    ds_read_b128 v[16:19], v3 offset:8224
    s_waitcnt lgkmcnt(5)
    v_smfmac_f32_16x16x64_bf16 v[36:39], v[20:23], v[56:63], v1
    ds_read_b128 v[56:59], v4 offset:26624
    s_waitcnt lgkmcnt(5)
    v_smfmac_f32_16x16x64_bf16 v[28:31], v[24:27], a[88:95], v1
    ds_read_b128 v[20:23], v3 offset:9216
    v_smfmac_f32_16x16x64_bf16 v[32:35], v[24:27], a[96:103], v1
    ds_read_b128 v[60:63], v4 offset:27648
    v_smfmac_f32_16x16x64_bf16 v[36:39], v[24:27], a[104:111], v1
    ds_read_b128 v[24:27], v3 offset:9248
    s_waitcnt lgkmcnt(5)
    v_smfmac_f32_16x16x64_bf16 v[28:31], v[12:15], v[48:55], v1
    v_smfmac_f32_16x16x64_bf16 v[32:35], v[12:15], a[112:119], v1
    s_waitcnt lgkmcnt(4)
    v_smfmac_f32_16x16x64_bf16 v[28:31], v[16:19], a[120:127], v1
    v_smfmac_f32_16x16x64_bf16 v[32:35], v[16:19], a[128:135], v1
    s_waitcnt lgkmcnt(1)
    v_smfmac_f32_16x16x64_bf16 v[28:31], v[20:23], v[56:63], v1
    v_smfmac_f32_16x16x64_bf16 v[32:35], v[20:23], a[136:143], v1
    s_waitcnt lgkmcnt(0)
    v_smfmac_f32_16x16x64_bf16 v[28:31], v[24:27], a[144:151], v1
    v_smfmac_f32_16x16x64_bf16 v[32:35], v[24:27], a[152:159], v1
    v_smfmac_f32_16x16x64_bf16 v[36:39], v[12:15], a[160:167], v1
    v_smfmac_f32_16x16x64_bf16 v[36:39], v[16:19], a[168:175], v1
    v_cvt_pk_bf16_f32 v44, v28, v29
    v_cvt_pk_bf16_f32 v45, v32, v33
    v_cvt_pk_bf16_f32 v46, v30, v31
    v_cvt_pk_bf16_f32 v47, v34, v35
    v_mfma_f32_16x16x16_bf16 v[28:31], v[44:45], v[40:41], 0
    v_mfma_f32_16x16x16_bf16 v[32:35], v[46:47], v[40:41], 0
    v_smfmac_f32_16x16x64_bf16 v[36:39], v[20:23], a[176:183], v1
    s_nop 3
    v_cvt_pk_bf16_f32 v44, v28, v32
    v_cvt_pk_bf16_f32 v45, v29, v33
    v_cvt_pk_bf16_f32 v46, v30, v34
    v_cvt_pk_bf16_f32 v47, v31, v35
    s_nop 1
    v_mfma_f32_16x16x32_bf16 v[32:35], v[68:71], v[44:47], 0
    v_mfma_f32_16x16x32_bf16 v[28:31], v[64:67], v[44:47], 0
    v_mfma_f32_16x16x32_bf16 v[12:15], v[44:47], v[44:47], 0
    v_smfmac_f32_16x16x64_bf16 v[36:39], v[24:27], a[184:191], v1
    v_cndmask_b32_dpp v28, v32, v28, vcc quad_perm:[2,3,2,3] row_mask:0xf bank_mask:0xf
    v_cndmask_b32_dpp v29, v33, v29, vcc quad_perm:[2,3,2,3] row_mask:0xf bank_mask:0xf
    v_cndmask_b32_dpp v30, v34, v30, vcc quad_perm:[2,3,2,3] row_mask:0xf bank_mask:0xf
    v_cndmask_b32_dpp v31, v35, v31, vcc quad_perm:[2,3,2,3] row_mask:0xf bank_mask:0xf
    ds_write_b128 v0, v[28:31] offset:13312
    v_cndmask_b32_dpp v11, v13, v12, vcc quad_perm:[2,3,2,3] row_mask:0xf bank_mask:0xf
    ds_write_b32 v0, v11 offset:14348
    buffer_load_dwordx4 v[64:67], v0, s[4:7], s30 offen offset:0 sc1
    buffer_load_dwordx4 v[68:71], v0, s[4:7], s30 offen offset:1024 sc1
    buffer_load_dword v6, off, s[8:11], s51 sc1
    s_waitcnt lgkmcnt(0)
    s_barrier
    ds_read_b128 v[24:27], v0 offset:14336
    ds_read_b128 v[28:31], v0 offset:10240
    ds_read_b128 v[32:35], v0 offset:11264
    ds_read_b128 v[16:19], v0 offset:12288
    ds_read_b128 v[20:23], v0 offset:13312
    v_cvt_pk_bf16_f32 v42, v36, v37
    v_cvt_pk_bf16_f32 v43, v38, v39
    v_mov_b32 v13, 0
    v_mov_b32 v14, 0
    s_cmp_ge_u32 s18, 63
    s_cbranch_scc1 L_cdone0
    s_waitcnt lgkmcnt(4)
    v_pk_add_f32 v[24:25], v[24:25], v[26:27]
    v_add_f32 v24, v24, v25
    v_mul_f32 v40, s20, v24
    s_waitcnt lgkmcnt(3)
    v_pk_mul_f32 v[28:29], v[28:29], s[48:49]
    v_pk_mul_f32 v[30:31], v[30:31], s[48:49]
    v_exp_f32 v11, v40
    s_waitcnt lgkmcnt(2)
    v_pk_fma_f32 v[28:29], v[32:33], s[48:49], v[28:29]
    v_pk_fma_f32 v[30:31], v[34:35], s[48:49], v[30:31]
    s_waitcnt lgkmcnt(1)
    v_pk_fma_f32 v[28:29], v[16:17], s[48:49], v[28:29]
    v_pk_fma_f32 v[30:31], v[18:19], s[48:49], v[30:31]
    s_waitcnt lgkmcnt(0)
    v_pk_fma_f32 v[28:29], v[20:21], s[48:49], v[28:29]
    v_pk_fma_f32 v[30:31], v[22:23], s[48:49], v[30:31]
    v_mov_b32_dpp v9, v11 quad_perm:[0,1,0,1] row_mask:0xf bank_mask:0xf
    v_exp_f32 v16, v28
    v_exp_f32 v17, v29
    v_cvt_pk_bf16_f32 v12, v11, v9
    v_cvt_pk_bf16_f32 v15, v11, v9
    v_cvt_pk_bf16_f32 v32, v16, v17
    v_exp_f32 v18, v30
    v_mfma_f32_16x16x16_bf16 v[20:23], v[42:43], v[12:13], 0
    ds_read_b128 v[48:51], v4 offset:28672
    v_exp_f32 v19, v31
    v_mov_b32_dpp v34, v32 quad_perm:[0,1,0,1] row_mask:0xf bank_mask:0xf
    v_cvt_pk_bf16_f32 v33, v18, v19
    v_mfma_f32_16x16x16_bf16 v[24:27], v[42:43], v[14:15], 0
    ds_read_b128 v[52:55], v4 offset:29696
    v_add_f32 v8, v16, v17
    v_mov_b32_dpp v35, v33 quad_perm:[0,1,0,1] row_mask:0xf bank_mask:0xf
    v_add_f32 v10, v18, v19
    v_add_f32 v8, v8, v11
    s_waitcnt vmcnt(4)
    v_mfma_f32_16x16x32_bf16 v[20:23], v[72:75], v[32:35], v[20:23]
    ds_read_b128 v[56:59], v4 offset:32768
    v_add_f32 v8, v8, v10
    s_waitcnt vmcnt(3)
    v_mfma_f32_16x16x32_bf16 v[24:27], v[76:79], v[32:35], v[24:27]
    ds_read_b128 v[60:63], v4 offset:33792
    v_add_f32_dpp v9, v8, v8 quad_perm:[2,3,0,1] row_mask:0xf bank_mask:0xf
    v_add_f32_dpp v10, v8, v8 quad_perm:[2,3,0,1] row_mask:0xf bank_mask:0xf
    s_nop 1
    v_permlane16_swap_b32 v9, v10
    v_add_f32 v8, v9, v10
    v_add_f32 v9, v9, v10
    s_nop 1
    v_permlane32_swap_b32 v8, v9
    v_add_f32 v8, v8, v9
    v_rcp_f32 v10, v8
    v_subrev_u32 v8, s47, v8
    v_cmp_le_u32 s[44:45], s50, v8
    v_pk_mul_f32 v[20:21], v[20:21], v[10:11] op_sel_hi:[1,0]
    v_pk_mul_f32 v[22:23], v[22:23], v[10:11] op_sel_hi:[1,0]
    v_pk_mul_f32 v[24:25], v[24:25], v[10:11] op_sel_hi:[1,0]
    v_pk_mul_f32 v[26:27], v[26:27], v[10:11] op_sel_hi:[1,0]
    v_cvt_pk_bf16_f32 v32, v20, v24
    v_cvt_pk_bf16_f32 v33, v21, v25
    v_cvt_pk_bf16_f32 v34, v22, v26
    v_cvt_pk_bf16_f32 v35, v23, v27
    s_cmp_lg_u64 s[44:45], 0
    s_cbranch_scc1 L_sm_L_ch03o_r
L_sm_L_ch03o:
    s_mov_b64 exec, s[36:37]
    ds_write_b128 v3, v[32:35] offset:7200
    s_mov_b64 exec, -1
    v_mov_b64 v[36:37], 0
    v_mov_b64 v[38:39], 0
    v_mov_b64 v[40:41], 0
    v_mov_b64 v[42:43], 0
    v_mov_b64 v[44:45], 0
    v_mov_b64 v[46:47], 0
    s_waitcnt lgkmcnt(0)
    s_barrier
    ds_read_b128 v[12:15], v3 offset:6144
    ds_read_b128 v[16:19], v3 offset:6176
    ds_read_b128 v[20:23], v3 offset:7168
    ds_read_b128 v[24:27], v3 offset:7200
    s_waitcnt lgkmcnt(3)
    v_smfmac_f32_16x16x64_bf16 v[36:39], v[12:15], v[48:55], v1
    ds_read_b128 v[72:75], v4 offset:34816
    s_waitcnt lgkmcnt(3)
    v_smfmac_f32_16x16x64_bf16 v[36:39], v[16:19], v[56:63], v1
    ds_read_b128 v[76:79], v4 offset:35840
    s_waitcnt lgkmcnt(3)
    v_smfmac_f32_16x16x64_bf16 v[36:39], v[20:23], a[192:199], v1
    ds_read_b128 v[48:51], v4 offset:30720
    s_waitcnt lgkmcnt(3)
    v_smfmac_f32_16x16x64_bf16 v[36:39], v[24:27], a[200:207], v1
    ds_read_b128 v[52:55], v4 offset:31744
    v_smfmac_f32_16x16x64_bf16 v[40:43], v[12:15], a[208:215], v1
    v_smfmac_f32_16x16x64_bf16 v[40:43], v[16:19], a[216:223], v1
    v_cvt_pk_bf16_f32 v36, v36, v37
    s_waitcnt lgkmcnt(2)
    v_smfmac_f32_16x16x64_bf16 v[40:43], v[20:23], v[72:79], v1
    v_or_b32 v36, 1, v36
    v_smfmac_f32_16x16x64_bf16 v[40:43], v[24:27], a[224:231], v1
    buffer_store_dword v36, v5, s[4:7], s28 offen
    v_cvt_pk_bf16_f32 v37, v38, v39
    v_smfmac_f32_16x16x64_bf16 v[44:47], v[12:15], a[232:239], v1
    v_or_b32 v37, 1, v37
    s_waitcnt lgkmcnt(0)
    v_smfmac_f32_16x16x64_bf16 v[44:47], v[16:19], v[48:55], v1
    buffer_store_dword v37, v5, s[4:7], s29 offen
    v_cvt_pk_bf16_f32 v40, v40, v41
    v_smfmac_f32_16x16x64_bf16 v[44:47], v[20:23], a[240:247], v1
    v_or_b32 v40, 1, v40
    v_smfmac_f32_16x16x64_bf16 v[44:47], v[24:27], a[248:255], v1
    buffer_store_dword v40, v5, s[4:7], s46 offen
    v_cvt_pk_bf16_f32 v41, v42, v43
    v_or_b32 v41, 1, v41
    buffer_store_dword v41, v5, s[4:7], s73 offen
    s_nop 2
    v_cvt_pk_bf16_f32 v44, v44, v45
    v_cvt_pk_bf16_f32 v45, v46, v47
    v_or_b32 v44, 1, v44
    v_or_b32 v45, 1, v45
    buffer_store_dword v44, v5, s[4:7], s74 offen
    buffer_store_dword v45, v5, s[4:7], s75 offen
    ds_read_b128 v[48:51], v4 offset:0
    ds_read_b128 v[52:55], v4 offset:1024
    ds_read_b128 v[56:59], v4 offset:14336
    ds_read_b128 v[60:63], v4 offset:15360
    v_mov_b64 v[28:29], 0
    v_mov_b64 v[30:31], 0
    v_mov_b64 v[36:37], 0
    v_mov_b64 v[38:39], 0
    s_add_u32 s26, s26, 32768
    s_add_u32 s23, s23, 32768
    s_add_u32 s30, s30, 524288
    s_add_u32 s27, s27, 524288
    s_waitcnt vmcnt(6)
    v_readfirstlane_b32 s33, v6
    s_nop 0
    s_and_b32 s33, s33, 0xffff
    s_cmp_lg_u32 s33, 32
    s_cbranch_scc1 L_fl_L_ch03o_r
L_fl_L_ch03o:
    s_add_u32 s51, s18, 3
    s_min_u32 s51, s51, 63
    s_lshr_b32 s33, s51, 3
    s_add_u32 s33, s33, 10
    s_cmp_lt_u32 s51, 4
    s_cselect_b32 s51, 28, s33
    s_lshl_b32 s51, s51, 2
    s_barrier
    s_add_u32 s18, s18, 1
    v_mov_b64 v[32:33], 0
    v_mov_b64 v[34:35], 0
    s_nop 15
    s_nop 15
    s_nop 15
    s_nop 6
    buffer_load_dwordx4 v[24:27], v0, s[4:7], s22 offen sc1
    s_nop 15
    s_nop 3
    buffer_load_dwordx4 v[16:19], v0, s[4:7], s22 offen sc1
    s_waitcnt vmcnt(1)
    v_bitop3_b32 v8, v24, v25, v26 bitop3:0x80
    v_bitop3_b32 v8, v8, v27, 1 bitop3:0x80
    v_cmp_ne_u32 vcc, 1, v8
    ds_write_b128 v0, v[24:27] offset:3072
    s_cbranch_vccnz L_c3_L_ch03o_r
L_c3_L_ch03o:
    buffer_load_dwordx4 v[40:43], v0, s[4:7], s23 offen sc1
    s_waitcnt lgkmcnt(0)
    s_barrier
    s_branch L_ch0_w3
L_c2_L_ch03e_r:
    s_add_u32 s19, s19, 1
    s_cmp_gt_u32 s19, 4000000
    s_cbranch_scc1 L_cend0
    buffer_load_dwordx4 v[40:43], v0, s[4:7], s23 offen sc1
    s_waitcnt vmcnt(0)
    v_bitop3_b32 v8, v40, v41, v42 bitop3:0x80
    v_bitop3_b32 v8, v8, v43, 1 bitop3:0x80
    v_cmp_ne_u32 vcc, 1, v8
    s_cbranch_vccnz L_c2_L_ch03e_r
    ds_write_b128 v0, v[40:43] offset:9216
    s_nop 7
    s_waitcnt lgkmcnt(0)
    s_branch L_c2_L_ch03e
L_sm_L_ch03e_r:
    v_max3_f32 v8, v28, v29, v30
    v_max3_f32 v8, v8, v31, v40
    s_nop 1
    v_max_f32_dpp v9, v8, v8 quad_perm:[2,3,0,1] row_mask:0xf bank_mask:0xf
    v_max_f32_dpp v10, v8, v8 quad_perm:[2,3,0,1] row_mask:0xf bank_mask:0xf
    s_nop 1
    v_permlane16_swap_b32 v9, v10
    v_max_f32 v8, v9, v10
    v_max_f32 v11, v9, v10
    s_nop 1
    v_permlane32_swap_b32 v8, v11
    v_max_f32 v8, v8, v11
    v_sub_f32 v28, v28, v8
    v_sub_f32 v29, v29, v8
    v_sub_f32 v30, v30, v8
    v_sub_f32 v31, v31, v8
    v_sub_f32 v40, v40, v8
    v_exp_f32 v11, v40
    s_nop 1
    v_mov_b32_dpp v9, v11 quad_perm:[0,1,0,1] row_mask:0xf bank_mask:0xf
    v_exp_f32 v16, v28
    v_exp_f32 v17, v29
    v_cvt_pk_bf16_f32 v12, v11, v9
    v_cvt_pk_bf16_f32 v15, v11, v9
    v_cvt_pk_bf16_f32 v32, v16, v17
    v_exp_f32 v18, v30
    v_mfma_f32_16x16x16_bf16 v[20:23], v[42:43], v[12:13], 0
    v_exp_f32 v19, v31
    v_mov_b32_dpp v34, v32 quad_perm:[0,1,0,1] row_mask:0xf bank_mask:0xf
    v_cvt_pk_bf16_f32 v33, v18, v19
    v_mfma_f32_16x16x16_bf16 v[24:27], v[42:43], v[14:15], 0
    v_add_f32 v8, v16, v17
    v_mov_b32_dpp v35, v33 quad_perm:[0,1,0,1] row_mask:0xf bank_mask:0xf
    v_add_f32 v10, v18, v19
    v_add_f32 v8, v8, v11
    v_mfma_f32_16x16x32_bf16 v[20:23], v[72:75], v[32:35], v[20:23]
    v_add_f32 v8, v8, v10
    v_mfma_f32_16x16x32_bf16 v[24:27], v[76:79], v[32:35], v[24:27]
    v_add_f32_dpp v9, v8, v8 quad_perm:[2,3,0,1] row_mask:0xf bank_mask:0xf
    v_add_f32_dpp v10, v8, v8 quad_perm:[2,3,0,1] row_mask:0xf bank_mask:0xf
    s_nop 1
    v_permlane16_swap_b32 v9, v10
    v_add_f32 v8, v9, v10
    v_add_f32 v9, v9, v10
    s_nop 1
    v_permlane32_swap_b32 v8, v9
    v_add_f32 v8, v8, v9
    v_rcp_f32 v10, v8
    s_nop 0
    v_pk_mul_f32 v[20:21], v[20:21], v[10:11] op_sel_hi:[1,0]
    v_pk_mul_f32 v[22:23], v[22:23], v[10:11] op_sel_hi:[1,0]
    v_pk_mul_f32 v[24:25], v[24:25], v[10:11] op_sel_hi:[1,0]
    v_pk_mul_f32 v[26:27], v[26:27], v[10:11] op_sel_hi:[1,0]
    v_cvt_pk_bf16_f32 v32, v20, v24
    v_cvt_pk_bf16_f32 v33, v21, v25
    v_cvt_pk_bf16_f32 v34, v22, v26
    v_cvt_pk_bf16_f32 v35, v23, v27
    s_branch L_sm_L_ch03e
L_fl_L_ch03e_r:
    s_add_u32 s19, s19, 1
    s_cmp_gt_u32 s19, 4000000
    s_cbranch_scc1 L_cend0
    s_sleep 8
    buffer_load_dword v6, off, s[8:11], s51 sc1
    s_waitcnt vmcnt(0)
    v_readfirstlane_b32 s33, v6
    s_nop 0
    s_and_b32 s33, s33, 0xffff
    s_cmp_lg_u32 s33, 32
    s_cbranch_scc1 L_fl_L_ch03e_r
    s_branch L_fl_L_ch03e
L_c3_L_ch03e_r:
    s_add_u32 s19, s19, 1
    s_cmp_gt_u32 s19, 4000000
    s_cbranch_scc1 L_cend0
    buffer_load_dwordx4 v[24:27], v0, s[4:7], s22 offen sc1
    s_waitcnt vmcnt(1)
    v_or3_b32 v8, v16, v17, v18
    v_or_b32 v8, v8, v19
    v_and_b32 v8, 1, v8
    v_cmp_ne_u32 vcc, 0, v8
    s_cbranch_vccnz L_c3_L_ch03e_r2
    ds_write_b128 v0, v[16:19] offset:3072
    s_branch L_c3_L_ch03e
L_c3_L_ch03e_r2:
    buffer_load_dwordx4 v[16:19], v0, s[4:7], s22 offen sc1
    s_waitcnt vmcnt(1)
    v_or3_b32 v8, v24, v25, v26
    v_or_b32 v8, v8, v27
    v_and_b32 v8, 1, v8
    v_cmp_ne_u32 vcc, 0, v8
    s_cbranch_vccnz L_c3_L_ch03e_r
    ds_write_b128 v0, v[24:27] offset:3072
    s_branch L_c3_L_ch03e
L_c2_L_ch03o_r:
    s_add_u32 s19, s19, 1
    s_cmp_gt_u32 s19, 4000000
    s_cbranch_scc1 L_cend0
    buffer_load_dwordx4 v[40:43], v0, s[4:7], s23 offen sc1
    s_waitcnt vmcnt(0)
    v_or3_b32 v8, v40, v41, v42
    v_or_b32 v8, v8, v43
    v_and_b32 v8, 1, v8
    v_cmp_ne_u32 vcc, 0, v8
    s_cbranch_vccnz L_c2_L_ch03o_r
    ds_write_b128 v0, v[40:43] offset:9216
    s_nop 7
    s_waitcnt lgkmcnt(0)
    s_branch L_c2_L_ch03o
L_sm_L_ch03o_r:
    v_max3_f32 v8, v28, v29, v30
    v_max3_f32 v8, v8, v31, v40
    s_nop 1
    v_max_f32_dpp v9, v8, v8 quad_perm:[2,3,0,1] row_mask:0xf bank_mask:0xf
    v_max_f32_dpp v10, v8, v8 quad_perm:[2,3,0,1] row_mask:0xf bank_mask:0xf
    s_nop 1
    v_permlane16_swap_b32 v9, v10
    v_max_f32 v8, v9, v10
    v_max_f32 v11, v9, v10
    s_nop 1
    v_permlane32_swap_b32 v8, v11
    v_max_f32 v8, v8, v11
    v_sub_f32 v28, v28, v8
    v_sub_f32 v29, v29, v8
    v_sub_f32 v30, v30, v8
    v_sub_f32 v31, v31, v8
    v_sub_f32 v40, v40, v8
    v_exp_f32 v11, v40
    s_nop 1
    v_mov_b32_dpp v9, v11 quad_perm:[0,1,0,1] row_mask:0xf bank_mask:0xf
    v_exp_f32 v16, v28
    v_exp_f32 v17, v29
    v_cvt_pk_bf16_f32 v12, v11, v9
    v_cvt_pk_bf16_f32 v15, v11, v9
    v_cvt_pk_bf16_f32 v32, v16, v17
    v_exp_f32 v18, v30
    v_mfma_f32_16x16x16_bf16 v[20:23], v[42:43], v[12:13], 0
    v_exp_f32 v19, v31
    v_mov_b32_dpp v34, v32 quad_perm:[0,1,0,1] row_mask:0xf bank_mask:0xf
    v_cvt_pk_bf16_f32 v33, v18, v19
    v_mfma_f32_16x16x16_bf16 v[24:27], v[42:43], v[14:15], 0
    v_add_f32 v8, v16, v17
    v_mov_b32_dpp v35, v33 quad_perm:[0,1,0,1] row_mask:0xf bank_mask:0xf
    v_add_f32 v10, v18, v19
    v_add_f32 v8, v8, v11
    v_mfma_f32_16x16x32_bf16 v[20:23], v[72:75], v[32:35], v[20:23]
    v_add_f32 v8, v8, v10
    v_mfma_f32_16x16x32_bf16 v[24:27], v[76:79], v[32:35], v[24:27]
    v_add_f32_dpp v9, v8, v8 quad_perm:[2,3,0,1] row_mask:0xf bank_mask:0xf
    v_add_f32_dpp v10, v8, v8 quad_perm:[2,3,0,1] row_mask:0xf bank_mask:0xf
    s_nop 1
    v_permlane16_swap_b32 v9, v10
    v_add_f32 v8, v9, v10
    v_add_f32 v9, v9, v10
    s_nop 1
    v_permlane32_swap_b32 v8, v9
    v_add_f32 v8, v8, v9
    v_rcp_f32 v10, v8
    s_nop 0
    v_pk_mul_f32 v[20:21], v[20:21], v[10:11] op_sel_hi:[1,0]
    v_pk_mul_f32 v[22:23], v[22:23], v[10:11] op_sel_hi:[1,0]
    v_pk_mul_f32 v[24:25], v[24:25], v[10:11] op_sel_hi:[1,0]
    v_pk_mul_f32 v[26:27], v[26:27], v[10:11] op_sel_hi:[1,0]
    v_cvt_pk_bf16_f32 v32, v20, v24
    v_cvt_pk_bf16_f32 v33, v21, v25
    v_cvt_pk_bf16_f32 v34, v22, v26
    v_cvt_pk_bf16_f32 v35, v23, v27
    s_branch L_sm_L_ch03o
L_fl_L_ch03o_r:
    s_add_u32 s19, s19, 1
    s_cmp_gt_u32 s19, 4000000
    s_cbranch_scc1 L_cend0
    s_sleep 8
    buffer_load_dword v6, off, s[8:11], s51 sc1
    s_waitcnt vmcnt(0)
    v_readfirstlane_b32 s33, v6
    s_nop 0
    s_and_b32 s33, s33, 0xffff
    s_cmp_lg_u32 s33, 32
    s_cbranch_scc1 L_fl_L_ch03o_r
    s_branch L_fl_L_ch03o
L_c3_L_ch03o_r:
    s_add_u32 s19, s19, 1
    s_cmp_gt_u32 s19, 4000000
    s_cbranch_scc1 L_cend0
    buffer_load_dwordx4 v[24:27], v0, s[4:7], s22 offen sc1
    s_waitcnt vmcnt(1)
    v_bitop3_b32 v8, v16, v17, v18 bitop3:0x80
    v_bitop3_b32 v8, v8, v19, 1 bitop3:0x80
    v_cmp_ne_u32 vcc, 1, v8
    s_cbranch_vccnz L_c3_L_ch03o_r2
    ds_write_b128 v0, v[16:19] offset:3072
    s_branch L_c3_L_ch03o
L_c3_L_ch03o_r2:
    buffer_load_dwordx4 v[16:19], v0, s[4:7], s22 offen sc1
    s_waitcnt vmcnt(1)
    v_bitop3_b32 v8, v24, v25, v26 bitop3:0x80
    v_bitop3_b32 v8, v8, v27, 1 bitop3:0x80
    v_cmp_ne_u32 vcc, 1, v8
    s_cbranch_vccnz L_c3_L_ch03o_r
    ds_write_b128 v0, v[24:27] offset:3072
    s_branch L_c3_L_ch03o
L_cdone0:
    s_nop 7
L_cend0:
    s_waitcnt vmcnt(0)
    s_endpgm
L_role1:
    s_load_dwordx2 s[60:61], s[0:1], 56
    s_load_dwordx2 s[62:63], s[0:1], 64
    s_load_dwordx2 s[64:65], s[0:1], 72
    s_load_dwordx2 s[66:67], s[0:1], 80
    s_load_dwordx2 s[68:69], s[0:1], 48
    v_mov_b32 v73, v0
    v_lshlrev_b32 v0, 4, v73
    v_and_b32 v76, 15, v73
    v_lshrrev_b32 v77, 4, v73
    v_lshrrev_b32 v78, 1, v77
    v_and_b32 v79, 1, v77
    v_lshlrev_b32 v74, 4, v76
    v_lshlrev_b32 v75, 6, v79
    v_xor_b32 v74, v74, v75
    s_lshr_b32 s33, s17, 1
    s_and_b32 s34, s17, 1
    s_lshl_b32 s70, s33, 6
    s_lshl_b32 s71, s34, 2
    s_add_u32 s70, s70, s71
    v_lshlrev_b32 v75, 5, v78
    v_lshl_add_u32 v75, v79, 3, v75
    v_add_u32 v75, s70, v75
    v_lshlrev_b32 v75, 13, v75
    s_lshl_b32 s71, s16, 8
    v_add3_u32 v48, v75, v74, s71
    v_add_u32 v49, 15360, v48
    s_lshl_b32 s70, s33, 4
    s_lshl_b32 s71, s34, 1
    s_add_u32 s70, s70, s71
    s_lshl_b32 s71, s16, 7
    s_add_u32 s70, s70, s71
    v_lshlrev_b32 v75, 3, v78
    v_lshl_add_u32 v75, v79, 2, v75
    v_add_u32 v75, s70, v75
    v_mul_u32_u24 v75, 1280, v75
    v_add_u32 v50, v75, v74
    v_add_u32 v51, 256, v50
    v_xor_b32 v75, s17, v79
    v_lshlrev_b32 v75, 6, v75
    v_lshl_add_u32 v75, v77, 8, v75
    v_lshl_add_u32 v52, v76, 2, v75
    v_add_u32 v52, 16384, v52
    v_add_u32 v53, 36864, v52
    v_add_u32 v54, 36864, v53
    v_add_u32 v55, 36864, v54
    s_mul_i32 s72, s17, 36864
    s_add_u32 s72, s72, 16384
    v_add_u32 v4, s72, v0
    s_lshl_b32 s33, s16, 2
    s_add_u32 s33, s33, s17
    s_lshl_b32 s34, s33, 12
    s_add_u32 s30, s34, 13631488
    s_mov_b32 s27, s30
    s_lshl_b32 s34, s33, 10
    s_add_u32 s31, s34, 4194304
    s_mov_b32 s14, 5242880
    s_mov_b32 s15, 0x20000
    s_waitcnt lgkmcnt(0)
    s_mov_b32 s12, s68
    s_mov_b32 s13, s69
    s_mov_b32 s14, 10240
    v_lshrrev_b32 v74, 2, v76
    v_lshlrev_b32 v74, 1, v74
    v_and_b32 v75, 1, v73
    v_add_u32 v74, v74, v75
    v_mul_u32_u24 v74, 1280, v74
    v_lshl_add_u32 v74, v77, 6, v74
    v_bfe_u32 v75, v73, 1, 1
    v_lshl_add_u32 v74, v75, 5, v74
    s_lshr_b32 s33, s17, 1
    s_lshl_b32 s33, s33, 8
    buffer_load_dwordx4 v[28:31], v74, s[12:15], s33 offen offset:768
    buffer_load_dwordx4 v[32:35], v74, s[12:15], s33 offen offset:784
    buffer_load_dwordx4 v[64:67], v74, s[12:15], s33 offen offset:0
    buffer_load_dwordx4 v[68:71], v74, s[12:15], s33 offen offset:16
    buffer_load_dwordx4 v[56:59], v74, s[12:15], s33 offen offset:512
    buffer_load_dwordx4 v[60:63], v74, s[12:15], s33 offen offset:528
    s_mov_b32 s14, 5242880
    s_mov_b32 s12, s60
    s_mov_b32 s13, s61
    s_add_u32 m0, s72, 0
    s_mov_b32 s33, 131072
    buffer_load_dwordx4 v48, s[12:15], s33 offen lds
    buffer_load_dwordx4 v49, s[12:15], s33 offen offset:1024 lds
    s_add_u32 m0, s72, 2048
    s_mov_b32 s33, 8192
    buffer_load_dwordx4 v48, s[12:15], s33 offen lds
    buffer_load_dwordx4 v49, s[12:15], s33 offen offset:1024 lds
    s_add_u32 m0, s72, 4096
    s_mov_b32 s33, 139264
    buffer_load_dwordx4 v48, s[12:15], s33 offen lds
    buffer_load_dwordx4 v49, s[12:15], s33 offen offset:1024 lds
    s_add_u32 m0, s72, 6144
    s_mov_b32 s33, 1179648
    buffer_load_dwordx4 v48, s[12:15], s33 offen lds
    buffer_load_dwordx4 v49, s[12:15], s33 offen offset:1024 lds
    s_add_u32 m0, s72, 8192
    s_mov_b32 s33, 1056768
    buffer_load_dwordx4 v48, s[12:15], s33 offen lds
    buffer_load_dwordx4 v49, s[12:15], s33 offen offset:1024 lds
    s_add_u32 m0, s72, 10240
    s_mov_b32 s33, 1187840
    buffer_load_dwordx4 v48, s[12:15], s33 offen lds
    buffer_load_dwordx4 v49, s[12:15], s33 offen offset:1024 lds
    s_add_u32 m0, s72, 12288
    s_mov_b32 s33, 2228224
    buffer_load_dwordx4 v48, s[12:15], s33 offen lds
    buffer_load_dwordx4 v49, s[12:15], s33 offen offset:1024 lds
    s_add_u32 m0, s72, 14336
    s_mov_b32 s33, 2236416
    buffer_load_dwordx4 v48, s[12:15], s33 offen lds
    buffer_load_dwordx4 v49, s[12:15], s33 offen offset:1024 lds
    s_add_u32 m0, s72, 16384
    s_mov_b32 s33, 3276800
    buffer_load_dwordx4 v48, s[12:15], s33 offen lds
    buffer_load_dwordx4 v49, s[12:15], s33 offen offset:1024 lds
    s_add_u32 m0, s72, 18432
    s_mov_b32 s33, 3153920
    buffer_load_dwordx4 v48, s[12:15], s33 offen lds
    buffer_load_dwordx4 v49, s[12:15], s33 offen offset:1024 lds
    s_add_u32 m0, s72, 20480
    s_mov_b32 s33, 3284992
    buffer_load_dwordx4 v48, s[12:15], s33 offen lds
    buffer_load_dwordx4 v49, s[12:15], s33 offen offset:1024 lds
    s_add_u32 m0, s72, 22528
    s_mov_b32 s33, 4325376
    buffer_load_dwordx4 v48, s[12:15], s33 offen lds
    buffer_load_dwordx4 v49, s[12:15], s33 offen offset:1024 lds
    s_add_u32 m0, s72, 24576
    s_mov_b32 s33, 4202496
    buffer_load_dwordx4 v48, s[12:15], s33 offen lds
    buffer_load_dwordx4 v49, s[12:15], s33 offen offset:1024 lds
    s_add_u32 m0, s72, 26624
    s_mov_b32 s33, 4333568
    buffer_load_dwordx4 v48, s[12:15], s33 offen lds
    buffer_load_dwordx4 v49, s[12:15], s33 offen offset:1024 lds
    s_mov_b32 s12, s62
    s_mov_b32 s13, s63
    s_add_u32 m0, s72, 28672
    s_mov_b32 s33, 0
    buffer_load_dwordx4 v48, s[12:15], s33 offen lds
    buffer_load_dwordx4 v49, s[12:15], s33 offen offset:1024 lds
    s_add_u32 m0, s72, 30720
    s_mov_b32 s33, 8192
    buffer_load_dwordx4 v48, s[12:15], s33 offen lds
    buffer_load_dwordx4 v49, s[12:15], s33 offen offset:1024 lds
    s_add_u32 m0, s72, 32768
    s_mov_b32 s33, 139264
    buffer_load_dwordx4 v48, s[12:15], s33 offen lds
    buffer_load_dwordx4 v49, s[12:15], s33 offen offset:1024 lds
    s_add_u32 m0, s72, 34816
    s_mov_b32 s33, 1048576
    buffer_load_dwordx4 v48, s[12:15], s33 offen lds
    buffer_load_dwordx4 v49, s[12:15], s33 offen offset:1024 lds
    v_and_b32 v76, 15, v73
    v_lshrrev_b32 v77, 4, v73
    v_bfe_u32 v75, v73, 1, 1
    v_mov_b32 v74, 0x88888888
    v_mov_b32 v78, 0xdddddddd
    v_cmp_eq_u32 vcc, 1, v75
    s_nop 1
    v_cndmask_b32 v1, v74, v78, vcc
    v_and_b32 v79, 1, v73
    v_lshlrev_b32 v74, 4, v79
    v_mov_b32 v78, 0x3f80
    v_lshlrev_b32 v2, v74, v78
    v_and_b32 v3, 0x3d0, v0
    s_lshl_b32 s33, s17, 14
    s_lshl_b32 s34, s16, 6
    s_add_u32 s33, s33, s34
    v_lshlrev_b32 v74, 11, v77
    v_lshl_add_u32 v74, v76, 2, v74
    v_add_u32 v5, s33, v74
    v_lshlrev_b32 v7, 2, v73
    s_mov_b32 s28, 196608
    s_mov_b32 s29, 204800
    s_mov_b32 s46, 262144
    s_mov_b32 s73, 270336
    s_mov_b32 s74, 327680
    s_mov_b32 s75, 335872
    s_min_u32 s70, s17, 1
    s_lshl_b32 s34, s16, 11
    s_lshl_b32 s33, s70, 16
    s_add_u32 s33, s33, s34
    s_add_u32 s21, s33, 196608
    s_bfe_u32 s33, s16, 0x10002
    s_lshl_b32 s33, s33, 10
    s_lshr_b32 s34, s16, 3
    s_lshl_b32 s34, s34, 8
    s_add_u32 s33, s33, s34
    s_and_b32 s34, s16, 3
    s_lshl_b32 s34, s34, 6
    s_add_u32 s33, s33, s34
    v_lshrrev_b32 v74, 1, v77
    v_lshlrev_b32 v74, 5, v74
    v_lshl_add_u32 v74, v79, 4, v74
    v_and_b32 v78, 1, v77
    v_lshl_add_u32 v74, v78, 3, v74
    v_add_u32 v74, s33, v74
    v_cmp_gt_u32 vcc, 2, v76
    v_mov_b32 v78, 0x7ffffff0
    s_nop 0
    v_cndmask_b32 v6, v78, v74, vcc
    s_lshl_b32 s33, s70, 11
    s_add_u32 s25, s33, 333824
    s_add_u32 s26, s33, 2113536
    s_mov_b32 s20, 1040356334
    s_lshl_b32 s33, s17, 10
    s_add_u32 s22, s33, 333824
    s_add_u32 s23, s33, 2097152
    s_add_u32 s24, s23, 4096
    s_mov_b32 s48, s20
    s_mov_b32 s49, s20
    s_mov_b32 s47, 729808896
    s_mov_b32 s50, 671088640
    s_mov_b32 s51, 112
    s_mov_b32 s36, 0xcccccccc
    s_mov_b32 s37, 0xcccccccc
    s_mov_b32 s42, 0x00030003
    s_mov_b32 s43, 0x00030003
    v_mov_b32 v12, 1
    v_mov_b32 v13, 1
    v_mov_b32 v14, 1
    v_mov_b32 v15, 1
    buffer_store_dwordx4 v[12:15], v0, s[4:7], s21 offen
    buffer_store_dwordx4 v[12:15], v0, s[4:7], s21 offen offset:1024
    buffer_store_dwordx2 v[12:13], v6, s[4:7], s25 offen
    s_lshl_b32 s32, s16, 7
    s_add_u32 s32, s32, 524288
    s_lshl_b32 s33, s16, 8
    s_add_u32 s33, s33, 532480
    v_mov_b32 v16, 0
    s_mov_b64 exec, 1
    buffer_store_dword v16, off, s[4:7], s32 sc1
    buffer_store_dword v16, off, s[4:7], s33 sc1
    buffer_store_dword v16, off, s[4:7], s33 offset:128 sc1
    s_mov_b64 exec, -1
    s_mov_b32 s38, 12582924
    s_mov_b32 s39, 3221228544
    s_mov_b32 s40, 3145731
    s_mov_b32 s41, 805307136
    s_waitcnt vmcnt(40)
    s_waitcnt lgkmcnt(0)
    s_barrier
    ds_read2st64_b32 a[8:9], v52 offset0:0 offset1:4
    ds_read2st64_b32 a[10:11], v53 offset0:0 offset1:4
    ds_read2st64_b32 a[12:13], v54 offset0:0 offset1:4
    ds_read2st64_b32 a[14:15], v55 offset0:0 offset1:4
    s_and_b32 s34, s17, 1
    s_mul_i32 s34, s34, 0x02020202
    s_add_u32 s34, s34, 0x05040100
    s_lshl_b32 s70, s17, 10
    v_add_u32 v75, s70, v0
    v_perm_b32 v24, v29, v28, s34
    v_perm_b32 v25, v31, v30, s34
    v_perm_b32 v26, v33, v32, s34
    v_perm_b32 v27, v35, v34, s34
    ds_write_b128 v75, v[24:27] offset:6144
    v_perm_b32 v40, v65, v64, s34
    v_perm_b32 v41, v67, v66, s34
    v_perm_b32 v42, v69, v68, s34
    v_perm_b32 v43, v71, v70, s34
    ds_write_b128 v75, v[40:43] offset:0
    v_perm_b32 v44, v57, v56, s34
    v_perm_b32 v45, v59, v58, s34
    v_perm_b32 v46, v61, v60, s34
    v_perm_b32 v47, v63, v62, s34
    ds_write_b128 v75, v[44:47] offset:4096
    s_waitcnt vmcnt(38)
    s_waitcnt lgkmcnt(0)
    s_barrier
    s_add_u32 m0, s72, 0
    s_mov_b32 s33, 1056768
    buffer_load_dwordx4 v48, s[12:15], s33 offen lds
    buffer_load_dwordx4 v49, s[12:15], s33 offen offset:1024 lds
    ds_read2st64_b32 a[24:25], v52 offset0:8 offset1:12
    ds_read2st64_b32 a[26:27], v53 offset0:8 offset1:12
    ds_read2st64_b32 a[28:29], v54 offset0:8 offset1:12
    ds_read2st64_b32 a[30:31], v55 offset0:8 offset1:12
    s_waitcnt vmcnt(38)
    s_waitcnt lgkmcnt(0)
    s_barrier
    s_add_u32 m0, s72, 2048
    s_mov_b32 s33, 1187840
    buffer_load_dwordx4 v48, s[12:15], s33 offen lds
    buffer_load_dwordx4 v49, s[12:15], s33 offen offset:1024 lds
    ds_read2st64_b32 a[40:41], v52 offset0:16 offset1:20
    ds_read2st64_b32 a[42:43], v53 offset0:16 offset1:20
    ds_read2st64_b32 a[44:45], v54 offset0:16 offset1:20
    ds_read2st64_b32 a[46:47], v55 offset0:16 offset1:20
    s_lshl_b32 s33, s16, 16
    s_lshr_b32 s34, s17, 1
    v_mov_b32 v16, s34
    v_mov_b32 v17, s34
    v_mov_b32 v18, s34
    v_mov_b32 v19, s34
    s_lshl_b32 s34, s34, 15
    s_add_u32 s33, s33, s34
    s_and_b32 s34, s17, 1
    s_mul_i32 s34, s34, 2048
    s_add_u32 s33, s33, s34
    s_add_u32 s33, s33, 2113536
    buffer_store_dwordx4 v[16:19], v0, s[4:7], s33 offen offset:0 sc1
    buffer_store_dwordx4 v[16:19], v0, s[4:7], s33 offen offset:1024 sc1
    s_waitcnt vmcnt(40)
    s_waitcnt lgkmcnt(0)
    s_barrier
    s_add_u32 m0, s72, 4096
    s_mov_b32 s33, 2097152
    buffer_load_dwordx4 v48, s[12:15], s33 offen lds
    buffer_load_dwordx4 v49, s[12:15], s33 offen offset:1024 lds
    ds_read2st64_b32 a[80:81], v52 offset0:24 offset1:28
    ds_read2st64_b32 a[82:83], v53 offset0:24 offset1:28
    ds_read2st64_b32 a[84:85], v54 offset0:24 offset1:28
    ds_read2st64_b32 a[86:87], v55 offset0:24 offset1:28
    s_waitcnt vmcnt(40)
    s_waitcnt lgkmcnt(0)
    s_barrier
    s_add_u32 m0, s72, 6144
    s_mov_b32 s33, 2228224
    buffer_load_dwordx4 v48, s[12:15], s33 offen lds
    buffer_load_dwordx4 v49, s[12:15], s33 offen offset:1024 lds
    ds_read2st64_b32 a[96:97], v52 offset0:32 offset1:36
    ds_read2st64_b32 a[98:99], v53 offset0:32 offset1:36
    ds_read2st64_b32 a[100:101], v54 offset0:32 offset1:36
    ds_read2st64_b32 a[102:103], v55 offset0:32 offset1:36
    s_waitcnt vmcnt(40)
    s_waitcnt lgkmcnt(0)
    s_barrier
    s_add_u32 m0, s72, 8192
    s_mov_b32 s33, 2105344
    buffer_load_dwordx4 v48, s[12:15], s33 offen lds
    buffer_load_dwordx4 v49, s[12:15], s33 offen offset:1024 lds
    ds_read2st64_b32 a[112:113], v52 offset0:40 offset1:44
    ds_read2st64_b32 a[114:115], v53 offset0:40 offset1:44
    ds_read2st64_b32 a[116:117], v54 offset0:40 offset1:44
    ds_read2st64_b32 a[118:119], v55 offset0:40 offset1:44
    s_waitcnt vmcnt(40)
    s_waitcnt lgkmcnt(0)
    s_barrier
    s_add_u32 m0, s72, 10240
    s_mov_b32 s33, 2236416
    buffer_load_dwordx4 v48, s[12:15], s33 offen lds
    buffer_load_dwordx4 v49, s[12:15], s33 offen offset:1024 lds
    ds_read2st64_b32 a[144:145], v52 offset0:48 offset1:52
    ds_read2st64_b32 a[146:147], v53 offset0:48 offset1:52
    ds_read2st64_b32 a[148:149], v54 offset0:48 offset1:52
    ds_read2st64_b32 a[150:151], v55 offset0:48 offset1:52
    s_lshl_b32 s33, s16, 16
    s_lshr_b32 s34, s17, 1
    v_mov_b32 v16, s34
    v_mov_b32 v17, s34
    v_mov_b32 v18, s34
    v_mov_b32 v19, s34
    s_lshl_b32 s34, s34, 15
    s_add_u32 s33, s33, s34
    s_and_b32 s34, s17, 1
    s_mul_i32 s34, s34, 2048
    s_add_u32 s33, s33, s34
    s_add_u32 s33, s33, 2121728
    buffer_store_dwordx4 v[16:19], v0, s[4:7], s33 offen offset:0 sc1
    buffer_store_dwordx4 v[16:19], v0, s[4:7], s33 offen offset:1024 sc1
    s_waitcnt vmcnt(42)
    s_waitcnt lgkmcnt(0)
    s_barrier
    s_add_u32 m0, s72, 12288
    s_mov_b32 s33, 3276800
    buffer_load_dwordx4 v48, s[12:15], s33 offen lds
    buffer_load_dwordx4 v49, s[12:15], s33 offen offset:1024 lds
    ds_read2st64_b32 a[168:169], v52 offset0:56 offset1:60
    ds_read2st64_b32 a[170:171], v53 offset0:56 offset1:60
    ds_read2st64_b32 a[172:173], v54 offset0:56 offset1:60
    ds_read2st64_b32 a[174:175], v55 offset0:56 offset1:60
    s_waitcnt vmcnt(42)
    s_waitcnt lgkmcnt(0)
    s_barrier
    s_add_u32 m0, s72, 14336
    s_mov_b32 s33, 3153920
    buffer_load_dwordx4 v48, s[12:15], s33 offen lds
    buffer_load_dwordx4 v49, s[12:15], s33 offen offset:1024 lds
    ds_read2st64_b32 v[112:113], v52 offset0:64 offset1:68
    ds_read2st64_b32 v[114:115], v53 offset0:64 offset1:68
    ds_read2st64_b32 v[116:117], v54 offset0:64 offset1:68
    ds_read2st64_b32 v[118:119], v55 offset0:64 offset1:68
    s_waitcnt vmcnt(42)
    s_waitcnt lgkmcnt(0)
    s_barrier
    s_add_u32 m0, s72, 16384
    s_mov_b32 s33, 3284992
    buffer_load_dwordx4 v48, s[12:15], s33 offen lds
    buffer_load_dwordx4 v49, s[12:15], s33 offen offset:1024 lds
    ds_read2st64_b32 v[136:137], v52 offset0:72 offset1:76
    ds_read2st64_b32 v[138:139], v53 offset0:72 offset1:76
    ds_read2st64_b32 v[140:141], v54 offset0:72 offset1:76
    ds_read2st64_b32 v[142:143], v55 offset0:72 offset1:76
    s_waitcnt vmcnt(42)
    s_waitcnt lgkmcnt(0)
    s_barrier
    s_add_u32 m0, s72, 18432
    s_mov_b32 s33, 4194304
    buffer_load_dwordx4 v48, s[12:15], s33 offen lds
    buffer_load_dwordx4 v49, s[12:15], s33 offen offset:1024 lds
    ds_read2st64_b32 v[152:153], v52 offset0:80 offset1:84
    ds_read2st64_b32 v[154:155], v53 offset0:80 offset1:84
    ds_read2st64_b32 v[156:157], v54 offset0:80 offset1:84
    ds_read2st64_b32 v[158:159], v55 offset0:80 offset1:84
    s_waitcnt vmcnt(42)
    s_waitcnt lgkmcnt(0)
    s_barrier
    s_add_u32 m0, s72, 20480
    s_mov_b32 s33, 4202496
    buffer_load_dwordx4 v48, s[12:15], s33 offen lds
    buffer_load_dwordx4 v49, s[12:15], s33 offen offset:1024 lds
    ds_read2st64_b32 v[192:193], v52 offset0:88 offset1:92
    ds_read2st64_b32 v[194:195], v53 offset0:88 offset1:92
    ds_read2st64_b32 v[196:197], v54 offset0:88 offset1:92
    ds_read2st64_b32 v[198:199], v55 offset0:88 offset1:92
    s_waitcnt vmcnt(42)
    s_waitcnt lgkmcnt(0)
    s_barrier
    s_add_u32 m0, s72, 22528
    s_mov_b32 s33, 4333568
    buffer_load_dwordx4 v48, s[12:15], s33 offen lds
    buffer_load_dwordx4 v49, s[12:15], s33 offen offset:1024 lds
    ds_read2st64_b32 v[208:209], v52 offset0:96 offset1:100
    ds_read2st64_b32 v[210:211], v53 offset0:96 offset1:100
    ds_read2st64_b32 v[212:213], v54 offset0:96 offset1:100
    ds_read2st64_b32 v[214:215], v55 offset0:96 offset1:100
    s_waitcnt vmcnt(42)
    s_waitcnt lgkmcnt(0)
    s_barrier
    s_mov_b32 s12, s64
    s_mov_b32 s13, s65
    s_add_u32 m0, s72, 24576
    s_mov_b32 s33, 0
    buffer_load_dwordx4 v48, s[12:15], s33 offen lds
    buffer_load_dwordx4 v49, s[12:15], s33 offen offset:1024 lds
    ds_read2st64_b32 v[224:225], v52 offset0:104 offset1:108
    ds_read2st64_b32 v[226:227], v53 offset0:104 offset1:108
    ds_read2st64_b32 v[228:229], v54 offset0:104 offset1:108
    ds_read2st64_b32 v[230:231], v55 offset0:104 offset1:108
    s_waitcnt vmcnt(42)
    s_waitcnt lgkmcnt(0)
    s_barrier
    s_add_u32 m0, s72, 26624
    s_mov_b32 s33, 131072
    buffer_load_dwordx4 v48, s[12:15], s33 offen lds
    buffer_load_dwordx4 v49, s[12:15], s33 offen offset:1024 lds
    ds_read2st64_b32 v[248:249], v52 offset0:112 offset1:116
    ds_read2st64_b32 v[250:251], v53 offset0:112 offset1:116
    ds_read2st64_b32 v[252:253], v54 offset0:112 offset1:116
    ds_read2st64_b32 v[254:255], v55 offset0:112 offset1:116
    s_waitcnt vmcnt(42)
    s_waitcnt lgkmcnt(0)
    s_barrier
    s_add_u32 m0, s72, 28672
    s_mov_b32 s33, 139264
    buffer_load_dwordx4 v48, s[12:15], s33 offen lds
    buffer_load_dwordx4 v49, s[12:15], s33 offen offset:1024 lds
    ds_read2st64_b32 a[32:33], v52 offset0:120 offset1:124
    ds_read2st64_b32 a[34:35], v53 offset0:120 offset1:124
    ds_read2st64_b32 a[36:37], v54 offset0:120 offset1:124
    ds_read2st64_b32 a[38:39], v55 offset0:120 offset1:124
    s_waitcnt vmcnt(42)
    s_waitcnt lgkmcnt(0)
    s_barrier
    s_add_u32 m0, s72, 30720
    s_mov_b32 s33, 1048576
    buffer_load_dwordx4 v48, s[12:15], s33 offen lds
    buffer_load_dwordx4 v49, s[12:15], s33 offen offset:1024 lds
    ds_read2st64_b32 a[48:49], v52 offset0:128 offset1:132
    ds_read2st64_b32 a[50:51], v53 offset0:128 offset1:132
    ds_read2st64_b32 a[52:53], v54 offset0:128 offset1:132
    ds_read2st64_b32 a[54:55], v55 offset0:128 offset1:132
    s_waitcnt vmcnt(42)
    s_waitcnt lgkmcnt(0)
    s_barrier
    s_add_u32 m0, s72, 32768
    s_mov_b32 s33, 1179648
    buffer_load_dwordx4 v48, s[12:15], s33 offen lds
    buffer_load_dwordx4 v49, s[12:15], s33 offen offset:1024 lds
    ds_read2st64_b32 a[64:65], v52 offset0:136 offset1:140
    ds_read2st64_b32 a[66:67], v53 offset0:136 offset1:140
    ds_read2st64_b32 a[68:69], v54 offset0:136 offset1:140
    ds_read2st64_b32 a[70:71], v55 offset0:136 offset1:140
    s_waitcnt vmcnt(36)
    s_waitcnt lgkmcnt(0)
    s_barrier
    s_add_u32 m0, s72, 34816
    s_mov_b32 s33, 1187840
    buffer_load_dwordx4 v48, s[12:15], s33 offen lds
    buffer_load_dwordx4 v49, s[12:15], s33 offen offset:1024 lds
    ds_read2st64_b32 a[104:105], v52 offset0:0 offset1:4
    ds_read2st64_b32 a[106:107], v53 offset0:0 offset1:4
    ds_read2st64_b32 a[108:109], v54 offset0:0 offset1:4
    ds_read2st64_b32 a[110:111], v55 offset0:0 offset1:4
    s_waitcnt vmcnt(36)
    s_waitcnt lgkmcnt(0)
    s_barrier
    s_add_u32 m0, s72, 0
    s_mov_b32 s33, 2097152
    buffer_load_dwordx4 v48, s[12:15], s33 offen lds
    buffer_load_dwordx4 v49, s[12:15], s33 offen offset:1024 lds
    ds_read2st64_b32 a[120:121], v52 offset0:8 offset1:12
    ds_read2st64_b32 a[122:123], v53 offset0:8 offset1:12
    ds_read2st64_b32 a[124:125], v54 offset0:8 offset1:12
    ds_read2st64_b32 a[126:127], v55 offset0:8 offset1:12
    s_waitcnt vmcnt(34)
    s_waitcnt lgkmcnt(0)
    s_barrier
    s_add_u32 m0, s72, 2048
    s_mov_b32 s33, 2228224
    buffer_load_dwordx4 v48, s[12:15], s33 offen lds
    buffer_load_dwordx4 v49, s[12:15], s33 offen offset:1024 lds
    ds_read2st64_b32 a[136:137], v52 offset0:16 offset1:20
    ds_read2st64_b32 a[138:139], v53 offset0:16 offset1:20
    ds_read2st64_b32 a[140:141], v54 offset0:16 offset1:20
    ds_read2st64_b32 a[142:143], v55 offset0:16 offset1:20
    s_waitcnt vmcnt(34)
    s_waitcnt lgkmcnt(0)
    s_barrier
    s_add_u32 m0, s72, 4096
    s_mov_b32 s33, 2105344
    buffer_load_dwordx4 v48, s[12:15], s33 offen lds
    buffer_load_dwordx4 v49, s[12:15], s33 offen offset:1024 lds
    ds_read2st64_b32 a[152:153], v52 offset0:24 offset1:28
    ds_read2st64_b32 a[154:155], v53 offset0:24 offset1:28
    ds_read2st64_b32 a[156:157], v54 offset0:24 offset1:28
    ds_read2st64_b32 a[158:159], v55 offset0:24 offset1:28
    s_waitcnt vmcnt(34)
    s_waitcnt lgkmcnt(0)
    s_barrier
    s_add_u32 m0, s72, 6144
    s_mov_b32 s33, 2236416
    buffer_load_dwordx4 v48, s[12:15], s33 offen lds
    buffer_load_dwordx4 v49, s[12:15], s33 offen offset:1024 lds
    ds_read2st64_b32 a[160:161], v52 offset0:32 offset1:36
    ds_read2st64_b32 a[162:163], v53 offset0:32 offset1:36
    ds_read2st64_b32 a[164:165], v54 offset0:32 offset1:36
    ds_read2st64_b32 a[166:167], v55 offset0:32 offset1:36
    s_waitcnt vmcnt(34)
    s_waitcnt lgkmcnt(0)
    s_barrier
    s_add_u32 m0, s72, 8192
    s_mov_b32 s33, 3145728
    buffer_load_dwordx4 v48, s[12:15], s33 offen lds
    buffer_load_dwordx4 v49, s[12:15], s33 offen offset:1024 lds
    ds_read2st64_b32 a[176:177], v52 offset0:40 offset1:44
    ds_read2st64_b32 a[178:179], v53 offset0:40 offset1:44
    ds_read2st64_b32 a[180:181], v54 offset0:40 offset1:44
    ds_read2st64_b32 a[182:183], v55 offset0:40 offset1:44
    s_waitcnt vmcnt(32)
    s_waitcnt lgkmcnt(0)
    s_barrier
    s_add_u32 m0, s72, 10240
    s_mov_b32 s33, 3276800
    buffer_load_dwordx4 v48, s[12:15], s33 offen lds
    buffer_load_dwordx4 v49, s[12:15], s33 offen offset:1024 lds
    ds_read2st64_b32 v[120:121], v52 offset0:48 offset1:52
    ds_read2st64_b32 v[122:123], v53 offset0:48 offset1:52
    ds_read2st64_b32 v[124:125], v54 offset0:48 offset1:52
    ds_read2st64_b32 v[126:127], v55 offset0:48 offset1:52
    s_waitcnt vmcnt(32)
    s_waitcnt lgkmcnt(0)
    s_barrier
    s_add_u32 m0, s72, 12288
    s_mov_b32 s33, 3284992
    buffer_load_dwordx4 v48, s[12:15], s33 offen lds
    buffer_load_dwordx4 v49, s[12:15], s33 offen offset:1024 lds
    ds_read2st64_b32 v[144:145], v52 offset0:56 offset1:60
    ds_read2st64_b32 v[146:147], v53 offset0:56 offset1:60
    ds_read2st64_b32 v[148:149], v54 offset0:56 offset1:60
    ds_read2st64_b32 v[150:151], v55 offset0:56 offset1:60
    s_waitcnt vmcnt(32)
    s_waitcnt lgkmcnt(0)
    s_barrier
    s_add_u32 m0, s72, 14336
    s_mov_b32 s33, 4194304
    buffer_load_dwordx4 v48, s[12:15], s33 offen lds
    buffer_load_dwordx4 v49, s[12:15], s33 offen offset:1024 lds
    ds_read2st64_b32 v[160:161], v52 offset0:64 offset1:68
    ds_read2st64_b32 v[162:163], v53 offset0:64 offset1:68
    ds_read2st64_b32 v[164:165], v54 offset0:64 offset1:68
    ds_read2st64_b32 v[166:167], v55 offset0:64 offset1:68
    s_cmp_lg_u32 s17, 0
    s_cbranch_scc1 L_nordy1
    v_mov_b32 v8, 1
    s_mov_b64 exec, 1
    buffer_atomic_add v8, off, s[8:11], 0 offset:32
    s_mov_b64 exec, -1
L_nordy1:
    s_waitcnt vmcnt(33)
    s_waitcnt lgkmcnt(0)
    s_barrier
    s_add_u32 m0, s72, 16384
    s_mov_b32 s33, 4325376
    buffer_load_dwordx4 v48, s[12:15], s33 offen lds
    buffer_load_dwordx4 v49, s[12:15], s33 offen offset:1024 lds
    ds_read2st64_b32 v[176:177], v52 offset0:72 offset1:76
    ds_read2st64_b32 v[178:179], v53 offset0:72 offset1:76
    ds_read2st64_b32 v[180:181], v54 offset0:72 offset1:76
    ds_read2st64_b32 v[182:183], v55 offset0:72 offset1:76
    s_waitcnt vmcnt(33)
    s_waitcnt lgkmcnt(0)
    s_barrier
    s_add_u32 m0, s72, 18432
    s_mov_b32 s33, 4333568
    buffer_load_dwordx4 v48, s[12:15], s33 offen lds
    buffer_load_dwordx4 v49, s[12:15], s33 offen offset:1024 lds
    ds_read2st64_b32 v[216:217], v52 offset0:80 offset1:84
    ds_read2st64_b32 v[218:219], v53 offset0:80 offset1:84
    ds_read2st64_b32 v[220:221], v54 offset0:80 offset1:84
    ds_read2st64_b32 v[222:223], v55 offset0:80 offset1:84
    s_waitcnt vmcnt(33)
    s_waitcnt lgkmcnt(0)
    s_barrier
    s_mov_b32 s12, s66
    s_mov_b32 s13, s67
    s_add_u32 m0, s72, 20480
    s_mov_b32 s33, 82688
    buffer_load_dwordx4 v50, s[12:15], s33 offen lds
    buffer_load_dwordx4 v51, s[12:15], s33 offen offset:1024 lds
    ds_read2st64_b32 v[232:233], v52 offset0:88 offset1:92
    ds_read2st64_b32 v[234:235], v53 offset0:88 offset1:92
    ds_read2st64_b32 v[236:237], v54 offset0:88 offset1:92
    ds_read2st64_b32 v[238:239], v55 offset0:88 offset1:92
    s_waitcnt vmcnt(33)
    s_waitcnt lgkmcnt(0)
    s_barrier
    s_add_u32 m0, s72, 22528
    s_mov_b32 s33, 123648
    buffer_load_dwordx4 v50, s[12:15], s33 offen lds
    buffer_load_dwordx4 v51, s[12:15], s33 offen offset:1024 lds
    ds_read2st64_b32 a[0:1], v52 offset0:96 offset1:100
    ds_read2st64_b32 a[2:3], v53 offset0:96 offset1:100
    ds_read2st64_b32 a[4:5], v54 offset0:96 offset1:100
    ds_read2st64_b32 a[6:7], v55 offset0:96 offset1:100
    s_waitcnt vmcnt(33)
    s_waitcnt lgkmcnt(0)
    s_barrier
    s_add_u32 m0, s72, 24576
    s_mov_b32 s33, 1024
    buffer_load_dwordx4 v50, s[12:15], s33 offen lds
    buffer_load_dwordx4 v51, s[12:15], s33 offen offset:1024 lds
    ds_read2st64_b32 a[16:17], v52 offset0:104 offset1:108
    ds_read2st64_b32 a[18:19], v53 offset0:104 offset1:108
    ds_read2st64_b32 a[20:21], v54 offset0:104 offset1:108
    ds_read2st64_b32 a[22:23], v55 offset0:104 offset1:108
    s_waitcnt vmcnt(33)
    s_waitcnt lgkmcnt(0)
    s_barrier
    s_add_u32 m0, s72, 26624
    s_mov_b32 s33, 41984
    buffer_load_dwordx4 v50, s[12:15], s33 offen lds
    buffer_load_dwordx4 v51, s[12:15], s33 offen offset:1024 lds
    ds_read2st64_b32 a[56:57], v52 offset0:112 offset1:116
    ds_read2st64_b32 a[58:59], v53 offset0:112 offset1:116
    ds_read2st64_b32 a[60:61], v54 offset0:112 offset1:116
    ds_read2st64_b32 a[62:63], v55 offset0:112 offset1:116
    s_waitcnt vmcnt(33)
    s_waitcnt lgkmcnt(0)
    s_barrier
    s_add_u32 m0, s72, 28672
    s_mov_b32 s33, 123904
    buffer_load_dwordx4 v50, s[12:15], s33 offen lds
    buffer_load_dwordx4 v51, s[12:15], s33 offen offset:1024 lds
    ds_read2st64_b32 a[72:73], v52 offset0:120 offset1:124
    ds_read2st64_b32 a[74:75], v53 offset0:120 offset1:124
    ds_read2st64_b32 a[76:77], v54 offset0:120 offset1:124
    ds_read2st64_b32 a[78:79], v55 offset0:120 offset1:124
    s_waitcnt vmcnt(33)
    s_waitcnt lgkmcnt(0)
    s_barrier
    s_add_u32 m0, s72, 30720
    s_mov_b32 s33, 41728
    buffer_load_dwordx4 v50, s[12:15], s33 offen lds
    buffer_load_dwordx4 v51, s[12:15], s33 offen offset:1024 lds
    ds_read2st64_b32 a[88:89], v52 offset0:128 offset1:132
    ds_read2st64_b32 a[90:91], v53 offset0:128 offset1:132
    ds_read2st64_b32 a[92:93], v54 offset0:128 offset1:132
    ds_read2st64_b32 a[94:95], v55 offset0:128 offset1:132
    s_waitcnt vmcnt(33)
    s_waitcnt lgkmcnt(0)
    s_barrier
    s_add_u32 m0, s72, 32768
    s_mov_b32 s33, 82944
    buffer_load_dwordx4 v50, s[12:15], s33 offen lds
    buffer_load_dwordx4 v51, s[12:15], s33 offen offset:1024 lds
    ds_read2st64_b32 a[128:129], v52 offset0:136 offset1:140
    ds_read2st64_b32 a[130:131], v53 offset0:136 offset1:140
    ds_read2st64_b32 a[132:133], v54 offset0:136 offset1:140
    ds_read2st64_b32 a[134:135], v55 offset0:136 offset1:140
    s_waitcnt vmcnt(33)
    s_waitcnt lgkmcnt(0)
    s_barrier
    ds_read2st64_b32 a[184:185], v52 offset0:0 offset1:4
    ds_read2st64_b32 a[186:187], v53 offset0:0 offset1:4
    ds_read2st64_b32 a[188:189], v54 offset0:0 offset1:4
    ds_read2st64_b32 a[190:191], v55 offset0:0 offset1:4
    s_waitcnt vmcnt(31)
    s_waitcnt lgkmcnt(0)
    s_barrier
    s_mov_b32 s12, s60
    s_mov_b32 s13, s61
    s_add_u32 m0, s72, 0
    s_mov_b32 s33, 3145728
    buffer_load_dwordx4 v48, s[12:15], s33 offen lds
    buffer_load_dwordx4 v49, s[12:15], s33 offen offset:1024 lds
    ds_read2st64_b32 a[192:193], v52 offset0:8 offset1:12
    ds_read2st64_b32 a[194:195], v53 offset0:8 offset1:12
    ds_read2st64_b32 a[196:197], v54 offset0:8 offset1:12
    ds_read2st64_b32 a[198:199], v55 offset0:8 offset1:12
    s_waitcnt vmcnt(31)
    s_waitcnt lgkmcnt(0)
    s_barrier
    s_mov_b32 s12, s64
    s_mov_b32 s13, s65
    s_add_u32 m0, s72, 2048
    s_mov_b32 s33, 3153920
    buffer_load_dwordx4 v48, s[12:15], s33 offen lds
    buffer_load_dwordx4 v49, s[12:15], s33 offen offset:1024 lds
    ds_read2st64_b32 a[200:201], v52 offset0:16 offset1:20
    ds_read2st64_b32 a[202:203], v53 offset0:16 offset1:20
    ds_read2st64_b32 a[204:205], v54 offset0:16 offset1:20
    ds_read2st64_b32 a[206:207], v55 offset0:16 offset1:20
    s_waitcnt vmcnt(31)
    s_waitcnt lgkmcnt(0)
    s_barrier
    s_mov_b32 s12, s62
    s_mov_b32 s13, s63
    s_add_u32 m0, s72, 4096
    s_mov_b32 s33, 4325376
    buffer_load_dwordx4 v48, s[12:15], s33 offen lds
    buffer_load_dwordx4 v49, s[12:15], s33 offen offset:1024 lds
    ds_read2st64_b32 a[208:209], v52 offset0:24 offset1:28
    ds_read2st64_b32 a[210:211], v53 offset0:24 offset1:28
    ds_read2st64_b32 a[212:213], v54 offset0:24 offset1:28
    ds_read2st64_b32 a[214:215], v55 offset0:24 offset1:28
    s_waitcnt vmcnt(31)
    s_waitcnt lgkmcnt(0)
    s_barrier
    s_mov_b32 s12, s60
    s_mov_b32 s13, s61
    s_add_u32 m0, s72, 6144
    s_mov_b32 s33, 0
    buffer_load_dwordx4 v48, s[12:15], s33 offen lds
    buffer_load_dwordx4 v49, s[12:15], s33 offen offset:1024 lds
    ds_read2st64_b32 v[104:105], v52 offset0:32 offset1:36
    ds_read2st64_b32 v[106:107], v53 offset0:32 offset1:36
    ds_read2st64_b32 v[108:109], v54 offset0:32 offset1:36
    ds_read2st64_b32 v[110:111], v55 offset0:32 offset1:36
    s_waitcnt vmcnt(31)
    s_waitcnt lgkmcnt(0)
    s_barrier
    s_mov_b32 s12, s64
    s_mov_b32 s13, s65
    s_add_u32 m0, s72, 8192
    s_mov_b32 s33, 8192
    buffer_load_dwordx4 v48, s[12:15], s33 offen lds
    buffer_load_dwordx4 v49, s[12:15], s33 offen offset:1024 lds
    ds_read2st64_b32 v[128:129], v52 offset0:40 offset1:44
    ds_read2st64_b32 v[130:131], v53 offset0:40 offset1:44
    ds_read2st64_b32 v[132:133], v54 offset0:40 offset1:44
    ds_read2st64_b32 v[134:135], v55 offset0:40 offset1:44
    s_waitcnt vmcnt(31)
    s_waitcnt lgkmcnt(0)
    s_barrier
    s_mov_b32 s12, s62
    s_mov_b32 s13, s63
    s_add_u32 m0, s72, 10240
    s_mov_b32 s33, 1179648
    buffer_load_dwordx4 v48, s[12:15], s33 offen lds
    buffer_load_dwordx4 v49, s[12:15], s33 offen offset:1024 lds
    ds_read2st64_b32 v[168:169], v52 offset0:48 offset1:52
    ds_read2st64_b32 v[170:171], v53 offset0:48 offset1:52
    ds_read2st64_b32 v[172:173], v54 offset0:48 offset1:52
    ds_read2st64_b32 v[174:175], v55 offset0:48 offset1:52
    s_waitcnt vmcnt(31)
    s_waitcnt lgkmcnt(0)
    s_barrier
    s_mov_b32 s12, s60
    s_mov_b32 s13, s61
    s_add_u32 m0, s72, 12288
    s_mov_b32 s33, 2097152
    buffer_load_dwordx4 v48, s[12:15], s33 offen lds
    buffer_load_dwordx4 v49, s[12:15], s33 offen offset:1024 lds
    ds_read2st64_b32 v[184:185], v52 offset0:56 offset1:60
    ds_read2st64_b32 v[186:187], v53 offset0:56 offset1:60
    ds_read2st64_b32 v[188:189], v54 offset0:56 offset1:60
    ds_read2st64_b32 v[190:191], v55 offset0:56 offset1:60
    s_waitcnt vmcnt(30)
    s_waitcnt lgkmcnt(0)
    s_barrier
    s_mov_b32 s12, s62
    s_mov_b32 s13, s63
    s_add_u32 m0, s72, 14336
    s_mov_b32 s33, 3145728
    buffer_load_dwordx4 v48, s[12:15], s33 offen lds
    buffer_load_dwordx4 v49, s[12:15], s33 offen offset:1024 lds
    ds_read2st64_b32 v[200:201], v52 offset0:64 offset1:68
    ds_read2st64_b32 v[202:203], v53 offset0:64 offset1:68
    ds_read2st64_b32 v[204:205], v54 offset0:64 offset1:68
    ds_read2st64_b32 v[206:207], v55 offset0:64 offset1:68
    s_waitcnt vmcnt(30)
    s_waitcnt lgkmcnt(0)
    s_barrier
    s_mov_b32 s12, s60
    s_mov_b32 s13, s61
    s_add_u32 m0, s72, 16384
    s_mov_b32 s33, 4194304
    buffer_load_dwordx4 v48, s[12:15], s33 offen lds
    buffer_load_dwordx4 v49, s[12:15], s33 offen offset:1024 lds
    ds_read2st64_b32 v[240:241], v52 offset0:72 offset1:76
    ds_read2st64_b32 v[242:243], v53 offset0:72 offset1:76
    ds_read2st64_b32 v[244:245], v54 offset0:72 offset1:76
    ds_read2st64_b32 v[246:247], v55 offset0:72 offset1:76
    s_waitcnt vmcnt(30)
    s_waitcnt lgkmcnt(0)
    s_barrier
    s_mov_b32 s12, s64
    s_mov_b32 s13, s65
    s_add_u32 m0, s72, 18432
    s_mov_b32 s33, 4202496
    buffer_load_dwordx4 v48, s[12:15], s33 offen lds
    buffer_load_dwordx4 v49, s[12:15], s33 offen offset:1024 lds
    ds_read2st64_b32 a[216:217], v52 offset0:80 offset1:84
    ds_read2st64_b32 a[218:219], v53 offset0:80 offset1:84
    ds_read2st64_b32 a[220:221], v54 offset0:80 offset1:84
    ds_read2st64_b32 a[222:223], v55 offset0:80 offset1:84
    s_waitcnt vmcnt(30)
    s_waitcnt lgkmcnt(0)
    s_barrier
    s_mov_b32 s12, s62
    s_mov_b32 s13, s63
    s_add_u32 m0, s72, 20480
    s_mov_b32 s33, 131072
    buffer_load_dwordx4 v48, s[12:15], s33 offen lds
    buffer_load_dwordx4 v49, s[12:15], s33 offen offset:1024 lds
    ds_read2st64_b32 a[224:225], v52 offset0:88 offset1:92
    ds_read2st64_b32 a[226:227], v53 offset0:88 offset1:92
    ds_read2st64_b32 a[228:229], v54 offset0:88 offset1:92
    ds_read2st64_b32 a[230:231], v55 offset0:88 offset1:92
    s_waitcnt vmcnt(30)
    s_waitcnt lgkmcnt(0)
    s_barrier
    s_mov_b32 s12, s60
    s_mov_b32 s13, s61
    s_add_u32 m0, s72, 22528
    s_mov_b32 s33, 1048576
    buffer_load_dwordx4 v48, s[12:15], s33 offen lds
    buffer_load_dwordx4 v49, s[12:15], s33 offen offset:1024 lds
    ds_read2st64_b32 a[232:233], v52 offset0:96 offset1:100
    ds_read2st64_b32 a[234:235], v53 offset0:96 offset1:100
    ds_read2st64_b32 a[236:237], v54 offset0:96 offset1:100
    ds_read2st64_b32 a[238:239], v55 offset0:96 offset1:100
    s_waitcnt vmcnt(30)
    s_waitcnt lgkmcnt(0)
    s_barrier
    s_mov_b32 s12, s64
    s_mov_b32 s13, s65
    s_add_u32 m0, s72, 24576
    s_mov_b32 s33, 1056768
    buffer_load_dwordx4 v48, s[12:15], s33 offen lds
    buffer_load_dwordx4 v49, s[12:15], s33 offen offset:1024 lds
    ds_read2st64_b32 a[240:241], v52 offset0:104 offset1:108
    ds_read2st64_b32 a[242:243], v53 offset0:104 offset1:108
    ds_read2st64_b32 a[244:245], v54 offset0:104 offset1:108
    ds_read2st64_b32 a[246:247], v55 offset0:104 offset1:108
    s_waitcnt vmcnt(30)
    s_waitcnt lgkmcnt(0)
    s_barrier
    s_mov_b32 s12, s60
    s_mov_b32 s13, s61
    s_add_u32 m0, s72, 26624
    s_mov_b32 s33, 2105344
    buffer_load_dwordx4 v48, s[12:15], s33 offen lds
    buffer_load_dwordx4 v49, s[12:15], s33 offen offset:1024 lds
    ds_read2st64_b32 a[248:249], v52 offset0:112 offset1:116
    ds_read2st64_b32 a[250:251], v53 offset0:112 offset1:116
    ds_read2st64_b32 a[252:253], v54 offset0:112 offset1:116
    ds_read2st64_b32 a[254:255], v55 offset0:112 offset1:116
    s_waitcnt vmcnt(30)
    s_waitcnt lgkmcnt(0)
    s_barrier
    s_mov_b32 s12, s66
    s_mov_b32 s13, s67
    s_add_u32 m0, s72, 28672
    s_mov_b32 s33, 768
    buffer_load_dwordx4 v50, s[12:15], s33 offen lds
    buffer_load_dwordx4 v51, s[12:15], s33 offen offset:1024 lds
    ds_read2st64_b32 v[56:57], v52 offset0:120 offset1:124
    ds_read2st64_b32 v[58:59], v53 offset0:120 offset1:124
    ds_read2st64_b32 v[60:61], v54 offset0:120 offset1:124
    ds_read2st64_b32 v[62:63], v55 offset0:120 offset1:124
    s_waitcnt vmcnt(30)
    s_waitcnt lgkmcnt(0)
    s_barrier
    ds_write_b128 v4, v[56:59] offset:30720
    ds_write_b128 v4, v[60:63] offset:31744
    ds_read2st64_b32 v[12:13], v52 offset0:128 offset1:132
    ds_read2st64_b32 v[14:15], v53 offset0:128 offset1:132
    ds_read2st64_b32 v[16:17], v54 offset0:128 offset1:132
    ds_read2st64_b32 v[18:19], v55 offset0:128 offset1:132
    s_waitcnt vmcnt(28)
    s_waitcnt lgkmcnt(0)
    s_barrier
    ds_write_b128 v4, v[12:15] offset:32768
    ds_write_b128 v4, v[16:19] offset:33792
    ds_read2st64_b32 v[56:57], v52 offset0:0 offset1:4
    ds_read2st64_b32 v[58:59], v53 offset0:0 offset1:4
    ds_read2st64_b32 v[60:61], v54 offset0:0 offset1:4
    ds_read2st64_b32 v[62:63], v55 offset0:0 offset1:4
    s_waitcnt vmcnt(26)
    s_waitcnt lgkmcnt(0)
    s_barrier
    ds_write_b128 v4, v[56:59] offset:0
    ds_write_b128 v4, v[60:63] offset:1024
    ds_read2st64_b32 v[12:13], v52 offset0:8 offset1:12
    ds_read2st64_b32 v[14:15], v53 offset0:8 offset1:12
    ds_read2st64_b32 v[16:17], v54 offset0:8 offset1:12
    ds_read2st64_b32 v[18:19], v55 offset0:8 offset1:12
    s_waitcnt vmcnt(24)
    s_waitcnt lgkmcnt(0)
    s_barrier
    ds_write_b128 v4, v[12:15] offset:2048
    ds_write_b128 v4, v[16:19] offset:3072
    ds_read2st64_b32 v[56:57], v52 offset0:16 offset1:20
    ds_read2st64_b32 v[58:59], v53 offset0:16 offset1:20
    ds_read2st64_b32 v[60:61], v54 offset0:16 offset1:20
    ds_read2st64_b32 v[62:63], v55 offset0:16 offset1:20
    s_waitcnt vmcnt(22)
    s_waitcnt lgkmcnt(0)
    s_barrier
    ds_write_b128 v4, v[56:59] offset:4096
    ds_write_b128 v4, v[60:63] offset:5120
    ds_read2st64_b32 v[12:13], v52 offset0:24 offset1:28
    ds_read2st64_b32 v[14:15], v53 offset0:24 offset1:28
    ds_read2st64_b32 v[16:17], v54 offset0:24 offset1:28
    ds_read2st64_b32 v[18:19], v55 offset0:24 offset1:28
    s_waitcnt vmcnt(20)
    s_waitcnt lgkmcnt(0)
    s_barrier
    ds_write_b128 v4, v[12:15] offset:6144
    ds_write_b128 v4, v[16:19] offset:7168
    ds_read2st64_b32 v[56:57], v52 offset0:32 offset1:36
    ds_read2st64_b32 v[58:59], v53 offset0:32 offset1:36
    ds_read2st64_b32 v[60:61], v54 offset0:32 offset1:36
    ds_read2st64_b32 v[62:63], v55 offset0:32 offset1:36
    s_waitcnt vmcnt(18)
    s_waitcnt lgkmcnt(0)
    s_barrier
    ds_write_b128 v4, v[56:59] offset:8192
    ds_write_b128 v4, v[60:63] offset:9216
    ds_read2st64_b32 v[12:13], v52 offset0:40 offset1:44
    ds_read2st64_b32 v[14:15], v53 offset0:40 offset1:44
    ds_read2st64_b32 v[16:17], v54 offset0:40 offset1:44
    ds_read2st64_b32 v[18:19], v55 offset0:40 offset1:44
    s_waitcnt vmcnt(16)
    s_waitcnt lgkmcnt(0)
    s_barrier
    ds_write_b128 v4, v[12:15] offset:10240
    ds_write_b128 v4, v[16:19] offset:11264
    ds_read2st64_b32 v[56:57], v52 offset0:48 offset1:52
    ds_read2st64_b32 v[58:59], v53 offset0:48 offset1:52
    ds_read2st64_b32 v[60:61], v54 offset0:48 offset1:52
    ds_read2st64_b32 v[62:63], v55 offset0:48 offset1:52
    s_waitcnt vmcnt(14)
    s_waitcnt lgkmcnt(0)
    s_barrier
    ds_write_b128 v4, v[56:59] offset:12288
    ds_write_b128 v4, v[60:63] offset:13312
    ds_read2st64_b32 v[12:13], v52 offset0:56 offset1:60
    ds_read2st64_b32 v[14:15], v53 offset0:56 offset1:60
    ds_read2st64_b32 v[16:17], v54 offset0:56 offset1:60
    ds_read2st64_b32 v[18:19], v55 offset0:56 offset1:60
    s_waitcnt vmcnt(12)
    s_waitcnt lgkmcnt(0)
    s_barrier
    ds_write_b128 v4, v[12:15] offset:14336
    ds_write_b128 v4, v[16:19] offset:15360
    ds_read2st64_b32 v[56:57], v52 offset0:64 offset1:68
    ds_read2st64_b32 v[58:59], v53 offset0:64 offset1:68
    ds_read2st64_b32 v[60:61], v54 offset0:64 offset1:68
    ds_read2st64_b32 v[62:63], v55 offset0:64 offset1:68
    s_waitcnt vmcnt(10)
    s_waitcnt lgkmcnt(0)
    s_barrier
    ds_write_b128 v4, v[56:59] offset:16384
    ds_write_b128 v4, v[60:63] offset:17408
    ds_read2st64_b32 v[12:13], v52 offset0:72 offset1:76
    ds_read2st64_b32 v[14:15], v53 offset0:72 offset1:76
    ds_read2st64_b32 v[16:17], v54 offset0:72 offset1:76
    ds_read2st64_b32 v[18:19], v55 offset0:72 offset1:76
    s_waitcnt vmcnt(8)
    s_waitcnt lgkmcnt(0)
    s_barrier
    ds_write_b128 v4, v[12:15] offset:18432
    ds_write_b128 v4, v[16:19] offset:19456
    ds_read2st64_b32 v[56:57], v52 offset0:80 offset1:84
    ds_read2st64_b32 v[58:59], v53 offset0:80 offset1:84
    ds_read2st64_b32 v[60:61], v54 offset0:80 offset1:84
    ds_read2st64_b32 v[62:63], v55 offset0:80 offset1:84
    buffer_load_dwordx2 v[8:9], off, s[8:11], 0 offset:32 sc1
    buffer_load_dword v10, off, s[8:11], 0 offset:112 sc1
    s_waitcnt vmcnt(8)
    s_waitcnt lgkmcnt(0)
    s_barrier
    ds_write_b128 v4, v[56:59] offset:20480
    ds_write_b128 v4, v[60:63] offset:21504
    ds_read2st64_b32 v[12:13], v52 offset0:88 offset1:92
    ds_read2st64_b32 v[14:15], v53 offset0:88 offset1:92
    ds_read2st64_b32 v[16:17], v54 offset0:88 offset1:92
    ds_read2st64_b32 v[18:19], v55 offset0:88 offset1:92
    s_waitcnt vmcnt(6)
    s_waitcnt lgkmcnt(0)
    s_barrier
    ds_write_b128 v4, v[12:15] offset:22528
    ds_write_b128 v4, v[16:19] offset:23552
    ds_read2st64_b32 v[56:57], v52 offset0:96 offset1:100
    ds_read2st64_b32 v[58:59], v53 offset0:96 offset1:100
    ds_read2st64_b32 v[60:61], v54 offset0:96 offset1:100
    ds_read2st64_b32 v[62:63], v55 offset0:96 offset1:100
    s_waitcnt vmcnt(4)
    s_waitcnt lgkmcnt(0)
    s_barrier
    ds_write_b128 v4, v[56:59] offset:24576
    ds_write_b128 v4, v[60:63] offset:25600
    ds_read2st64_b32 v[12:13], v52 offset0:104 offset1:108
    ds_read2st64_b32 v[14:15], v53 offset0:104 offset1:108
    ds_read2st64_b32 v[16:17], v54 offset0:104 offset1:108
    ds_read2st64_b32 v[18:19], v55 offset0:104 offset1:108
    s_waitcnt vmcnt(2)
    s_waitcnt lgkmcnt(0)
    s_barrier
    ds_write_b128 v4, v[12:15] offset:26624
    ds_write_b128 v4, v[16:19] offset:27648
    ds_read2st64_b32 v[56:57], v52 offset0:112 offset1:116
    ds_read2st64_b32 v[58:59], v53 offset0:112 offset1:116
    ds_read2st64_b32 v[60:61], v54 offset0:112 offset1:116
    ds_read2st64_b32 v[62:63], v55 offset0:112 offset1:116
    s_waitcnt vmcnt(1)
    v_readfirstlane_b32 s70, v8
    s_waitcnt vmcnt(0)
    v_readfirstlane_b32 s71, v10
    v_readfirstlane_b32 s60, v9
    s_lshl_b32 s71, s71, 16
    s_or_b32 s70, s70, s71
    s_cmp_eq_u32 s60, 0
    s_cselect_b32 s70, 0, s70
    s_cmp_eq_u32 s70, 2097216
    s_cbranch_scc0 L_rdy1
L_rdy1_ok:
    buffer_load_dwordx4 v[64:67], v0, s[4:7], s30 offen offset:0 sc1
    buffer_load_dwordx4 v[68:71], v0, s[4:7], s30 offen offset:1024 sc1
    s_add_u32 s30, s30, 524288
    s_sub_u32 s60, s60, 1
    s_lshl_b32 s60, s60, 13
    s_add_u32 s26, s26, s60
    s_add_u32 s23, s23, s60
    s_add_u32 s24, s24, s60
    s_waitcnt lgkmcnt(0)
    s_barrier
    ds_write_b128 v4, v[56:59] offset:28672
    ds_write_b128 v4, v[60:63] offset:29696
    s_waitcnt lgkmcnt(0)
    ds_read_b128 v[48:51], v4 offset:0
    ds_read_b128 v[52:55], v4 offset:1024
    ds_read_b128 v[56:59], v4 offset:14336
    ds_read_b128 v[60:63], v4 offset:15360
    v_mov_b64 v[28:29], 0
    v_mov_b64 v[30:31], 0
    v_mov_b64 v[32:33], 0
    v_mov_b64 v[34:35], 0
    v_mov_b64 v[36:37], 0
    v_mov_b64 v[38:39], 0
    s_mov_b32 s18, 0
    s_mov_b32 s19, 0
    s_mov_b32 s35, 1
    s_waitcnt lgkmcnt(0)
    s_waitcnt vmcnt(0)
    s_barrier
    s_cmp_eq_u32 s17, 0
    s_cbranch_scc1 L_ch1_w0
    s_cmp_eq_u32 s17, 1
    s_cbranch_scc1 L_ch1_w1
    s_cmp_eq_u32 s17, 2
    s_cbranch_scc1 L_ch1_w2
    s_branch L_ch1_w3
L_rdy1:
    s_add_u32 s19, s19, 1
    s_cmp_gt_u32 s19, 3000000
    s_cbranch_scc1 L_cend1
    s_sleep 8
    buffer_load_dwordx2 v[8:9], off, s[8:11], 0 offset:32 sc1
    buffer_load_dword v10, off, s[8:11], 0 offset:112 sc1
    s_waitcnt vmcnt(0)
    v_readfirstlane_b32 s70, v8
    v_readfirstlane_b32 s71, v10
    v_readfirstlane_b32 s60, v9
    s_lshl_b32 s71, s71, 16
    s_or_b32 s70, s70, s71
    s_cmp_eq_u32 s60, 0
    s_cselect_b32 s70, 0, s70
    s_cmp_eq_u32 s70, 2097216
    s_cbranch_scc0 L_rdy1
    s_branch L_rdy1_ok
    .p2align 6
L_ch1_w0:
    ds_read_b128 v[12:15], v3 offset:6144
    s_waitcnt vmcnt(2)
    ds_read_b128 v[16:19], v3 offset:6176
    s_waitcnt lgkmcnt(1)
    v_smfmac_f32_16x16x64_bf16 v[28:31], v[12:15], v[48:55], v1
    ds_read_b128 v[20:23], v3 offset:7168
    v_smfmac_f32_16x16x64_bf16 v[32:35], v[12:15], v[56:63], v1
    ds_read_b128 v[48:51], v4 offset:2048
    v_smfmac_f32_16x16x64_bf16 v[36:39], v[12:15], v[104:111], v1
    ds_read_b128 v[24:27], v3 offset:7200
    s_waitcnt lgkmcnt(3)
    v_smfmac_f32_16x16x64_bf16 v[28:31], v[16:19], v[112:119], v1
    ds_read_b128 v[52:55], v4 offset:3072
    v_smfmac_f32_16x16x64_bf16 v[32:35], v[16:19], v[120:127], v1
    ds_read_b128 v[56:59], v4 offset:16384
    v_smfmac_f32_16x16x64_bf16 v[36:39], v[16:19], v[128:135], v1
    ds_read_b128 v[12:15], v3 offset:8192
    s_waitcnt lgkmcnt(5)
    v_smfmac_f32_16x16x64_bf16 v[28:31], v[20:23], v[136:143], v1
    ds_read_b128 v[60:63], v4 offset:17408
    v_smfmac_f32_16x16x64_bf16 v[32:35], v[20:23], v[144:151], v1
    s_waitcnt lgkmcnt(3)
    v_smfmac_f32_16x16x64_bf16 v[36:39], v[20:23], v[48:55], v1
    ds_read_b128 v[16:19], v3 offset:8224
    v_smfmac_f32_16x16x64_bf16 v[28:31], v[24:27], v[152:159], v1
    ds_read_b128 v[48:51], v4 offset:4096
    v_smfmac_f32_16x16x64_bf16 v[32:35], v[24:27], v[160:167], v1
    ds_read_b128 v[52:55], v4 offset:5120
    v_smfmac_f32_16x16x64_bf16 v[36:39], v[24:27], v[168:175], v1
    ds_read_b128 v[20:23], v3 offset:9216
    s_waitcnt lgkmcnt(4)
    v_smfmac_f32_16x16x64_bf16 v[28:31], v[12:15], v[56:63], v1
    s_waitcnt vmcnt(1)
    ds_write_b128 v0, v[40:43] offset:0
    v_bitop3_b32 v8, v40, v41, v42 bitop3:0x80
    v_smfmac_f32_16x16x64_bf16 v[32:35], v[12:15], v[176:183], v1
    s_waitcnt vmcnt(0)
    ds_write_b128 v0, v[44:47] offset:4096
    v_bitop3_b32 v8, v8, v43, v44 bitop3:0x80
    v_smfmac_f32_16x16x64_bf16 v[36:39], v[12:15], v[184:191], v1
    ds_read_b128 v[24:27], v3 offset:9248
    v_bitop3_b32 v8, v8, v45, v46 bitop3:0x80
    s_waitcnt lgkmcnt(6)
    v_smfmac_f32_16x16x64_bf16 v[28:31], v[16:19], v[192:199], v1
    ds_read_b128 v[56:59], v4 offset:18432
    v_and_b32 v8, v8, v47
    s_waitcnt lgkmcnt(5)
    v_smfmac_f32_16x16x64_bf16 v[32:35], v[16:19], v[48:55], v1
    ds_read_b128 v[60:63], v4 offset:19456
    v_and_or_b32 v8, v8, 1, s35
    v_smfmac_f32_16x16x64_bf16 v[36:39], v[16:19], v[200:207], v1
    ds_read_b128 v[48:51], v4 offset:6144
    v_cmp_ne_u32 vcc, 1, v8
    s_waitcnt lgkmcnt(6)
    v_smfmac_f32_16x16x64_bf16 v[28:31], v[20:23], v[208:215], v1
    ds_read_b128 v[52:55], v4 offset:7168
    s_nop 0
    v_smfmac_f32_16x16x64_bf16 v[32:35], v[20:23], v[216:223], v1
    s_cbranch_vccnz L_c2_L_ch10e_r
L_c2_L_ch10e:
    s_waitcnt lgkmcnt(5)
    s_barrier
    s_mov_b64 vcc, s[36:37]
    s_mov_b32 s35, 0
    s_waitcnt lgkmcnt(2)
    v_smfmac_f32_16x16x64_bf16 v[36:39], v[20:23], v[56:63], v1
    ds_read_b128 v[12:15], v3 offset:0
    v_cndmask_b32 v40, 0, v2, s[38:39]
    v_smfmac_f32_16x16x64_bf16 v[28:31], v[24:27], v[224:231], v1
    ds_read_b128 v[16:19], v3 offset:32
    buffer_store_dwordx4 v[96:99], v0, s[4:7], s31 offen sc1
    s_add_u32 s31, s31, 131072
    v_cndmask_b32 v41, 0, v2, s[40:41]
    v_smfmac_f32_16x16x64_bf16 v[32:35], v[24:27], v[232:239], v1
    ds_read_b128 v[56:59], v4 offset:20480
    v_smfmac_f32_16x16x64_bf16 v[36:39], v[24:27], v[240:247], v1
    ds_read_b128 v[20:23], v3 offset:1024
    buffer_load_dwordx4 v[72:75], v0, s[4:7], s27 offen offset:2048 sc1
    s_waitcnt lgkmcnt(3)
    v_smfmac_f32_16x16x64_bf16 v[28:31], v[12:15], v[48:55], v1
    ds_read_b128 v[60:63], v4 offset:21504
    v_smfmac_f32_16x16x64_bf16 v[32:35], v[12:15], v[248:255], v1
    ds_read_b128 v[48:51], v4 offset:8192
    buffer_load_dwordx4 v[76:79], v0, s[4:7], s27 offen offset:3072 sc1
    v_smfmac_f32_16x16x64_bf16 v[36:39], v[12:15], a[0:7], v1
    ds_read_b128 v[24:27], v3 offset:1056
    s_waitcnt lgkmcnt(5)
    v_smfmac_f32_16x16x64_bf16 v[28:31], v[16:19], a[8:15], v1
    ds_read_b128 v[52:55], v4 offset:9216
    s_waitcnt lgkmcnt(3)
    v_smfmac_f32_16x16x64_bf16 v[32:35], v[16:19], v[56:63], v1
    ds_read_b128 v[56:59], v4 offset:22528
    v_smfmac_f32_16x16x64_bf16 v[36:39], v[16:19], a[16:23], v1
    ds_read_b128 v[12:15], v3 offset:2048
    v_smfmac_f32_16x16x64_bf16 v[28:31], v[20:23], a[24:31], v1
    ds_read_b128 v[60:63], v4 offset:23552
    v_smfmac_f32_16x16x64_bf16 v[32:35], v[20:23], a[32:39], v1
    s_waitcnt lgkmcnt(3)
    v_smfmac_f32_16x16x64_bf16 v[36:39], v[20:23], v[48:55], v1
    ds_read_b128 v[16:19], v3 offset:2080
    v_smfmac_f32_16x16x64_bf16 v[28:31], v[24:27], a[40:47], v1
    ds_read_b128 v[48:51], v4 offset:10240
    v_smfmac_f32_16x16x64_bf16 v[32:35], v[24:27], a[48:55], v1
    ds_read_b128 v[52:55], v4 offset:11264
    v_smfmac_f32_16x16x64_bf16 v[36:39], v[24:27], a[56:63], v1
    ds_read_b128 v[20:23], v3 offset:3072
    s_waitcnt lgkmcnt(4)
    v_smfmac_f32_16x16x64_bf16 v[28:31], v[12:15], v[56:63], v1
    ds_read_b128 v[56:59], v4 offset:24576
    v_smfmac_f32_16x16x64_bf16 v[32:35], v[12:15], a[64:71], v1
    ds_read_b128 v[60:63], v4 offset:25600
    v_smfmac_f32_16x16x64_bf16 v[36:39], v[12:15], a[72:79], v1
    ds_read_b128 v[24:27], v3 offset:3104
    s_waitcnt lgkmcnt(6)
    v_smfmac_f32_16x16x64_bf16 v[28:31], v[16:19], a[80:87], v1
    s_waitcnt lgkmcnt(4)
    v_smfmac_f32_16x16x64_bf16 v[32:35], v[16:19], v[48:55], v1
    ds_read_b128 v[48:51], v4 offset:12288
    v_smfmac_f32_16x16x64_bf16 v[36:39], v[16:19], a[88:95], v1
    ds_read_b128 v[12:15], v3 offset:4096
    s_waitcnt lgkmcnt(5)
    v_smfmac_f32_16x16x64_bf16 v[28:31], v[20:23], a[96:103], v1
    ds_read_b128 v[52:55], v4 offset:13312
    v_smfmac_f32_16x16x64_bf16 v[32:35], v[20:23], a[104:111], v1
    ds_read_b128 v[16:19], v3 offset:4128
    s_waitcnt lgkmcnt(5)
    v_smfmac_f32_16x16x64_bf16 v[36:39], v[20:23], v[56:63], v1
    ds_read_b128 v[56:59], v4 offset:26624
    s_waitcnt lgkmcnt(5)
    v_smfmac_f32_16x16x64_bf16 v[28:31], v[24:27], a[112:119], v1
    ds_read_b128 v[20:23], v3 offset:5120
    v_smfmac_f32_16x16x64_bf16 v[32:35], v[24:27], a[120:127], v1
    ds_read_b128 v[60:63], v4 offset:27648
    v_smfmac_f32_16x16x64_bf16 v[36:39], v[24:27], a[128:135], v1
    ds_read_b128 v[24:27], v3 offset:5152
    s_waitcnt lgkmcnt(5)
    v_smfmac_f32_16x16x64_bf16 v[28:31], v[12:15], v[48:55], v1
    v_smfmac_f32_16x16x64_bf16 v[32:35], v[12:15], a[136:143], v1
    s_waitcnt lgkmcnt(4)
    v_smfmac_f32_16x16x64_bf16 v[28:31], v[16:19], a[144:151], v1
    v_smfmac_f32_16x16x64_bf16 v[32:35], v[16:19], a[152:159], v1
    s_waitcnt lgkmcnt(1)
    v_smfmac_f32_16x16x64_bf16 v[28:31], v[20:23], v[56:63], v1
    v_smfmac_f32_16x16x64_bf16 v[32:35], v[20:23], a[160:167], v1
    s_waitcnt lgkmcnt(0)
    v_smfmac_f32_16x16x64_bf16 v[28:31], v[24:27], a[168:175], v1
    v_smfmac_f32_16x16x64_bf16 v[32:35], v[24:27], a[176:183], v1
    v_smfmac_f32_16x16x64_bf16 v[36:39], v[12:15], a[184:191], v1
    v_smfmac_f32_16x16x64_bf16 v[36:39], v[16:19], a[192:199], v1
    v_cvt_pk_bf16_f32 v44, v28, v29
    v_cvt_pk_bf16_f32 v45, v32, v33
    v_cvt_pk_bf16_f32 v46, v30, v31
    v_cvt_pk_bf16_f32 v47, v34, v35
    v_mfma_f32_16x16x16_bf16 v[28:31], v[44:45], v[40:41], 0
    v_mfma_f32_16x16x16_bf16 v[32:35], v[46:47], v[40:41], 0
    v_smfmac_f32_16x16x64_bf16 v[36:39], v[20:23], a[200:207], v1
    s_nop 3
    v_cvt_pk_bf16_f32 v44, v28, v32
    v_cvt_pk_bf16_f32 v45, v29, v33
    v_cvt_pk_bf16_f32 v46, v30, v34
    v_cvt_pk_bf16_f32 v47, v31, v35
    s_nop 1
    v_mfma_f32_16x16x32_bf16 v[32:35], v[68:71], v[44:47], 0
    v_mfma_f32_16x16x32_bf16 v[28:31], v[64:67], v[44:47], 0
    v_mfma_f32_16x16x32_bf16 v[12:15], v[44:47], v[44:47], 0
    v_smfmac_f32_16x16x64_bf16 v[36:39], v[24:27], a[208:215], v1
    v_cndmask_b32_dpp v28, v32, v28, vcc quad_perm:[2,3,2,3] row_mask:0xf bank_mask:0xf
    v_cndmask_b32_dpp v29, v33, v29, vcc quad_perm:[2,3,2,3] row_mask:0xf bank_mask:0xf
    v_cndmask_b32_dpp v30, v34, v30, vcc quad_perm:[2,3,2,3] row_mask:0xf bank_mask:0xf
    v_cndmask_b32_dpp v31, v35, v31, vcc quad_perm:[2,3,2,3] row_mask:0xf bank_mask:0xf
    ds_write_b128 v0, v[28:31] offset:10240
    v_cndmask_b32_dpp v11, v13, v12, vcc quad_perm:[2,3,2,3] row_mask:0xf bank_mask:0xf
    ds_write_b32 v0, v11 offset:14336
    buffer_load_dwordx4 v[64:67], v0, s[4:7], s30 offen offset:0 sc1
    buffer_load_dwordx4 v[68:71], v0, s[4:7], s30 offen offset:1024 sc1
    s_waitcnt lgkmcnt(0)
    s_barrier
    ds_read_b128 v[24:27], v0 offset:14336
    ds_read_b128 v[28:31], v0 offset:10240
    ds_read_b128 v[32:35], v0 offset:11264
    ds_read_b128 v[16:19], v0 offset:12288
    ds_read_b128 v[20:23], v0 offset:13312
    v_cvt_pk_bf16_f32 v42, v36, v37
    v_cvt_pk_bf16_f32 v43, v38, v39
    v_mov_b32 v13, 0
    v_mov_b32 v14, 0
    s_waitcnt lgkmcnt(4)
    v_pk_add_f32 v[24:25], v[24:25], v[26:27]
    v_add_f32 v24, v24, v25
    v_mul_f32 v40, s20, v24
    s_waitcnt lgkmcnt(3)
    v_pk_mul_f32 v[28:29], v[28:29], s[48:49]
    v_pk_mul_f32 v[30:31], v[30:31], s[48:49]
    v_exp_f32 v11, v40
    s_waitcnt lgkmcnt(2)
    v_pk_fma_f32 v[28:29], v[32:33], s[48:49], v[28:29]
    v_pk_fma_f32 v[30:31], v[34:35], s[48:49], v[30:31]
    s_waitcnt lgkmcnt(1)
    v_pk_fma_f32 v[28:29], v[16:17], s[48:49], v[28:29]
    v_pk_fma_f32 v[30:31], v[18:19], s[48:49], v[30:31]
    s_waitcnt lgkmcnt(0)
    v_pk_fma_f32 v[28:29], v[20:21], s[48:49], v[28:29]
    v_pk_fma_f32 v[30:31], v[22:23], s[48:49], v[30:31]
    v_mov_b32_dpp v9, v11 quad_perm:[0,1,0,1] row_mask:0xf bank_mask:0xf
    v_exp_f32 v16, v28
    v_exp_f32 v17, v29
    v_cvt_pk_bf16_f32 v12, v11, v9
    v_cvt_pk_bf16_f32 v15, v11, v9
    v_cvt_pk_bf16_f32 v32, v16, v17
    v_exp_f32 v18, v30
    v_mfma_f32_16x16x16_bf16 v[20:23], v[42:43], v[12:13], 0
    ds_read_b128 v[48:51], v4 offset:28672
    v_exp_f32 v19, v31
    v_mov_b32_dpp v34, v32 quad_perm:[0,1,0,1] row_mask:0xf bank_mask:0xf
    v_cvt_pk_bf16_f32 v33, v18, v19
    v_mfma_f32_16x16x16_bf16 v[24:27], v[42:43], v[14:15], 0
    ds_read_b128 v[52:55], v4 offset:29696
    v_add_f32 v8, v16, v17
    v_mov_b32_dpp v35, v33 quad_perm:[0,1,0,1] row_mask:0xf bank_mask:0xf
    v_add_f32 v10, v18, v19
    v_add_f32 v8, v8, v11
    s_waitcnt vmcnt(3)
    v_mfma_f32_16x16x32_bf16 v[20:23], v[72:75], v[32:35], v[20:23]
    ds_read_b128 v[56:59], v4 offset:30720
    v_add_f32 v8, v8, v10
    s_waitcnt vmcnt(2)
    v_mfma_f32_16x16x32_bf16 v[24:27], v[76:79], v[32:35], v[24:27]
    ds_read_b128 v[60:63], v4 offset:31744
    v_add_f32_dpp v9, v8, v8 quad_perm:[2,3,0,1] row_mask:0xf bank_mask:0xf
    v_add_f32_dpp v10, v8, v8 quad_perm:[2,3,0,1] row_mask:0xf bank_mask:0xf
    s_nop 1
    v_permlane16_swap_b32 v9, v10
    v_add_f32 v8, v9, v10
    v_add_f32 v9, v9, v10
    s_nop 1
    v_permlane32_swap_b32 v8, v9
    v_add_f32 v8, v8, v9
    v_rcp_f32 v10, v8
    v_subrev_u32 v8, s47, v8
    v_cmp_le_u32 s[44:45], s50, v8
    v_pk_mul_f32 v[20:21], v[20:21], v[10:11] op_sel_hi:[1,0]
    v_pk_mul_f32 v[22:23], v[22:23], v[10:11] op_sel_hi:[1,0]
    v_pk_mul_f32 v[24:25], v[24:25], v[10:11] op_sel_hi:[1,0]
    v_pk_mul_f32 v[26:27], v[26:27], v[10:11] op_sel_hi:[1,0]
    v_cvt_pk_bf16_f32 v32, v20, v24
    v_cvt_pk_bf16_f32 v33, v21, v25
    v_cvt_pk_bf16_f32 v34, v22, v26
    v_cvt_pk_bf16_f32 v35, v23, v27
    s_cmp_lg_u64 s[44:45], 0
    s_cbranch_scc1 L_sm_L_ch10e_r
L_sm_L_ch10e:
    s_mov_b64 exec, s[36:37]
    ds_write_b128 v3, v[32:35] offset:0
    s_mov_b64 exec, -1
    v_mov_b64 v[36:37], 0
    v_mov_b64 v[38:39], 0
    v_mov_b64 v[28:29], 0
    v_mov_b64 v[30:31], 0
    s_waitcnt lgkmcnt(0)
    s_barrier
    ds_read_b128 v[12:15], v3 offset:0
    ds_read_b128 v[16:19], v3 offset:32
    ds_read_b128 v[20:23], v3 offset:1024
    ds_read_b128 v[24:27], v3 offset:1056
    s_waitcnt lgkmcnt(3)
    v_smfmac_f32_16x16x64_bf16 v[36:39], v[12:15], v[48:55], v1
    ds_read_b128 v[72:75], v4 offset:32768
    s_waitcnt lgkmcnt(3)
    v_smfmac_f32_16x16x64_bf16 v[36:39], v[16:19], v[56:63], v1
    ds_read_b128 v[76:79], v4 offset:33792
    s_waitcnt lgkmcnt(3)
    v_smfmac_f32_16x16x64_bf16 v[36:39], v[20:23], a[216:223], v1
    s_waitcnt lgkmcnt(2)
    v_smfmac_f32_16x16x64_bf16 v[36:39], v[24:27], a[224:231], v1
    v_smfmac_f32_16x16x64_bf16 v[28:31], v[12:15], a[232:239], v1
    v_smfmac_f32_16x16x64_bf16 v[28:31], v[16:19], a[240:247], v1
    v_cvt_pk_bf16_f32 v36, v36, v37
    s_waitcnt lgkmcnt(0)
    v_smfmac_f32_16x16x64_bf16 v[28:31], v[20:23], v[72:79], v1
    v_and_b32 v36, -2, v36
    v_smfmac_f32_16x16x64_bf16 v[28:31], v[24:27], a[248:255], v1
    buffer_store_dword v36, v5, s[4:7], s28 offen
    v_cvt_pk_bf16_f32 v37, v38, v39
    v_and_b32 v37, -2, v37
    buffer_store_dword v37, v5, s[4:7], s29 offen
    s_nop 2
    v_cvt_pk_bf16_f32 v28, v28, v29
    v_cvt_pk_bf16_f32 v29, v30, v31
    v_and_b32 v28, -2, v28
    v_and_b32 v29, -2, v29
    buffer_store_dword v28, v5, s[4:7], s46 offen
    buffer_store_dword v29, v5, s[4:7], s73 offen
    ds_read_b128 v[48:51], v4 offset:0
    ds_read_b128 v[52:55], v4 offset:1024
    ds_read_b128 v[56:59], v4 offset:14336
    ds_read_b128 v[60:63], v4 offset:15360
    v_mov_b32_dpp v9, v42 quad_perm:[0,1,0,1] row_mask:0xf bank_mask:0xf
    v_mov_b32_dpp v10, v43 quad_perm:[0,1,0,1] row_mask:0xf bank_mask:0xf
    v_cndmask_b32 v96, v44, v42, vcc
    v_cndmask_b32 v97, v45, v43, vcc
    v_cndmask_b32 v98, v46, v9, vcc
    v_cndmask_b32 v99, v47, v10, vcc
    v_cndmask_b32 v20, 0, v2, s[42:43]
    v_cndmask_b32 v21, 0, v2, s[42:43]
    v_cndmask_b32 v22, 0, v2, s[42:43]
    v_cndmask_b32 v23, 0, v2, s[42:43]
    s_nop 9
    buffer_load_dword v12, v7, s[4:7], s21 offen offset:0 sc1
    buffer_load_dword v13, v7, s[4:7], s21 offen offset:256 sc1
    buffer_load_dword v14, v7, s[4:7], s21 offen offset:512 sc1
    buffer_load_dword v15, v7, s[4:7], s21 offen offset:768 sc1
    buffer_load_dword v16, v7, s[4:7], s21 offen offset:1024 sc1
    buffer_load_dword v17, v7, s[4:7], s21 offen offset:1280 sc1
    buffer_load_dword v18, v7, s[4:7], s21 offen offset:1536 sc1
    buffer_load_dword v19, v7, s[4:7], s21 offen offset:1792 sc1
    v_mov_b64 v[36:37], 0
    v_mov_b64 v[38:39], 0
    v_mov_b64 v[28:29], 0
    v_mov_b64 v[30:31], 0
    s_add_u32 s26, s26, 32768
    s_add_u32 s23, s23, 32768
    s_add_u32 s24, s24, 32768
    s_add_u32 s30, s30, 524288
    s_add_u32 s27, s27, 524288
    s_nop 14
    buffer_load_dword v40, v7, s[4:7], s21 offen offset:0 sc1
    buffer_load_dword v41, v7, s[4:7], s21 offen offset:256 sc1
    buffer_load_dword v42, v7, s[4:7], s21 offen offset:512 sc1
    buffer_load_dword v43, v7, s[4:7], s21 offen offset:768 sc1
    buffer_load_dword v44, v7, s[4:7], s21 offen offset:1024 sc1
    buffer_load_dword v45, v7, s[4:7], s21 offen offset:1280 sc1
    buffer_load_dword v46, v7, s[4:7], s21 offen offset:1536 sc1
    buffer_load_dword v47, v7, s[4:7], s21 offen offset:1792 sc1
    s_waitcnt vmcnt(12)
    v_mfma_f32_16x16x32_bf16 v[32:35], v[12:15], v[20:23], 0
    v_or3_b32 v8, v12, v13, v14
    s_waitcnt vmcnt(8)
    v_mfma_f32_16x16x32_bf16 v[32:35], v[16:19], v[20:23], v[32:35]
    v_or3_b32 v8, v8, v15, v16
    v_or3_b32 v8, v8, v17, v18
    v_or_b32 v8, v8, v19
    v_and_b32 v8, 1, v8
    v_cmp_ne_u32 vcc, 0, v8
    s_nop 1
    v_cvt_pk_bf16_f32 v10, v32, v33
    v_cvt_pk_bf16_f32 v11, v34, v35
    v_and_b32 v10, -2, v10
    v_and_b32 v11, -2, v11
    s_cbranch_vccnz L_c1_L_ch10e_r
L_c1_L_ch10e:
    buffer_store_dwordx2 v[10:11], v6, s[4:7], s25 offen
    s_barrier
    buffer_store_dwordx2 v[10:11], v6, s[4:7], s26 offen sc1
    s_add_u32 s18, s18, 1
    v_mov_b64 v[32:33], 0
    v_mov_b64 v[34:35], 0
    s_nop 15
    s_nop 15
    s_nop 15
    s_nop 6
    buffer_load_dwordx4 v[24:27], v0, s[4:7], s22 offen sc1
    s_nop 15
    s_nop 3
    buffer_load_dwordx4 v[16:19], v0, s[4:7], s22 offen sc1
    s_waitcnt vmcnt(1)
    v_or3_b32 v8, v24, v25, v26
    v_or_b32 v8, v8, v27
    v_and_b32 v8, 1, v8
    v_cmp_ne_u32 vcc, 0, v8
    ds_write_b128 v0, v[24:27] offset:6144
    s_cbranch_vccnz L_c3_L_ch10e_r
L_c3_L_ch10e:
    buffer_load_dwordx4 v[40:43], v0, s[4:7], s23 offen sc1
    buffer_load_dwordx4 v[44:47], v0, s[4:7], s24 offen sc1
    s_waitcnt lgkmcnt(0)
    s_barrier
    ds_read_b128 v[12:15], v3 offset:6144
    s_waitcnt vmcnt(2)
    ds_read_b128 v[16:19], v3 offset:6176
    s_waitcnt lgkmcnt(1)
    v_smfmac_f32_16x16x64_bf16 v[28:31], v[12:15], v[48:55], v1
    ds_read_b128 v[20:23], v3 offset:7168
    v_smfmac_f32_16x16x64_bf16 v[32:35], v[12:15], v[56:63], v1
    ds_read_b128 v[48:51], v4 offset:2048
    v_smfmac_f32_16x16x64_bf16 v[36:39], v[12:15], v[104:111], v1
    ds_read_b128 v[24:27], v3 offset:7200
    s_waitcnt lgkmcnt(3)
    v_smfmac_f32_16x16x64_bf16 v[28:31], v[16:19], v[112:119], v1
    ds_read_b128 v[52:55], v4 offset:3072
    v_smfmac_f32_16x16x64_bf16 v[32:35], v[16:19], v[120:127], v1
    ds_read_b128 v[56:59], v4 offset:16384
    v_smfmac_f32_16x16x64_bf16 v[36:39], v[16:19], v[128:135], v1
    ds_read_b128 v[12:15], v3 offset:8192
    s_waitcnt lgkmcnt(5)
    v_smfmac_f32_16x16x64_bf16 v[28:31], v[20:23], v[136:143], v1
    ds_read_b128 v[60:63], v4 offset:17408
    v_smfmac_f32_16x16x64_bf16 v[32:35], v[20:23], v[144:151], v1
    s_waitcnt lgkmcnt(3)
    v_smfmac_f32_16x16x64_bf16 v[36:39], v[20:23], v[48:55], v1
    ds_read_b128 v[16:19], v3 offset:8224
    v_smfmac_f32_16x16x64_bf16 v[28:31], v[24:27], v[152:159], v1
    ds_read_b128 v[48:51], v4 offset:4096
    v_smfmac_f32_16x16x64_bf16 v[32:35], v[24:27], v[160:167], v1
    ds_read_b128 v[52:55], v4 offset:5120
    v_smfmac_f32_16x16x64_bf16 v[36:39], v[24:27], v[168:175], v1
    ds_read_b128 v[20:23], v3 offset:9216
    s_waitcnt lgkmcnt(4)
    v_smfmac_f32_16x16x64_bf16 v[28:31], v[12:15], v[56:63], v1
    s_waitcnt vmcnt(1)
    ds_write_b128 v0, v[40:43] offset:0
    v_or3_b32 v8, v40, v41, v42
    v_smfmac_f32_16x16x64_bf16 v[32:35], v[12:15], v[176:183], v1
    s_waitcnt vmcnt(0)
    ds_write_b128 v0, v[44:47] offset:4096
    v_or3_b32 v8, v8, v43, v44
    v_smfmac_f32_16x16x64_bf16 v[36:39], v[12:15], v[184:191], v1
    ds_read_b128 v[24:27], v3 offset:9248
    v_or3_b32 v8, v8, v45, v46
    s_waitcnt lgkmcnt(6)
    v_smfmac_f32_16x16x64_bf16 v[28:31], v[16:19], v[192:199], v1
    ds_read_b128 v[56:59], v4 offset:18432
    v_or_b32 v8, v8, v47
    s_waitcnt lgkmcnt(5)
    v_smfmac_f32_16x16x64_bf16 v[32:35], v[16:19], v[48:55], v1
    ds_read_b128 v[60:63], v4 offset:19456
    v_and_b32 v8, 1, v8
    v_smfmac_f32_16x16x64_bf16 v[36:39], v[16:19], v[200:207], v1
    ds_read_b128 v[48:51], v4 offset:6144
    v_cmp_ne_u32 vcc, 0, v8
    s_waitcnt lgkmcnt(6)
    v_smfmac_f32_16x16x64_bf16 v[28:31], v[20:23], v[208:215], v1
    ds_read_b128 v[52:55], v4 offset:7168
    s_nop 0
    v_smfmac_f32_16x16x64_bf16 v[32:35], v[20:23], v[216:223], v1
    s_cbranch_vccnz L_c2_L_ch10o_r
L_c2_L_ch10o:
    s_waitcnt lgkmcnt(5)
    s_barrier
    s_mov_b64 vcc, s[36:37]
    s_waitcnt lgkmcnt(2)
    v_smfmac_f32_16x16x64_bf16 v[36:39], v[20:23], v[56:63], v1
    ds_read_b128 v[12:15], v3 offset:0
    v_cndmask_b32 v40, 0, v2, s[38:39]
    v_smfmac_f32_16x16x64_bf16 v[28:31], v[24:27], v[224:231], v1
    ds_read_b128 v[16:19], v3 offset:32
    buffer_store_dwordx4 v[96:99], v0, s[4:7], s31 offen sc1
    s_add_u32 s31, s31, 131072
    v_cndmask_b32 v41, 0, v2, s[40:41]
    v_smfmac_f32_16x16x64_bf16 v[32:35], v[24:27], v[232:239], v1
    ds_read_b128 v[56:59], v4 offset:20480
    v_smfmac_f32_16x16x64_bf16 v[36:39], v[24:27], v[240:247], v1
    ds_read_b128 v[20:23], v3 offset:1024
    buffer_load_dwordx4 v[72:75], v0, s[4:7], s27 offen offset:2048 sc1
    s_waitcnt lgkmcnt(3)
    v_smfmac_f32_16x16x64_bf16 v[28:31], v[12:15], v[48:55], v1
    ds_read_b128 v[60:63], v4 offset:21504
    v_smfmac_f32_16x16x64_bf16 v[32:35], v[12:15], v[248:255], v1
    ds_read_b128 v[48:51], v4 offset:8192
    buffer_load_dwordx4 v[76:79], v0, s[4:7], s27 offen offset:3072 sc1
    v_smfmac_f32_16x16x64_bf16 v[36:39], v[12:15], a[0:7], v1
    ds_read_b128 v[24:27], v3 offset:1056
    s_waitcnt lgkmcnt(5)
    v_smfmac_f32_16x16x64_bf16 v[28:31], v[16:19], a[8:15], v1
    ds_read_b128 v[52:55], v4 offset:9216
    s_waitcnt lgkmcnt(3)
    v_smfmac_f32_16x16x64_bf16 v[32:35], v[16:19], v[56:63], v1
    ds_read_b128 v[56:59], v4 offset:22528
    v_smfmac_f32_16x16x64_bf16 v[36:39], v[16:19], a[16:23], v1
    ds_read_b128 v[12:15], v3 offset:2048
    v_smfmac_f32_16x16x64_bf16 v[28:31], v[20:23], a[24:31], v1
    ds_read_b128 v[60:63], v4 offset:23552
    v_smfmac_f32_16x16x64_bf16 v[32:35], v[20:23], a[32:39], v1
    s_waitcnt lgkmcnt(3)
    v_smfmac_f32_16x16x64_bf16 v[36:39], v[20:23], v[48:55], v1
    ds_read_b128 v[16:19], v3 offset:2080
    v_smfmac_f32_16x16x64_bf16 v[28:31], v[24:27], a[40:47], v1
    ds_read_b128 v[48:51], v4 offset:10240
    v_smfmac_f32_16x16x64_bf16 v[32:35], v[24:27], a[48:55], v1
    ds_read_b128 v[52:55], v4 offset:11264
    v_smfmac_f32_16x16x64_bf16 v[36:39], v[24:27], a[56:63], v1
    ds_read_b128 v[20:23], v3 offset:3072
    s_waitcnt lgkmcnt(4)
    v_smfmac_f32_16x16x64_bf16 v[28:31], v[12:15], v[56:63], v1
    ds_read_b128 v[56:59], v4 offset:24576
    v_smfmac_f32_16x16x64_bf16 v[32:35], v[12:15], a[64:71], v1
    ds_read_b128 v[60:63], v4 offset:25600
    v_smfmac_f32_16x16x64_bf16 v[36:39], v[12:15], a[72:79], v1
    ds_read_b128 v[24:27], v3 offset:3104
    s_waitcnt lgkmcnt(6)
    v_smfmac_f32_16x16x64_bf16 v[28:31], v[16:19], a[80:87], v1
    s_waitcnt lgkmcnt(4)
    v_smfmac_f32_16x16x64_bf16 v[32:35], v[16:19], v[48:55], v1
    ds_read_b128 v[48:51], v4 offset:12288
    v_smfmac_f32_16x16x64_bf16 v[36:39], v[16:19], a[88:95], v1
    ds_read_b128 v[12:15], v3 offset:4096
    s_waitcnt lgkmcnt(5)
    v_smfmac_f32_16x16x64_bf16 v[28:31], v[20:23], a[96:103], v1
    ds_read_b128 v[52:55], v4 offset:13312
    v_smfmac_f32_16x16x64_bf16 v[32:35], v[20:23], a[104:111], v1
    ds_read_b128 v[16:19], v3 offset:4128
    s_waitcnt lgkmcnt(5)
    v_smfmac_f32_16x16x64_bf16 v[36:39], v[20:23], v[56:63], v1
    ds_read_b128 v[56:59], v4 offset:26624
    s_waitcnt lgkmcnt(5)
    v_smfmac_f32_16x16x64_bf16 v[28:31], v[24:27], a[112:119], v1
    ds_read_b128 v[20:23], v3 offset:5120
    v_smfmac_f32_16x16x64_bf16 v[32:35], v[24:27], a[120:127], v1
    ds_read_b128 v[60:63], v4 offset:27648
    v_smfmac_f32_16x16x64_bf16 v[36:39], v[24:27], a[128:135], v1
    ds_read_b128 v[24:27], v3 offset:5152
    s_waitcnt lgkmcnt(5)
    v_smfmac_f32_16x16x64_bf16 v[28:31], v[12:15], v[48:55], v1
    v_smfmac_f32_16x16x64_bf16 v[32:35], v[12:15], a[136:143], v1
    s_waitcnt lgkmcnt(4)
    v_smfmac_f32_16x16x64_bf16 v[28:31], v[16:19], a[144:151], v1
    v_smfmac_f32_16x16x64_bf16 v[32:35], v[16:19], a[152:159], v1
    s_waitcnt lgkmcnt(1)
    v_smfmac_f32_16x16x64_bf16 v[28:31], v[20:23], v[56:63], v1
    v_smfmac_f32_16x16x64_bf16 v[32:35], v[20:23], a[160:167], v1
    s_waitcnt lgkmcnt(0)
    v_smfmac_f32_16x16x64_bf16 v[28:31], v[24:27], a[168:175], v1
    v_smfmac_f32_16x16x64_bf16 v[32:35], v[24:27], a[176:183], v1
    v_smfmac_f32_16x16x64_bf16 v[36:39], v[12:15], a[184:191], v1
    v_smfmac_f32_16x16x64_bf16 v[36:39], v[16:19], a[192:199], v1
    v_cvt_pk_bf16_f32 v44, v28, v29
    v_cvt_pk_bf16_f32 v45, v32, v33
    v_cvt_pk_bf16_f32 v46, v30, v31
    v_cvt_pk_bf16_f32 v47, v34, v35
    v_mfma_f32_16x16x16_bf16 v[28:31], v[44:45], v[40:41], 0
    v_mfma_f32_16x16x16_bf16 v[32:35], v[46:47], v[40:41], 0
    v_smfmac_f32_16x16x64_bf16 v[36:39], v[20:23], a[200:207], v1
    s_nop 3
    v_cvt_pk_bf16_f32 v44, v28, v32
    v_cvt_pk_bf16_f32 v45, v29, v33
    v_cvt_pk_bf16_f32 v46, v30, v34
    v_cvt_pk_bf16_f32 v47, v31, v35
    s_nop 1
    v_mfma_f32_16x16x32_bf16 v[32:35], v[68:71], v[44:47], 0
    v_mfma_f32_16x16x32_bf16 v[28:31], v[64:67], v[44:47], 0
    v_mfma_f32_16x16x32_bf16 v[12:15], v[44:47], v[44:47], 0
    v_smfmac_f32_16x16x64_bf16 v[36:39], v[24:27], a[208:215], v1
    v_cndmask_b32_dpp v28, v32, v28, vcc quad_perm:[2,3,2,3] row_mask:0xf bank_mask:0xf
    v_cndmask_b32_dpp v29, v33, v29, vcc quad_perm:[2,3,2,3] row_mask:0xf bank_mask:0xf
    v_cndmask_b32_dpp v30, v34, v30, vcc quad_perm:[2,3,2,3] row_mask:0xf bank_mask:0xf
    v_cndmask_b32_dpp v31, v35, v31, vcc quad_perm:[2,3,2,3] row_mask:0xf bank_mask:0xf
    ds_write_b128 v0, v[28:31] offset:10240
    v_cndmask_b32_dpp v11, v13, v12, vcc quad_perm:[2,3,2,3] row_mask:0xf bank_mask:0xf
    ds_write_b32 v0, v11 offset:14336
    buffer_load_dwordx4 v[64:67], v0, s[4:7], s30 offen offset:0 sc1
    buffer_load_dwordx4 v[68:71], v0, s[4:7], s30 offen offset:1024 sc1
    s_waitcnt lgkmcnt(0)
    s_barrier
    ds_read_b128 v[24:27], v0 offset:14336
    ds_read_b128 v[28:31], v0 offset:10240
    ds_read_b128 v[32:35], v0 offset:11264
    ds_read_b128 v[16:19], v0 offset:12288
    ds_read_b128 v[20:23], v0 offset:13312
    v_cvt_pk_bf16_f32 v42, v36, v37
    v_cvt_pk_bf16_f32 v43, v38, v39
    v_mov_b32 v13, 0
    v_mov_b32 v14, 0
    s_cmp_ge_u32 s18, 63
    s_cbranch_scc1 L_cdone1
    s_waitcnt lgkmcnt(4)
    v_pk_add_f32 v[24:25], v[24:25], v[26:27]
    v_add_f32 v24, v24, v25
    v_mul_f32 v40, s20, v24
    s_waitcnt lgkmcnt(3)
    v_pk_mul_f32 v[28:29], v[28:29], s[48:49]
    v_pk_mul_f32 v[30:31], v[30:31], s[48:49]
    v_exp_f32 v11, v40
    s_waitcnt lgkmcnt(2)
    v_pk_fma_f32 v[28:29], v[32:33], s[48:49], v[28:29]
    v_pk_fma_f32 v[30:31], v[34:35], s[48:49], v[30:31]
    s_waitcnt lgkmcnt(1)
    v_pk_fma_f32 v[28:29], v[16:17], s[48:49], v[28:29]
    v_pk_fma_f32 v[30:31], v[18:19], s[48:49], v[30:31]
    s_waitcnt lgkmcnt(0)
    v_pk_fma_f32 v[28:29], v[20:21], s[48:49], v[28:29]
    v_pk_fma_f32 v[30:31], v[22:23], s[48:49], v[30:31]
    v_mov_b32_dpp v9, v11 quad_perm:[0,1,0,1] row_mask:0xf bank_mask:0xf
    v_exp_f32 v16, v28
    v_exp_f32 v17, v29
    v_cvt_pk_bf16_f32 v12, v11, v9
    v_cvt_pk_bf16_f32 v15, v11, v9
    v_cvt_pk_bf16_f32 v32, v16, v17
    v_exp_f32 v18, v30
    v_mfma_f32_16x16x16_bf16 v[20:23], v[42:43], v[12:13], 0
    ds_read_b128 v[48:51], v4 offset:28672
    v_exp_f32 v19, v31
    v_mov_b32_dpp v34, v32 quad_perm:[0,1,0,1] row_mask:0xf bank_mask:0xf
    v_cvt_pk_bf16_f32 v33, v18, v19
    v_mfma_f32_16x16x16_bf16 v[24:27], v[42:43], v[14:15], 0
    ds_read_b128 v[52:55], v4 offset:29696
    v_add_f32 v8, v16, v17
    v_mov_b32_dpp v35, v33 quad_perm:[0,1,0,1] row_mask:0xf bank_mask:0xf
    v_add_f32 v10, v18, v19
    v_add_f32 v8, v8, v11
    s_waitcnt vmcnt(3)
    v_mfma_f32_16x16x32_bf16 v[20:23], v[72:75], v[32:35], v[20:23]
    ds_read_b128 v[56:59], v4 offset:30720
    v_add_f32 v8, v8, v10
    s_waitcnt vmcnt(2)
    v_mfma_f32_16x16x32_bf16 v[24:27], v[76:79], v[32:35], v[24:27]
    ds_read_b128 v[60:63], v4 offset:31744
    v_add_f32_dpp v9, v8, v8 quad_perm:[2,3,0,1] row_mask:0xf bank_mask:0xf
    v_add_f32_dpp v10, v8, v8 quad_perm:[2,3,0,1] row_mask:0xf bank_mask:0xf
    s_nop 1
    v_permlane16_swap_b32 v9, v10
    v_add_f32 v8, v9, v10
    v_add_f32 v9, v9, v10
    s_nop 1
    v_permlane32_swap_b32 v8, v9
    v_add_f32 v8, v8, v9
    v_rcp_f32 v10, v8
    v_subrev_u32 v8, s47, v8
    v_cmp_le_u32 s[44:45], s50, v8
    v_pk_mul_f32 v[20:21], v[20:21], v[10:11] op_sel_hi:[1,0]
    v_pk_mul_f32 v[22:23], v[22:23], v[10:11] op_sel_hi:[1,0]
    v_pk_mul_f32 v[24:25], v[24:25], v[10:11] op_sel_hi:[1,0]
    v_pk_mul_f32 v[26:27], v[26:27], v[10:11] op_sel_hi:[1,0]
    v_cvt_pk_bf16_f32 v32, v20, v24
    v_cvt_pk_bf16_f32 v33, v21, v25
    v_cvt_pk_bf16_f32 v34, v22, v26
    v_cvt_pk_bf16_f32 v35, v23, v27
    s_cmp_lg_u64 s[44:45], 0
    s_cbranch_scc1 L_sm_L_ch10o_r
L_sm_L_ch10o:
    s_mov_b64 exec, s[36:37]
    ds_write_b128 v3, v[32:35] offset:0
    s_mov_b64 exec, -1
    v_mov_b64 v[36:37], 0
    v_mov_b64 v[38:39], 0
    v_mov_b64 v[28:29], 0
    v_mov_b64 v[30:31], 0
    s_waitcnt lgkmcnt(0)
    s_barrier
    ds_read_b128 v[12:15], v3 offset:0
    ds_read_b128 v[16:19], v3 offset:32
    ds_read_b128 v[20:23], v3 offset:1024
    ds_read_b128 v[24:27], v3 offset:1056
    s_waitcnt lgkmcnt(3)
    v_smfmac_f32_16x16x64_bf16 v[36:39], v[12:15], v[48:55], v1
    ds_read_b128 v[72:75], v4 offset:32768
    s_waitcnt lgkmcnt(3)
    v_smfmac_f32_16x16x64_bf16 v[36:39], v[16:19], v[56:63], v1
    ds_read_b128 v[76:79], v4 offset:33792
    s_waitcnt lgkmcnt(3)
    v_smfmac_f32_16x16x64_bf16 v[36:39], v[20:23], a[216:223], v1
    s_waitcnt lgkmcnt(2)
    v_smfmac_f32_16x16x64_bf16 v[36:39], v[24:27], a[224:231], v1
    v_smfmac_f32_16x16x64_bf16 v[28:31], v[12:15], a[232:239], v1
    v_smfmac_f32_16x16x64_bf16 v[28:31], v[16:19], a[240:247], v1
    v_cvt_pk_bf16_f32 v36, v36, v37
    s_waitcnt lgkmcnt(0)
    v_smfmac_f32_16x16x64_bf16 v[28:31], v[20:23], v[72:79], v1
    v_or_b32 v36, 1, v36
    v_smfmac_f32_16x16x64_bf16 v[28:31], v[24:27], a[248:255], v1
    buffer_store_dword v36, v5, s[4:7], s28 offen
    v_cvt_pk_bf16_f32 v37, v38, v39
    v_or_b32 v37, 1, v37
    buffer_store_dword v37, v5, s[4:7], s29 offen
    s_nop 2
    v_cvt_pk_bf16_f32 v28, v28, v29
    v_cvt_pk_bf16_f32 v29, v30, v31
    v_or_b32 v28, 1, v28
    v_or_b32 v29, 1, v29
    buffer_store_dword v28, v5, s[4:7], s46 offen
    buffer_store_dword v29, v5, s[4:7], s73 offen
    ds_read_b128 v[48:51], v4 offset:0
    ds_read_b128 v[52:55], v4 offset:1024
    ds_read_b128 v[56:59], v4 offset:14336
    ds_read_b128 v[60:63], v4 offset:15360
    v_mov_b32_dpp v9, v42 quad_perm:[0,1,0,1] row_mask:0xf bank_mask:0xf
    v_mov_b32_dpp v10, v43 quad_perm:[0,1,0,1] row_mask:0xf bank_mask:0xf
    v_cndmask_b32 v96, v44, v42, vcc
    v_cndmask_b32 v97, v45, v43, vcc
    v_cndmask_b32 v98, v46, v9, vcc
    v_cndmask_b32 v99, v47, v10, vcc
    v_cndmask_b32 v20, 0, v2, s[42:43]
    v_cndmask_b32 v21, 0, v2, s[42:43]
    v_cndmask_b32 v22, 0, v2, s[42:43]
    v_cndmask_b32 v23, 0, v2, s[42:43]
    s_nop 9
    buffer_load_dword v12, v7, s[4:7], s21 offen offset:0 sc1
    buffer_load_dword v13, v7, s[4:7], s21 offen offset:256 sc1
    buffer_load_dword v14, v7, s[4:7], s21 offen offset:512 sc1
    buffer_load_dword v15, v7, s[4:7], s21 offen offset:768 sc1
    buffer_load_dword v16, v7, s[4:7], s21 offen offset:1024 sc1
    buffer_load_dword v17, v7, s[4:7], s21 offen offset:1280 sc1
    buffer_load_dword v18, v7, s[4:7], s21 offen offset:1536 sc1
    buffer_load_dword v19, v7, s[4:7], s21 offen offset:1792 sc1
    v_mov_b64 v[36:37], 0
    v_mov_b64 v[38:39], 0
    v_mov_b64 v[28:29], 0
    v_mov_b64 v[30:31], 0
    s_add_u32 s26, s26, 32768
    s_add_u32 s23, s23, 32768
    s_add_u32 s24, s24, 32768
    s_add_u32 s30, s30, 524288
    s_add_u32 s27, s27, 524288
    s_nop 14
    buffer_load_dword v40, v7, s[4:7], s21 offen offset:0 sc1
    buffer_load_dword v41, v7, s[4:7], s21 offen offset:256 sc1
    buffer_load_dword v42, v7, s[4:7], s21 offen offset:512 sc1
    buffer_load_dword v43, v7, s[4:7], s21 offen offset:768 sc1
    buffer_load_dword v44, v7, s[4:7], s21 offen offset:1024 sc1
    buffer_load_dword v45, v7, s[4:7], s21 offen offset:1280 sc1
    buffer_load_dword v46, v7, s[4:7], s21 offen offset:1536 sc1
    buffer_load_dword v47, v7, s[4:7], s21 offen offset:1792 sc1
    s_waitcnt vmcnt(12)
    v_mfma_f32_16x16x32_bf16 v[32:35], v[12:15], v[20:23], 0
    v_bitop3_b32 v8, v12, v13, v14 bitop3:0x80
    s_waitcnt vmcnt(8)
    v_mfma_f32_16x16x32_bf16 v[32:35], v[16:19], v[20:23], v[32:35]
    v_bitop3_b32 v8, v8, v15, v16 bitop3:0x80
    v_bitop3_b32 v8, v8, v17, v18 bitop3:0x80
    v_bitop3_b32 v8, v8, v19, 1 bitop3:0x80
    v_cmp_ne_u32 vcc, 1, v8
    s_nop 2
    v_cvt_pk_bf16_f32 v10, v32, v33
    v_cvt_pk_bf16_f32 v11, v34, v35
    v_or_b32 v10, 1, v10
    v_or_b32 v11, 1, v11
    s_cbranch_vccnz L_c1_L_ch10o_r
L_c1_L_ch10o:
    buffer_store_dwordx2 v[10:11], v6, s[4:7], s25 offen
    s_barrier
    buffer_store_dwordx2 v[10:11], v6, s[4:7], s26 offen sc1
    s_add_u32 s18, s18, 1
    v_mov_b64 v[32:33], 0
    v_mov_b64 v[34:35], 0
    s_nop 15
    s_nop 15
    s_nop 15
    s_nop 6
    buffer_load_dwordx4 v[24:27], v0, s[4:7], s22 offen sc1
    s_nop 15
    s_nop 3
    buffer_load_dwordx4 v[16:19], v0, s[4:7], s22 offen sc1
    s_waitcnt vmcnt(1)
    v_bitop3_b32 v8, v24, v25, v26 bitop3:0x80
    v_bitop3_b32 v8, v8, v27, 1 bitop3:0x80
    v_cmp_ne_u32 vcc, 1, v8
    ds_write_b128 v0, v[24:27] offset:6144
    s_cbranch_vccnz L_c3_L_ch10o_r
L_c3_L_ch10o:
    buffer_load_dwordx4 v[40:43], v0, s[4:7], s23 offen sc1
    buffer_load_dwordx4 v[44:47], v0, s[4:7], s24 offen sc1
    s_waitcnt lgkmcnt(0)
    s_barrier
    s_branch L_ch1_w0
L_c2_L_ch10e_r:
    s_add_u32 s19, s19, 1
    s_cmp_gt_u32 s19, 4000000
    s_cbranch_scc1 L_cend1
    buffer_load_dwordx4 v[40:43], v0, s[4:7], s23 offen sc1
    buffer_load_dwordx4 v[44:47], v0, s[4:7], s24 offen sc1
    s_waitcnt vmcnt(0)
    v_bitop3_b32 v8, v40, v41, v42 bitop3:0x80
    v_bitop3_b32 v8, v8, v43, v44 bitop3:0x80
    v_bitop3_b32 v8, v8, v45, v46 bitop3:0x80
    v_bitop3_b32 v8, v8, v47, 1 bitop3:0x80
    v_cmp_ne_u32 vcc, 1, v8
    s_cbranch_vccnz L_c2_L_ch10e_r
    ds_write_b128 v0, v[40:43] offset:0
    ds_write_b128 v0, v[44:47] offset:4096
    s_nop 7
    s_waitcnt lgkmcnt(0)
    s_branch L_c2_L_ch10e
L_sm_L_ch10e_r:
    v_max3_f32 v8, v28, v29, v30
    v_max3_f32 v8, v8, v31, v40
    s_nop 1
    v_max_f32_dpp v9, v8, v8 quad_perm:[2,3,0,1] row_mask:0xf bank_mask:0xf
    v_max_f32_dpp v10, v8, v8 quad_perm:[2,3,0,1] row_mask:0xf bank_mask:0xf
    s_nop 1
    v_permlane16_swap_b32 v9, v10
    v_max_f32 v8, v9, v10
    v_max_f32 v11, v9, v10
    s_nop 1
    v_permlane32_swap_b32 v8, v11
    v_max_f32 v8, v8, v11
    v_sub_f32 v28, v28, v8
    v_sub_f32 v29, v29, v8
    v_sub_f32 v30, v30, v8
    v_sub_f32 v31, v31, v8
    v_sub_f32 v40, v40, v8
    v_exp_f32 v11, v40
    s_nop 1
    v_mov_b32_dpp v9, v11 quad_perm:[0,1,0,1] row_mask:0xf bank_mask:0xf
    v_exp_f32 v16, v28
    v_exp_f32 v17, v29
    v_cvt_pk_bf16_f32 v12, v11, v9
    v_cvt_pk_bf16_f32 v15, v11, v9
    v_cvt_pk_bf16_f32 v32, v16, v17
    v_exp_f32 v18, v30
    v_mfma_f32_16x16x16_bf16 v[20:23], v[42:43], v[12:13], 0
    v_exp_f32 v19, v31
    v_mov_b32_dpp v34, v32 quad_perm:[0,1,0,1] row_mask:0xf bank_mask:0xf
    v_cvt_pk_bf16_f32 v33, v18, v19
    v_mfma_f32_16x16x16_bf16 v[24:27], v[42:43], v[14:15], 0
    v_add_f32 v8, v16, v17
    v_mov_b32_dpp v35, v33 quad_perm:[0,1,0,1] row_mask:0xf bank_mask:0xf
    v_add_f32 v10, v18, v19
    v_add_f32 v8, v8, v11
    v_mfma_f32_16x16x32_bf16 v[20:23], v[72:75], v[32:35], v[20:23]
    v_add_f32 v8, v8, v10
    v_mfma_f32_16x16x32_bf16 v[24:27], v[76:79], v[32:35], v[24:27]
    v_add_f32_dpp v9, v8, v8 quad_perm:[2,3,0,1] row_mask:0xf bank_mask:0xf
    v_add_f32_dpp v10, v8, v8 quad_perm:[2,3,0,1] row_mask:0xf bank_mask:0xf
    s_nop 1
    v_permlane16_swap_b32 v9, v10
    v_add_f32 v8, v9, v10
    v_add_f32 v9, v9, v10
    s_nop 1
    v_permlane32_swap_b32 v8, v9
    v_add_f32 v8, v8, v9
    v_rcp_f32 v10, v8
    s_nop 0
    v_pk_mul_f32 v[20:21], v[20:21], v[10:11] op_sel_hi:[1,0]
    v_pk_mul_f32 v[22:23], v[22:23], v[10:11] op_sel_hi:[1,0]
    v_pk_mul_f32 v[24:25], v[24:25], v[10:11] op_sel_hi:[1,0]
    v_pk_mul_f32 v[26:27], v[26:27], v[10:11] op_sel_hi:[1,0]
    v_cvt_pk_bf16_f32 v32, v20, v24
    v_cvt_pk_bf16_f32 v33, v21, v25
    v_cvt_pk_bf16_f32 v34, v22, v26
    v_cvt_pk_bf16_f32 v35, v23, v27
    s_branch L_sm_L_ch10e
L_c1_L_ch10e_r:
    s_add_u32 s19, s19, 1
    s_cmp_gt_u32 s19, 4000000
    s_cbranch_scc1 L_cend1
    buffer_load_dword v12, v7, s[4:7], s21 offen offset:0 sc1
    buffer_load_dword v13, v7, s[4:7], s21 offen offset:256 sc1
    buffer_load_dword v14, v7, s[4:7], s21 offen offset:512 sc1
    buffer_load_dword v15, v7, s[4:7], s21 offen offset:768 sc1
    buffer_load_dword v16, v7, s[4:7], s21 offen offset:1024 sc1
    buffer_load_dword v17, v7, s[4:7], s21 offen offset:1280 sc1
    buffer_load_dword v18, v7, s[4:7], s21 offen offset:1536 sc1
    buffer_load_dword v19, v7, s[4:7], s21 offen offset:1792 sc1
    s_waitcnt vmcnt(8)
    v_mfma_f32_16x16x32_bf16 v[32:35], v[40:43], v[20:23], 0
    v_or3_b32 v8, v40, v41, v42
    v_mfma_f32_16x16x32_bf16 v[32:35], v[44:47], v[20:23], v[32:35]
    v_or3_b32 v8, v8, v43, v44
    v_or3_b32 v8, v8, v45, v46
    v_or_b32 v8, v8, v47
    v_and_b32 v8, 1, v8
    v_cmp_ne_u32 vcc, 0, v8
    s_nop 1
    v_cvt_pk_bf16_f32 v10, v32, v33
    v_cvt_pk_bf16_f32 v11, v34, v35
    v_and_b32 v10, -2, v10
    v_and_b32 v11, -2, v11
    s_cbranch_vccnz L_c1_L_ch10e_r2
    s_branch L_c1_L_ch10e
L_c1_L_ch10e_r2:
    s_add_u32 s19, s19, 1
    s_cmp_gt_u32 s19, 4000000
    s_cbranch_scc1 L_cend1
    buffer_load_dword v40, v7, s[4:7], s21 offen offset:0 sc1
    buffer_load_dword v41, v7, s[4:7], s21 offen offset:256 sc1
    buffer_load_dword v42, v7, s[4:7], s21 offen offset:512 sc1
    buffer_load_dword v43, v7, s[4:7], s21 offen offset:768 sc1
    buffer_load_dword v44, v7, s[4:7], s21 offen offset:1024 sc1
    buffer_load_dword v45, v7, s[4:7], s21 offen offset:1280 sc1
    buffer_load_dword v46, v7, s[4:7], s21 offen offset:1536 sc1
    buffer_load_dword v47, v7, s[4:7], s21 offen offset:1792 sc1
    s_waitcnt vmcnt(8)
    v_mfma_f32_16x16x32_bf16 v[32:35], v[12:15], v[20:23], 0
    v_or3_b32 v8, v12, v13, v14
    v_mfma_f32_16x16x32_bf16 v[32:35], v[16:19], v[20:23], v[32:35]
    v_or3_b32 v8, v8, v15, v16
    v_or3_b32 v8, v8, v17, v18
    v_or_b32 v8, v8, v19
    v_and_b32 v8, 1, v8
    v_cmp_ne_u32 vcc, 0, v8
    s_nop 1
    v_cvt_pk_bf16_f32 v10, v32, v33
    v_cvt_pk_bf16_f32 v11, v34, v35
    v_and_b32 v10, -2, v10
    v_and_b32 v11, -2, v11
    s_cbranch_vccnz L_c1_L_ch10e_r
    s_branch L_c1_L_ch10e
L_c3_L_ch10e_r:
    s_add_u32 s19, s19, 1
    s_cmp_gt_u32 s19, 4000000
    s_cbranch_scc1 L_cend1
    buffer_load_dwordx4 v[24:27], v0, s[4:7], s22 offen sc1
    s_waitcnt vmcnt(1)
    v_or3_b32 v8, v16, v17, v18
    v_or_b32 v8, v8, v19
    v_and_b32 v8, 1, v8
    v_cmp_ne_u32 vcc, 0, v8
    s_cbranch_vccnz L_c3_L_ch10e_r2
    ds_write_b128 v0, v[16:19] offset:6144
    s_branch L_c3_L_ch10e
L_c3_L_ch10e_r2:
    buffer_load_dwordx4 v[16:19], v0, s[4:7], s22 offen sc1
    s_waitcnt vmcnt(1)
    v_or3_b32 v8, v24, v25, v26
    v_or_b32 v8, v8, v27
    v_and_b32 v8, 1, v8
    v_cmp_ne_u32 vcc, 0, v8
    s_cbranch_vccnz L_c3_L_ch10e_r
    ds_write_b128 v0, v[24:27] offset:6144
    s_branch L_c3_L_ch10e
L_c2_L_ch10o_r:
    s_add_u32 s19, s19, 1
    s_cmp_gt_u32 s19, 4000000
    s_cbranch_scc1 L_cend1
    buffer_load_dwordx4 v[40:43], v0, s[4:7], s23 offen sc1
    buffer_load_dwordx4 v[44:47], v0, s[4:7], s24 offen sc1
    s_waitcnt vmcnt(0)
    v_or3_b32 v8, v40, v41, v42
    v_or3_b32 v8, v8, v43, v44
    v_or3_b32 v8, v8, v45, v46
    v_or_b32 v8, v8, v47
    v_and_b32 v8, 1, v8
    v_cmp_ne_u32 vcc, 0, v8
    s_cbranch_vccnz L_c2_L_ch10o_r
    ds_write_b128 v0, v[40:43] offset:0
    ds_write_b128 v0, v[44:47] offset:4096
    s_nop 7
    s_waitcnt lgkmcnt(0)
    s_branch L_c2_L_ch10o
L_sm_L_ch10o_r:
    v_max3_f32 v8, v28, v29, v30
    v_max3_f32 v8, v8, v31, v40
    s_nop 1
    v_max_f32_dpp v9, v8, v8 quad_perm:[2,3,0,1] row_mask:0xf bank_mask:0xf
    v_max_f32_dpp v10, v8, v8 quad_perm:[2,3,0,1] row_mask:0xf bank_mask:0xf
    s_nop 1
    v_permlane16_swap_b32 v9, v10
    v_max_f32 v8, v9, v10
    v_max_f32 v11, v9, v10
    s_nop 1
    v_permlane32_swap_b32 v8, v11
    v_max_f32 v8, v8, v11
    v_sub_f32 v28, v28, v8
    v_sub_f32 v29, v29, v8
    v_sub_f32 v30, v30, v8
    v_sub_f32 v31, v31, v8
    v_sub_f32 v40, v40, v8
    v_exp_f32 v11, v40
    s_nop 1
    v_mov_b32_dpp v9, v11 quad_perm:[0,1,0,1] row_mask:0xf bank_mask:0xf
    v_exp_f32 v16, v28
    v_exp_f32 v17, v29
    v_cvt_pk_bf16_f32 v12, v11, v9
    v_cvt_pk_bf16_f32 v15, v11, v9
    v_cvt_pk_bf16_f32 v32, v16, v17
    v_exp_f32 v18, v30
    v_mfma_f32_16x16x16_bf16 v[20:23], v[42:43], v[12:13], 0
    v_exp_f32 v19, v31
    v_mov_b32_dpp v34, v32 quad_perm:[0,1,0,1] row_mask:0xf bank_mask:0xf
    v_cvt_pk_bf16_f32 v33, v18, v19
    v_mfma_f32_16x16x16_bf16 v[24:27], v[42:43], v[14:15], 0
    v_add_f32 v8, v16, v17
    v_mov_b32_dpp v35, v33 quad_perm:[0,1,0,1] row_mask:0xf bank_mask:0xf
    v_add_f32 v10, v18, v19
    v_add_f32 v8, v8, v11
    v_mfma_f32_16x16x32_bf16 v[20:23], v[72:75], v[32:35], v[20:23]
    v_add_f32 v8, v8, v10
    v_mfma_f32_16x16x32_bf16 v[24:27], v[76:79], v[32:35], v[24:27]
    v_add_f32_dpp v9, v8, v8 quad_perm:[2,3,0,1] row_mask:0xf bank_mask:0xf
    v_add_f32_dpp v10, v8, v8 quad_perm:[2,3,0,1] row_mask:0xf bank_mask:0xf
    s_nop 1
    v_permlane16_swap_b32 v9, v10
    v_add_f32 v8, v9, v10
    v_add_f32 v9, v9, v10
    s_nop 1
    v_permlane32_swap_b32 v8, v9
    v_add_f32 v8, v8, v9
    v_rcp_f32 v10, v8
    s_nop 0
    v_pk_mul_f32 v[20:21], v[20:21], v[10:11] op_sel_hi:[1,0]
    v_pk_mul_f32 v[22:23], v[22:23], v[10:11] op_sel_hi:[1,0]
    v_pk_mul_f32 v[24:25], v[24:25], v[10:11] op_sel_hi:[1,0]
    v_pk_mul_f32 v[26:27], v[26:27], v[10:11] op_sel_hi:[1,0]
    v_cvt_pk_bf16_f32 v32, v20, v24
    v_cvt_pk_bf16_f32 v33, v21, v25
    v_cvt_pk_bf16_f32 v34, v22, v26
    v_cvt_pk_bf16_f32 v35, v23, v27
    s_branch L_sm_L_ch10o
L_c1_L_ch10o_r:
    s_add_u32 s19, s19, 1
    s_cmp_gt_u32 s19, 4000000
    s_cbranch_scc1 L_cend1
    buffer_load_dword v12, v7, s[4:7], s21 offen offset:0 sc1
    buffer_load_dword v13, v7, s[4:7], s21 offen offset:256 sc1
    buffer_load_dword v14, v7, s[4:7], s21 offen offset:512 sc1
    buffer_load_dword v15, v7, s[4:7], s21 offen offset:768 sc1
    buffer_load_dword v16, v7, s[4:7], s21 offen offset:1024 sc1
    buffer_load_dword v17, v7, s[4:7], s21 offen offset:1280 sc1
    buffer_load_dword v18, v7, s[4:7], s21 offen offset:1536 sc1
    buffer_load_dword v19, v7, s[4:7], s21 offen offset:1792 sc1
    s_waitcnt vmcnt(8)
    v_mfma_f32_16x16x32_bf16 v[32:35], v[40:43], v[20:23], 0
    v_bitop3_b32 v8, v40, v41, v42 bitop3:0x80
    v_mfma_f32_16x16x32_bf16 v[32:35], v[44:47], v[20:23], v[32:35]
    v_bitop3_b32 v8, v8, v43, v44 bitop3:0x80
    v_bitop3_b32 v8, v8, v45, v46 bitop3:0x80
    v_bitop3_b32 v8, v8, v47, 1 bitop3:0x80
    v_cmp_ne_u32 vcc, 1, v8
    s_nop 2
    v_cvt_pk_bf16_f32 v10, v32, v33
    v_cvt_pk_bf16_f32 v11, v34, v35
    v_or_b32 v10, 1, v10
    v_or_b32 v11, 1, v11
    s_cbranch_vccnz L_c1_L_ch10o_r2
    s_branch L_c1_L_ch10o
L_c1_L_ch10o_r2:
    s_add_u32 s19, s19, 1
    s_cmp_gt_u32 s19, 4000000
    s_cbranch_scc1 L_cend1
    buffer_load_dword v40, v7, s[4:7], s21 offen offset:0 sc1
    buffer_load_dword v41, v7, s[4:7], s21 offen offset:256 sc1
    buffer_load_dword v42, v7, s[4:7], s21 offen offset:512 sc1
    buffer_load_dword v43, v7, s[4:7], s21 offen offset:768 sc1
    buffer_load_dword v44, v7, s[4:7], s21 offen offset:1024 sc1
    buffer_load_dword v45, v7, s[4:7], s21 offen offset:1280 sc1
    buffer_load_dword v46, v7, s[4:7], s21 offen offset:1536 sc1
    buffer_load_dword v47, v7, s[4:7], s21 offen offset:1792 sc1
    s_waitcnt vmcnt(8)
    v_mfma_f32_16x16x32_bf16 v[32:35], v[12:15], v[20:23], 0
    v_bitop3_b32 v8, v12, v13, v14 bitop3:0x80
    v_mfma_f32_16x16x32_bf16 v[32:35], v[16:19], v[20:23], v[32:35]
    v_bitop3_b32 v8, v8, v15, v16 bitop3:0x80
    v_bitop3_b32 v8, v8, v17, v18 bitop3:0x80
    v_bitop3_b32 v8, v8, v19, 1 bitop3:0x80
    v_cmp_ne_u32 vcc, 1, v8
    s_nop 2
    v_cvt_pk_bf16_f32 v10, v32, v33
    v_cvt_pk_bf16_f32 v11, v34, v35
    v_or_b32 v10, 1, v10
    v_or_b32 v11, 1, v11
    s_cbranch_vccnz L_c1_L_ch10o_r
    s_branch L_c1_L_ch10o
L_c3_L_ch10o_r:
    s_add_u32 s19, s19, 1
    s_cmp_gt_u32 s19, 4000000
    s_cbranch_scc1 L_cend1
    buffer_load_dwordx4 v[24:27], v0, s[4:7], s22 offen sc1
    s_waitcnt vmcnt(1)
    v_bitop3_b32 v8, v16, v17, v18 bitop3:0x80
    v_bitop3_b32 v8, v8, v19, 1 bitop3:0x80
    v_cmp_ne_u32 vcc, 1, v8
    s_cbranch_vccnz L_c3_L_ch10o_r2
    ds_write_b128 v0, v[16:19] offset:6144
    s_branch L_c3_L_ch10o
L_c3_L_ch10o_r2:
    buffer_load_dwordx4 v[16:19], v0, s[4:7], s22 offen sc1
    s_waitcnt vmcnt(1)
    v_bitop3_b32 v8, v24, v25, v26 bitop3:0x80
    v_bitop3_b32 v8, v8, v27, 1 bitop3:0x80
    v_cmp_ne_u32 vcc, 1, v8
    s_cbranch_vccnz L_c3_L_ch10o_r
    ds_write_b128 v0, v[24:27] offset:6144
    s_branch L_c3_L_ch10o
    .p2align 6
L_ch1_w1:
    ds_read_b128 v[12:15], v3 offset:6144
    s_waitcnt vmcnt(2)
    ds_read_b128 v[16:19], v3 offset:6176
    s_waitcnt lgkmcnt(1)
    v_smfmac_f32_16x16x64_bf16 v[28:31], v[12:15], v[48:55], v1
    ds_read_b128 v[20:23], v3 offset:7168
    v_smfmac_f32_16x16x64_bf16 v[32:35], v[12:15], v[56:63], v1
    ds_read_b128 v[48:51], v4 offset:2048
    v_smfmac_f32_16x16x64_bf16 v[36:39], v[12:15], v[104:111], v1
    ds_read_b128 v[24:27], v3 offset:7200
    s_waitcnt lgkmcnt(3)
    v_smfmac_f32_16x16x64_bf16 v[28:31], v[16:19], v[112:119], v1
    ds_read_b128 v[52:55], v4 offset:3072
    v_smfmac_f32_16x16x64_bf16 v[32:35], v[16:19], v[120:127], v1
    ds_read_b128 v[56:59], v4 offset:16384
    v_smfmac_f32_16x16x64_bf16 v[36:39], v[16:19], v[128:135], v1
    ds_read_b128 v[12:15], v3 offset:8192
    s_waitcnt lgkmcnt(5)
    v_smfmac_f32_16x16x64_bf16 v[28:31], v[20:23], v[136:143], v1
    ds_read_b128 v[60:63], v4 offset:17408
    v_smfmac_f32_16x16x64_bf16 v[32:35], v[20:23], v[144:151], v1
    s_waitcnt lgkmcnt(3)
    v_smfmac_f32_16x16x64_bf16 v[36:39], v[20:23], v[48:55], v1
    ds_read_b128 v[16:19], v3 offset:8224
    v_smfmac_f32_16x16x64_bf16 v[28:31], v[24:27], v[152:159], v1
    ds_read_b128 v[48:51], v4 offset:4096
    v_smfmac_f32_16x16x64_bf16 v[32:35], v[24:27], v[160:167], v1
    ds_read_b128 v[52:55], v4 offset:5120
    v_smfmac_f32_16x16x64_bf16 v[36:39], v[24:27], v[168:175], v1
    ds_read_b128 v[20:23], v3 offset:9216
    s_waitcnt lgkmcnt(4)
    v_smfmac_f32_16x16x64_bf16 v[28:31], v[12:15], v[56:63], v1
    s_waitcnt vmcnt(1)
    ds_write_b128 v0, v[40:43] offset:1024
    v_bitop3_b32 v8, v40, v41, v42 bitop3:0x80
    v_smfmac_f32_16x16x64_bf16 v[32:35], v[12:15], v[176:183], v1
    s_waitcnt vmcnt(0)
    ds_write_b128 v0, v[44:47] offset:5120
    v_bitop3_b32 v8, v8, v43, v44 bitop3:0x80
    v_smfmac_f32_16x16x64_bf16 v[36:39], v[12:15], v[184:191], v1
    ds_read_b128 v[24:27], v3 offset:9248
    v_bitop3_b32 v8, v8, v45, v46 bitop3:0x80
    s_waitcnt lgkmcnt(6)
    v_smfmac_f32_16x16x64_bf16 v[28:31], v[16:19], v[192:199], v1
    ds_read_b128 v[56:59], v4 offset:18432
    v_and_b32 v8, v8, v47
    s_waitcnt lgkmcnt(5)
    v_smfmac_f32_16x16x64_bf16 v[32:35], v[16:19], v[48:55], v1
    ds_read_b128 v[60:63], v4 offset:19456
    v_and_or_b32 v8, v8, 1, s35
    v_smfmac_f32_16x16x64_bf16 v[36:39], v[16:19], v[200:207], v1
    ds_read_b128 v[48:51], v4 offset:6144
    v_cmp_ne_u32 vcc, 1, v8
    s_waitcnt lgkmcnt(6)
    v_smfmac_f32_16x16x64_bf16 v[28:31], v[20:23], v[208:215], v1
    ds_read_b128 v[52:55], v4 offset:7168
    s_nop 0
    v_smfmac_f32_16x16x64_bf16 v[32:35], v[20:23], v[216:223], v1
    s_cbranch_vccnz L_c2_L_ch11e_r
L_c2_L_ch11e:
    s_waitcnt lgkmcnt(5)
    s_barrier
    s_mov_b64 vcc, s[36:37]
    s_mov_b32 s35, 0
    s_waitcnt lgkmcnt(2)
    v_smfmac_f32_16x16x64_bf16 v[36:39], v[20:23], v[56:63], v1
    ds_read_b128 v[12:15], v3 offset:0
    v_cndmask_b32 v40, 0, v2, s[38:39]
    v_smfmac_f32_16x16x64_bf16 v[28:31], v[24:27], v[224:231], v1
    ds_read_b128 v[16:19], v3 offset:32
    buffer_store_dwordx4 v[96:99], v0, s[4:7], s31 offen sc1
    s_add_u32 s31, s31, 131072
    v_cndmask_b32 v41, 0, v2, s[40:41]
    v_smfmac_f32_16x16x64_bf16 v[32:35], v[24:27], v[232:239], v1
    ds_read_b128 v[56:59], v4 offset:20480
    v_smfmac_f32_16x16x64_bf16 v[36:39], v[24:27], v[240:247], v1
    ds_read_b128 v[20:23], v3 offset:1024
    buffer_load_dwordx4 v[72:75], v0, s[4:7], s27 offen offset:2048 sc1
    s_waitcnt lgkmcnt(3)
    v_smfmac_f32_16x16x64_bf16 v[28:31], v[12:15], v[48:55], v1
    ds_read_b128 v[60:63], v4 offset:21504
    v_smfmac_f32_16x16x64_bf16 v[32:35], v[12:15], v[248:255], v1
    ds_read_b128 v[48:51], v4 offset:8192
    buffer_load_dwordx4 v[76:79], v0, s[4:7], s27 offen offset:3072 sc1
    v_smfmac_f32_16x16x64_bf16 v[36:39], v[12:15], a[0:7], v1
    ds_read_b128 v[24:27], v3 offset:1056
    s_waitcnt lgkmcnt(5)
    v_smfmac_f32_16x16x64_bf16 v[28:31], v[16:19], a[8:15], v1
    ds_read_b128 v[52:55], v4 offset:9216
    s_waitcnt lgkmcnt(3)
    v_smfmac_f32_16x16x64_bf16 v[32:35], v[16:19], v[56:63], v1
    ds_read_b128 v[56:59], v4 offset:22528
    v_smfmac_f32_16x16x64_bf16 v[36:39], v[16:19], a[16:23], v1
    ds_read_b128 v[12:15], v3 offset:2048
    v_smfmac_f32_16x16x64_bf16 v[28:31], v[20:23], a[24:31], v1
    ds_read_b128 v[60:63], v4 offset:23552
    v_smfmac_f32_16x16x64_bf16 v[32:35], v[20:23], a[32:39], v1
    s_waitcnt lgkmcnt(3)
    v_smfmac_f32_16x16x64_bf16 v[36:39], v[20:23], v[48:55], v1
    ds_read_b128 v[16:19], v3 offset:2080
    v_smfmac_f32_16x16x64_bf16 v[28:31], v[24:27], a[40:47], v1
    ds_read_b128 v[48:51], v4 offset:10240
    v_smfmac_f32_16x16x64_bf16 v[32:35], v[24:27], a[48:55], v1
    ds_read_b128 v[52:55], v4 offset:11264
    v_smfmac_f32_16x16x64_bf16 v[36:39], v[24:27], a[56:63], v1
    ds_read_b128 v[20:23], v3 offset:3072
    s_waitcnt lgkmcnt(4)
    v_smfmac_f32_16x16x64_bf16 v[28:31], v[12:15], v[56:63], v1
    ds_read_b128 v[56:59], v4 offset:24576
    v_smfmac_f32_16x16x64_bf16 v[32:35], v[12:15], a[64:71], v1
    ds_read_b128 v[60:63], v4 offset:25600
    v_smfmac_f32_16x16x64_bf16 v[36:39], v[12:15], a[72:79], v1
    ds_read_b128 v[24:27], v3 offset:3104
    s_waitcnt lgkmcnt(6)
    v_smfmac_f32_16x16x64_bf16 v[28:31], v[16:19], a[80:87], v1
    s_waitcnt lgkmcnt(4)
    v_smfmac_f32_16x16x64_bf16 v[32:35], v[16:19], v[48:55], v1
    ds_read_b128 v[48:51], v4 offset:12288
    v_smfmac_f32_16x16x64_bf16 v[36:39], v[16:19], a[88:95], v1
    ds_read_b128 v[12:15], v3 offset:4096
    s_waitcnt lgkmcnt(5)
    v_smfmac_f32_16x16x64_bf16 v[28:31], v[20:23], a[96:103], v1
    ds_read_b128 v[52:55], v4 offset:13312
    v_smfmac_f32_16x16x64_bf16 v[32:35], v[20:23], a[104:111], v1
    ds_read_b128 v[16:19], v3 offset:4128
    s_waitcnt lgkmcnt(5)
    v_smfmac_f32_16x16x64_bf16 v[36:39], v[20:23], v[56:63], v1
    ds_read_b128 v[56:59], v4 offset:26624
    s_waitcnt lgkmcnt(5)
    v_smfmac_f32_16x16x64_bf16 v[28:31], v[24:27], a[112:119], v1
    ds_read_b128 v[20:23], v3 offset:5120
    v_smfmac_f32_16x16x64_bf16 v[32:35], v[24:27], a[120:127], v1
    ds_read_b128 v[60:63], v4 offset:27648
    v_smfmac_f32_16x16x64_bf16 v[36:39], v[24:27], a[128:135], v1
    ds_read_b128 v[24:27], v3 offset:5152
    s_waitcnt lgkmcnt(5)
    v_smfmac_f32_16x16x64_bf16 v[28:31], v[12:15], v[48:55], v1
    v_smfmac_f32_16x16x64_bf16 v[32:35], v[12:15], a[136:143], v1
    s_waitcnt lgkmcnt(4)
    v_smfmac_f32_16x16x64_bf16 v[28:31], v[16:19], a[144:151], v1
    v_smfmac_f32_16x16x64_bf16 v[32:35], v[16:19], a[152:159], v1
    s_waitcnt lgkmcnt(1)
    v_smfmac_f32_16x16x64_bf16 v[28:31], v[20:23], v[56:63], v1
    v_smfmac_f32_16x16x64_bf16 v[32:35], v[20:23], a[160:167], v1
    s_waitcnt lgkmcnt(0)
    v_smfmac_f32_16x16x64_bf16 v[28:31], v[24:27], a[168:175], v1
    v_smfmac_f32_16x16x64_bf16 v[32:35], v[24:27], a[176:183], v1
    v_smfmac_f32_16x16x64_bf16 v[36:39], v[12:15], a[184:191], v1
    v_smfmac_f32_16x16x64_bf16 v[36:39], v[16:19], a[192:199], v1
    v_cvt_pk_bf16_f32 v44, v28, v29
    v_cvt_pk_bf16_f32 v45, v32, v33
    v_cvt_pk_bf16_f32 v46, v30, v31
    v_cvt_pk_bf16_f32 v47, v34, v35
    v_mfma_f32_16x16x16_bf16 v[28:31], v[44:45], v[40:41], 0
    v_mfma_f32_16x16x16_bf16 v[32:35], v[46:47], v[40:41], 0
    v_smfmac_f32_16x16x64_bf16 v[36:39], v[20:23], a[200:207], v1
    s_nop 3
    v_cvt_pk_bf16_f32 v44, v28, v32
    v_cvt_pk_bf16_f32 v45, v29, v33
    v_cvt_pk_bf16_f32 v46, v30, v34
    v_cvt_pk_bf16_f32 v47, v31, v35
    s_nop 1
    v_mfma_f32_16x16x32_bf16 v[32:35], v[68:71], v[44:47], 0
    v_mfma_f32_16x16x32_bf16 v[28:31], v[64:67], v[44:47], 0
    v_mfma_f32_16x16x32_bf16 v[12:15], v[44:47], v[44:47], 0
    v_smfmac_f32_16x16x64_bf16 v[36:39], v[24:27], a[208:215], v1
    v_cndmask_b32_dpp v28, v32, v28, vcc quad_perm:[2,3,2,3] row_mask:0xf bank_mask:0xf
    v_cndmask_b32_dpp v29, v33, v29, vcc quad_perm:[2,3,2,3] row_mask:0xf bank_mask:0xf
    v_cndmask_b32_dpp v30, v34, v30, vcc quad_perm:[2,3,2,3] row_mask:0xf bank_mask:0xf
    v_cndmask_b32_dpp v31, v35, v31, vcc quad_perm:[2,3,2,3] row_mask:0xf bank_mask:0xf
    ds_write_b128 v0, v[28:31] offset:11264
    v_cndmask_b32_dpp v11, v13, v12, vcc quad_perm:[2,3,2,3] row_mask:0xf bank_mask:0xf
    ds_write_b32 v0, v11 offset:14340
    buffer_load_dwordx4 v[64:67], v0, s[4:7], s30 offen offset:0 sc1
    buffer_load_dwordx4 v[68:71], v0, s[4:7], s30 offen offset:1024 sc1
    s_waitcnt lgkmcnt(0)
    s_barrier
    ds_read_b128 v[24:27], v0 offset:14336
    ds_read_b128 v[28:31], v0 offset:10240
    ds_read_b128 v[32:35], v0 offset:11264
    ds_read_b128 v[16:19], v0 offset:12288
    ds_read_b128 v[20:23], v0 offset:13312
    v_cvt_pk_bf16_f32 v42, v36, v37
    v_cvt_pk_bf16_f32 v43, v38, v39
    v_mov_b32 v13, 0
    v_mov_b32 v14, 0
    s_waitcnt lgkmcnt(4)
    v_pk_add_f32 v[24:25], v[24:25], v[26:27]
    v_add_f32 v24, v24, v25
    v_mul_f32 v40, s20, v24
    s_waitcnt lgkmcnt(3)
    v_pk_mul_f32 v[28:29], v[28:29], s[48:49]
    v_pk_mul_f32 v[30:31], v[30:31], s[48:49]
    v_exp_f32 v11, v40
    s_waitcnt lgkmcnt(2)
    v_pk_fma_f32 v[28:29], v[32:33], s[48:49], v[28:29]
    v_pk_fma_f32 v[30:31], v[34:35], s[48:49], v[30:31]
    s_waitcnt lgkmcnt(1)
    v_pk_fma_f32 v[28:29], v[16:17], s[48:49], v[28:29]
    v_pk_fma_f32 v[30:31], v[18:19], s[48:49], v[30:31]
    s_waitcnt lgkmcnt(0)
    v_pk_fma_f32 v[28:29], v[20:21], s[48:49], v[28:29]
    v_pk_fma_f32 v[30:31], v[22:23], s[48:49], v[30:31]
    v_mov_b32_dpp v9, v11 quad_perm:[0,1,0,1] row_mask:0xf bank_mask:0xf
    v_exp_f32 v16, v28
    v_exp_f32 v17, v29
    v_cvt_pk_bf16_f32 v12, v11, v9
    v_cvt_pk_bf16_f32 v15, v11, v9
    v_cvt_pk_bf16_f32 v32, v16, v17
    v_exp_f32 v18, v30
    v_mfma_f32_16x16x16_bf16 v[20:23], v[42:43], v[12:13], 0
    ds_read_b128 v[48:51], v4 offset:28672
    v_exp_f32 v19, v31
    v_mov_b32_dpp v34, v32 quad_perm:[0,1,0,1] row_mask:0xf bank_mask:0xf
    v_cvt_pk_bf16_f32 v33, v18, v19
    v_mfma_f32_16x16x16_bf16 v[24:27], v[42:43], v[14:15], 0
    ds_read_b128 v[52:55], v4 offset:29696
    v_add_f32 v8, v16, v17
    v_mov_b32_dpp v35, v33 quad_perm:[0,1,0,1] row_mask:0xf bank_mask:0xf
    v_add_f32 v10, v18, v19
    v_add_f32 v8, v8, v11
    s_waitcnt vmcnt(3)
    v_mfma_f32_16x16x32_bf16 v[20:23], v[72:75], v[32:35], v[20:23]
    ds_read_b128 v[56:59], v4 offset:30720
    v_add_f32 v8, v8, v10
    s_waitcnt vmcnt(2)
    v_mfma_f32_16x16x32_bf16 v[24:27], v[76:79], v[32:35], v[24:27]
    ds_read_b128 v[60:63], v4 offset:31744
    v_add_f32_dpp v9, v8, v8 quad_perm:[2,3,0,1] row_mask:0xf bank_mask:0xf
    v_add_f32_dpp v10, v8, v8 quad_perm:[2,3,0,1] row_mask:0xf bank_mask:0xf
    s_nop 1
    v_permlane16_swap_b32 v9, v10
    v_add_f32 v8, v9, v10
    v_add_f32 v9, v9, v10
    s_nop 1
    v_permlane32_swap_b32 v8, v9
    v_add_f32 v8, v8, v9
    v_rcp_f32 v10, v8
    v_subrev_u32 v8, s47, v8
    v_cmp_le_u32 s[44:45], s50, v8
    v_pk_mul_f32 v[20:21], v[20:21], v[10:11] op_sel_hi:[1,0]
    v_pk_mul_f32 v[22:23], v[22:23], v[10:11] op_sel_hi:[1,0]
    v_pk_mul_f32 v[24:25], v[24:25], v[10:11] op_sel_hi:[1,0]
    v_pk_mul_f32 v[26:27], v[26:27], v[10:11] op_sel_hi:[1,0]
    v_cvt_pk_bf16_f32 v32, v20, v24
    v_cvt_pk_bf16_f32 v33, v21, v25
    v_cvt_pk_bf16_f32 v34, v22, v26
    v_cvt_pk_bf16_f32 v35, v23, v27
    s_cmp_lg_u64 s[44:45], 0
    s_cbranch_scc1 L_sm_L_ch11e_r
L_sm_L_ch11e:
    s_mov_b64 exec, s[36:37]
    ds_write_b128 v3, v[32:35] offset:32
    s_mov_b64 exec, -1
    v_mov_b64 v[36:37], 0
    v_mov_b64 v[38:39], 0
    v_mov_b64 v[28:29], 0
    v_mov_b64 v[30:31], 0
    s_waitcnt lgkmcnt(0)
    s_barrier
    ds_read_b128 v[12:15], v3 offset:0
    ds_read_b128 v[16:19], v3 offset:32
    ds_read_b128 v[20:23], v3 offset:1024
    ds_read_b128 v[24:27], v3 offset:1056
    s_waitcnt lgkmcnt(3)
    v_smfmac_f32_16x16x64_bf16 v[36:39], v[12:15], v[48:55], v1
    ds_read_b128 v[72:75], v4 offset:32768
    s_waitcnt lgkmcnt(3)
    v_smfmac_f32_16x16x64_bf16 v[36:39], v[16:19], v[56:63], v1
    ds_read_b128 v[76:79], v4 offset:33792
    s_waitcnt lgkmcnt(3)
    v_smfmac_f32_16x16x64_bf16 v[36:39], v[20:23], a[216:223], v1
    s_waitcnt lgkmcnt(2)
    v_smfmac_f32_16x16x64_bf16 v[36:39], v[24:27], a[224:231], v1
    v_smfmac_f32_16x16x64_bf16 v[28:31], v[12:15], a[232:239], v1
    v_smfmac_f32_16x16x64_bf16 v[28:31], v[16:19], a[240:247], v1
    v_cvt_pk_bf16_f32 v36, v36, v37
    s_waitcnt lgkmcnt(0)
    v_smfmac_f32_16x16x64_bf16 v[28:31], v[20:23], v[72:79], v1
    v_and_b32 v36, -2, v36
    v_smfmac_f32_16x16x64_bf16 v[28:31], v[24:27], a[248:255], v1
    buffer_store_dword v36, v5, s[4:7], s28 offen
    v_cvt_pk_bf16_f32 v37, v38, v39
    v_and_b32 v37, -2, v37
    buffer_store_dword v37, v5, s[4:7], s29 offen
    s_nop 2
    v_cvt_pk_bf16_f32 v28, v28, v29
    v_cvt_pk_bf16_f32 v29, v30, v31
    v_and_b32 v28, -2, v28
    v_and_b32 v29, -2, v29
    buffer_store_dword v28, v5, s[4:7], s46 offen
    buffer_store_dword v29, v5, s[4:7], s73 offen
    ds_read_b128 v[48:51], v4 offset:0
    ds_read_b128 v[52:55], v4 offset:1024
    ds_read_b128 v[56:59], v4 offset:14336
    ds_read_b128 v[60:63], v4 offset:15360
    v_mov_b32_dpp v9, v42 quad_perm:[0,1,0,1] row_mask:0xf bank_mask:0xf
    v_mov_b32_dpp v10, v43 quad_perm:[0,1,0,1] row_mask:0xf bank_mask:0xf
    v_cndmask_b32 v96, v44, v42, vcc
    v_cndmask_b32 v97, v45, v43, vcc
    v_cndmask_b32 v98, v46, v9, vcc
    v_cndmask_b32 v99, v47, v10, vcc
    v_cndmask_b32 v20, 0, v2, s[42:43]
    v_cndmask_b32 v21, 0, v2, s[42:43]
    v_cndmask_b32 v22, 0, v2, s[42:43]
    v_cndmask_b32 v23, 0, v2, s[42:43]
    s_nop 15
    s_nop 3
    buffer_load_dword v12, v7, s[4:7], s21 offen offset:0 sc1
    buffer_load_dword v13, v7, s[4:7], s21 offen offset:256 sc1
    buffer_load_dword v14, v7, s[4:7], s21 offen offset:512 sc1
    buffer_load_dword v15, v7, s[4:7], s21 offen offset:768 sc1
    buffer_load_dword v16, v7, s[4:7], s21 offen offset:1024 sc1
    buffer_load_dword v17, v7, s[4:7], s21 offen offset:1280 sc1
    buffer_load_dword v18, v7, s[4:7], s21 offen offset:1536 sc1
    buffer_load_dword v19, v7, s[4:7], s21 offen offset:1792 sc1
    v_mov_b64 v[36:37], 0
    v_mov_b64 v[38:39], 0
    v_mov_b64 v[28:29], 0
    v_mov_b64 v[30:31], 0
    s_add_u32 s26, s26, 32768
    s_add_u32 s23, s23, 32768
    s_add_u32 s24, s24, 32768
    s_add_u32 s30, s30, 524288
    s_add_u32 s27, s27, 524288
    s_nop 14
    buffer_load_dword v40, v7, s[4:7], s21 offen offset:0 sc1
    buffer_load_dword v41, v7, s[4:7], s21 offen offset:256 sc1
    buffer_load_dword v42, v7, s[4:7], s21 offen offset:512 sc1
    buffer_load_dword v43, v7, s[4:7], s21 offen offset:768 sc1
    buffer_load_dword v44, v7, s[4:7], s21 offen offset:1024 sc1
    buffer_load_dword v45, v7, s[4:7], s21 offen offset:1280 sc1
    buffer_load_dword v46, v7, s[4:7], s21 offen offset:1536 sc1
    buffer_load_dword v47, v7, s[4:7], s21 offen offset:1792 sc1
    s_waitcnt vmcnt(12)
    v_mfma_f32_16x16x32_bf16 v[32:35], v[12:15], v[20:23], 0
    v_or3_b32 v8, v12, v13, v14
    s_waitcnt vmcnt(8)
    v_mfma_f32_16x16x32_bf16 v[32:35], v[16:19], v[20:23], v[32:35]
    v_or3_b32 v8, v8, v15, v16
    v_or3_b32 v8, v8, v17, v18
    v_or_b32 v8, v8, v19
    v_and_b32 v8, 1, v8
    v_cmp_ne_u32 vcc, 0, v8
    s_nop 1
    v_cvt_pk_bf16_f32 v10, v32, v33
    v_cvt_pk_bf16_f32 v11, v34, v35
    v_and_b32 v10, -2, v10
    v_and_b32 v11, -2, v11
    s_cbranch_vccnz L_c1_L_ch11e_r
L_c1_L_ch11e:
    buffer_store_dwordx2 v[10:11], v6, s[4:7], s25 offen
    s_barrier
    buffer_store_dwordx2 v[10:11], v6, s[4:7], s26 offen sc1
    s_add_u32 s18, s18, 1
    v_mov_b64 v[32:33], 0
    v_mov_b64 v[34:35], 0
    s_nop 15
    s_nop 15
    s_nop 15
    s_nop 6
    buffer_load_dwordx4 v[24:27], v0, s[4:7], s22 offen sc1
    s_nop 15
    s_nop 3
    buffer_load_dwordx4 v[16:19], v0, s[4:7], s22 offen sc1
    s_waitcnt vmcnt(1)
    v_or3_b32 v8, v24, v25, v26
    v_or_b32 v8, v8, v27
    v_and_b32 v8, 1, v8
    v_cmp_ne_u32 vcc, 0, v8
    ds_write_b128 v0, v[24:27] offset:7168
    s_cbranch_vccnz L_c3_L_ch11e_r
L_c3_L_ch11e:
    buffer_load_dwordx4 v[40:43], v0, s[4:7], s23 offen sc1
    buffer_load_dwordx4 v[44:47], v0, s[4:7], s24 offen sc1
    s_waitcnt lgkmcnt(0)
    s_barrier
    ds_read_b128 v[12:15], v3 offset:6144
    s_waitcnt vmcnt(2)
    ds_read_b128 v[16:19], v3 offset:6176
    s_waitcnt lgkmcnt(1)
    v_smfmac_f32_16x16x64_bf16 v[28:31], v[12:15], v[48:55], v1
    ds_read_b128 v[20:23], v3 offset:7168
    v_smfmac_f32_16x16x64_bf16 v[32:35], v[12:15], v[56:63], v1
    ds_read_b128 v[48:51], v4 offset:2048
    v_smfmac_f32_16x16x64_bf16 v[36:39], v[12:15], v[104:111], v1
    ds_read_b128 v[24:27], v3 offset:7200
    s_waitcnt lgkmcnt(3)
    v_smfmac_f32_16x16x64_bf16 v[28:31], v[16:19], v[112:119], v1
    ds_read_b128 v[52:55], v4 offset:3072
    v_smfmac_f32_16x16x64_bf16 v[32:35], v[16:19], v[120:127], v1
    ds_read_b128 v[56:59], v4 offset:16384
    v_smfmac_f32_16x16x64_bf16 v[36:39], v[16:19], v[128:135], v1
    ds_read_b128 v[12:15], v3 offset:8192
    s_waitcnt lgkmcnt(5)
    v_smfmac_f32_16x16x64_bf16 v[28:31], v[20:23], v[136:143], v1
    ds_read_b128 v[60:63], v4 offset:17408
    v_smfmac_f32_16x16x64_bf16 v[32:35], v[20:23], v[144:151], v1
    s_waitcnt lgkmcnt(3)
    v_smfmac_f32_16x16x64_bf16 v[36:39], v[20:23], v[48:55], v1
    ds_read_b128 v[16:19], v3 offset:8224
    v_smfmac_f32_16x16x64_bf16 v[28:31], v[24:27], v[152:159], v1
    ds_read_b128 v[48:51], v4 offset:4096
    v_smfmac_f32_16x16x64_bf16 v[32:35], v[24:27], v[160:167], v1
    ds_read_b128 v[52:55], v4 offset:5120
    v_smfmac_f32_16x16x64_bf16 v[36:39], v[24:27], v[168:175], v1
    ds_read_b128 v[20:23], v3 offset:9216
    s_waitcnt lgkmcnt(4)
    v_smfmac_f32_16x16x64_bf16 v[28:31], v[12:15], v[56:63], v1
    s_waitcnt vmcnt(1)
    ds_write_b128 v0, v[40:43] offset:1024
    v_or3_b32 v8, v40, v41, v42
    v_smfmac_f32_16x16x64_bf16 v[32:35], v[12:15], v[176:183], v1
    s_waitcnt vmcnt(0)
    ds_write_b128 v0, v[44:47] offset:5120
    v_or3_b32 v8, v8, v43, v44
    v_smfmac_f32_16x16x64_bf16 v[36:39], v[12:15], v[184:191], v1
    ds_read_b128 v[24:27], v3 offset:9248
    v_or3_b32 v8, v8, v45, v46
    s_waitcnt lgkmcnt(6)
    v_smfmac_f32_16x16x64_bf16 v[28:31], v[16:19], v[192:199], v1
    ds_read_b128 v[56:59], v4 offset:18432
    v_or_b32 v8, v8, v47
    s_waitcnt lgkmcnt(5)
    v_smfmac_f32_16x16x64_bf16 v[32:35], v[16:19], v[48:55], v1
    ds_read_b128 v[60:63], v4 offset:19456
    v_and_b32 v8, 1, v8
    v_smfmac_f32_16x16x64_bf16 v[36:39], v[16:19], v[200:207], v1
    ds_read_b128 v[48:51], v4 offset:6144
    v_cmp_ne_u32 vcc, 0, v8
    s_waitcnt lgkmcnt(6)
    v_smfmac_f32_16x16x64_bf16 v[28:31], v[20:23], v[208:215], v1
    ds_read_b128 v[52:55], v4 offset:7168
    s_nop 0
    v_smfmac_f32_16x16x64_bf16 v[32:35], v[20:23], v[216:223], v1
    s_cbranch_vccnz L_c2_L_ch11o_r
L_c2_L_ch11o:
    s_waitcnt lgkmcnt(5)
    s_barrier
    s_mov_b64 vcc, s[36:37]
    s_waitcnt lgkmcnt(2)
    v_smfmac_f32_16x16x64_bf16 v[36:39], v[20:23], v[56:63], v1
    ds_read_b128 v[12:15], v3 offset:0
    v_cndmask_b32 v40, 0, v2, s[38:39]
    v_smfmac_f32_16x16x64_bf16 v[28:31], v[24:27], v[224:231], v1
    ds_read_b128 v[16:19], v3 offset:32
    buffer_store_dwordx4 v[96:99], v0, s[4:7], s31 offen sc1
    s_add_u32 s31, s31, 131072
    v_cndmask_b32 v41, 0, v2, s[40:41]
    v_smfmac_f32_16x16x64_bf16 v[32:35], v[24:27], v[232:239], v1
    ds_read_b128 v[56:59], v4 offset:20480
    v_smfmac_f32_16x16x64_bf16 v[36:39], v[24:27], v[240:247], v1
    ds_read_b128 v[20:23], v3 offset:1024
    buffer_load_dwordx4 v[72:75], v0, s[4:7], s27 offen offset:2048 sc1
    s_waitcnt lgkmcnt(3)
    v_smfmac_f32_16x16x64_bf16 v[28:31], v[12:15], v[48:55], v1
    ds_read_b128 v[60:63], v4 offset:21504
    v_smfmac_f32_16x16x64_bf16 v[32:35], v[12:15], v[248:255], v1
    ds_read_b128 v[48:51], v4 offset:8192
    buffer_load_dwordx4 v[76:79], v0, s[4:7], s27 offen offset:3072 sc1
    v_smfmac_f32_16x16x64_bf16 v[36:39], v[12:15], a[0:7], v1
    ds_read_b128 v[24:27], v3 offset:1056
    s_waitcnt lgkmcnt(5)
    v_smfmac_f32_16x16x64_bf16 v[28:31], v[16:19], a[8:15], v1
    ds_read_b128 v[52:55], v4 offset:9216
    s_waitcnt lgkmcnt(3)
    v_smfmac_f32_16x16x64_bf16 v[32:35], v[16:19], v[56:63], v1
    ds_read_b128 v[56:59], v4 offset:22528
    v_smfmac_f32_16x16x64_bf16 v[36:39], v[16:19], a[16:23], v1
    ds_read_b128 v[12:15], v3 offset:2048
    v_smfmac_f32_16x16x64_bf16 v[28:31], v[20:23], a[24:31], v1
    ds_read_b128 v[60:63], v4 offset:23552
    v_smfmac_f32_16x16x64_bf16 v[32:35], v[20:23], a[32:39], v1
    s_waitcnt lgkmcnt(3)
    v_smfmac_f32_16x16x64_bf16 v[36:39], v[20:23], v[48:55], v1
    ds_read_b128 v[16:19], v3 offset:2080
    v_smfmac_f32_16x16x64_bf16 v[28:31], v[24:27], a[40:47], v1
    ds_read_b128 v[48:51], v4 offset:10240
    v_smfmac_f32_16x16x64_bf16 v[32:35], v[24:27], a[48:55], v1
    ds_read_b128 v[52:55], v4 offset:11264
    v_smfmac_f32_16x16x64_bf16 v[36:39], v[24:27], a[56:63], v1
    ds_read_b128 v[20:23], v3 offset:3072
    s_waitcnt lgkmcnt(4)
    v_smfmac_f32_16x16x64_bf16 v[28:31], v[12:15], v[56:63], v1
    ds_read_b128 v[56:59], v4 offset:24576
    v_smfmac_f32_16x16x64_bf16 v[32:35], v[12:15], a[64:71], v1
    ds_read_b128 v[60:63], v4 offset:25600
    v_smfmac_f32_16x16x64_bf16 v[36:39], v[12:15], a[72:79], v1
    ds_read_b128 v[24:27], v3 offset:3104
    s_waitcnt lgkmcnt(6)
    v_smfmac_f32_16x16x64_bf16 v[28:31], v[16:19], a[80:87], v1
    s_waitcnt lgkmcnt(4)
    v_smfmac_f32_16x16x64_bf16 v[32:35], v[16:19], v[48:55], v1
    ds_read_b128 v[48:51], v4 offset:12288
    v_smfmac_f32_16x16x64_bf16 v[36:39], v[16:19], a[88:95], v1
    ds_read_b128 v[12:15], v3 offset:4096
    s_waitcnt lgkmcnt(5)
    v_smfmac_f32_16x16x64_bf16 v[28:31], v[20:23], a[96:103], v1
    ds_read_b128 v[52:55], v4 offset:13312
    v_smfmac_f32_16x16x64_bf16 v[32:35], v[20:23], a[104:111], v1
    ds_read_b128 v[16:19], v3 offset:4128
    s_waitcnt lgkmcnt(5)
    v_smfmac_f32_16x16x64_bf16 v[36:39], v[20:23], v[56:63], v1
    ds_read_b128 v[56:59], v4 offset:26624
    s_waitcnt lgkmcnt(5)
    v_smfmac_f32_16x16x64_bf16 v[28:31], v[24:27], a[112:119], v1
    ds_read_b128 v[20:23], v3 offset:5120
    v_smfmac_f32_16x16x64_bf16 v[32:35], v[24:27], a[120:127], v1
    ds_read_b128 v[60:63], v4 offset:27648
    v_smfmac_f32_16x16x64_bf16 v[36:39], v[24:27], a[128:135], v1
    ds_read_b128 v[24:27], v3 offset:5152
    s_waitcnt lgkmcnt(5)
    v_smfmac_f32_16x16x64_bf16 v[28:31], v[12:15], v[48:55], v1
    v_smfmac_f32_16x16x64_bf16 v[32:35], v[12:15], a[136:143], v1
    s_waitcnt lgkmcnt(4)
    v_smfmac_f32_16x16x64_bf16 v[28:31], v[16:19], a[144:151], v1
    v_smfmac_f32_16x16x64_bf16 v[32:35], v[16:19], a[152:159], v1
    s_waitcnt lgkmcnt(1)
    v_smfmac_f32_16x16x64_bf16 v[28:31], v[20:23], v[56:63], v1
    v_smfmac_f32_16x16x64_bf16 v[32:35], v[20:23], a[160:167], v1
    s_waitcnt lgkmcnt(0)
    v_smfmac_f32_16x16x64_bf16 v[28:31], v[24:27], a[168:175], v1
    v_smfmac_f32_16x16x64_bf16 v[32:35], v[24:27], a[176:183], v1
    v_smfmac_f32_16x16x64_bf16 v[36:39], v[12:15], a[184:191], v1
    v_smfmac_f32_16x16x64_bf16 v[36:39], v[16:19], a[192:199], v1
    v_cvt_pk_bf16_f32 v44, v28, v29
    v_cvt_pk_bf16_f32 v45, v32, v33
    v_cvt_pk_bf16_f32 v46, v30, v31
    v_cvt_pk_bf16_f32 v47, v34, v35
    v_mfma_f32_16x16x16_bf16 v[28:31], v[44:45], v[40:41], 0
    v_mfma_f32_16x16x16_bf16 v[32:35], v[46:47], v[40:41], 0
    v_smfmac_f32_16x16x64_bf16 v[36:39], v[20:23], a[200:207], v1
    s_nop 3
    v_cvt_pk_bf16_f32 v44, v28, v32
    v_cvt_pk_bf16_f32 v45, v29, v33
    v_cvt_pk_bf16_f32 v46, v30, v34
    v_cvt_pk_bf16_f32 v47, v31, v35
    s_nop 1
    v_mfma_f32_16x16x32_bf16 v[32:35], v[68:71], v[44:47], 0
    v_mfma_f32_16x16x32_bf16 v[28:31], v[64:67], v[44:47], 0
    v_mfma_f32_16x16x32_bf16 v[12:15], v[44:47], v[44:47], 0
    v_smfmac_f32_16x16x64_bf16 v[36:39], v[24:27], a[208:215], v1
    v_cndmask_b32_dpp v28, v32, v28, vcc quad_perm:[2,3,2,3] row_mask:0xf bank_mask:0xf
    v_cndmask_b32_dpp v29, v33, v29, vcc quad_perm:[2,3,2,3] row_mask:0xf bank_mask:0xf
    v_cndmask_b32_dpp v30, v34, v30, vcc quad_perm:[2,3,2,3] row_mask:0xf bank_mask:0xf
    v_cndmask_b32_dpp v31, v35, v31, vcc quad_perm:[2,3,2,3] row_mask:0xf bank_mask:0xf
    ds_write_b128 v0, v[28:31] offset:11264
    v_cndmask_b32_dpp v11, v13, v12, vcc quad_perm:[2,3,2,3] row_mask:0xf bank_mask:0xf
    ds_write_b32 v0, v11 offset:14340
    buffer_load_dwordx4 v[64:67], v0, s[4:7], s30 offen offset:0 sc1
    buffer_load_dwordx4 v[68:71], v0, s[4:7], s30 offen offset:1024 sc1
    s_waitcnt lgkmcnt(0)
    s_barrier
    ds_read_b128 v[24:27], v0 offset:14336
    ds_read_b128 v[28:31], v0 offset:10240
    ds_read_b128 v[32:35], v0 offset:11264
    ds_read_b128 v[16:19], v0 offset:12288
    ds_read_b128 v[20:23], v0 offset:13312
    v_cvt_pk_bf16_f32 v42, v36, v37
    v_cvt_pk_bf16_f32 v43, v38, v39
    v_mov_b32 v13, 0
    v_mov_b32 v14, 0
    s_cmp_ge_u32 s18, 63
    s_cbranch_scc1 L_cdone1
    s_waitcnt lgkmcnt(4)
    v_pk_add_f32 v[24:25], v[24:25], v[26:27]
    v_add_f32 v24, v24, v25
    v_mul_f32 v40, s20, v24
    s_waitcnt lgkmcnt(3)
    v_pk_mul_f32 v[28:29], v[28:29], s[48:49]
    v_pk_mul_f32 v[30:31], v[30:31], s[48:49]
    v_exp_f32 v11, v40
    s_waitcnt lgkmcnt(2)
    v_pk_fma_f32 v[28:29], v[32:33], s[48:49], v[28:29]
    v_pk_fma_f32 v[30:31], v[34:35], s[48:49], v[30:31]
    s_waitcnt lgkmcnt(1)
    v_pk_fma_f32 v[28:29], v[16:17], s[48:49], v[28:29]
    v_pk_fma_f32 v[30:31], v[18:19], s[48:49], v[30:31]
    s_waitcnt lgkmcnt(0)
    v_pk_fma_f32 v[28:29], v[20:21], s[48:49], v[28:29]
    v_pk_fma_f32 v[30:31], v[22:23], s[48:49], v[30:31]
    v_mov_b32_dpp v9, v11 quad_perm:[0,1,0,1] row_mask:0xf bank_mask:0xf
    v_exp_f32 v16, v28
    v_exp_f32 v17, v29
    v_cvt_pk_bf16_f32 v12, v11, v9
    v_cvt_pk_bf16_f32 v15, v11, v9
    v_cvt_pk_bf16_f32 v32, v16, v17
    v_exp_f32 v18, v30
    v_mfma_f32_16x16x16_bf16 v[20:23], v[42:43], v[12:13], 0
    ds_read_b128 v[48:51], v4 offset:28672
    v_exp_f32 v19, v31
    v_mov_b32_dpp v34, v32 quad_perm:[0,1,0,1] row_mask:0xf bank_mask:0xf
    v_cvt_pk_bf16_f32 v33, v18, v19
    v_mfma_f32_16x16x16_bf16 v[24:27], v[42:43], v[14:15], 0
    ds_read_b128 v[52:55], v4 offset:29696
    v_add_f32 v8, v16, v17
    v_mov_b32_dpp v35, v33 quad_perm:[0,1,0,1] row_mask:0xf bank_mask:0xf
    v_add_f32 v10, v18, v19
    v_add_f32 v8, v8, v11
    s_waitcnt vmcnt(3)
    v_mfma_f32_16x16x32_bf16 v[20:23], v[72:75], v[32:35], v[20:23]
    ds_read_b128 v[56:59], v4 offset:30720
    v_add_f32 v8, v8, v10
    s_waitcnt vmcnt(2)
    v_mfma_f32_16x16x32_bf16 v[24:27], v[76:79], v[32:35], v[24:27]
    ds_read_b128 v[60:63], v4 offset:31744
    v_add_f32_dpp v9, v8, v8 quad_perm:[2,3,0,1] row_mask:0xf bank_mask:0xf
    v_add_f32_dpp v10, v8, v8 quad_perm:[2,3,0,1] row_mask:0xf bank_mask:0xf
    s_nop 1
    v_permlane16_swap_b32 v9, v10
    v_add_f32 v8, v9, v10
    v_add_f32 v9, v9, v10
    s_nop 1
    v_permlane32_swap_b32 v8, v9
    v_add_f32 v8, v8, v9
    v_rcp_f32 v10, v8
    v_subrev_u32 v8, s47, v8
    v_cmp_le_u32 s[44:45], s50, v8
    v_pk_mul_f32 v[20:21], v[20:21], v[10:11] op_sel_hi:[1,0]
    v_pk_mul_f32 v[22:23], v[22:23], v[10:11] op_sel_hi:[1,0]
    v_pk_mul_f32 v[24:25], v[24:25], v[10:11] op_sel_hi:[1,0]
    v_pk_mul_f32 v[26:27], v[26:27], v[10:11] op_sel_hi:[1,0]
    v_cvt_pk_bf16_f32 v32, v20, v24
    v_cvt_pk_bf16_f32 v33, v21, v25
    v_cvt_pk_bf16_f32 v34, v22, v26
    v_cvt_pk_bf16_f32 v35, v23, v27
    s_cmp_lg_u64 s[44:45], 0
    s_cbranch_scc1 L_sm_L_ch11o_r
L_sm_L_ch11o:
    s_mov_b64 exec, s[36:37]
    ds_write_b128 v3, v[32:35] offset:32
    s_mov_b64 exec, -1
    v_mov_b64 v[36:37], 0
    v_mov_b64 v[38:39], 0
    v_mov_b64 v[28:29], 0
    v_mov_b64 v[30:31], 0
    s_waitcnt lgkmcnt(0)
    s_barrier
    ds_read_b128 v[12:15], v3 offset:0
    ds_read_b128 v[16:19], v3 offset:32
    ds_read_b128 v[20:23], v3 offset:1024
    ds_read_b128 v[24:27], v3 offset:1056
    s_waitcnt lgkmcnt(3)
    v_smfmac_f32_16x16x64_bf16 v[36:39], v[12:15], v[48:55], v1
    ds_read_b128 v[72:75], v4 offset:32768
    s_waitcnt lgkmcnt(3)
    v_smfmac_f32_16x16x64_bf16 v[36:39], v[16:19], v[56:63], v1
    ds_read_b128 v[76:79], v4 offset:33792
    s_waitcnt lgkmcnt(3)
    v_smfmac_f32_16x16x64_bf16 v[36:39], v[20:23], a[216:223], v1
    s_waitcnt lgkmcnt(2)
    v_smfmac_f32_16x16x64_bf16 v[36:39], v[24:27], a[224:231], v1
    v_smfmac_f32_16x16x64_bf16 v[28:31], v[12:15], a[232:239], v1
    v_smfmac_f32_16x16x64_bf16 v[28:31], v[16:19], a[240:247], v1
    v_cvt_pk_bf16_f32 v36, v36, v37
    s_waitcnt lgkmcnt(0)
    v_smfmac_f32_16x16x64_bf16 v[28:31], v[20:23], v[72:79], v1
    v_or_b32 v36, 1, v36
    v_smfmac_f32_16x16x64_bf16 v[28:31], v[24:27], a[248:255], v1
    buffer_store_dword v36, v5, s[4:7], s28 offen
    v_cvt_pk_bf16_f32 v37, v38, v39
    v_or_b32 v37, 1, v37
    buffer_store_dword v37, v5, s[4:7], s29 offen
    s_nop 2
    v_cvt_pk_bf16_f32 v28, v28, v29
    v_cvt_pk_bf16_f32 v29, v30, v31
    v_or_b32 v28, 1, v28
    v_or_b32 v29, 1, v29
    buffer_store_dword v28, v5, s[4:7], s46 offen
    buffer_store_dword v29, v5, s[4:7], s73 offen
    ds_read_b128 v[48:51], v4 offset:0
    ds_read_b128 v[52:55], v4 offset:1024
    ds_read_b128 v[56:59], v4 offset:14336
    ds_read_b128 v[60:63], v4 offset:15360
    v_mov_b32_dpp v9, v42 quad_perm:[0,1,0,1] row_mask:0xf bank_mask:0xf
    v_mov_b32_dpp v10, v43 quad_perm:[0,1,0,1] row_mask:0xf bank_mask:0xf
    v_cndmask_b32 v96, v44, v42, vcc
    v_cndmask_b32 v97, v45, v43, vcc
    v_cndmask_b32 v98, v46, v9, vcc
    v_cndmask_b32 v99, v47, v10, vcc
    v_cndmask_b32 v20, 0, v2, s[42:43]
    v_cndmask_b32 v21, 0, v2, s[42:43]
    v_cndmask_b32 v22, 0, v2, s[42:43]
    v_cndmask_b32 v23, 0, v2, s[42:43]
    s_nop 15
    s_nop 3
    buffer_load_dword v12, v7, s[4:7], s21 offen offset:0 sc1
    buffer_load_dword v13, v7, s[4:7], s21 offen offset:256 sc1
    buffer_load_dword v14, v7, s[4:7], s21 offen offset:512 sc1
    buffer_load_dword v15, v7, s[4:7], s21 offen offset:768 sc1
    buffer_load_dword v16, v7, s[4:7], s21 offen offset:1024 sc1
    buffer_load_dword v17, v7, s[4:7], s21 offen offset:1280 sc1
    buffer_load_dword v18, v7, s[4:7], s21 offen offset:1536 sc1
    buffer_load_dword v19, v7, s[4:7], s21 offen offset:1792 sc1
    v_mov_b64 v[36:37], 0
    v_mov_b64 v[38:39], 0
    v_mov_b64 v[28:29], 0
    v_mov_b64 v[30:31], 0
    s_add_u32 s26, s26, 32768
    s_add_u32 s23, s23, 32768
    s_add_u32 s24, s24, 32768
    s_add_u32 s30, s30, 524288
    s_add_u32 s27, s27, 524288
    s_nop 14
    buffer_load_dword v40, v7, s[4:7], s21 offen offset:0 sc1
    buffer_load_dword v41, v7, s[4:7], s21 offen offset:256 sc1
    buffer_load_dword v42, v7, s[4:7], s21 offen offset:512 sc1
    buffer_load_dword v43, v7, s[4:7], s21 offen offset:768 sc1
    buffer_load_dword v44, v7, s[4:7], s21 offen offset:1024 sc1
    buffer_load_dword v45, v7, s[4:7], s21 offen offset:1280 sc1
    buffer_load_dword v46, v7, s[4:7], s21 offen offset:1536 sc1
    buffer_load_dword v47, v7, s[4:7], s21 offen offset:1792 sc1
    s_waitcnt vmcnt(12)
    v_mfma_f32_16x16x32_bf16 v[32:35], v[12:15], v[20:23], 0
    v_bitop3_b32 v8, v12, v13, v14 bitop3:0x80
    s_waitcnt vmcnt(8)
    v_mfma_f32_16x16x32_bf16 v[32:35], v[16:19], v[20:23], v[32:35]
    v_bitop3_b32 v8, v8, v15, v16 bitop3:0x80
    v_bitop3_b32 v8, v8, v17, v18 bitop3:0x80
    v_bitop3_b32 v8, v8, v19, 1 bitop3:0x80
    v_cmp_ne_u32 vcc, 1, v8
    s_nop 2
    v_cvt_pk_bf16_f32 v10, v32, v33
    v_cvt_pk_bf16_f32 v11, v34, v35
    v_or_b32 v10, 1, v10
    v_or_b32 v11, 1, v11
    s_cbranch_vccnz L_c1_L_ch11o_r
L_c1_L_ch11o:
    buffer_store_dwordx2 v[10:11], v6, s[4:7], s25 offen
    s_barrier
    buffer_store_dwordx2 v[10:11], v6, s[4:7], s26 offen sc1
    s_add_u32 s18, s18, 1
    v_mov_b64 v[32:33], 0
    v_mov_b64 v[34:35], 0
    s_nop 15
    s_nop 15
    s_nop 15
    s_nop 6
    buffer_load_dwordx4 v[24:27], v0, s[4:7], s22 offen sc1
    s_nop 15
    s_nop 3
    buffer_load_dwordx4 v[16:19], v0, s[4:7], s22 offen sc1
    s_waitcnt vmcnt(1)
    v_bitop3_b32 v8, v24, v25, v26 bitop3:0x80
    v_bitop3_b32 v8, v8, v27, 1 bitop3:0x80
    v_cmp_ne_u32 vcc, 1, v8
    ds_write_b128 v0, v[24:27] offset:7168
    s_cbranch_vccnz L_c3_L_ch11o_r
L_c3_L_ch11o:
    buffer_load_dwordx4 v[40:43], v0, s[4:7], s23 offen sc1
    buffer_load_dwordx4 v[44:47], v0, s[4:7], s24 offen sc1
    s_waitcnt lgkmcnt(0)
    s_barrier
    s_branch L_ch1_w1
L_c2_L_ch11e_r:
    s_add_u32 s19, s19, 1
    s_cmp_gt_u32 s19, 4000000
    s_cbranch_scc1 L_cend1
    buffer_load_dwordx4 v[40:43], v0, s[4:7], s23 offen sc1
    buffer_load_dwordx4 v[44:47], v0, s[4:7], s24 offen sc1
    s_waitcnt vmcnt(0)
    v_bitop3_b32 v8, v40, v41, v42 bitop3:0x80
    v_bitop3_b32 v8, v8, v43, v44 bitop3:0x80
    v_bitop3_b32 v8, v8, v45, v46 bitop3:0x80
    v_bitop3_b32 v8, v8, v47, 1 bitop3:0x80
    v_cmp_ne_u32 vcc, 1, v8
    s_cbranch_vccnz L_c2_L_ch11e_r
    ds_write_b128 v0, v[40:43] offset:1024
    ds_write_b128 v0, v[44:47] offset:5120
    s_nop 7
    s_waitcnt lgkmcnt(0)
    s_branch L_c2_L_ch11e
L_sm_L_ch11e_r:
    v_max3_f32 v8, v28, v29, v30
    v_max3_f32 v8, v8, v31, v40
    s_nop 1
    v_max_f32_dpp v9, v8, v8 quad_perm:[2,3,0,1] row_mask:0xf bank_mask:0xf
    v_max_f32_dpp v10, v8, v8 quad_perm:[2,3,0,1] row_mask:0xf bank_mask:0xf
    s_nop 1
    v_permlane16_swap_b32 v9, v10
    v_max_f32 v8, v9, v10
    v_max_f32 v11, v9, v10
    s_nop 1
    v_permlane32_swap_b32 v8, v11
    v_max_f32 v8, v8, v11
    v_sub_f32 v28, v28, v8
    v_sub_f32 v29, v29, v8
    v_sub_f32 v30, v30, v8
    v_sub_f32 v31, v31, v8
    v_sub_f32 v40, v40, v8
    v_exp_f32 v11, v40
    s_nop 1
    v_mov_b32_dpp v9, v11 quad_perm:[0,1,0,1] row_mask:0xf bank_mask:0xf
    v_exp_f32 v16, v28
    v_exp_f32 v17, v29
    v_cvt_pk_bf16_f32 v12, v11, v9
    v_cvt_pk_bf16_f32 v15, v11, v9
    v_cvt_pk_bf16_f32 v32, v16, v17
    v_exp_f32 v18, v30
    v_mfma_f32_16x16x16_bf16 v[20:23], v[42:43], v[12:13], 0
    v_exp_f32 v19, v31
    v_mov_b32_dpp v34, v32 quad_perm:[0,1,0,1] row_mask:0xf bank_mask:0xf
    v_cvt_pk_bf16_f32 v33, v18, v19
    v_mfma_f32_16x16x16_bf16 v[24:27], v[42:43], v[14:15], 0
    v_add_f32 v8, v16, v17
    v_mov_b32_dpp v35, v33 quad_perm:[0,1,0,1] row_mask:0xf bank_mask:0xf
    v_add_f32 v10, v18, v19
    v_add_f32 v8, v8, v11
    v_mfma_f32_16x16x32_bf16 v[20:23], v[72:75], v[32:35], v[20:23]
    v_add_f32 v8, v8, v10
    v_mfma_f32_16x16x32_bf16 v[24:27], v[76:79], v[32:35], v[24:27]
    v_add_f32_dpp v9, v8, v8 quad_perm:[2,3,0,1] row_mask:0xf bank_mask:0xf
    v_add_f32_dpp v10, v8, v8 quad_perm:[2,3,0,1] row_mask:0xf bank_mask:0xf
    s_nop 1
    v_permlane16_swap_b32 v9, v10
    v_add_f32 v8, v9, v10
    v_add_f32 v9, v9, v10
    s_nop 1
    v_permlane32_swap_b32 v8, v9
    v_add_f32 v8, v8, v9
    v_rcp_f32 v10, v8
    s_nop 0
    v_pk_mul_f32 v[20:21], v[20:21], v[10:11] op_sel_hi:[1,0]
    v_pk_mul_f32 v[22:23], v[22:23], v[10:11] op_sel_hi:[1,0]
    v_pk_mul_f32 v[24:25], v[24:25], v[10:11] op_sel_hi:[1,0]
    v_pk_mul_f32 v[26:27], v[26:27], v[10:11] op_sel_hi:[1,0]
    v_cvt_pk_bf16_f32 v32, v20, v24
    v_cvt_pk_bf16_f32 v33, v21, v25
    v_cvt_pk_bf16_f32 v34, v22, v26
    v_cvt_pk_bf16_f32 v35, v23, v27
    s_branch L_sm_L_ch11e
L_c1_L_ch11e_r:
    s_add_u32 s19, s19, 1
    s_cmp_gt_u32 s19, 4000000
    s_cbranch_scc1 L_cend1
    buffer_load_dword v12, v7, s[4:7], s21 offen offset:0 sc1
    buffer_load_dword v13, v7, s[4:7], s21 offen offset:256 sc1
    buffer_load_dword v14, v7, s[4:7], s21 offen offset:512 sc1
    buffer_load_dword v15, v7, s[4:7], s21 offen offset:768 sc1
    buffer_load_dword v16, v7, s[4:7], s21 offen offset:1024 sc1
    buffer_load_dword v17, v7, s[4:7], s21 offen offset:1280 sc1
    buffer_load_dword v18, v7, s[4:7], s21 offen offset:1536 sc1
    buffer_load_dword v19, v7, s[4:7], s21 offen offset:1792 sc1
    s_waitcnt vmcnt(8)
    v_mfma_f32_16x16x32_bf16 v[32:35], v[40:43], v[20:23], 0
    v_or3_b32 v8, v40, v41, v42
    v_mfma_f32_16x16x32_bf16 v[32:35], v[44:47], v[20:23], v[32:35]
    v_or3_b32 v8, v8, v43, v44
    v_or3_b32 v8, v8, v45, v46
    v_or_b32 v8, v8, v47
    v_and_b32 v8, 1, v8
    v_cmp_ne_u32 vcc, 0, v8
    s_nop 1
    v_cvt_pk_bf16_f32 v10, v32, v33
    v_cvt_pk_bf16_f32 v11, v34, v35
    v_and_b32 v10, -2, v10
    v_and_b32 v11, -2, v11
    s_cbranch_vccnz L_c1_L_ch11e_r2
    s_branch L_c1_L_ch11e
L_c1_L_ch11e_r2:
    s_add_u32 s19, s19, 1
    s_cmp_gt_u32 s19, 4000000
    s_cbranch_scc1 L_cend1
    buffer_load_dword v40, v7, s[4:7], s21 offen offset:0 sc1
    buffer_load_dword v41, v7, s[4:7], s21 offen offset:256 sc1
    buffer_load_dword v42, v7, s[4:7], s21 offen offset:512 sc1
    buffer_load_dword v43, v7, s[4:7], s21 offen offset:768 sc1
    buffer_load_dword v44, v7, s[4:7], s21 offen offset:1024 sc1
    buffer_load_dword v45, v7, s[4:7], s21 offen offset:1280 sc1
    buffer_load_dword v46, v7, s[4:7], s21 offen offset:1536 sc1
    buffer_load_dword v47, v7, s[4:7], s21 offen offset:1792 sc1
    s_waitcnt vmcnt(8)
    v_mfma_f32_16x16x32_bf16 v[32:35], v[12:15], v[20:23], 0
    v_or3_b32 v8, v12, v13, v14
    v_mfma_f32_16x16x32_bf16 v[32:35], v[16:19], v[20:23], v[32:35]
    v_or3_b32 v8, v8, v15, v16
    v_or3_b32 v8, v8, v17, v18
    v_or_b32 v8, v8, v19
    v_and_b32 v8, 1, v8
    v_cmp_ne_u32 vcc, 0, v8
    s_nop 1
    v_cvt_pk_bf16_f32 v10, v32, v33
    v_cvt_pk_bf16_f32 v11, v34, v35
    v_and_b32 v10, -2, v10
    v_and_b32 v11, -2, v11
    s_cbranch_vccnz L_c1_L_ch11e_r
    s_branch L_c1_L_ch11e
L_c3_L_ch11e_r:
    s_add_u32 s19, s19, 1
    s_cmp_gt_u32 s19, 4000000
    s_cbranch_scc1 L_cend1
    buffer_load_dwordx4 v[24:27], v0, s[4:7], s22 offen sc1
    s_waitcnt vmcnt(1)
    v_or3_b32 v8, v16, v17, v18
    v_or_b32 v8, v8, v19
    v_and_b32 v8, 1, v8
    v_cmp_ne_u32 vcc, 0, v8
    s_cbranch_vccnz L_c3_L_ch11e_r2
    ds_write_b128 v0, v[16:19] offset:7168
    s_branch L_c3_L_ch11e
L_c3_L_ch11e_r2:
    buffer_load_dwordx4 v[16:19], v0, s[4:7], s22 offen sc1
    s_waitcnt vmcnt(1)
    v_or3_b32 v8, v24, v25, v26
    v_or_b32 v8, v8, v27
    v_and_b32 v8, 1, v8
    v_cmp_ne_u32 vcc, 0, v8
    s_cbranch_vccnz L_c3_L_ch11e_r
    ds_write_b128 v0, v[24:27] offset:7168
    s_branch L_c3_L_ch11e
L_c2_L_ch11o_r:
    s_add_u32 s19, s19, 1
    s_cmp_gt_u32 s19, 4000000
    s_cbranch_scc1 L_cend1
    buffer_load_dwordx4 v[40:43], v0, s[4:7], s23 offen sc1
    buffer_load_dwordx4 v[44:47], v0, s[4:7], s24 offen sc1
    s_waitcnt vmcnt(0)
    v_or3_b32 v8, v40, v41, v42
    v_or3_b32 v8, v8, v43, v44
    v_or3_b32 v8, v8, v45, v46
    v_or_b32 v8, v8, v47
    v_and_b32 v8, 1, v8
    v_cmp_ne_u32 vcc, 0, v8
    s_cbranch_vccnz L_c2_L_ch11o_r
    ds_write_b128 v0, v[40:43] offset:1024
    ds_write_b128 v0, v[44:47] offset:5120
    s_nop 7
    s_waitcnt lgkmcnt(0)
    s_branch L_c2_L_ch11o
L_sm_L_ch11o_r:
    v_max3_f32 v8, v28, v29, v30
    v_max3_f32 v8, v8, v31, v40
    s_nop 1
    v_max_f32_dpp v9, v8, v8 quad_perm:[2,3,0,1] row_mask:0xf bank_mask:0xf
    v_max_f32_dpp v10, v8, v8 quad_perm:[2,3,0,1] row_mask:0xf bank_mask:0xf
    s_nop 1
    v_permlane16_swap_b32 v9, v10
    v_max_f32 v8, v9, v10
    v_max_f32 v11, v9, v10
    s_nop 1
    v_permlane32_swap_b32 v8, v11
    v_max_f32 v8, v8, v11
    v_sub_f32 v28, v28, v8
    v_sub_f32 v29, v29, v8
    v_sub_f32 v30, v30, v8
    v_sub_f32 v31, v31, v8
    v_sub_f32 v40, v40, v8
    v_exp_f32 v11, v40
    s_nop 1
    v_mov_b32_dpp v9, v11 quad_perm:[0,1,0,1] row_mask:0xf bank_mask:0xf
    v_exp_f32 v16, v28
    v_exp_f32 v17, v29
    v_cvt_pk_bf16_f32 v12, v11, v9
    v_cvt_pk_bf16_f32 v15, v11, v9
    v_cvt_pk_bf16_f32 v32, v16, v17
    v_exp_f32 v18, v30
    v_mfma_f32_16x16x16_bf16 v[20:23], v[42:43], v[12:13], 0
    v_exp_f32 v19, v31
    v_mov_b32_dpp v34, v32 quad_perm:[0,1,0,1] row_mask:0xf bank_mask:0xf
    v_cvt_pk_bf16_f32 v33, v18, v19
    v_mfma_f32_16x16x16_bf16 v[24:27], v[42:43], v[14:15], 0
    v_add_f32 v8, v16, v17
    v_mov_b32_dpp v35, v33 quad_perm:[0,1,0,1] row_mask:0xf bank_mask:0xf
    v_add_f32 v10, v18, v19
    v_add_f32 v8, v8, v11
    v_mfma_f32_16x16x32_bf16 v[20:23], v[72:75], v[32:35], v[20:23]
    v_add_f32 v8, v8, v10
    v_mfma_f32_16x16x32_bf16 v[24:27], v[76:79], v[32:35], v[24:27]
    v_add_f32_dpp v9, v8, v8 quad_perm:[2,3,0,1] row_mask:0xf bank_mask:0xf
    v_add_f32_dpp v10, v8, v8 quad_perm:[2,3,0,1] row_mask:0xf bank_mask:0xf
    s_nop 1
    v_permlane16_swap_b32 v9, v10
    v_add_f32 v8, v9, v10
    v_add_f32 v9, v9, v10
    s_nop 1
    v_permlane32_swap_b32 v8, v9
    v_add_f32 v8, v8, v9
    v_rcp_f32 v10, v8
    s_nop 0
    v_pk_mul_f32 v[20:21], v[20:21], v[10:11] op_sel_hi:[1,0]
    v_pk_mul_f32 v[22:23], v[22:23], v[10:11] op_sel_hi:[1,0]
    v_pk_mul_f32 v[24:25], v[24:25], v[10:11] op_sel_hi:[1,0]
    v_pk_mul_f32 v[26:27], v[26:27], v[10:11] op_sel_hi:[1,0]
    v_cvt_pk_bf16_f32 v32, v20, v24
    v_cvt_pk_bf16_f32 v33, v21, v25
    v_cvt_pk_bf16_f32 v34, v22, v26
    v_cvt_pk_bf16_f32 v35, v23, v27
    s_branch L_sm_L_ch11o
L_c1_L_ch11o_r:
    s_add_u32 s19, s19, 1
    s_cmp_gt_u32 s19, 4000000
    s_cbranch_scc1 L_cend1
    buffer_load_dword v12, v7, s[4:7], s21 offen offset:0 sc1
    buffer_load_dword v13, v7, s[4:7], s21 offen offset:256 sc1
    buffer_load_dword v14, v7, s[4:7], s21 offen offset:512 sc1
    buffer_load_dword v15, v7, s[4:7], s21 offen offset:768 sc1
    buffer_load_dword v16, v7, s[4:7], s21 offen offset:1024 sc1
    buffer_load_dword v17, v7, s[4:7], s21 offen offset:1280 sc1
    buffer_load_dword v18, v7, s[4:7], s21 offen offset:1536 sc1
    buffer_load_dword v19, v7, s[4:7], s21 offen offset:1792 sc1
    s_waitcnt vmcnt(8)
    v_mfma_f32_16x16x32_bf16 v[32:35], v[40:43], v[20:23], 0
    v_bitop3_b32 v8, v40, v41, v42 bitop3:0x80
    v_mfma_f32_16x16x32_bf16 v[32:35], v[44:47], v[20:23], v[32:35]
    v_bitop3_b32 v8, v8, v43, v44 bitop3:0x80
    v_bitop3_b32 v8, v8, v45, v46 bitop3:0x80
    v_bitop3_b32 v8, v8, v47, 1 bitop3:0x80
    v_cmp_ne_u32 vcc, 1, v8
    s_nop 2
    v_cvt_pk_bf16_f32 v10, v32, v33
    v_cvt_pk_bf16_f32 v11, v34, v35
    v_or_b32 v10, 1, v10
    v_or_b32 v11, 1, v11
    s_cbranch_vccnz L_c1_L_ch11o_r2
    s_branch L_c1_L_ch11o
L_c1_L_ch11o_r2:
    s_add_u32 s19, s19, 1
    s_cmp_gt_u32 s19, 4000000
    s_cbranch_scc1 L_cend1
    buffer_load_dword v40, v7, s[4:7], s21 offen offset:0 sc1
    buffer_load_dword v41, v7, s[4:7], s21 offen offset:256 sc1
    buffer_load_dword v42, v7, s[4:7], s21 offen offset:512 sc1
    buffer_load_dword v43, v7, s[4:7], s21 offen offset:768 sc1
    buffer_load_dword v44, v7, s[4:7], s21 offen offset:1024 sc1
    buffer_load_dword v45, v7, s[4:7], s21 offen offset:1280 sc1
    buffer_load_dword v46, v7, s[4:7], s21 offen offset:1536 sc1
    buffer_load_dword v47, v7, s[4:7], s21 offen offset:1792 sc1
    s_waitcnt vmcnt(8)
    v_mfma_f32_16x16x32_bf16 v[32:35], v[12:15], v[20:23], 0
    v_bitop3_b32 v8, v12, v13, v14 bitop3:0x80
    v_mfma_f32_16x16x32_bf16 v[32:35], v[16:19], v[20:23], v[32:35]
    v_bitop3_b32 v8, v8, v15, v16 bitop3:0x80
    v_bitop3_b32 v8, v8, v17, v18 bitop3:0x80
    v_bitop3_b32 v8, v8, v19, 1 bitop3:0x80
    v_cmp_ne_u32 vcc, 1, v8
    s_nop 2
    v_cvt_pk_bf16_f32 v10, v32, v33
    v_cvt_pk_bf16_f32 v11, v34, v35
    v_or_b32 v10, 1, v10
    v_or_b32 v11, 1, v11
    s_cbranch_vccnz L_c1_L_ch11o_r
    s_branch L_c1_L_ch11o
L_c3_L_ch11o_r:
    s_add_u32 s19, s19, 1
    s_cmp_gt_u32 s19, 4000000
    s_cbranch_scc1 L_cend1
    buffer_load_dwordx4 v[24:27], v0, s[4:7], s22 offen sc1
    s_waitcnt vmcnt(1)
    v_bitop3_b32 v8, v16, v17, v18 bitop3:0x80
    v_bitop3_b32 v8, v8, v19, 1 bitop3:0x80
    v_cmp_ne_u32 vcc, 1, v8
    s_cbranch_vccnz L_c3_L_ch11o_r2
    ds_write_b128 v0, v[16:19] offset:7168
    s_branch L_c3_L_ch11o
L_c3_L_ch11o_r2:
    buffer_load_dwordx4 v[16:19], v0, s[4:7], s22 offen sc1
    s_waitcnt vmcnt(1)
    v_bitop3_b32 v8, v24, v25, v26 bitop3:0x80
    v_bitop3_b32 v8, v8, v27, 1 bitop3:0x80
    v_cmp_ne_u32 vcc, 1, v8
    s_cbranch_vccnz L_c3_L_ch11o_r
    ds_write_b128 v0, v[24:27] offset:7168
    s_branch L_c3_L_ch11o
    .p2align 6
L_ch1_w2:
    ds_read_b128 v[12:15], v3 offset:6144
    s_waitcnt vmcnt(1)
    ds_read_b128 v[16:19], v3 offset:6176
    s_waitcnt lgkmcnt(1)
    v_smfmac_f32_16x16x64_bf16 v[28:31], v[12:15], v[48:55], v1
    ds_read_b128 v[20:23], v3 offset:7168
    v_smfmac_f32_16x16x64_bf16 v[32:35], v[12:15], v[56:63], v1
    ds_read_b128 v[48:51], v4 offset:2048
    v_smfmac_f32_16x16x64_bf16 v[36:39], v[12:15], v[104:111], v1
    ds_read_b128 v[24:27], v3 offset:7200
    s_waitcnt lgkmcnt(3)
    v_smfmac_f32_16x16x64_bf16 v[28:31], v[16:19], v[112:119], v1
    ds_read_b128 v[52:55], v4 offset:3072
    v_smfmac_f32_16x16x64_bf16 v[32:35], v[16:19], v[120:127], v1
    ds_read_b128 v[56:59], v4 offset:16384
    v_smfmac_f32_16x16x64_bf16 v[36:39], v[16:19], v[128:135], v1
    ds_read_b128 v[12:15], v3 offset:8192
    s_waitcnt lgkmcnt(5)
    v_smfmac_f32_16x16x64_bf16 v[28:31], v[20:23], v[136:143], v1
    ds_read_b128 v[60:63], v4 offset:17408
    v_smfmac_f32_16x16x64_bf16 v[32:35], v[20:23], v[144:151], v1
    s_waitcnt lgkmcnt(3)
    v_smfmac_f32_16x16x64_bf16 v[36:39], v[20:23], v[48:55], v1
    ds_read_b128 v[16:19], v3 offset:8224
    v_smfmac_f32_16x16x64_bf16 v[28:31], v[24:27], v[152:159], v1
    ds_read_b128 v[48:51], v4 offset:4096
    v_smfmac_f32_16x16x64_bf16 v[32:35], v[24:27], v[160:167], v1
    ds_read_b128 v[52:55], v4 offset:5120
    v_smfmac_f32_16x16x64_bf16 v[36:39], v[24:27], v[168:175], v1
    ds_read_b128 v[20:23], v3 offset:9216
    s_waitcnt lgkmcnt(4)
    v_smfmac_f32_16x16x64_bf16 v[28:31], v[12:15], v[56:63], v1
    s_waitcnt vmcnt(0)
    ds_write_b128 v0, v[40:43] offset:2048
    v_bitop3_b32 v8, v40, v41, v42 bitop3:0x80
    v_smfmac_f32_16x16x64_bf16 v[32:35], v[12:15], v[176:183], v1
    ds_read_b128 v[56:59], v4 offset:18432
    v_and_b32 v8, v8, v43
    v_smfmac_f32_16x16x64_bf16 v[36:39], v[12:15], v[184:191], v1
    ds_read_b128 v[24:27], v3 offset:9248
    v_and_or_b32 v8, v8, 1, s35
    s_waitcnt lgkmcnt(6)
    v_smfmac_f32_16x16x64_bf16 v[28:31], v[16:19], v[192:199], v1
    ds_read_b128 v[60:63], v4 offset:19456
    v_cmp_ne_u32 vcc, 1, v8
    s_waitcnt lgkmcnt(5)
    v_smfmac_f32_16x16x64_bf16 v[32:35], v[16:19], v[48:55], v1
    ds_read_b128 v[48:51], v4 offset:6144
    s_nop 0
    v_smfmac_f32_16x16x64_bf16 v[36:39], v[16:19], v[200:207], v1
    ds_read_b128 v[52:55], v4 offset:7168
    s_cbranch_vccnz L_c2_L_ch12e_r
L_c2_L_ch12e:
    s_waitcnt lgkmcnt(6)
    v_smfmac_f32_16x16x64_bf16 v[28:31], v[20:23], v[208:215], v1
    v_smfmac_f32_16x16x64_bf16 v[32:35], v[20:23], v[216:223], v1
    buffer_store_dwordx4 v[96:99], v0, s[4:7], s31 offen sc1
    s_add_u32 s31, s31, 131072
    s_waitcnt lgkmcnt(5)
    s_barrier
    s_mov_b64 vcc, s[36:37]
    s_mov_b32 s35, 0
    s_waitcnt lgkmcnt(2)
    v_smfmac_f32_16x16x64_bf16 v[36:39], v[20:23], v[56:63], v1
    ds_read_b128 v[12:15], v3 offset:0
    v_cndmask_b32 v40, 0, v2, s[38:39]
    v_smfmac_f32_16x16x64_bf16 v[28:31], v[24:27], v[224:231], v1
    ds_read_b128 v[16:19], v3 offset:32
    buffer_load_dwordx4 v[72:75], v0, s[4:7], s27 offen offset:2048 sc1
    v_cndmask_b32 v41, 0, v2, s[40:41]
    v_smfmac_f32_16x16x64_bf16 v[32:35], v[24:27], v[232:239], v1
    ds_read_b128 v[56:59], v4 offset:20480
    v_smfmac_f32_16x16x64_bf16 v[36:39], v[24:27], v[240:247], v1
    ds_read_b128 v[20:23], v3 offset:1024
    buffer_load_dwordx4 v[76:79], v0, s[4:7], s27 offen offset:3072 sc1
    s_waitcnt lgkmcnt(3)
    v_smfmac_f32_16x16x64_bf16 v[28:31], v[12:15], v[48:55], v1
    ds_read_b128 v[60:63], v4 offset:21504
    v_smfmac_f32_16x16x64_bf16 v[32:35], v[12:15], v[248:255], v1
    ds_read_b128 v[48:51], v4 offset:8192
    v_smfmac_f32_16x16x64_bf16 v[36:39], v[12:15], a[0:7], v1
    ds_read_b128 v[24:27], v3 offset:1056
    s_waitcnt lgkmcnt(5)
    v_smfmac_f32_16x16x64_bf16 v[28:31], v[16:19], a[8:15], v1
    ds_read_b128 v[52:55], v4 offset:9216
    s_waitcnt lgkmcnt(3)
    v_smfmac_f32_16x16x64_bf16 v[32:35], v[16:19], v[56:63], v1
    ds_read_b128 v[56:59], v4 offset:22528
    v_smfmac_f32_16x16x64_bf16 v[36:39], v[16:19], a[16:23], v1
    ds_read_b128 v[12:15], v3 offset:2048
    v_smfmac_f32_16x16x64_bf16 v[28:31], v[20:23], a[24:31], v1
    ds_read_b128 v[60:63], v4 offset:23552
    v_smfmac_f32_16x16x64_bf16 v[32:35], v[20:23], a[32:39], v1
    s_waitcnt lgkmcnt(3)
    v_smfmac_f32_16x16x64_bf16 v[36:39], v[20:23], v[48:55], v1
    ds_read_b128 v[16:19], v3 offset:2080
    v_smfmac_f32_16x16x64_bf16 v[28:31], v[24:27], a[40:47], v1
    ds_read_b128 v[48:51], v4 offset:10240
    v_smfmac_f32_16x16x64_bf16 v[32:35], v[24:27], a[48:55], v1
    ds_read_b128 v[52:55], v4 offset:11264
    v_smfmac_f32_16x16x64_bf16 v[36:39], v[24:27], a[56:63], v1
    ds_read_b128 v[20:23], v3 offset:3072
    s_waitcnt lgkmcnt(4)
    v_smfmac_f32_16x16x64_bf16 v[28:31], v[12:15], v[56:63], v1
    ds_read_b128 v[56:59], v4 offset:24576
    v_smfmac_f32_16x16x64_bf16 v[32:35], v[12:15], a[64:71], v1
    ds_read_b128 v[60:63], v4 offset:25600
    v_smfmac_f32_16x16x64_bf16 v[36:39], v[12:15], a[72:79], v1
    ds_read_b128 v[24:27], v3 offset:3104
    s_waitcnt lgkmcnt(6)
    v_smfmac_f32_16x16x64_bf16 v[28:31], v[16:19], a[80:87], v1
    s_waitcnt lgkmcnt(4)
    v_smfmac_f32_16x16x64_bf16 v[32:35], v[16:19], v[48:55], v1
    ds_read_b128 v[48:51], v4 offset:12288
    v_smfmac_f32_16x16x64_bf16 v[36:39], v[16:19], a[88:95], v1
    ds_read_b128 v[12:15], v3 offset:4096
    s_waitcnt lgkmcnt(5)
    v_smfmac_f32_16x16x64_bf16 v[28:31], v[20:23], a[96:103], v1
    ds_read_b128 v[52:55], v4 offset:13312
    v_smfmac_f32_16x16x64_bf16 v[32:35], v[20:23], a[104:111], v1
    ds_read_b128 v[16:19], v3 offset:4128
    s_waitcnt lgkmcnt(5)
    v_smfmac_f32_16x16x64_bf16 v[36:39], v[20:23], v[56:63], v1
    ds_read_b128 v[56:59], v4 offset:26624
    s_waitcnt lgkmcnt(5)
    v_smfmac_f32_16x16x64_bf16 v[28:31], v[24:27], a[112:119], v1
    ds_read_b128 v[20:23], v3 offset:5120
    v_smfmac_f32_16x16x64_bf16 v[32:35], v[24:27], a[120:127], v1
    ds_read_b128 v[60:63], v4 offset:27648
    v_smfmac_f32_16x16x64_bf16 v[36:39], v[24:27], a[128:135], v1
    ds_read_b128 v[24:27], v3 offset:5152
    s_waitcnt lgkmcnt(5)
    v_smfmac_f32_16x16x64_bf16 v[28:31], v[12:15], v[48:55], v1
    v_smfmac_f32_16x16x64_bf16 v[32:35], v[12:15], a[136:143], v1
    s_waitcnt lgkmcnt(4)
    v_smfmac_f32_16x16x64_bf16 v[28:31], v[16:19], a[144:151], v1
    v_smfmac_f32_16x16x64_bf16 v[32:35], v[16:19], a[152:159], v1
    s_waitcnt lgkmcnt(1)
    v_smfmac_f32_16x16x64_bf16 v[28:31], v[20:23], v[56:63], v1
    v_smfmac_f32_16x16x64_bf16 v[32:35], v[20:23], a[160:167], v1
    s_waitcnt lgkmcnt(0)
    v_smfmac_f32_16x16x64_bf16 v[28:31], v[24:27], a[168:175], v1
    v_smfmac_f32_16x16x64_bf16 v[32:35], v[24:27], a[176:183], v1
    v_smfmac_f32_16x16x64_bf16 v[36:39], v[12:15], a[184:191], v1
    v_smfmac_f32_16x16x64_bf16 v[36:39], v[16:19], a[192:199], v1
    v_cvt_pk_bf16_f32 v44, v28, v29
    v_cvt_pk_bf16_f32 v45, v32, v33
    v_cvt_pk_bf16_f32 v46, v30, v31
    v_cvt_pk_bf16_f32 v47, v34, v35
    v_mfma_f32_16x16x16_bf16 v[28:31], v[44:45], v[40:41], 0
    v_mfma_f32_16x16x16_bf16 v[32:35], v[46:47], v[40:41], 0
    v_smfmac_f32_16x16x64_bf16 v[36:39], v[20:23], a[200:207], v1
    s_nop 3
    v_cvt_pk_bf16_f32 v44, v28, v32
    v_cvt_pk_bf16_f32 v45, v29, v33
    v_cvt_pk_bf16_f32 v46, v30, v34
    v_cvt_pk_bf16_f32 v47, v31, v35
    s_nop 1
    v_mfma_f32_16x16x32_bf16 v[32:35], v[68:71], v[44:47], 0
    v_mfma_f32_16x16x32_bf16 v[28:31], v[64:67], v[44:47], 0
    v_mfma_f32_16x16x32_bf16 v[12:15], v[44:47], v[44:47], 0
    v_smfmac_f32_16x16x64_bf16 v[36:39], v[24:27], a[208:215], v1
    v_cndmask_b32_dpp v28, v32, v28, vcc quad_perm:[2,3,2,3] row_mask:0xf bank_mask:0xf
    v_cndmask_b32_dpp v29, v33, v29, vcc quad_perm:[2,3,2,3] row_mask:0xf bank_mask:0xf
    v_cndmask_b32_dpp v30, v34, v30, vcc quad_perm:[2,3,2,3] row_mask:0xf bank_mask:0xf
    v_cndmask_b32_dpp v31, v35, v31, vcc quad_perm:[2,3,2,3] row_mask:0xf bank_mask:0xf
    ds_write_b128 v0, v[28:31] offset:12288
    v_cndmask_b32_dpp v11, v13, v12, vcc quad_perm:[2,3,2,3] row_mask:0xf bank_mask:0xf
    ds_write_b32 v0, v11 offset:14344
    buffer_load_dwordx4 v[64:67], v0, s[4:7], s30 offen offset:0 sc1
    buffer_load_dwordx4 v[68:71], v0, s[4:7], s30 offen offset:1024 sc1
    s_waitcnt lgkmcnt(0)
    s_barrier
    ds_read_b128 v[24:27], v0 offset:14336
    ds_read_b128 v[28:31], v0 offset:10240
    ds_read_b128 v[32:35], v0 offset:11264
    ds_read_b128 v[16:19], v0 offset:12288
    ds_read_b128 v[20:23], v0 offset:13312
    v_cvt_pk_bf16_f32 v42, v36, v37
    v_cvt_pk_bf16_f32 v43, v38, v39
    v_mov_b32 v13, 0
    v_mov_b32 v14, 0
    s_waitcnt lgkmcnt(4)
    v_pk_add_f32 v[24:25], v[24:25], v[26:27]
    v_add_f32 v24, v24, v25
    v_mul_f32 v40, s20, v24
    s_waitcnt lgkmcnt(3)
    v_pk_mul_f32 v[28:29], v[28:29], s[48:49]
    v_pk_mul_f32 v[30:31], v[30:31], s[48:49]
    v_exp_f32 v11, v40
    s_waitcnt lgkmcnt(2)
    v_pk_fma_f32 v[28:29], v[32:33], s[48:49], v[28:29]
    v_pk_fma_f32 v[30:31], v[34:35], s[48:49], v[30:31]
    s_waitcnt lgkmcnt(1)
    v_pk_fma_f32 v[28:29], v[16:17], s[48:49], v[28:29]
    v_pk_fma_f32 v[30:31], v[18:19], s[48:49], v[30:31]
    s_waitcnt lgkmcnt(0)
    v_pk_fma_f32 v[28:29], v[20:21], s[48:49], v[28:29]
    v_pk_fma_f32 v[30:31], v[22:23], s[48:49], v[30:31]
    v_mov_b32_dpp v9, v11 quad_perm:[0,1,0,1] row_mask:0xf bank_mask:0xf
    v_exp_f32 v16, v28
    v_exp_f32 v17, v29
    v_cvt_pk_bf16_f32 v12, v11, v9
    v_cvt_pk_bf16_f32 v15, v11, v9
    v_cvt_pk_bf16_f32 v32, v16, v17
    v_exp_f32 v18, v30
    v_mfma_f32_16x16x16_bf16 v[20:23], v[42:43], v[12:13], 0
    ds_read_b128 v[48:51], v4 offset:28672
    v_exp_f32 v19, v31
    v_mov_b32_dpp v34, v32 quad_perm:[0,1,0,1] row_mask:0xf bank_mask:0xf
    v_cvt_pk_bf16_f32 v33, v18, v19
    v_mfma_f32_16x16x16_bf16 v[24:27], v[42:43], v[14:15], 0
    ds_read_b128 v[52:55], v4 offset:29696
    v_add_f32 v8, v16, v17
    v_mov_b32_dpp v35, v33 quad_perm:[0,1,0,1] row_mask:0xf bank_mask:0xf
    v_add_f32 v10, v18, v19
    v_add_f32 v8, v8, v11
    s_waitcnt vmcnt(3)
    v_mfma_f32_16x16x32_bf16 v[20:23], v[72:75], v[32:35], v[20:23]
    ds_read_b128 v[56:59], v4 offset:30720
    v_add_f32 v8, v8, v10
    s_waitcnt vmcnt(2)
    v_mfma_f32_16x16x32_bf16 v[24:27], v[76:79], v[32:35], v[24:27]
    ds_read_b128 v[60:63], v4 offset:31744
    v_add_f32_dpp v9, v8, v8 quad_perm:[2,3,0,1] row_mask:0xf bank_mask:0xf
    v_add_f32_dpp v10, v8, v8 quad_perm:[2,3,0,1] row_mask:0xf bank_mask:0xf
    s_nop 1
    v_permlane16_swap_b32 v9, v10
    v_add_f32 v8, v9, v10
    v_add_f32 v9, v9, v10
    s_nop 1
    v_permlane32_swap_b32 v8, v9
    v_add_f32 v8, v8, v9
    v_rcp_f32 v10, v8
    v_subrev_u32 v8, s47, v8
    v_cmp_le_u32 s[44:45], s50, v8
    v_pk_mul_f32 v[20:21], v[20:21], v[10:11] op_sel_hi:[1,0]
    v_pk_mul_f32 v[22:23], v[22:23], v[10:11] op_sel_hi:[1,0]
    v_pk_mul_f32 v[24:25], v[24:25], v[10:11] op_sel_hi:[1,0]
    v_pk_mul_f32 v[26:27], v[26:27], v[10:11] op_sel_hi:[1,0]
    v_cvt_pk_bf16_f32 v32, v20, v24
    v_cvt_pk_bf16_f32 v33, v21, v25
    v_cvt_pk_bf16_f32 v34, v22, v26
    v_cvt_pk_bf16_f32 v35, v23, v27
    s_cmp_lg_u64 s[44:45], 0
    s_cbranch_scc1 L_sm_L_ch12e_r
L_sm_L_ch12e:
    s_mov_b64 exec, s[36:37]
    ds_write_b128 v3, v[32:35] offset:1024
    s_mov_b64 exec, -1
    v_mov_b64 v[36:37], 0
    v_mov_b64 v[38:39], 0
    v_mov_b64 v[28:29], 0
    v_mov_b64 v[30:31], 0
    s_waitcnt lgkmcnt(0)
    s_barrier
    ds_read_b128 v[12:15], v3 offset:0
    ds_read_b128 v[16:19], v3 offset:32
    ds_read_b128 v[20:23], v3 offset:1024
    ds_read_b128 v[24:27], v3 offset:1056
    s_waitcnt lgkmcnt(3)
    v_smfmac_f32_16x16x64_bf16 v[36:39], v[12:15], v[48:55], v1
    ds_read_b128 v[72:75], v4 offset:32768
    s_waitcnt lgkmcnt(3)
    v_smfmac_f32_16x16x64_bf16 v[36:39], v[16:19], v[56:63], v1
    ds_read_b128 v[76:79], v4 offset:33792
    s_waitcnt lgkmcnt(3)
    v_smfmac_f32_16x16x64_bf16 v[36:39], v[20:23], a[216:223], v1
    s_waitcnt lgkmcnt(2)
    v_smfmac_f32_16x16x64_bf16 v[36:39], v[24:27], a[224:231], v1
    v_smfmac_f32_16x16x64_bf16 v[28:31], v[12:15], a[232:239], v1
    v_smfmac_f32_16x16x64_bf16 v[28:31], v[16:19], a[240:247], v1
    v_cvt_pk_bf16_f32 v36, v36, v37
    s_waitcnt lgkmcnt(0)
    v_smfmac_f32_16x16x64_bf16 v[28:31], v[20:23], v[72:79], v1
    v_and_b32 v36, -2, v36
    v_smfmac_f32_16x16x64_bf16 v[28:31], v[24:27], a[248:255], v1
    buffer_store_dword v36, v5, s[4:7], s28 offen
    v_cvt_pk_bf16_f32 v37, v38, v39
    v_and_b32 v37, -2, v37
    buffer_store_dword v37, v5, s[4:7], s29 offen
    s_nop 2
    v_cvt_pk_bf16_f32 v28, v28, v29
    v_cvt_pk_bf16_f32 v29, v30, v31
    v_and_b32 v28, -2, v28
    v_and_b32 v29, -2, v29
    buffer_store_dword v28, v5, s[4:7], s46 offen
    buffer_store_dword v29, v5, s[4:7], s73 offen
    ds_read_b128 v[48:51], v4 offset:0
    ds_read_b128 v[52:55], v4 offset:1024
    ds_read_b128 v[56:59], v4 offset:14336
    ds_read_b128 v[60:63], v4 offset:15360
    v_mov_b32_dpp v9, v42 quad_perm:[0,1,0,1] row_mask:0xf bank_mask:0xf
    v_mov_b32_dpp v10, v43 quad_perm:[0,1,0,1] row_mask:0xf bank_mask:0xf
    v_cndmask_b32 v96, v44, v42, vcc
    v_cndmask_b32 v97, v45, v43, vcc
    v_cndmask_b32 v98, v46, v9, vcc
    v_cndmask_b32 v99, v47, v10, vcc
    v_mov_b64 v[28:29], 0
    v_mov_b64 v[30:31], 0
    v_mov_b64 v[36:37], 0
    v_mov_b64 v[38:39], 0
    s_add_u32 s26, s26, 32768
    s_add_u32 s23, s23, 32768
    s_add_u32 s24, s24, 32768
    s_add_u32 s30, s30, 524288
    s_add_u32 s27, s27, 524288
    s_barrier
    s_add_u32 s18, s18, 1
    v_mov_b64 v[32:33], 0
    v_mov_b64 v[34:35], 0
    s_nop 15
    s_nop 15
    s_nop 15
    s_nop 6
    buffer_load_dwordx4 v[24:27], v0, s[4:7], s22 offen sc1
    s_nop 15
    s_nop 3
    buffer_load_dwordx4 v[16:19], v0, s[4:7], s22 offen sc1
    s_waitcnt vmcnt(1)
    v_or3_b32 v8, v24, v25, v26
    v_or_b32 v8, v8, v27
    v_and_b32 v8, 1, v8
    v_cmp_ne_u32 vcc, 0, v8
    ds_write_b128 v0, v[24:27] offset:8192
    s_cbranch_vccnz L_c3_L_ch12e_r
L_c3_L_ch12e:
    buffer_load_dwordx4 v[40:43], v0, s[4:7], s23 offen sc1
    s_waitcnt lgkmcnt(0)
    s_barrier
    ds_read_b128 v[12:15], v3 offset:6144
    s_waitcnt vmcnt(1)
    ds_read_b128 v[16:19], v3 offset:6176
    s_waitcnt lgkmcnt(1)
    v_smfmac_f32_16x16x64_bf16 v[28:31], v[12:15], v[48:55], v1
    ds_read_b128 v[20:23], v3 offset:7168
    v_smfmac_f32_16x16x64_bf16 v[32:35], v[12:15], v[56:63], v1
    ds_read_b128 v[48:51], v4 offset:2048
    v_smfmac_f32_16x16x64_bf16 v[36:39], v[12:15], v[104:111], v1
    ds_read_b128 v[24:27], v3 offset:7200
    s_waitcnt lgkmcnt(3)
    v_smfmac_f32_16x16x64_bf16 v[28:31], v[16:19], v[112:119], v1
    ds_read_b128 v[52:55], v4 offset:3072
    v_smfmac_f32_16x16x64_bf16 v[32:35], v[16:19], v[120:127], v1
    ds_read_b128 v[56:59], v4 offset:16384
    v_smfmac_f32_16x16x64_bf16 v[36:39], v[16:19], v[128:135], v1
    ds_read_b128 v[12:15], v3 offset:8192
    s_waitcnt lgkmcnt(5)
    v_smfmac_f32_16x16x64_bf16 v[28:31], v[20:23], v[136:143], v1
    ds_read_b128 v[60:63], v4 offset:17408
    v_smfmac_f32_16x16x64_bf16 v[32:35], v[20:23], v[144:151], v1
    s_waitcnt lgkmcnt(3)
    v_smfmac_f32_16x16x64_bf16 v[36:39], v[20:23], v[48:55], v1
    ds_read_b128 v[16:19], v3 offset:8224
    v_smfmac_f32_16x16x64_bf16 v[28:31], v[24:27], v[152:159], v1
    ds_read_b128 v[48:51], v4 offset:4096
    v_smfmac_f32_16x16x64_bf16 v[32:35], v[24:27], v[160:167], v1
    ds_read_b128 v[52:55], v4 offset:5120
    v_smfmac_f32_16x16x64_bf16 v[36:39], v[24:27], v[168:175], v1
    ds_read_b128 v[20:23], v3 offset:9216
    s_waitcnt lgkmcnt(4)
    v_smfmac_f32_16x16x64_bf16 v[28:31], v[12:15], v[56:63], v1
    s_waitcnt vmcnt(0)
    ds_write_b128 v0, v[40:43] offset:2048
    v_or3_b32 v8, v40, v41, v42
    v_smfmac_f32_16x16x64_bf16 v[32:35], v[12:15], v[176:183], v1
    ds_read_b128 v[56:59], v4 offset:18432
    v_or_b32 v8, v8, v43
    v_smfmac_f32_16x16x64_bf16 v[36:39], v[12:15], v[184:191], v1
    ds_read_b128 v[24:27], v3 offset:9248
    v_and_b32 v8, 1, v8
    s_waitcnt lgkmcnt(6)
    v_smfmac_f32_16x16x64_bf16 v[28:31], v[16:19], v[192:199], v1
    ds_read_b128 v[60:63], v4 offset:19456
    v_cmp_ne_u32 vcc, 0, v8
    s_waitcnt lgkmcnt(5)
    v_smfmac_f32_16x16x64_bf16 v[32:35], v[16:19], v[48:55], v1
    ds_read_b128 v[48:51], v4 offset:6144
    s_nop 0
    v_smfmac_f32_16x16x64_bf16 v[36:39], v[16:19], v[200:207], v1
    ds_read_b128 v[52:55], v4 offset:7168
    s_cbranch_vccnz L_c2_L_ch12o_r
L_c2_L_ch12o:
    s_waitcnt lgkmcnt(6)
    v_smfmac_f32_16x16x64_bf16 v[28:31], v[20:23], v[208:215], v1
    v_smfmac_f32_16x16x64_bf16 v[32:35], v[20:23], v[216:223], v1
    buffer_store_dwordx4 v[96:99], v0, s[4:7], s31 offen sc1
    s_add_u32 s31, s31, 131072
    s_waitcnt lgkmcnt(5)
    s_barrier
    s_mov_b64 vcc, s[36:37]
    s_waitcnt lgkmcnt(2)
    v_smfmac_f32_16x16x64_bf16 v[36:39], v[20:23], v[56:63], v1
    ds_read_b128 v[12:15], v3 offset:0
    v_cndmask_b32 v40, 0, v2, s[38:39]
    v_smfmac_f32_16x16x64_bf16 v[28:31], v[24:27], v[224:231], v1
    ds_read_b128 v[16:19], v3 offset:32
    buffer_load_dwordx4 v[72:75], v0, s[4:7], s27 offen offset:2048 sc1
    v_cndmask_b32 v41, 0, v2, s[40:41]
    v_smfmac_f32_16x16x64_bf16 v[32:35], v[24:27], v[232:239], v1
    ds_read_b128 v[56:59], v4 offset:20480
    v_smfmac_f32_16x16x64_bf16 v[36:39], v[24:27], v[240:247], v1
    ds_read_b128 v[20:23], v3 offset:1024
    buffer_load_dwordx4 v[76:79], v0, s[4:7], s27 offen offset:3072 sc1
    s_waitcnt lgkmcnt(3)
    v_smfmac_f32_16x16x64_bf16 v[28:31], v[12:15], v[48:55], v1
    ds_read_b128 v[60:63], v4 offset:21504
    v_smfmac_f32_16x16x64_bf16 v[32:35], v[12:15], v[248:255], v1
    ds_read_b128 v[48:51], v4 offset:8192
    v_smfmac_f32_16x16x64_bf16 v[36:39], v[12:15], a[0:7], v1
    ds_read_b128 v[24:27], v3 offset:1056
    s_waitcnt lgkmcnt(5)
    v_smfmac_f32_16x16x64_bf16 v[28:31], v[16:19], a[8:15], v1
    ds_read_b128 v[52:55], v4 offset:9216
    s_waitcnt lgkmcnt(3)
    v_smfmac_f32_16x16x64_bf16 v[32:35], v[16:19], v[56:63], v1
    ds_read_b128 v[56:59], v4 offset:22528
    v_smfmac_f32_16x16x64_bf16 v[36:39], v[16:19], a[16:23], v1
    ds_read_b128 v[12:15], v3 offset:2048
    v_smfmac_f32_16x16x64_bf16 v[28:31], v[20:23], a[24:31], v1
    ds_read_b128 v[60:63], v4 offset:23552
    v_smfmac_f32_16x16x64_bf16 v[32:35], v[20:23], a[32:39], v1
    s_waitcnt lgkmcnt(3)
    v_smfmac_f32_16x16x64_bf16 v[36:39], v[20:23], v[48:55], v1
    ds_read_b128 v[16:19], v3 offset:2080
    v_smfmac_f32_16x16x64_bf16 v[28:31], v[24:27], a[40:47], v1
    ds_read_b128 v[48:51], v4 offset:10240
    v_smfmac_f32_16x16x64_bf16 v[32:35], v[24:27], a[48:55], v1
    ds_read_b128 v[52:55], v4 offset:11264
    v_smfmac_f32_16x16x64_bf16 v[36:39], v[24:27], a[56:63], v1
    ds_read_b128 v[20:23], v3 offset:3072
    s_waitcnt lgkmcnt(4)
    v_smfmac_f32_16x16x64_bf16 v[28:31], v[12:15], v[56:63], v1
    ds_read_b128 v[56:59], v4 offset:24576
    v_smfmac_f32_16x16x64_bf16 v[32:35], v[12:15], a[64:71], v1
    ds_read_b128 v[60:63], v4 offset:25600
    v_smfmac_f32_16x16x64_bf16 v[36:39], v[12:15], a[72:79], v1
    ds_read_b128 v[24:27], v3 offset:3104
    s_waitcnt lgkmcnt(6)
    v_smfmac_f32_16x16x64_bf16 v[28:31], v[16:19], a[80:87], v1
    s_waitcnt lgkmcnt(4)
    v_smfmac_f32_16x16x64_bf16 v[32:35], v[16:19], v[48:55], v1
    ds_read_b128 v[48:51], v4 offset:12288
    v_smfmac_f32_16x16x64_bf16 v[36:39], v[16:19], a[88:95], v1
    ds_read_b128 v[12:15], v3 offset:4096
    s_waitcnt lgkmcnt(5)
    v_smfmac_f32_16x16x64_bf16 v[28:31], v[20:23], a[96:103], v1
    ds_read_b128 v[52:55], v4 offset:13312
    v_smfmac_f32_16x16x64_bf16 v[32:35], v[20:23], a[104:111], v1
    ds_read_b128 v[16:19], v3 offset:4128
    s_waitcnt lgkmcnt(5)
    v_smfmac_f32_16x16x64_bf16 v[36:39], v[20:23], v[56:63], v1
    ds_read_b128 v[56:59], v4 offset:26624
    s_waitcnt lgkmcnt(5)
    v_smfmac_f32_16x16x64_bf16 v[28:31], v[24:27], a[112:119], v1
    ds_read_b128 v[20:23], v3 offset:5120
    v_smfmac_f32_16x16x64_bf16 v[32:35], v[24:27], a[120:127], v1
    ds_read_b128 v[60:63], v4 offset:27648
    v_smfmac_f32_16x16x64_bf16 v[36:39], v[24:27], a[128:135], v1
    ds_read_b128 v[24:27], v3 offset:5152
    s_waitcnt lgkmcnt(5)
    v_smfmac_f32_16x16x64_bf16 v[28:31], v[12:15], v[48:55], v1
    v_smfmac_f32_16x16x64_bf16 v[32:35], v[12:15], a[136:143], v1
    s_waitcnt lgkmcnt(4)
    v_smfmac_f32_16x16x64_bf16 v[28:31], v[16:19], a[144:151], v1
    v_smfmac_f32_16x16x64_bf16 v[32:35], v[16:19], a[152:159], v1
    s_waitcnt lgkmcnt(1)
    v_smfmac_f32_16x16x64_bf16 v[28:31], v[20:23], v[56:63], v1
    v_smfmac_f32_16x16x64_bf16 v[32:35], v[20:23], a[160:167], v1
    s_waitcnt lgkmcnt(0)
    v_smfmac_f32_16x16x64_bf16 v[28:31], v[24:27], a[168:175], v1
    v_smfmac_f32_16x16x64_bf16 v[32:35], v[24:27], a[176:183], v1
    v_smfmac_f32_16x16x64_bf16 v[36:39], v[12:15], a[184:191], v1
    v_smfmac_f32_16x16x64_bf16 v[36:39], v[16:19], a[192:199], v1
    v_cvt_pk_bf16_f32 v44, v28, v29
    v_cvt_pk_bf16_f32 v45, v32, v33
    v_cvt_pk_bf16_f32 v46, v30, v31
    v_cvt_pk_bf16_f32 v47, v34, v35
    v_mfma_f32_16x16x16_bf16 v[28:31], v[44:45], v[40:41], 0
    v_mfma_f32_16x16x16_bf16 v[32:35], v[46:47], v[40:41], 0
    v_smfmac_f32_16x16x64_bf16 v[36:39], v[20:23], a[200:207], v1
    s_nop 3
    v_cvt_pk_bf16_f32 v44, v28, v32
    v_cvt_pk_bf16_f32 v45, v29, v33
    v_cvt_pk_bf16_f32 v46, v30, v34
    v_cvt_pk_bf16_f32 v47, v31, v35
    s_nop 1
    v_mfma_f32_16x16x32_bf16 v[32:35], v[68:71], v[44:47], 0
    v_mfma_f32_16x16x32_bf16 v[28:31], v[64:67], v[44:47], 0
    v_mfma_f32_16x16x32_bf16 v[12:15], v[44:47], v[44:47], 0
    v_smfmac_f32_16x16x64_bf16 v[36:39], v[24:27], a[208:215], v1
    v_cndmask_b32_dpp v28, v32, v28, vcc quad_perm:[2,3,2,3] row_mask:0xf bank_mask:0xf
    v_cndmask_b32_dpp v29, v33, v29, vcc quad_perm:[2,3,2,3] row_mask:0xf bank_mask:0xf
    v_cndmask_b32_dpp v30, v34, v30, vcc quad_perm:[2,3,2,3] row_mask:0xf bank_mask:0xf
    v_cndmask_b32_dpp v31, v35, v31, vcc quad_perm:[2,3,2,3] row_mask:0xf bank_mask:0xf
    ds_write_b128 v0, v[28:31] offset:12288
    v_cndmask_b32_dpp v11, v13, v12, vcc quad_perm:[2,3,2,3] row_mask:0xf bank_mask:0xf
    ds_write_b32 v0, v11 offset:14344
    buffer_load_dwordx4 v[64:67], v0, s[4:7], s30 offen offset:0 sc1
    buffer_load_dwordx4 v[68:71], v0, s[4:7], s30 offen offset:1024 sc1
    s_waitcnt lgkmcnt(0)
    s_barrier
    ds_read_b128 v[24:27], v0 offset:14336
    ds_read_b128 v[28:31], v0 offset:10240
    ds_read_b128 v[32:35], v0 offset:11264
    ds_read_b128 v[16:19], v0 offset:12288
    ds_read_b128 v[20:23], v0 offset:13312
    v_cvt_pk_bf16_f32 v42, v36, v37
    v_cvt_pk_bf16_f32 v43, v38, v39
    v_mov_b32 v13, 0
    v_mov_b32 v14, 0
    s_cmp_ge_u32 s18, 63
    s_cbranch_scc1 L_cdone1
    s_waitcnt lgkmcnt(4)
    v_pk_add_f32 v[24:25], v[24:25], v[26:27]
    v_add_f32 v24, v24, v25
    v_mul_f32 v40, s20, v24
    s_waitcnt lgkmcnt(3)
    v_pk_mul_f32 v[28:29], v[28:29], s[48:49]
    v_pk_mul_f32 v[30:31], v[30:31], s[48:49]
    v_exp_f32 v11, v40
    s_waitcnt lgkmcnt(2)
    v_pk_fma_f32 v[28:29], v[32:33], s[48:49], v[28:29]
    v_pk_fma_f32 v[30:31], v[34:35], s[48:49], v[30:31]
    s_waitcnt lgkmcnt(1)
    v_pk_fma_f32 v[28:29], v[16:17], s[48:49], v[28:29]
    v_pk_fma_f32 v[30:31], v[18:19], s[48:49], v[30:31]
    s_waitcnt lgkmcnt(0)
    v_pk_fma_f32 v[28:29], v[20:21], s[48:49], v[28:29]
    v_pk_fma_f32 v[30:31], v[22:23], s[48:49], v[30:31]
    v_mov_b32_dpp v9, v11 quad_perm:[0,1,0,1] row_mask:0xf bank_mask:0xf
    v_exp_f32 v16, v28
    v_exp_f32 v17, v29
    v_cvt_pk_bf16_f32 v12, v11, v9
    v_cvt_pk_bf16_f32 v15, v11, v9
    v_cvt_pk_bf16_f32 v32, v16, v17
    v_exp_f32 v18, v30
    v_mfma_f32_16x16x16_bf16 v[20:23], v[42:43], v[12:13], 0
    ds_read_b128 v[48:51], v4 offset:28672
    v_exp_f32 v19, v31
    v_mov_b32_dpp v34, v32 quad_perm:[0,1,0,1] row_mask:0xf bank_mask:0xf
    v_cvt_pk_bf16_f32 v33, v18, v19
    v_mfma_f32_16x16x16_bf16 v[24:27], v[42:43], v[14:15], 0
    ds_read_b128 v[52:55], v4 offset:29696
    v_add_f32 v8, v16, v17
    v_mov_b32_dpp v35, v33 quad_perm:[0,1,0,1] row_mask:0xf bank_mask:0xf
    v_add_f32 v10, v18, v19
    v_add_f32 v8, v8, v11
    s_waitcnt vmcnt(3)
    v_mfma_f32_16x16x32_bf16 v[20:23], v[72:75], v[32:35], v[20:23]
    ds_read_b128 v[56:59], v4 offset:30720
    v_add_f32 v8, v8, v10
    s_waitcnt vmcnt(2)
    v_mfma_f32_16x16x32_bf16 v[24:27], v[76:79], v[32:35], v[24:27]
    ds_read_b128 v[60:63], v4 offset:31744
    v_add_f32_dpp v9, v8, v8 quad_perm:[2,3,0,1] row_mask:0xf bank_mask:0xf
    v_add_f32_dpp v10, v8, v8 quad_perm:[2,3,0,1] row_mask:0xf bank_mask:0xf
    s_nop 1
    v_permlane16_swap_b32 v9, v10
    v_add_f32 v8, v9, v10
    v_add_f32 v9, v9, v10
    s_nop 1
    v_permlane32_swap_b32 v8, v9
    v_add_f32 v8, v8, v9
    v_rcp_f32 v10, v8
    v_subrev_u32 v8, s47, v8
    v_cmp_le_u32 s[44:45], s50, v8
    v_pk_mul_f32 v[20:21], v[20:21], v[10:11] op_sel_hi:[1,0]
    v_pk_mul_f32 v[22:23], v[22:23], v[10:11] op_sel_hi:[1,0]
    v_pk_mul_f32 v[24:25], v[24:25], v[10:11] op_sel_hi:[1,0]
    v_pk_mul_f32 v[26:27], v[26:27], v[10:11] op_sel_hi:[1,0]
    v_cvt_pk_bf16_f32 v32, v20, v24
    v_cvt_pk_bf16_f32 v33, v21, v25
    v_cvt_pk_bf16_f32 v34, v22, v26
    v_cvt_pk_bf16_f32 v35, v23, v27
    s_cmp_lg_u64 s[44:45], 0
    s_cbranch_scc1 L_sm_L_ch12o_r
L_sm_L_ch12o:
    s_mov_b64 exec, s[36:37]
    ds_write_b128 v3, v[32:35] offset:1024
    s_mov_b64 exec, -1
    v_mov_b64 v[36:37], 0
    v_mov_b64 v[38:39], 0
    v_mov_b64 v[28:29], 0
    v_mov_b64 v[30:31], 0
    s_waitcnt lgkmcnt(0)
    s_barrier
    ds_read_b128 v[12:15], v3 offset:0
    ds_read_b128 v[16:19], v3 offset:32
    ds_read_b128 v[20:23], v3 offset:1024
    ds_read_b128 v[24:27], v3 offset:1056
    s_waitcnt lgkmcnt(3)
    v_smfmac_f32_16x16x64_bf16 v[36:39], v[12:15], v[48:55], v1
    ds_read_b128 v[72:75], v4 offset:32768
    s_waitcnt lgkmcnt(3)
    v_smfmac_f32_16x16x64_bf16 v[36:39], v[16:19], v[56:63], v1
    ds_read_b128 v[76:79], v4 offset:33792
    s_waitcnt lgkmcnt(3)
    v_smfmac_f32_16x16x64_bf16 v[36:39], v[20:23], a[216:223], v1
    s_waitcnt lgkmcnt(2)
    v_smfmac_f32_16x16x64_bf16 v[36:39], v[24:27], a[224:231], v1
    v_smfmac_f32_16x16x64_bf16 v[28:31], v[12:15], a[232:239], v1
    v_smfmac_f32_16x16x64_bf16 v[28:31], v[16:19], a[240:247], v1
    v_cvt_pk_bf16_f32 v36, v36, v37
    s_waitcnt lgkmcnt(0)
    v_smfmac_f32_16x16x64_bf16 v[28:31], v[20:23], v[72:79], v1
    v_or_b32 v36, 1, v36
    v_smfmac_f32_16x16x64_bf16 v[28:31], v[24:27], a[248:255], v1
    buffer_store_dword v36, v5, s[4:7], s28 offen
    v_cvt_pk_bf16_f32 v37, v38, v39
    v_or_b32 v37, 1, v37
    buffer_store_dword v37, v5, s[4:7], s29 offen
    s_nop 2
    v_cvt_pk_bf16_f32 v28, v28, v29
    v_cvt_pk_bf16_f32 v29, v30, v31
    v_or_b32 v28, 1, v28
    v_or_b32 v29, 1, v29
    buffer_store_dword v28, v5, s[4:7], s46 offen
    buffer_store_dword v29, v5, s[4:7], s73 offen
    ds_read_b128 v[48:51], v4 offset:0
    ds_read_b128 v[52:55], v4 offset:1024
    ds_read_b128 v[56:59], v4 offset:14336
    ds_read_b128 v[60:63], v4 offset:15360
    v_mov_b32_dpp v9, v42 quad_perm:[0,1,0,1] row_mask:0xf bank_mask:0xf
    v_mov_b32_dpp v10, v43 quad_perm:[0,1,0,1] row_mask:0xf bank_mask:0xf
    v_cndmask_b32 v96, v44, v42, vcc
    v_cndmask_b32 v97, v45, v43, vcc
    v_cndmask_b32 v98, v46, v9, vcc
    v_cndmask_b32 v99, v47, v10, vcc
    v_mov_b64 v[28:29], 0
    v_mov_b64 v[30:31], 0
    v_mov_b64 v[36:37], 0
    v_mov_b64 v[38:39], 0
    s_add_u32 s26, s26, 32768
    s_add_u32 s23, s23, 32768
    s_add_u32 s24, s24, 32768
    s_add_u32 s30, s30, 524288
    s_add_u32 s27, s27, 524288
    s_barrier
    s_add_u32 s18, s18, 1
    v_mov_b64 v[32:33], 0
    v_mov_b64 v[34:35], 0
    s_nop 15
    s_nop 15
    s_nop 15
    s_nop 6
    buffer_load_dwordx4 v[24:27], v0, s[4:7], s22 offen sc1
    s_nop 15
    s_nop 3
    buffer_load_dwordx4 v[16:19], v0, s[4:7], s22 offen sc1
    s_waitcnt vmcnt(1)
    v_bitop3_b32 v8, v24, v25, v26 bitop3:0x80
    v_bitop3_b32 v8, v8, v27, 1 bitop3:0x80
    v_cmp_ne_u32 vcc, 1, v8
    ds_write_b128 v0, v[24:27] offset:8192
    s_cbranch_vccnz L_c3_L_ch12o_r
L_c3_L_ch12o:
    buffer_load_dwordx4 v[40:43], v0, s[4:7], s23 offen sc1
    s_waitcnt lgkmcnt(0)
    s_barrier
    s_branch L_ch1_w2
L_c2_L_ch12e_r:
    s_add_u32 s19, s19, 1
    s_cmp_gt_u32 s19, 4000000
    s_cbranch_scc1 L_cend1
    buffer_load_dwordx4 v[40:43], v0, s[4:7], s23 offen sc1
    s_waitcnt vmcnt(0)
    v_bitop3_b32 v8, v40, v41, v42 bitop3:0x80
    v_bitop3_b32 v8, v8, v43, 1 bitop3:0x80
    v_cmp_ne_u32 vcc, 1, v8
    s_cbranch_vccnz L_c2_L_ch12e_r
    ds_write_b128 v0, v[40:43] offset:2048
    s_nop 7
    s_waitcnt lgkmcnt(0)
    s_branch L_c2_L_ch12e
L_sm_L_ch12e_r:
    v_max3_f32 v8, v28, v29, v30
    v_max3_f32 v8, v8, v31, v40
    s_nop 1
    v_max_f32_dpp v9, v8, v8 quad_perm:[2,3,0,1] row_mask:0xf bank_mask:0xf
    v_max_f32_dpp v10, v8, v8 quad_perm:[2,3,0,1] row_mask:0xf bank_mask:0xf
    s_nop 1
    v_permlane16_swap_b32 v9, v10
    v_max_f32 v8, v9, v10
    v_max_f32 v11, v9, v10
    s_nop 1
    v_permlane32_swap_b32 v8, v11
    v_max_f32 v8, v8, v11
    v_sub_f32 v28, v28, v8
    v_sub_f32 v29, v29, v8
    v_sub_f32 v30, v30, v8
    v_sub_f32 v31, v31, v8
    v_sub_f32 v40, v40, v8
    v_exp_f32 v11, v40
    s_nop 1
    v_mov_b32_dpp v9, v11 quad_perm:[0,1,0,1] row_mask:0xf bank_mask:0xf
    v_exp_f32 v16, v28
    v_exp_f32 v17, v29
    v_cvt_pk_bf16_f32 v12, v11, v9
    v_cvt_pk_bf16_f32 v15, v11, v9
    v_cvt_pk_bf16_f32 v32, v16, v17
    v_exp_f32 v18, v30
    v_mfma_f32_16x16x16_bf16 v[20:23], v[42:43], v[12:13], 0
    v_exp_f32 v19, v31
    v_mov_b32_dpp v34, v32 quad_perm:[0,1,0,1] row_mask:0xf bank_mask:0xf
    v_cvt_pk_bf16_f32 v33, v18, v19
    v_mfma_f32_16x16x16_bf16 v[24:27], v[42:43], v[14:15], 0
    v_add_f32 v8, v16, v17
    v_mov_b32_dpp v35, v33 quad_perm:[0,1,0,1] row_mask:0xf bank_mask:0xf
    v_add_f32 v10, v18, v19
    v_add_f32 v8, v8, v11
    v_mfma_f32_16x16x32_bf16 v[20:23], v[72:75], v[32:35], v[20:23]
    v_add_f32 v8, v8, v10
    v_mfma_f32_16x16x32_bf16 v[24:27], v[76:79], v[32:35], v[24:27]
    v_add_f32_dpp v9, v8, v8 quad_perm:[2,3,0,1] row_mask:0xf bank_mask:0xf
    v_add_f32_dpp v10, v8, v8 quad_perm:[2,3,0,1] row_mask:0xf bank_mask:0xf
    s_nop 1
    v_permlane16_swap_b32 v9, v10
    v_add_f32 v8, v9, v10
    v_add_f32 v9, v9, v10
    s_nop 1
    v_permlane32_swap_b32 v8, v9
    v_add_f32 v8, v8, v9
    v_rcp_f32 v10, v8
    s_nop 0
    v_pk_mul_f32 v[20:21], v[20:21], v[10:11] op_sel_hi:[1,0]
    v_pk_mul_f32 v[22:23], v[22:23], v[10:11] op_sel_hi:[1,0]
    v_pk_mul_f32 v[24:25], v[24:25], v[10:11] op_sel_hi:[1,0]
    v_pk_mul_f32 v[26:27], v[26:27], v[10:11] op_sel_hi:[1,0]
    v_cvt_pk_bf16_f32 v32, v20, v24
    v_cvt_pk_bf16_f32 v33, v21, v25
    v_cvt_pk_bf16_f32 v34, v22, v26
    v_cvt_pk_bf16_f32 v35, v23, v27
    s_branch L_sm_L_ch12e
L_c3_L_ch12e_r:
    s_add_u32 s19, s19, 1
    s_cmp_gt_u32 s19, 4000000
    s_cbranch_scc1 L_cend1
    buffer_load_dwordx4 v[24:27], v0, s[4:7], s22 offen sc1
    s_waitcnt vmcnt(1)
    v_or3_b32 v8, v16, v17, v18
    v_or_b32 v8, v8, v19
    v_and_b32 v8, 1, v8
    v_cmp_ne_u32 vcc, 0, v8
    s_cbranch_vccnz L_c3_L_ch12e_r2
    ds_write_b128 v0, v[16:19] offset:8192
    s_branch L_c3_L_ch12e
L_c3_L_ch12e_r2:
    buffer_load_dwordx4 v[16:19], v0, s[4:7], s22 offen sc1
    s_waitcnt vmcnt(1)
    v_or3_b32 v8, v24, v25, v26
    v_or_b32 v8, v8, v27
    v_and_b32 v8, 1, v8
    v_cmp_ne_u32 vcc, 0, v8
    s_cbranch_vccnz L_c3_L_ch12e_r
    ds_write_b128 v0, v[24:27] offset:8192
    s_branch L_c3_L_ch12e
L_c2_L_ch12o_r:
    s_add_u32 s19, s19, 1
    s_cmp_gt_u32 s19, 4000000
    s_cbranch_scc1 L_cend1
    buffer_load_dwordx4 v[40:43], v0, s[4:7], s23 offen sc1
    s_waitcnt vmcnt(0)
    v_or3_b32 v8, v40, v41, v42
    v_or_b32 v8, v8, v43
    v_and_b32 v8, 1, v8
    v_cmp_ne_u32 vcc, 0, v8
    s_cbranch_vccnz L_c2_L_ch12o_r
    ds_write_b128 v0, v[40:43] offset:2048
    s_nop 7
    s_waitcnt lgkmcnt(0)
    s_branch L_c2_L_ch12o
L_sm_L_ch12o_r:
    v_max3_f32 v8, v28, v29, v30
    v_max3_f32 v8, v8, v31, v40
    s_nop 1
    v_max_f32_dpp v9, v8, v8 quad_perm:[2,3,0,1] row_mask:0xf bank_mask:0xf
    v_max_f32_dpp v10, v8, v8 quad_perm:[2,3,0,1] row_mask:0xf bank_mask:0xf
    s_nop 1
    v_permlane16_swap_b32 v9, v10
    v_max_f32 v8, v9, v10
    v_max_f32 v11, v9, v10
    s_nop 1
    v_permlane32_swap_b32 v8, v11
    v_max_f32 v8, v8, v11
    v_sub_f32 v28, v28, v8
    v_sub_f32 v29, v29, v8
    v_sub_f32 v30, v30, v8
    v_sub_f32 v31, v31, v8
    v_sub_f32 v40, v40, v8
    v_exp_f32 v11, v40
    s_nop 1
    v_mov_b32_dpp v9, v11 quad_perm:[0,1,0,1] row_mask:0xf bank_mask:0xf
    v_exp_f32 v16, v28
    v_exp_f32 v17, v29
    v_cvt_pk_bf16_f32 v12, v11, v9
    v_cvt_pk_bf16_f32 v15, v11, v9
    v_cvt_pk_bf16_f32 v32, v16, v17
    v_exp_f32 v18, v30
    v_mfma_f32_16x16x16_bf16 v[20:23], v[42:43], v[12:13], 0
    v_exp_f32 v19, v31
    v_mov_b32_dpp v34, v32 quad_perm:[0,1,0,1] row_mask:0xf bank_mask:0xf
    v_cvt_pk_bf16_f32 v33, v18, v19
    v_mfma_f32_16x16x16_bf16 v[24:27], v[42:43], v[14:15], 0
    v_add_f32 v8, v16, v17
    v_mov_b32_dpp v35, v33 quad_perm:[0,1,0,1] row_mask:0xf bank_mask:0xf
    v_add_f32 v10, v18, v19
    v_add_f32 v8, v8, v11
    v_mfma_f32_16x16x32_bf16 v[20:23], v[72:75], v[32:35], v[20:23]
    v_add_f32 v8, v8, v10
    v_mfma_f32_16x16x32_bf16 v[24:27], v[76:79], v[32:35], v[24:27]
    v_add_f32_dpp v9, v8, v8 quad_perm:[2,3,0,1] row_mask:0xf bank_mask:0xf
    v_add_f32_dpp v10, v8, v8 quad_perm:[2,3,0,1] row_mask:0xf bank_mask:0xf
    s_nop 1
    v_permlane16_swap_b32 v9, v10
    v_add_f32 v8, v9, v10
    v_add_f32 v9, v9, v10
    s_nop 1
    v_permlane32_swap_b32 v8, v9
    v_add_f32 v8, v8, v9
    v_rcp_f32 v10, v8
    s_nop 0
    v_pk_mul_f32 v[20:21], v[20:21], v[10:11] op_sel_hi:[1,0]
    v_pk_mul_f32 v[22:23], v[22:23], v[10:11] op_sel_hi:[1,0]
    v_pk_mul_f32 v[24:25], v[24:25], v[10:11] op_sel_hi:[1,0]
    v_pk_mul_f32 v[26:27], v[26:27], v[10:11] op_sel_hi:[1,0]
    v_cvt_pk_bf16_f32 v32, v20, v24
    v_cvt_pk_bf16_f32 v33, v21, v25
    v_cvt_pk_bf16_f32 v34, v22, v26
    v_cvt_pk_bf16_f32 v35, v23, v27
    s_branch L_sm_L_ch12o
L_c3_L_ch12o_r:
    s_add_u32 s19, s19, 1
    s_cmp_gt_u32 s19, 4000000
    s_cbranch_scc1 L_cend1
    buffer_load_dwordx4 v[24:27], v0, s[4:7], s22 offen sc1
    s_waitcnt vmcnt(1)
    v_bitop3_b32 v8, v16, v17, v18 bitop3:0x80
    v_bitop3_b32 v8, v8, v19, 1 bitop3:0x80
    v_cmp_ne_u32 vcc, 1, v8
    s_cbranch_vccnz L_c3_L_ch12o_r2
    ds_write_b128 v0, v[16:19] offset:8192
    s_branch L_c3_L_ch12o
L_c3_L_ch12o_r2:
    buffer_load_dwordx4 v[16:19], v0, s[4:7], s22 offen sc1
    s_waitcnt vmcnt(1)
    v_bitop3_b32 v8, v24, v25, v26 bitop3:0x80
    v_bitop3_b32 v8, v8, v27, 1 bitop3:0x80
    v_cmp_ne_u32 vcc, 1, v8
    s_cbranch_vccnz L_c3_L_ch12o_r
    ds_write_b128 v0, v[24:27] offset:8192
    s_branch L_c3_L_ch12o
    .p2align 6
L_ch1_w3:
    ds_read_b128 v[12:15], v3 offset:6144
    s_waitcnt vmcnt(1)
    ds_read_b128 v[16:19], v3 offset:6176
    s_waitcnt lgkmcnt(1)
    v_smfmac_f32_16x16x64_bf16 v[28:31], v[12:15], v[48:55], v1
    ds_read_b128 v[20:23], v3 offset:7168
    v_smfmac_f32_16x16x64_bf16 v[32:35], v[12:15], v[56:63], v1
    ds_read_b128 v[48:51], v4 offset:2048
    v_smfmac_f32_16x16x64_bf16 v[36:39], v[12:15], v[104:111], v1
    ds_read_b128 v[24:27], v3 offset:7200
    s_waitcnt lgkmcnt(3)
    v_smfmac_f32_16x16x64_bf16 v[28:31], v[16:19], v[112:119], v1
    ds_read_b128 v[52:55], v4 offset:3072
    v_smfmac_f32_16x16x64_bf16 v[32:35], v[16:19], v[120:127], v1
    ds_read_b128 v[56:59], v4 offset:16384
    v_smfmac_f32_16x16x64_bf16 v[36:39], v[16:19], v[128:135], v1
    ds_read_b128 v[12:15], v3 offset:8192
    s_waitcnt lgkmcnt(5)
    v_smfmac_f32_16x16x64_bf16 v[28:31], v[20:23], v[136:143], v1
    ds_read_b128 v[60:63], v4 offset:17408
    v_smfmac_f32_16x16x64_bf16 v[32:35], v[20:23], v[144:151], v1
    s_waitcnt lgkmcnt(3)
    v_smfmac_f32_16x16x64_bf16 v[36:39], v[20:23], v[48:55], v1
    ds_read_b128 v[16:19], v3 offset:8224
    v_smfmac_f32_16x16x64_bf16 v[28:31], v[24:27], v[152:159], v1
    ds_read_b128 v[48:51], v4 offset:4096
    v_smfmac_f32_16x16x64_bf16 v[32:35], v[24:27], v[160:167], v1
    ds_read_b128 v[52:55], v4 offset:5120
    v_smfmac_f32_16x16x64_bf16 v[36:39], v[24:27], v[168:175], v1
    ds_read_b128 v[20:23], v3 offset:9216
    s_waitcnt lgkmcnt(4)
    v_smfmac_f32_16x16x64_bf16 v[28:31], v[12:15], v[56:63], v1
    s_waitcnt vmcnt(0)
    ds_write_b128 v0, v[40:43] offset:3072
    v_bitop3_b32 v8, v40, v41, v42 bitop3:0x80
    v_smfmac_f32_16x16x64_bf16 v[32:35], v[12:15], v[176:183], v1
    ds_read_b128 v[56:59], v4 offset:18432
    v_and_b32 v8, v8, v43
    v_smfmac_f32_16x16x64_bf16 v[36:39], v[12:15], v[184:191], v1
    ds_read_b128 v[24:27], v3 offset:9248
    v_and_or_b32 v8, v8, 1, s35
    s_waitcnt lgkmcnt(6)
    v_smfmac_f32_16x16x64_bf16 v[28:31], v[16:19], v[192:199], v1
    ds_read_b128 v[60:63], v4 offset:19456
    v_cmp_ne_u32 vcc, 1, v8
    s_waitcnt lgkmcnt(5)
    v_smfmac_f32_16x16x64_bf16 v[32:35], v[16:19], v[48:55], v1
    ds_read_b128 v[48:51], v4 offset:6144
    s_nop 0
    v_smfmac_f32_16x16x64_bf16 v[36:39], v[16:19], v[200:207], v1
    ds_read_b128 v[52:55], v4 offset:7168
    s_cbranch_vccnz L_c2_L_ch13e_r
L_c2_L_ch13e:
    s_waitcnt lgkmcnt(6)
    v_smfmac_f32_16x16x64_bf16 v[28:31], v[20:23], v[208:215], v1
    v_smfmac_f32_16x16x64_bf16 v[32:35], v[20:23], v[216:223], v1
    buffer_store_dwordx4 v[96:99], v0, s[4:7], s31 offen sc1
    s_add_u32 s31, s31, 131072
    s_waitcnt lgkmcnt(5)
    s_barrier
    s_mov_b64 vcc, s[36:37]
    s_mov_b32 s35, 0
    s_waitcnt lgkmcnt(2)
    v_smfmac_f32_16x16x64_bf16 v[36:39], v[20:23], v[56:63], v1
    ds_read_b128 v[12:15], v3 offset:0
    v_cndmask_b32 v40, 0, v2, s[38:39]
    v_smfmac_f32_16x16x64_bf16 v[28:31], v[24:27], v[224:231], v1
    ds_read_b128 v[16:19], v3 offset:32
    s_sub_u32 s33, s18, 1
    s_max_i32 s33, s33, 0
    v_mov_b32 v7, s33
    s_mov_b64 exec, 1
    buffer_store_dword v7, off, s[4:7], s32 sc1
    s_mov_b64 exec, -1
    v_cndmask_b32 v41, 0, v2, s[40:41]
    v_smfmac_f32_16x16x64_bf16 v[32:35], v[24:27], v[232:239], v1
    ds_read_b128 v[56:59], v4 offset:20480
    v_smfmac_f32_16x16x64_bf16 v[36:39], v[24:27], v[240:247], v1
    ds_read_b128 v[20:23], v3 offset:1024
    buffer_load_dwordx4 v[72:75], v0, s[4:7], s27 offen offset:2048 sc1
    s_waitcnt lgkmcnt(3)
    v_smfmac_f32_16x16x64_bf16 v[28:31], v[12:15], v[48:55], v1
    ds_read_b128 v[60:63], v4 offset:21504
    v_smfmac_f32_16x16x64_bf16 v[32:35], v[12:15], v[248:255], v1
    ds_read_b128 v[48:51], v4 offset:8192
    buffer_load_dwordx4 v[76:79], v0, s[4:7], s27 offen offset:3072 sc1
    v_smfmac_f32_16x16x64_bf16 v[36:39], v[12:15], a[0:7], v1
    ds_read_b128 v[24:27], v3 offset:1056
    s_waitcnt lgkmcnt(5)
    v_smfmac_f32_16x16x64_bf16 v[28:31], v[16:19], a[8:15], v1
    ds_read_b128 v[52:55], v4 offset:9216
    s_waitcnt lgkmcnt(3)
    v_smfmac_f32_16x16x64_bf16 v[32:35], v[16:19], v[56:63], v1
    ds_read_b128 v[56:59], v4 offset:22528
    v_smfmac_f32_16x16x64_bf16 v[36:39], v[16:19], a[16:23], v1
    ds_read_b128 v[12:15], v3 offset:2048
    v_smfmac_f32_16x16x64_bf16 v[28:31], v[20:23], a[24:31], v1
    ds_read_b128 v[60:63], v4 offset:23552
    v_smfmac_f32_16x16x64_bf16 v[32:35], v[20:23], a[32:39], v1
    s_waitcnt lgkmcnt(3)
    v_smfmac_f32_16x16x64_bf16 v[36:39], v[20:23], v[48:55], v1
    ds_read_b128 v[16:19], v3 offset:2080
    v_smfmac_f32_16x16x64_bf16 v[28:31], v[24:27], a[40:47], v1
    ds_read_b128 v[48:51], v4 offset:10240
    v_smfmac_f32_16x16x64_bf16 v[32:35], v[24:27], a[48:55], v1
    ds_read_b128 v[52:55], v4 offset:11264
    v_smfmac_f32_16x16x64_bf16 v[36:39], v[24:27], a[56:63], v1
    ds_read_b128 v[20:23], v3 offset:3072
    s_waitcnt lgkmcnt(4)
    v_smfmac_f32_16x16x64_bf16 v[28:31], v[12:15], v[56:63], v1
    ds_read_b128 v[56:59], v4 offset:24576
    v_smfmac_f32_16x16x64_bf16 v[32:35], v[12:15], a[64:71], v1
    ds_read_b128 v[60:63], v4 offset:25600
    v_smfmac_f32_16x16x64_bf16 v[36:39], v[12:15], a[72:79], v1
    ds_read_b128 v[24:27], v3 offset:3104
    s_waitcnt lgkmcnt(6)
    v_smfmac_f32_16x16x64_bf16 v[28:31], v[16:19], a[80:87], v1
    s_waitcnt lgkmcnt(4)
    v_smfmac_f32_16x16x64_bf16 v[32:35], v[16:19], v[48:55], v1
    ds_read_b128 v[48:51], v4 offset:12288
    v_smfmac_f32_16x16x64_bf16 v[36:39], v[16:19], a[88:95], v1
    ds_read_b128 v[12:15], v3 offset:4096
    s_waitcnt lgkmcnt(5)
    v_smfmac_f32_16x16x64_bf16 v[28:31], v[20:23], a[96:103], v1
    ds_read_b128 v[52:55], v4 offset:13312
    v_smfmac_f32_16x16x64_bf16 v[32:35], v[20:23], a[104:111], v1
    ds_read_b128 v[16:19], v3 offset:4128
    s_waitcnt lgkmcnt(5)
    v_smfmac_f32_16x16x64_bf16 v[36:39], v[20:23], v[56:63], v1
    ds_read_b128 v[56:59], v4 offset:26624
    s_waitcnt lgkmcnt(5)
    v_smfmac_f32_16x16x64_bf16 v[28:31], v[24:27], a[112:119], v1
    ds_read_b128 v[20:23], v3 offset:5120
    v_smfmac_f32_16x16x64_bf16 v[32:35], v[24:27], a[120:127], v1
    ds_read_b128 v[60:63], v4 offset:27648
    v_smfmac_f32_16x16x64_bf16 v[36:39], v[24:27], a[128:135], v1
    ds_read_b128 v[24:27], v3 offset:5152
    s_waitcnt lgkmcnt(5)
    v_smfmac_f32_16x16x64_bf16 v[28:31], v[12:15], v[48:55], v1
    v_smfmac_f32_16x16x64_bf16 v[32:35], v[12:15], a[136:143], v1
    s_waitcnt lgkmcnt(4)
    v_smfmac_f32_16x16x64_bf16 v[28:31], v[16:19], a[144:151], v1
    v_smfmac_f32_16x16x64_bf16 v[32:35], v[16:19], a[152:159], v1
    s_waitcnt lgkmcnt(1)
    v_smfmac_f32_16x16x64_bf16 v[28:31], v[20:23], v[56:63], v1
    v_smfmac_f32_16x16x64_bf16 v[32:35], v[20:23], a[160:167], v1
    s_waitcnt lgkmcnt(0)
    v_smfmac_f32_16x16x64_bf16 v[28:31], v[24:27], a[168:175], v1
    v_smfmac_f32_16x16x64_bf16 v[32:35], v[24:27], a[176:183], v1
    v_smfmac_f32_16x16x64_bf16 v[36:39], v[12:15], a[184:191], v1
    v_smfmac_f32_16x16x64_bf16 v[36:39], v[16:19], a[192:199], v1
    v_cvt_pk_bf16_f32 v44, v28, v29
    v_cvt_pk_bf16_f32 v45, v32, v33
    v_cvt_pk_bf16_f32 v46, v30, v31
    v_cvt_pk_bf16_f32 v47, v34, v35
    v_mfma_f32_16x16x16_bf16 v[28:31], v[44:45], v[40:41], 0
    v_mfma_f32_16x16x16_bf16 v[32:35], v[46:47], v[40:41], 0
    v_smfmac_f32_16x16x64_bf16 v[36:39], v[20:23], a[200:207], v1
    s_nop 3
    v_cvt_pk_bf16_f32 v44, v28, v32
    v_cvt_pk_bf16_f32 v45, v29, v33
    v_cvt_pk_bf16_f32 v46, v30, v34
    v_cvt_pk_bf16_f32 v47, v31, v35
    s_nop 1
    v_mfma_f32_16x16x32_bf16 v[32:35], v[68:71], v[44:47], 0
    v_mfma_f32_16x16x32_bf16 v[28:31], v[64:67], v[44:47], 0
    v_mfma_f32_16x16x32_bf16 v[12:15], v[44:47], v[44:47], 0
    v_smfmac_f32_16x16x64_bf16 v[36:39], v[24:27], a[208:215], v1
    v_cndmask_b32_dpp v28, v32, v28, vcc quad_perm:[2,3,2,3] row_mask:0xf bank_mask:0xf
    v_cndmask_b32_dpp v29, v33, v29, vcc quad_perm:[2,3,2,3] row_mask:0xf bank_mask:0xf
    v_cndmask_b32_dpp v30, v34, v30, vcc quad_perm:[2,3,2,3] row_mask:0xf bank_mask:0xf
    v_cndmask_b32_dpp v31, v35, v31, vcc quad_perm:[2,3,2,3] row_mask:0xf bank_mask:0xf
    ds_write_b128 v0, v[28:31] offset:13312
    v_cndmask_b32_dpp v11, v13, v12, vcc quad_perm:[2,3,2,3] row_mask:0xf bank_mask:0xf
    ds_write_b32 v0, v11 offset:14348
    buffer_load_dwordx4 v[64:67], v0, s[4:7], s30 offen offset:0 sc1
    buffer_load_dwordx4 v[68:71], v0, s[4:7], s30 offen offset:1024 sc1
    buffer_load_dword v6, off, s[8:11], s51 sc1
    s_waitcnt lgkmcnt(0)
    s_barrier
    ds_read_b128 v[24:27], v0 offset:14336
    ds_read_b128 v[28:31], v0 offset:10240
    ds_read_b128 v[32:35], v0 offset:11264
    ds_read_b128 v[16:19], v0 offset:12288
    ds_read_b128 v[20:23], v0 offset:13312
    v_cvt_pk_bf16_f32 v42, v36, v37
    v_cvt_pk_bf16_f32 v43, v38, v39
    v_mov_b32 v13, 0
    v_mov_b32 v14, 0
    s_waitcnt lgkmcnt(4)
    v_pk_add_f32 v[24:25], v[24:25], v[26:27]
    v_add_f32 v24, v24, v25
    v_mul_f32 v40, s20, v24
    s_waitcnt lgkmcnt(3)
    v_pk_mul_f32 v[28:29], v[28:29], s[48:49]
    v_pk_mul_f32 v[30:31], v[30:31], s[48:49]
    v_exp_f32 v11, v40
    s_waitcnt lgkmcnt(2)
    v_pk_fma_f32 v[28:29], v[32:33], s[48:49], v[28:29]
    v_pk_fma_f32 v[30:31], v[34:35], s[48:49], v[30:31]
    s_waitcnt lgkmcnt(1)
    v_pk_fma_f32 v[28:29], v[16:17], s[48:49], v[28:29]
    v_pk_fma_f32 v[30:31], v[18:19], s[48:49], v[30:31]
    s_waitcnt lgkmcnt(0)
    v_pk_fma_f32 v[28:29], v[20:21], s[48:49], v[28:29]
    v_pk_fma_f32 v[30:31], v[22:23], s[48:49], v[30:31]
    v_mov_b32_dpp v9, v11 quad_perm:[0,1,0,1] row_mask:0xf bank_mask:0xf
    v_exp_f32 v16, v28
    v_exp_f32 v17, v29
    v_cvt_pk_bf16_f32 v12, v11, v9
    v_cvt_pk_bf16_f32 v15, v11, v9
    v_cvt_pk_bf16_f32 v32, v16, v17
    v_exp_f32 v18, v30
    v_mfma_f32_16x16x16_bf16 v[20:23], v[42:43], v[12:13], 0
    ds_read_b128 v[48:51], v4 offset:28672
    v_exp_f32 v19, v31
    v_mov_b32_dpp v34, v32 quad_perm:[0,1,0,1] row_mask:0xf bank_mask:0xf
    v_cvt_pk_bf16_f32 v33, v18, v19
    v_mfma_f32_16x16x16_bf16 v[24:27], v[42:43], v[14:15], 0
    ds_read_b128 v[52:55], v4 offset:29696
    v_add_f32 v8, v16, v17
    v_mov_b32_dpp v35, v33 quad_perm:[0,1,0,1] row_mask:0xf bank_mask:0xf
    v_add_f32 v10, v18, v19
    v_add_f32 v8, v8, v11
    s_waitcnt vmcnt(4)
    v_mfma_f32_16x16x32_bf16 v[20:23], v[72:75], v[32:35], v[20:23]
    ds_read_b128 v[56:59], v4 offset:30720
    v_add_f32 v8, v8, v10
    s_waitcnt vmcnt(3)
    v_mfma_f32_16x16x32_bf16 v[24:27], v[76:79], v[32:35], v[24:27]
    ds_read_b128 v[60:63], v4 offset:31744
    v_add_f32_dpp v9, v8, v8 quad_perm:[2,3,0,1] row_mask:0xf bank_mask:0xf
    v_add_f32_dpp v10, v8, v8 quad_perm:[2,3,0,1] row_mask:0xf bank_mask:0xf
    s_nop 1
    v_permlane16_swap_b32 v9, v10
    v_add_f32 v8, v9, v10
    v_add_f32 v9, v9, v10
    s_nop 1
    v_permlane32_swap_b32 v8, v9
    v_add_f32 v8, v8, v9
    v_rcp_f32 v10, v8
    v_subrev_u32 v8, s47, v8
    v_cmp_le_u32 s[44:45], s50, v8
    v_pk_mul_f32 v[20:21], v[20:21], v[10:11] op_sel_hi:[1,0]
    v_pk_mul_f32 v[22:23], v[22:23], v[10:11] op_sel_hi:[1,0]
    v_pk_mul_f32 v[24:25], v[24:25], v[10:11] op_sel_hi:[1,0]
    v_pk_mul_f32 v[26:27], v[26:27], v[10:11] op_sel_hi:[1,0]
    v_cvt_pk_bf16_f32 v32, v20, v24
    v_cvt_pk_bf16_f32 v33, v21, v25
    v_cvt_pk_bf16_f32 v34, v22, v26
    v_cvt_pk_bf16_f32 v35, v23, v27
    s_cmp_lg_u64 s[44:45], 0
    s_cbranch_scc1 L_sm_L_ch13e_r
L_sm_L_ch13e:
    s_mov_b64 exec, s[36:37]
    ds_write_b128 v3, v[32:35] offset:1056
    s_mov_b64 exec, -1
    v_mov_b64 v[36:37], 0
    v_mov_b64 v[38:39], 0
    v_mov_b64 v[28:29], 0
    v_mov_b64 v[30:31], 0
    s_waitcnt lgkmcnt(0)
    s_barrier
    ds_read_b128 v[12:15], v3 offset:0
    ds_read_b128 v[16:19], v3 offset:32
    ds_read_b128 v[20:23], v3 offset:1024
    ds_read_b128 v[24:27], v3 offset:1056
    s_waitcnt lgkmcnt(3)
    v_smfmac_f32_16x16x64_bf16 v[36:39], v[12:15], v[48:55], v1
    ds_read_b128 v[72:75], v4 offset:32768
    s_waitcnt lgkmcnt(3)
    v_smfmac_f32_16x16x64_bf16 v[36:39], v[16:19], v[56:63], v1
    ds_read_b128 v[76:79], v4 offset:33792
    s_waitcnt lgkmcnt(3)
    v_smfmac_f32_16x16x64_bf16 v[36:39], v[20:23], a[216:223], v1
    s_waitcnt lgkmcnt(2)
    v_smfmac_f32_16x16x64_bf16 v[36:39], v[24:27], a[224:231], v1
    v_smfmac_f32_16x16x64_bf16 v[28:31], v[12:15], a[232:239], v1
    v_smfmac_f32_16x16x64_bf16 v[28:31], v[16:19], a[240:247], v1
    v_cvt_pk_bf16_f32 v36, v36, v37
    s_waitcnt lgkmcnt(0)
    v_smfmac_f32_16x16x64_bf16 v[28:31], v[20:23], v[72:79], v1
    v_and_b32 v36, -2, v36
    v_smfmac_f32_16x16x64_bf16 v[28:31], v[24:27], a[248:255], v1
    buffer_store_dword v36, v5, s[4:7], s28 offen
    v_cvt_pk_bf16_f32 v37, v38, v39
    v_and_b32 v37, -2, v37
    buffer_store_dword v37, v5, s[4:7], s29 offen
    s_nop 2
    v_cvt_pk_bf16_f32 v28, v28, v29
    v_cvt_pk_bf16_f32 v29, v30, v31
    v_and_b32 v28, -2, v28
    v_and_b32 v29, -2, v29
    buffer_store_dword v28, v5, s[4:7], s46 offen
    buffer_store_dword v29, v5, s[4:7], s73 offen
    ds_read_b128 v[48:51], v4 offset:0
    ds_read_b128 v[52:55], v4 offset:1024
    ds_read_b128 v[56:59], v4 offset:14336
    ds_read_b128 v[60:63], v4 offset:15360
    v_mov_b32_dpp v9, v42 quad_perm:[0,1,0,1] row_mask:0xf bank_mask:0xf
    v_mov_b32_dpp v10, v43 quad_perm:[0,1,0,1] row_mask:0xf bank_mask:0xf
    v_cndmask_b32 v96, v44, v42, vcc
    v_cndmask_b32 v97, v45, v43, vcc
    v_cndmask_b32 v98, v46, v9, vcc
    v_cndmask_b32 v99, v47, v10, vcc
    v_mov_b64 v[28:29], 0
    v_mov_b64 v[30:31], 0
    v_mov_b64 v[36:37], 0
    v_mov_b64 v[38:39], 0
    s_add_u32 s26, s26, 32768
    s_add_u32 s23, s23, 32768
    s_add_u32 s24, s24, 32768
    s_add_u32 s30, s30, 524288
    s_add_u32 s27, s27, 524288
    s_waitcnt vmcnt(4)
    v_readfirstlane_b32 s33, v6
    s_nop 0
    s_and_b32 s33, s33, 0xffff
    s_cmp_lg_u32 s33, 32
    s_cbranch_scc1 L_fl_L_ch13e_r
L_fl_L_ch13e:
    s_add_u32 s51, s18, 3
    s_min_u32 s51, s51, 63
    s_lshr_b32 s33, s51, 3
    s_add_u32 s33, s33, 10
    s_cmp_lt_u32 s51, 4
    s_cselect_b32 s51, 28, s33
    s_lshl_b32 s51, s51, 2
    s_barrier
    s_add_u32 s18, s18, 1
    v_mov_b64 v[32:33], 0
    v_mov_b64 v[34:35], 0
    s_nop 15
    s_nop 15
    s_nop 15
    s_nop 6
    buffer_load_dwordx4 v[24:27], v0, s[4:7], s22 offen sc1
    s_nop 15
    s_nop 3
    buffer_load_dwordx4 v[16:19], v0, s[4:7], s22 offen sc1
    s_waitcnt vmcnt(1)
    v_or3_b32 v8, v24, v25, v26
    v_or_b32 v8, v8, v27
    v_and_b32 v8, 1, v8
    v_cmp_ne_u32 vcc, 0, v8
    ds_write_b128 v0, v[24:27] offset:9216
    s_cbranch_vccnz L_c3_L_ch13e_r
L_c3_L_ch13e:
    buffer_load_dwordx4 v[40:43], v0, s[4:7], s23 offen sc1
    s_waitcnt lgkmcnt(0)
    s_barrier
    ds_read_b128 v[12:15], v3 offset:6144
    s_waitcnt vmcnt(1)
    ds_read_b128 v[16:19], v3 offset:6176
    s_waitcnt lgkmcnt(1)
    v_smfmac_f32_16x16x64_bf16 v[28:31], v[12:15], v[48:55], v1
    ds_read_b128 v[20:23], v3 offset:7168
    v_smfmac_f32_16x16x64_bf16 v[32:35], v[12:15], v[56:63], v1
    ds_read_b128 v[48:51], v4 offset:2048
    v_smfmac_f32_16x16x64_bf16 v[36:39], v[12:15], v[104:111], v1
    ds_read_b128 v[24:27], v3 offset:7200
    s_waitcnt lgkmcnt(3)
    v_smfmac_f32_16x16x64_bf16 v[28:31], v[16:19], v[112:119], v1
    ds_read_b128 v[52:55], v4 offset:3072
    v_smfmac_f32_16x16x64_bf16 v[32:35], v[16:19], v[120:127], v1
    ds_read_b128 v[56:59], v4 offset:16384
    v_smfmac_f32_16x16x64_bf16 v[36:39], v[16:19], v[128:135], v1
    ds_read_b128 v[12:15], v3 offset:8192
    s_waitcnt lgkmcnt(5)
    v_smfmac_f32_16x16x64_bf16 v[28:31], v[20:23], v[136:143], v1
    ds_read_b128 v[60:63], v4 offset:17408
    v_smfmac_f32_16x16x64_bf16 v[32:35], v[20:23], v[144:151], v1
    s_waitcnt lgkmcnt(3)
    v_smfmac_f32_16x16x64_bf16 v[36:39], v[20:23], v[48:55], v1
    ds_read_b128 v[16:19], v3 offset:8224
    v_smfmac_f32_16x16x64_bf16 v[28:31], v[24:27], v[152:159], v1
    ds_read_b128 v[48:51], v4 offset:4096
    v_smfmac_f32_16x16x64_bf16 v[32:35], v[24:27], v[160:167], v1
    ds_read_b128 v[52:55], v4 offset:5120
    v_smfmac_f32_16x16x64_bf16 v[36:39], v[24:27], v[168:175], v1
    ds_read_b128 v[20:23], v3 offset:9216
    s_waitcnt lgkmcnt(4)
    v_smfmac_f32_16x16x64_bf16 v[28:31], v[12:15], v[56:63], v1
    s_waitcnt vmcnt(0)
    ds_write_b128 v0, v[40:43] offset:3072
    v_or3_b32 v8, v40, v41, v42
    v_smfmac_f32_16x16x64_bf16 v[32:35], v[12:15], v[176:183], v1
    ds_read_b128 v[56:59], v4 offset:18432
    v_or_b32 v8, v8, v43
    v_smfmac_f32_16x16x64_bf16 v[36:39], v[12:15], v[184:191], v1
    ds_read_b128 v[24:27], v3 offset:9248
    v_and_b32 v8, 1, v8
    s_waitcnt lgkmcnt(6)
    v_smfmac_f32_16x16x64_bf16 v[28:31], v[16:19], v[192:199], v1
    ds_read_b128 v[60:63], v4 offset:19456
    v_cmp_ne_u32 vcc, 0, v8
    s_waitcnt lgkmcnt(5)
    v_smfmac_f32_16x16x64_bf16 v[32:35], v[16:19], v[48:55], v1
    ds_read_b128 v[48:51], v4 offset:6144
    s_nop 0
    v_smfmac_f32_16x16x64_bf16 v[36:39], v[16:19], v[200:207], v1
    ds_read_b128 v[52:55], v4 offset:7168
    s_cbranch_vccnz L_c2_L_ch13o_r
L_c2_L_ch13o:
    s_waitcnt lgkmcnt(6)
    v_smfmac_f32_16x16x64_bf16 v[28:31], v[20:23], v[208:215], v1
    v_smfmac_f32_16x16x64_bf16 v[32:35], v[20:23], v[216:223], v1
    buffer_store_dwordx4 v[96:99], v0, s[4:7], s31 offen sc1
    s_add_u32 s31, s31, 131072
    s_waitcnt lgkmcnt(5)
    s_barrier
    s_mov_b64 vcc, s[36:37]
    s_waitcnt lgkmcnt(2)
    v_smfmac_f32_16x16x64_bf16 v[36:39], v[20:23], v[56:63], v1
    ds_read_b128 v[12:15], v3 offset:0
    v_cndmask_b32 v40, 0, v2, s[38:39]
    v_smfmac_f32_16x16x64_bf16 v[28:31], v[24:27], v[224:231], v1
    ds_read_b128 v[16:19], v3 offset:32
    s_sub_u32 s33, s18, 1
    s_max_i32 s33, s33, 0
    v_mov_b32 v7, s33
    s_mov_b64 exec, 1
    buffer_store_dword v7, off, s[4:7], s32 sc1
    s_mov_b64 exec, -1
    v_cndmask_b32 v41, 0, v2, s[40:41]
    v_smfmac_f32_16x16x64_bf16 v[32:35], v[24:27], v[232:239], v1
    ds_read_b128 v[56:59], v4 offset:20480
    v_smfmac_f32_16x16x64_bf16 v[36:39], v[24:27], v[240:247], v1
    ds_read_b128 v[20:23], v3 offset:1024
    buffer_load_dwordx4 v[72:75], v0, s[4:7], s27 offen offset:2048 sc1
    s_waitcnt lgkmcnt(3)
    v_smfmac_f32_16x16x64_bf16 v[28:31], v[12:15], v[48:55], v1
    ds_read_b128 v[60:63], v4 offset:21504
    v_smfmac_f32_16x16x64_bf16 v[32:35], v[12:15], v[248:255], v1
    ds_read_b128 v[48:51], v4 offset:8192
    buffer_load_dwordx4 v[76:79], v0, s[4:7], s27 offen offset:3072 sc1
    v_smfmac_f32_16x16x64_bf16 v[36:39], v[12:15], a[0:7], v1
    ds_read_b128 v[24:27], v3 offset:1056
    s_waitcnt lgkmcnt(5)
    v_smfmac_f32_16x16x64_bf16 v[28:31], v[16:19], a[8:15], v1
    ds_read_b128 v[52:55], v4 offset:9216
    s_waitcnt lgkmcnt(3)
    v_smfmac_f32_16x16x64_bf16 v[32:35], v[16:19], v[56:63], v1
    ds_read_b128 v[56:59], v4 offset:22528
    v_smfmac_f32_16x16x64_bf16 v[36:39], v[16:19], a[16:23], v1
    ds_read_b128 v[12:15], v3 offset:2048
    v_smfmac_f32_16x16x64_bf16 v[28:31], v[20:23], a[24:31], v1
    ds_read_b128 v[60:63], v4 offset:23552
    v_smfmac_f32_16x16x64_bf16 v[32:35], v[20:23], a[32:39], v1
    s_waitcnt lgkmcnt(3)
    v_smfmac_f32_16x16x64_bf16 v[36:39], v[20:23], v[48:55], v1
    ds_read_b128 v[16:19], v3 offset:2080
    v_smfmac_f32_16x16x64_bf16 v[28:31], v[24:27], a[40:47], v1
    ds_read_b128 v[48:51], v4 offset:10240
    v_smfmac_f32_16x16x64_bf16 v[32:35], v[24:27], a[48:55], v1
    ds_read_b128 v[52:55], v4 offset:11264
    v_smfmac_f32_16x16x64_bf16 v[36:39], v[24:27], a[56:63], v1
    ds_read_b128 v[20:23], v3 offset:3072
    s_waitcnt lgkmcnt(4)
    v_smfmac_f32_16x16x64_bf16 v[28:31], v[12:15], v[56:63], v1
    ds_read_b128 v[56:59], v4 offset:24576
    v_smfmac_f32_16x16x64_bf16 v[32:35], v[12:15], a[64:71], v1
    ds_read_b128 v[60:63], v4 offset:25600
    v_smfmac_f32_16x16x64_bf16 v[36:39], v[12:15], a[72:79], v1
    ds_read_b128 v[24:27], v3 offset:3104
    s_waitcnt lgkmcnt(6)
    v_smfmac_f32_16x16x64_bf16 v[28:31], v[16:19], a[80:87], v1
    s_waitcnt lgkmcnt(4)
    v_smfmac_f32_16x16x64_bf16 v[32:35], v[16:19], v[48:55], v1
    ds_read_b128 v[48:51], v4 offset:12288
    v_smfmac_f32_16x16x64_bf16 v[36:39], v[16:19], a[88:95], v1
    ds_read_b128 v[12:15], v3 offset:4096
    s_waitcnt lgkmcnt(5)
    v_smfmac_f32_16x16x64_bf16 v[28:31], v[20:23], a[96:103], v1
    ds_read_b128 v[52:55], v4 offset:13312
    v_smfmac_f32_16x16x64_bf16 v[32:35], v[20:23], a[104:111], v1
    ds_read_b128 v[16:19], v3 offset:4128
    s_waitcnt lgkmcnt(5)
    v_smfmac_f32_16x16x64_bf16 v[36:39], v[20:23], v[56:63], v1
    ds_read_b128 v[56:59], v4 offset:26624
    s_waitcnt lgkmcnt(5)
    v_smfmac_f32_16x16x64_bf16 v[28:31], v[24:27], a[112:119], v1
    ds_read_b128 v[20:23], v3 offset:5120
    v_smfmac_f32_16x16x64_bf16 v[32:35], v[24:27], a[120:127], v1
    ds_read_b128 v[60:63], v4 offset:27648
    v_smfmac_f32_16x16x64_bf16 v[36:39], v[24:27], a[128:135], v1
    ds_read_b128 v[24:27], v3 offset:5152
    s_waitcnt lgkmcnt(5)
    v_smfmac_f32_16x16x64_bf16 v[28:31], v[12:15], v[48:55], v1
    v_smfmac_f32_16x16x64_bf16 v[32:35], v[12:15], a[136:143], v1
    s_waitcnt lgkmcnt(4)
    v_smfmac_f32_16x16x64_bf16 v[28:31], v[16:19], a[144:151], v1
    v_smfmac_f32_16x16x64_bf16 v[32:35], v[16:19], a[152:159], v1
    s_waitcnt lgkmcnt(1)
    v_smfmac_f32_16x16x64_bf16 v[28:31], v[20:23], v[56:63], v1
    v_smfmac_f32_16x16x64_bf16 v[32:35], v[20:23], a[160:167], v1
    s_waitcnt lgkmcnt(0)
    v_smfmac_f32_16x16x64_bf16 v[28:31], v[24:27], a[168:175], v1
    v_smfmac_f32_16x16x64_bf16 v[32:35], v[24:27], a[176:183], v1
    v_smfmac_f32_16x16x64_bf16 v[36:39], v[12:15], a[184:191], v1
    v_smfmac_f32_16x16x64_bf16 v[36:39], v[16:19], a[192:199], v1
    v_cvt_pk_bf16_f32 v44, v28, v29
    v_cvt_pk_bf16_f32 v45, v32, v33
    v_cvt_pk_bf16_f32 v46, v30, v31
    v_cvt_pk_bf16_f32 v47, v34, v35
    v_mfma_f32_16x16x16_bf16 v[28:31], v[44:45], v[40:41], 0
    v_mfma_f32_16x16x16_bf16 v[32:35], v[46:47], v[40:41], 0
    v_smfmac_f32_16x16x64_bf16 v[36:39], v[20:23], a[200:207], v1
    s_nop 3
    v_cvt_pk_bf16_f32 v44, v28, v32
    v_cvt_pk_bf16_f32 v45, v29, v33
    v_cvt_pk_bf16_f32 v46, v30, v34
    v_cvt_pk_bf16_f32 v47, v31, v35
    s_nop 1
    v_mfma_f32_16x16x32_bf16 v[32:35], v[68:71], v[44:47], 0
    v_mfma_f32_16x16x32_bf16 v[28:31], v[64:67], v[44:47], 0
    v_mfma_f32_16x16x32_bf16 v[12:15], v[44:47], v[44:47], 0
    v_smfmac_f32_16x16x64_bf16 v[36:39], v[24:27], a[208:215], v1
    v_cndmask_b32_dpp v28, v32, v28, vcc quad_perm:[2,3,2,3] row_mask:0xf bank_mask:0xf
    v_cndmask_b32_dpp v29, v33, v29, vcc quad_perm:[2,3,2,3] row_mask:0xf bank_mask:0xf
    v_cndmask_b32_dpp v30, v34, v30, vcc quad_perm:[2,3,2,3] row_mask:0xf bank_mask:0xf
    v_cndmask_b32_dpp v31, v35, v31, vcc quad_perm:[2,3,2,3] row_mask:0xf bank_mask:0xf
    ds_write_b128 v0, v[28:31] offset:13312
    v_cndmask_b32_dpp v11, v13, v12, vcc quad_perm:[2,3,2,3] row_mask:0xf bank_mask:0xf
    ds_write_b32 v0, v11 offset:14348
    buffer_load_dwordx4 v[64:67], v0, s[4:7], s30 offen offset:0 sc1
    buffer_load_dwordx4 v[68:71], v0, s[4:7], s30 offen offset:1024 sc1
    buffer_load_dword v6, off, s[8:11], s51 sc1
    s_waitcnt lgkmcnt(0)
    s_barrier
    ds_read_b128 v[24:27], v0 offset:14336
    ds_read_b128 v[28:31], v0 offset:10240
    ds_read_b128 v[32:35], v0 offset:11264
    ds_read_b128 v[16:19], v0 offset:12288
    ds_read_b128 v[20:23], v0 offset:13312
    v_cvt_pk_bf16_f32 v42, v36, v37
    v_cvt_pk_bf16_f32 v43, v38, v39
    v_mov_b32 v13, 0
    v_mov_b32 v14, 0
    s_cmp_ge_u32 s18, 63
    s_cbranch_scc1 L_cdone1
    s_waitcnt lgkmcnt(4)
    v_pk_add_f32 v[24:25], v[24:25], v[26:27]
    v_add_f32 v24, v24, v25
    v_mul_f32 v40, s20, v24
    s_waitcnt lgkmcnt(3)
    v_pk_mul_f32 v[28:29], v[28:29], s[48:49]
    v_pk_mul_f32 v[30:31], v[30:31], s[48:49]
    v_exp_f32 v11, v40
    s_waitcnt lgkmcnt(2)
    v_pk_fma_f32 v[28:29], v[32:33], s[48:49], v[28:29]
    v_pk_fma_f32 v[30:31], v[34:35], s[48:49], v[30:31]
    s_waitcnt lgkmcnt(1)
    v_pk_fma_f32 v[28:29], v[16:17], s[48:49], v[28:29]
    v_pk_fma_f32 v[30:31], v[18:19], s[48:49], v[30:31]
    s_waitcnt lgkmcnt(0)
    v_pk_fma_f32 v[28:29], v[20:21], s[48:49], v[28:29]
    v_pk_fma_f32 v[30:31], v[22:23], s[48:49], v[30:31]
    v_mov_b32_dpp v9, v11 quad_perm:[0,1,0,1] row_mask:0xf bank_mask:0xf
    v_exp_f32 v16, v28
    v_exp_f32 v17, v29
    v_cvt_pk_bf16_f32 v12, v11, v9
    v_cvt_pk_bf16_f32 v15, v11, v9
    v_cvt_pk_bf16_f32 v32, v16, v17
    v_exp_f32 v18, v30
    v_mfma_f32_16x16x16_bf16 v[20:23], v[42:43], v[12:13], 0
    ds_read_b128 v[48:51], v4 offset:28672
    v_exp_f32 v19, v31
    v_mov_b32_dpp v34, v32 quad_perm:[0,1,0,1] row_mask:0xf bank_mask:0xf
    v_cvt_pk_bf16_f32 v33, v18, v19
    v_mfma_f32_16x16x16_bf16 v[24:27], v[42:43], v[14:15], 0
    ds_read_b128 v[52:55], v4 offset:29696
    v_add_f32 v8, v16, v17
    v_mov_b32_dpp v35, v33 quad_perm:[0,1,0,1] row_mask:0xf bank_mask:0xf
    v_add_f32 v10, v18, v19
    v_add_f32 v8, v8, v11
    s_waitcnt vmcnt(4)
    v_mfma_f32_16x16x32_bf16 v[20:23], v[72:75], v[32:35], v[20:23]
    ds_read_b128 v[56:59], v4 offset:30720
    v_add_f32 v8, v8, v10
    s_waitcnt vmcnt(3)
    v_mfma_f32_16x16x32_bf16 v[24:27], v[76:79], v[32:35], v[24:27]
    ds_read_b128 v[60:63], v4 offset:31744
    v_add_f32_dpp v9, v8, v8 quad_perm:[2,3,0,1] row_mask:0xf bank_mask:0xf
    v_add_f32_dpp v10, v8, v8 quad_perm:[2,3,0,1] row_mask:0xf bank_mask:0xf
    s_nop 1
    v_permlane16_swap_b32 v9, v10
    v_add_f32 v8, v9, v10
    v_add_f32 v9, v9, v10
    s_nop 1
    v_permlane32_swap_b32 v8, v9
    v_add_f32 v8, v8, v9
    v_rcp_f32 v10, v8
    v_subrev_u32 v8, s47, v8
    v_cmp_le_u32 s[44:45], s50, v8
    v_pk_mul_f32 v[20:21], v[20:21], v[10:11] op_sel_hi:[1,0]
    v_pk_mul_f32 v[22:23], v[22:23], v[10:11] op_sel_hi:[1,0]
    v_pk_mul_f32 v[24:25], v[24:25], v[10:11] op_sel_hi:[1,0]
    v_pk_mul_f32 v[26:27], v[26:27], v[10:11] op_sel_hi:[1,0]
    v_cvt_pk_bf16_f32 v32, v20, v24
    v_cvt_pk_bf16_f32 v33, v21, v25
    v_cvt_pk_bf16_f32 v34, v22, v26
    v_cvt_pk_bf16_f32 v35, v23, v27
    s_cmp_lg_u64 s[44:45], 0
    s_cbranch_scc1 L_sm_L_ch13o_r
L_sm_L_ch13o:
    s_mov_b64 exec, s[36:37]
    ds_write_b128 v3, v[32:35] offset:1056
    s_mov_b64 exec, -1
    v_mov_b64 v[36:37], 0
    v_mov_b64 v[38:39], 0
    v_mov_b64 v[28:29], 0
    v_mov_b64 v[30:31], 0
    s_waitcnt lgkmcnt(0)
    s_barrier
    ds_read_b128 v[12:15], v3 offset:0
    ds_read_b128 v[16:19], v3 offset:32
    ds_read_b128 v[20:23], v3 offset:1024
    ds_read_b128 v[24:27], v3 offset:1056
    s_waitcnt lgkmcnt(3)
    v_smfmac_f32_16x16x64_bf16 v[36:39], v[12:15], v[48:55], v1
    ds_read_b128 v[72:75], v4 offset:32768
    s_waitcnt lgkmcnt(3)
    v_smfmac_f32_16x16x64_bf16 v[36:39], v[16:19], v[56:63], v1
    ds_read_b128 v[76:79], v4 offset:33792
    s_waitcnt lgkmcnt(3)
    v_smfmac_f32_16x16x64_bf16 v[36:39], v[20:23], a[216:223], v1
    s_waitcnt lgkmcnt(2)
    v_smfmac_f32_16x16x64_bf16 v[36:39], v[24:27], a[224:231], v1
    v_smfmac_f32_16x16x64_bf16 v[28:31], v[12:15], a[232:239], v1
    v_smfmac_f32_16x16x64_bf16 v[28:31], v[16:19], a[240:247], v1
    v_cvt_pk_bf16_f32 v36, v36, v37
    s_waitcnt lgkmcnt(0)
    v_smfmac_f32_16x16x64_bf16 v[28:31], v[20:23], v[72:79], v1
    v_or_b32 v36, 1, v36
    v_smfmac_f32_16x16x64_bf16 v[28:31], v[24:27], a[248:255], v1
    buffer_store_dword v36, v5, s[4:7], s28 offen
    v_cvt_pk_bf16_f32 v37, v38, v39
    v_or_b32 v37, 1, v37
    buffer_store_dword v37, v5, s[4:7], s29 offen
    s_nop 2
    v_cvt_pk_bf16_f32 v28, v28, v29
    v_cvt_pk_bf16_f32 v29, v30, v31
    v_or_b32 v28, 1, v28
    v_or_b32 v29, 1, v29
    buffer_store_dword v28, v5, s[4:7], s46 offen
    buffer_store_dword v29, v5, s[4:7], s73 offen
    ds_read_b128 v[48:51], v4 offset:0
    ds_read_b128 v[52:55], v4 offset:1024
    ds_read_b128 v[56:59], v4 offset:14336
    ds_read_b128 v[60:63], v4 offset:15360
    v_mov_b32_dpp v9, v42 quad_perm:[0,1,0,1] row_mask:0xf bank_mask:0xf
    v_mov_b32_dpp v10, v43 quad_perm:[0,1,0,1] row_mask:0xf bank_mask:0xf
    v_cndmask_b32 v96, v44, v42, vcc
    v_cndmask_b32 v97, v45, v43, vcc
    v_cndmask_b32 v98, v46, v9, vcc
    v_cndmask_b32 v99, v47, v10, vcc
    v_mov_b64 v[28:29], 0
    v_mov_b64 v[30:31], 0
    v_mov_b64 v[36:37], 0
    v_mov_b64 v[38:39], 0
    s_add_u32 s26, s26, 32768
    s_add_u32 s23, s23, 32768
    s_add_u32 s24, s24, 32768
    s_add_u32 s30, s30, 524288
    s_add_u32 s27, s27, 524288
    s_waitcnt vmcnt(4)
    v_readfirstlane_b32 s33, v6
    s_nop 0
    s_and_b32 s33, s33, 0xffff
    s_cmp_lg_u32 s33, 32
    s_cbranch_scc1 L_fl_L_ch13o_r
L_fl_L_ch13o:
    s_add_u32 s51, s18, 3
    s_min_u32 s51, s51, 63
    s_lshr_b32 s33, s51, 3
    s_add_u32 s33, s33, 10
    s_cmp_lt_u32 s51, 4
    s_cselect_b32 s51, 28, s33
    s_lshl_b32 s51, s51, 2
    s_barrier
    s_add_u32 s18, s18, 1
    v_mov_b64 v[32:33], 0
    v_mov_b64 v[34:35], 0
    s_nop 15
    s_nop 15
    s_nop 15
    s_nop 6
    buffer_load_dwordx4 v[24:27], v0, s[4:7], s22 offen sc1
    s_nop 15
    s_nop 3
    buffer_load_dwordx4 v[16:19], v0, s[4:7], s22 offen sc1
    s_waitcnt vmcnt(1)
    v_bitop3_b32 v8, v24, v25, v26 bitop3:0x80
    v_bitop3_b32 v8, v8, v27, 1 bitop3:0x80
    v_cmp_ne_u32 vcc, 1, v8
    ds_write_b128 v0, v[24:27] offset:9216
    s_cbranch_vccnz L_c3_L_ch13o_r
L_c3_L_ch13o:
    buffer_load_dwordx4 v[40:43], v0, s[4:7], s23 offen sc1
    s_waitcnt lgkmcnt(0)
    s_barrier
    s_branch L_ch1_w3
L_c2_L_ch13e_r:
    s_add_u32 s19, s19, 1
    s_cmp_gt_u32 s19, 4000000
    s_cbranch_scc1 L_cend1
    buffer_load_dwordx4 v[40:43], v0, s[4:7], s23 offen sc1
    s_waitcnt vmcnt(0)
    v_bitop3_b32 v8, v40, v41, v42 bitop3:0x80
    v_bitop3_b32 v8, v8, v43, 1 bitop3:0x80
    v_cmp_ne_u32 vcc, 1, v8
    s_cbranch_vccnz L_c2_L_ch13e_r
    ds_write_b128 v0, v[40:43] offset:3072
    s_nop 7
    s_waitcnt lgkmcnt(0)
    s_branch L_c2_L_ch13e
L_sm_L_ch13e_r:
    v_max3_f32 v8, v28, v29, v30
    v_max3_f32 v8, v8, v31, v40
    s_nop 1
    v_max_f32_dpp v9, v8, v8 quad_perm:[2,3,0,1] row_mask:0xf bank_mask:0xf
    v_max_f32_dpp v10, v8, v8 quad_perm:[2,3,0,1] row_mask:0xf bank_mask:0xf
    s_nop 1
    v_permlane16_swap_b32 v9, v10
    v_max_f32 v8, v9, v10
    v_max_f32 v11, v9, v10
    s_nop 1
    v_permlane32_swap_b32 v8, v11
    v_max_f32 v8, v8, v11
    v_sub_f32 v28, v28, v8
    v_sub_f32 v29, v29, v8
    v_sub_f32 v30, v30, v8
    v_sub_f32 v31, v31, v8
    v_sub_f32 v40, v40, v8
    v_exp_f32 v11, v40
    s_nop 1
    v_mov_b32_dpp v9, v11 quad_perm:[0,1,0,1] row_mask:0xf bank_mask:0xf
    v_exp_f32 v16, v28
    v_exp_f32 v17, v29
    v_cvt_pk_bf16_f32 v12, v11, v9
    v_cvt_pk_bf16_f32 v15, v11, v9
    v_cvt_pk_bf16_f32 v32, v16, v17
    v_exp_f32 v18, v30
    v_mfma_f32_16x16x16_bf16 v[20:23], v[42:43], v[12:13], 0
    v_exp_f32 v19, v31
    v_mov_b32_dpp v34, v32 quad_perm:[0,1,0,1] row_mask:0xf bank_mask:0xf
    v_cvt_pk_bf16_f32 v33, v18, v19
    v_mfma_f32_16x16x16_bf16 v[24:27], v[42:43], v[14:15], 0
    v_add_f32 v8, v16, v17
    v_mov_b32_dpp v35, v33 quad_perm:[0,1,0,1] row_mask:0xf bank_mask:0xf
    v_add_f32 v10, v18, v19
    v_add_f32 v8, v8, v11
    v_mfma_f32_16x16x32_bf16 v[20:23], v[72:75], v[32:35], v[20:23]
    v_add_f32 v8, v8, v10
    v_mfma_f32_16x16x32_bf16 v[24:27], v[76:79], v[32:35], v[24:27]
    v_add_f32_dpp v9, v8, v8 quad_perm:[2,3,0,1] row_mask:0xf bank_mask:0xf
    v_add_f32_dpp v10, v8, v8 quad_perm:[2,3,0,1] row_mask:0xf bank_mask:0xf
    s_nop 1
    v_permlane16_swap_b32 v9, v10
    v_add_f32 v8, v9, v10
    v_add_f32 v9, v9, v10
    s_nop 1
    v_permlane32_swap_b32 v8, v9
    v_add_f32 v8, v8, v9
    v_rcp_f32 v10, v8
    s_nop 0
    v_pk_mul_f32 v[20:21], v[20:21], v[10:11] op_sel_hi:[1,0]
    v_pk_mul_f32 v[22:23], v[22:23], v[10:11] op_sel_hi:[1,0]
    v_pk_mul_f32 v[24:25], v[24:25], v[10:11] op_sel_hi:[1,0]
    v_pk_mul_f32 v[26:27], v[26:27], v[10:11] op_sel_hi:[1,0]
    v_cvt_pk_bf16_f32 v32, v20, v24
    v_cvt_pk_bf16_f32 v33, v21, v25
    v_cvt_pk_bf16_f32 v34, v22, v26
    v_cvt_pk_bf16_f32 v35, v23, v27
    s_branch L_sm_L_ch13e
L_fl_L_ch13e_r:
    s_add_u32 s19, s19, 1
    s_cmp_gt_u32 s19, 4000000
    s_cbranch_scc1 L_cend1
    s_sleep 8
    buffer_load_dword v6, off, s[8:11], s51 sc1
    s_waitcnt vmcnt(0)
    v_readfirstlane_b32 s33, v6
    s_nop 0
    s_and_b32 s33, s33, 0xffff
    s_cmp_lg_u32 s33, 32
    s_cbranch_scc1 L_fl_L_ch13e_r
    s_branch L_fl_L_ch13e
L_c3_L_ch13e_r:
    s_add_u32 s19, s19, 1
    s_cmp_gt_u32 s19, 4000000
    s_cbranch_scc1 L_cend1
    buffer_load_dwordx4 v[24:27], v0, s[4:7], s22 offen sc1
    s_waitcnt vmcnt(1)
    v_or3_b32 v8, v16, v17, v18
    v_or_b32 v8, v8, v19
    v_and_b32 v8, 1, v8
    v_cmp_ne_u32 vcc, 0, v8
    s_cbranch_vccnz L_c3_L_ch13e_r2
    ds_write_b128 v0, v[16:19] offset:9216
    s_branch L_c3_L_ch13e
L_c3_L_ch13e_r2:
    buffer_load_dwordx4 v[16:19], v0, s[4:7], s22 offen sc1
    s_waitcnt vmcnt(1)
    v_or3_b32 v8, v24, v25, v26
    v_or_b32 v8, v8, v27
    v_and_b32 v8, 1, v8
    v_cmp_ne_u32 vcc, 0, v8
    s_cbranch_vccnz L_c3_L_ch13e_r
    ds_write_b128 v0, v[24:27] offset:9216
    s_branch L_c3_L_ch13e
L_c2_L_ch13o_r:
    s_add_u32 s19, s19, 1
    s_cmp_gt_u32 s19, 4000000
    s_cbranch_scc1 L_cend1
    buffer_load_dwordx4 v[40:43], v0, s[4:7], s23 offen sc1
    s_waitcnt vmcnt(0)
    v_or3_b32 v8, v40, v41, v42
    v_or_b32 v8, v8, v43
    v_and_b32 v8, 1, v8
    v_cmp_ne_u32 vcc, 0, v8
    s_cbranch_vccnz L_c2_L_ch13o_r
    ds_write_b128 v0, v[40:43] offset:3072
    s_nop 7
    s_waitcnt lgkmcnt(0)
    s_branch L_c2_L_ch13o
L_sm_L_ch13o_r:
    v_max3_f32 v8, v28, v29, v30
    v_max3_f32 v8, v8, v31, v40
    s_nop 1
    v_max_f32_dpp v9, v8, v8 quad_perm:[2,3,0,1] row_mask:0xf bank_mask:0xf
    v_max_f32_dpp v10, v8, v8 quad_perm:[2,3,0,1] row_mask:0xf bank_mask:0xf
    s_nop 1
    v_permlane16_swap_b32 v9, v10
    v_max_f32 v8, v9, v10
    v_max_f32 v11, v9, v10
    s_nop 1
    v_permlane32_swap_b32 v8, v11
    v_max_f32 v8, v8, v11
    v_sub_f32 v28, v28, v8
    v_sub_f32 v29, v29, v8
    v_sub_f32 v30, v30, v8
    v_sub_f32 v31, v31, v8
    v_sub_f32 v40, v40, v8
    v_exp_f32 v11, v40
    s_nop 1
    v_mov_b32_dpp v9, v11 quad_perm:[0,1,0,1] row_mask:0xf bank_mask:0xf
    v_exp_f32 v16, v28
    v_exp_f32 v17, v29
    v_cvt_pk_bf16_f32 v12, v11, v9
    v_cvt_pk_bf16_f32 v15, v11, v9
    v_cvt_pk_bf16_f32 v32, v16, v17
    v_exp_f32 v18, v30
    v_mfma_f32_16x16x16_bf16 v[20:23], v[42:43], v[12:13], 0
    v_exp_f32 v19, v31
    v_mov_b32_dpp v34, v32 quad_perm:[0,1,0,1] row_mask:0xf bank_mask:0xf
    v_cvt_pk_bf16_f32 v33, v18, v19
    v_mfma_f32_16x16x16_bf16 v[24:27], v[42:43], v[14:15], 0
    v_add_f32 v8, v16, v17
    v_mov_b32_dpp v35, v33 quad_perm:[0,1,0,1] row_mask:0xf bank_mask:0xf
    v_add_f32 v10, v18, v19
    v_add_f32 v8, v8, v11
    v_mfma_f32_16x16x32_bf16 v[20:23], v[72:75], v[32:35], v[20:23]
    v_add_f32 v8, v8, v10
    v_mfma_f32_16x16x32_bf16 v[24:27], v[76:79], v[32:35], v[24:27]
    v_add_f32_dpp v9, v8, v8 quad_perm:[2,3,0,1] row_mask:0xf bank_mask:0xf
    v_add_f32_dpp v10, v8, v8 quad_perm:[2,3,0,1] row_mask:0xf bank_mask:0xf
    s_nop 1
    v_permlane16_swap_b32 v9, v10
    v_add_f32 v8, v9, v10
    v_add_f32 v9, v9, v10
    s_nop 1
    v_permlane32_swap_b32 v8, v9
    v_add_f32 v8, v8, v9
    v_rcp_f32 v10, v8
    s_nop 0
    v_pk_mul_f32 v[20:21], v[20:21], v[10:11] op_sel_hi:[1,0]
    v_pk_mul_f32 v[22:23], v[22:23], v[10:11] op_sel_hi:[1,0]
    v_pk_mul_f32 v[24:25], v[24:25], v[10:11] op_sel_hi:[1,0]
    v_pk_mul_f32 v[26:27], v[26:27], v[10:11] op_sel_hi:[1,0]
    v_cvt_pk_bf16_f32 v32, v20, v24
    v_cvt_pk_bf16_f32 v33, v21, v25
    v_cvt_pk_bf16_f32 v34, v22, v26
    v_cvt_pk_bf16_f32 v35, v23, v27
    s_branch L_sm_L_ch13o
L_fl_L_ch13o_r:
    s_add_u32 s19, s19, 1
    s_cmp_gt_u32 s19, 4000000
    s_cbranch_scc1 L_cend1
    s_sleep 8
    buffer_load_dword v6, off, s[8:11], s51 sc1
    s_waitcnt vmcnt(0)
    v_readfirstlane_b32 s33, v6
    s_nop 0
    s_and_b32 s33, s33, 0xffff
    s_cmp_lg_u32 s33, 32
    s_cbranch_scc1 L_fl_L_ch13o_r
    s_branch L_fl_L_ch13o
L_c3_L_ch13o_r:
    s_add_u32 s19, s19, 1
    s_cmp_gt_u32 s19, 4000000
    s_cbranch_scc1 L_cend1
    buffer_load_dwordx4 v[24:27], v0, s[4:7], s22 offen sc1
    s_waitcnt vmcnt(1)
    v_bitop3_b32 v8, v16, v17, v18 bitop3:0x80
    v_bitop3_b32 v8, v8, v19, 1 bitop3:0x80
    v_cmp_ne_u32 vcc, 1, v8
    s_cbranch_vccnz L_c3_L_ch13o_r2
    ds_write_b128 v0, v[16:19] offset:9216
    s_branch L_c3_L_ch13o
L_c3_L_ch13o_r2:
    buffer_load_dwordx4 v[16:19], v0, s[4:7], s22 offen sc1
    s_waitcnt vmcnt(1)
    v_bitop3_b32 v8, v24, v25, v26 bitop3:0x80
    v_bitop3_b32 v8, v8, v27, 1 bitop3:0x80
    v_cmp_ne_u32 vcc, 1, v8
    s_cbranch_vccnz L_c3_L_ch13o_r
    ds_write_b128 v0, v[24:27] offset:9216
    s_branch L_c3_L_ch13o
L_cdone1:
    s_nop 7
    v_mov_b32_dpp v9, v42 quad_perm:[0,1,0,1] row_mask:0xf bank_mask:0xf
    v_mov_b32_dpp v10, v43 quad_perm:[0,1,0,1] row_mask:0xf bank_mask:0xf
    v_cndmask_b32 v96, v44, v42, vcc
    v_cndmask_b32 v97, v45, v43, vcc
    v_cndmask_b32 v98, v46, v9, vcc
    v_cndmask_b32 v99, v47, v10, vcc
    buffer_store_dwordx4 v[96:99], v0, s[4:7], s31 offen sc1
    s_waitcnt vmcnt(0)
    s_barrier
    s_cmp_lg_u32 s17, 3
    s_cbranch_scc1 L_cexit1
    v_mov_b32 v8, 64
    s_mov_b64 exec, 1
    buffer_store_dword v8, off, s[4:7], s32 sc1
    s_mov_b64 exec, -1
L_cexit1:
L_cend1:
    s_waitcnt vmcnt(0)
    s_endpgm
L_worker:
    s_load_dwordx16 s[64:79], s[0:1], 0
    s_load_dwordx8 s[80:87], s[0:1], 64
    s_load_dwordx2 s[28:29], s[0:1], 96
    s_sub_u32 s47, s3, 2
    s_mov_b32 s30, 5242880
    s_mov_b32 s31, 0x20000
    s_mov_b32 s15, 0x20000
    s_mov_b32 s23, 0x20000
    s_mov_b32 s27, 0x20000
    s_or_b32 s39, s47, s16
    s_or_b32 s39, s39, s17
    s_cmp_lg_u32 s39, 0
    s_cbranch_scc1 L_noprobe
    v_mov_b32 v8, 0
    s_mov_b64 exec, 1
    s_mov_b32 s50, -1
    s_mov_b32 s51, -1
    s_mov_b32 s52, 0
    s_mov_b32 s53, 2104320
    s_mov_b32 s54, 2112512
L_probe:
    s_waitcnt lgkmcnt(0)
    s_memtime s[56:57]
    s_waitcnt lgkmcnt(0)
    buffer_store_dword v8, off, s[4:7], s53 sc1
    s_waitcnt vmcnt(0)
    s_memtime s[60:61]
    s_waitcnt lgkmcnt(0)
    buffer_store_dword v8, off, s[4:7], s54 sc1
    s_waitcnt vmcnt(0)
    s_memtime s[62:63]
    s_waitcnt lgkmcnt(0)
    s_sub_u32 s56, s60, s56
    s_sub_u32 s57, s62, s60
    s_min_u32 s50, s50, s56
    s_min_u32 s51, s51, s57
    s_add_u32 s52, s52, 1
    s_cmp_lt_u32 s52, 3
    s_cbranch_scc1 L_probe
    s_cmp_le_u32 s50, s51
    s_cselect_b32 s50, 1, 2
    v_mov_b32 v8, s50
    buffer_store_dword v8, off, s[8:11], 0 offset:36 sc1
    s_mov_b64 exec, -1
L_noprobe:
    s_waitcnt lgkmcnt(0)
    v_lshrrev_b32 v16, 3, v0
    v_mul_u32_u24 v16, 1280, v16
    v_and_b32 v17, 7, v0
    v_lshrrev_b32 v18, 4, v0
    v_xor_b32 v17, v17, v18
    v_lshl_add_u32 v1, v17, 4, v16
    v_xor_b32 v2, 64, v1
    v_and_b32 v16, 31, v0
    v_and_b32 v17, 0x13, v16
    v_bfe_u32 v18, v16, 2, 1
    v_lshl_add_u32 v17, v18, 3, v17
    v_bfe_u32 v18, v16, 3, 1
    v_lshl_add_u32 v17, v18, 2, v17
    v_bfe_u32 v18, v17, 1, 3
    v_lshrrev_b32 v19, 5, v0
    v_xor_b32 v18, v18, v19
    v_lshlrev_b32 v18, 4, v18
    v_lshl_add_u32 v18, v17, 7, v18
    s_lshl_b32 s39, s17, 13
    v_add_u32 v4, s39, v18
    v_xor_b32 v5, 32, v4
    v_xor_b32 v6, 64, v4
    v_xor_b32 v7, 0x60, v4
    v_bfe_u32 v16, v0, 2, 2
    v_lshl_add_u32 v17, v19, 3, v16
    v_lshlrev_b32 v17, 8, v17
    v_lshl_add_u32 v17, v16, 6, v17
    v_bfe_u32 v18, v0, 4, 1
    v_lshl_add_u32 v17, v18, 5, v17
    v_and_b32 v18, 1, v0
    v_bfe_u32 v19, v0, 1, 1
    v_lshl_add_u32 v16, v18, 4, v17
    v_lshl_add_u32 v8, v19, 3, v16
    v_lshl_add_u32 v16, v19, 4, v17
    v_lshl_add_u32 v12, v18, 3, v16
    v_xor_b32 v9, 64, v8
    v_xor_b32 v10, 128, v8
    v_xor_b32 v11, 192, v8
    v_xor_b32 v13, 64, v12
    v_xor_b32 v14, 128, v12
    v_xor_b32 v15, 192, v12
    s_lshl_b32 s37, s17, 13
    s_lshl_b32 s38, s17, 12
    s_add_u32 s38, s38, 32768
    s_mov_b32 s48, 0
    s_mov_b32 s49, 9
    s_mov_b32 s58, 0
    s_mov_b32 s59, 0
    s_mov_b32 s88, s4
    s_mov_b32 s89, s5
    s_mov_b32 s90, 0
    s_mov_b32 s91, 0x20000
    s_mov_b32 s62, 0
    s_mov_b32 s61, 0
    s_mov_b32 s92, 0
    v_mov_b32 v20, 0
    v_mov_b32 v21, 0
    s_mov_b32 s12, s74
    s_mov_b32 s13, s75
    s_mov_b32 s20, s80
    s_mov_b32 s21, s81
    s_mov_b32 s24, s82
    s_mov_b32 s25, s83
    s_mov_b32 s14, 0
    s_mov_b32 s22, 0
    s_mov_b32 s26, 0
    s_mov_b32 s93, 0
    s_mov_b32 s94, 0
    s_mov_b32 s95, 0
    s_mov_b32 s96, 0
L_task:
    s_mov_b32 s55, s49
    s_mov_b32 s56, s58
    s_mov_b32 s57, s59
    s_lshl_b32 s50, s47, 5
    s_add_u32 s50, s50, s16
    s_cmp_eq_u32 s48, 0
    s_cbranch_scc0 L_r1
    s_cmp_eq_u32 s47, 5
    s_cbranch_scc1 L_taskA
    s_mul_i32 s59, s50, 52429
    s_lshr_b32 s59, s59, 18
    s_mul_i32 s51, s59, 5
    s_sub_u32 s58, s50, s51
    s_cmp_lt_u32 s58, 2
    s_cbranch_scc1 L_half
    s_sub_u32 s58, s58, 1
    s_branch L_taskKV
L_r1:
    s_cmp_eq_u32 s48, 1
    s_cbranch_scc0 L_r2
    s_cmp_ge_u32 s47, 4
    s_cbranch_scc1 L_r1q
    s_lshr_b32 s59, s50, 2
    s_and_b32 s58, s50, 3
    s_add_u32 s58, s58, 4
    s_branch L_taskKV
L_r1q:
    s_sub_u32 s50, s50, 128
    s_branch L_taskQ
L_r2:
    s_mov_b32 s49, 8
    s_cmp_eq_u32 s48, 2
    s_cbranch_scc0 L_finish
    s_cmp_ge_u32 s47, 4
    s_cbranch_scc0 L_finish
    s_sub_u32 s50, s50, 64
    s_branch L_taskQ
L_taskAO:
    s_mov_b32 s55, 9
    s_mul_i32 s50, s47, 6
    s_add_u32 s50, s50, s16
    s_sub_u32 s50, s50, 26
    s_and_b32 s58, s50, 7
    s_lshr_b32 s59, s50, 3
    s_lshl_b32 s51, s58, 2
L_pt5:
    buffer_load_dword v251, off, s[8:11], s51 offset:80 sc1
    s_add_u32 s19, s19, 1
    s_cmp_gt_u32 s19, 3000000
    s_cbranch_scc1 L_wend2
    s_waitcnt vmcnt(0)
    v_readfirstlane_b32 s39, v251
    s_nop 0
    s_cmp_eq_u32 s39, 16
    s_cbranch_scc1 L_pt5_ok
    s_sleep 16
    s_branch L_pt5
L_pt5_ok:
    v_lshrrev_b32 v16, 3, v0
    v_mul_u32_u24 v16, 1280, v16
    v_and_b32 v17, 7, v0
    v_lshrrev_b32 v18, 4, v0
    v_xor_b32 v17, v17, v18
    v_lshl_add_u32 v1, v17, 4, v16
    v_xor_b32 v2, 64, v1
    v_and_b32 v16, 31, v0
    v_and_b32 v17, 0x13, v16
    v_bfe_u32 v18, v16, 2, 1
    v_lshl_add_u32 v17, v18, 3, v17
    v_bfe_u32 v18, v16, 3, 1
    v_lshl_add_u32 v17, v18, 2, v17
    v_bfe_u32 v18, v17, 1, 3
    v_lshrrev_b32 v19, 5, v0
    v_xor_b32 v18, v18, v19
    v_lshlrev_b32 v18, 4, v18
    v_lshl_add_u32 v18, v17, 7, v18
    s_lshl_b32 s39, s17, 13
    v_add_u32 v4, s39, v18
    v_xor_b32 v5, 32, v4
    v_xor_b32 v6, 64, v4
    v_xor_b32 v7, 0x60, v4
    v_bfe_u32 v16, v0, 2, 2
    v_lshl_add_u32 v17, v19, 3, v16
    v_lshlrev_b32 v17, 8, v17
    v_lshl_add_u32 v17, v16, 6, v17
    v_bfe_u32 v18, v0, 4, 1
    v_lshl_add_u32 v17, v18, 5, v17
    v_and_b32 v18, 1, v0
    v_bfe_u32 v19, v0, 1, 1
    v_lshl_add_u32 v16, v18, 4, v17
    v_lshl_add_u32 v8, v19, 3, v16
    v_lshl_add_u32 v16, v19, 4, v17
    v_lshl_add_u32 v12, v18, 3, v16
    v_xor_b32 v9, 64, v8
    v_xor_b32 v10, 128, v8
    v_xor_b32 v11, 192, v8
    v_xor_b32 v13, 64, v12
    v_xor_b32 v14, 128, v12
    v_xor_b32 v15, 192, v12
    s_lshl_b32 s37, s17, 13
    s_lshl_b32 s38, s17, 12
    s_add_u32 s38, s38, 32768
    s_mov_b32 s61, 0
    v_mov_b32 v20, 0
    v_mov_b32 v21, 0
    s_mov_b32 s49, 4
    s_mov_b32 s12, s4
    s_mov_b32 s13, s5
    s_mov_b32 s14, 0x10000000
    s_mov_b32 s20, s72
    s_mov_b32 s21, s73
    s_mov_b32 s24, s72
    s_mov_b32 s25, s73
    s_mov_b32 s32, 88080384
    s_branch L_taskA2
L_taskA:
    s_and_b32 s58, s16, 7
    s_lshr_b32 s59, s16, 3
    s_mov_b32 s12, s64
    s_mov_b32 s13, s65
    s_mov_b32 s14, 2621440
    s_mov_b32 s32, 0
    s_cmp_eq_u32 s59, 3
    s_cbranch_scc1 L_taskAKV
    s_mov_b32 s49, 2
    s_mov_b32 s20, s66
    s_mov_b32 s21, s67
    s_mov_b32 s24, s66
    s_mov_b32 s25, s67
L_taskA2:
    s_mov_b32 s22, 819200
    s_mov_b32 s26, 819200
    s_movk_i32 s60, 1280
    s_lshl_b32 s33, s59, 9
    s_add_u32 s34, s33, 256
    s_branch L_gemm
L_taskAKV:
    s_mov_b32 s49, 3
    s_mov_b32 s20, s68
    s_mov_b32 s21, s69
    s_mov_b32 s24, s70
    s_mov_b32 s25, s71
    s_mov_b32 s22, 25600
    s_mov_b32 s26, 25600
    s_movk_i32 s60, 40
    s_mov_b32 s33, 0
    s_mov_b32 s34, 0
    s_branch L_gemm
L_taskQ:
    s_mov_b32 s49, 1
    s_and_b32 s58, s50, 7
    s_lshr_b32 s59, s50, 3
    s_mov_b32 s20, s78
    s_mov_b32 s21, s79
    s_mov_b32 s24, s78
    s_mov_b32 s25, s79
    s_lshl_b32 s33, s59, 9
    s_add_u32 s34, s33, 256
    s_branch L_taskB
L_taskKV:
    s_mov_b32 s49, 0
    s_mov_b32 s20, s80
    s_mov_b32 s21, s81
    s_mov_b32 s24, s82
    s_mov_b32 s25, s83
    s_lshl_b32 s33, s59, 8
    s_mov_b32 s34, s33
L_taskB:
    s_mov_b32 s12, s74
    s_mov_b32 s13, s75
    s_mov_b32 s14, 2621440
    s_mov_b32 s32, 0
    s_mov_b32 s22, 5242880
    s_mov_b32 s26, 5242880
    s_movk_i32 s60, 8192
L_gemm:
    s_mul_i32 s50, s58, 327680
    s_add_u32 s32, s32, s50
    s_mul_i32 s39, s17, 81920
    s_add_u32 s32, s32, s39
    s_lshl_b32 s35, s60, 2
    s_lshl_b32 s36, s60, 6
    v_lshrrev_b32 v16, 4, v0
    s_lshl_b32 s39, s17, 4
    v_add_u32 v17, s39, v16
    v_mul_lo_u32 v17, v17, s60
    v_lshlrev_b32 v16, 2, v16
    v_and_b32 v18, 15, v0
    v_xor_b32 v16, v16, v18
    v_lshl_add_u32 v3, v16, 4, v17
    s_add_u32 m0, s38, 0
    s_mov_b32 s40, s33
    buffer_load_dwordx4 v3, s[20:23], s40 offen  lds
    s_add_u32 m0, s38, 1024
    s_add_u32 s40, s40, s35
    buffer_load_dwordx4 v3, s[20:23], s40 offen  lds
    s_add_u32 m0, s38, 2048
    s_add_u32 s40, s40, s35
    buffer_load_dwordx4 v3, s[20:23], s40 offen  lds
    s_add_u32 m0, s38, 3072
    s_add_u32 s40, s40, s35
    buffer_load_dwordx4 v3, s[20:23], s40 offen  lds
    s_add_u32 m0, s38, 16384
    s_mov_b32 s40, s34
    buffer_load_dwordx4 v3, s[24:27], s40 offen  lds
    s_add_u32 m0, s38, 17408
    s_add_u32 s40, s40, s35
    buffer_load_dwordx4 v3, s[24:27], s40 offen  lds
    s_add_u32 m0, s38, 18432
    s_add_u32 s40, s40, s35
    buffer_load_dwordx4 v3, s[24:27], s40 offen  lds
    s_add_u32 m0, s38, 19456
    s_add_u32 s40, s40, s35
    buffer_load_dwordx4 v3, s[24:27], s40 offen  lds
    s_add_u32 s33, s33, s36
    s_add_u32 s34, s34, s36
    s_add_u32 m0, s37, 0
    s_add_u32 s39, s32, 0
    buffer_load_dwordx4 v1, s[12:15], s39 offen  lds
    s_add_u32 m0, s37, 1024
    s_add_u32 s39, s32, 10240
    buffer_load_dwordx4 v2, s[12:15], s39 offen  lds
    s_add_u32 m0, s37, 2048
    s_add_u32 s39, s32, 20480
    buffer_load_dwordx4 v1, s[12:15], s39 offen  lds
    s_add_u32 m0, s37, 3072
    s_add_u32 s39, s32, 30720
    buffer_load_dwordx4 v2, s[12:15], s39 offen  lds
    s_add_u32 m0, s37, 4096
    s_add_u32 s39, s32, 40960
    buffer_load_dwordx4 v1, s[12:15], s39 offen  lds
    s_add_u32 m0, s37, 5120
    s_add_u32 s39, s32, 51200
    buffer_load_dwordx4 v2, s[12:15], s39 offen  lds
    s_add_u32 m0, s37, 6144
    s_add_u32 s39, s32, 61440
    buffer_load_dwordx4 v1, s[12:15], s39 offen  lds
    s_add_u32 m0, s37, 7168
    s_add_u32 s39, s32, 71680
    buffer_load_dwordx4 v2, s[12:15], s39 offen  lds
    s_add_u32 s32, s32, 128
    s_add_u32 m0, s38, 65536
    s_mov_b32 s40, s33
    buffer_load_dwordx4 v3, s[20:23], s40 offen  lds
    s_add_u32 m0, s38, 66560
    s_add_u32 s40, s40, s35
    buffer_load_dwordx4 v3, s[20:23], s40 offen  lds
    s_add_u32 m0, s38, 67584
    s_add_u32 s40, s40, s35
    buffer_load_dwordx4 v3, s[20:23], s40 offen  lds
    s_add_u32 m0, s38, 68608
    s_add_u32 s40, s40, s35
    buffer_load_dwordx4 v3, s[20:23], s40 offen  lds
    s_add_u32 m0, s38, 81920
    s_mov_b32 s40, s34
    buffer_load_dwordx4 v3, s[24:27], s40 offen  lds
    s_add_u32 m0, s38, 82944
    s_add_u32 s40, s40, s35
    buffer_load_dwordx4 v3, s[24:27], s40 offen  lds
    s_add_u32 m0, s38, 83968
    s_add_u32 s40, s40, s35
    buffer_load_dwordx4 v3, s[24:27], s40 offen  lds
    s_add_u32 m0, s38, 84992
    s_add_u32 s40, s40, s35
    buffer_load_dwordx4 v3, s[24:27], s40 offen  lds
    s_add_u32 s33, s33, s36
    s_add_u32 s34, s34, s36
L_finish:
    s_cmp_eq_u32 s55, 9
    s_cbranch_scc1 L_go
    s_lshl_b32 s53, s56, 3
    s_lshl_b32 s54, s17, 1
    s_add_u32 s53, s53, s54
    s_cmp_eq_u32 s55, 3
    s_cbranch_scc1 L_fin_akv
    s_mov_b32 s88, s4
    s_mov_b32 s89, s5
    s_mov_b32 s90, 0x10000000
    s_cmp_ge_u32 s55, 2
    s_cbranch_scc1 L_fin_rows
    v_bfe_u32 v17, v0, 3, 1
    v_lshlrev_b32 v20, 10, v17
    v_bfe_u32 v17, v0, 4, 1
    v_lshl_add_u32 v20, v17, 7, v20
    v_bfe_u32 v17, v0, 2, 1
    v_lshl_add_u32 v20, v17, 6, v20
    v_and_b32 v17, 3, v0
    v_lshl_add_u32 v20, v17, 4, v20
    v_lshrrev_b32 v17, 5, v0
    v_lshl_add_u32 v20, v17, 8, v20
    v_and_b32 v17, 1, v0
    v_lshlrev_b32 v21, 10, v17
    v_bfe_u32 v17, v0, 1, 4
    v_lshl_add_u32 v21, v17, 4, v21
    v_lshrrev_b32 v17, 5, v0
    v_lshl_add_u32 v21, v17, 8, v21
    s_lshl_b32 s54, s57, 14
    s_lshl_b32 s61, s56, 2
    s_add_u32 s61, s61, 40
    s_cmp_eq_u32 s55, 0
    s_cbranch_scc0 L_fin_q
    s_lshl_b32 s92, s53, 19
    s_add_u32 s92, s92, 13631488
    s_mov_b32 s62, 1
    s_mov_b32 s93, 512
    s_mov_b32 s94, 3584
    s_mov_b32 s95, 511488
    s_mov_b32 s96, 4294432256
    s_branch L_fin_frag
L_fin_q:
    v_mov_b32 v21, v20
    s_lshl_b32 s92, s53, 18
    s_add_u32 s92, s92, 50331648
    s_mov_b32 s62, 0x10000
    s_mov_b32 s93, 512
    s_mov_b32 s94, 1536
    s_mov_b32 s95, 255488
    s_mov_b32 s96, 4294706688
L_fin_frag:
    s_add_u32 s92, s92, s54
    v_accvgpr_read_b32 v232, a0
    v_accvgpr_read_b32 v233, a1
    v_accvgpr_read_b32 v234, a2
    v_accvgpr_read_b32 v235, a3
    v_accvgpr_read_b32 v236, a4
    v_accvgpr_read_b32 v237, a5
    v_accvgpr_read_b32 v238, a6
    v_accvgpr_read_b32 v239, a7
    v_accvgpr_read_b32 v240, a8
    v_accvgpr_read_b32 v241, a9
    v_accvgpr_read_b32 v242, a10
    v_accvgpr_read_b32 v243, a11
    v_accvgpr_read_b32 v244, a12
    v_accvgpr_read_b32 v245, a13
    v_accvgpr_read_b32 v246, a14
    v_accvgpr_read_b32 v247, a15
    v_cvt_pk_bf16_f32 v104, v232, v233
    v_cvt_pk_bf16_f32 v105, v234, v235
    v_cvt_pk_bf16_f32 v106, v236, v237
    v_cvt_pk_bf16_f32 v107, v238, v239
    v_cvt_pk_bf16_f32 v108, v240, v241
    v_cvt_pk_bf16_f32 v109, v242, v243
    v_cvt_pk_bf16_f32 v110, v244, v245
    v_cvt_pk_bf16_f32 v111, v246, v247
    v_accvgpr_read_b32 v232, a16
    v_accvgpr_read_b32 v233, a17
    v_accvgpr_read_b32 v234, a18
    v_accvgpr_read_b32 v235, a19
    v_accvgpr_read_b32 v236, a20
    v_accvgpr_read_b32 v237, a21
    v_accvgpr_read_b32 v238, a22
    v_accvgpr_read_b32 v239, a23
    v_accvgpr_read_b32 v240, a24
    v_accvgpr_read_b32 v241, a25
    v_accvgpr_read_b32 v242, a26
    v_accvgpr_read_b32 v243, a27
    v_accvgpr_read_b32 v244, a28
    v_accvgpr_read_b32 v245, a29
    v_accvgpr_read_b32 v246, a30
    v_accvgpr_read_b32 v247, a31
    v_cvt_pk_bf16_f32 v112, v232, v233
    v_cvt_pk_bf16_f32 v113, v234, v235
    v_cvt_pk_bf16_f32 v114, v236, v237
    v_cvt_pk_bf16_f32 v115, v238, v239
    v_cvt_pk_bf16_f32 v116, v240, v241
    v_cvt_pk_bf16_f32 v117, v242, v243
    v_cvt_pk_bf16_f32 v118, v244, v245
    v_cvt_pk_bf16_f32 v119, v246, v247
    v_accvgpr_read_b32 v232, a32
    v_accvgpr_read_b32 v233, a33
    v_accvgpr_read_b32 v234, a34
    v_accvgpr_read_b32 v235, a35
    v_accvgpr_read_b32 v236, a36
    v_accvgpr_read_b32 v237, a37
    v_accvgpr_read_b32 v238, a38
    v_accvgpr_read_b32 v239, a39
    v_accvgpr_read_b32 v240, a40
    v_accvgpr_read_b32 v241, a41
    v_accvgpr_read_b32 v242, a42
    v_accvgpr_read_b32 v243, a43
    v_accvgpr_read_b32 v244, a44
    v_accvgpr_read_b32 v245, a45
    v_accvgpr_read_b32 v246, a46
    v_accvgpr_read_b32 v247, a47
    v_cvt_pk_bf16_f32 v120, v232, v233
    v_cvt_pk_bf16_f32 v121, v234, v235
    v_cvt_pk_bf16_f32 v122, v236, v237
    v_cvt_pk_bf16_f32 v123, v238, v239
    v_cvt_pk_bf16_f32 v124, v240, v241
    v_cvt_pk_bf16_f32 v125, v242, v243
    v_cvt_pk_bf16_f32 v126, v244, v245
    v_cvt_pk_bf16_f32 v127, v246, v247
    v_accvgpr_read_b32 v232, a48
    v_accvgpr_read_b32 v233, a49
    v_accvgpr_read_b32 v234, a50
    v_accvgpr_read_b32 v235, a51
    v_accvgpr_read_b32 v236, a52
    v_accvgpr_read_b32 v237, a53
    v_accvgpr_read_b32 v238, a54
    v_accvgpr_read_b32 v239, a55
    v_accvgpr_read_b32 v240, a56
    v_accvgpr_read_b32 v241, a57
    v_accvgpr_read_b32 v242, a58
    v_accvgpr_read_b32 v243, a59
    v_accvgpr_read_b32 v244, a60
    v_accvgpr_read_b32 v245, a61
    v_accvgpr_read_b32 v246, a62
    v_accvgpr_read_b32 v247, a63
    v_cvt_pk_bf16_f32 v128, v232, v233
    v_cvt_pk_bf16_f32 v129, v234, v235
    v_cvt_pk_bf16_f32 v130, v236, v237
    v_cvt_pk_bf16_f32 v131, v238, v239
    v_cvt_pk_bf16_f32 v132, v240, v241
    v_cvt_pk_bf16_f32 v133, v242, v243
    v_cvt_pk_bf16_f32 v134, v244, v245
    v_cvt_pk_bf16_f32 v135, v246, v247
    v_accvgpr_read_b32 v232, a64
    v_accvgpr_read_b32 v233, a65
    v_accvgpr_read_b32 v234, a66
    v_accvgpr_read_b32 v235, a67
    v_accvgpr_read_b32 v236, a68
    v_accvgpr_read_b32 v237, a69
    v_accvgpr_read_b32 v238, a70
    v_accvgpr_read_b32 v239, a71
    v_accvgpr_read_b32 v240, a72
    v_accvgpr_read_b32 v241, a73
    v_accvgpr_read_b32 v242, a74
    v_accvgpr_read_b32 v243, a75
    v_accvgpr_read_b32 v244, a76
    v_accvgpr_read_b32 v245, a77
    v_accvgpr_read_b32 v246, a78
    v_accvgpr_read_b32 v247, a79
    v_cvt_pk_bf16_f32 v136, v232, v233
    v_cvt_pk_bf16_f32 v137, v234, v235
    v_cvt_pk_bf16_f32 v138, v236, v237
    v_cvt_pk_bf16_f32 v139, v238, v239
    v_cvt_pk_bf16_f32 v140, v240, v241
    v_cvt_pk_bf16_f32 v141, v242, v243
    v_cvt_pk_bf16_f32 v142, v244, v245
    v_cvt_pk_bf16_f32 v143, v246, v247
    v_accvgpr_read_b32 v232, a80
    v_accvgpr_read_b32 v233, a81
    v_accvgpr_read_b32 v234, a82
    v_accvgpr_read_b32 v235, a83
    v_accvgpr_read_b32 v236, a84
    v_accvgpr_read_b32 v237, a85
    v_accvgpr_read_b32 v238, a86
    v_accvgpr_read_b32 v239, a87
    v_accvgpr_read_b32 v240, a88
    v_accvgpr_read_b32 v241, a89
    v_accvgpr_read_b32 v242, a90
    v_accvgpr_read_b32 v243, a91
    v_accvgpr_read_b32 v244, a92
    v_accvgpr_read_b32 v245, a93
    v_accvgpr_read_b32 v246, a94
    v_accvgpr_read_b32 v247, a95
    v_cvt_pk_bf16_f32 v144, v232, v233
    v_cvt_pk_bf16_f32 v145, v234, v235
    v_cvt_pk_bf16_f32 v146, v236, v237
    v_cvt_pk_bf16_f32 v147, v238, v239
    v_cvt_pk_bf16_f32 v148, v240, v241
    v_cvt_pk_bf16_f32 v149, v242, v243
    v_cvt_pk_bf16_f32 v150, v244, v245
    v_cvt_pk_bf16_f32 v151, v246, v247
    v_accvgpr_read_b32 v232, a96
    v_accvgpr_read_b32 v233, a97
    v_accvgpr_read_b32 v234, a98
    v_accvgpr_read_b32 v235, a99
    v_accvgpr_read_b32 v236, a100
    v_accvgpr_read_b32 v237, a101
    v_accvgpr_read_b32 v238, a102
    v_accvgpr_read_b32 v239, a103
    v_accvgpr_read_b32 v240, a104
    v_accvgpr_read_b32 v241, a105
    v_accvgpr_read_b32 v242, a106
    v_accvgpr_read_b32 v243, a107
    v_accvgpr_read_b32 v244, a108
    v_accvgpr_read_b32 v245, a109
    v_accvgpr_read_b32 v246, a110
    v_accvgpr_read_b32 v247, a111
    v_cvt_pk_bf16_f32 v152, v232, v233
    v_cvt_pk_bf16_f32 v153, v234, v235
    v_cvt_pk_bf16_f32 v154, v236, v237
    v_cvt_pk_bf16_f32 v155, v238, v239
    v_cvt_pk_bf16_f32 v156, v240, v241
    v_cvt_pk_bf16_f32 v157, v242, v243
    v_cvt_pk_bf16_f32 v158, v244, v245
    v_cvt_pk_bf16_f32 v159, v246, v247
    v_accvgpr_read_b32 v232, a112
    v_accvgpr_read_b32 v233, a113
    v_accvgpr_read_b32 v234, a114
    v_accvgpr_read_b32 v235, a115
    v_accvgpr_read_b32 v236, a116
    v_accvgpr_read_b32 v237, a117
    v_accvgpr_read_b32 v238, a118
    v_accvgpr_read_b32 v239, a119
    v_accvgpr_read_b32 v240, a120
    v_accvgpr_read_b32 v241, a121
    v_accvgpr_read_b32 v242, a122
    v_accvgpr_read_b32 v243, a123
    v_accvgpr_read_b32 v244, a124
    v_accvgpr_read_b32 v245, a125
    v_accvgpr_read_b32 v246, a126
    v_accvgpr_read_b32 v247, a127
    v_cvt_pk_bf16_f32 v160, v232, v233
    v_cvt_pk_bf16_f32 v161, v234, v235
    v_cvt_pk_bf16_f32 v162, v236, v237
    v_cvt_pk_bf16_f32 v163, v238, v239
    v_cvt_pk_bf16_f32 v164, v240, v241
    v_cvt_pk_bf16_f32 v165, v242, v243
    v_cvt_pk_bf16_f32 v166, v244, v245
    v_cvt_pk_bf16_f32 v167, v246, v247
    v_accvgpr_read_b32 v232, a128
    v_accvgpr_read_b32 v233, a129
    v_accvgpr_read_b32 v234, a130
    v_accvgpr_read_b32 v235, a131
    v_accvgpr_read_b32 v236, a132
    v_accvgpr_read_b32 v237, a133
    v_accvgpr_read_b32 v238, a134
    v_accvgpr_read_b32 v239, a135
    v_accvgpr_read_b32 v240, a136
    v_accvgpr_read_b32 v241, a137
    v_accvgpr_read_b32 v242, a138
    v_accvgpr_read_b32 v243, a139
    v_accvgpr_read_b32 v244, a140
    v_accvgpr_read_b32 v245, a141
    v_accvgpr_read_b32 v246, a142
    v_accvgpr_read_b32 v247, a143
    v_cvt_pk_bf16_f32 v168, v232, v233
    v_cvt_pk_bf16_f32 v169, v234, v235
    v_cvt_pk_bf16_f32 v170, v236, v237
    v_cvt_pk_bf16_f32 v171, v238, v239
    v_cvt_pk_bf16_f32 v172, v240, v241
    v_cvt_pk_bf16_f32 v173, v242, v243
    v_cvt_pk_bf16_f32 v174, v244, v245
    v_cvt_pk_bf16_f32 v175, v246, v247
    v_accvgpr_read_b32 v232, a144
    v_accvgpr_read_b32 v233, a145
    v_accvgpr_read_b32 v234, a146
    v_accvgpr_read_b32 v235, a147
    v_accvgpr_read_b32 v236, a148
    v_accvgpr_read_b32 v237, a149
    v_accvgpr_read_b32 v238, a150
    v_accvgpr_read_b32 v239, a151
    v_accvgpr_read_b32 v240, a152
    v_accvgpr_read_b32 v241, a153
    v_accvgpr_read_b32 v242, a154
    v_accvgpr_read_b32 v243, a155
    v_accvgpr_read_b32 v244, a156
    v_accvgpr_read_b32 v245, a157
    v_accvgpr_read_b32 v246, a158
    v_accvgpr_read_b32 v247, a159
    v_cvt_pk_bf16_f32 v176, v232, v233
    v_cvt_pk_bf16_f32 v177, v234, v235
    v_cvt_pk_bf16_f32 v178, v236, v237
    v_cvt_pk_bf16_f32 v179, v238, v239
    v_cvt_pk_bf16_f32 v180, v240, v241
    v_cvt_pk_bf16_f32 v181, v242, v243
    v_cvt_pk_bf16_f32 v182, v244, v245
    v_cvt_pk_bf16_f32 v183, v246, v247
    v_accvgpr_read_b32 v232, a160
    v_accvgpr_read_b32 v233, a161
    v_accvgpr_read_b32 v234, a162
    v_accvgpr_read_b32 v235, a163
    v_accvgpr_read_b32 v236, a164
    v_accvgpr_read_b32 v237, a165
    v_accvgpr_read_b32 v238, a166
    v_accvgpr_read_b32 v239, a167
    v_accvgpr_read_b32 v240, a168
    v_accvgpr_read_b32 v241, a169
    v_accvgpr_read_b32 v242, a170
    v_accvgpr_read_b32 v243, a171
    v_accvgpr_read_b32 v244, a172
    v_accvgpr_read_b32 v245, a173
    v_accvgpr_read_b32 v246, a174
    v_accvgpr_read_b32 v247, a175
    v_cvt_pk_bf16_f32 v184, v232, v233
    v_cvt_pk_bf16_f32 v185, v234, v235
    v_cvt_pk_bf16_f32 v186, v236, v237
    v_cvt_pk_bf16_f32 v187, v238, v239
    v_cvt_pk_bf16_f32 v188, v240, v241
    v_cvt_pk_bf16_f32 v189, v242, v243
    v_cvt_pk_bf16_f32 v190, v244, v245
    v_cvt_pk_bf16_f32 v191, v246, v247
    v_accvgpr_read_b32 v232, a176
    v_accvgpr_read_b32 v233, a177
    v_accvgpr_read_b32 v234, a178
    v_accvgpr_read_b32 v235, a179
    v_accvgpr_read_b32 v236, a180
    v_accvgpr_read_b32 v237, a181
    v_accvgpr_read_b32 v238, a182
    v_accvgpr_read_b32 v239, a183
    v_accvgpr_read_b32 v240, a184
    v_accvgpr_read_b32 v241, a185
    v_accvgpr_read_b32 v242, a186
    v_accvgpr_read_b32 v243, a187
    v_accvgpr_read_b32 v244, a188
    v_accvgpr_read_b32 v245, a189
    v_accvgpr_read_b32 v246, a190
    v_accvgpr_read_b32 v247, a191
    v_cvt_pk_bf16_f32 v192, v232, v233
    v_cvt_pk_bf16_f32 v193, v234, v235
    v_cvt_pk_bf16_f32 v194, v236, v237
    v_cvt_pk_bf16_f32 v195, v238, v239
    v_cvt_pk_bf16_f32 v196, v240, v241
    v_cvt_pk_bf16_f32 v197, v242, v243
    v_cvt_pk_bf16_f32 v198, v244, v245
    v_cvt_pk_bf16_f32 v199, v246, v247
    v_accvgpr_read_b32 v232, a192
    v_accvgpr_read_b32 v233, a193
    v_accvgpr_read_b32 v234, a194
    v_accvgpr_read_b32 v235, a195
    v_accvgpr_read_b32 v236, a196
    v_accvgpr_read_b32 v237, a197
    v_accvgpr_read_b32 v238, a198
    v_accvgpr_read_b32 v239, a199
    v_accvgpr_read_b32 v240, a200
    v_accvgpr_read_b32 v241, a201
    v_accvgpr_read_b32 v242, a202
    v_accvgpr_read_b32 v243, a203
    v_accvgpr_read_b32 v244, a204
    v_accvgpr_read_b32 v245, a205
    v_accvgpr_read_b32 v246, a206
    v_accvgpr_read_b32 v247, a207
    v_cvt_pk_bf16_f32 v200, v232, v233
    v_cvt_pk_bf16_f32 v201, v234, v235
    v_cvt_pk_bf16_f32 v202, v236, v237
    v_cvt_pk_bf16_f32 v203, v238, v239
    v_cvt_pk_bf16_f32 v204, v240, v241
    v_cvt_pk_bf16_f32 v205, v242, v243
    v_cvt_pk_bf16_f32 v206, v244, v245
    v_cvt_pk_bf16_f32 v207, v246, v247
    v_accvgpr_read_b32 v232, a208
    v_accvgpr_read_b32 v233, a209
    v_accvgpr_read_b32 v234, a210
    v_accvgpr_read_b32 v235, a211
    v_accvgpr_read_b32 v236, a212
    v_accvgpr_read_b32 v237, a213
    v_accvgpr_read_b32 v238, a214
    v_accvgpr_read_b32 v239, a215
    v_accvgpr_read_b32 v240, a216
    v_accvgpr_read_b32 v241, a217
    v_accvgpr_read_b32 v242, a218
    v_accvgpr_read_b32 v243, a219
    v_accvgpr_read_b32 v244, a220
    v_accvgpr_read_b32 v245, a221
    v_accvgpr_read_b32 v246, a222
    v_accvgpr_read_b32 v247, a223
    v_cvt_pk_bf16_f32 v208, v232, v233
    v_cvt_pk_bf16_f32 v209, v234, v235
    v_cvt_pk_bf16_f32 v210, v236, v237
    v_cvt_pk_bf16_f32 v211, v238, v239
    v_cvt_pk_bf16_f32 v212, v240, v241
    v_cvt_pk_bf16_f32 v213, v242, v243
    v_cvt_pk_bf16_f32 v214, v244, v245
    v_cvt_pk_bf16_f32 v215, v246, v247
    v_accvgpr_read_b32 v232, a224
    v_accvgpr_read_b32 v233, a225
    v_accvgpr_read_b32 v234, a226
    v_accvgpr_read_b32 v235, a227
    v_accvgpr_read_b32 v236, a228
    v_accvgpr_read_b32 v237, a229
    v_accvgpr_read_b32 v238, a230
    v_accvgpr_read_b32 v239, a231
    v_accvgpr_read_b32 v240, a232
    v_accvgpr_read_b32 v241, a233
    v_accvgpr_read_b32 v242, a234
    v_accvgpr_read_b32 v243, a235
    v_accvgpr_read_b32 v244, a236
    v_accvgpr_read_b32 v245, a237
    v_accvgpr_read_b32 v246, a238
    v_accvgpr_read_b32 v247, a239
    v_cvt_pk_bf16_f32 v216, v232, v233
    v_cvt_pk_bf16_f32 v217, v234, v235
    v_cvt_pk_bf16_f32 v218, v236, v237
    v_cvt_pk_bf16_f32 v219, v238, v239
    v_cvt_pk_bf16_f32 v220, v240, v241
    v_cvt_pk_bf16_f32 v221, v242, v243
    v_cvt_pk_bf16_f32 v222, v244, v245
    v_cvt_pk_bf16_f32 v223, v246, v247
    v_accvgpr_read_b32 v232, a240
    v_accvgpr_read_b32 v233, a241
    v_accvgpr_read_b32 v234, a242
    v_accvgpr_read_b32 v235, a243
    v_accvgpr_read_b32 v236, a244
    v_accvgpr_read_b32 v237, a245
    v_accvgpr_read_b32 v238, a246
    v_accvgpr_read_b32 v239, a247
    v_accvgpr_read_b32 v240, a248
    v_accvgpr_read_b32 v241, a249
    v_accvgpr_read_b32 v242, a250
    v_accvgpr_read_b32 v243, a251
    v_accvgpr_read_b32 v244, a252
    v_accvgpr_read_b32 v245, a253
    v_accvgpr_read_b32 v246, a254
    v_accvgpr_read_b32 v247, a255
    v_cvt_pk_bf16_f32 v224, v232, v233
    v_cvt_pk_bf16_f32 v225, v234, v235
    v_cvt_pk_bf16_f32 v226, v236, v237
    v_cvt_pk_bf16_f32 v227, v238, v239
    v_cvt_pk_bf16_f32 v228, v240, v241
    v_cvt_pk_bf16_f32 v229, v242, v243
    v_cvt_pk_bf16_f32 v230, v244, v245
    v_cvt_pk_bf16_f32 v231, v246, v247
    s_branch L_packed
L_fin_rows:
    s_lshl_b32 s54, s57, 9
    s_cmp_eq_u32 s55, 2
    s_cbranch_scc0 L_fin_out
    s_movk_i32 s51, 1280
    s_mov_b32 s44, 1051011932
    s_add_u32 s54, s54, 83886080
    s_mov_b32 s62, 1
    s_movk_i32 s61, 72
    s_mov_b32 s93, 20480
    s_mov_b32 s94, -20416
    s_mov_b32 s95, 20288
    s_mov_b32 s96, 4294905920
    s_branch L_fin_rows2
L_fin_out:
    s_movk_i32 s51, 2560
    s_mov_b32 s44, 1.0
    s_mov_b32 s88, s28
    s_mov_b32 s89, s29
    s_mov_b32 s90, s30
    s_mov_b32 s62, 0
    s_mov_b32 s93, 40960
    s_mov_b32 s94, -40896
    s_mov_b32 s95, 40768
    s_mov_b32 s96, 4294844480
L_fin_rows2:
    s_mul_i32 s92, s53, s51
    s_lshl_b32 s92, s92, 5
    s_add_u32 s92, s92, s54
    v_and_b32 v20, 3, v0
    v_bfe_u32 v17, v0, 2, 1
    v_lshl_add_u32 v20, v17, 3, v20
    v_bfe_u32 v17, v0, 3, 1
    v_lshl_add_u32 v20, v17, 2, v20
    v_mul_lo_u32 v20, v20, s51
    v_lshrrev_b32 v17, 5, v0
    v_lshl_add_u32 v20, v17, 4, v20
    v_bfe_u32 v17, v0, 4, 1
    v_lshl_add_u32 v20, v17, 5, v20
    v_mov_b32 v21, v20
    s_cmp_eq_u32 s57, 2
    s_cbranch_scc0 L_fin_rows3
    v_mov_b32 v21, 0x7ff00000
L_fin_rows3:
    v_accvgpr_read_b32 v232, a0
    v_accvgpr_read_b32 v233, a1
    v_accvgpr_read_b32 v234, a2
    v_accvgpr_read_b32 v235, a3
    v_accvgpr_read_b32 v236, a4
    v_accvgpr_read_b32 v237, a5
    v_accvgpr_read_b32 v238, a6
    v_accvgpr_read_b32 v239, a7
    v_accvgpr_read_b32 v240, a8
    v_accvgpr_read_b32 v241, a9
    v_accvgpr_read_b32 v242, a10
    v_accvgpr_read_b32 v243, a11
    v_accvgpr_read_b32 v244, a12
    v_accvgpr_read_b32 v245, a13
    v_accvgpr_read_b32 v246, a14
    v_accvgpr_read_b32 v247, a15
    v_mul_f32 v232, s44, v232
    v_mul_f32 v233, s44, v233
    v_mul_f32 v234, s44, v234
    v_mul_f32 v235, s44, v235
    v_mul_f32 v236, s44, v236
    v_mul_f32 v237, s44, v237
    v_mul_f32 v238, s44, v238
    v_mul_f32 v239, s44, v239
    v_mul_f32 v240, s44, v240
    v_mul_f32 v241, s44, v241
    v_mul_f32 v242, s44, v242
    v_mul_f32 v243, s44, v243
    v_mul_f32 v244, s44, v244
    v_mul_f32 v245, s44, v245
    v_mul_f32 v246, s44, v246
    v_mul_f32 v247, s44, v247
    v_cvt_pk_bf16_f32 v104, v232, v233
    v_cvt_pk_bf16_f32 v105, v234, v235
    v_cvt_pk_bf16_f32 v106, v236, v237
    v_cvt_pk_bf16_f32 v107, v238, v239
    v_cvt_pk_bf16_f32 v108, v240, v241
    v_cvt_pk_bf16_f32 v109, v242, v243
    v_cvt_pk_bf16_f32 v110, v244, v245
    v_cvt_pk_bf16_f32 v111, v246, v247
    v_permlane16_swap_b32 v104, v108
    v_permlane16_swap_b32 v105, v109
    v_permlane16_swap_b32 v106, v110
    v_permlane16_swap_b32 v107, v111
    v_accvgpr_read_b32 v232, a16
    v_accvgpr_read_b32 v233, a17
    v_accvgpr_read_b32 v234, a18
    v_accvgpr_read_b32 v235, a19
    v_accvgpr_read_b32 v236, a20
    v_accvgpr_read_b32 v237, a21
    v_accvgpr_read_b32 v238, a22
    v_accvgpr_read_b32 v239, a23
    v_accvgpr_read_b32 v240, a24
    v_accvgpr_read_b32 v241, a25
    v_accvgpr_read_b32 v242, a26
    v_accvgpr_read_b32 v243, a27
    v_accvgpr_read_b32 v244, a28
    v_accvgpr_read_b32 v245, a29
    v_accvgpr_read_b32 v246, a30
    v_accvgpr_read_b32 v247, a31
    v_mul_f32 v232, s44, v232
    v_mul_f32 v233, s44, v233
    v_mul_f32 v234, s44, v234
    v_mul_f32 v235, s44, v235
    v_mul_f32 v236, s44, v236
    v_mul_f32 v237, s44, v237
    v_mul_f32 v238, s44, v238
    v_mul_f32 v239, s44, v239
    v_mul_f32 v240, s44, v240
    v_mul_f32 v241, s44, v241
    v_mul_f32 v242, s44, v242
    v_mul_f32 v243, s44, v243
    v_mul_f32 v244, s44, v244
    v_mul_f32 v245, s44, v245
    v_mul_f32 v246, s44, v246
    v_mul_f32 v247, s44, v247
    v_cvt_pk_bf16_f32 v112, v232, v233
    v_cvt_pk_bf16_f32 v113, v234, v235
    v_cvt_pk_bf16_f32 v114, v236, v237
    v_cvt_pk_bf16_f32 v115, v238, v239
    v_cvt_pk_bf16_f32 v116, v240, v241
    v_cvt_pk_bf16_f32 v117, v242, v243
    v_cvt_pk_bf16_f32 v118, v244, v245
    v_cvt_pk_bf16_f32 v119, v246, v247
    v_permlane16_swap_b32 v112, v116
    v_permlane16_swap_b32 v113, v117
    v_permlane16_swap_b32 v114, v118
    v_permlane16_swap_b32 v115, v119
    v_accvgpr_read_b32 v232, a32
    v_accvgpr_read_b32 v233, a33
    v_accvgpr_read_b32 v234, a34
    v_accvgpr_read_b32 v235, a35
    v_accvgpr_read_b32 v236, a36
    v_accvgpr_read_b32 v237, a37
    v_accvgpr_read_b32 v238, a38
    v_accvgpr_read_b32 v239, a39
    v_accvgpr_read_b32 v240, a40
    v_accvgpr_read_b32 v241, a41
    v_accvgpr_read_b32 v242, a42
    v_accvgpr_read_b32 v243, a43
    v_accvgpr_read_b32 v244, a44
    v_accvgpr_read_b32 v245, a45
    v_accvgpr_read_b32 v246, a46
    v_accvgpr_read_b32 v247, a47
    v_mul_f32 v232, s44, v232
    v_mul_f32 v233, s44, v233
    v_mul_f32 v234, s44, v234
    v_mul_f32 v235, s44, v235
    v_mul_f32 v236, s44, v236
    v_mul_f32 v237, s44, v237
    v_mul_f32 v238, s44, v238
    v_mul_f32 v239, s44, v239
    v_mul_f32 v240, s44, v240
    v_mul_f32 v241, s44, v241
    v_mul_f32 v242, s44, v242
    v_mul_f32 v243, s44, v243
    v_mul_f32 v244, s44, v244
    v_mul_f32 v245, s44, v245
    v_mul_f32 v246, s44, v246
    v_mul_f32 v247, s44, v247
    v_cvt_pk_bf16_f32 v120, v232, v233
    v_cvt_pk_bf16_f32 v121, v234, v235
    v_cvt_pk_bf16_f32 v122, v236, v237
    v_cvt_pk_bf16_f32 v123, v238, v239
    v_cvt_pk_bf16_f32 v124, v240, v241
    v_cvt_pk_bf16_f32 v125, v242, v243
    v_cvt_pk_bf16_f32 v126, v244, v245
    v_cvt_pk_bf16_f32 v127, v246, v247
    v_permlane16_swap_b32 v120, v124
    v_permlane16_swap_b32 v121, v125
    v_permlane16_swap_b32 v122, v126
    v_permlane16_swap_b32 v123, v127
    v_accvgpr_read_b32 v232, a48
    v_accvgpr_read_b32 v233, a49
    v_accvgpr_read_b32 v234, a50
    v_accvgpr_read_b32 v235, a51
    v_accvgpr_read_b32 v236, a52
    v_accvgpr_read_b32 v237, a53
    v_accvgpr_read_b32 v238, a54
    v_accvgpr_read_b32 v239, a55
    v_accvgpr_read_b32 v240, a56
    v_accvgpr_read_b32 v241, a57
    v_accvgpr_read_b32 v242, a58
    v_accvgpr_read_b32 v243, a59
    v_accvgpr_read_b32 v244, a60
    v_accvgpr_read_b32 v245, a61
    v_accvgpr_read_b32 v246, a62
    v_accvgpr_read_b32 v247, a63
    v_mul_f32 v232, s44, v232
    v_mul_f32 v233, s44, v233
    v_mul_f32 v234, s44, v234
    v_mul_f32 v235, s44, v235
    v_mul_f32 v236, s44, v236
    v_mul_f32 v237, s44, v237
    v_mul_f32 v238, s44, v238
    v_mul_f32 v239, s44, v239
    v_mul_f32 v240, s44, v240
    v_mul_f32 v241, s44, v241
    v_mul_f32 v242, s44, v242
    v_mul_f32 v243, s44, v243
    v_mul_f32 v244, s44, v244
    v_mul_f32 v245, s44, v245
    v_mul_f32 v246, s44, v246
    v_mul_f32 v247, s44, v247
    v_cvt_pk_bf16_f32 v128, v232, v233
    v_cvt_pk_bf16_f32 v129, v234, v235
    v_cvt_pk_bf16_f32 v130, v236, v237
    v_cvt_pk_bf16_f32 v131, v238, v239
    v_cvt_pk_bf16_f32 v132, v240, v241
    v_cvt_pk_bf16_f32 v133, v242, v243
    v_cvt_pk_bf16_f32 v134, v244, v245
    v_cvt_pk_bf16_f32 v135, v246, v247
    v_permlane16_swap_b32 v128, v132
    v_permlane16_swap_b32 v129, v133
    v_permlane16_swap_b32 v130, v134
    v_permlane16_swap_b32 v131, v135
    v_accvgpr_read_b32 v232, a64
    v_accvgpr_read_b32 v233, a65
    v_accvgpr_read_b32 v234, a66
    v_accvgpr_read_b32 v235, a67
    v_accvgpr_read_b32 v236, a68
    v_accvgpr_read_b32 v237, a69
    v_accvgpr_read_b32 v238, a70
    v_accvgpr_read_b32 v239, a71
    v_accvgpr_read_b32 v240, a72
    v_accvgpr_read_b32 v241, a73
    v_accvgpr_read_b32 v242, a74
    v_accvgpr_read_b32 v243, a75
    v_accvgpr_read_b32 v244, a76
    v_accvgpr_read_b32 v245, a77
    v_accvgpr_read_b32 v246, a78
    v_accvgpr_read_b32 v247, a79
    v_mul_f32 v232, s44, v232
    v_mul_f32 v233, s44, v233
    v_mul_f32 v234, s44, v234
    v_mul_f32 v235, s44, v235
    v_mul_f32 v236, s44, v236
    v_mul_f32 v237, s44, v237
    v_mul_f32 v238, s44, v238
    v_mul_f32 v239, s44, v239
    v_mul_f32 v240, s44, v240
    v_mul_f32 v241, s44, v241
    v_mul_f32 v242, s44, v242
    v_mul_f32 v243, s44, v243
    v_mul_f32 v244, s44, v244
    v_mul_f32 v245, s44, v245
    v_mul_f32 v246, s44, v246
    v_mul_f32 v247, s44, v247
    v_cvt_pk_bf16_f32 v136, v232, v233
    v_cvt_pk_bf16_f32 v137, v234, v235
    v_cvt_pk_bf16_f32 v138, v236, v237
    v_cvt_pk_bf16_f32 v139, v238, v239
    v_cvt_pk_bf16_f32 v140, v240, v241
    v_cvt_pk_bf16_f32 v141, v242, v243
    v_cvt_pk_bf16_f32 v142, v244, v245
    v_cvt_pk_bf16_f32 v143, v246, v247
    v_permlane16_swap_b32 v136, v140
    v_permlane16_swap_b32 v137, v141
    v_permlane16_swap_b32 v138, v142
    v_permlane16_swap_b32 v139, v143
    v_accvgpr_read_b32 v232, a80
    v_accvgpr_read_b32 v233, a81
    v_accvgpr_read_b32 v234, a82
    v_accvgpr_read_b32 v235, a83
    v_accvgpr_read_b32 v236, a84
    v_accvgpr_read_b32 v237, a85
    v_accvgpr_read_b32 v238, a86
    v_accvgpr_read_b32 v239, a87
    v_accvgpr_read_b32 v240, a88
    v_accvgpr_read_b32 v241, a89
    v_accvgpr_read_b32 v242, a90
    v_accvgpr_read_b32 v243, a91
    v_accvgpr_read_b32 v244, a92
    v_accvgpr_read_b32 v245, a93
    v_accvgpr_read_b32 v246, a94
    v_accvgpr_read_b32 v247, a95
    v_mul_f32 v232, s44, v232
    v_mul_f32 v233, s44, v233
    v_mul_f32 v234, s44, v234
    v_mul_f32 v235, s44, v235
    v_mul_f32 v236, s44, v236
    v_mul_f32 v237, s44, v237
    v_mul_f32 v238, s44, v238
    v_mul_f32 v239, s44, v239
    v_mul_f32 v240, s44, v240
    v_mul_f32 v241, s44, v241
    v_mul_f32 v242, s44, v242
    v_mul_f32 v243, s44, v243
    v_mul_f32 v244, s44, v244
    v_mul_f32 v245, s44, v245
    v_mul_f32 v246, s44, v246
    v_mul_f32 v247, s44, v247
    v_cvt_pk_bf16_f32 v144, v232, v233
    v_cvt_pk_bf16_f32 v145, v234, v235
    v_cvt_pk_bf16_f32 v146, v236, v237
    v_cvt_pk_bf16_f32 v147, v238, v239
    v_cvt_pk_bf16_f32 v148, v240, v241
    v_cvt_pk_bf16_f32 v149, v242, v243
    v_cvt_pk_bf16_f32 v150, v244, v245
    v_cvt_pk_bf16_f32 v151, v246, v247
    v_permlane16_swap_b32 v144, v148
    v_permlane16_swap_b32 v145, v149
    v_permlane16_swap_b32 v146, v150
    v_permlane16_swap_b32 v147, v151
    v_accvgpr_read_b32 v232, a96
    v_accvgpr_read_b32 v233, a97
    v_accvgpr_read_b32 v234, a98
    v_accvgpr_read_b32 v235, a99
    v_accvgpr_read_b32 v236, a100
    v_accvgpr_read_b32 v237, a101
    v_accvgpr_read_b32 v238, a102
    v_accvgpr_read_b32 v239, a103
    v_accvgpr_read_b32 v240, a104
    v_accvgpr_read_b32 v241, a105
    v_accvgpr_read_b32 v242, a106
    v_accvgpr_read_b32 v243, a107
    v_accvgpr_read_b32 v244, a108
    v_accvgpr_read_b32 v245, a109
    v_accvgpr_read_b32 v246, a110
    v_accvgpr_read_b32 v247, a111
    v_mul_f32 v232, s44, v232
    v_mul_f32 v233, s44, v233
    v_mul_f32 v234, s44, v234
    v_mul_f32 v235, s44, v235
    v_mul_f32 v236, s44, v236
    v_mul_f32 v237, s44, v237
    v_mul_f32 v238, s44, v238
    v_mul_f32 v239, s44, v239
    v_mul_f32 v240, s44, v240
    v_mul_f32 v241, s44, v241
    v_mul_f32 v242, s44, v242
    v_mul_f32 v243, s44, v243
    v_mul_f32 v244, s44, v244
    v_mul_f32 v245, s44, v245
    v_mul_f32 v246, s44, v246
    v_mul_f32 v247, s44, v247
    v_cvt_pk_bf16_f32 v152, v232, v233
    v_cvt_pk_bf16_f32 v153, v234, v235
    v_cvt_pk_bf16_f32 v154, v236, v237
    v_cvt_pk_bf16_f32 v155, v238, v239
    v_cvt_pk_bf16_f32 v156, v240, v241
    v_cvt_pk_bf16_f32 v157, v242, v243
    v_cvt_pk_bf16_f32 v158, v244, v245
    v_cvt_pk_bf16_f32 v159, v246, v247
    v_permlane16_swap_b32 v152, v156
    v_permlane16_swap_b32 v153, v157
    v_permlane16_swap_b32 v154, v158
    v_permlane16_swap_b32 v155, v159
    v_accvgpr_read_b32 v232, a112
    v_accvgpr_read_b32 v233, a113
    v_accvgpr_read_b32 v234, a114
    v_accvgpr_read_b32 v235, a115
    v_accvgpr_read_b32 v236, a116
    v_accvgpr_read_b32 v237, a117
    v_accvgpr_read_b32 v238, a118
    v_accvgpr_read_b32 v239, a119
    v_accvgpr_read_b32 v240, a120
    v_accvgpr_read_b32 v241, a121
    v_accvgpr_read_b32 v242, a122
    v_accvgpr_read_b32 v243, a123
    v_accvgpr_read_b32 v244, a124
    v_accvgpr_read_b32 v245, a125
    v_accvgpr_read_b32 v246, a126
    v_accvgpr_read_b32 v247, a127
    v_mul_f32 v232, s44, v232
    v_mul_f32 v233, s44, v233
    v_mul_f32 v234, s44, v234
    v_mul_f32 v235, s44, v235
    v_mul_f32 v236, s44, v236
    v_mul_f32 v237, s44, v237
    v_mul_f32 v238, s44, v238
    v_mul_f32 v239, s44, v239
    v_mul_f32 v240, s44, v240
    v_mul_f32 v241, s44, v241
    v_mul_f32 v242, s44, v242
    v_mul_f32 v243, s44, v243
    v_mul_f32 v244, s44, v244
    v_mul_f32 v245, s44, v245
    v_mul_f32 v246, s44, v246
    v_mul_f32 v247, s44, v247
    v_cvt_pk_bf16_f32 v160, v232, v233
    v_cvt_pk_bf16_f32 v161, v234, v235
    v_cvt_pk_bf16_f32 v162, v236, v237
    v_cvt_pk_bf16_f32 v163, v238, v239
    v_cvt_pk_bf16_f32 v164, v240, v241
    v_cvt_pk_bf16_f32 v165, v242, v243
    v_cvt_pk_bf16_f32 v166, v244, v245
    v_cvt_pk_bf16_f32 v167, v246, v247
    v_permlane16_swap_b32 v160, v164
    v_permlane16_swap_b32 v161, v165
    v_permlane16_swap_b32 v162, v166
    v_permlane16_swap_b32 v163, v167
    v_accvgpr_read_b32 v232, a128
    v_accvgpr_read_b32 v233, a129
    v_accvgpr_read_b32 v234, a130
    v_accvgpr_read_b32 v235, a131
    v_accvgpr_read_b32 v236, a132
    v_accvgpr_read_b32 v237, a133
    v_accvgpr_read_b32 v238, a134
    v_accvgpr_read_b32 v239, a135
    v_accvgpr_read_b32 v240, a136
    v_accvgpr_read_b32 v241, a137
    v_accvgpr_read_b32 v242, a138
    v_accvgpr_read_b32 v243, a139
    v_accvgpr_read_b32 v244, a140
    v_accvgpr_read_b32 v245, a141
    v_accvgpr_read_b32 v246, a142
    v_accvgpr_read_b32 v247, a143
    v_mul_f32 v232, s44, v232
    v_mul_f32 v233, s44, v233
    v_mul_f32 v234, s44, v234
    v_mul_f32 v235, s44, v235
    v_mul_f32 v236, s44, v236
    v_mul_f32 v237, s44, v237
    v_mul_f32 v238, s44, v238
    v_mul_f32 v239, s44, v239
    v_mul_f32 v240, s44, v240
    v_mul_f32 v241, s44, v241
    v_mul_f32 v242, s44, v242
    v_mul_f32 v243, s44, v243
    v_mul_f32 v244, s44, v244
    v_mul_f32 v245, s44, v245
    v_mul_f32 v246, s44, v246
    v_mul_f32 v247, s44, v247
    v_cvt_pk_bf16_f32 v168, v232, v233
    v_cvt_pk_bf16_f32 v169, v234, v235
    v_cvt_pk_bf16_f32 v170, v236, v237
    v_cvt_pk_bf16_f32 v171, v238, v239
    v_cvt_pk_bf16_f32 v172, v240, v241
    v_cvt_pk_bf16_f32 v173, v242, v243
    v_cvt_pk_bf16_f32 v174, v244, v245
    v_cvt_pk_bf16_f32 v175, v246, v247
    v_permlane16_swap_b32 v168, v172
    v_permlane16_swap_b32 v169, v173
    v_permlane16_swap_b32 v170, v174
    v_permlane16_swap_b32 v171, v175
    v_accvgpr_read_b32 v232, a144
    v_accvgpr_read_b32 v233, a145
    v_accvgpr_read_b32 v234, a146
    v_accvgpr_read_b32 v235, a147
    v_accvgpr_read_b32 v236, a148
    v_accvgpr_read_b32 v237, a149
    v_accvgpr_read_b32 v238, a150
    v_accvgpr_read_b32 v239, a151
    v_accvgpr_read_b32 v240, a152
    v_accvgpr_read_b32 v241, a153
    v_accvgpr_read_b32 v242, a154
    v_accvgpr_read_b32 v243, a155
    v_accvgpr_read_b32 v244, a156
    v_accvgpr_read_b32 v245, a157
    v_accvgpr_read_b32 v246, a158
    v_accvgpr_read_b32 v247, a159
    v_mul_f32 v232, s44, v232
    v_mul_f32 v233, s44, v233
    v_mul_f32 v234, s44, v234
    v_mul_f32 v235, s44, v235
    v_mul_f32 v236, s44, v236
    v_mul_f32 v237, s44, v237
    v_mul_f32 v238, s44, v238
    v_mul_f32 v239, s44, v239
    v_mul_f32 v240, s44, v240
    v_mul_f32 v241, s44, v241
    v_mul_f32 v242, s44, v242
    v_mul_f32 v243, s44, v243
    v_mul_f32 v244, s44, v244
    v_mul_f32 v245, s44, v245
    v_mul_f32 v246, s44, v246
    v_mul_f32 v247, s44, v247
    v_cvt_pk_bf16_f32 v176, v232, v233
    v_cvt_pk_bf16_f32 v177, v234, v235
    v_cvt_pk_bf16_f32 v178, v236, v237
    v_cvt_pk_bf16_f32 v179, v238, v239
    v_cvt_pk_bf16_f32 v180, v240, v241
    v_cvt_pk_bf16_f32 v181, v242, v243
    v_cvt_pk_bf16_f32 v182, v244, v245
    v_cvt_pk_bf16_f32 v183, v246, v247
    v_permlane16_swap_b32 v176, v180
    v_permlane16_swap_b32 v177, v181
    v_permlane16_swap_b32 v178, v182
    v_permlane16_swap_b32 v179, v183
    v_accvgpr_read_b32 v232, a160
    v_accvgpr_read_b32 v233, a161
    v_accvgpr_read_b32 v234, a162
    v_accvgpr_read_b32 v235, a163
    v_accvgpr_read_b32 v236, a164
    v_accvgpr_read_b32 v237, a165
    v_accvgpr_read_b32 v238, a166
    v_accvgpr_read_b32 v239, a167
    v_accvgpr_read_b32 v240, a168
    v_accvgpr_read_b32 v241, a169
    v_accvgpr_read_b32 v242, a170
    v_accvgpr_read_b32 v243, a171
    v_accvgpr_read_b32 v244, a172
    v_accvgpr_read_b32 v245, a173
    v_accvgpr_read_b32 v246, a174
    v_accvgpr_read_b32 v247, a175
    v_mul_f32 v232, s44, v232
    v_mul_f32 v233, s44, v233
    v_mul_f32 v234, s44, v234
    v_mul_f32 v235, s44, v235
    v_mul_f32 v236, s44, v236
    v_mul_f32 v237, s44, v237
    v_mul_f32 v238, s44, v238
    v_mul_f32 v239, s44, v239
    v_mul_f32 v240, s44, v240
    v_mul_f32 v241, s44, v241
    v_mul_f32 v242, s44, v242
    v_mul_f32 v243, s44, v243
    v_mul_f32 v244, s44, v244
    v_mul_f32 v245, s44, v245
    v_mul_f32 v246, s44, v246
    v_mul_f32 v247, s44, v247
    v_cvt_pk_bf16_f32 v184, v232, v233
    v_cvt_pk_bf16_f32 v185, v234, v235
    v_cvt_pk_bf16_f32 v186, v236, v237
    v_cvt_pk_bf16_f32 v187, v238, v239
    v_cvt_pk_bf16_f32 v188, v240, v241
    v_cvt_pk_bf16_f32 v189, v242, v243
    v_cvt_pk_bf16_f32 v190, v244, v245
    v_cvt_pk_bf16_f32 v191, v246, v247
    v_permlane16_swap_b32 v184, v188
    v_permlane16_swap_b32 v185, v189
    v_permlane16_swap_b32 v186, v190
    v_permlane16_swap_b32 v187, v191
    v_accvgpr_read_b32 v232, a176
    v_accvgpr_read_b32 v233, a177
    v_accvgpr_read_b32 v234, a178
    v_accvgpr_read_b32 v235, a179
    v_accvgpr_read_b32 v236, a180
    v_accvgpr_read_b32 v237, a181
    v_accvgpr_read_b32 v238, a182
    v_accvgpr_read_b32 v239, a183
    v_accvgpr_read_b32 v240, a184
    v_accvgpr_read_b32 v241, a185
    v_accvgpr_read_b32 v242, a186
    v_accvgpr_read_b32 v243, a187
    v_accvgpr_read_b32 v244, a188
    v_accvgpr_read_b32 v245, a189
    v_accvgpr_read_b32 v246, a190
    v_accvgpr_read_b32 v247, a191
    v_mul_f32 v232, s44, v232
    v_mul_f32 v233, s44, v233
    v_mul_f32 v234, s44, v234
    v_mul_f32 v235, s44, v235
    v_mul_f32 v236, s44, v236
    v_mul_f32 v237, s44, v237
    v_mul_f32 v238, s44, v238
    v_mul_f32 v239, s44, v239
    v_mul_f32 v240, s44, v240
    v_mul_f32 v241, s44, v241
    v_mul_f32 v242, s44, v242
    v_mul_f32 v243, s44, v243
    v_mul_f32 v244, s44, v244
    v_mul_f32 v245, s44, v245
    v_mul_f32 v246, s44, v246
    v_mul_f32 v247, s44, v247
    v_cvt_pk_bf16_f32 v192, v232, v233
    v_cvt_pk_bf16_f32 v193, v234, v235
    v_cvt_pk_bf16_f32 v194, v236, v237
    v_cvt_pk_bf16_f32 v195, v238, v239
    v_cvt_pk_bf16_f32 v196, v240, v241
    v_cvt_pk_bf16_f32 v197, v242, v243
    v_cvt_pk_bf16_f32 v198, v244, v245
    v_cvt_pk_bf16_f32 v199, v246, v247
    v_permlane16_swap_b32 v192, v196
    v_permlane16_swap_b32 v193, v197
    v_permlane16_swap_b32 v194, v198
    v_permlane16_swap_b32 v195, v199
    v_accvgpr_read_b32 v232, a192
    v_accvgpr_read_b32 v233, a193
    v_accvgpr_read_b32 v234, a194
    v_accvgpr_read_b32 v235, a195
    v_accvgpr_read_b32 v236, a196
    v_accvgpr_read_b32 v237, a197
    v_accvgpr_read_b32 v238, a198
    v_accvgpr_read_b32 v239, a199
    v_accvgpr_read_b32 v240, a200
    v_accvgpr_read_b32 v241, a201
    v_accvgpr_read_b32 v242, a202
    v_accvgpr_read_b32 v243, a203
    v_accvgpr_read_b32 v244, a204
    v_accvgpr_read_b32 v245, a205
    v_accvgpr_read_b32 v246, a206
    v_accvgpr_read_b32 v247, a207
    v_mul_f32 v232, s44, v232
    v_mul_f32 v233, s44, v233
    v_mul_f32 v234, s44, v234
    v_mul_f32 v235, s44, v235
    v_mul_f32 v236, s44, v236
    v_mul_f32 v237, s44, v237
    v_mul_f32 v238, s44, v238
    v_mul_f32 v239, s44, v239
    v_mul_f32 v240, s44, v240
    v_mul_f32 v241, s44, v241
    v_mul_f32 v242, s44, v242
    v_mul_f32 v243, s44, v243
    v_mul_f32 v244, s44, v244
    v_mul_f32 v245, s44, v245
    v_mul_f32 v246, s44, v246
    v_mul_f32 v247, s44, v247
    v_cvt_pk_bf16_f32 v200, v232, v233
    v_cvt_pk_bf16_f32 v201, v234, v235
    v_cvt_pk_bf16_f32 v202, v236, v237
    v_cvt_pk_bf16_f32 v203, v238, v239
    v_cvt_pk_bf16_f32 v204, v240, v241
    v_cvt_pk_bf16_f32 v205, v242, v243
    v_cvt_pk_bf16_f32 v206, v244, v245
    v_cvt_pk_bf16_f32 v207, v246, v247
    v_permlane16_swap_b32 v200, v204
    v_permlane16_swap_b32 v201, v205
    v_permlane16_swap_b32 v202, v206
    v_permlane16_swap_b32 v203, v207
    v_accvgpr_read_b32 v232, a208
    v_accvgpr_read_b32 v233, a209
    v_accvgpr_read_b32 v234, a210
    v_accvgpr_read_b32 v235, a211
    v_accvgpr_read_b32 v236, a212
    v_accvgpr_read_b32 v237, a213
    v_accvgpr_read_b32 v238, a214
    v_accvgpr_read_b32 v239, a215
    v_accvgpr_read_b32 v240, a216
    v_accvgpr_read_b32 v241, a217
    v_accvgpr_read_b32 v242, a218
    v_accvgpr_read_b32 v243, a219
    v_accvgpr_read_b32 v244, a220
    v_accvgpr_read_b32 v245, a221
    v_accvgpr_read_b32 v246, a222
    v_accvgpr_read_b32 v247, a223
    v_mul_f32 v232, s44, v232
    v_mul_f32 v233, s44, v233
    v_mul_f32 v234, s44, v234
    v_mul_f32 v235, s44, v235
    v_mul_f32 v236, s44, v236
    v_mul_f32 v237, s44, v237
    v_mul_f32 v238, s44, v238
    v_mul_f32 v239, s44, v239
    v_mul_f32 v240, s44, v240
    v_mul_f32 v241, s44, v241
    v_mul_f32 v242, s44, v242
    v_mul_f32 v243, s44, v243
    v_mul_f32 v244, s44, v244
    v_mul_f32 v245, s44, v245
    v_mul_f32 v246, s44, v246
    v_mul_f32 v247, s44, v247
    v_cvt_pk_bf16_f32 v208, v232, v233
    v_cvt_pk_bf16_f32 v209, v234, v235
    v_cvt_pk_bf16_f32 v210, v236, v237
    v_cvt_pk_bf16_f32 v211, v238, v239
    v_cvt_pk_bf16_f32 v212, v240, v241
    v_cvt_pk_bf16_f32 v213, v242, v243
    v_cvt_pk_bf16_f32 v214, v244, v245
    v_cvt_pk_bf16_f32 v215, v246, v247
    v_permlane16_swap_b32 v208, v212
    v_permlane16_swap_b32 v209, v213
    v_permlane16_swap_b32 v210, v214
    v_permlane16_swap_b32 v211, v215
    v_accvgpr_read_b32 v232, a224
    v_accvgpr_read_b32 v233, a225
    v_accvgpr_read_b32 v234, a226
    v_accvgpr_read_b32 v235, a227
    v_accvgpr_read_b32 v236, a228
    v_accvgpr_read_b32 v237, a229
    v_accvgpr_read_b32 v238, a230
    v_accvgpr_read_b32 v239, a231
    v_accvgpr_read_b32 v240, a232
    v_accvgpr_read_b32 v241, a233
    v_accvgpr_read_b32 v242, a234
    v_accvgpr_read_b32 v243, a235
    v_accvgpr_read_b32 v244, a236
    v_accvgpr_read_b32 v245, a237
    v_accvgpr_read_b32 v246, a238
    v_accvgpr_read_b32 v247, a239
    v_mul_f32 v232, s44, v232
    v_mul_f32 v233, s44, v233
    v_mul_f32 v234, s44, v234
    v_mul_f32 v235, s44, v235
    v_mul_f32 v236, s44, v236
    v_mul_f32 v237, s44, v237
    v_mul_f32 v238, s44, v238
    v_mul_f32 v239, s44, v239
    v_mul_f32 v240, s44, v240
    v_mul_f32 v241, s44, v241
    v_mul_f32 v242, s44, v242
    v_mul_f32 v243, s44, v243
    v_mul_f32 v244, s44, v244
    v_mul_f32 v245, s44, v245
    v_mul_f32 v246, s44, v246
    v_mul_f32 v247, s44, v247
    v_cvt_pk_bf16_f32 v216, v232, v233
    v_cvt_pk_bf16_f32 v217, v234, v235
    v_cvt_pk_bf16_f32 v218, v236, v237
    v_cvt_pk_bf16_f32 v219, v238, v239
    v_cvt_pk_bf16_f32 v220, v240, v241
    v_cvt_pk_bf16_f32 v221, v242, v243
    v_cvt_pk_bf16_f32 v222, v244, v245
    v_cvt_pk_bf16_f32 v223, v246, v247
    v_permlane16_swap_b32 v216, v220
    v_permlane16_swap_b32 v217, v221
    v_permlane16_swap_b32 v218, v222
    v_permlane16_swap_b32 v219, v223
    v_accvgpr_read_b32 v232, a240
    v_accvgpr_read_b32 v233, a241
    v_accvgpr_read_b32 v234, a242
    v_accvgpr_read_b32 v235, a243
    v_accvgpr_read_b32 v236, a244
    v_accvgpr_read_b32 v237, a245
    v_accvgpr_read_b32 v238, a246
    v_accvgpr_read_b32 v239, a247
    v_accvgpr_read_b32 v240, a248
    v_accvgpr_read_b32 v241, a249
    v_accvgpr_read_b32 v242, a250
    v_accvgpr_read_b32 v243, a251
    v_accvgpr_read_b32 v244, a252
    v_accvgpr_read_b32 v245, a253
    v_accvgpr_read_b32 v246, a254
    v_accvgpr_read_b32 v247, a255
    v_mul_f32 v232, s44, v232
    v_mul_f32 v233, s44, v233
    v_mul_f32 v234, s44, v234
    v_mul_f32 v235, s44, v235
    v_mul_f32 v236, s44, v236
    v_mul_f32 v237, s44, v237
    v_mul_f32 v238, s44, v238
    v_mul_f32 v239, s44, v239
    v_mul_f32 v240, s44, v240
    v_mul_f32 v241, s44, v241
    v_mul_f32 v242, s44, v242
    v_mul_f32 v243, s44, v243
    v_mul_f32 v244, s44, v244
    v_mul_f32 v245, s44, v245
    v_mul_f32 v246, s44, v246
    v_mul_f32 v247, s44, v247
    v_cvt_pk_bf16_f32 v224, v232, v233
    v_cvt_pk_bf16_f32 v225, v234, v235
    v_cvt_pk_bf16_f32 v226, v236, v237
    v_cvt_pk_bf16_f32 v227, v238, v239
    v_cvt_pk_bf16_f32 v228, v240, v241
    v_cvt_pk_bf16_f32 v229, v242, v243
    v_cvt_pk_bf16_f32 v230, v244, v245
    v_cvt_pk_bf16_f32 v231, v246, v247
    v_permlane16_swap_b32 v224, v228
    v_permlane16_swap_b32 v225, v229
    v_permlane16_swap_b32 v226, v230
    v_permlane16_swap_b32 v227, v231
L_packed:
    s_cmp_eq_u32 s49, 8
    s_cbranch_scc1 L_flush
    s_cmp_eq_u32 s55, 2
    s_cbranch_scc0 L_go
L_flush:
    buffer_store_dwordx4 v[104:107], v20, s[88:91], s92 offen sc1
    s_add_u32 s92, s92, s93
    buffer_store_dwordx4 v[108:111], v20, s[88:91], s92 offen sc1
    s_add_u32 s92, s92, s94
    buffer_store_dwordx4 v[112:115], v20, s[88:91], s92 offen sc1
    s_add_u32 s92, s92, s93
    buffer_store_dwordx4 v[116:119], v20, s[88:91], s92 offen sc1
    s_add_u32 s92, s92, s94
    buffer_store_dwordx4 v[120:123], v20, s[88:91], s92 offen sc1
    s_add_u32 s92, s92, s93
    buffer_store_dwordx4 v[124:127], v20, s[88:91], s92 offen sc1
    s_add_u32 s92, s92, s94
    buffer_store_dwordx4 v[128:131], v20, s[88:91], s92 offen sc1
    s_add_u32 s92, s92, s93
    buffer_store_dwordx4 v[132:135], v20, s[88:91], s92 offen sc1
    s_add_u32 s92, s92, s95
    buffer_store_dwordx4 v[136:139], v20, s[88:91], s92 offen sc1
    s_add_u32 s92, s92, s93
    buffer_store_dwordx4 v[140:143], v20, s[88:91], s92 offen sc1
    s_add_u32 s92, s92, s94
    buffer_store_dwordx4 v[144:147], v20, s[88:91], s92 offen sc1
    s_add_u32 s92, s92, s93
    buffer_store_dwordx4 v[148:151], v20, s[88:91], s92 offen sc1
    s_add_u32 s92, s92, s94
    buffer_store_dwordx4 v[152:155], v20, s[88:91], s92 offen sc1
    s_add_u32 s92, s92, s93
    buffer_store_dwordx4 v[156:159], v20, s[88:91], s92 offen sc1
    s_add_u32 s92, s92, s94
    buffer_store_dwordx4 v[160:163], v20, s[88:91], s92 offen sc1
    s_add_u32 s92, s92, s93
    buffer_store_dwordx4 v[164:167], v20, s[88:91], s92 offen sc1
    s_add_u32 s92, s92, s96
    buffer_store_dwordx4 v[168:171], v21, s[88:91], s92 offen sc1
    s_add_u32 s92, s92, s93
    buffer_store_dwordx4 v[172:175], v21, s[88:91], s92 offen sc1
    s_add_u32 s92, s92, s94
    buffer_store_dwordx4 v[176:179], v21, s[88:91], s92 offen sc1
    s_add_u32 s92, s92, s93
    buffer_store_dwordx4 v[180:183], v21, s[88:91], s92 offen sc1
    s_add_u32 s92, s92, s94
    buffer_store_dwordx4 v[184:187], v21, s[88:91], s92 offen sc1
    s_add_u32 s92, s92, s93
    buffer_store_dwordx4 v[188:191], v21, s[88:91], s92 offen sc1
    s_add_u32 s92, s92, s94
    buffer_store_dwordx4 v[192:195], v21, s[88:91], s92 offen sc1
    s_add_u32 s92, s92, s93
    buffer_store_dwordx4 v[196:199], v21, s[88:91], s92 offen sc1
    s_add_u32 s92, s92, s95
    buffer_store_dwordx4 v[200:203], v21, s[88:91], s92 offen sc1
    s_add_u32 s92, s92, s93
    buffer_store_dwordx4 v[204:207], v21, s[88:91], s92 offen sc1
    s_add_u32 s92, s92, s94
    buffer_store_dwordx4 v[208:211], v21, s[88:91], s92 offen sc1
    s_add_u32 s92, s92, s93
    buffer_store_dwordx4 v[212:215], v21, s[88:91], s92 offen sc1
    s_add_u32 s92, s92, s94
    buffer_store_dwordx4 v[216:219], v21, s[88:91], s92 offen sc1
    s_add_u32 s92, s92, s93
    buffer_store_dwordx4 v[220:223], v21, s[88:91], s92 offen sc1
    s_add_u32 s92, s92, s94
    buffer_store_dwordx4 v[224:227], v21, s[88:91], s92 offen sc1
    s_add_u32 s92, s92, s93
    buffer_store_dwordx4 v[228:231], v21, s[88:91], s92 offen sc1
    s_add_u32 s92, s92, s96
    s_waitcnt vmcnt(0)
    s_barrier
    s_cmp_lg_u32 s17, 0
    s_cbranch_scc1 L_ps_fl
    v_mov_b32 v22, s62
    s_mov_b64 exec, 1
    buffer_atomic_add v22, off, s[8:11], s61
    s_mov_b64 exec, -1
L_ps_fl:
    s_mov_b32 s90, 0
    s_mov_b32 s62, 0
    s_branch L_go
L_fin_akv:
    s_lshl_b32 s43, s53, 12
    s_add_u32 s43, s43, 92274688
    v_lshlrev_b32 v18, 4, v0
    v_and_b32 v17, 31, v0
    v_cmp_eq_u32 vcc, 20, v17
    v_mov_b32 v17, 0x3f803f80
    v_accvgpr_read_b32 v136, a0
    v_accvgpr_read_b32 v137, a1
    v_accvgpr_read_b32 v138, a2
    v_accvgpr_read_b32 v139, a3
    v_accvgpr_read_b32 v140, a4
    v_accvgpr_read_b32 v141, a5
    v_accvgpr_read_b32 v142, a6
    v_accvgpr_read_b32 v143, a7
    v_accvgpr_read_b32 v144, a8
    v_accvgpr_read_b32 v145, a9
    v_accvgpr_read_b32 v146, a10
    v_accvgpr_read_b32 v147, a11
    v_accvgpr_read_b32 v148, a12
    v_accvgpr_read_b32 v149, a13
    v_accvgpr_read_b32 v150, a14
    v_accvgpr_read_b32 v151, a15
    v_cvt_pk_bf16_f32 v104, v136, v137
    v_cvt_pk_bf16_f32 v105, v138, v139
    v_cvt_pk_bf16_f32 v106, v140, v141
    v_cvt_pk_bf16_f32 v107, v142, v143
    v_cvt_pk_bf16_f32 v108, v144, v145
    v_cvt_pk_bf16_f32 v109, v146, v147
    v_cvt_pk_bf16_f32 v110, v148, v149
    v_cvt_pk_bf16_f32 v111, v150, v151
    s_add_u32 s39, s43, 0
    buffer_store_dwordx4 v[104:107], v18, s[4:7], s39 offen offset:0 sc1
    buffer_store_dwordx4 v[108:111], v18, s[4:7], s39 offen offset:1024 sc1
    v_accvgpr_read_b32 v136, a64
    v_accvgpr_read_b32 v137, a65
    v_accvgpr_read_b32 v138, a66
    v_accvgpr_read_b32 v139, a67
    v_accvgpr_read_b32 v140, a68
    v_accvgpr_read_b32 v141, a69
    v_accvgpr_read_b32 v142, a70
    v_accvgpr_read_b32 v143, a71
    v_accvgpr_read_b32 v144, a72
    v_accvgpr_read_b32 v145, a73
    v_accvgpr_read_b32 v146, a74
    v_accvgpr_read_b32 v147, a75
    v_accvgpr_read_b32 v148, a76
    v_accvgpr_read_b32 v149, a77
    v_accvgpr_read_b32 v150, a78
    v_accvgpr_read_b32 v151, a79
    v_cvt_pk_bf16_f32 v112, v136, v137
    v_cvt_pk_bf16_f32 v113, v138, v139
    v_cvt_pk_bf16_f32 v114, v140, v141
    v_cvt_pk_bf16_f32 v115, v142, v143
    v_cvt_pk_bf16_f32 v116, v144, v145
    v_cvt_pk_bf16_f32 v117, v146, v147
    v_cvt_pk_bf16_f32 v118, v148, v149
    v_cvt_pk_bf16_f32 v119, v150, v151
    s_add_u32 s39, s43, 4096
    buffer_store_dwordx4 v[112:115], v18, s[4:7], s39 offen offset:0 sc1
    buffer_store_dwordx4 v[116:119], v18, s[4:7], s39 offen offset:1024 sc1
    v_accvgpr_read_b32 v136, a128
    v_accvgpr_read_b32 v137, a129
    v_accvgpr_read_b32 v138, a130
    v_accvgpr_read_b32 v139, a131
    v_accvgpr_read_b32 v140, a132
    v_accvgpr_read_b32 v141, a133
    v_accvgpr_read_b32 v142, a134
    v_accvgpr_read_b32 v143, a135
    v_accvgpr_read_b32 v144, a136
    v_accvgpr_read_b32 v145, a137
    v_accvgpr_read_b32 v146, a138
    v_accvgpr_read_b32 v147, a139
    v_accvgpr_read_b32 v148, a140
    v_accvgpr_read_b32 v149, a141
    v_accvgpr_read_b32 v150, a142
    v_accvgpr_read_b32 v151, a143
    v_cvt_pk_bf16_f32 v120, v136, v137
    v_cvt_pk_bf16_f32 v121, v138, v139
    v_cvt_pk_bf16_f32 v122, v140, v141
    v_cvt_pk_bf16_f32 v123, v142, v143
    v_cvt_pk_bf16_f32 v124, v144, v145
    v_cvt_pk_bf16_f32 v125, v146, v147
    v_cvt_pk_bf16_f32 v126, v148, v149
    v_cvt_pk_bf16_f32 v127, v150, v151
    v_cndmask_b32 v120, v120, v17, vcc
    v_cndmask_b32 v121, v121, v17, vcc
    v_cndmask_b32 v122, v122, v17, vcc
    v_cndmask_b32 v123, v123, v17, vcc
    v_cndmask_b32 v124, v124, v17, vcc
    v_cndmask_b32 v125, v125, v17, vcc
    v_cndmask_b32 v126, v126, v17, vcc
    v_cndmask_b32 v127, v127, v17, vcc
    s_add_u32 s39, s43, 0
    buffer_store_dwordx4 v[120:123], v18, s[4:7], s39 offen offset:2048 sc1
    buffer_store_dwordx4 v[124:127], v18, s[4:7], s39 offen offset:3072 sc1
    v_accvgpr_read_b32 v136, a192
    v_accvgpr_read_b32 v137, a193
    v_accvgpr_read_b32 v138, a194
    v_accvgpr_read_b32 v139, a195
    v_accvgpr_read_b32 v140, a196
    v_accvgpr_read_b32 v141, a197
    v_accvgpr_read_b32 v142, a198
    v_accvgpr_read_b32 v143, a199
    v_accvgpr_read_b32 v144, a200
    v_accvgpr_read_b32 v145, a201
    v_accvgpr_read_b32 v146, a202
    v_accvgpr_read_b32 v147, a203
    v_accvgpr_read_b32 v148, a204
    v_accvgpr_read_b32 v149, a205
    v_accvgpr_read_b32 v150, a206
    v_accvgpr_read_b32 v151, a207
    v_cvt_pk_bf16_f32 v128, v136, v137
    v_cvt_pk_bf16_f32 v129, v138, v139
    v_cvt_pk_bf16_f32 v130, v140, v141
    v_cvt_pk_bf16_f32 v131, v142, v143
    v_cvt_pk_bf16_f32 v132, v144, v145
    v_cvt_pk_bf16_f32 v133, v146, v147
    v_cvt_pk_bf16_f32 v134, v148, v149
    v_cvt_pk_bf16_f32 v135, v150, v151
    v_cndmask_b32 v128, v128, v17, vcc
    v_cndmask_b32 v129, v129, v17, vcc
    v_cndmask_b32 v130, v130, v17, vcc
    v_cndmask_b32 v131, v131, v17, vcc
    v_cndmask_b32 v132, v132, v17, vcc
    v_cndmask_b32 v133, v133, v17, vcc
    v_cndmask_b32 v134, v134, v17, vcc
    v_cndmask_b32 v135, v135, v17, vcc
    s_add_u32 s39, s43, 4096
    buffer_store_dwordx4 v[128:131], v18, s[4:7], s39 offen offset:2048 sc1
    buffer_store_dwordx4 v[132:135], v18, s[4:7], s39 offen offset:3072 sc1
    s_waitcnt vmcnt(0)
    s_barrier
    s_cmp_lg_u32 s17, 0
    s_cbranch_scc1 L_sig_akv
    v_mov_b32 v251, 1
    s_mov_b64 exec, 1
    buffer_atomic_add v251, off, s[8:11], 0 offset:72
    s_mov_b64 exec, -1
L_sig_akv:
L_go:
    s_add_u32 s48, s48, 1
    s_cmp_eq_u32 s49, 8
    s_cbranch_scc1 L_after
    s_cmp_eq_u32 s49, 0
    s_cbranch_scc1 L_coreTN
    s_cmp_eq_u32 s49, 3
    s_cbranch_scc1 L_coreTN
    s_waitcnt vmcnt(0)
    s_barrier
    ds_read_b128 v[24:27], v4 offset:0
    ds_read_b64_tr_b16 v[40:41], v8 offset:32768
    ds_read_b64_tr_b16 v[42:43], v8 offset:33792
    ds_read_b128 v[28:31], v4 offset:4096
    ds_read_b64_tr_b16 v[44:45], v9 offset:32768
    ds_read_b64_tr_b16 v[46:47], v9 offset:33792
    ds_read_b64_tr_b16 v[48:49], v10 offset:32768
    ds_read_b64_tr_b16 v[50:51], v10 offset:33792
    ds_read_b64_tr_b16 v[52:53], v11 offset:32768
    ds_read_b64_tr_b16 v[54:55], v11 offset:33792
    ds_read_b64_tr_b16 v[56:57], v8 offset:49152
    ds_read_b64_tr_b16 v[58:59], v8 offset:50176
    ds_read_b64_tr_b16 v[60:61], v9 offset:49152
    ds_read_b64_tr_b16 v[62:63], v9 offset:50176
    s_waitcnt lgkmcnt(10)
    ds_read_b64_tr_b16 v[64:65], v10 offset:49152
    ds_read_b64_tr_b16 v[66:67], v10 offset:50176
    ds_read_b64_tr_b16 v[68:69], v11 offset:49152
    ds_read_b64_tr_b16 v[70:71], v11 offset:50176
    v_mfma_f32_32x32x16_bf16 a[0:15], v[40:43], v[24:27], 0
    s_waitcnt lgkmcnt(10)
    ds_read_b128 v[32:35], v5 offset:0
    ds_read_b64_tr_b16 v[72:73], v8 offset:36864
    v_mfma_f32_32x32x16_bf16 a[64:79], v[40:43], v[28:31], 0
    ds_read_b64_tr_b16 v[74:75], v8 offset:37888
    ds_read_b128 v[36:39], v5 offset:4096
    s_add_u32 m0, s37, 65536
    s_add_u32 s39, s32, 0
    buffer_load_dwordx4 v1, s[12:15], s39 offen  lds
    v_mfma_f32_32x32x16_bf16 a[16:31], v[44:47], v[24:27], 0
    s_waitcnt lgkmcnt(10)
    ds_read_b64_tr_b16 v[76:77], v9 offset:36864
    ds_read_b64_tr_b16 v[78:79], v9 offset:37888
    v_mfma_f32_32x32x16_bf16 a[80:95], v[44:47], v[28:31], 0
    ds_read_b64_tr_b16 v[80:81], v10 offset:36864
    ds_read_b64_tr_b16 v[82:83], v10 offset:37888
    s_add_u32 m0, s37, 66560
    s_add_u32 s39, s32, 10240
    buffer_load_dwordx4 v2, s[12:15], s39 offen  lds
    v_mfma_f32_32x32x16_bf16 a[32:47], v[48:51], v[24:27], 0
    s_waitcnt lgkmcnt(10)
    ds_read_b64_tr_b16 v[84:85], v11 offset:36864
    ds_read_b64_tr_b16 v[86:87], v11 offset:37888
    v_mfma_f32_32x32x16_bf16 a[96:111], v[48:51], v[28:31], 0
    ds_read_b64_tr_b16 v[88:89], v8 offset:53248
    ds_read_b64_tr_b16 v[90:91], v8 offset:54272
    s_add_u32 m0, s37, 67584
    s_add_u32 s39, s32, 20480
    buffer_load_dwordx4 v1, s[12:15], s39 offen  lds
    v_mfma_f32_32x32x16_bf16 a[48:63], v[52:55], v[24:27], 0
    s_waitcnt lgkmcnt(10)
    ds_read_b64_tr_b16 v[92:93], v9 offset:53248
    ds_read_b64_tr_b16 v[94:95], v9 offset:54272
    v_mfma_f32_32x32x16_bf16 a[112:127], v[52:55], v[28:31], 0
    ds_read_b64_tr_b16 v[96:97], v10 offset:53248
    ds_read_b64_tr_b16 v[98:99], v10 offset:54272
    s_add_u32 m0, s37, 68608
    s_add_u32 s39, s32, 30720
    buffer_load_dwordx4 v2, s[12:15], s39 offen  lds
    v_mfma_f32_32x32x16_bf16 a[128:143], v[56:59], v[24:27], 0
    s_waitcnt lgkmcnt(10)
    ds_read_b64_tr_b16 v[100:101], v11 offset:53248
    ds_read_b64_tr_b16 v[102:103], v11 offset:54272
    v_mfma_f32_32x32x16_bf16 a[192:207], v[56:59], v[28:31], 0
    s_add_u32 m0, s37, 69632
    s_add_u32 s39, s32, 40960
    buffer_load_dwordx4 v1, s[12:15], s39 offen  lds
    v_mfma_f32_32x32x16_bf16 a[144:159], v[60:63], v[24:27], 0
    v_mfma_f32_32x32x16_bf16 a[208:223], v[60:63], v[28:31], 0
    s_add_u32 m0, s37, 70656
    s_add_u32 s39, s32, 51200
    buffer_load_dwordx4 v2, s[12:15], s39 offen  lds
    v_mfma_f32_32x32x16_bf16 a[160:175], v[64:67], v[24:27], 0
    v_mfma_f32_32x32x16_bf16 a[224:239], v[64:67], v[28:31], 0
    s_add_u32 m0, s37, 71680
    s_add_u32 s39, s32, 61440
    buffer_load_dwordx4 v1, s[12:15], s39 offen  lds
    v_mfma_f32_32x32x16_bf16 a[176:191], v[68:71], v[24:27], 0
    v_mfma_f32_32x32x16_bf16 a[240:255], v[68:71], v[28:31], 0
    s_add_u32 m0, s37, 72704
    s_add_u32 s39, s32, 71680
    buffer_load_dwordx4 v2, s[12:15], s39 offen  lds
    s_add_u32 s32, s32, 128
    v_mfma_f32_32x32x16_bf16 a[0:15], v[72:75], v[32:35], a[0:15]
    ds_read_b128 v[24:27], v6 offset:0
    ds_read_b64_tr_b16 v[40:41], v8 offset:40960
    v_mfma_f32_32x32x16_bf16 a[64:79], v[72:75], v[36:39], a[64:79]
    s_waitcnt lgkmcnt(10)
    ds_read_b64_tr_b16 v[42:43], v8 offset:41984
    ds_read_b128 v[28:31], v6 offset:4096
    buffer_store_dwordx4 v[104:107], v20, s[88:91], s92 offen sc1
    s_add_u32 s92, s92, s93
    v_mfma_f32_32x32x16_bf16 a[16:31], v[76:79], v[32:35], a[16:31]
    ds_read_b64_tr_b16 v[44:45], v9 offset:40960
    ds_read_b64_tr_b16 v[46:47], v9 offset:41984
    v_mfma_f32_32x32x16_bf16 a[80:95], v[76:79], v[36:39], a[80:95]
    s_waitcnt lgkmcnt(10)
    ds_read_b64_tr_b16 v[48:49], v10 offset:40960
    ds_read_b64_tr_b16 v[50:51], v10 offset:41984
    v_mfma_f32_32x32x16_bf16 a[32:47], v[80:83], v[32:35], a[32:47]
    ds_read_b64_tr_b16 v[52:53], v11 offset:40960
    ds_read_b64_tr_b16 v[54:55], v11 offset:41984
    buffer_store_dwordx4 v[108:111], v20, s[88:91], s92 offen sc1
    s_add_u32 s92, s92, s94
    v_mfma_f32_32x32x16_bf16 a[96:111], v[80:83], v[36:39], a[96:111]
    s_waitcnt lgkmcnt(10)
    ds_read_b64_tr_b16 v[56:57], v8 offset:57344
    ds_read_b64_tr_b16 v[58:59], v8 offset:58368
    v_mfma_f32_32x32x16_bf16 a[48:63], v[84:87], v[32:35], a[48:63]
    ds_read_b64_tr_b16 v[60:61], v9 offset:57344
    ds_read_b64_tr_b16 v[62:63], v9 offset:58368
    v_mfma_f32_32x32x16_bf16 a[112:127], v[84:87], v[36:39], a[112:127]
    s_waitcnt lgkmcnt(10)
    ds_read_b64_tr_b16 v[64:65], v10 offset:57344
    ds_read_b64_tr_b16 v[66:67], v10 offset:58368
    buffer_store_dwordx4 v[112:115], v20, s[88:91], s92 offen sc1
    s_add_u32 s92, s92, s93
    v_mfma_f32_32x32x16_bf16 a[128:143], v[88:91], v[32:35], a[128:143]
    ds_read_b64_tr_b16 v[68:69], v11 offset:57344
    ds_read_b64_tr_b16 v[70:71], v11 offset:58368
    v_mfma_f32_32x32x16_bf16 a[192:207], v[88:91], v[36:39], a[192:207]
    v_mfma_f32_32x32x16_bf16 a[144:159], v[92:95], v[32:35], a[144:159]
    buffer_store_dwordx4 v[116:119], v20, s[88:91], s92 offen sc1
    s_add_u32 s92, s92, s94
    v_mfma_f32_32x32x16_bf16 a[208:223], v[92:95], v[36:39], a[208:223]
    v_mfma_f32_32x32x16_bf16 a[160:175], v[96:99], v[32:35], a[160:175]
    v_mfma_f32_32x32x16_bf16 a[224:239], v[96:99], v[36:39], a[224:239]
    v_mfma_f32_32x32x16_bf16 a[176:191], v[100:103], v[32:35], a[176:191]
    v_mfma_f32_32x32x16_bf16 a[240:255], v[100:103], v[36:39], a[240:255]
    v_mfma_f32_32x32x16_bf16 a[0:15], v[40:43], v[24:27], a[0:15]
    s_waitcnt lgkmcnt(10)
    ds_read_b128 v[32:35], v7 offset:0
    ds_read_b64_tr_b16 v[72:73], v8 offset:45056
    v_mfma_f32_32x32x16_bf16 a[64:79], v[40:43], v[28:31], a[64:79]
    ds_read_b64_tr_b16 v[74:75], v8 offset:46080
    ds_read_b128 v[36:39], v7 offset:4096
    v_mfma_f32_32x32x16_bf16 a[16:31], v[44:47], v[24:27], a[16:31]
    s_waitcnt lgkmcnt(10)
    ds_read_b64_tr_b16 v[76:77], v9 offset:45056
    ds_read_b64_tr_b16 v[78:79], v9 offset:46080
    v_mfma_f32_32x32x16_bf16 a[80:95], v[44:47], v[28:31], a[80:95]
    ds_read_b64_tr_b16 v[80:81], v10 offset:45056
    ds_read_b64_tr_b16 v[82:83], v10 offset:46080
    v_mfma_f32_32x32x16_bf16 a[32:47], v[48:51], v[24:27], a[32:47]
    s_waitcnt lgkmcnt(10)
    ds_read_b64_tr_b16 v[84:85], v11 offset:45056
    ds_read_b64_tr_b16 v[86:87], v11 offset:46080
    v_mfma_f32_32x32x16_bf16 a[96:111], v[48:51], v[28:31], a[96:111]
    ds_read_b64_tr_b16 v[88:89], v8 offset:61440
    ds_read_b64_tr_b16 v[90:91], v8 offset:62464
    v_mfma_f32_32x32x16_bf16 a[48:63], v[52:55], v[24:27], a[48:63]
    s_waitcnt lgkmcnt(10)
    ds_read_b64_tr_b16 v[92:93], v9 offset:61440
    ds_read_b64_tr_b16 v[94:95], v9 offset:62464
    v_mfma_f32_32x32x16_bf16 a[112:127], v[52:55], v[28:31], a[112:127]
    ds_read_b64_tr_b16 v[96:97], v10 offset:61440
    ds_read_b64_tr_b16 v[98:99], v10 offset:62464
    v_mfma_f32_32x32x16_bf16 a[128:143], v[56:59], v[24:27], a[128:143]
    s_waitcnt lgkmcnt(10)
    ds_read_b64_tr_b16 v[100:101], v11 offset:61440
    ds_read_b64_tr_b16 v[102:103], v11 offset:62464
    v_mfma_f32_32x32x16_bf16 a[192:207], v[56:59], v[28:31], a[192:207]
    v_mfma_f32_32x32x16_bf16 a[144:159], v[60:63], v[24:27], a[144:159]
    v_xor_b32 v4, 0x10000, v4
    v_xor_b32 v5, 0x10000, v5
    v_mfma_f32_32x32x16_bf16 a[208:223], v[60:63], v[28:31], a[208:223]
    v_xor_b32 v6, 0x10000, v6
    v_xor_b32 v7, 0x10000, v7
    v_mfma_f32_32x32x16_bf16 a[160:175], v[64:67], v[24:27], a[160:175]
    v_xor_b32 v8, 0x10000, v8
    v_xor_b32 v9, 0x10000, v9
    v_mfma_f32_32x32x16_bf16 a[224:239], v[64:67], v[28:31], a[224:239]
    v_xor_b32 v10, 0x10000, v10
    v_xor_b32 v11, 0x10000, v11
    v_mfma_f32_32x32x16_bf16 a[176:191], v[68:71], v[24:27], a[176:191]
    v_xor_b32 v12, 0x10000, v12
    v_xor_b32 v13, 0x10000, v13
    v_mfma_f32_32x32x16_bf16 a[240:255], v[68:71], v[28:31], a[240:255]
    v_xor_b32 v14, 0x10000, v14
    v_xor_b32 v15, 0x10000, v15
    s_waitcnt vmcnt(0) lgkmcnt(0)
    s_barrier
    v_mfma_f32_32x32x16_bf16 a[0:15], v[72:75], v[32:35], a[0:15]
    ds_read_b128 v[24:27], v4 offset:0
    ds_read_b64_tr_b16 v[40:41], v8 offset:32768
    v_mfma_f32_32x32x16_bf16 a[64:79], v[72:75], v[36:39], a[64:79]
    ds_read_b64_tr_b16 v[42:43], v8 offset:33792
    ds_read_b128 v[28:31], v4 offset:4096
    s_add_u32 m0, s38, 0
    s_mov_b32 s40, s33
    buffer_load_dwordx4 v3, s[20:23], s40 offen  lds
    v_mfma_f32_32x32x16_bf16 a[16:31], v[76:79], v[32:35], a[16:31]
    ds_read_b64_tr_b16 v[44:45], v9 offset:32768
    ds_read_b64_tr_b16 v[46:47], v9 offset:33792
    v_mfma_f32_32x32x16_bf16 a[80:95], v[76:79], v[36:39], a[80:95]
    ds_read_b64_tr_b16 v[48:49], v10 offset:32768
    ds_read_b64_tr_b16 v[50:51], v10 offset:33792
    s_add_u32 m0, s38, 1024
    s_add_u32 s40, s40, s35
    buffer_load_dwordx4 v3, s[20:23], s40 offen  lds
    v_mfma_f32_32x32x16_bf16 a[32:47], v[80:83], v[32:35], a[32:47]
    ds_read_b64_tr_b16 v[52:53], v11 offset:32768
    ds_read_b64_tr_b16 v[54:55], v11 offset:33792
    v_mfma_f32_32x32x16_bf16 a[96:111], v[80:83], v[36:39], a[96:111]
    ds_read_b64_tr_b16 v[56:57], v8 offset:49152
    ds_read_b64_tr_b16 v[58:59], v8 offset:50176
    s_add_u32 m0, s38, 2048
    s_add_u32 s40, s40, s35
    buffer_load_dwordx4 v3, s[20:23], s40 offen  lds
    v_mfma_f32_32x32x16_bf16 a[48:63], v[84:87], v[32:35], a[48:63]
    ds_read_b64_tr_b16 v[60:61], v9 offset:49152
    ds_read_b64_tr_b16 v[62:63], v9 offset:50176
    v_mfma_f32_32x32x16_bf16 a[112:127], v[84:87], v[36:39], a[112:127]
    s_waitcnt lgkmcnt(10)
    ds_read_b64_tr_b16 v[64:65], v10 offset:49152
    ds_read_b64_tr_b16 v[66:67], v10 offset:50176
    s_add_u32 m0, s38, 3072
    s_add_u32 s40, s40, s35
    buffer_load_dwordx4 v3, s[20:23], s40 offen  lds
    v_mfma_f32_32x32x16_bf16 a[128:143], v[88:91], v[32:35], a[128:143]
    ds_read_b64_tr_b16 v[68:69], v11 offset:49152
    ds_read_b64_tr_b16 v[70:71], v11 offset:50176
    v_mfma_f32_32x32x16_bf16 a[192:207], v[88:91], v[36:39], a[192:207]
    s_add_u32 m0, s38, 16384
    s_mov_b32 s40, s34
    buffer_load_dwordx4 v3, s[24:27], s40 offen  lds
    v_mfma_f32_32x32x16_bf16 a[144:159], v[92:95], v[32:35], a[144:159]
    v_mfma_f32_32x32x16_bf16 a[208:223], v[92:95], v[36:39], a[208:223]
    s_add_u32 m0, s38, 17408
    s_add_u32 s40, s40, s35
    buffer_load_dwordx4 v3, s[24:27], s40 offen  lds
    v_mfma_f32_32x32x16_bf16 a[160:175], v[96:99], v[32:35], a[160:175]
    v_mfma_f32_32x32x16_bf16 a[224:239], v[96:99], v[36:39], a[224:239]
    s_add_u32 m0, s38, 18432
    s_add_u32 s40, s40, s35
    buffer_load_dwordx4 v3, s[24:27], s40 offen  lds
    v_mfma_f32_32x32x16_bf16 a[176:191], v[100:103], v[32:35], a[176:191]
    v_mfma_f32_32x32x16_bf16 a[240:255], v[100:103], v[36:39], a[240:255]
    s_add_u32 m0, s38, 19456
    s_add_u32 s40, s40, s35
    buffer_load_dwordx4 v3, s[24:27], s40 offen  lds
    s_add_u32 s33, s33, s36
    s_add_u32 s34, s34, s36
    v_mfma_f32_32x32x16_bf16 a[0:15], v[40:43], v[24:27], a[0:15]
    s_waitcnt lgkmcnt(10)
    ds_read_b128 v[32:35], v5 offset:0
    ds_read_b64_tr_b16 v[72:73], v8 offset:36864
    v_mfma_f32_32x32x16_bf16 a[64:79], v[40:43], v[28:31], a[64:79]
    ds_read_b64_tr_b16 v[74:75], v8 offset:37888
    ds_read_b128 v[36:39], v5 offset:4096
    s_add_u32 m0, s37, 0
    s_add_u32 s39, s32, 0
    buffer_load_dwordx4 v1, s[12:15], s39 offen  lds
    v_mfma_f32_32x32x16_bf16 a[16:31], v[44:47], v[24:27], a[16:31]
    s_waitcnt lgkmcnt(10)
    ds_read_b64_tr_b16 v[76:77], v9 offset:36864
    ds_read_b64_tr_b16 v[78:79], v9 offset:37888
    v_mfma_f32_32x32x16_bf16 a[80:95], v[44:47], v[28:31], a[80:95]
    ds_read_b64_tr_b16 v[80:81], v10 offset:36864
    ds_read_b64_tr_b16 v[82:83], v10 offset:37888
    s_add_u32 m0, s37, 1024
    s_add_u32 s39, s32, 10240
    buffer_load_dwordx4 v2, s[12:15], s39 offen  lds
    v_mfma_f32_32x32x16_bf16 a[32:47], v[48:51], v[24:27], a[32:47]
    s_waitcnt lgkmcnt(10)
    ds_read_b64_tr_b16 v[84:85], v11 offset:36864
    ds_read_b64_tr_b16 v[86:87], v11 offset:37888
    v_mfma_f32_32x32x16_bf16 a[96:111], v[48:51], v[28:31], a[96:111]
    ds_read_b64_tr_b16 v[88:89], v8 offset:53248
    ds_read_b64_tr_b16 v[90:91], v8 offset:54272
    s_add_u32 m0, s37, 2048
    s_add_u32 s39, s32, 20480
    buffer_load_dwordx4 v1, s[12:15], s39 offen  lds
    v_mfma_f32_32x32x16_bf16 a[48:63], v[52:55], v[24:27], a[48:63]
    s_waitcnt lgkmcnt(10)
    ds_read_b64_tr_b16 v[92:93], v9 offset:53248
    ds_read_b64_tr_b16 v[94:95], v9 offset:54272
    v_mfma_f32_32x32x16_bf16 a[112:127], v[52:55], v[28:31], a[112:127]
    ds_read_b64_tr_b16 v[96:97], v10 offset:53248
    ds_read_b64_tr_b16 v[98:99], v10 offset:54272
    s_add_u32 m0, s37, 3072
    s_add_u32 s39, s32, 30720
    buffer_load_dwordx4 v2, s[12:15], s39 offen  lds
    v_mfma_f32_32x32x16_bf16 a[128:143], v[56:59], v[24:27], a[128:143]
    s_waitcnt lgkmcnt(10)
    ds_read_b64_tr_b16 v[100:101], v11 offset:53248
    ds_read_b64_tr_b16 v[102:103], v11 offset:54272
    v_mfma_f32_32x32x16_bf16 a[192:207], v[56:59], v[28:31], a[192:207]
    s_add_u32 m0, s37, 4096
    s_add_u32 s39, s32, 40960
    buffer_load_dwordx4 v1, s[12:15], s39 offen  lds
    v_mfma_f32_32x32x16_bf16 a[144:159], v[60:63], v[24:27], a[144:159]
    v_mfma_f32_32x32x16_bf16 a[208:223], v[60:63], v[28:31], a[208:223]
    s_add_u32 m0, s37, 5120
    s_add_u32 s39, s32, 51200
    buffer_load_dwordx4 v2, s[12:15], s39 offen  lds
    v_mfma_f32_32x32x16_bf16 a[160:175], v[64:67], v[24:27], a[160:175]
    v_mfma_f32_32x32x16_bf16 a[224:239], v[64:67], v[28:31], a[224:239]
    s_add_u32 m0, s37, 6144
    s_add_u32 s39, s32, 61440
    buffer_load_dwordx4 v1, s[12:15], s39 offen  lds
    v_mfma_f32_32x32x16_bf16 a[176:191], v[68:71], v[24:27], a[176:191]
    v_mfma_f32_32x32x16_bf16 a[240:255], v[68:71], v[28:31], a[240:255]
    s_add_u32 m0, s37, 7168
    s_add_u32 s39, s32, 71680
    buffer_load_dwordx4 v2, s[12:15], s39 offen  lds
    s_add_u32 s32, s32, 128
    v_mfma_f32_32x32x16_bf16 a[0:15], v[72:75], v[32:35], a[0:15]
    ds_read_b128 v[24:27], v6 offset:0
    ds_read_b64_tr_b16 v[40:41], v8 offset:40960
    v_mfma_f32_32x32x16_bf16 a[64:79], v[72:75], v[36:39], a[64:79]
    s_waitcnt lgkmcnt(10)
    ds_read_b64_tr_b16 v[42:43], v8 offset:41984
    ds_read_b128 v[28:31], v6 offset:4096
    buffer_store_dwordx4 v[120:123], v20, s[88:91], s92 offen sc1
    s_add_u32 s92, s92, s93
    v_mfma_f32_32x32x16_bf16 a[16:31], v[76:79], v[32:35], a[16:31]
    ds_read_b64_tr_b16 v[44:45], v9 offset:40960
    ds_read_b64_tr_b16 v[46:47], v9 offset:41984
    v_mfma_f32_32x32x16_bf16 a[80:95], v[76:79], v[36:39], a[80:95]
    s_waitcnt lgkmcnt(10)
    ds_read_b64_tr_b16 v[48:49], v10 offset:40960
    ds_read_b64_tr_b16 v[50:51], v10 offset:41984
    v_mfma_f32_32x32x16_bf16 a[32:47], v[80:83], v[32:35], a[32:47]
    ds_read_b64_tr_b16 v[52:53], v11 offset:40960
    ds_read_b64_tr_b16 v[54:55], v11 offset:41984
    buffer_store_dwordx4 v[124:127], v20, s[88:91], s92 offen sc1
    s_add_u32 s92, s92, s94
    v_mfma_f32_32x32x16_bf16 a[96:111], v[80:83], v[36:39], a[96:111]
    s_waitcnt lgkmcnt(10)
    ds_read_b64_tr_b16 v[56:57], v8 offset:57344
    ds_read_b64_tr_b16 v[58:59], v8 offset:58368
    v_mfma_f32_32x32x16_bf16 a[48:63], v[84:87], v[32:35], a[48:63]
    ds_read_b64_tr_b16 v[60:61], v9 offset:57344
    ds_read_b64_tr_b16 v[62:63], v9 offset:58368
    v_mfma_f32_32x32x16_bf16 a[112:127], v[84:87], v[36:39], a[112:127]
    s_waitcnt lgkmcnt(10)
    ds_read_b64_tr_b16 v[64:65], v10 offset:57344
    ds_read_b64_tr_b16 v[66:67], v10 offset:58368
    buffer_store_dwordx4 v[128:131], v20, s[88:91], s92 offen sc1
    s_add_u32 s92, s92, s93
    v_mfma_f32_32x32x16_bf16 a[128:143], v[88:91], v[32:35], a[128:143]
    ds_read_b64_tr_b16 v[68:69], v11 offset:57344
    ds_read_b64_tr_b16 v[70:71], v11 offset:58368
    v_mfma_f32_32x32x16_bf16 a[192:207], v[88:91], v[36:39], a[192:207]
    v_mfma_f32_32x32x16_bf16 a[144:159], v[92:95], v[32:35], a[144:159]
    buffer_store_dwordx4 v[132:135], v20, s[88:91], s92 offen sc1
    s_add_u32 s92, s92, s95
    v_mfma_f32_32x32x16_bf16 a[208:223], v[92:95], v[36:39], a[208:223]
    v_mfma_f32_32x32x16_bf16 a[160:175], v[96:99], v[32:35], a[160:175]
    v_mfma_f32_32x32x16_bf16 a[224:239], v[96:99], v[36:39], a[224:239]
    v_mfma_f32_32x32x16_bf16 a[176:191], v[100:103], v[32:35], a[176:191]
    v_mfma_f32_32x32x16_bf16 a[240:255], v[100:103], v[36:39], a[240:255]
    v_mfma_f32_32x32x16_bf16 a[0:15], v[40:43], v[24:27], a[0:15]
    s_waitcnt lgkmcnt(10)
    ds_read_b128 v[32:35], v7 offset:0
    ds_read_b64_tr_b16 v[72:73], v8 offset:45056
    v_mfma_f32_32x32x16_bf16 a[64:79], v[40:43], v[28:31], a[64:79]
    ds_read_b64_tr_b16 v[74:75], v8 offset:46080
    ds_read_b128 v[36:39], v7 offset:4096
    v_mfma_f32_32x32x16_bf16 a[16:31], v[44:47], v[24:27], a[16:31]
    s_waitcnt lgkmcnt(10)
    ds_read_b64_tr_b16 v[76:77], v9 offset:45056
    ds_read_b64_tr_b16 v[78:79], v9 offset:46080
    v_mfma_f32_32x32x16_bf16 a[80:95], v[44:47], v[28:31], a[80:95]
    ds_read_b64_tr_b16 v[80:81], v10 offset:45056
    ds_read_b64_tr_b16 v[82:83], v10 offset:46080
    v_mfma_f32_32x32x16_bf16 a[32:47], v[48:51], v[24:27], a[32:47]
    s_waitcnt lgkmcnt(10)
    ds_read_b64_tr_b16 v[84:85], v11 offset:45056
    ds_read_b64_tr_b16 v[86:87], v11 offset:46080
    v_mfma_f32_32x32x16_bf16 a[96:111], v[48:51], v[28:31], a[96:111]
    ds_read_b64_tr_b16 v[88:89], v8 offset:61440
    ds_read_b64_tr_b16 v[90:91], v8 offset:62464
    v_mfma_f32_32x32x16_bf16 a[48:63], v[52:55], v[24:27], a[48:63]
    s_waitcnt lgkmcnt(10)
    ds_read_b64_tr_b16 v[92:93], v9 offset:61440
    ds_read_b64_tr_b16 v[94:95], v9 offset:62464
    v_mfma_f32_32x32x16_bf16 a[112:127], v[52:55], v[28:31], a[112:127]
    ds_read_b64_tr_b16 v[96:97], v10 offset:61440
    ds_read_b64_tr_b16 v[98:99], v10 offset:62464
    v_mfma_f32_32x32x16_bf16 a[128:143], v[56:59], v[24:27], a[128:143]
    s_waitcnt lgkmcnt(10)
    ds_read_b64_tr_b16 v[100:101], v11 offset:61440
    ds_read_b64_tr_b16 v[102:103], v11 offset:62464
    v_mfma_f32_32x32x16_bf16 a[192:207], v[56:59], v[28:31], a[192:207]
    v_mfma_f32_32x32x16_bf16 a[144:159], v[60:63], v[24:27], a[144:159]
    v_xor_b32 v4, 0x10000, v4
    v_xor_b32 v5, 0x10000, v5
    v_mfma_f32_32x32x16_bf16 a[208:223], v[60:63], v[28:31], a[208:223]
    v_xor_b32 v6, 0x10000, v6
    v_xor_b32 v7, 0x10000, v7
    v_mfma_f32_32x32x16_bf16 a[160:175], v[64:67], v[24:27], a[160:175]
    v_xor_b32 v8, 0x10000, v8
    v_xor_b32 v9, 0x10000, v9
    v_mfma_f32_32x32x16_bf16 a[224:239], v[64:67], v[28:31], a[224:239]
    v_xor_b32 v10, 0x10000, v10
    v_xor_b32 v11, 0x10000, v11
    v_mfma_f32_32x32x16_bf16 a[176:191], v[68:71], v[24:27], a[176:191]
    v_xor_b32 v12, 0x10000, v12
    v_xor_b32 v13, 0x10000, v13
    v_mfma_f32_32x32x16_bf16 a[240:255], v[68:71], v[28:31], a[240:255]
    v_xor_b32 v14, 0x10000, v14
    v_xor_b32 v15, 0x10000, v15
    s_waitcnt vmcnt(0) lgkmcnt(0)
    s_barrier
    v_mfma_f32_32x32x16_bf16 a[0:15], v[72:75], v[32:35], a[0:15]
    ds_read_b128 v[24:27], v4 offset:0
    ds_read_b64_tr_b16 v[40:41], v8 offset:32768
    v_mfma_f32_32x32x16_bf16 a[64:79], v[72:75], v[36:39], a[64:79]
    ds_read_b64_tr_b16 v[42:43], v8 offset:33792
    ds_read_b128 v[28:31], v4 offset:4096
    s_add_u32 m0, s38, 65536
    s_mov_b32 s40, s33
    buffer_load_dwordx4 v3, s[20:23], s40 offen  lds
    v_mfma_f32_32x32x16_bf16 a[16:31], v[76:79], v[32:35], a[16:31]
    ds_read_b64_tr_b16 v[44:45], v9 offset:32768
    ds_read_b64_tr_b16 v[46:47], v9 offset:33792
    v_mfma_f32_32x32x16_bf16 a[80:95], v[76:79], v[36:39], a[80:95]
    ds_read_b64_tr_b16 v[48:49], v10 offset:32768
    ds_read_b64_tr_b16 v[50:51], v10 offset:33792
    s_add_u32 m0, s38, 66560
    s_add_u32 s40, s40, s35
    buffer_load_dwordx4 v3, s[20:23], s40 offen  lds
    v_mfma_f32_32x32x16_bf16 a[32:47], v[80:83], v[32:35], a[32:47]
    ds_read_b64_tr_b16 v[52:53], v11 offset:32768
    ds_read_b64_tr_b16 v[54:55], v11 offset:33792
    v_mfma_f32_32x32x16_bf16 a[96:111], v[80:83], v[36:39], a[96:111]
    ds_read_b64_tr_b16 v[56:57], v8 offset:49152
    ds_read_b64_tr_b16 v[58:59], v8 offset:50176
    s_add_u32 m0, s38, 67584
    s_add_u32 s40, s40, s35
    buffer_load_dwordx4 v3, s[20:23], s40 offen  lds
    v_mfma_f32_32x32x16_bf16 a[48:63], v[84:87], v[32:35], a[48:63]
    ds_read_b64_tr_b16 v[60:61], v9 offset:49152
    ds_read_b64_tr_b16 v[62:63], v9 offset:50176
    v_mfma_f32_32x32x16_bf16 a[112:127], v[84:87], v[36:39], a[112:127]
    s_waitcnt lgkmcnt(10)
    ds_read_b64_tr_b16 v[64:65], v10 offset:49152
    ds_read_b64_tr_b16 v[66:67], v10 offset:50176
    s_add_u32 m0, s38, 68608
    s_add_u32 s40, s40, s35
    buffer_load_dwordx4 v3, s[20:23], s40 offen  lds
    v_mfma_f32_32x32x16_bf16 a[128:143], v[88:91], v[32:35], a[128:143]
    ds_read_b64_tr_b16 v[68:69], v11 offset:49152
    ds_read_b64_tr_b16 v[70:71], v11 offset:50176
    v_mfma_f32_32x32x16_bf16 a[192:207], v[88:91], v[36:39], a[192:207]
    s_add_u32 m0, s38, 81920
    s_mov_b32 s40, s34
    buffer_load_dwordx4 v3, s[24:27], s40 offen  lds
    v_mfma_f32_32x32x16_bf16 a[144:159], v[92:95], v[32:35], a[144:159]
    v_mfma_f32_32x32x16_bf16 a[208:223], v[92:95], v[36:39], a[208:223]
    s_add_u32 m0, s38, 82944
    s_add_u32 s40, s40, s35
    buffer_load_dwordx4 v3, s[24:27], s40 offen  lds
    v_mfma_f32_32x32x16_bf16 a[160:175], v[96:99], v[32:35], a[160:175]
    v_mfma_f32_32x32x16_bf16 a[224:239], v[96:99], v[36:39], a[224:239]
    s_add_u32 m0, s38, 83968
    s_add_u32 s40, s40, s35
    buffer_load_dwordx4 v3, s[24:27], s40 offen  lds
    v_mfma_f32_32x32x16_bf16 a[176:191], v[100:103], v[32:35], a[176:191]
    v_mfma_f32_32x32x16_bf16 a[240:255], v[100:103], v[36:39], a[240:255]
    s_add_u32 m0, s38, 84992
    s_add_u32 s40, s40, s35
    buffer_load_dwordx4 v3, s[24:27], s40 offen  lds
    s_add_u32 s33, s33, s36
    s_add_u32 s34, s34, s36
    v_mfma_f32_32x32x16_bf16 a[0:15], v[40:43], v[24:27], a[0:15]
    s_waitcnt lgkmcnt(10)
    ds_read_b128 v[32:35], v5 offset:0
    ds_read_b64_tr_b16 v[72:73], v8 offset:36864
    v_mfma_f32_32x32x16_bf16 a[64:79], v[40:43], v[28:31], a[64:79]
    ds_read_b64_tr_b16 v[74:75], v8 offset:37888
    ds_read_b128 v[36:39], v5 offset:4096
    s_add_u32 m0, s37, 65536
    s_add_u32 s39, s32, 0
    buffer_load_dwordx4 v1, s[12:15], s39 offen  lds
    v_mfma_f32_32x32x16_bf16 a[16:31], v[44:47], v[24:27], a[16:31]
    s_waitcnt lgkmcnt(10)
    ds_read_b64_tr_b16 v[76:77], v9 offset:36864
    ds_read_b64_tr_b16 v[78:79], v9 offset:37888
    v_mfma_f32_32x32x16_bf16 a[80:95], v[44:47], v[28:31], a[80:95]
    ds_read_b64_tr_b16 v[80:81], v10 offset:36864
    ds_read_b64_tr_b16 v[82:83], v10 offset:37888
    s_add_u32 m0, s37, 66560
    s_add_u32 s39, s32, 10240
    buffer_load_dwordx4 v2, s[12:15], s39 offen  lds
    v_mfma_f32_32x32x16_bf16 a[32:47], v[48:51], v[24:27], a[32:47]
    s_waitcnt lgkmcnt(10)
    ds_read_b64_tr_b16 v[84:85], v11 offset:36864
    ds_read_b64_tr_b16 v[86:87], v11 offset:37888
    v_mfma_f32_32x32x16_bf16 a[96:111], v[48:51], v[28:31], a[96:111]
    ds_read_b64_tr_b16 v[88:89], v8 offset:53248
    ds_read_b64_tr_b16 v[90:91], v8 offset:54272
    s_add_u32 m0, s37, 67584
    s_add_u32 s39, s32, 20480
    buffer_load_dwordx4 v1, s[12:15], s39 offen  lds
    v_mfma_f32_32x32x16_bf16 a[48:63], v[52:55], v[24:27], a[48:63]
    s_waitcnt lgkmcnt(10)
    ds_read_b64_tr_b16 v[92:93], v9 offset:53248
    ds_read_b64_tr_b16 v[94:95], v9 offset:54272
    v_mfma_f32_32x32x16_bf16 a[112:127], v[52:55], v[28:31], a[112:127]
    ds_read_b64_tr_b16 v[96:97], v10 offset:53248
    ds_read_b64_tr_b16 v[98:99], v10 offset:54272
    s_add_u32 m0, s37, 68608
    s_add_u32 s39, s32, 30720
    buffer_load_dwordx4 v2, s[12:15], s39 offen  lds
    v_mfma_f32_32x32x16_bf16 a[128:143], v[56:59], v[24:27], a[128:143]
    s_waitcnt lgkmcnt(10)
    ds_read_b64_tr_b16 v[100:101], v11 offset:53248
    ds_read_b64_tr_b16 v[102:103], v11 offset:54272
    v_mfma_f32_32x32x16_bf16 a[192:207], v[56:59], v[28:31], a[192:207]
    s_add_u32 m0, s37, 69632
    s_add_u32 s39, s32, 40960
    buffer_load_dwordx4 v1, s[12:15], s39 offen  lds
    v_mfma_f32_32x32x16_bf16 a[144:159], v[60:63], v[24:27], a[144:159]
    v_mfma_f32_32x32x16_bf16 a[208:223], v[60:63], v[28:31], a[208:223]
    s_add_u32 m0, s37, 70656
    s_add_u32 s39, s32, 51200
    buffer_load_dwordx4 v2, s[12:15], s39 offen  lds
    v_mfma_f32_32x32x16_bf16 a[160:175], v[64:67], v[24:27], a[160:175]
    v_mfma_f32_32x32x16_bf16 a[224:239], v[64:67], v[28:31], a[224:239]
    s_add_u32 m0, s37, 71680
    s_add_u32 s39, s32, 61440
    buffer_load_dwordx4 v1, s[12:15], s39 offen  lds
    v_mfma_f32_32x32x16_bf16 a[176:191], v[68:71], v[24:27], a[176:191]
    v_mfma_f32_32x32x16_bf16 a[240:255], v[68:71], v[28:31], a[240:255]
    s_add_u32 m0, s37, 72704
    s_add_u32 s39, s32, 71680
    buffer_load_dwordx4 v2, s[12:15], s39 offen  lds
    s_add_u32 s32, s32, 128
    v_mfma_f32_32x32x16_bf16 a[0:15], v[72:75], v[32:35], a[0:15]
    ds_read_b128 v[24:27], v6 offset:0
    ds_read_b64_tr_b16 v[40:41], v8 offset:40960
    v_mfma_f32_32x32x16_bf16 a[64:79], v[72:75], v[36:39], a[64:79]
    s_waitcnt lgkmcnt(10)
    ds_read_b64_tr_b16 v[42:43], v8 offset:41984
    ds_read_b128 v[28:31], v6 offset:4096
    buffer_store_dwordx4 v[136:139], v20, s[88:91], s92 offen sc1
    s_add_u32 s92, s92, s93
    v_mfma_f32_32x32x16_bf16 a[16:31], v[76:79], v[32:35], a[16:31]
    ds_read_b64_tr_b16 v[44:45], v9 offset:40960
    ds_read_b64_tr_b16 v[46:47], v9 offset:41984
    v_mfma_f32_32x32x16_bf16 a[80:95], v[76:79], v[36:39], a[80:95]
    s_waitcnt lgkmcnt(10)
    ds_read_b64_tr_b16 v[48:49], v10 offset:40960
    ds_read_b64_tr_b16 v[50:51], v10 offset:41984
    v_mfma_f32_32x32x16_bf16 a[32:47], v[80:83], v[32:35], a[32:47]
    ds_read_b64_tr_b16 v[52:53], v11 offset:40960
    ds_read_b64_tr_b16 v[54:55], v11 offset:41984
    buffer_store_dwordx4 v[140:143], v20, s[88:91], s92 offen sc1
    s_add_u32 s92, s92, s94
    v_mfma_f32_32x32x16_bf16 a[96:111], v[80:83], v[36:39], a[96:111]
    s_waitcnt lgkmcnt(10)
    ds_read_b64_tr_b16 v[56:57], v8 offset:57344
    ds_read_b64_tr_b16 v[58:59], v8 offset:58368
    v_mfma_f32_32x32x16_bf16 a[48:63], v[84:87], v[32:35], a[48:63]
    ds_read_b64_tr_b16 v[60:61], v9 offset:57344
    ds_read_b64_tr_b16 v[62:63], v9 offset:58368
    v_mfma_f32_32x32x16_bf16 a[112:127], v[84:87], v[36:39], a[112:127]
    s_waitcnt lgkmcnt(10)
    ds_read_b64_tr_b16 v[64:65], v10 offset:57344
    ds_read_b64_tr_b16 v[66:67], v10 offset:58368
    buffer_store_dwordx4 v[144:147], v20, s[88:91], s92 offen sc1
    s_add_u32 s92, s92, s93
    v_mfma_f32_32x32x16_bf16 a[128:143], v[88:91], v[32:35], a[128:143]
    ds_read_b64_tr_b16 v[68:69], v11 offset:57344
    ds_read_b64_tr_b16 v[70:71], v11 offset:58368
    v_mfma_f32_32x32x16_bf16 a[192:207], v[88:91], v[36:39], a[192:207]
    v_mfma_f32_32x32x16_bf16 a[144:159], v[92:95], v[32:35], a[144:159]
    buffer_store_dwordx4 v[148:151], v20, s[88:91], s92 offen sc1
    s_add_u32 s92, s92, s94
    v_mfma_f32_32x32x16_bf16 a[208:223], v[92:95], v[36:39], a[208:223]
    v_mfma_f32_32x32x16_bf16 a[160:175], v[96:99], v[32:35], a[160:175]
    v_mfma_f32_32x32x16_bf16 a[224:239], v[96:99], v[36:39], a[224:239]
    v_mfma_f32_32x32x16_bf16 a[176:191], v[100:103], v[32:35], a[176:191]
    v_mfma_f32_32x32x16_bf16 a[240:255], v[100:103], v[36:39], a[240:255]
    v_mfma_f32_32x32x16_bf16 a[0:15], v[40:43], v[24:27], a[0:15]
    s_waitcnt lgkmcnt(10)
    ds_read_b128 v[32:35], v7 offset:0
    ds_read_b64_tr_b16 v[72:73], v8 offset:45056
    v_mfma_f32_32x32x16_bf16 a[64:79], v[40:43], v[28:31], a[64:79]
    ds_read_b64_tr_b16 v[74:75], v8 offset:46080
    ds_read_b128 v[36:39], v7 offset:4096
    v_mfma_f32_32x32x16_bf16 a[16:31], v[44:47], v[24:27], a[16:31]
    s_waitcnt lgkmcnt(10)
    ds_read_b64_tr_b16 v[76:77], v9 offset:45056
    ds_read_b64_tr_b16 v[78:79], v9 offset:46080
    v_mfma_f32_32x32x16_bf16 a[80:95], v[44:47], v[28:31], a[80:95]
    ds_read_b64_tr_b16 v[80:81], v10 offset:45056
    ds_read_b64_tr_b16 v[82:83], v10 offset:46080
    v_mfma_f32_32x32x16_bf16 a[32:47], v[48:51], v[24:27], a[32:47]
    s_waitcnt lgkmcnt(10)
    ds_read_b64_tr_b16 v[84:85], v11 offset:45056
    ds_read_b64_tr_b16 v[86:87], v11 offset:46080
    v_mfma_f32_32x32x16_bf16 a[96:111], v[48:51], v[28:31], a[96:111]
    ds_read_b64_tr_b16 v[88:89], v8 offset:61440
    ds_read_b64_tr_b16 v[90:91], v8 offset:62464
    v_mfma_f32_32x32x16_bf16 a[48:63], v[52:55], v[24:27], a[48:63]
    s_waitcnt lgkmcnt(10)
    ds_read_b64_tr_b16 v[92:93], v9 offset:61440
    ds_read_b64_tr_b16 v[94:95], v9 offset:62464
    v_mfma_f32_32x32x16_bf16 a[112:127], v[52:55], v[28:31], a[112:127]
    ds_read_b64_tr_b16 v[96:97], v10 offset:61440
    ds_read_b64_tr_b16 v[98:99], v10 offset:62464
    v_mfma_f32_32x32x16_bf16 a[128:143], v[56:59], v[24:27], a[128:143]
    s_waitcnt lgkmcnt(10)
    ds_read_b64_tr_b16 v[100:101], v11 offset:61440
    ds_read_b64_tr_b16 v[102:103], v11 offset:62464
    v_mfma_f32_32x32x16_bf16 a[192:207], v[56:59], v[28:31], a[192:207]
    v_mfma_f32_32x32x16_bf16 a[144:159], v[60:63], v[24:27], a[144:159]
    v_xor_b32 v4, 0x10000, v4
    v_xor_b32 v5, 0x10000, v5
    v_mfma_f32_32x32x16_bf16 a[208:223], v[60:63], v[28:31], a[208:223]
    v_xor_b32 v6, 0x10000, v6
    v_xor_b32 v7, 0x10000, v7
    v_mfma_f32_32x32x16_bf16 a[160:175], v[64:67], v[24:27], a[160:175]
    v_xor_b32 v8, 0x10000, v8
    v_xor_b32 v9, 0x10000, v9
    v_mfma_f32_32x32x16_bf16 a[224:239], v[64:67], v[28:31], a[224:239]
    v_xor_b32 v10, 0x10000, v10
    v_xor_b32 v11, 0x10000, v11
    v_mfma_f32_32x32x16_bf16 a[176:191], v[68:71], v[24:27], a[176:191]
    v_xor_b32 v12, 0x10000, v12
    v_xor_b32 v13, 0x10000, v13
    v_mfma_f32_32x32x16_bf16 a[240:255], v[68:71], v[28:31], a[240:255]
    v_xor_b32 v14, 0x10000, v14
    v_xor_b32 v15, 0x10000, v15
    s_waitcnt vmcnt(0) lgkmcnt(0)
    s_barrier
    v_mfma_f32_32x32x16_bf16 a[0:15], v[72:75], v[32:35], a[0:15]
    ds_read_b128 v[24:27], v4 offset:0
    ds_read_b64_tr_b16 v[40:41], v8 offset:32768
    v_mfma_f32_32x32x16_bf16 a[64:79], v[72:75], v[36:39], a[64:79]
    ds_read_b64_tr_b16 v[42:43], v8 offset:33792
    ds_read_b128 v[28:31], v4 offset:4096
    s_add_u32 m0, s38, 0
    s_mov_b32 s40, s33
    buffer_load_dwordx4 v3, s[20:23], s40 offen  lds
    v_mfma_f32_32x32x16_bf16 a[16:31], v[76:79], v[32:35], a[16:31]
    ds_read_b64_tr_b16 v[44:45], v9 offset:32768
    ds_read_b64_tr_b16 v[46:47], v9 offset:33792
    v_mfma_f32_32x32x16_bf16 a[80:95], v[76:79], v[36:39], a[80:95]
    ds_read_b64_tr_b16 v[48:49], v10 offset:32768
    ds_read_b64_tr_b16 v[50:51], v10 offset:33792
    s_add_u32 m0, s38, 1024
    s_add_u32 s40, s40, s35
    buffer_load_dwordx4 v3, s[20:23], s40 offen  lds
    v_mfma_f32_32x32x16_bf16 a[32:47], v[80:83], v[32:35], a[32:47]
    ds_read_b64_tr_b16 v[52:53], v11 offset:32768
    ds_read_b64_tr_b16 v[54:55], v11 offset:33792
    v_mfma_f32_32x32x16_bf16 a[96:111], v[80:83], v[36:39], a[96:111]
    ds_read_b64_tr_b16 v[56:57], v8 offset:49152
    ds_read_b64_tr_b16 v[58:59], v8 offset:50176
    s_add_u32 m0, s38, 2048
    s_add_u32 s40, s40, s35
    buffer_load_dwordx4 v3, s[20:23], s40 offen  lds
    v_mfma_f32_32x32x16_bf16 a[48:63], v[84:87], v[32:35], a[48:63]
    ds_read_b64_tr_b16 v[60:61], v9 offset:49152
    ds_read_b64_tr_b16 v[62:63], v9 offset:50176
    v_mfma_f32_32x32x16_bf16 a[112:127], v[84:87], v[36:39], a[112:127]
    s_waitcnt lgkmcnt(10)
    ds_read_b64_tr_b16 v[64:65], v10 offset:49152
    ds_read_b64_tr_b16 v[66:67], v10 offset:50176
    s_add_u32 m0, s38, 3072
    s_add_u32 s40, s40, s35
    buffer_load_dwordx4 v3, s[20:23], s40 offen  lds
    v_mfma_f32_32x32x16_bf16 a[128:143], v[88:91], v[32:35], a[128:143]
    ds_read_b64_tr_b16 v[68:69], v11 offset:49152
    ds_read_b64_tr_b16 v[70:71], v11 offset:50176
    v_mfma_f32_32x32x16_bf16 a[192:207], v[88:91], v[36:39], a[192:207]
    s_add_u32 m0, s38, 16384
    s_mov_b32 s40, s34
    buffer_load_dwordx4 v3, s[24:27], s40 offen  lds
    v_mfma_f32_32x32x16_bf16 a[144:159], v[92:95], v[32:35], a[144:159]
    v_mfma_f32_32x32x16_bf16 a[208:223], v[92:95], v[36:39], a[208:223]
    s_add_u32 m0, s38, 17408
    s_add_u32 s40, s40, s35
    buffer_load_dwordx4 v3, s[24:27], s40 offen  lds
    v_mfma_f32_32x32x16_bf16 a[160:175], v[96:99], v[32:35], a[160:175]
    v_mfma_f32_32x32x16_bf16 a[224:239], v[96:99], v[36:39], a[224:239]
    s_add_u32 m0, s38, 18432
    s_add_u32 s40, s40, s35
    buffer_load_dwordx4 v3, s[24:27], s40 offen  lds
    v_mfma_f32_32x32x16_bf16 a[176:191], v[100:103], v[32:35], a[176:191]
    v_mfma_f32_32x32x16_bf16 a[240:255], v[100:103], v[36:39], a[240:255]
    s_add_u32 m0, s38, 19456
    s_add_u32 s40, s40, s35
    buffer_load_dwordx4 v3, s[24:27], s40 offen  lds
    s_add_u32 s33, s33, s36
    s_add_u32 s34, s34, s36
    v_mfma_f32_32x32x16_bf16 a[0:15], v[40:43], v[24:27], a[0:15]
    s_waitcnt lgkmcnt(10)
    ds_read_b128 v[32:35], v5 offset:0
    ds_read_b64_tr_b16 v[72:73], v8 offset:36864
    v_mfma_f32_32x32x16_bf16 a[64:79], v[40:43], v[28:31], a[64:79]
    ds_read_b64_tr_b16 v[74:75], v8 offset:37888
    ds_read_b128 v[36:39], v5 offset:4096
    s_add_u32 m0, s37, 0
    s_add_u32 s39, s32, 0
    buffer_load_dwordx4 v1, s[12:15], s39 offen  lds
    v_mfma_f32_32x32x16_bf16 a[16:31], v[44:47], v[24:27], a[16:31]
    s_waitcnt lgkmcnt(10)
    ds_read_b64_tr_b16 v[76:77], v9 offset:36864
    ds_read_b64_tr_b16 v[78:79], v9 offset:37888
    v_mfma_f32_32x32x16_bf16 a[80:95], v[44:47], v[28:31], a[80:95]
    ds_read_b64_tr_b16 v[80:81], v10 offset:36864
    ds_read_b64_tr_b16 v[82:83], v10 offset:37888
    s_add_u32 m0, s37, 1024
    s_add_u32 s39, s32, 10240
    buffer_load_dwordx4 v2, s[12:15], s39 offen  lds
    v_mfma_f32_32x32x16_bf16 a[32:47], v[48:51], v[24:27], a[32:47]
    s_waitcnt lgkmcnt(10)
    ds_read_b64_tr_b16 v[84:85], v11 offset:36864
    ds_read_b64_tr_b16 v[86:87], v11 offset:37888
    v_mfma_f32_32x32x16_bf16 a[96:111], v[48:51], v[28:31], a[96:111]
    ds_read_b64_tr_b16 v[88:89], v8 offset:53248
    ds_read_b64_tr_b16 v[90:91], v8 offset:54272
    s_add_u32 m0, s37, 2048
    s_add_u32 s39, s32, 20480
    buffer_load_dwordx4 v1, s[12:15], s39 offen  lds
    v_mfma_f32_32x32x16_bf16 a[48:63], v[52:55], v[24:27], a[48:63]
    s_waitcnt lgkmcnt(10)
    ds_read_b64_tr_b16 v[92:93], v9 offset:53248
    ds_read_b64_tr_b16 v[94:95], v9 offset:54272
    v_mfma_f32_32x32x16_bf16 a[112:127], v[52:55], v[28:31], a[112:127]
    ds_read_b64_tr_b16 v[96:97], v10 offset:53248
    ds_read_b64_tr_b16 v[98:99], v10 offset:54272
    s_add_u32 m0, s37, 3072
    s_add_u32 s39, s32, 30720
    buffer_load_dwordx4 v2, s[12:15], s39 offen  lds
    v_mfma_f32_32x32x16_bf16 a[128:143], v[56:59], v[24:27], a[128:143]
    s_waitcnt lgkmcnt(10)
    ds_read_b64_tr_b16 v[100:101], v11 offset:53248
    ds_read_b64_tr_b16 v[102:103], v11 offset:54272
    v_mfma_f32_32x32x16_bf16 a[192:207], v[56:59], v[28:31], a[192:207]
    s_add_u32 m0, s37, 4096
    s_add_u32 s39, s32, 40960
    buffer_load_dwordx4 v1, s[12:15], s39 offen  lds
    v_mfma_f32_32x32x16_bf16 a[144:159], v[60:63], v[24:27], a[144:159]
    v_mfma_f32_32x32x16_bf16 a[208:223], v[60:63], v[28:31], a[208:223]
    s_add_u32 m0, s37, 5120
    s_add_u32 s39, s32, 51200
    buffer_load_dwordx4 v2, s[12:15], s39 offen  lds
    v_mfma_f32_32x32x16_bf16 a[160:175], v[64:67], v[24:27], a[160:175]
    v_mfma_f32_32x32x16_bf16 a[224:239], v[64:67], v[28:31], a[224:239]
    s_add_u32 m0, s37, 6144
    s_add_u32 s39, s32, 61440
    buffer_load_dwordx4 v1, s[12:15], s39 offen  lds
    v_mfma_f32_32x32x16_bf16 a[176:191], v[68:71], v[24:27], a[176:191]
    v_mfma_f32_32x32x16_bf16 a[240:255], v[68:71], v[28:31], a[240:255]
    s_add_u32 m0, s37, 7168
    s_add_u32 s39, s32, 71680
    buffer_load_dwordx4 v2, s[12:15], s39 offen  lds
    s_add_u32 s32, s32, 128
    v_mfma_f32_32x32x16_bf16 a[0:15], v[72:75], v[32:35], a[0:15]
    ds_read_b128 v[24:27], v6 offset:0
    ds_read_b64_tr_b16 v[40:41], v8 offset:40960
    v_mfma_f32_32x32x16_bf16 a[64:79], v[72:75], v[36:39], a[64:79]
    s_waitcnt lgkmcnt(10)
    ds_read_b64_tr_b16 v[42:43], v8 offset:41984
    ds_read_b128 v[28:31], v6 offset:4096
    buffer_store_dwordx4 v[152:155], v20, s[88:91], s92 offen sc1
    s_add_u32 s92, s92, s93
    v_mfma_f32_32x32x16_bf16 a[16:31], v[76:79], v[32:35], a[16:31]
    ds_read_b64_tr_b16 v[44:45], v9 offset:40960
    ds_read_b64_tr_b16 v[46:47], v9 offset:41984
    v_mfma_f32_32x32x16_bf16 a[80:95], v[76:79], v[36:39], a[80:95]
    s_waitcnt lgkmcnt(10)
    ds_read_b64_tr_b16 v[48:49], v10 offset:40960
    ds_read_b64_tr_b16 v[50:51], v10 offset:41984
    v_mfma_f32_32x32x16_bf16 a[32:47], v[80:83], v[32:35], a[32:47]
    ds_read_b64_tr_b16 v[52:53], v11 offset:40960
    ds_read_b64_tr_b16 v[54:55], v11 offset:41984
    buffer_store_dwordx4 v[156:159], v20, s[88:91], s92 offen sc1
    s_add_u32 s92, s92, s94
    v_mfma_f32_32x32x16_bf16 a[96:111], v[80:83], v[36:39], a[96:111]
    s_waitcnt lgkmcnt(10)
    ds_read_b64_tr_b16 v[56:57], v8 offset:57344
    ds_read_b64_tr_b16 v[58:59], v8 offset:58368
    v_mfma_f32_32x32x16_bf16 a[48:63], v[84:87], v[32:35], a[48:63]
    ds_read_b64_tr_b16 v[60:61], v9 offset:57344
    ds_read_b64_tr_b16 v[62:63], v9 offset:58368
    v_mfma_f32_32x32x16_bf16 a[112:127], v[84:87], v[36:39], a[112:127]
    s_waitcnt lgkmcnt(10)
    ds_read_b64_tr_b16 v[64:65], v10 offset:57344
    ds_read_b64_tr_b16 v[66:67], v10 offset:58368
    buffer_store_dwordx4 v[160:163], v20, s[88:91], s92 offen sc1
    s_add_u32 s92, s92, s93
    v_mfma_f32_32x32x16_bf16 a[128:143], v[88:91], v[32:35], a[128:143]
    ds_read_b64_tr_b16 v[68:69], v11 offset:57344
    ds_read_b64_tr_b16 v[70:71], v11 offset:58368
    v_mfma_f32_32x32x16_bf16 a[192:207], v[88:91], v[36:39], a[192:207]
    v_mfma_f32_32x32x16_bf16 a[144:159], v[92:95], v[32:35], a[144:159]
    buffer_store_dwordx4 v[164:167], v20, s[88:91], s92 offen sc1
    s_add_u32 s92, s92, s96
    v_mfma_f32_32x32x16_bf16 a[208:223], v[92:95], v[36:39], a[208:223]
    v_mfma_f32_32x32x16_bf16 a[160:175], v[96:99], v[32:35], a[160:175]
    v_mfma_f32_32x32x16_bf16 a[224:239], v[96:99], v[36:39], a[224:239]
    v_mfma_f32_32x32x16_bf16 a[176:191], v[100:103], v[32:35], a[176:191]
    v_mfma_f32_32x32x16_bf16 a[240:255], v[100:103], v[36:39], a[240:255]
    v_mfma_f32_32x32x16_bf16 a[0:15], v[40:43], v[24:27], a[0:15]
    s_waitcnt lgkmcnt(10)
    ds_read_b128 v[32:35], v7 offset:0
    ds_read_b64_tr_b16 v[72:73], v8 offset:45056
    v_mfma_f32_32x32x16_bf16 a[64:79], v[40:43], v[28:31], a[64:79]
    ds_read_b64_tr_b16 v[74:75], v8 offset:46080
    ds_read_b128 v[36:39], v7 offset:4096
    v_mfma_f32_32x32x16_bf16 a[16:31], v[44:47], v[24:27], a[16:31]
    s_waitcnt lgkmcnt(10)
    ds_read_b64_tr_b16 v[76:77], v9 offset:45056
    ds_read_b64_tr_b16 v[78:79], v9 offset:46080
    v_mfma_f32_32x32x16_bf16 a[80:95], v[44:47], v[28:31], a[80:95]
    ds_read_b64_tr_b16 v[80:81], v10 offset:45056
    ds_read_b64_tr_b16 v[82:83], v10 offset:46080
    v_mfma_f32_32x32x16_bf16 a[32:47], v[48:51], v[24:27], a[32:47]
    s_waitcnt lgkmcnt(10)
    ds_read_b64_tr_b16 v[84:85], v11 offset:45056
    ds_read_b64_tr_b16 v[86:87], v11 offset:46080
    v_mfma_f32_32x32x16_bf16 a[96:111], v[48:51], v[28:31], a[96:111]
    ds_read_b64_tr_b16 v[88:89], v8 offset:61440
    ds_read_b64_tr_b16 v[90:91], v8 offset:62464
    v_mfma_f32_32x32x16_bf16 a[48:63], v[52:55], v[24:27], a[48:63]
    s_waitcnt lgkmcnt(10)
    ds_read_b64_tr_b16 v[92:93], v9 offset:61440
    ds_read_b64_tr_b16 v[94:95], v9 offset:62464
    v_mfma_f32_32x32x16_bf16 a[112:127], v[52:55], v[28:31], a[112:127]
    ds_read_b64_tr_b16 v[96:97], v10 offset:61440
    ds_read_b64_tr_b16 v[98:99], v10 offset:62464
    v_mfma_f32_32x32x16_bf16 a[128:143], v[56:59], v[24:27], a[128:143]
    s_waitcnt lgkmcnt(10)
    ds_read_b64_tr_b16 v[100:101], v11 offset:61440
    ds_read_b64_tr_b16 v[102:103], v11 offset:62464
    v_mfma_f32_32x32x16_bf16 a[192:207], v[56:59], v[28:31], a[192:207]
    v_mfma_f32_32x32x16_bf16 a[144:159], v[60:63], v[24:27], a[144:159]
    v_xor_b32 v4, 0x10000, v4
    v_xor_b32 v5, 0x10000, v5
    v_mfma_f32_32x32x16_bf16 a[208:223], v[60:63], v[28:31], a[208:223]
    v_xor_b32 v6, 0x10000, v6
    v_xor_b32 v7, 0x10000, v7
    v_mfma_f32_32x32x16_bf16 a[160:175], v[64:67], v[24:27], a[160:175]
    v_xor_b32 v8, 0x10000, v8
    v_xor_b32 v9, 0x10000, v9
    v_mfma_f32_32x32x16_bf16 a[224:239], v[64:67], v[28:31], a[224:239]
    v_xor_b32 v10, 0x10000, v10
    v_xor_b32 v11, 0x10000, v11
    v_mfma_f32_32x32x16_bf16 a[176:191], v[68:71], v[24:27], a[176:191]
    v_xor_b32 v12, 0x10000, v12
    v_xor_b32 v13, 0x10000, v13
    v_mfma_f32_32x32x16_bf16 a[240:255], v[68:71], v[28:31], a[240:255]
    v_xor_b32 v14, 0x10000, v14
    v_xor_b32 v15, 0x10000, v15
    s_waitcnt vmcnt(0) lgkmcnt(0)
    s_barrier
    v_mfma_f32_32x32x16_bf16 a[0:15], v[72:75], v[32:35], a[0:15]
    ds_read_b128 v[24:27], v4 offset:0
    ds_read_b64_tr_b16 v[40:41], v8 offset:32768
    v_mfma_f32_32x32x16_bf16 a[64:79], v[72:75], v[36:39], a[64:79]
    ds_read_b64_tr_b16 v[42:43], v8 offset:33792
    ds_read_b128 v[28:31], v4 offset:4096
    s_add_u32 m0, s38, 65536
    s_mov_b32 s40, s33
    buffer_load_dwordx4 v3, s[20:23], s40 offen  lds
    v_mfma_f32_32x32x16_bf16 a[16:31], v[76:79], v[32:35], a[16:31]
    ds_read_b64_tr_b16 v[44:45], v9 offset:32768
    ds_read_b64_tr_b16 v[46:47], v9 offset:33792
    v_mfma_f32_32x32x16_bf16 a[80:95], v[76:79], v[36:39], a[80:95]
    ds_read_b64_tr_b16 v[48:49], v10 offset:32768
    ds_read_b64_tr_b16 v[50:51], v10 offset:33792
    s_add_u32 m0, s38, 66560
    s_add_u32 s40, s40, s35
    buffer_load_dwordx4 v3, s[20:23], s40 offen  lds
    v_mfma_f32_32x32x16_bf16 a[32:47], v[80:83], v[32:35], a[32:47]
    ds_read_b64_tr_b16 v[52:53], v11 offset:32768
    ds_read_b64_tr_b16 v[54:55], v11 offset:33792
    v_mfma_f32_32x32x16_bf16 a[96:111], v[80:83], v[36:39], a[96:111]
    ds_read_b64_tr_b16 v[56:57], v8 offset:49152
    ds_read_b64_tr_b16 v[58:59], v8 offset:50176
    s_add_u32 m0, s38, 67584
    s_add_u32 s40, s40, s35
    buffer_load_dwordx4 v3, s[20:23], s40 offen  lds
    v_mfma_f32_32x32x16_bf16 a[48:63], v[84:87], v[32:35], a[48:63]
    ds_read_b64_tr_b16 v[60:61], v9 offset:49152
    ds_read_b64_tr_b16 v[62:63], v9 offset:50176
    v_mfma_f32_32x32x16_bf16 a[112:127], v[84:87], v[36:39], a[112:127]
    s_waitcnt lgkmcnt(10)
    ds_read_b64_tr_b16 v[64:65], v10 offset:49152
    ds_read_b64_tr_b16 v[66:67], v10 offset:50176
    s_add_u32 m0, s38, 68608
    s_add_u32 s40, s40, s35
    buffer_load_dwordx4 v3, s[20:23], s40 offen  lds
    v_mfma_f32_32x32x16_bf16 a[128:143], v[88:91], v[32:35], a[128:143]
    ds_read_b64_tr_b16 v[68:69], v11 offset:49152
    ds_read_b64_tr_b16 v[70:71], v11 offset:50176
    v_mfma_f32_32x32x16_bf16 a[192:207], v[88:91], v[36:39], a[192:207]
    s_add_u32 m0, s38, 81920
    s_mov_b32 s40, s34
    buffer_load_dwordx4 v3, s[24:27], s40 offen  lds
    v_mfma_f32_32x32x16_bf16 a[144:159], v[92:95], v[32:35], a[144:159]
    v_mfma_f32_32x32x16_bf16 a[208:223], v[92:95], v[36:39], a[208:223]
    s_add_u32 m0, s38, 82944
    s_add_u32 s40, s40, s35
    buffer_load_dwordx4 v3, s[24:27], s40 offen  lds
    v_mfma_f32_32x32x16_bf16 a[160:175], v[96:99], v[32:35], a[160:175]
    v_mfma_f32_32x32x16_bf16 a[224:239], v[96:99], v[36:39], a[224:239]
    s_add_u32 m0, s38, 83968
    s_add_u32 s40, s40, s35
    buffer_load_dwordx4 v3, s[24:27], s40 offen  lds
    v_mfma_f32_32x32x16_bf16 a[176:191], v[100:103], v[32:35], a[176:191]
    v_mfma_f32_32x32x16_bf16 a[240:255], v[100:103], v[36:39], a[240:255]
    s_add_u32 m0, s38, 84992
    s_add_u32 s40, s40, s35
    buffer_load_dwordx4 v3, s[24:27], s40 offen  lds
    s_add_u32 s33, s33, s36
    s_add_u32 s34, s34, s36
    v_mfma_f32_32x32x16_bf16 a[0:15], v[40:43], v[24:27], a[0:15]
    s_waitcnt lgkmcnt(10)
    ds_read_b128 v[32:35], v5 offset:0
    ds_read_b64_tr_b16 v[72:73], v8 offset:36864
    v_mfma_f32_32x32x16_bf16 a[64:79], v[40:43], v[28:31], a[64:79]
    ds_read_b64_tr_b16 v[74:75], v8 offset:37888
    ds_read_b128 v[36:39], v5 offset:4096
    s_add_u32 m0, s37, 65536
    s_add_u32 s39, s32, 0
    buffer_load_dwordx4 v1, s[12:15], s39 offen  lds
    v_mfma_f32_32x32x16_bf16 a[16:31], v[44:47], v[24:27], a[16:31]
    s_waitcnt lgkmcnt(10)
    ds_read_b64_tr_b16 v[76:77], v9 offset:36864
    ds_read_b64_tr_b16 v[78:79], v9 offset:37888
    v_mfma_f32_32x32x16_bf16 a[80:95], v[44:47], v[28:31], a[80:95]
    ds_read_b64_tr_b16 v[80:81], v10 offset:36864
    ds_read_b64_tr_b16 v[82:83], v10 offset:37888
    s_add_u32 m0, s37, 66560
    s_add_u32 s39, s32, 10240
    buffer_load_dwordx4 v2, s[12:15], s39 offen  lds
    v_mfma_f32_32x32x16_bf16 a[32:47], v[48:51], v[24:27], a[32:47]
    s_waitcnt lgkmcnt(10)
    ds_read_b64_tr_b16 v[84:85], v11 offset:36864
    ds_read_b64_tr_b16 v[86:87], v11 offset:37888
    v_mfma_f32_32x32x16_bf16 a[96:111], v[48:51], v[28:31], a[96:111]
    ds_read_b64_tr_b16 v[88:89], v8 offset:53248
    ds_read_b64_tr_b16 v[90:91], v8 offset:54272
    s_add_u32 m0, s37, 67584
    s_add_u32 s39, s32, 20480
    buffer_load_dwordx4 v1, s[12:15], s39 offen  lds
    v_mfma_f32_32x32x16_bf16 a[48:63], v[52:55], v[24:27], a[48:63]
    s_waitcnt lgkmcnt(10)
    ds_read_b64_tr_b16 v[92:93], v9 offset:53248
    ds_read_b64_tr_b16 v[94:95], v9 offset:54272
    v_mfma_f32_32x32x16_bf16 a[112:127], v[52:55], v[28:31], a[112:127]
    ds_read_b64_tr_b16 v[96:97], v10 offset:53248
    ds_read_b64_tr_b16 v[98:99], v10 offset:54272
    s_add_u32 m0, s37, 68608
    s_add_u32 s39, s32, 30720
    buffer_load_dwordx4 v2, s[12:15], s39 offen  lds
    v_mfma_f32_32x32x16_bf16 a[128:143], v[56:59], v[24:27], a[128:143]
    s_waitcnt lgkmcnt(10)
    ds_read_b64_tr_b16 v[100:101], v11 offset:53248
    ds_read_b64_tr_b16 v[102:103], v11 offset:54272
    v_mfma_f32_32x32x16_bf16 a[192:207], v[56:59], v[28:31], a[192:207]
    s_add_u32 m0, s37, 69632
    s_add_u32 s39, s32, 40960
    buffer_load_dwordx4 v1, s[12:15], s39 offen  lds
    v_mfma_f32_32x32x16_bf16 a[144:159], v[60:63], v[24:27], a[144:159]
    v_mfma_f32_32x32x16_bf16 a[208:223], v[60:63], v[28:31], a[208:223]
    s_add_u32 m0, s37, 70656
    s_add_u32 s39, s32, 51200
    buffer_load_dwordx4 v2, s[12:15], s39 offen  lds
    v_mfma_f32_32x32x16_bf16 a[160:175], v[64:67], v[24:27], a[160:175]
    v_mfma_f32_32x32x16_bf16 a[224:239], v[64:67], v[28:31], a[224:239]
    s_add_u32 m0, s37, 71680
    s_add_u32 s39, s32, 61440
    buffer_load_dwordx4 v1, s[12:15], s39 offen  lds
    v_mfma_f32_32x32x16_bf16 a[176:191], v[68:71], v[24:27], a[176:191]
    v_mfma_f32_32x32x16_bf16 a[240:255], v[68:71], v[28:31], a[240:255]
    s_add_u32 m0, s37, 72704
    s_add_u32 s39, s32, 71680
    buffer_load_dwordx4 v2, s[12:15], s39 offen  lds
    s_add_u32 s32, s32, 128
    v_mfma_f32_32x32x16_bf16 a[0:15], v[72:75], v[32:35], a[0:15]
    ds_read_b128 v[24:27], v6 offset:0
    ds_read_b64_tr_b16 v[40:41], v8 offset:40960
    v_mfma_f32_32x32x16_bf16 a[64:79], v[72:75], v[36:39], a[64:79]
    s_waitcnt lgkmcnt(10)
    ds_read_b64_tr_b16 v[42:43], v8 offset:41984
    ds_read_b128 v[28:31], v6 offset:4096
    buffer_store_dwordx4 v[168:171], v21, s[88:91], s92 offen sc1
    s_add_u32 s92, s92, s93
    v_mfma_f32_32x32x16_bf16 a[16:31], v[76:79], v[32:35], a[16:31]
    ds_read_b64_tr_b16 v[44:45], v9 offset:40960
    ds_read_b64_tr_b16 v[46:47], v9 offset:41984
    v_mfma_f32_32x32x16_bf16 a[80:95], v[76:79], v[36:39], a[80:95]
    s_waitcnt lgkmcnt(10)
    ds_read_b64_tr_b16 v[48:49], v10 offset:40960
    ds_read_b64_tr_b16 v[50:51], v10 offset:41984
    v_mfma_f32_32x32x16_bf16 a[32:47], v[80:83], v[32:35], a[32:47]
    ds_read_b64_tr_b16 v[52:53], v11 offset:40960
    ds_read_b64_tr_b16 v[54:55], v11 offset:41984
    buffer_store_dwordx4 v[172:175], v21, s[88:91], s92 offen sc1
    s_add_u32 s92, s92, s94
    v_mfma_f32_32x32x16_bf16 a[96:111], v[80:83], v[36:39], a[96:111]
    s_waitcnt lgkmcnt(10)
    ds_read_b64_tr_b16 v[56:57], v8 offset:57344
    ds_read_b64_tr_b16 v[58:59], v8 offset:58368
    v_mfma_f32_32x32x16_bf16 a[48:63], v[84:87], v[32:35], a[48:63]
    ds_read_b64_tr_b16 v[60:61], v9 offset:57344
    ds_read_b64_tr_b16 v[62:63], v9 offset:58368
    v_mfma_f32_32x32x16_bf16 a[112:127], v[84:87], v[36:39], a[112:127]
    s_waitcnt lgkmcnt(10)
    ds_read_b64_tr_b16 v[64:65], v10 offset:57344
    ds_read_b64_tr_b16 v[66:67], v10 offset:58368
    buffer_store_dwordx4 v[176:179], v21, s[88:91], s92 offen sc1
    s_add_u32 s92, s92, s93
    v_mfma_f32_32x32x16_bf16 a[128:143], v[88:91], v[32:35], a[128:143]
    ds_read_b64_tr_b16 v[68:69], v11 offset:57344
    ds_read_b64_tr_b16 v[70:71], v11 offset:58368
    v_mfma_f32_32x32x16_bf16 a[192:207], v[88:91], v[36:39], a[192:207]
    v_mfma_f32_32x32x16_bf16 a[144:159], v[92:95], v[32:35], a[144:159]
    buffer_store_dwordx4 v[180:183], v21, s[88:91], s92 offen sc1
    s_add_u32 s92, s92, s94
    v_mfma_f32_32x32x16_bf16 a[208:223], v[92:95], v[36:39], a[208:223]
    v_mfma_f32_32x32x16_bf16 a[160:175], v[96:99], v[32:35], a[160:175]
    v_mfma_f32_32x32x16_bf16 a[224:239], v[96:99], v[36:39], a[224:239]
    v_mfma_f32_32x32x16_bf16 a[176:191], v[100:103], v[32:35], a[176:191]
    v_mfma_f32_32x32x16_bf16 a[240:255], v[100:103], v[36:39], a[240:255]
    v_mfma_f32_32x32x16_bf16 a[0:15], v[40:43], v[24:27], a[0:15]
    s_waitcnt lgkmcnt(10)
    ds_read_b128 v[32:35], v7 offset:0
    ds_read_b64_tr_b16 v[72:73], v8 offset:45056
    v_mfma_f32_32x32x16_bf16 a[64:79], v[40:43], v[28:31], a[64:79]
    ds_read_b64_tr_b16 v[74:75], v8 offset:46080
    ds_read_b128 v[36:39], v7 offset:4096
    v_mfma_f32_32x32x16_bf16 a[16:31], v[44:47], v[24:27], a[16:31]
    s_waitcnt lgkmcnt(10)
    ds_read_b64_tr_b16 v[76:77], v9 offset:45056
    ds_read_b64_tr_b16 v[78:79], v9 offset:46080
    v_mfma_f32_32x32x16_bf16 a[80:95], v[44:47], v[28:31], a[80:95]
    ds_read_b64_tr_b16 v[80:81], v10 offset:45056
    ds_read_b64_tr_b16 v[82:83], v10 offset:46080
    v_mfma_f32_32x32x16_bf16 a[32:47], v[48:51], v[24:27], a[32:47]
    s_waitcnt lgkmcnt(10)
    ds_read_b64_tr_b16 v[84:85], v11 offset:45056
    ds_read_b64_tr_b16 v[86:87], v11 offset:46080
    v_mfma_f32_32x32x16_bf16 a[96:111], v[48:51], v[28:31], a[96:111]
    ds_read_b64_tr_b16 v[88:89], v8 offset:61440
    ds_read_b64_tr_b16 v[90:91], v8 offset:62464
    v_mfma_f32_32x32x16_bf16 a[48:63], v[52:55], v[24:27], a[48:63]
    s_waitcnt lgkmcnt(10)
    ds_read_b64_tr_b16 v[92:93], v9 offset:61440
    ds_read_b64_tr_b16 v[94:95], v9 offset:62464
    v_mfma_f32_32x32x16_bf16 a[112:127], v[52:55], v[28:31], a[112:127]
    ds_read_b64_tr_b16 v[96:97], v10 offset:61440
    ds_read_b64_tr_b16 v[98:99], v10 offset:62464
    v_mfma_f32_32x32x16_bf16 a[128:143], v[56:59], v[24:27], a[128:143]
    s_waitcnt lgkmcnt(10)
    ds_read_b64_tr_b16 v[100:101], v11 offset:61440
    ds_read_b64_tr_b16 v[102:103], v11 offset:62464
    v_mfma_f32_32x32x16_bf16 a[192:207], v[56:59], v[28:31], a[192:207]
    v_mfma_f32_32x32x16_bf16 a[144:159], v[60:63], v[24:27], a[144:159]
    v_xor_b32 v4, 0x10000, v4
    v_xor_b32 v5, 0x10000, v5
    v_mfma_f32_32x32x16_bf16 a[208:223], v[60:63], v[28:31], a[208:223]
    v_xor_b32 v6, 0x10000, v6
    v_xor_b32 v7, 0x10000, v7
    v_mfma_f32_32x32x16_bf16 a[160:175], v[64:67], v[24:27], a[160:175]
    v_xor_b32 v8, 0x10000, v8
    v_xor_b32 v9, 0x10000, v9
    v_mfma_f32_32x32x16_bf16 a[224:239], v[64:67], v[28:31], a[224:239]
    v_xor_b32 v10, 0x10000, v10
    v_xor_b32 v11, 0x10000, v11
    v_mfma_f32_32x32x16_bf16 a[176:191], v[68:71], v[24:27], a[176:191]
    v_xor_b32 v12, 0x10000, v12
    v_xor_b32 v13, 0x10000, v13
    v_mfma_f32_32x32x16_bf16 a[240:255], v[68:71], v[28:31], a[240:255]
    v_xor_b32 v14, 0x10000, v14
    v_xor_b32 v15, 0x10000, v15
    s_waitcnt vmcnt(0) lgkmcnt(0)
    s_barrier
    v_mfma_f32_32x32x16_bf16 a[0:15], v[72:75], v[32:35], a[0:15]
    ds_read_b128 v[24:27], v4 offset:0
    ds_read_b64_tr_b16 v[40:41], v8 offset:32768
    v_mfma_f32_32x32x16_bf16 a[64:79], v[72:75], v[36:39], a[64:79]
    ds_read_b64_tr_b16 v[42:43], v8 offset:33792
    ds_read_b128 v[28:31], v4 offset:4096
    s_add_u32 m0, s38, 0
    s_mov_b32 s40, s33
    buffer_load_dwordx4 v3, s[20:23], s40 offen  lds
    v_mfma_f32_32x32x16_bf16 a[16:31], v[76:79], v[32:35], a[16:31]
    ds_read_b64_tr_b16 v[44:45], v9 offset:32768
    ds_read_b64_tr_b16 v[46:47], v9 offset:33792
    v_mfma_f32_32x32x16_bf16 a[80:95], v[76:79], v[36:39], a[80:95]
    ds_read_b64_tr_b16 v[48:49], v10 offset:32768
    ds_read_b64_tr_b16 v[50:51], v10 offset:33792
    s_add_u32 m0, s38, 1024
    s_add_u32 s40, s40, s35
    buffer_load_dwordx4 v3, s[20:23], s40 offen  lds
    v_mfma_f32_32x32x16_bf16 a[32:47], v[80:83], v[32:35], a[32:47]
    ds_read_b64_tr_b16 v[52:53], v11 offset:32768
    ds_read_b64_tr_b16 v[54:55], v11 offset:33792
    v_mfma_f32_32x32x16_bf16 a[96:111], v[80:83], v[36:39], a[96:111]
    ds_read_b64_tr_b16 v[56:57], v8 offset:49152
    ds_read_b64_tr_b16 v[58:59], v8 offset:50176
    s_add_u32 m0, s38, 2048
    s_add_u32 s40, s40, s35
    buffer_load_dwordx4 v3, s[20:23], s40 offen  lds
    v_mfma_f32_32x32x16_bf16 a[48:63], v[84:87], v[32:35], a[48:63]
    ds_read_b64_tr_b16 v[60:61], v9 offset:49152
    ds_read_b64_tr_b16 v[62:63], v9 offset:50176
    v_mfma_f32_32x32x16_bf16 a[112:127], v[84:87], v[36:39], a[112:127]
    s_waitcnt lgkmcnt(10)
    ds_read_b64_tr_b16 v[64:65], v10 offset:49152
    ds_read_b64_tr_b16 v[66:67], v10 offset:50176
    s_add_u32 m0, s38, 3072
    s_add_u32 s40, s40, s35
    buffer_load_dwordx4 v3, s[20:23], s40 offen  lds
    v_mfma_f32_32x32x16_bf16 a[128:143], v[88:91], v[32:35], a[128:143]
    ds_read_b64_tr_b16 v[68:69], v11 offset:49152
    ds_read_b64_tr_b16 v[70:71], v11 offset:50176
    v_mfma_f32_32x32x16_bf16 a[192:207], v[88:91], v[36:39], a[192:207]
    s_add_u32 m0, s38, 16384
    s_mov_b32 s40, s34
    buffer_load_dwordx4 v3, s[24:27], s40 offen  lds
    v_mfma_f32_32x32x16_bf16 a[144:159], v[92:95], v[32:35], a[144:159]
    v_mfma_f32_32x32x16_bf16 a[208:223], v[92:95], v[36:39], a[208:223]
    s_add_u32 m0, s38, 17408
    s_add_u32 s40, s40, s35
    buffer_load_dwordx4 v3, s[24:27], s40 offen  lds
    v_mfma_f32_32x32x16_bf16 a[160:175], v[96:99], v[32:35], a[160:175]
    v_mfma_f32_32x32x16_bf16 a[224:239], v[96:99], v[36:39], a[224:239]
    s_add_u32 m0, s38, 18432
    s_add_u32 s40, s40, s35
    buffer_load_dwordx4 v3, s[24:27], s40 offen  lds
    v_mfma_f32_32x32x16_bf16 a[176:191], v[100:103], v[32:35], a[176:191]
    v_mfma_f32_32x32x16_bf16 a[240:255], v[100:103], v[36:39], a[240:255]
    s_add_u32 m0, s38, 19456
    s_add_u32 s40, s40, s35
    buffer_load_dwordx4 v3, s[24:27], s40 offen  lds
    s_add_u32 s33, s33, s36
    s_add_u32 s34, s34, s36
    v_mfma_f32_32x32x16_bf16 a[0:15], v[40:43], v[24:27], a[0:15]
    s_waitcnt lgkmcnt(10)
    ds_read_b128 v[32:35], v5 offset:0
    ds_read_b64_tr_b16 v[72:73], v8 offset:36864
    v_mfma_f32_32x32x16_bf16 a[64:79], v[40:43], v[28:31], a[64:79]
    ds_read_b64_tr_b16 v[74:75], v8 offset:37888
    ds_read_b128 v[36:39], v5 offset:4096
    s_add_u32 m0, s37, 0
    s_add_u32 s39, s32, 0
    buffer_load_dwordx4 v1, s[12:15], s39 offen  lds
    v_mfma_f32_32x32x16_bf16 a[16:31], v[44:47], v[24:27], a[16:31]
    s_waitcnt lgkmcnt(10)
    ds_read_b64_tr_b16 v[76:77], v9 offset:36864
    ds_read_b64_tr_b16 v[78:79], v9 offset:37888
    v_mfma_f32_32x32x16_bf16 a[80:95], v[44:47], v[28:31], a[80:95]
    ds_read_b64_tr_b16 v[80:81], v10 offset:36864
    ds_read_b64_tr_b16 v[82:83], v10 offset:37888
    s_add_u32 m0, s37, 1024
    s_add_u32 s39, s32, 10240
    buffer_load_dwordx4 v2, s[12:15], s39 offen  lds
    v_mfma_f32_32x32x16_bf16 a[32:47], v[48:51], v[24:27], a[32:47]
    s_waitcnt lgkmcnt(10)
    ds_read_b64_tr_b16 v[84:85], v11 offset:36864
    ds_read_b64_tr_b16 v[86:87], v11 offset:37888
    v_mfma_f32_32x32x16_bf16 a[96:111], v[48:51], v[28:31], a[96:111]
    ds_read_b64_tr_b16 v[88:89], v8 offset:53248
    ds_read_b64_tr_b16 v[90:91], v8 offset:54272
    s_add_u32 m0, s37, 2048
    s_add_u32 s39, s32, 20480
    buffer_load_dwordx4 v1, s[12:15], s39 offen  lds
    v_mfma_f32_32x32x16_bf16 a[48:63], v[52:55], v[24:27], a[48:63]
    s_waitcnt lgkmcnt(10)
    ds_read_b64_tr_b16 v[92:93], v9 offset:53248
    ds_read_b64_tr_b16 v[94:95], v9 offset:54272
    v_mfma_f32_32x32x16_bf16 a[112:127], v[52:55], v[28:31], a[112:127]
    ds_read_b64_tr_b16 v[96:97], v10 offset:53248
    ds_read_b64_tr_b16 v[98:99], v10 offset:54272
    s_add_u32 m0, s37, 3072
    s_add_u32 s39, s32, 30720
    buffer_load_dwordx4 v2, s[12:15], s39 offen  lds
    v_mfma_f32_32x32x16_bf16 a[128:143], v[56:59], v[24:27], a[128:143]
    s_waitcnt lgkmcnt(10)
    ds_read_b64_tr_b16 v[100:101], v11 offset:53248
    ds_read_b64_tr_b16 v[102:103], v11 offset:54272
    v_mfma_f32_32x32x16_bf16 a[192:207], v[56:59], v[28:31], a[192:207]
    s_add_u32 m0, s37, 4096
    s_add_u32 s39, s32, 40960
    buffer_load_dwordx4 v1, s[12:15], s39 offen  lds
    v_mfma_f32_32x32x16_bf16 a[144:159], v[60:63], v[24:27], a[144:159]
    v_mfma_f32_32x32x16_bf16 a[208:223], v[60:63], v[28:31], a[208:223]
    s_add_u32 m0, s37, 5120
    s_add_u32 s39, s32, 51200
    buffer_load_dwordx4 v2, s[12:15], s39 offen  lds
    v_mfma_f32_32x32x16_bf16 a[160:175], v[64:67], v[24:27], a[160:175]
    v_mfma_f32_32x32x16_bf16 a[224:239], v[64:67], v[28:31], a[224:239]
    s_add_u32 m0, s37, 6144
    s_add_u32 s39, s32, 61440
    buffer_load_dwordx4 v1, s[12:15], s39 offen  lds
    v_mfma_f32_32x32x16_bf16 a[176:191], v[68:71], v[24:27], a[176:191]
    v_mfma_f32_32x32x16_bf16 a[240:255], v[68:71], v[28:31], a[240:255]
    s_add_u32 m0, s37, 7168
    s_add_u32 s39, s32, 71680
    buffer_load_dwordx4 v2, s[12:15], s39 offen  lds
    s_add_u32 s32, s32, 128
    v_mfma_f32_32x32x16_bf16 a[0:15], v[72:75], v[32:35], a[0:15]
    ds_read_b128 v[24:27], v6 offset:0
    ds_read_b64_tr_b16 v[40:41], v8 offset:40960
    v_mfma_f32_32x32x16_bf16 a[64:79], v[72:75], v[36:39], a[64:79]
    s_waitcnt lgkmcnt(10)
    ds_read_b64_tr_b16 v[42:43], v8 offset:41984
    ds_read_b128 v[28:31], v6 offset:4096
    buffer_store_dwordx4 v[184:187], v21, s[88:91], s92 offen sc1
    s_add_u32 s92, s92, s93
    v_mfma_f32_32x32x16_bf16 a[16:31], v[76:79], v[32:35], a[16:31]
    ds_read_b64_tr_b16 v[44:45], v9 offset:40960
    ds_read_b64_tr_b16 v[46:47], v9 offset:41984
    v_mfma_f32_32x32x16_bf16 a[80:95], v[76:79], v[36:39], a[80:95]
    s_waitcnt lgkmcnt(10)
    ds_read_b64_tr_b16 v[48:49], v10 offset:40960
    ds_read_b64_tr_b16 v[50:51], v10 offset:41984
    v_mfma_f32_32x32x16_bf16 a[32:47], v[80:83], v[32:35], a[32:47]
    ds_read_b64_tr_b16 v[52:53], v11 offset:40960
    ds_read_b64_tr_b16 v[54:55], v11 offset:41984
    buffer_store_dwordx4 v[188:191], v21, s[88:91], s92 offen sc1
    s_add_u32 s92, s92, s94
    v_mfma_f32_32x32x16_bf16 a[96:111], v[80:83], v[36:39], a[96:111]
    s_waitcnt lgkmcnt(10)
    ds_read_b64_tr_b16 v[56:57], v8 offset:57344
    ds_read_b64_tr_b16 v[58:59], v8 offset:58368
    v_mfma_f32_32x32x16_bf16 a[48:63], v[84:87], v[32:35], a[48:63]
    ds_read_b64_tr_b16 v[60:61], v9 offset:57344
    ds_read_b64_tr_b16 v[62:63], v9 offset:58368
    v_mfma_f32_32x32x16_bf16 a[112:127], v[84:87], v[36:39], a[112:127]
    s_waitcnt lgkmcnt(10)
    ds_read_b64_tr_b16 v[64:65], v10 offset:57344
    ds_read_b64_tr_b16 v[66:67], v10 offset:58368
    buffer_store_dwordx4 v[192:195], v21, s[88:91], s92 offen sc1
    s_add_u32 s92, s92, s93
    v_mfma_f32_32x32x16_bf16 a[128:143], v[88:91], v[32:35], a[128:143]
    ds_read_b64_tr_b16 v[68:69], v11 offset:57344
    ds_read_b64_tr_b16 v[70:71], v11 offset:58368
    v_mfma_f32_32x32x16_bf16 a[192:207], v[88:91], v[36:39], a[192:207]
    v_mfma_f32_32x32x16_bf16 a[144:159], v[92:95], v[32:35], a[144:159]
    buffer_store_dwordx4 v[196:199], v21, s[88:91], s92 offen sc1
    s_add_u32 s92, s92, s95
    v_mfma_f32_32x32x16_bf16 a[208:223], v[92:95], v[36:39], a[208:223]
    v_mfma_f32_32x32x16_bf16 a[160:175], v[96:99], v[32:35], a[160:175]
    v_mfma_f32_32x32x16_bf16 a[224:239], v[96:99], v[36:39], a[224:239]
    v_mfma_f32_32x32x16_bf16 a[176:191], v[100:103], v[32:35], a[176:191]
    v_mfma_f32_32x32x16_bf16 a[240:255], v[100:103], v[36:39], a[240:255]
    v_mfma_f32_32x32x16_bf16 a[0:15], v[40:43], v[24:27], a[0:15]
    s_waitcnt lgkmcnt(10)
    ds_read_b128 v[32:35], v7 offset:0
    ds_read_b64_tr_b16 v[72:73], v8 offset:45056
    v_mfma_f32_32x32x16_bf16 a[64:79], v[40:43], v[28:31], a[64:79]
    ds_read_b64_tr_b16 v[74:75], v8 offset:46080
    ds_read_b128 v[36:39], v7 offset:4096
    v_mfma_f32_32x32x16_bf16 a[16:31], v[44:47], v[24:27], a[16:31]
    s_waitcnt lgkmcnt(10)
    ds_read_b64_tr_b16 v[76:77], v9 offset:45056
    ds_read_b64_tr_b16 v[78:79], v9 offset:46080
    v_mfma_f32_32x32x16_bf16 a[80:95], v[44:47], v[28:31], a[80:95]
    ds_read_b64_tr_b16 v[80:81], v10 offset:45056
    ds_read_b64_tr_b16 v[82:83], v10 offset:46080
    v_mfma_f32_32x32x16_bf16 a[32:47], v[48:51], v[24:27], a[32:47]
    s_waitcnt lgkmcnt(10)
    ds_read_b64_tr_b16 v[84:85], v11 offset:45056
    ds_read_b64_tr_b16 v[86:87], v11 offset:46080
    v_mfma_f32_32x32x16_bf16 a[96:111], v[48:51], v[28:31], a[96:111]
    ds_read_b64_tr_b16 v[88:89], v8 offset:61440
    ds_read_b64_tr_b16 v[90:91], v8 offset:62464
    v_mfma_f32_32x32x16_bf16 a[48:63], v[52:55], v[24:27], a[48:63]
    s_waitcnt lgkmcnt(10)
    ds_read_b64_tr_b16 v[92:93], v9 offset:61440
    ds_read_b64_tr_b16 v[94:95], v9 offset:62464
    v_mfma_f32_32x32x16_bf16 a[112:127], v[52:55], v[28:31], a[112:127]
    ds_read_b64_tr_b16 v[96:97], v10 offset:61440
    ds_read_b64_tr_b16 v[98:99], v10 offset:62464
    v_mfma_f32_32x32x16_bf16 a[128:143], v[56:59], v[24:27], a[128:143]
    s_waitcnt lgkmcnt(10)
    ds_read_b64_tr_b16 v[100:101], v11 offset:61440
    ds_read_b64_tr_b16 v[102:103], v11 offset:62464
    v_mfma_f32_32x32x16_bf16 a[192:207], v[56:59], v[28:31], a[192:207]
    v_mfma_f32_32x32x16_bf16 a[144:159], v[60:63], v[24:27], a[144:159]
    v_xor_b32 v4, 0x10000, v4
    v_xor_b32 v5, 0x10000, v5
    v_mfma_f32_32x32x16_bf16 a[208:223], v[60:63], v[28:31], a[208:223]
    v_xor_b32 v6, 0x10000, v6
    v_xor_b32 v7, 0x10000, v7
    v_mfma_f32_32x32x16_bf16 a[160:175], v[64:67], v[24:27], a[160:175]
    v_xor_b32 v8, 0x10000, v8
    v_xor_b32 v9, 0x10000, v9
    v_mfma_f32_32x32x16_bf16 a[224:239], v[64:67], v[28:31], a[224:239]
    v_xor_b32 v10, 0x10000, v10
    v_xor_b32 v11, 0x10000, v11
    v_mfma_f32_32x32x16_bf16 a[176:191], v[68:71], v[24:27], a[176:191]
    v_xor_b32 v12, 0x10000, v12
    v_xor_b32 v13, 0x10000, v13
    v_mfma_f32_32x32x16_bf16 a[240:255], v[68:71], v[28:31], a[240:255]
    v_xor_b32 v14, 0x10000, v14
    v_xor_b32 v15, 0x10000, v15
    s_waitcnt vmcnt(0) lgkmcnt(0)
    s_barrier
    v_mfma_f32_32x32x16_bf16 a[0:15], v[72:75], v[32:35], a[0:15]
    ds_read_b128 v[24:27], v4 offset:0
    ds_read_b64_tr_b16 v[40:41], v8 offset:32768
    v_mfma_f32_32x32x16_bf16 a[64:79], v[72:75], v[36:39], a[64:79]
    ds_read_b64_tr_b16 v[42:43], v8 offset:33792
    ds_read_b128 v[28:31], v4 offset:4096
    s_add_u32 m0, s38, 65536
    s_mov_b32 s40, s33
    buffer_load_dwordx4 v3, s[20:23], s40 offen  lds
    v_mfma_f32_32x32x16_bf16 a[16:31], v[76:79], v[32:35], a[16:31]
    ds_read_b64_tr_b16 v[44:45], v9 offset:32768
    ds_read_b64_tr_b16 v[46:47], v9 offset:33792
    v_mfma_f32_32x32x16_bf16 a[80:95], v[76:79], v[36:39], a[80:95]
    ds_read_b64_tr_b16 v[48:49], v10 offset:32768
    ds_read_b64_tr_b16 v[50:51], v10 offset:33792
    s_add_u32 m0, s38, 66560
    s_add_u32 s40, s40, s35
    buffer_load_dwordx4 v3, s[20:23], s40 offen  lds
    v_mfma_f32_32x32x16_bf16 a[32:47], v[80:83], v[32:35], a[32:47]
    ds_read_b64_tr_b16 v[52:53], v11 offset:32768
    ds_read_b64_tr_b16 v[54:55], v11 offset:33792
    v_mfma_f32_32x32x16_bf16 a[96:111], v[80:83], v[36:39], a[96:111]
    ds_read_b64_tr_b16 v[56:57], v8 offset:49152
    ds_read_b64_tr_b16 v[58:59], v8 offset:50176
    s_add_u32 m0, s38, 67584
    s_add_u32 s40, s40, s35
    buffer_load_dwordx4 v3, s[20:23], s40 offen  lds
    v_mfma_f32_32x32x16_bf16 a[48:63], v[84:87], v[32:35], a[48:63]
    ds_read_b64_tr_b16 v[60:61], v9 offset:49152
    ds_read_b64_tr_b16 v[62:63], v9 offset:50176
    v_mfma_f32_32x32x16_bf16 a[112:127], v[84:87], v[36:39], a[112:127]
    s_waitcnt lgkmcnt(10)
    ds_read_b64_tr_b16 v[64:65], v10 offset:49152
    ds_read_b64_tr_b16 v[66:67], v10 offset:50176
    s_add_u32 m0, s38, 68608
    s_add_u32 s40, s40, s35
    buffer_load_dwordx4 v3, s[20:23], s40 offen  lds
    v_mfma_f32_32x32x16_bf16 a[128:143], v[88:91], v[32:35], a[128:143]
    ds_read_b64_tr_b16 v[68:69], v11 offset:49152
    ds_read_b64_tr_b16 v[70:71], v11 offset:50176
    v_mfma_f32_32x32x16_bf16 a[192:207], v[88:91], v[36:39], a[192:207]
    s_add_u32 m0, s38, 81920
    s_mov_b32 s40, s34
    buffer_load_dwordx4 v3, s[24:27], s40 offen  lds
    v_mfma_f32_32x32x16_bf16 a[144:159], v[92:95], v[32:35], a[144:159]
    v_mfma_f32_32x32x16_bf16 a[208:223], v[92:95], v[36:39], a[208:223]
    s_add_u32 m0, s38, 82944
    s_add_u32 s40, s40, s35
    buffer_load_dwordx4 v3, s[24:27], s40 offen  lds
    v_mfma_f32_32x32x16_bf16 a[160:175], v[96:99], v[32:35], a[160:175]
    v_mfma_f32_32x32x16_bf16 a[224:239], v[96:99], v[36:39], a[224:239]
    s_add_u32 m0, s38, 83968
    s_add_u32 s40, s40, s35
    buffer_load_dwordx4 v3, s[24:27], s40 offen  lds
    v_mfma_f32_32x32x16_bf16 a[176:191], v[100:103], v[32:35], a[176:191]
    v_mfma_f32_32x32x16_bf16 a[240:255], v[100:103], v[36:39], a[240:255]
    s_add_u32 m0, s38, 84992
    s_add_u32 s40, s40, s35
    buffer_load_dwordx4 v3, s[24:27], s40 offen  lds
    s_add_u32 s33, s33, s36
    s_add_u32 s34, s34, s36
    v_mfma_f32_32x32x16_bf16 a[0:15], v[40:43], v[24:27], a[0:15]
    s_waitcnt lgkmcnt(10)
    ds_read_b128 v[32:35], v5 offset:0
    ds_read_b64_tr_b16 v[72:73], v8 offset:36864
    v_mfma_f32_32x32x16_bf16 a[64:79], v[40:43], v[28:31], a[64:79]
    ds_read_b64_tr_b16 v[74:75], v8 offset:37888
    ds_read_b128 v[36:39], v5 offset:4096
    s_add_u32 m0, s37, 65536
    s_add_u32 s39, s32, 0
    buffer_load_dwordx4 v1, s[12:15], s39 offen  lds
    v_mfma_f32_32x32x16_bf16 a[16:31], v[44:47], v[24:27], a[16:31]
    s_waitcnt lgkmcnt(10)
    ds_read_b64_tr_b16 v[76:77], v9 offset:36864
    ds_read_b64_tr_b16 v[78:79], v9 offset:37888
    v_mfma_f32_32x32x16_bf16 a[80:95], v[44:47], v[28:31], a[80:95]
    ds_read_b64_tr_b16 v[80:81], v10 offset:36864
    ds_read_b64_tr_b16 v[82:83], v10 offset:37888
    s_add_u32 m0, s37, 66560
    s_add_u32 s39, s32, 10240
    buffer_load_dwordx4 v2, s[12:15], s39 offen  lds
    v_mfma_f32_32x32x16_bf16 a[32:47], v[48:51], v[24:27], a[32:47]
    s_waitcnt lgkmcnt(10)
    ds_read_b64_tr_b16 v[84:85], v11 offset:36864
    ds_read_b64_tr_b16 v[86:87], v11 offset:37888
    v_mfma_f32_32x32x16_bf16 a[96:111], v[48:51], v[28:31], a[96:111]
    ds_read_b64_tr_b16 v[88:89], v8 offset:53248
    ds_read_b64_tr_b16 v[90:91], v8 offset:54272
    s_add_u32 m0, s37, 67584
    s_add_u32 s39, s32, 20480
    buffer_load_dwordx4 v1, s[12:15], s39 offen  lds
    v_mfma_f32_32x32x16_bf16 a[48:63], v[52:55], v[24:27], a[48:63]
    s_waitcnt lgkmcnt(10)
    ds_read_b64_tr_b16 v[92:93], v9 offset:53248
    ds_read_b64_tr_b16 v[94:95], v9 offset:54272
    v_mfma_f32_32x32x16_bf16 a[112:127], v[52:55], v[28:31], a[112:127]
    ds_read_b64_tr_b16 v[96:97], v10 offset:53248
    ds_read_b64_tr_b16 v[98:99], v10 offset:54272
    s_add_u32 m0, s37, 68608
    s_add_u32 s39, s32, 30720
    buffer_load_dwordx4 v2, s[12:15], s39 offen  lds
    v_mfma_f32_32x32x16_bf16 a[128:143], v[56:59], v[24:27], a[128:143]
    s_waitcnt lgkmcnt(10)
    ds_read_b64_tr_b16 v[100:101], v11 offset:53248
    ds_read_b64_tr_b16 v[102:103], v11 offset:54272
    v_mfma_f32_32x32x16_bf16 a[192:207], v[56:59], v[28:31], a[192:207]
    s_add_u32 m0, s37, 69632
    s_add_u32 s39, s32, 40960
    buffer_load_dwordx4 v1, s[12:15], s39 offen  lds
    v_mfma_f32_32x32x16_bf16 a[144:159], v[60:63], v[24:27], a[144:159]
    v_mfma_f32_32x32x16_bf16 a[208:223], v[60:63], v[28:31], a[208:223]
    s_add_u32 m0, s37, 70656
    s_add_u32 s39, s32, 51200
    buffer_load_dwordx4 v2, s[12:15], s39 offen  lds
    v_mfma_f32_32x32x16_bf16 a[160:175], v[64:67], v[24:27], a[160:175]
    v_mfma_f32_32x32x16_bf16 a[224:239], v[64:67], v[28:31], a[224:239]
    s_add_u32 m0, s37, 71680
    s_add_u32 s39, s32, 61440
    buffer_load_dwordx4 v1, s[12:15], s39 offen  lds
    v_mfma_f32_32x32x16_bf16 a[176:191], v[68:71], v[24:27], a[176:191]
    v_mfma_f32_32x32x16_bf16 a[240:255], v[68:71], v[28:31], a[240:255]
    s_add_u32 m0, s37, 72704
    s_add_u32 s39, s32, 71680
    buffer_load_dwordx4 v2, s[12:15], s39 offen  lds
    s_add_u32 s32, s32, 128
    v_mfma_f32_32x32x16_bf16 a[0:15], v[72:75], v[32:35], a[0:15]
    ds_read_b128 v[24:27], v6 offset:0
    ds_read_b64_tr_b16 v[40:41], v8 offset:40960
    v_mfma_f32_32x32x16_bf16 a[64:79], v[72:75], v[36:39], a[64:79]
    s_waitcnt lgkmcnt(10)
    ds_read_b64_tr_b16 v[42:43], v8 offset:41984
    ds_read_b128 v[28:31], v6 offset:4096
    buffer_store_dwordx4 v[200:203], v21, s[88:91], s92 offen sc1
    s_add_u32 s92, s92, s93
    v_mfma_f32_32x32x16_bf16 a[16:31], v[76:79], v[32:35], a[16:31]
    ds_read_b64_tr_b16 v[44:45], v9 offset:40960
    ds_read_b64_tr_b16 v[46:47], v9 offset:41984
    v_mfma_f32_32x32x16_bf16 a[80:95], v[76:79], v[36:39], a[80:95]
    s_waitcnt lgkmcnt(10)
    ds_read_b64_tr_b16 v[48:49], v10 offset:40960
    ds_read_b64_tr_b16 v[50:51], v10 offset:41984
    v_mfma_f32_32x32x16_bf16 a[32:47], v[80:83], v[32:35], a[32:47]
    ds_read_b64_tr_b16 v[52:53], v11 offset:40960
    ds_read_b64_tr_b16 v[54:55], v11 offset:41984
    buffer_store_dwordx4 v[204:207], v21, s[88:91], s92 offen sc1
    s_add_u32 s92, s92, s94
    v_mfma_f32_32x32x16_bf16 a[96:111], v[80:83], v[36:39], a[96:111]
    s_waitcnt lgkmcnt(10)
    ds_read_b64_tr_b16 v[56:57], v8 offset:57344
    ds_read_b64_tr_b16 v[58:59], v8 offset:58368
    v_mfma_f32_32x32x16_bf16 a[48:63], v[84:87], v[32:35], a[48:63]
    ds_read_b64_tr_b16 v[60:61], v9 offset:57344
    ds_read_b64_tr_b16 v[62:63], v9 offset:58368
    v_mfma_f32_32x32x16_bf16 a[112:127], v[84:87], v[36:39], a[112:127]
    s_waitcnt lgkmcnt(10)
    ds_read_b64_tr_b16 v[64:65], v10 offset:57344
    ds_read_b64_tr_b16 v[66:67], v10 offset:58368
    buffer_store_dwordx4 v[208:211], v21, s[88:91], s92 offen sc1
    s_add_u32 s92, s92, s93
    v_mfma_f32_32x32x16_bf16 a[128:143], v[88:91], v[32:35], a[128:143]
    ds_read_b64_tr_b16 v[68:69], v11 offset:57344
    ds_read_b64_tr_b16 v[70:71], v11 offset:58368
    v_mfma_f32_32x32x16_bf16 a[192:207], v[88:91], v[36:39], a[192:207]
    v_mfma_f32_32x32x16_bf16 a[144:159], v[92:95], v[32:35], a[144:159]
    buffer_store_dwordx4 v[212:215], v21, s[88:91], s92 offen sc1
    s_add_u32 s92, s92, s94
    v_mfma_f32_32x32x16_bf16 a[208:223], v[92:95], v[36:39], a[208:223]
    v_mfma_f32_32x32x16_bf16 a[160:175], v[96:99], v[32:35], a[160:175]
    v_mfma_f32_32x32x16_bf16 a[224:239], v[96:99], v[36:39], a[224:239]
    v_mfma_f32_32x32x16_bf16 a[176:191], v[100:103], v[32:35], a[176:191]
    v_mfma_f32_32x32x16_bf16 a[240:255], v[100:103], v[36:39], a[240:255]
    v_mfma_f32_32x32x16_bf16 a[0:15], v[40:43], v[24:27], a[0:15]
    s_waitcnt lgkmcnt(10)
    ds_read_b128 v[32:35], v7 offset:0
    ds_read_b64_tr_b16 v[72:73], v8 offset:45056
    v_mfma_f32_32x32x16_bf16 a[64:79], v[40:43], v[28:31], a[64:79]
    ds_read_b64_tr_b16 v[74:75], v8 offset:46080
    ds_read_b128 v[36:39], v7 offset:4096
    v_mfma_f32_32x32x16_bf16 a[16:31], v[44:47], v[24:27], a[16:31]
    s_waitcnt lgkmcnt(10)
    ds_read_b64_tr_b16 v[76:77], v9 offset:45056
    ds_read_b64_tr_b16 v[78:79], v9 offset:46080
    v_mfma_f32_32x32x16_bf16 a[80:95], v[44:47], v[28:31], a[80:95]
    ds_read_b64_tr_b16 v[80:81], v10 offset:45056
    ds_read_b64_tr_b16 v[82:83], v10 offset:46080
    v_mfma_f32_32x32x16_bf16 a[32:47], v[48:51], v[24:27], a[32:47]
    s_waitcnt lgkmcnt(10)
    ds_read_b64_tr_b16 v[84:85], v11 offset:45056
    ds_read_b64_tr_b16 v[86:87], v11 offset:46080
    v_mfma_f32_32x32x16_bf16 a[96:111], v[48:51], v[28:31], a[96:111]
    ds_read_b64_tr_b16 v[88:89], v8 offset:61440
    ds_read_b64_tr_b16 v[90:91], v8 offset:62464
    v_mfma_f32_32x32x16_bf16 a[48:63], v[52:55], v[24:27], a[48:63]
    s_waitcnt lgkmcnt(10)
    ds_read_b64_tr_b16 v[92:93], v9 offset:61440
    ds_read_b64_tr_b16 v[94:95], v9 offset:62464
    v_mfma_f32_32x32x16_bf16 a[112:127], v[52:55], v[28:31], a[112:127]
    ds_read_b64_tr_b16 v[96:97], v10 offset:61440
    ds_read_b64_tr_b16 v[98:99], v10 offset:62464
    v_mfma_f32_32x32x16_bf16 a[128:143], v[56:59], v[24:27], a[128:143]
    s_waitcnt lgkmcnt(10)
    ds_read_b64_tr_b16 v[100:101], v11 offset:61440
    ds_read_b64_tr_b16 v[102:103], v11 offset:62464
    v_mfma_f32_32x32x16_bf16 a[192:207], v[56:59], v[28:31], a[192:207]
    v_mfma_f32_32x32x16_bf16 a[144:159], v[60:63], v[24:27], a[144:159]
    v_xor_b32 v4, 0x10000, v4
    v_xor_b32 v5, 0x10000, v5
    v_mfma_f32_32x32x16_bf16 a[208:223], v[60:63], v[28:31], a[208:223]
    v_xor_b32 v6, 0x10000, v6
    v_xor_b32 v7, 0x10000, v7
    v_mfma_f32_32x32x16_bf16 a[160:175], v[64:67], v[24:27], a[160:175]
    v_xor_b32 v8, 0x10000, v8
    v_xor_b32 v9, 0x10000, v9
    v_mfma_f32_32x32x16_bf16 a[224:239], v[64:67], v[28:31], a[224:239]
    v_xor_b32 v10, 0x10000, v10
    v_xor_b32 v11, 0x10000, v11
    v_mfma_f32_32x32x16_bf16 a[176:191], v[68:71], v[24:27], a[176:191]
    v_xor_b32 v12, 0x10000, v12
    v_xor_b32 v13, 0x10000, v13
    v_mfma_f32_32x32x16_bf16 a[240:255], v[68:71], v[28:31], a[240:255]
    v_xor_b32 v14, 0x10000, v14
    v_xor_b32 v15, 0x10000, v15
    s_waitcnt vmcnt(0) lgkmcnt(0)
    s_barrier
    v_mfma_f32_32x32x16_bf16 a[0:15], v[72:75], v[32:35], a[0:15]
    ds_read_b128 v[24:27], v4 offset:0
    ds_read_b64_tr_b16 v[40:41], v8 offset:32768
    v_mfma_f32_32x32x16_bf16 a[64:79], v[72:75], v[36:39], a[64:79]
    ds_read_b64_tr_b16 v[42:43], v8 offset:33792
    ds_read_b128 v[28:31], v4 offset:4096
    s_add_u32 m0, s38, 0
    s_mov_b32 s40, s33
    buffer_load_dwordx4 v3, s[20:23], s40 offen  lds
    v_mfma_f32_32x32x16_bf16 a[16:31], v[76:79], v[32:35], a[16:31]
    ds_read_b64_tr_b16 v[44:45], v9 offset:32768
    ds_read_b64_tr_b16 v[46:47], v9 offset:33792
    v_mfma_f32_32x32x16_bf16 a[80:95], v[76:79], v[36:39], a[80:95]
    ds_read_b64_tr_b16 v[48:49], v10 offset:32768
    ds_read_b64_tr_b16 v[50:51], v10 offset:33792
    s_add_u32 m0, s38, 1024
    s_add_u32 s40, s40, s35
    buffer_load_dwordx4 v3, s[20:23], s40 offen  lds
    v_mfma_f32_32x32x16_bf16 a[32:47], v[80:83], v[32:35], a[32:47]
    ds_read_b64_tr_b16 v[52:53], v11 offset:32768
    ds_read_b64_tr_b16 v[54:55], v11 offset:33792
    v_mfma_f32_32x32x16_bf16 a[96:111], v[80:83], v[36:39], a[96:111]
    ds_read_b64_tr_b16 v[56:57], v8 offset:49152
    ds_read_b64_tr_b16 v[58:59], v8 offset:50176
    s_add_u32 m0, s38, 2048
    s_add_u32 s40, s40, s35
    buffer_load_dwordx4 v3, s[20:23], s40 offen  lds
    v_mfma_f32_32x32x16_bf16 a[48:63], v[84:87], v[32:35], a[48:63]
    ds_read_b64_tr_b16 v[60:61], v9 offset:49152
    ds_read_b64_tr_b16 v[62:63], v9 offset:50176
    v_mfma_f32_32x32x16_bf16 a[112:127], v[84:87], v[36:39], a[112:127]
    s_waitcnt lgkmcnt(10)
    ds_read_b64_tr_b16 v[64:65], v10 offset:49152
    ds_read_b64_tr_b16 v[66:67], v10 offset:50176
    s_add_u32 m0, s38, 3072
    s_add_u32 s40, s40, s35
    buffer_load_dwordx4 v3, s[20:23], s40 offen  lds
    v_mfma_f32_32x32x16_bf16 a[128:143], v[88:91], v[32:35], a[128:143]
    ds_read_b64_tr_b16 v[68:69], v11 offset:49152
    ds_read_b64_tr_b16 v[70:71], v11 offset:50176
    v_mfma_f32_32x32x16_bf16 a[192:207], v[88:91], v[36:39], a[192:207]
    s_add_u32 m0, s38, 16384
    s_mov_b32 s40, s34
    buffer_load_dwordx4 v3, s[24:27], s40 offen  lds
    v_mfma_f32_32x32x16_bf16 a[144:159], v[92:95], v[32:35], a[144:159]
    v_mfma_f32_32x32x16_bf16 a[208:223], v[92:95], v[36:39], a[208:223]
    s_add_u32 m0, s38, 17408
    s_add_u32 s40, s40, s35
    buffer_load_dwordx4 v3, s[24:27], s40 offen  lds
    v_mfma_f32_32x32x16_bf16 a[160:175], v[96:99], v[32:35], a[160:175]
    v_mfma_f32_32x32x16_bf16 a[224:239], v[96:99], v[36:39], a[224:239]
    s_add_u32 m0, s38, 18432
    s_add_u32 s40, s40, s35
    buffer_load_dwordx4 v3, s[24:27], s40 offen  lds
    v_mfma_f32_32x32x16_bf16 a[176:191], v[100:103], v[32:35], a[176:191]
    v_mfma_f32_32x32x16_bf16 a[240:255], v[100:103], v[36:39], a[240:255]
    s_add_u32 m0, s38, 19456
    s_add_u32 s40, s40, s35
    buffer_load_dwordx4 v3, s[24:27], s40 offen  lds
    s_add_u32 s33, s33, s36
    s_add_u32 s34, s34, s36
    v_mfma_f32_32x32x16_bf16 a[0:15], v[40:43], v[24:27], a[0:15]
    s_waitcnt lgkmcnt(10)
    ds_read_b128 v[32:35], v5 offset:0
    ds_read_b64_tr_b16 v[72:73], v8 offset:36864
    v_mfma_f32_32x32x16_bf16 a[64:79], v[40:43], v[28:31], a[64:79]
    ds_read_b64_tr_b16 v[74:75], v8 offset:37888
    ds_read_b128 v[36:39], v5 offset:4096
    s_add_u32 m0, s37, 0
    s_add_u32 s39, s32, 0
    buffer_load_dwordx4 v1, s[12:15], s39 offen  lds
    v_mfma_f32_32x32x16_bf16 a[16:31], v[44:47], v[24:27], a[16:31]
    s_waitcnt lgkmcnt(10)
    ds_read_b64_tr_b16 v[76:77], v9 offset:36864
    ds_read_b64_tr_b16 v[78:79], v9 offset:37888
    v_mfma_f32_32x32x16_bf16 a[80:95], v[44:47], v[28:31], a[80:95]
    ds_read_b64_tr_b16 v[80:81], v10 offset:36864
    ds_read_b64_tr_b16 v[82:83], v10 offset:37888
    s_add_u32 m0, s37, 1024
    s_add_u32 s39, s32, 10240
    buffer_load_dwordx4 v2, s[12:15], s39 offen  lds
    v_mfma_f32_32x32x16_bf16 a[32:47], v[48:51], v[24:27], a[32:47]
    s_waitcnt lgkmcnt(10)
    ds_read_b64_tr_b16 v[84:85], v11 offset:36864
    ds_read_b64_tr_b16 v[86:87], v11 offset:37888
    v_mfma_f32_32x32x16_bf16 a[96:111], v[48:51], v[28:31], a[96:111]
    ds_read_b64_tr_b16 v[88:89], v8 offset:53248
    ds_read_b64_tr_b16 v[90:91], v8 offset:54272
    s_add_u32 m0, s37, 2048
    s_add_u32 s39, s32, 20480
    buffer_load_dwordx4 v1, s[12:15], s39 offen  lds
    v_mfma_f32_32x32x16_bf16 a[48:63], v[52:55], v[24:27], a[48:63]
    s_waitcnt lgkmcnt(10)
    ds_read_b64_tr_b16 v[92:93], v9 offset:53248
    ds_read_b64_tr_b16 v[94:95], v9 offset:54272
    v_mfma_f32_32x32x16_bf16 a[112:127], v[52:55], v[28:31], a[112:127]
    ds_read_b64_tr_b16 v[96:97], v10 offset:53248
    ds_read_b64_tr_b16 v[98:99], v10 offset:54272
    s_add_u32 m0, s37, 3072
    s_add_u32 s39, s32, 30720
    buffer_load_dwordx4 v2, s[12:15], s39 offen  lds
    v_mfma_f32_32x32x16_bf16 a[128:143], v[56:59], v[24:27], a[128:143]
    s_waitcnt lgkmcnt(10)
    ds_read_b64_tr_b16 v[100:101], v11 offset:53248
    ds_read_b64_tr_b16 v[102:103], v11 offset:54272
    v_mfma_f32_32x32x16_bf16 a[192:207], v[56:59], v[28:31], a[192:207]
    s_add_u32 m0, s37, 4096
    s_add_u32 s39, s32, 40960
    buffer_load_dwordx4 v1, s[12:15], s39 offen  lds
    v_mfma_f32_32x32x16_bf16 a[144:159], v[60:63], v[24:27], a[144:159]
    v_mfma_f32_32x32x16_bf16 a[208:223], v[60:63], v[28:31], a[208:223]
    s_add_u32 m0, s37, 5120
    s_add_u32 s39, s32, 51200
    buffer_load_dwordx4 v2, s[12:15], s39 offen  lds
    v_mfma_f32_32x32x16_bf16 a[160:175], v[64:67], v[24:27], a[160:175]
    v_mfma_f32_32x32x16_bf16 a[224:239], v[64:67], v[28:31], a[224:239]
    s_add_u32 m0, s37, 6144
    s_add_u32 s39, s32, 61440
    buffer_load_dwordx4 v1, s[12:15], s39 offen  lds
    v_mfma_f32_32x32x16_bf16 a[176:191], v[68:71], v[24:27], a[176:191]
    v_mfma_f32_32x32x16_bf16 a[240:255], v[68:71], v[28:31], a[240:255]
    s_add_u32 m0, s37, 7168
    s_add_u32 s39, s32, 71680
    buffer_load_dwordx4 v2, s[12:15], s39 offen  lds
    s_add_u32 s32, s32, 128
    v_mfma_f32_32x32x16_bf16 a[0:15], v[72:75], v[32:35], a[0:15]
    ds_read_b128 v[24:27], v6 offset:0
    ds_read_b64_tr_b16 v[40:41], v8 offset:40960
    v_mfma_f32_32x32x16_bf16 a[64:79], v[72:75], v[36:39], a[64:79]
    s_waitcnt lgkmcnt(10)
    ds_read_b64_tr_b16 v[42:43], v8 offset:41984
    ds_read_b128 v[28:31], v6 offset:4096
    buffer_store_dwordx4 v[216:219], v21, s[88:91], s92 offen sc1
    s_add_u32 s92, s92, s93
    v_mfma_f32_32x32x16_bf16 a[16:31], v[76:79], v[32:35], a[16:31]
    ds_read_b64_tr_b16 v[44:45], v9 offset:40960
    ds_read_b64_tr_b16 v[46:47], v9 offset:41984
    v_mfma_f32_32x32x16_bf16 a[80:95], v[76:79], v[36:39], a[80:95]
    s_waitcnt lgkmcnt(10)
    ds_read_b64_tr_b16 v[48:49], v10 offset:40960
    ds_read_b64_tr_b16 v[50:51], v10 offset:41984
    v_mfma_f32_32x32x16_bf16 a[32:47], v[80:83], v[32:35], a[32:47]
    ds_read_b64_tr_b16 v[52:53], v11 offset:40960
    ds_read_b64_tr_b16 v[54:55], v11 offset:41984
    buffer_store_dwordx4 v[220:223], v21, s[88:91], s92 offen sc1
    s_add_u32 s92, s92, s94
    v_mfma_f32_32x32x16_bf16 a[96:111], v[80:83], v[36:39], a[96:111]
    s_waitcnt lgkmcnt(10)
    ds_read_b64_tr_b16 v[56:57], v8 offset:57344
    ds_read_b64_tr_b16 v[58:59], v8 offset:58368
    v_mfma_f32_32x32x16_bf16 a[48:63], v[84:87], v[32:35], a[48:63]
    ds_read_b64_tr_b16 v[60:61], v9 offset:57344
    ds_read_b64_tr_b16 v[62:63], v9 offset:58368
    v_mfma_f32_32x32x16_bf16 a[112:127], v[84:87], v[36:39], a[112:127]
    s_waitcnt lgkmcnt(10)
    ds_read_b64_tr_b16 v[64:65], v10 offset:57344
    ds_read_b64_tr_b16 v[66:67], v10 offset:58368
    buffer_store_dwordx4 v[224:227], v21, s[88:91], s92 offen sc1
    s_add_u32 s92, s92, s93
    v_mfma_f32_32x32x16_bf16 a[128:143], v[88:91], v[32:35], a[128:143]
    ds_read_b64_tr_b16 v[68:69], v11 offset:57344
    ds_read_b64_tr_b16 v[70:71], v11 offset:58368
    v_mfma_f32_32x32x16_bf16 a[192:207], v[88:91], v[36:39], a[192:207]
    v_mfma_f32_32x32x16_bf16 a[144:159], v[92:95], v[32:35], a[144:159]
    buffer_store_dwordx4 v[228:231], v21, s[88:91], s92 offen sc1
    s_add_u32 s92, s92, s96
    v_mfma_f32_32x32x16_bf16 a[208:223], v[92:95], v[36:39], a[208:223]
    v_mfma_f32_32x32x16_bf16 a[160:175], v[96:99], v[32:35], a[160:175]
    v_mfma_f32_32x32x16_bf16 a[224:239], v[96:99], v[36:39], a[224:239]
    v_mfma_f32_32x32x16_bf16 a[176:191], v[100:103], v[32:35], a[176:191]
    v_mfma_f32_32x32x16_bf16 a[240:255], v[100:103], v[36:39], a[240:255]
    v_mfma_f32_32x32x16_bf16 a[0:15], v[40:43], v[24:27], a[0:15]
    s_waitcnt lgkmcnt(10)
    ds_read_b128 v[32:35], v7 offset:0
    ds_read_b64_tr_b16 v[72:73], v8 offset:45056
    v_mfma_f32_32x32x16_bf16 a[64:79], v[40:43], v[28:31], a[64:79]
    ds_read_b64_tr_b16 v[74:75], v8 offset:46080
    ds_read_b128 v[36:39], v7 offset:4096
    v_mfma_f32_32x32x16_bf16 a[16:31], v[44:47], v[24:27], a[16:31]
    s_waitcnt lgkmcnt(10)
    ds_read_b64_tr_b16 v[76:77], v9 offset:45056
    ds_read_b64_tr_b16 v[78:79], v9 offset:46080
    v_mfma_f32_32x32x16_bf16 a[80:95], v[44:47], v[28:31], a[80:95]
    ds_read_b64_tr_b16 v[80:81], v10 offset:45056
    ds_read_b64_tr_b16 v[82:83], v10 offset:46080
    v_mfma_f32_32x32x16_bf16 a[32:47], v[48:51], v[24:27], a[32:47]
    s_waitcnt lgkmcnt(10)
    ds_read_b64_tr_b16 v[84:85], v11 offset:45056
    ds_read_b64_tr_b16 v[86:87], v11 offset:46080
    v_mfma_f32_32x32x16_bf16 a[96:111], v[48:51], v[28:31], a[96:111]
    ds_read_b64_tr_b16 v[88:89], v8 offset:61440
    ds_read_b64_tr_b16 v[90:91], v8 offset:62464
    v_mfma_f32_32x32x16_bf16 a[48:63], v[52:55], v[24:27], a[48:63]
    s_waitcnt lgkmcnt(10)
    ds_read_b64_tr_b16 v[92:93], v9 offset:61440
    ds_read_b64_tr_b16 v[94:95], v9 offset:62464
    v_mfma_f32_32x32x16_bf16 a[112:127], v[52:55], v[28:31], a[112:127]
    ds_read_b64_tr_b16 v[96:97], v10 offset:61440
    ds_read_b64_tr_b16 v[98:99], v10 offset:62464
    v_mfma_f32_32x32x16_bf16 a[128:143], v[56:59], v[24:27], a[128:143]
    s_waitcnt lgkmcnt(10)
    ds_read_b64_tr_b16 v[100:101], v11 offset:61440
    ds_read_b64_tr_b16 v[102:103], v11 offset:62464
    v_mfma_f32_32x32x16_bf16 a[192:207], v[56:59], v[28:31], a[192:207]
    v_mfma_f32_32x32x16_bf16 a[144:159], v[60:63], v[24:27], a[144:159]
    v_xor_b32 v4, 0x10000, v4
    v_xor_b32 v5, 0x10000, v5
    v_mfma_f32_32x32x16_bf16 a[208:223], v[60:63], v[28:31], a[208:223]
    v_xor_b32 v6, 0x10000, v6
    v_xor_b32 v7, 0x10000, v7
    v_mfma_f32_32x32x16_bf16 a[160:175], v[64:67], v[24:27], a[160:175]
    v_xor_b32 v8, 0x10000, v8
    v_xor_b32 v9, 0x10000, v9
    v_mfma_f32_32x32x16_bf16 a[224:239], v[64:67], v[28:31], a[224:239]
    v_xor_b32 v10, 0x10000, v10
    v_xor_b32 v11, 0x10000, v11
    v_mfma_f32_32x32x16_bf16 a[176:191], v[68:71], v[24:27], a[176:191]
    v_xor_b32 v12, 0x10000, v12
    v_xor_b32 v13, 0x10000, v13
    v_mfma_f32_32x32x16_bf16 a[240:255], v[68:71], v[28:31], a[240:255]
    v_xor_b32 v14, 0x10000, v14
    v_xor_b32 v15, 0x10000, v15
    s_waitcnt vmcnt(0) lgkmcnt(0)
    s_barrier
    s_cmp_lg_u32 s17, 0
    s_cbranch_scc1 L_ps_gtt
    v_mov_b32 v22, s62
    s_mov_b64 exec, 1
    buffer_atomic_add v22, off, s[8:11], s61
    s_mov_b64 exec, -1
L_ps_gtt:
    s_mov_b32 s90, 0
    s_mov_b32 s62, 0
    v_mfma_f32_32x32x16_bf16 a[0:15], v[72:75], v[32:35], a[0:15]
    ds_read_b128 v[24:27], v4 offset:0
    ds_read_b64_tr_b16 v[40:41], v8 offset:32768
    v_mfma_f32_32x32x16_bf16 a[64:79], v[72:75], v[36:39], a[64:79]
    ds_read_b64_tr_b16 v[42:43], v8 offset:33792
    ds_read_b128 v[28:31], v4 offset:4096
    s_add_u32 m0, s38, 65536
    s_mov_b32 s40, s33
    buffer_load_dwordx4 v3, s[20:23], s40 offen  lds
    v_mfma_f32_32x32x16_bf16 a[16:31], v[76:79], v[32:35], a[16:31]
    ds_read_b64_tr_b16 v[44:45], v9 offset:32768
    ds_read_b64_tr_b16 v[46:47], v9 offset:33792
    v_mfma_f32_32x32x16_bf16 a[80:95], v[76:79], v[36:39], a[80:95]
    ds_read_b64_tr_b16 v[48:49], v10 offset:32768
    ds_read_b64_tr_b16 v[50:51], v10 offset:33792
    s_add_u32 m0, s38, 66560
    s_add_u32 s40, s40, s35
    buffer_load_dwordx4 v3, s[20:23], s40 offen  lds
    v_mfma_f32_32x32x16_bf16 a[32:47], v[80:83], v[32:35], a[32:47]
    ds_read_b64_tr_b16 v[52:53], v11 offset:32768
    ds_read_b64_tr_b16 v[54:55], v11 offset:33792
    v_mfma_f32_32x32x16_bf16 a[96:111], v[80:83], v[36:39], a[96:111]
    ds_read_b64_tr_b16 v[56:57], v8 offset:49152
    ds_read_b64_tr_b16 v[58:59], v8 offset:50176
    s_add_u32 m0, s38, 67584
    s_add_u32 s40, s40, s35
    buffer_load_dwordx4 v3, s[20:23], s40 offen  lds
    v_mfma_f32_32x32x16_bf16 a[48:63], v[84:87], v[32:35], a[48:63]
    ds_read_b64_tr_b16 v[60:61], v9 offset:49152
    ds_read_b64_tr_b16 v[62:63], v9 offset:50176
    v_mfma_f32_32x32x16_bf16 a[112:127], v[84:87], v[36:39], a[112:127]
    s_waitcnt lgkmcnt(10)
    ds_read_b64_tr_b16 v[64:65], v10 offset:49152
    ds_read_b64_tr_b16 v[66:67], v10 offset:50176
    s_add_u32 m0, s38, 68608
    s_add_u32 s40, s40, s35
    buffer_load_dwordx4 v3, s[20:23], s40 offen  lds
    v_mfma_f32_32x32x16_bf16 a[128:143], v[88:91], v[32:35], a[128:143]
    ds_read_b64_tr_b16 v[68:69], v11 offset:49152
    ds_read_b64_tr_b16 v[70:71], v11 offset:50176
    v_mfma_f32_32x32x16_bf16 a[192:207], v[88:91], v[36:39], a[192:207]
    s_add_u32 m0, s38, 81920
    s_mov_b32 s40, s34
    buffer_load_dwordx4 v3, s[24:27], s40 offen  lds
    v_mfma_f32_32x32x16_bf16 a[144:159], v[92:95], v[32:35], a[144:159]
    v_mfma_f32_32x32x16_bf16 a[208:223], v[92:95], v[36:39], a[208:223]
    s_add_u32 m0, s38, 82944
    s_add_u32 s40, s40, s35
    buffer_load_dwordx4 v3, s[24:27], s40 offen  lds
    v_mfma_f32_32x32x16_bf16 a[160:175], v[96:99], v[32:35], a[160:175]
    v_mfma_f32_32x32x16_bf16 a[224:239], v[96:99], v[36:39], a[224:239]
    s_add_u32 m0, s38, 83968
    s_add_u32 s40, s40, s35
    buffer_load_dwordx4 v3, s[24:27], s40 offen  lds
    v_mfma_f32_32x32x16_bf16 a[176:191], v[100:103], v[32:35], a[176:191]
    v_mfma_f32_32x32x16_bf16 a[240:255], v[100:103], v[36:39], a[240:255]
    s_add_u32 m0, s38, 84992
    s_add_u32 s40, s40, s35
    buffer_load_dwordx4 v3, s[24:27], s40 offen  lds
    s_add_u32 s33, s33, s36
    s_add_u32 s34, s34, s36
    v_mfma_f32_32x32x16_bf16 a[0:15], v[40:43], v[24:27], a[0:15]
    s_waitcnt lgkmcnt(10)
    ds_read_b128 v[32:35], v5 offset:0
    ds_read_b64_tr_b16 v[72:73], v8 offset:36864
    v_mfma_f32_32x32x16_bf16 a[64:79], v[40:43], v[28:31], a[64:79]
    ds_read_b64_tr_b16 v[74:75], v8 offset:37888
    ds_read_b128 v[36:39], v5 offset:4096
    s_add_u32 m0, s37, 65536
    s_add_u32 s39, s32, 0
    buffer_load_dwordx4 v1, s[12:15], s39 offen  lds
    v_mfma_f32_32x32x16_bf16 a[16:31], v[44:47], v[24:27], a[16:31]
    s_waitcnt lgkmcnt(10)
    ds_read_b64_tr_b16 v[76:77], v9 offset:36864
    ds_read_b64_tr_b16 v[78:79], v9 offset:37888
    v_mfma_f32_32x32x16_bf16 a[80:95], v[44:47], v[28:31], a[80:95]
    ds_read_b64_tr_b16 v[80:81], v10 offset:36864
    ds_read_b64_tr_b16 v[82:83], v10 offset:37888
    s_add_u32 m0, s37, 66560
    s_add_u32 s39, s32, 10240
    buffer_load_dwordx4 v2, s[12:15], s39 offen  lds
    v_mfma_f32_32x32x16_bf16 a[32:47], v[48:51], v[24:27], a[32:47]
    s_waitcnt lgkmcnt(10)
    ds_read_b64_tr_b16 v[84:85], v11 offset:36864
    ds_read_b64_tr_b16 v[86:87], v11 offset:37888
    v_mfma_f32_32x32x16_bf16 a[96:111], v[48:51], v[28:31], a[96:111]
    ds_read_b64_tr_b16 v[88:89], v8 offset:53248
    ds_read_b64_tr_b16 v[90:91], v8 offset:54272
    s_add_u32 m0, s37, 67584
    s_add_u32 s39, s32, 20480
    buffer_load_dwordx4 v1, s[12:15], s39 offen  lds
    v_mfma_f32_32x32x16_bf16 a[48:63], v[52:55], v[24:27], a[48:63]
    s_waitcnt lgkmcnt(10)
    ds_read_b64_tr_b16 v[92:93], v9 offset:53248
    ds_read_b64_tr_b16 v[94:95], v9 offset:54272
    v_mfma_f32_32x32x16_bf16 a[112:127], v[52:55], v[28:31], a[112:127]
    ds_read_b64_tr_b16 v[96:97], v10 offset:53248
    ds_read_b64_tr_b16 v[98:99], v10 offset:54272
    s_add_u32 m0, s37, 68608
    s_add_u32 s39, s32, 30720
    buffer_load_dwordx4 v2, s[12:15], s39 offen  lds
    v_mfma_f32_32x32x16_bf16 a[128:143], v[56:59], v[24:27], a[128:143]
    s_waitcnt lgkmcnt(10)
    ds_read_b64_tr_b16 v[100:101], v11 offset:53248
    ds_read_b64_tr_b16 v[102:103], v11 offset:54272
    v_mfma_f32_32x32x16_bf16 a[192:207], v[56:59], v[28:31], a[192:207]
    s_add_u32 m0, s37, 69632
    s_add_u32 s39, s32, 40960
    buffer_load_dwordx4 v1, s[12:15], s39 offen  lds
    v_mfma_f32_32x32x16_bf16 a[144:159], v[60:63], v[24:27], a[144:159]
    v_mfma_f32_32x32x16_bf16 a[208:223], v[60:63], v[28:31], a[208:223]
    s_add_u32 m0, s37, 70656
    s_add_u32 s39, s32, 51200
    buffer_load_dwordx4 v2, s[12:15], s39 offen  lds
    v_mfma_f32_32x32x16_bf16 a[160:175], v[64:67], v[24:27], a[160:175]
    v_mfma_f32_32x32x16_bf16 a[224:239], v[64:67], v[28:31], a[224:239]
    s_add_u32 m0, s37, 71680
    s_add_u32 s39, s32, 61440
    buffer_load_dwordx4 v1, s[12:15], s39 offen  lds
    v_mfma_f32_32x32x16_bf16 a[176:191], v[68:71], v[24:27], a[176:191]
    v_mfma_f32_32x32x16_bf16 a[240:255], v[68:71], v[28:31], a[240:255]
    s_add_u32 m0, s37, 72704
    s_add_u32 s39, s32, 71680
    buffer_load_dwordx4 v2, s[12:15], s39 offen  lds
    s_add_u32 s32, s32, 128
    v_mfma_f32_32x32x16_bf16 a[0:15], v[72:75], v[32:35], a[0:15]
    ds_read_b128 v[24:27], v6 offset:0
    ds_read_b64_tr_b16 v[40:41], v8 offset:40960
    v_mfma_f32_32x32x16_bf16 a[64:79], v[72:75], v[36:39], a[64:79]
    s_waitcnt lgkmcnt(10)
    ds_read_b64_tr_b16 v[42:43], v8 offset:41984
    ds_read_b128 v[28:31], v6 offset:4096
    v_mfma_f32_32x32x16_bf16 a[16:31], v[76:79], v[32:35], a[16:31]
    ds_read_b64_tr_b16 v[44:45], v9 offset:40960
    ds_read_b64_tr_b16 v[46:47], v9 offset:41984
    v_mfma_f32_32x32x16_bf16 a[80:95], v[76:79], v[36:39], a[80:95]
    s_waitcnt lgkmcnt(10)
    ds_read_b64_tr_b16 v[48:49], v10 offset:40960
    ds_read_b64_tr_b16 v[50:51], v10 offset:41984
    v_mfma_f32_32x32x16_bf16 a[32:47], v[80:83], v[32:35], a[32:47]
    ds_read_b64_tr_b16 v[52:53], v11 offset:40960
    ds_read_b64_tr_b16 v[54:55], v11 offset:41984
    v_mfma_f32_32x32x16_bf16 a[96:111], v[80:83], v[36:39], a[96:111]
    s_waitcnt lgkmcnt(10)
    ds_read_b64_tr_b16 v[56:57], v8 offset:57344
    ds_read_b64_tr_b16 v[58:59], v8 offset:58368
    v_mfma_f32_32x32x16_bf16 a[48:63], v[84:87], v[32:35], a[48:63]
    ds_read_b64_tr_b16 v[60:61], v9 offset:57344
    ds_read_b64_tr_b16 v[62:63], v9 offset:58368
    v_mfma_f32_32x32x16_bf16 a[112:127], v[84:87], v[36:39], a[112:127]
    s_waitcnt lgkmcnt(10)
    ds_read_b64_tr_b16 v[64:65], v10 offset:57344
    ds_read_b64_tr_b16 v[66:67], v10 offset:58368
    v_mfma_f32_32x32x16_bf16 a[128:143], v[88:91], v[32:35], a[128:143]
    ds_read_b64_tr_b16 v[68:69], v11 offset:57344
    ds_read_b64_tr_b16 v[70:71], v11 offset:58368
    v_mfma_f32_32x32x16_bf16 a[192:207], v[88:91], v[36:39], a[192:207]
    v_mfma_f32_32x32x16_bf16 a[144:159], v[92:95], v[32:35], a[144:159]
    v_mfma_f32_32x32x16_bf16 a[208:223], v[92:95], v[36:39], a[208:223]
    v_mfma_f32_32x32x16_bf16 a[160:175], v[96:99], v[32:35], a[160:175]
    v_mfma_f32_32x32x16_bf16 a[224:239], v[96:99], v[36:39], a[224:239]
    v_mfma_f32_32x32x16_bf16 a[176:191], v[100:103], v[32:35], a[176:191]
    v_mfma_f32_32x32x16_bf16 a[240:255], v[100:103], v[36:39], a[240:255]
    v_mfma_f32_32x32x16_bf16 a[0:15], v[40:43], v[24:27], a[0:15]
    s_waitcnt lgkmcnt(10)
    ds_read_b128 v[32:35], v7 offset:0
    ds_read_b64_tr_b16 v[72:73], v8 offset:45056
    v_mfma_f32_32x32x16_bf16 a[64:79], v[40:43], v[28:31], a[64:79]
    ds_read_b64_tr_b16 v[74:75], v8 offset:46080
    ds_read_b128 v[36:39], v7 offset:4096
    v_mfma_f32_32x32x16_bf16 a[16:31], v[44:47], v[24:27], a[16:31]
    s_waitcnt lgkmcnt(10)
    ds_read_b64_tr_b16 v[76:77], v9 offset:45056
    ds_read_b64_tr_b16 v[78:79], v9 offset:46080
    v_mfma_f32_32x32x16_bf16 a[80:95], v[44:47], v[28:31], a[80:95]
    ds_read_b64_tr_b16 v[80:81], v10 offset:45056
    ds_read_b64_tr_b16 v[82:83], v10 offset:46080
    v_mfma_f32_32x32x16_bf16 a[32:47], v[48:51], v[24:27], a[32:47]
    s_waitcnt lgkmcnt(10)
    ds_read_b64_tr_b16 v[84:85], v11 offset:45056
    ds_read_b64_tr_b16 v[86:87], v11 offset:46080
    v_mfma_f32_32x32x16_bf16 a[96:111], v[48:51], v[28:31], a[96:111]
    ds_read_b64_tr_b16 v[88:89], v8 offset:61440
    ds_read_b64_tr_b16 v[90:91], v8 offset:62464
    v_mfma_f32_32x32x16_bf16 a[48:63], v[52:55], v[24:27], a[48:63]
    s_waitcnt lgkmcnt(10)
    ds_read_b64_tr_b16 v[92:93], v9 offset:61440
    ds_read_b64_tr_b16 v[94:95], v9 offset:62464
    v_mfma_f32_32x32x16_bf16 a[112:127], v[52:55], v[28:31], a[112:127]
    ds_read_b64_tr_b16 v[96:97], v10 offset:61440
    ds_read_b64_tr_b16 v[98:99], v10 offset:62464
    v_mfma_f32_32x32x16_bf16 a[128:143], v[56:59], v[24:27], a[128:143]
    s_waitcnt lgkmcnt(10)
    ds_read_b64_tr_b16 v[100:101], v11 offset:61440
    ds_read_b64_tr_b16 v[102:103], v11 offset:62464
    v_mfma_f32_32x32x16_bf16 a[192:207], v[56:59], v[28:31], a[192:207]
    v_mfma_f32_32x32x16_bf16 a[144:159], v[60:63], v[24:27], a[144:159]
    v_xor_b32 v4, 0x10000, v4
    v_xor_b32 v5, 0x10000, v5
    v_mfma_f32_32x32x16_bf16 a[208:223], v[60:63], v[28:31], a[208:223]
    v_xor_b32 v6, 0x10000, v6
    v_xor_b32 v7, 0x10000, v7
    v_mfma_f32_32x32x16_bf16 a[160:175], v[64:67], v[24:27], a[160:175]
    v_xor_b32 v8, 0x10000, v8
    v_xor_b32 v9, 0x10000, v9
    v_mfma_f32_32x32x16_bf16 a[224:239], v[64:67], v[28:31], a[224:239]
    v_xor_b32 v10, 0x10000, v10
    v_xor_b32 v11, 0x10000, v11
    v_mfma_f32_32x32x16_bf16 a[176:191], v[68:71], v[24:27], a[176:191]
    v_xor_b32 v12, 0x10000, v12
    v_xor_b32 v13, 0x10000, v13
    v_mfma_f32_32x32x16_bf16 a[240:255], v[68:71], v[28:31], a[240:255]
    v_xor_b32 v14, 0x10000, v14
    v_xor_b32 v15, 0x10000, v15
    s_waitcnt vmcnt(0) lgkmcnt(0)
    s_barrier
    v_mfma_f32_32x32x16_bf16 a[0:15], v[72:75], v[32:35], a[0:15]
    ds_read_b128 v[24:27], v4 offset:0
    ds_read_b64_tr_b16 v[40:41], v8 offset:32768
    v_mfma_f32_32x32x16_bf16 a[64:79], v[72:75], v[36:39], a[64:79]
    ds_read_b64_tr_b16 v[42:43], v8 offset:33792
    ds_read_b128 v[28:31], v4 offset:4096
    v_mfma_f32_32x32x16_bf16 a[16:31], v[76:79], v[32:35], a[16:31]
    ds_read_b64_tr_b16 v[44:45], v9 offset:32768
    ds_read_b64_tr_b16 v[46:47], v9 offset:33792
    v_mfma_f32_32x32x16_bf16 a[80:95], v[76:79], v[36:39], a[80:95]
    ds_read_b64_tr_b16 v[48:49], v10 offset:32768
    ds_read_b64_tr_b16 v[50:51], v10 offset:33792
    v_mfma_f32_32x32x16_bf16 a[32:47], v[80:83], v[32:35], a[32:47]
    ds_read_b64_tr_b16 v[52:53], v11 offset:32768
    ds_read_b64_tr_b16 v[54:55], v11 offset:33792
    v_mfma_f32_32x32x16_bf16 a[96:111], v[80:83], v[36:39], a[96:111]
    ds_read_b64_tr_b16 v[56:57], v8 offset:49152
    ds_read_b64_tr_b16 v[58:59], v8 offset:50176
    v_mfma_f32_32x32x16_bf16 a[48:63], v[84:87], v[32:35], a[48:63]
    ds_read_b64_tr_b16 v[60:61], v9 offset:49152
    ds_read_b64_tr_b16 v[62:63], v9 offset:50176
    v_mfma_f32_32x32x16_bf16 a[112:127], v[84:87], v[36:39], a[112:127]
    s_waitcnt lgkmcnt(10)
    ds_read_b64_tr_b16 v[64:65], v10 offset:49152
    ds_read_b64_tr_b16 v[66:67], v10 offset:50176
    v_mfma_f32_32x32x16_bf16 a[128:143], v[88:91], v[32:35], a[128:143]
    ds_read_b64_tr_b16 v[68:69], v11 offset:49152
    ds_read_b64_tr_b16 v[70:71], v11 offset:50176
    v_mfma_f32_32x32x16_bf16 a[192:207], v[88:91], v[36:39], a[192:207]
    v_mfma_f32_32x32x16_bf16 a[144:159], v[92:95], v[32:35], a[144:159]
    v_mfma_f32_32x32x16_bf16 a[208:223], v[92:95], v[36:39], a[208:223]
    v_mfma_f32_32x32x16_bf16 a[160:175], v[96:99], v[32:35], a[160:175]
    v_mfma_f32_32x32x16_bf16 a[224:239], v[96:99], v[36:39], a[224:239]
    v_mfma_f32_32x32x16_bf16 a[176:191], v[100:103], v[32:35], a[176:191]
    v_mfma_f32_32x32x16_bf16 a[240:255], v[100:103], v[36:39], a[240:255]
    v_mfma_f32_32x32x16_bf16 a[0:15], v[40:43], v[24:27], a[0:15]
    s_waitcnt lgkmcnt(10)
    ds_read_b128 v[32:35], v5 offset:0
    ds_read_b64_tr_b16 v[72:73], v8 offset:36864
    v_mfma_f32_32x32x16_bf16 a[64:79], v[40:43], v[28:31], a[64:79]
    ds_read_b64_tr_b16 v[74:75], v8 offset:37888
    ds_read_b128 v[36:39], v5 offset:4096
    v_mfma_f32_32x32x16_bf16 a[16:31], v[44:47], v[24:27], a[16:31]
    s_waitcnt lgkmcnt(10)
    ds_read_b64_tr_b16 v[76:77], v9 offset:36864
    ds_read_b64_tr_b16 v[78:79], v9 offset:37888
    v_mfma_f32_32x32x16_bf16 a[80:95], v[44:47], v[28:31], a[80:95]
    ds_read_b64_tr_b16 v[80:81], v10 offset:36864
    ds_read_b64_tr_b16 v[82:83], v10 offset:37888
    v_mfma_f32_32x32x16_bf16 a[32:47], v[48:51], v[24:27], a[32:47]
    s_waitcnt lgkmcnt(10)
    ds_read_b64_tr_b16 v[84:85], v11 offset:36864
    ds_read_b64_tr_b16 v[86:87], v11 offset:37888
    v_mfma_f32_32x32x16_bf16 a[96:111], v[48:51], v[28:31], a[96:111]
    ds_read_b64_tr_b16 v[88:89], v8 offset:53248
    ds_read_b64_tr_b16 v[90:91], v8 offset:54272
    v_mfma_f32_32x32x16_bf16 a[48:63], v[52:55], v[24:27], a[48:63]
    s_waitcnt lgkmcnt(10)
    ds_read_b64_tr_b16 v[92:93], v9 offset:53248
    ds_read_b64_tr_b16 v[94:95], v9 offset:54272
    v_mfma_f32_32x32x16_bf16 a[112:127], v[52:55], v[28:31], a[112:127]
    ds_read_b64_tr_b16 v[96:97], v10 offset:53248
    ds_read_b64_tr_b16 v[98:99], v10 offset:54272
    v_mfma_f32_32x32x16_bf16 a[128:143], v[56:59], v[24:27], a[128:143]
    s_waitcnt lgkmcnt(10)
    ds_read_b64_tr_b16 v[100:101], v11 offset:53248
    ds_read_b64_tr_b16 v[102:103], v11 offset:54272
    v_mfma_f32_32x32x16_bf16 a[192:207], v[56:59], v[28:31], a[192:207]
    v_mfma_f32_32x32x16_bf16 a[144:159], v[60:63], v[24:27], a[144:159]
    v_mfma_f32_32x32x16_bf16 a[208:223], v[60:63], v[28:31], a[208:223]
    v_mfma_f32_32x32x16_bf16 a[160:175], v[64:67], v[24:27], a[160:175]
    v_mfma_f32_32x32x16_bf16 a[224:239], v[64:67], v[28:31], a[224:239]
    v_mfma_f32_32x32x16_bf16 a[176:191], v[68:71], v[24:27], a[176:191]
    v_mfma_f32_32x32x16_bf16 a[240:255], v[68:71], v[28:31], a[240:255]
    v_mfma_f32_32x32x16_bf16 a[0:15], v[72:75], v[32:35], a[0:15]
    ds_read_b128 v[24:27], v6 offset:0
    ds_read_b64_tr_b16 v[40:41], v8 offset:40960
    v_mfma_f32_32x32x16_bf16 a[64:79], v[72:75], v[36:39], a[64:79]
    s_waitcnt lgkmcnt(10)
    ds_read_b64_tr_b16 v[42:43], v8 offset:41984
    ds_read_b128 v[28:31], v6 offset:4096
    v_mfma_f32_32x32x16_bf16 a[16:31], v[76:79], v[32:35], a[16:31]
    ds_read_b64_tr_b16 v[44:45], v9 offset:40960
    ds_read_b64_tr_b16 v[46:47], v9 offset:41984
    v_mfma_f32_32x32x16_bf16 a[80:95], v[76:79], v[36:39], a[80:95]
    s_waitcnt lgkmcnt(10)
    ds_read_b64_tr_b16 v[48:49], v10 offset:40960
    ds_read_b64_tr_b16 v[50:51], v10 offset:41984
    v_mfma_f32_32x32x16_bf16 a[32:47], v[80:83], v[32:35], a[32:47]
    ds_read_b64_tr_b16 v[52:53], v11 offset:40960
    ds_read_b64_tr_b16 v[54:55], v11 offset:41984
    v_mfma_f32_32x32x16_bf16 a[96:111], v[80:83], v[36:39], a[96:111]
    s_waitcnt lgkmcnt(10)
    ds_read_b64_tr_b16 v[56:57], v8 offset:57344
    ds_read_b64_tr_b16 v[58:59], v8 offset:58368
    v_mfma_f32_32x32x16_bf16 a[48:63], v[84:87], v[32:35], a[48:63]
    ds_read_b64_tr_b16 v[60:61], v9 offset:57344
    ds_read_b64_tr_b16 v[62:63], v9 offset:58368
    v_mfma_f32_32x32x16_bf16 a[112:127], v[84:87], v[36:39], a[112:127]
    s_waitcnt lgkmcnt(10)
    ds_read_b64_tr_b16 v[64:65], v10 offset:57344
    ds_read_b64_tr_b16 v[66:67], v10 offset:58368
    v_mfma_f32_32x32x16_bf16 a[128:143], v[88:91], v[32:35], a[128:143]
    ds_read_b64_tr_b16 v[68:69], v11 offset:57344
    ds_read_b64_tr_b16 v[70:71], v11 offset:58368
    v_mfma_f32_32x32x16_bf16 a[192:207], v[88:91], v[36:39], a[192:207]
    v_mfma_f32_32x32x16_bf16 a[144:159], v[92:95], v[32:35], a[144:159]
    v_mfma_f32_32x32x16_bf16 a[208:223], v[92:95], v[36:39], a[208:223]
    v_mfma_f32_32x32x16_bf16 a[160:175], v[96:99], v[32:35], a[160:175]
    v_mfma_f32_32x32x16_bf16 a[224:239], v[96:99], v[36:39], a[224:239]
    v_mfma_f32_32x32x16_bf16 a[176:191], v[100:103], v[32:35], a[176:191]
    v_mfma_f32_32x32x16_bf16 a[240:255], v[100:103], v[36:39], a[240:255]
    v_mfma_f32_32x32x16_bf16 a[0:15], v[40:43], v[24:27], a[0:15]
    s_waitcnt lgkmcnt(10)
    ds_read_b128 v[32:35], v7 offset:0
    ds_read_b64_tr_b16 v[72:73], v8 offset:45056
    v_mfma_f32_32x32x16_bf16 a[64:79], v[40:43], v[28:31], a[64:79]
    ds_read_b64_tr_b16 v[74:75], v8 offset:46080
    ds_read_b128 v[36:39], v7 offset:4096
    v_mfma_f32_32x32x16_bf16 a[16:31], v[44:47], v[24:27], a[16:31]
    s_waitcnt lgkmcnt(10)
    ds_read_b64_tr_b16 v[76:77], v9 offset:45056
    ds_read_b64_tr_b16 v[78:79], v9 offset:46080
    v_mfma_f32_32x32x16_bf16 a[80:95], v[44:47], v[28:31], a[80:95]
    ds_read_b64_tr_b16 v[80:81], v10 offset:45056
    ds_read_b64_tr_b16 v[82:83], v10 offset:46080
    v_mfma_f32_32x32x16_bf16 a[32:47], v[48:51], v[24:27], a[32:47]
    s_waitcnt lgkmcnt(10)
    ds_read_b64_tr_b16 v[84:85], v11 offset:45056
    ds_read_b64_tr_b16 v[86:87], v11 offset:46080
    v_mfma_f32_32x32x16_bf16 a[96:111], v[48:51], v[28:31], a[96:111]
    ds_read_b64_tr_b16 v[88:89], v8 offset:61440
    ds_read_b64_tr_b16 v[90:91], v8 offset:62464
    v_mfma_f32_32x32x16_bf16 a[48:63], v[52:55], v[24:27], a[48:63]
    s_waitcnt lgkmcnt(10)
    ds_read_b64_tr_b16 v[92:93], v9 offset:61440
    ds_read_b64_tr_b16 v[94:95], v9 offset:62464
    v_mfma_f32_32x32x16_bf16 a[112:127], v[52:55], v[28:31], a[112:127]
    ds_read_b64_tr_b16 v[96:97], v10 offset:61440
    ds_read_b64_tr_b16 v[98:99], v10 offset:62464
    v_mfma_f32_32x32x16_bf16 a[128:143], v[56:59], v[24:27], a[128:143]
    s_waitcnt lgkmcnt(10)
    ds_read_b64_tr_b16 v[100:101], v11 offset:61440
    ds_read_b64_tr_b16 v[102:103], v11 offset:62464
    v_mfma_f32_32x32x16_bf16 a[192:207], v[56:59], v[28:31], a[192:207]
    v_mfma_f32_32x32x16_bf16 a[144:159], v[60:63], v[24:27], a[144:159]
    v_xor_b32 v4, 0x10000, v4
    v_xor_b32 v5, 0x10000, v5
    v_mfma_f32_32x32x16_bf16 a[208:223], v[60:63], v[28:31], a[208:223]
    v_xor_b32 v6, 0x10000, v6
    v_xor_b32 v7, 0x10000, v7
    v_mfma_f32_32x32x16_bf16 a[160:175], v[64:67], v[24:27], a[160:175]
    v_xor_b32 v8, 0x10000, v8
    v_xor_b32 v9, 0x10000, v9
    v_mfma_f32_32x32x16_bf16 a[224:239], v[64:67], v[28:31], a[224:239]
    v_xor_b32 v10, 0x10000, v10
    v_xor_b32 v11, 0x10000, v11
    v_mfma_f32_32x32x16_bf16 a[176:191], v[68:71], v[24:27], a[176:191]
    v_xor_b32 v12, 0x10000, v12
    v_xor_b32 v13, 0x10000, v13
    v_mfma_f32_32x32x16_bf16 a[240:255], v[68:71], v[28:31], a[240:255]
    v_xor_b32 v14, 0x10000, v14
    v_xor_b32 v15, 0x10000, v15
    v_mfma_f32_32x32x16_bf16 a[0:15], v[72:75], v[32:35], a[0:15]
    v_mfma_f32_32x32x16_bf16 a[64:79], v[72:75], v[36:39], a[64:79]
    v_mfma_f32_32x32x16_bf16 a[16:31], v[76:79], v[32:35], a[16:31]
    v_mfma_f32_32x32x16_bf16 a[80:95], v[76:79], v[36:39], a[80:95]
    s_waitcnt lgkmcnt(10)
    v_mfma_f32_32x32x16_bf16 a[32:47], v[80:83], v[32:35], a[32:47]
    v_mfma_f32_32x32x16_bf16 a[96:111], v[80:83], v[36:39], a[96:111]
    s_waitcnt lgkmcnt(8)
    v_mfma_f32_32x32x16_bf16 a[48:63], v[84:87], v[32:35], a[48:63]
    v_mfma_f32_32x32x16_bf16 a[112:127], v[84:87], v[36:39], a[112:127]
    s_waitcnt lgkmcnt(6)
    v_mfma_f32_32x32x16_bf16 a[128:143], v[88:91], v[32:35], a[128:143]
    v_mfma_f32_32x32x16_bf16 a[192:207], v[88:91], v[36:39], a[192:207]
    s_waitcnt lgkmcnt(4)
    v_mfma_f32_32x32x16_bf16 a[144:159], v[92:95], v[32:35], a[144:159]
    v_mfma_f32_32x32x16_bf16 a[208:223], v[92:95], v[36:39], a[208:223]
    s_waitcnt lgkmcnt(2)
    v_mfma_f32_32x32x16_bf16 a[160:175], v[96:99], v[32:35], a[160:175]
    v_mfma_f32_32x32x16_bf16 a[224:239], v[96:99], v[36:39], a[224:239]
    s_waitcnt lgkmcnt(0)
    v_mfma_f32_32x32x16_bf16 a[176:191], v[100:103], v[32:35], a[176:191]
    v_mfma_f32_32x32x16_bf16 a[240:255], v[100:103], v[36:39], a[240:255]
    s_barrier
    s_branch L_task
L_coreTN:
    s_waitcnt vmcnt(0)
    s_barrier
    ds_read_b128 v[24:27], v4 offset:0
    ds_read_b64_tr_b16 v[40:41], v8 offset:32768
    ds_read_b64_tr_b16 v[42:43], v8 offset:33792
    ds_read_b128 v[28:31], v4 offset:4096
    ds_read_b64_tr_b16 v[44:45], v9 offset:32768
    ds_read_b64_tr_b16 v[46:47], v9 offset:33792
    ds_read_b64_tr_b16 v[48:49], v10 offset:32768
    ds_read_b64_tr_b16 v[50:51], v10 offset:33792
    ds_read_b64_tr_b16 v[52:53], v11 offset:32768
    ds_read_b64_tr_b16 v[54:55], v11 offset:33792
    ds_read_b64_tr_b16 v[56:57], v12 offset:49152
    ds_read_b64_tr_b16 v[58:59], v12 offset:50176
    ds_read_b64_tr_b16 v[60:61], v13 offset:49152
    ds_read_b64_tr_b16 v[62:63], v13 offset:50176
    s_waitcnt lgkmcnt(10)
    ds_read_b64_tr_b16 v[64:65], v14 offset:49152
    ds_read_b64_tr_b16 v[66:67], v14 offset:50176
    ds_read_b64_tr_b16 v[68:69], v15 offset:49152
    ds_read_b64_tr_b16 v[70:71], v15 offset:50176
    v_mfma_f32_32x32x16_bf16 a[0:15], v[40:43], v[24:27], 0
    s_waitcnt lgkmcnt(10)
    ds_read_b128 v[32:35], v5 offset:0
    ds_read_b64_tr_b16 v[72:73], v8 offset:36864
    v_mfma_f32_32x32x16_bf16 a[64:79], v[40:43], v[28:31], 0
    ds_read_b64_tr_b16 v[74:75], v8 offset:37888
    ds_read_b128 v[36:39], v5 offset:4096
    s_add_u32 m0, s37, 65536
    s_add_u32 s39, s32, 0
    buffer_load_dwordx4 v1, s[12:15], s39 offen  lds
    v_mfma_f32_32x32x16_bf16 a[16:31], v[44:47], v[24:27], 0
    s_waitcnt lgkmcnt(10)
    ds_read_b64_tr_b16 v[76:77], v9 offset:36864
    ds_read_b64_tr_b16 v[78:79], v9 offset:37888
    v_mfma_f32_32x32x16_bf16 a[80:95], v[44:47], v[28:31], 0
    ds_read_b64_tr_b16 v[80:81], v10 offset:36864
    ds_read_b64_tr_b16 v[82:83], v10 offset:37888
    s_add_u32 m0, s37, 66560
    s_add_u32 s39, s32, 10240
    buffer_load_dwordx4 v2, s[12:15], s39 offen  lds
    v_mfma_f32_32x32x16_bf16 a[32:47], v[48:51], v[24:27], 0
    s_waitcnt lgkmcnt(10)
    ds_read_b64_tr_b16 v[84:85], v11 offset:36864
    ds_read_b64_tr_b16 v[86:87], v11 offset:37888
    v_mfma_f32_32x32x16_bf16 a[96:111], v[48:51], v[28:31], 0
    ds_read_b64_tr_b16 v[88:89], v12 offset:53248
    ds_read_b64_tr_b16 v[90:91], v12 offset:54272
    s_add_u32 m0, s37, 67584
    s_add_u32 s39, s32, 20480
    buffer_load_dwordx4 v1, s[12:15], s39 offen  lds
    v_mfma_f32_32x32x16_bf16 a[48:63], v[52:55], v[24:27], 0
    s_waitcnt lgkmcnt(10)
    ds_read_b64_tr_b16 v[92:93], v13 offset:53248
    ds_read_b64_tr_b16 v[94:95], v13 offset:54272
    v_mfma_f32_32x32x16_bf16 a[112:127], v[52:55], v[28:31], 0
    ds_read_b64_tr_b16 v[96:97], v14 offset:53248
    ds_read_b64_tr_b16 v[98:99], v14 offset:54272
    s_add_u32 m0, s37, 68608
    s_add_u32 s39, s32, 30720
    buffer_load_dwordx4 v2, s[12:15], s39 offen  lds
    v_mfma_f32_32x32x16_bf16 a[128:143], v[24:27], v[56:59], 0
    s_waitcnt lgkmcnt(10)
    ds_read_b64_tr_b16 v[100:101], v15 offset:53248
    ds_read_b64_tr_b16 v[102:103], v15 offset:54272
    v_mfma_f32_32x32x16_bf16 a[192:207], v[28:31], v[56:59], 0
    s_add_u32 m0, s37, 69632
    s_add_u32 s39, s32, 40960
    buffer_load_dwordx4 v1, s[12:15], s39 offen  lds
    v_mfma_f32_32x32x16_bf16 a[144:159], v[24:27], v[60:63], 0
    v_mfma_f32_32x32x16_bf16 a[208:223], v[28:31], v[60:63], 0
    s_add_u32 m0, s37, 70656
    s_add_u32 s39, s32, 51200
    buffer_load_dwordx4 v2, s[12:15], s39 offen  lds
    v_mfma_f32_32x32x16_bf16 a[160:175], v[24:27], v[64:67], 0
    v_mfma_f32_32x32x16_bf16 a[224:239], v[28:31], v[64:67], 0
    s_add_u32 m0, s37, 71680
    s_add_u32 s39, s32, 61440
    buffer_load_dwordx4 v1, s[12:15], s39 offen  lds
    v_mfma_f32_32x32x16_bf16 a[176:191], v[24:27], v[68:71], 0
    v_mfma_f32_32x32x16_bf16 a[240:255], v[28:31], v[68:71], 0
    s_add_u32 m0, s37, 72704
    s_add_u32 s39, s32, 71680
    buffer_load_dwordx4 v2, s[12:15], s39 offen  lds
    s_add_u32 s32, s32, 128
    v_mfma_f32_32x32x16_bf16 a[0:15], v[72:75], v[32:35], a[0:15]
    ds_read_b128 v[24:27], v6 offset:0
    ds_read_b64_tr_b16 v[40:41], v8 offset:40960
    v_mfma_f32_32x32x16_bf16 a[64:79], v[72:75], v[36:39], a[64:79]
    s_waitcnt lgkmcnt(10)
    ds_read_b64_tr_b16 v[42:43], v8 offset:41984
    ds_read_b128 v[28:31], v6 offset:4096
    buffer_store_dwordx4 v[104:107], v20, s[88:91], s92 offen sc1
    s_add_u32 s92, s92, s93
    v_mfma_f32_32x32x16_bf16 a[16:31], v[76:79], v[32:35], a[16:31]
    ds_read_b64_tr_b16 v[44:45], v9 offset:40960
    ds_read_b64_tr_b16 v[46:47], v9 offset:41984
    v_mfma_f32_32x32x16_bf16 a[80:95], v[76:79], v[36:39], a[80:95]
    s_waitcnt lgkmcnt(10)
    ds_read_b64_tr_b16 v[48:49], v10 offset:40960
    ds_read_b64_tr_b16 v[50:51], v10 offset:41984
    v_mfma_f32_32x32x16_bf16 a[32:47], v[80:83], v[32:35], a[32:47]
    ds_read_b64_tr_b16 v[52:53], v11 offset:40960
    ds_read_b64_tr_b16 v[54:55], v11 offset:41984
    buffer_store_dwordx4 v[108:111], v20, s[88:91], s92 offen sc1
    s_add_u32 s92, s92, s94
    v_mfma_f32_32x32x16_bf16 a[96:111], v[80:83], v[36:39], a[96:111]
    s_waitcnt lgkmcnt(10)
    ds_read_b64_tr_b16 v[56:57], v12 offset:57344
    ds_read_b64_tr_b16 v[58:59], v12 offset:58368
    v_mfma_f32_32x32x16_bf16 a[48:63], v[84:87], v[32:35], a[48:63]
    ds_read_b64_tr_b16 v[60:61], v13 offset:57344
    ds_read_b64_tr_b16 v[62:63], v13 offset:58368
    v_mfma_f32_32x32x16_bf16 a[112:127], v[84:87], v[36:39], a[112:127]
    s_waitcnt lgkmcnt(10)
    ds_read_b64_tr_b16 v[64:65], v14 offset:57344
    ds_read_b64_tr_b16 v[66:67], v14 offset:58368
    buffer_store_dwordx4 v[112:115], v20, s[88:91], s92 offen sc1
    s_add_u32 s92, s92, s93
    v_mfma_f32_32x32x16_bf16 a[128:143], v[32:35], v[88:91], a[128:143]
    ds_read_b64_tr_b16 v[68:69], v15 offset:57344
    ds_read_b64_tr_b16 v[70:71], v15 offset:58368
    v_mfma_f32_32x32x16_bf16 a[192:207], v[36:39], v[88:91], a[192:207]
    v_mfma_f32_32x32x16_bf16 a[144:159], v[32:35], v[92:95], a[144:159]
    buffer_store_dwordx4 v[116:119], v20, s[88:91], s92 offen sc1
    s_add_u32 s92, s92, s94
    v_mfma_f32_32x32x16_bf16 a[208:223], v[36:39], v[92:95], a[208:223]
    v_mfma_f32_32x32x16_bf16 a[160:175], v[32:35], v[96:99], a[160:175]
    v_mfma_f32_32x32x16_bf16 a[224:239], v[36:39], v[96:99], a[224:239]
    v_mfma_f32_32x32x16_bf16 a[176:191], v[32:35], v[100:103], a[176:191]
    v_mfma_f32_32x32x16_bf16 a[240:255], v[36:39], v[100:103], a[240:255]
    v_mfma_f32_32x32x16_bf16 a[0:15], v[40:43], v[24:27], a[0:15]
    s_waitcnt lgkmcnt(10)
    ds_read_b128 v[32:35], v7 offset:0
    ds_read_b64_tr_b16 v[72:73], v8 offset:45056
    v_mfma_f32_32x32x16_bf16 a[64:79], v[40:43], v[28:31], a[64:79]
    ds_read_b64_tr_b16 v[74:75], v8 offset:46080
    ds_read_b128 v[36:39], v7 offset:4096
    v_mfma_f32_32x32x16_bf16 a[16:31], v[44:47], v[24:27], a[16:31]
    s_waitcnt lgkmcnt(10)
    ds_read_b64_tr_b16 v[76:77], v9 offset:45056
    ds_read_b64_tr_b16 v[78:79], v9 offset:46080
    v_mfma_f32_32x32x16_bf16 a[80:95], v[44:47], v[28:31], a[80:95]
    ds_read_b64_tr_b16 v[80:81], v10 offset:45056
    ds_read_b64_tr_b16 v[82:83], v10 offset:46080
    v_mfma_f32_32x32x16_bf16 a[32:47], v[48:51], v[24:27], a[32:47]
    s_waitcnt lgkmcnt(10)
    ds_read_b64_tr_b16 v[84:85], v11 offset:45056
    ds_read_b64_tr_b16 v[86:87], v11 offset:46080
    v_mfma_f32_32x32x16_bf16 a[96:111], v[48:51], v[28:31], a[96:111]
    ds_read_b64_tr_b16 v[88:89], v12 offset:61440
    ds_read_b64_tr_b16 v[90:91], v12 offset:62464
    v_mfma_f32_32x32x16_bf16 a[48:63], v[52:55], v[24:27], a[48:63]
    s_waitcnt lgkmcnt(10)
    ds_read_b64_tr_b16 v[92:93], v13 offset:61440
    ds_read_b64_tr_b16 v[94:95], v13 offset:62464
    v_mfma_f32_32x32x16_bf16 a[112:127], v[52:55], v[28:31], a[112:127]
    ds_read_b64_tr_b16 v[96:97], v14 offset:61440
    ds_read_b64_tr_b16 v[98:99], v14 offset:62464
    v_mfma_f32_32x32x16_bf16 a[128:143], v[24:27], v[56:59], a[128:143]
    s_waitcnt lgkmcnt(10)
    ds_read_b64_tr_b16 v[100:101], v15 offset:61440
    ds_read_b64_tr_b16 v[102:103], v15 offset:62464
    v_mfma_f32_32x32x16_bf16 a[192:207], v[28:31], v[56:59], a[192:207]
    v_mfma_f32_32x32x16_bf16 a[144:159], v[24:27], v[60:63], a[144:159]
    v_xor_b32 v4, 0x10000, v4
    v_xor_b32 v5, 0x10000, v5
    v_mfma_f32_32x32x16_bf16 a[208:223], v[28:31], v[60:63], a[208:223]
    v_xor_b32 v6, 0x10000, v6
    v_xor_b32 v7, 0x10000, v7
    v_mfma_f32_32x32x16_bf16 a[160:175], v[24:27], v[64:67], a[160:175]
    v_xor_b32 v8, 0x10000, v8
    v_xor_b32 v9, 0x10000, v9
    v_mfma_f32_32x32x16_bf16 a[224:239], v[28:31], v[64:67], a[224:239]
    v_xor_b32 v10, 0x10000, v10
    v_xor_b32 v11, 0x10000, v11
    v_mfma_f32_32x32x16_bf16 a[176:191], v[24:27], v[68:71], a[176:191]
    v_xor_b32 v12, 0x10000, v12
    v_xor_b32 v13, 0x10000, v13
    v_mfma_f32_32x32x16_bf16 a[240:255], v[28:31], v[68:71], a[240:255]
    v_xor_b32 v14, 0x10000, v14
    v_xor_b32 v15, 0x10000, v15
    s_waitcnt vmcnt(0) lgkmcnt(0)
    s_barrier
    v_mfma_f32_32x32x16_bf16 a[0:15], v[72:75], v[32:35], a[0:15]
    ds_read_b128 v[24:27], v4 offset:0
    ds_read_b64_tr_b16 v[40:41], v8 offset:32768
    v_mfma_f32_32x32x16_bf16 a[64:79], v[72:75], v[36:39], a[64:79]
    ds_read_b64_tr_b16 v[42:43], v8 offset:33792
    ds_read_b128 v[28:31], v4 offset:4096
    s_add_u32 m0, s38, 0
    s_mov_b32 s40, s33
    buffer_load_dwordx4 v3, s[20:23], s40 offen  lds
    v_mfma_f32_32x32x16_bf16 a[16:31], v[76:79], v[32:35], a[16:31]
    ds_read_b64_tr_b16 v[44:45], v9 offset:32768
    ds_read_b64_tr_b16 v[46:47], v9 offset:33792
    v_mfma_f32_32x32x16_bf16 a[80:95], v[76:79], v[36:39], a[80:95]
    ds_read_b64_tr_b16 v[48:49], v10 offset:32768
    ds_read_b64_tr_b16 v[50:51], v10 offset:33792
    s_add_u32 m0, s38, 1024
    s_add_u32 s40, s40, s35
    buffer_load_dwordx4 v3, s[20:23], s40 offen  lds
    v_mfma_f32_32x32x16_bf16 a[32:47], v[80:83], v[32:35], a[32:47]
    ds_read_b64_tr_b16 v[52:53], v11 offset:32768
    ds_read_b64_tr_b16 v[54:55], v11 offset:33792
    v_mfma_f32_32x32x16_bf16 a[96:111], v[80:83], v[36:39], a[96:111]
    ds_read_b64_tr_b16 v[56:57], v12 offset:49152
    ds_read_b64_tr_b16 v[58:59], v12 offset:50176
    s_add_u32 m0, s38, 2048
    s_add_u32 s40, s40, s35
    buffer_load_dwordx4 v3, s[20:23], s40 offen  lds
    v_mfma_f32_32x32x16_bf16 a[48:63], v[84:87], v[32:35], a[48:63]
    ds_read_b64_tr_b16 v[60:61], v13 offset:49152
    ds_read_b64_tr_b16 v[62:63], v13 offset:50176
    v_mfma_f32_32x32x16_bf16 a[112:127], v[84:87], v[36:39], a[112:127]
    s_waitcnt lgkmcnt(10)
    ds_read_b64_tr_b16 v[64:65], v14 offset:49152
    ds_read_b64_tr_b16 v[66:67], v14 offset:50176
    s_add_u32 m0, s38, 3072
    s_add_u32 s40, s40, s35
    buffer_load_dwordx4 v3, s[20:23], s40 offen  lds
    v_mfma_f32_32x32x16_bf16 a[128:143], v[32:35], v[88:91], a[128:143]
    ds_read_b64_tr_b16 v[68:69], v15 offset:49152
    ds_read_b64_tr_b16 v[70:71], v15 offset:50176
    v_mfma_f32_32x32x16_bf16 a[192:207], v[36:39], v[88:91], a[192:207]
    s_add_u32 m0, s38, 16384
    s_mov_b32 s40, s34
    buffer_load_dwordx4 v3, s[24:27], s40 offen  lds
    v_mfma_f32_32x32x16_bf16 a[144:159], v[32:35], v[92:95], a[144:159]
    v_mfma_f32_32x32x16_bf16 a[208:223], v[36:39], v[92:95], a[208:223]
    s_add_u32 m0, s38, 17408
    s_add_u32 s40, s40, s35
    buffer_load_dwordx4 v3, s[24:27], s40 offen  lds
    v_mfma_f32_32x32x16_bf16 a[160:175], v[32:35], v[96:99], a[160:175]
    v_mfma_f32_32x32x16_bf16 a[224:239], v[36:39], v[96:99], a[224:239]
    s_add_u32 m0, s38, 18432
    s_add_u32 s40, s40, s35
    buffer_load_dwordx4 v3, s[24:27], s40 offen  lds
    v_mfma_f32_32x32x16_bf16 a[176:191], v[32:35], v[100:103], a[176:191]
    v_mfma_f32_32x32x16_bf16 a[240:255], v[36:39], v[100:103], a[240:255]
    s_add_u32 m0, s38, 19456
    s_add_u32 s40, s40, s35
    buffer_load_dwordx4 v3, s[24:27], s40 offen  lds
    s_add_u32 s33, s33, s36
    s_add_u32 s34, s34, s36
    v_mfma_f32_32x32x16_bf16 a[0:15], v[40:43], v[24:27], a[0:15]
    s_waitcnt lgkmcnt(10)
    ds_read_b128 v[32:35], v5 offset:0
    ds_read_b64_tr_b16 v[72:73], v8 offset:36864
    v_mfma_f32_32x32x16_bf16 a[64:79], v[40:43], v[28:31], a[64:79]
    ds_read_b64_tr_b16 v[74:75], v8 offset:37888
    ds_read_b128 v[36:39], v5 offset:4096
    s_add_u32 m0, s37, 0
    s_add_u32 s39, s32, 0
    buffer_load_dwordx4 v1, s[12:15], s39 offen  lds
    v_mfma_f32_32x32x16_bf16 a[16:31], v[44:47], v[24:27], a[16:31]
    s_waitcnt lgkmcnt(10)
    ds_read_b64_tr_b16 v[76:77], v9 offset:36864
    ds_read_b64_tr_b16 v[78:79], v9 offset:37888
    v_mfma_f32_32x32x16_bf16 a[80:95], v[44:47], v[28:31], a[80:95]
    ds_read_b64_tr_b16 v[80:81], v10 offset:36864
    ds_read_b64_tr_b16 v[82:83], v10 offset:37888
    s_add_u32 m0, s37, 1024
    s_add_u32 s39, s32, 10240
    buffer_load_dwordx4 v2, s[12:15], s39 offen  lds
    v_mfma_f32_32x32x16_bf16 a[32:47], v[48:51], v[24:27], a[32:47]
    s_waitcnt lgkmcnt(10)
    ds_read_b64_tr_b16 v[84:85], v11 offset:36864
    ds_read_b64_tr_b16 v[86:87], v11 offset:37888
    v_mfma_f32_32x32x16_bf16 a[96:111], v[48:51], v[28:31], a[96:111]
    ds_read_b64_tr_b16 v[88:89], v12 offset:53248
    ds_read_b64_tr_b16 v[90:91], v12 offset:54272
    s_add_u32 m0, s37, 2048
    s_add_u32 s39, s32, 20480
    buffer_load_dwordx4 v1, s[12:15], s39 offen  lds
    v_mfma_f32_32x32x16_bf16 a[48:63], v[52:55], v[24:27], a[48:63]
    s_waitcnt lgkmcnt(10)
    ds_read_b64_tr_b16 v[92:93], v13 offset:53248
    ds_read_b64_tr_b16 v[94:95], v13 offset:54272
    v_mfma_f32_32x32x16_bf16 a[112:127], v[52:55], v[28:31], a[112:127]
    ds_read_b64_tr_b16 v[96:97], v14 offset:53248
    ds_read_b64_tr_b16 v[98:99], v14 offset:54272
    s_add_u32 m0, s37, 3072
    s_add_u32 s39, s32, 30720
    buffer_load_dwordx4 v2, s[12:15], s39 offen  lds
    v_mfma_f32_32x32x16_bf16 a[128:143], v[24:27], v[56:59], a[128:143]
    s_waitcnt lgkmcnt(10)
    ds_read_b64_tr_b16 v[100:101], v15 offset:53248
    ds_read_b64_tr_b16 v[102:103], v15 offset:54272
    v_mfma_f32_32x32x16_bf16 a[192:207], v[28:31], v[56:59], a[192:207]
    s_add_u32 m0, s37, 4096
    s_add_u32 s39, s32, 40960
    buffer_load_dwordx4 v1, s[12:15], s39 offen  lds
    v_mfma_f32_32x32x16_bf16 a[144:159], v[24:27], v[60:63], a[144:159]
    v_mfma_f32_32x32x16_bf16 a[208:223], v[28:31], v[60:63], a[208:223]
    s_add_u32 m0, s37, 5120
    s_add_u32 s39, s32, 51200
    buffer_load_dwordx4 v2, s[12:15], s39 offen  lds
    v_mfma_f32_32x32x16_bf16 a[160:175], v[24:27], v[64:67], a[160:175]
    v_mfma_f32_32x32x16_bf16 a[224:239], v[28:31], v[64:67], a[224:239]
    s_add_u32 m0, s37, 6144
    s_add_u32 s39, s32, 61440
    buffer_load_dwordx4 v1, s[12:15], s39 offen  lds
    v_mfma_f32_32x32x16_bf16 a[176:191], v[24:27], v[68:71], a[176:191]
    v_mfma_f32_32x32x16_bf16 a[240:255], v[28:31], v[68:71], a[240:255]
    s_add_u32 m0, s37, 7168
    s_add_u32 s39, s32, 71680
    buffer_load_dwordx4 v2, s[12:15], s39 offen  lds
    s_add_u32 s32, s32, 128
    v_mfma_f32_32x32x16_bf16 a[0:15], v[72:75], v[32:35], a[0:15]
    ds_read_b128 v[24:27], v6 offset:0
    ds_read_b64_tr_b16 v[40:41], v8 offset:40960
    v_mfma_f32_32x32x16_bf16 a[64:79], v[72:75], v[36:39], a[64:79]
    s_waitcnt lgkmcnt(10)
    ds_read_b64_tr_b16 v[42:43], v8 offset:41984
    ds_read_b128 v[28:31], v6 offset:4096
    buffer_store_dwordx4 v[120:123], v20, s[88:91], s92 offen sc1
    s_add_u32 s92, s92, s93
    v_mfma_f32_32x32x16_bf16 a[16:31], v[76:79], v[32:35], a[16:31]
    ds_read_b64_tr_b16 v[44:45], v9 offset:40960
    ds_read_b64_tr_b16 v[46:47], v9 offset:41984
    v_mfma_f32_32x32x16_bf16 a[80:95], v[76:79], v[36:39], a[80:95]
    s_waitcnt lgkmcnt(10)
    ds_read_b64_tr_b16 v[48:49], v10 offset:40960
    ds_read_b64_tr_b16 v[50:51], v10 offset:41984
    v_mfma_f32_32x32x16_bf16 a[32:47], v[80:83], v[32:35], a[32:47]
    ds_read_b64_tr_b16 v[52:53], v11 offset:40960
    ds_read_b64_tr_b16 v[54:55], v11 offset:41984
    buffer_store_dwordx4 v[124:127], v20, s[88:91], s92 offen sc1
    s_add_u32 s92, s92, s94
    v_mfma_f32_32x32x16_bf16 a[96:111], v[80:83], v[36:39], a[96:111]
    s_waitcnt lgkmcnt(10)
    ds_read_b64_tr_b16 v[56:57], v12 offset:57344
    ds_read_b64_tr_b16 v[58:59], v12 offset:58368
    v_mfma_f32_32x32x16_bf16 a[48:63], v[84:87], v[32:35], a[48:63]
    ds_read_b64_tr_b16 v[60:61], v13 offset:57344
    ds_read_b64_tr_b16 v[62:63], v13 offset:58368
    v_mfma_f32_32x32x16_bf16 a[112:127], v[84:87], v[36:39], a[112:127]
    s_waitcnt lgkmcnt(10)
    ds_read_b64_tr_b16 v[64:65], v14 offset:57344
    ds_read_b64_tr_b16 v[66:67], v14 offset:58368
    buffer_store_dwordx4 v[128:131], v20, s[88:91], s92 offen sc1
    s_add_u32 s92, s92, s93
    v_mfma_f32_32x32x16_bf16 a[128:143], v[32:35], v[88:91], a[128:143]
    ds_read_b64_tr_b16 v[68:69], v15 offset:57344
    ds_read_b64_tr_b16 v[70:71], v15 offset:58368
    v_mfma_f32_32x32x16_bf16 a[192:207], v[36:39], v[88:91], a[192:207]
    v_mfma_f32_32x32x16_bf16 a[144:159], v[32:35], v[92:95], a[144:159]
    buffer_store_dwordx4 v[132:135], v20, s[88:91], s92 offen sc1
    s_add_u32 s92, s92, s95
    v_mfma_f32_32x32x16_bf16 a[208:223], v[36:39], v[92:95], a[208:223]
    v_mfma_f32_32x32x16_bf16 a[160:175], v[32:35], v[96:99], a[160:175]
    v_mfma_f32_32x32x16_bf16 a[224:239], v[36:39], v[96:99], a[224:239]
    v_mfma_f32_32x32x16_bf16 a[176:191], v[32:35], v[100:103], a[176:191]
    v_mfma_f32_32x32x16_bf16 a[240:255], v[36:39], v[100:103], a[240:255]
    v_mfma_f32_32x32x16_bf16 a[0:15], v[40:43], v[24:27], a[0:15]
    s_waitcnt lgkmcnt(10)
    ds_read_b128 v[32:35], v7 offset:0
    ds_read_b64_tr_b16 v[72:73], v8 offset:45056
    v_mfma_f32_32x32x16_bf16 a[64:79], v[40:43], v[28:31], a[64:79]
    ds_read_b64_tr_b16 v[74:75], v8 offset:46080
    ds_read_b128 v[36:39], v7 offset:4096
    v_mfma_f32_32x32x16_bf16 a[16:31], v[44:47], v[24:27], a[16:31]
    s_waitcnt lgkmcnt(10)
    ds_read_b64_tr_b16 v[76:77], v9 offset:45056
    ds_read_b64_tr_b16 v[78:79], v9 offset:46080
    v_mfma_f32_32x32x16_bf16 a[80:95], v[44:47], v[28:31], a[80:95]
    ds_read_b64_tr_b16 v[80:81], v10 offset:45056
    ds_read_b64_tr_b16 v[82:83], v10 offset:46080
    v_mfma_f32_32x32x16_bf16 a[32:47], v[48:51], v[24:27], a[32:47]
    s_waitcnt lgkmcnt(10)
    ds_read_b64_tr_b16 v[84:85], v11 offset:45056
    ds_read_b64_tr_b16 v[86:87], v11 offset:46080
    v_mfma_f32_32x32x16_bf16 a[96:111], v[48:51], v[28:31], a[96:111]
    ds_read_b64_tr_b16 v[88:89], v12 offset:61440
    ds_read_b64_tr_b16 v[90:91], v12 offset:62464
    v_mfma_f32_32x32x16_bf16 a[48:63], v[52:55], v[24:27], a[48:63]
    s_waitcnt lgkmcnt(10)
    ds_read_b64_tr_b16 v[92:93], v13 offset:61440
    ds_read_b64_tr_b16 v[94:95], v13 offset:62464
    v_mfma_f32_32x32x16_bf16 a[112:127], v[52:55], v[28:31], a[112:127]
    ds_read_b64_tr_b16 v[96:97], v14 offset:61440
    ds_read_b64_tr_b16 v[98:99], v14 offset:62464
    v_mfma_f32_32x32x16_bf16 a[128:143], v[24:27], v[56:59], a[128:143]
    s_waitcnt lgkmcnt(10)
    ds_read_b64_tr_b16 v[100:101], v15 offset:61440
    ds_read_b64_tr_b16 v[102:103], v15 offset:62464
    v_mfma_f32_32x32x16_bf16 a[192:207], v[28:31], v[56:59], a[192:207]
    v_mfma_f32_32x32x16_bf16 a[144:159], v[24:27], v[60:63], a[144:159]
    v_xor_b32 v4, 0x10000, v4
    v_xor_b32 v5, 0x10000, v5
    v_mfma_f32_32x32x16_bf16 a[208:223], v[28:31], v[60:63], a[208:223]
    v_xor_b32 v6, 0x10000, v6
    v_xor_b32 v7, 0x10000, v7
    v_mfma_f32_32x32x16_bf16 a[160:175], v[24:27], v[64:67], a[160:175]
    v_xor_b32 v8, 0x10000, v8
    v_xor_b32 v9, 0x10000, v9
    v_mfma_f32_32x32x16_bf16 a[224:239], v[28:31], v[64:67], a[224:239]
    v_xor_b32 v10, 0x10000, v10
    v_xor_b32 v11, 0x10000, v11
    v_mfma_f32_32x32x16_bf16 a[176:191], v[24:27], v[68:71], a[176:191]
    v_xor_b32 v12, 0x10000, v12
    v_xor_b32 v13, 0x10000, v13
    v_mfma_f32_32x32x16_bf16 a[240:255], v[28:31], v[68:71], a[240:255]
    v_xor_b32 v14, 0x10000, v14
    v_xor_b32 v15, 0x10000, v15
    s_waitcnt vmcnt(0) lgkmcnt(0)
    s_barrier
    v_mfma_f32_32x32x16_bf16 a[0:15], v[72:75], v[32:35], a[0:15]
    ds_read_b128 v[24:27], v4 offset:0
    ds_read_b64_tr_b16 v[40:41], v8 offset:32768
    v_mfma_f32_32x32x16_bf16 a[64:79], v[72:75], v[36:39], a[64:79]
    ds_read_b64_tr_b16 v[42:43], v8 offset:33792
    ds_read_b128 v[28:31], v4 offset:4096
    s_add_u32 m0, s38, 65536
    s_mov_b32 s40, s33
    buffer_load_dwordx4 v3, s[20:23], s40 offen  lds
    v_mfma_f32_32x32x16_bf16 a[16:31], v[76:79], v[32:35], a[16:31]
    ds_read_b64_tr_b16 v[44:45], v9 offset:32768
    ds_read_b64_tr_b16 v[46:47], v9 offset:33792
    v_mfma_f32_32x32x16_bf16 a[80:95], v[76:79], v[36:39], a[80:95]
    ds_read_b64_tr_b16 v[48:49], v10 offset:32768
    ds_read_b64_tr_b16 v[50:51], v10 offset:33792
    s_add_u32 m0, s38, 66560
    s_add_u32 s40, s40, s35
    buffer_load_dwordx4 v3, s[20:23], s40 offen  lds
    v_mfma_f32_32x32x16_bf16 a[32:47], v[80:83], v[32:35], a[32:47]
    ds_read_b64_tr_b16 v[52:53], v11 offset:32768
    ds_read_b64_tr_b16 v[54:55], v11 offset:33792
    v_mfma_f32_32x32x16_bf16 a[96:111], v[80:83], v[36:39], a[96:111]
    ds_read_b64_tr_b16 v[56:57], v12 offset:49152
    ds_read_b64_tr_b16 v[58:59], v12 offset:50176
    s_add_u32 m0, s38, 67584
    s_add_u32 s40, s40, s35
    buffer_load_dwordx4 v3, s[20:23], s40 offen  lds
    v_mfma_f32_32x32x16_bf16 a[48:63], v[84:87], v[32:35], a[48:63]
    ds_read_b64_tr_b16 v[60:61], v13 offset:49152
    ds_read_b64_tr_b16 v[62:63], v13 offset:50176
    v_mfma_f32_32x32x16_bf16 a[112:127], v[84:87], v[36:39], a[112:127]
    s_waitcnt lgkmcnt(10)
    ds_read_b64_tr_b16 v[64:65], v14 offset:49152
    ds_read_b64_tr_b16 v[66:67], v14 offset:50176
    s_add_u32 m0, s38, 68608
    s_add_u32 s40, s40, s35
    buffer_load_dwordx4 v3, s[20:23], s40 offen  lds
    v_mfma_f32_32x32x16_bf16 a[128:143], v[32:35], v[88:91], a[128:143]
    ds_read_b64_tr_b16 v[68:69], v15 offset:49152
    ds_read_b64_tr_b16 v[70:71], v15 offset:50176
    v_mfma_f32_32x32x16_bf16 a[192:207], v[36:39], v[88:91], a[192:207]
    s_add_u32 m0, s38, 81920
    s_mov_b32 s40, s34
    buffer_load_dwordx4 v3, s[24:27], s40 offen  lds
    v_mfma_f32_32x32x16_bf16 a[144:159], v[32:35], v[92:95], a[144:159]
    v_mfma_f32_32x32x16_bf16 a[208:223], v[36:39], v[92:95], a[208:223]
    s_add_u32 m0, s38, 82944
    s_add_u32 s40, s40, s35
    buffer_load_dwordx4 v3, s[24:27], s40 offen  lds
    v_mfma_f32_32x32x16_bf16 a[160:175], v[32:35], v[96:99], a[160:175]
    v_mfma_f32_32x32x16_bf16 a[224:239], v[36:39], v[96:99], a[224:239]
    s_add_u32 m0, s38, 83968
    s_add_u32 s40, s40, s35
    buffer_load_dwordx4 v3, s[24:27], s40 offen  lds
    v_mfma_f32_32x32x16_bf16 a[176:191], v[32:35], v[100:103], a[176:191]
    v_mfma_f32_32x32x16_bf16 a[240:255], v[36:39], v[100:103], a[240:255]
    s_add_u32 m0, s38, 84992
    s_add_u32 s40, s40, s35
    buffer_load_dwordx4 v3, s[24:27], s40 offen  lds
    s_add_u32 s33, s33, s36
    s_add_u32 s34, s34, s36
    v_mfma_f32_32x32x16_bf16 a[0:15], v[40:43], v[24:27], a[0:15]
    s_waitcnt lgkmcnt(10)
    ds_read_b128 v[32:35], v5 offset:0
    ds_read_b64_tr_b16 v[72:73], v8 offset:36864
    v_mfma_f32_32x32x16_bf16 a[64:79], v[40:43], v[28:31], a[64:79]
    ds_read_b64_tr_b16 v[74:75], v8 offset:37888
    ds_read_b128 v[36:39], v5 offset:4096
    s_add_u32 m0, s37, 65536
    s_add_u32 s39, s32, 0
    buffer_load_dwordx4 v1, s[12:15], s39 offen  lds
    v_mfma_f32_32x32x16_bf16 a[16:31], v[44:47], v[24:27], a[16:31]
    s_waitcnt lgkmcnt(10)
    ds_read_b64_tr_b16 v[76:77], v9 offset:36864
    ds_read_b64_tr_b16 v[78:79], v9 offset:37888
    v_mfma_f32_32x32x16_bf16 a[80:95], v[44:47], v[28:31], a[80:95]
    ds_read_b64_tr_b16 v[80:81], v10 offset:36864
    ds_read_b64_tr_b16 v[82:83], v10 offset:37888
    s_add_u32 m0, s37, 66560
    s_add_u32 s39, s32, 10240
    buffer_load_dwordx4 v2, s[12:15], s39 offen  lds
    v_mfma_f32_32x32x16_bf16 a[32:47], v[48:51], v[24:27], a[32:47]
    s_waitcnt lgkmcnt(10)
    ds_read_b64_tr_b16 v[84:85], v11 offset:36864
    ds_read_b64_tr_b16 v[86:87], v11 offset:37888
    v_mfma_f32_32x32x16_bf16 a[96:111], v[48:51], v[28:31], a[96:111]
    ds_read_b64_tr_b16 v[88:89], v12 offset:53248
    ds_read_b64_tr_b16 v[90:91], v12 offset:54272
    s_add_u32 m0, s37, 67584
    s_add_u32 s39, s32, 20480
    buffer_load_dwordx4 v1, s[12:15], s39 offen  lds
    v_mfma_f32_32x32x16_bf16 a[48:63], v[52:55], v[24:27], a[48:63]
    s_waitcnt lgkmcnt(10)
    ds_read_b64_tr_b16 v[92:93], v13 offset:53248
    ds_read_b64_tr_b16 v[94:95], v13 offset:54272
    v_mfma_f32_32x32x16_bf16 a[112:127], v[52:55], v[28:31], a[112:127]
    ds_read_b64_tr_b16 v[96:97], v14 offset:53248
    ds_read_b64_tr_b16 v[98:99], v14 offset:54272
    s_add_u32 m0, s37, 68608
    s_add_u32 s39, s32, 30720
    buffer_load_dwordx4 v2, s[12:15], s39 offen  lds
    v_mfma_f32_32x32x16_bf16 a[128:143], v[24:27], v[56:59], a[128:143]
    s_waitcnt lgkmcnt(10)
    ds_read_b64_tr_b16 v[100:101], v15 offset:53248
    ds_read_b64_tr_b16 v[102:103], v15 offset:54272
    v_mfma_f32_32x32x16_bf16 a[192:207], v[28:31], v[56:59], a[192:207]
    s_add_u32 m0, s37, 69632
    s_add_u32 s39, s32, 40960
    buffer_load_dwordx4 v1, s[12:15], s39 offen  lds
    v_mfma_f32_32x32x16_bf16 a[144:159], v[24:27], v[60:63], a[144:159]
    v_mfma_f32_32x32x16_bf16 a[208:223], v[28:31], v[60:63], a[208:223]
    s_add_u32 m0, s37, 70656
    s_add_u32 s39, s32, 51200
    buffer_load_dwordx4 v2, s[12:15], s39 offen  lds
    v_mfma_f32_32x32x16_bf16 a[160:175], v[24:27], v[64:67], a[160:175]
    v_mfma_f32_32x32x16_bf16 a[224:239], v[28:31], v[64:67], a[224:239]
    s_add_u32 m0, s37, 71680
    s_add_u32 s39, s32, 61440
    buffer_load_dwordx4 v1, s[12:15], s39 offen  lds
    v_mfma_f32_32x32x16_bf16 a[176:191], v[24:27], v[68:71], a[176:191]
    v_mfma_f32_32x32x16_bf16 a[240:255], v[28:31], v[68:71], a[240:255]
    s_add_u32 m0, s37, 72704
    s_add_u32 s39, s32, 71680
    buffer_load_dwordx4 v2, s[12:15], s39 offen  lds
    s_add_u32 s32, s32, 128
    v_mfma_f32_32x32x16_bf16 a[0:15], v[72:75], v[32:35], a[0:15]
    ds_read_b128 v[24:27], v6 offset:0
    ds_read_b64_tr_b16 v[40:41], v8 offset:40960
    v_mfma_f32_32x32x16_bf16 a[64:79], v[72:75], v[36:39], a[64:79]
    s_waitcnt lgkmcnt(10)
    ds_read_b64_tr_b16 v[42:43], v8 offset:41984
    ds_read_b128 v[28:31], v6 offset:4096
    buffer_store_dwordx4 v[136:139], v20, s[88:91], s92 offen sc1
    s_add_u32 s92, s92, s93
    v_mfma_f32_32x32x16_bf16 a[16:31], v[76:79], v[32:35], a[16:31]
    ds_read_b64_tr_b16 v[44:45], v9 offset:40960
    ds_read_b64_tr_b16 v[46:47], v9 offset:41984
    v_mfma_f32_32x32x16_bf16 a[80:95], v[76:79], v[36:39], a[80:95]
    s_waitcnt lgkmcnt(10)
    ds_read_b64_tr_b16 v[48:49], v10 offset:40960
    ds_read_b64_tr_b16 v[50:51], v10 offset:41984
    v_mfma_f32_32x32x16_bf16 a[32:47], v[80:83], v[32:35], a[32:47]
    ds_read_b64_tr_b16 v[52:53], v11 offset:40960
    ds_read_b64_tr_b16 v[54:55], v11 offset:41984
    buffer_store_dwordx4 v[140:143], v20, s[88:91], s92 offen sc1
    s_add_u32 s92, s92, s94
    v_mfma_f32_32x32x16_bf16 a[96:111], v[80:83], v[36:39], a[96:111]
    s_waitcnt lgkmcnt(10)
    ds_read_b64_tr_b16 v[56:57], v12 offset:57344
    ds_read_b64_tr_b16 v[58:59], v12 offset:58368
    v_mfma_f32_32x32x16_bf16 a[48:63], v[84:87], v[32:35], a[48:63]
    ds_read_b64_tr_b16 v[60:61], v13 offset:57344
    ds_read_b64_tr_b16 v[62:63], v13 offset:58368
    v_mfma_f32_32x32x16_bf16 a[112:127], v[84:87], v[36:39], a[112:127]
    s_waitcnt lgkmcnt(10)
    ds_read_b64_tr_b16 v[64:65], v14 offset:57344
    ds_read_b64_tr_b16 v[66:67], v14 offset:58368
    buffer_store_dwordx4 v[144:147], v20, s[88:91], s92 offen sc1
    s_add_u32 s92, s92, s93
    v_mfma_f32_32x32x16_bf16 a[128:143], v[32:35], v[88:91], a[128:143]
    ds_read_b64_tr_b16 v[68:69], v15 offset:57344
    ds_read_b64_tr_b16 v[70:71], v15 offset:58368
    v_mfma_f32_32x32x16_bf16 a[192:207], v[36:39], v[88:91], a[192:207]
    v_mfma_f32_32x32x16_bf16 a[144:159], v[32:35], v[92:95], a[144:159]
    buffer_store_dwordx4 v[148:151], v20, s[88:91], s92 offen sc1
    s_add_u32 s92, s92, s94
    v_mfma_f32_32x32x16_bf16 a[208:223], v[36:39], v[92:95], a[208:223]
    v_mfma_f32_32x32x16_bf16 a[160:175], v[32:35], v[96:99], a[160:175]
    v_mfma_f32_32x32x16_bf16 a[224:239], v[36:39], v[96:99], a[224:239]
    v_mfma_f32_32x32x16_bf16 a[176:191], v[32:35], v[100:103], a[176:191]
    v_mfma_f32_32x32x16_bf16 a[240:255], v[36:39], v[100:103], a[240:255]
    v_mfma_f32_32x32x16_bf16 a[0:15], v[40:43], v[24:27], a[0:15]
    s_waitcnt lgkmcnt(10)
    ds_read_b128 v[32:35], v7 offset:0
    ds_read_b64_tr_b16 v[72:73], v8 offset:45056
    v_mfma_f32_32x32x16_bf16 a[64:79], v[40:43], v[28:31], a[64:79]
    ds_read_b64_tr_b16 v[74:75], v8 offset:46080
    ds_read_b128 v[36:39], v7 offset:4096
    v_mfma_f32_32x32x16_bf16 a[16:31], v[44:47], v[24:27], a[16:31]
    s_waitcnt lgkmcnt(10)
    ds_read_b64_tr_b16 v[76:77], v9 offset:45056
    ds_read_b64_tr_b16 v[78:79], v9 offset:46080
    v_mfma_f32_32x32x16_bf16 a[80:95], v[44:47], v[28:31], a[80:95]
    ds_read_b64_tr_b16 v[80:81], v10 offset:45056
    ds_read_b64_tr_b16 v[82:83], v10 offset:46080
    v_mfma_f32_32x32x16_bf16 a[32:47], v[48:51], v[24:27], a[32:47]
    s_waitcnt lgkmcnt(10)
    ds_read_b64_tr_b16 v[84:85], v11 offset:45056
    ds_read_b64_tr_b16 v[86:87], v11 offset:46080
    v_mfma_f32_32x32x16_bf16 a[96:111], v[48:51], v[28:31], a[96:111]
    ds_read_b64_tr_b16 v[88:89], v12 offset:61440
    ds_read_b64_tr_b16 v[90:91], v12 offset:62464
    v_mfma_f32_32x32x16_bf16 a[48:63], v[52:55], v[24:27], a[48:63]
    s_waitcnt lgkmcnt(10)
    ds_read_b64_tr_b16 v[92:93], v13 offset:61440
    ds_read_b64_tr_b16 v[94:95], v13 offset:62464
    v_mfma_f32_32x32x16_bf16 a[112:127], v[52:55], v[28:31], a[112:127]
    ds_read_b64_tr_b16 v[96:97], v14 offset:61440
    ds_read_b64_tr_b16 v[98:99], v14 offset:62464
    v_mfma_f32_32x32x16_bf16 a[128:143], v[24:27], v[56:59], a[128:143]
    s_waitcnt lgkmcnt(10)
    ds_read_b64_tr_b16 v[100:101], v15 offset:61440
    ds_read_b64_tr_b16 v[102:103], v15 offset:62464
    v_mfma_f32_32x32x16_bf16 a[192:207], v[28:31], v[56:59], a[192:207]
    v_mfma_f32_32x32x16_bf16 a[144:159], v[24:27], v[60:63], a[144:159]
    v_xor_b32 v4, 0x10000, v4
    v_xor_b32 v5, 0x10000, v5
    v_mfma_f32_32x32x16_bf16 a[208:223], v[28:31], v[60:63], a[208:223]
    v_xor_b32 v6, 0x10000, v6
    v_xor_b32 v7, 0x10000, v7
    v_mfma_f32_32x32x16_bf16 a[160:175], v[24:27], v[64:67], a[160:175]
    v_xor_b32 v8, 0x10000, v8
    v_xor_b32 v9, 0x10000, v9
    v_mfma_f32_32x32x16_bf16 a[224:239], v[28:31], v[64:67], a[224:239]
    v_xor_b32 v10, 0x10000, v10
    v_xor_b32 v11, 0x10000, v11
    v_mfma_f32_32x32x16_bf16 a[176:191], v[24:27], v[68:71], a[176:191]
    v_xor_b32 v12, 0x10000, v12
    v_xor_b32 v13, 0x10000, v13
    v_mfma_f32_32x32x16_bf16 a[240:255], v[28:31], v[68:71], a[240:255]
    v_xor_b32 v14, 0x10000, v14
    v_xor_b32 v15, 0x10000, v15
    s_waitcnt vmcnt(0) lgkmcnt(0)
    s_barrier
    v_mfma_f32_32x32x16_bf16 a[0:15], v[72:75], v[32:35], a[0:15]
    ds_read_b128 v[24:27], v4 offset:0
    ds_read_b64_tr_b16 v[40:41], v8 offset:32768
    v_mfma_f32_32x32x16_bf16 a[64:79], v[72:75], v[36:39], a[64:79]
    ds_read_b64_tr_b16 v[42:43], v8 offset:33792
    ds_read_b128 v[28:31], v4 offset:4096
    s_add_u32 m0, s38, 0
    s_mov_b32 s40, s33
    buffer_load_dwordx4 v3, s[20:23], s40 offen  lds
    v_mfma_f32_32x32x16_bf16 a[16:31], v[76:79], v[32:35], a[16:31]
    ds_read_b64_tr_b16 v[44:45], v9 offset:32768
    ds_read_b64_tr_b16 v[46:47], v9 offset:33792
    v_mfma_f32_32x32x16_bf16 a[80:95], v[76:79], v[36:39], a[80:95]
    ds_read_b64_tr_b16 v[48:49], v10 offset:32768
    ds_read_b64_tr_b16 v[50:51], v10 offset:33792
    s_add_u32 m0, s38, 1024
    s_add_u32 s40, s40, s35
    buffer_load_dwordx4 v3, s[20:23], s40 offen  lds
    v_mfma_f32_32x32x16_bf16 a[32:47], v[80:83], v[32:35], a[32:47]
    ds_read_b64_tr_b16 v[52:53], v11 offset:32768
    ds_read_b64_tr_b16 v[54:55], v11 offset:33792
    v_mfma_f32_32x32x16_bf16 a[96:111], v[80:83], v[36:39], a[96:111]
    ds_read_b64_tr_b16 v[56:57], v12 offset:49152
    ds_read_b64_tr_b16 v[58:59], v12 offset:50176
    s_add_u32 m0, s38, 2048
    s_add_u32 s40, s40, s35
    buffer_load_dwordx4 v3, s[20:23], s40 offen  lds
    v_mfma_f32_32x32x16_bf16 a[48:63], v[84:87], v[32:35], a[48:63]
    ds_read_b64_tr_b16 v[60:61], v13 offset:49152
    ds_read_b64_tr_b16 v[62:63], v13 offset:50176
    v_mfma_f32_32x32x16_bf16 a[112:127], v[84:87], v[36:39], a[112:127]
    s_waitcnt lgkmcnt(10)
    ds_read_b64_tr_b16 v[64:65], v14 offset:49152
    ds_read_b64_tr_b16 v[66:67], v14 offset:50176
    s_add_u32 m0, s38, 3072
    s_add_u32 s40, s40, s35
    buffer_load_dwordx4 v3, s[20:23], s40 offen  lds
    v_mfma_f32_32x32x16_bf16 a[128:143], v[32:35], v[88:91], a[128:143]
    ds_read_b64_tr_b16 v[68:69], v15 offset:49152
    ds_read_b64_tr_b16 v[70:71], v15 offset:50176
    v_mfma_f32_32x32x16_bf16 a[192:207], v[36:39], v[88:91], a[192:207]
    s_add_u32 m0, s38, 16384
    s_mov_b32 s40, s34
    buffer_load_dwordx4 v3, s[24:27], s40 offen  lds
    v_mfma_f32_32x32x16_bf16 a[144:159], v[32:35], v[92:95], a[144:159]
    v_mfma_f32_32x32x16_bf16 a[208:223], v[36:39], v[92:95], a[208:223]
    s_add_u32 m0, s38, 17408
    s_add_u32 s40, s40, s35
    buffer_load_dwordx4 v3, s[24:27], s40 offen  lds
    v_mfma_f32_32x32x16_bf16 a[160:175], v[32:35], v[96:99], a[160:175]
    v_mfma_f32_32x32x16_bf16 a[224:239], v[36:39], v[96:99], a[224:239]
    s_add_u32 m0, s38, 18432
    s_add_u32 s40, s40, s35
    buffer_load_dwordx4 v3, s[24:27], s40 offen  lds
    v_mfma_f32_32x32x16_bf16 a[176:191], v[32:35], v[100:103], a[176:191]
    v_mfma_f32_32x32x16_bf16 a[240:255], v[36:39], v[100:103], a[240:255]
    s_add_u32 m0, s38, 19456
    s_add_u32 s40, s40, s35
    buffer_load_dwordx4 v3, s[24:27], s40 offen  lds
    s_add_u32 s33, s33, s36
    s_add_u32 s34, s34, s36
    v_mfma_f32_32x32x16_bf16 a[0:15], v[40:43], v[24:27], a[0:15]
    s_waitcnt lgkmcnt(10)
    ds_read_b128 v[32:35], v5 offset:0
    ds_read_b64_tr_b16 v[72:73], v8 offset:36864
    v_mfma_f32_32x32x16_bf16 a[64:79], v[40:43], v[28:31], a[64:79]
    ds_read_b64_tr_b16 v[74:75], v8 offset:37888
    ds_read_b128 v[36:39], v5 offset:4096
    s_add_u32 m0, s37, 0
    s_add_u32 s39, s32, 0
    buffer_load_dwordx4 v1, s[12:15], s39 offen  lds
    v_mfma_f32_32x32x16_bf16 a[16:31], v[44:47], v[24:27], a[16:31]
    s_waitcnt lgkmcnt(10)
    ds_read_b64_tr_b16 v[76:77], v9 offset:36864
    ds_read_b64_tr_b16 v[78:79], v9 offset:37888
    v_mfma_f32_32x32x16_bf16 a[80:95], v[44:47], v[28:31], a[80:95]
    ds_read_b64_tr_b16 v[80:81], v10 offset:36864
    ds_read_b64_tr_b16 v[82:83], v10 offset:37888
    s_add_u32 m0, s37, 1024
    s_add_u32 s39, s32, 10240
    buffer_load_dwordx4 v2, s[12:15], s39 offen  lds
    v_mfma_f32_32x32x16_bf16 a[32:47], v[48:51], v[24:27], a[32:47]
    s_waitcnt lgkmcnt(10)
    ds_read_b64_tr_b16 v[84:85], v11 offset:36864
    ds_read_b64_tr_b16 v[86:87], v11 offset:37888
    v_mfma_f32_32x32x16_bf16 a[96:111], v[48:51], v[28:31], a[96:111]
    ds_read_b64_tr_b16 v[88:89], v12 offset:53248
    ds_read_b64_tr_b16 v[90:91], v12 offset:54272
    s_add_u32 m0, s37, 2048
    s_add_u32 s39, s32, 20480
    buffer_load_dwordx4 v1, s[12:15], s39 offen  lds
    v_mfma_f32_32x32x16_bf16 a[48:63], v[52:55], v[24:27], a[48:63]
    s_waitcnt lgkmcnt(10)
    ds_read_b64_tr_b16 v[92:93], v13 offset:53248
    ds_read_b64_tr_b16 v[94:95], v13 offset:54272
    v_mfma_f32_32x32x16_bf16 a[112:127], v[52:55], v[28:31], a[112:127]
    ds_read_b64_tr_b16 v[96:97], v14 offset:53248
    ds_read_b64_tr_b16 v[98:99], v14 offset:54272
    s_add_u32 m0, s37, 3072
    s_add_u32 s39, s32, 30720
    buffer_load_dwordx4 v2, s[12:15], s39 offen  lds
    v_mfma_f32_32x32x16_bf16 a[128:143], v[24:27], v[56:59], a[128:143]
    s_waitcnt lgkmcnt(10)
    ds_read_b64_tr_b16 v[100:101], v15 offset:53248
    ds_read_b64_tr_b16 v[102:103], v15 offset:54272
    v_mfma_f32_32x32x16_bf16 a[192:207], v[28:31], v[56:59], a[192:207]
    s_add_u32 m0, s37, 4096
    s_add_u32 s39, s32, 40960
    buffer_load_dwordx4 v1, s[12:15], s39 offen  lds
    v_mfma_f32_32x32x16_bf16 a[144:159], v[24:27], v[60:63], a[144:159]
    v_mfma_f32_32x32x16_bf16 a[208:223], v[28:31], v[60:63], a[208:223]
    s_add_u32 m0, s37, 5120
    s_add_u32 s39, s32, 51200
    buffer_load_dwordx4 v2, s[12:15], s39 offen  lds
    v_mfma_f32_32x32x16_bf16 a[160:175], v[24:27], v[64:67], a[160:175]
    v_mfma_f32_32x32x16_bf16 a[224:239], v[28:31], v[64:67], a[224:239]
    s_add_u32 m0, s37, 6144
    s_add_u32 s39, s32, 61440
    buffer_load_dwordx4 v1, s[12:15], s39 offen  lds
    v_mfma_f32_32x32x16_bf16 a[176:191], v[24:27], v[68:71], a[176:191]
    v_mfma_f32_32x32x16_bf16 a[240:255], v[28:31], v[68:71], a[240:255]
    s_add_u32 m0, s37, 7168
    s_add_u32 s39, s32, 71680
    buffer_load_dwordx4 v2, s[12:15], s39 offen  lds
    s_add_u32 s32, s32, 128
    v_mfma_f32_32x32x16_bf16 a[0:15], v[72:75], v[32:35], a[0:15]
    ds_read_b128 v[24:27], v6 offset:0
    ds_read_b64_tr_b16 v[40:41], v8 offset:40960
    v_mfma_f32_32x32x16_bf16 a[64:79], v[72:75], v[36:39], a[64:79]
    s_waitcnt lgkmcnt(10)
    ds_read_b64_tr_b16 v[42:43], v8 offset:41984
    ds_read_b128 v[28:31], v6 offset:4096
    buffer_store_dwordx4 v[152:155], v20, s[88:91], s92 offen sc1
    s_add_u32 s92, s92, s93
    v_mfma_f32_32x32x16_bf16 a[16:31], v[76:79], v[32:35], a[16:31]
    ds_read_b64_tr_b16 v[44:45], v9 offset:40960
    ds_read_b64_tr_b16 v[46:47], v9 offset:41984
    v_mfma_f32_32x32x16_bf16 a[80:95], v[76:79], v[36:39], a[80:95]
    s_waitcnt lgkmcnt(10)
    ds_read_b64_tr_b16 v[48:49], v10 offset:40960
    ds_read_b64_tr_b16 v[50:51], v10 offset:41984
    v_mfma_f32_32x32x16_bf16 a[32:47], v[80:83], v[32:35], a[32:47]
    ds_read_b64_tr_b16 v[52:53], v11 offset:40960
    ds_read_b64_tr_b16 v[54:55], v11 offset:41984
    buffer_store_dwordx4 v[156:159], v20, s[88:91], s92 offen sc1
    s_add_u32 s92, s92, s94
    v_mfma_f32_32x32x16_bf16 a[96:111], v[80:83], v[36:39], a[96:111]
    s_waitcnt lgkmcnt(10)
    ds_read_b64_tr_b16 v[56:57], v12 offset:57344
    ds_read_b64_tr_b16 v[58:59], v12 offset:58368
    v_mfma_f32_32x32x16_bf16 a[48:63], v[84:87], v[32:35], a[48:63]
    ds_read_b64_tr_b16 v[60:61], v13 offset:57344
    ds_read_b64_tr_b16 v[62:63], v13 offset:58368
    v_mfma_f32_32x32x16_bf16 a[112:127], v[84:87], v[36:39], a[112:127]
    s_waitcnt lgkmcnt(10)
    ds_read_b64_tr_b16 v[64:65], v14 offset:57344
    ds_read_b64_tr_b16 v[66:67], v14 offset:58368
    buffer_store_dwordx4 v[160:163], v20, s[88:91], s92 offen sc1
    s_add_u32 s92, s92, s93
    v_mfma_f32_32x32x16_bf16 a[128:143], v[32:35], v[88:91], a[128:143]
    ds_read_b64_tr_b16 v[68:69], v15 offset:57344
    ds_read_b64_tr_b16 v[70:71], v15 offset:58368
    v_mfma_f32_32x32x16_bf16 a[192:207], v[36:39], v[88:91], a[192:207]
    v_mfma_f32_32x32x16_bf16 a[144:159], v[32:35], v[92:95], a[144:159]
    buffer_store_dwordx4 v[164:167], v20, s[88:91], s92 offen sc1
    s_add_u32 s92, s92, s96
    v_mfma_f32_32x32x16_bf16 a[208:223], v[36:39], v[92:95], a[208:223]
    v_mfma_f32_32x32x16_bf16 a[160:175], v[32:35], v[96:99], a[160:175]
    v_mfma_f32_32x32x16_bf16 a[224:239], v[36:39], v[96:99], a[224:239]
    v_mfma_f32_32x32x16_bf16 a[176:191], v[32:35], v[100:103], a[176:191]
    v_mfma_f32_32x32x16_bf16 a[240:255], v[36:39], v[100:103], a[240:255]
    v_mfma_f32_32x32x16_bf16 a[0:15], v[40:43], v[24:27], a[0:15]
    s_waitcnt lgkmcnt(10)
    ds_read_b128 v[32:35], v7 offset:0
    ds_read_b64_tr_b16 v[72:73], v8 offset:45056
    v_mfma_f32_32x32x16_bf16 a[64:79], v[40:43], v[28:31], a[64:79]
    ds_read_b64_tr_b16 v[74:75], v8 offset:46080
    ds_read_b128 v[36:39], v7 offset:4096
    v_mfma_f32_32x32x16_bf16 a[16:31], v[44:47], v[24:27], a[16:31]
    s_waitcnt lgkmcnt(10)
    ds_read_b64_tr_b16 v[76:77], v9 offset:45056
    ds_read_b64_tr_b16 v[78:79], v9 offset:46080
    v_mfma_f32_32x32x16_bf16 a[80:95], v[44:47], v[28:31], a[80:95]
    ds_read_b64_tr_b16 v[80:81], v10 offset:45056
    ds_read_b64_tr_b16 v[82:83], v10 offset:46080
    v_mfma_f32_32x32x16_bf16 a[32:47], v[48:51], v[24:27], a[32:47]
    s_waitcnt lgkmcnt(10)
    ds_read_b64_tr_b16 v[84:85], v11 offset:45056
    ds_read_b64_tr_b16 v[86:87], v11 offset:46080
    v_mfma_f32_32x32x16_bf16 a[96:111], v[48:51], v[28:31], a[96:111]
    ds_read_b64_tr_b16 v[88:89], v12 offset:61440
    ds_read_b64_tr_b16 v[90:91], v12 offset:62464
    v_mfma_f32_32x32x16_bf16 a[48:63], v[52:55], v[24:27], a[48:63]
    s_waitcnt lgkmcnt(10)
    ds_read_b64_tr_b16 v[92:93], v13 offset:61440
    ds_read_b64_tr_b16 v[94:95], v13 offset:62464
    v_mfma_f32_32x32x16_bf16 a[112:127], v[52:55], v[28:31], a[112:127]
    ds_read_b64_tr_b16 v[96:97], v14 offset:61440
    ds_read_b64_tr_b16 v[98:99], v14 offset:62464
    v_mfma_f32_32x32x16_bf16 a[128:143], v[24:27], v[56:59], a[128:143]
    s_waitcnt lgkmcnt(10)
    ds_read_b64_tr_b16 v[100:101], v15 offset:61440
    ds_read_b64_tr_b16 v[102:103], v15 offset:62464
    v_mfma_f32_32x32x16_bf16 a[192:207], v[28:31], v[56:59], a[192:207]
    v_mfma_f32_32x32x16_bf16 a[144:159], v[24:27], v[60:63], a[144:159]
    v_xor_b32 v4, 0x10000, v4
    v_xor_b32 v5, 0x10000, v5
    v_mfma_f32_32x32x16_bf16 a[208:223], v[28:31], v[60:63], a[208:223]
    v_xor_b32 v6, 0x10000, v6
    v_xor_b32 v7, 0x10000, v7
    v_mfma_f32_32x32x16_bf16 a[160:175], v[24:27], v[64:67], a[160:175]
    v_xor_b32 v8, 0x10000, v8
    v_xor_b32 v9, 0x10000, v9
    v_mfma_f32_32x32x16_bf16 a[224:239], v[28:31], v[64:67], a[224:239]
    v_xor_b32 v10, 0x10000, v10
    v_xor_b32 v11, 0x10000, v11
    v_mfma_f32_32x32x16_bf16 a[176:191], v[24:27], v[68:71], a[176:191]
    v_xor_b32 v12, 0x10000, v12
    v_xor_b32 v13, 0x10000, v13
    v_mfma_f32_32x32x16_bf16 a[240:255], v[28:31], v[68:71], a[240:255]
    v_xor_b32 v14, 0x10000, v14
    v_xor_b32 v15, 0x10000, v15
    s_waitcnt vmcnt(0) lgkmcnt(0)
    s_barrier
    v_mfma_f32_32x32x16_bf16 a[0:15], v[72:75], v[32:35], a[0:15]
    ds_read_b128 v[24:27], v4 offset:0
    ds_read_b64_tr_b16 v[40:41], v8 offset:32768
    v_mfma_f32_32x32x16_bf16 a[64:79], v[72:75], v[36:39], a[64:79]
    ds_read_b64_tr_b16 v[42:43], v8 offset:33792
    ds_read_b128 v[28:31], v4 offset:4096
    s_add_u32 m0, s38, 65536
    s_mov_b32 s40, s33
    buffer_load_dwordx4 v3, s[20:23], s40 offen  lds
    v_mfma_f32_32x32x16_bf16 a[16:31], v[76:79], v[32:35], a[16:31]
    ds_read_b64_tr_b16 v[44:45], v9 offset:32768
    ds_read_b64_tr_b16 v[46:47], v9 offset:33792
    v_mfma_f32_32x32x16_bf16 a[80:95], v[76:79], v[36:39], a[80:95]
    ds_read_b64_tr_b16 v[48:49], v10 offset:32768
    ds_read_b64_tr_b16 v[50:51], v10 offset:33792
    s_add_u32 m0, s38, 66560
    s_add_u32 s40, s40, s35
    buffer_load_dwordx4 v3, s[20:23], s40 offen  lds
    v_mfma_f32_32x32x16_bf16 a[32:47], v[80:83], v[32:35], a[32:47]
    ds_read_b64_tr_b16 v[52:53], v11 offset:32768
    ds_read_b64_tr_b16 v[54:55], v11 offset:33792
    v_mfma_f32_32x32x16_bf16 a[96:111], v[80:83], v[36:39], a[96:111]
    ds_read_b64_tr_b16 v[56:57], v12 offset:49152
    ds_read_b64_tr_b16 v[58:59], v12 offset:50176
    s_add_u32 m0, s38, 67584
    s_add_u32 s40, s40, s35
    buffer_load_dwordx4 v3, s[20:23], s40 offen  lds
    v_mfma_f32_32x32x16_bf16 a[48:63], v[84:87], v[32:35], a[48:63]
    ds_read_b64_tr_b16 v[60:61], v13 offset:49152
    ds_read_b64_tr_b16 v[62:63], v13 offset:50176
    v_mfma_f32_32x32x16_bf16 a[112:127], v[84:87], v[36:39], a[112:127]
    s_waitcnt lgkmcnt(10)
    ds_read_b64_tr_b16 v[64:65], v14 offset:49152
    ds_read_b64_tr_b16 v[66:67], v14 offset:50176
    s_add_u32 m0, s38, 68608
    s_add_u32 s40, s40, s35
    buffer_load_dwordx4 v3, s[20:23], s40 offen  lds
    v_mfma_f32_32x32x16_bf16 a[128:143], v[32:35], v[88:91], a[128:143]
    ds_read_b64_tr_b16 v[68:69], v15 offset:49152
    ds_read_b64_tr_b16 v[70:71], v15 offset:50176
    v_mfma_f32_32x32x16_bf16 a[192:207], v[36:39], v[88:91], a[192:207]
    s_add_u32 m0, s38, 81920
    s_mov_b32 s40, s34
    buffer_load_dwordx4 v3, s[24:27], s40 offen  lds
    v_mfma_f32_32x32x16_bf16 a[144:159], v[32:35], v[92:95], a[144:159]
    v_mfma_f32_32x32x16_bf16 a[208:223], v[36:39], v[92:95], a[208:223]
    s_add_u32 m0, s38, 82944
    s_add_u32 s40, s40, s35
    buffer_load_dwordx4 v3, s[24:27], s40 offen  lds
    v_mfma_f32_32x32x16_bf16 a[160:175], v[32:35], v[96:99], a[160:175]
    v_mfma_f32_32x32x16_bf16 a[224:239], v[36:39], v[96:99], a[224:239]
    s_add_u32 m0, s38, 83968
    s_add_u32 s40, s40, s35
    buffer_load_dwordx4 v3, s[24:27], s40 offen  lds
    v_mfma_f32_32x32x16_bf16 a[176:191], v[32:35], v[100:103], a[176:191]
    v_mfma_f32_32x32x16_bf16 a[240:255], v[36:39], v[100:103], a[240:255]
    s_add_u32 m0, s38, 84992
    s_add_u32 s40, s40, s35
    buffer_load_dwordx4 v3, s[24:27], s40 offen  lds
    s_add_u32 s33, s33, s36
    s_add_u32 s34, s34, s36
    v_mfma_f32_32x32x16_bf16 a[0:15], v[40:43], v[24:27], a[0:15]
    s_waitcnt lgkmcnt(10)
    ds_read_b128 v[32:35], v5 offset:0
    ds_read_b64_tr_b16 v[72:73], v8 offset:36864
    v_mfma_f32_32x32x16_bf16 a[64:79], v[40:43], v[28:31], a[64:79]
    ds_read_b64_tr_b16 v[74:75], v8 offset:37888
    ds_read_b128 v[36:39], v5 offset:4096
    s_add_u32 m0, s37, 65536
    s_add_u32 s39, s32, 0
    buffer_load_dwordx4 v1, s[12:15], s39 offen  lds
    v_mfma_f32_32x32x16_bf16 a[16:31], v[44:47], v[24:27], a[16:31]
    s_waitcnt lgkmcnt(10)
    ds_read_b64_tr_b16 v[76:77], v9 offset:36864
    ds_read_b64_tr_b16 v[78:79], v9 offset:37888
    v_mfma_f32_32x32x16_bf16 a[80:95], v[44:47], v[28:31], a[80:95]
    ds_read_b64_tr_b16 v[80:81], v10 offset:36864
    ds_read_b64_tr_b16 v[82:83], v10 offset:37888
    s_add_u32 m0, s37, 66560
    s_add_u32 s39, s32, 10240
    buffer_load_dwordx4 v2, s[12:15], s39 offen  lds
    v_mfma_f32_32x32x16_bf16 a[32:47], v[48:51], v[24:27], a[32:47]
    s_waitcnt lgkmcnt(10)
    ds_read_b64_tr_b16 v[84:85], v11 offset:36864
    ds_read_b64_tr_b16 v[86:87], v11 offset:37888
    v_mfma_f32_32x32x16_bf16 a[96:111], v[48:51], v[28:31], a[96:111]
    ds_read_b64_tr_b16 v[88:89], v12 offset:53248
    ds_read_b64_tr_b16 v[90:91], v12 offset:54272
    s_add_u32 m0, s37, 67584
    s_add_u32 s39, s32, 20480
    buffer_load_dwordx4 v1, s[12:15], s39 offen  lds
    v_mfma_f32_32x32x16_bf16 a[48:63], v[52:55], v[24:27], a[48:63]
    s_waitcnt lgkmcnt(10)
    ds_read_b64_tr_b16 v[92:93], v13 offset:53248
    ds_read_b64_tr_b16 v[94:95], v13 offset:54272
    v_mfma_f32_32x32x16_bf16 a[112:127], v[52:55], v[28:31], a[112:127]
    ds_read_b64_tr_b16 v[96:97], v14 offset:53248
    ds_read_b64_tr_b16 v[98:99], v14 offset:54272
    s_add_u32 m0, s37, 68608
    s_add_u32 s39, s32, 30720
    buffer_load_dwordx4 v2, s[12:15], s39 offen  lds
    v_mfma_f32_32x32x16_bf16 a[128:143], v[24:27], v[56:59], a[128:143]
    s_waitcnt lgkmcnt(10)
    ds_read_b64_tr_b16 v[100:101], v15 offset:53248
    ds_read_b64_tr_b16 v[102:103], v15 offset:54272
    v_mfma_f32_32x32x16_bf16 a[192:207], v[28:31], v[56:59], a[192:207]
    s_add_u32 m0, s37, 69632
    s_add_u32 s39, s32, 40960
    buffer_load_dwordx4 v1, s[12:15], s39 offen  lds
    v_mfma_f32_32x32x16_bf16 a[144:159], v[24:27], v[60:63], a[144:159]
    v_mfma_f32_32x32x16_bf16 a[208:223], v[28:31], v[60:63], a[208:223]
    s_add_u32 m0, s37, 70656
    s_add_u32 s39, s32, 51200
    buffer_load_dwordx4 v2, s[12:15], s39 offen  lds
    v_mfma_f32_32x32x16_bf16 a[160:175], v[24:27], v[64:67], a[160:175]
    v_mfma_f32_32x32x16_bf16 a[224:239], v[28:31], v[64:67], a[224:239]
    s_add_u32 m0, s37, 71680
    s_add_u32 s39, s32, 61440
    buffer_load_dwordx4 v1, s[12:15], s39 offen  lds
    v_mfma_f32_32x32x16_bf16 a[176:191], v[24:27], v[68:71], a[176:191]
    v_mfma_f32_32x32x16_bf16 a[240:255], v[28:31], v[68:71], a[240:255]
    s_add_u32 m0, s37, 72704
    s_add_u32 s39, s32, 71680
    buffer_load_dwordx4 v2, s[12:15], s39 offen  lds
    s_add_u32 s32, s32, 128
    v_mfma_f32_32x32x16_bf16 a[0:15], v[72:75], v[32:35], a[0:15]
    ds_read_b128 v[24:27], v6 offset:0
    ds_read_b64_tr_b16 v[40:41], v8 offset:40960
    v_mfma_f32_32x32x16_bf16 a[64:79], v[72:75], v[36:39], a[64:79]
    s_waitcnt lgkmcnt(10)
    ds_read_b64_tr_b16 v[42:43], v8 offset:41984
    ds_read_b128 v[28:31], v6 offset:4096
    buffer_store_dwordx4 v[168:171], v21, s[88:91], s92 offen sc1
    s_add_u32 s92, s92, s93
    v_mfma_f32_32x32x16_bf16 a[16:31], v[76:79], v[32:35], a[16:31]
    ds_read_b64_tr_b16 v[44:45], v9 offset:40960
    ds_read_b64_tr_b16 v[46:47], v9 offset:41984
    v_mfma_f32_32x32x16_bf16 a[80:95], v[76:79], v[36:39], a[80:95]
    s_waitcnt lgkmcnt(10)
    ds_read_b64_tr_b16 v[48:49], v10 offset:40960
    ds_read_b64_tr_b16 v[50:51], v10 offset:41984
    v_mfma_f32_32x32x16_bf16 a[32:47], v[80:83], v[32:35], a[32:47]
    ds_read_b64_tr_b16 v[52:53], v11 offset:40960
    ds_read_b64_tr_b16 v[54:55], v11 offset:41984
    buffer_store_dwordx4 v[172:175], v21, s[88:91], s92 offen sc1
    s_add_u32 s92, s92, s94
    v_mfma_f32_32x32x16_bf16 a[96:111], v[80:83], v[36:39], a[96:111]
    s_waitcnt lgkmcnt(10)
    ds_read_b64_tr_b16 v[56:57], v12 offset:57344
    ds_read_b64_tr_b16 v[58:59], v12 offset:58368
    v_mfma_f32_32x32x16_bf16 a[48:63], v[84:87], v[32:35], a[48:63]
    ds_read_b64_tr_b16 v[60:61], v13 offset:57344
    ds_read_b64_tr_b16 v[62:63], v13 offset:58368
    v_mfma_f32_32x32x16_bf16 a[112:127], v[84:87], v[36:39], a[112:127]
    s_waitcnt lgkmcnt(10)
    ds_read_b64_tr_b16 v[64:65], v14 offset:57344
    ds_read_b64_tr_b16 v[66:67], v14 offset:58368
    buffer_store_dwordx4 v[176:179], v21, s[88:91], s92 offen sc1
    s_add_u32 s92, s92, s93
    v_mfma_f32_32x32x16_bf16 a[128:143], v[32:35], v[88:91], a[128:143]
    ds_read_b64_tr_b16 v[68:69], v15 offset:57344
    ds_read_b64_tr_b16 v[70:71], v15 offset:58368
    v_mfma_f32_32x32x16_bf16 a[192:207], v[36:39], v[88:91], a[192:207]
    v_mfma_f32_32x32x16_bf16 a[144:159], v[32:35], v[92:95], a[144:159]
    buffer_store_dwordx4 v[180:183], v21, s[88:91], s92 offen sc1
    s_add_u32 s92, s92, s94
    v_mfma_f32_32x32x16_bf16 a[208:223], v[36:39], v[92:95], a[208:223]
    v_mfma_f32_32x32x16_bf16 a[160:175], v[32:35], v[96:99], a[160:175]
    v_mfma_f32_32x32x16_bf16 a[224:239], v[36:39], v[96:99], a[224:239]
    v_mfma_f32_32x32x16_bf16 a[176:191], v[32:35], v[100:103], a[176:191]
    v_mfma_f32_32x32x16_bf16 a[240:255], v[36:39], v[100:103], a[240:255]
    v_mfma_f32_32x32x16_bf16 a[0:15], v[40:43], v[24:27], a[0:15]
    s_waitcnt lgkmcnt(10)
    ds_read_b128 v[32:35], v7 offset:0
    ds_read_b64_tr_b16 v[72:73], v8 offset:45056
    v_mfma_f32_32x32x16_bf16 a[64:79], v[40:43], v[28:31], a[64:79]
    ds_read_b64_tr_b16 v[74:75], v8 offset:46080
    ds_read_b128 v[36:39], v7 offset:4096
    v_mfma_f32_32x32x16_bf16 a[16:31], v[44:47], v[24:27], a[16:31]
    s_waitcnt lgkmcnt(10)
    ds_read_b64_tr_b16 v[76:77], v9 offset:45056
    ds_read_b64_tr_b16 v[78:79], v9 offset:46080
    v_mfma_f32_32x32x16_bf16 a[80:95], v[44:47], v[28:31], a[80:95]
    ds_read_b64_tr_b16 v[80:81], v10 offset:45056
    ds_read_b64_tr_b16 v[82:83], v10 offset:46080
    v_mfma_f32_32x32x16_bf16 a[32:47], v[48:51], v[24:27], a[32:47]
    s_waitcnt lgkmcnt(10)
    ds_read_b64_tr_b16 v[84:85], v11 offset:45056
    ds_read_b64_tr_b16 v[86:87], v11 offset:46080
    v_mfma_f32_32x32x16_bf16 a[96:111], v[48:51], v[28:31], a[96:111]
    ds_read_b64_tr_b16 v[88:89], v12 offset:61440
    ds_read_b64_tr_b16 v[90:91], v12 offset:62464
    v_mfma_f32_32x32x16_bf16 a[48:63], v[52:55], v[24:27], a[48:63]
    s_waitcnt lgkmcnt(10)
    ds_read_b64_tr_b16 v[92:93], v13 offset:61440
    ds_read_b64_tr_b16 v[94:95], v13 offset:62464
    v_mfma_f32_32x32x16_bf16 a[112:127], v[52:55], v[28:31], a[112:127]
    ds_read_b64_tr_b16 v[96:97], v14 offset:61440
    ds_read_b64_tr_b16 v[98:99], v14 offset:62464
    v_mfma_f32_32x32x16_bf16 a[128:143], v[24:27], v[56:59], a[128:143]
    s_waitcnt lgkmcnt(10)
    ds_read_b64_tr_b16 v[100:101], v15 offset:61440
    ds_read_b64_tr_b16 v[102:103], v15 offset:62464
    v_mfma_f32_32x32x16_bf16 a[192:207], v[28:31], v[56:59], a[192:207]
    v_mfma_f32_32x32x16_bf16 a[144:159], v[24:27], v[60:63], a[144:159]
    v_xor_b32 v4, 0x10000, v4
    v_xor_b32 v5, 0x10000, v5
    v_mfma_f32_32x32x16_bf16 a[208:223], v[28:31], v[60:63], a[208:223]
    v_xor_b32 v6, 0x10000, v6
    v_xor_b32 v7, 0x10000, v7
    v_mfma_f32_32x32x16_bf16 a[160:175], v[24:27], v[64:67], a[160:175]
    v_xor_b32 v8, 0x10000, v8
    v_xor_b32 v9, 0x10000, v9
    v_mfma_f32_32x32x16_bf16 a[224:239], v[28:31], v[64:67], a[224:239]
    v_xor_b32 v10, 0x10000, v10
    v_xor_b32 v11, 0x10000, v11
    v_mfma_f32_32x32x16_bf16 a[176:191], v[24:27], v[68:71], a[176:191]
    v_xor_b32 v12, 0x10000, v12
    v_xor_b32 v13, 0x10000, v13
    v_mfma_f32_32x32x16_bf16 a[240:255], v[28:31], v[68:71], a[240:255]
    v_xor_b32 v14, 0x10000, v14
    v_xor_b32 v15, 0x10000, v15
    s_waitcnt vmcnt(0) lgkmcnt(0)
    s_barrier
    v_mfma_f32_32x32x16_bf16 a[0:15], v[72:75], v[32:35], a[0:15]
    ds_read_b128 v[24:27], v4 offset:0
    ds_read_b64_tr_b16 v[40:41], v8 offset:32768
    v_mfma_f32_32x32x16_bf16 a[64:79], v[72:75], v[36:39], a[64:79]
    ds_read_b64_tr_b16 v[42:43], v8 offset:33792
    ds_read_b128 v[28:31], v4 offset:4096
    s_add_u32 m0, s38, 0
    s_mov_b32 s40, s33
    buffer_load_dwordx4 v3, s[20:23], s40 offen  lds
    v_mfma_f32_32x32x16_bf16 a[16:31], v[76:79], v[32:35], a[16:31]
    ds_read_b64_tr_b16 v[44:45], v9 offset:32768
    ds_read_b64_tr_b16 v[46:47], v9 offset:33792
    v_mfma_f32_32x32x16_bf16 a[80:95], v[76:79], v[36:39], a[80:95]
    ds_read_b64_tr_b16 v[48:49], v10 offset:32768
    ds_read_b64_tr_b16 v[50:51], v10 offset:33792
    s_add_u32 m0, s38, 1024
    s_add_u32 s40, s40, s35
    buffer_load_dwordx4 v3, s[20:23], s40 offen  lds
    v_mfma_f32_32x32x16_bf16 a[32:47], v[80:83], v[32:35], a[32:47]
    ds_read_b64_tr_b16 v[52:53], v11 offset:32768
    ds_read_b64_tr_b16 v[54:55], v11 offset:33792
    v_mfma_f32_32x32x16_bf16 a[96:111], v[80:83], v[36:39], a[96:111]
    ds_read_b64_tr_b16 v[56:57], v12 offset:49152
    ds_read_b64_tr_b16 v[58:59], v12 offset:50176
    s_add_u32 m0, s38, 2048
    s_add_u32 s40, s40, s35
    buffer_load_dwordx4 v3, s[20:23], s40 offen  lds
    v_mfma_f32_32x32x16_bf16 a[48:63], v[84:87], v[32:35], a[48:63]
    ds_read_b64_tr_b16 v[60:61], v13 offset:49152
    ds_read_b64_tr_b16 v[62:63], v13 offset:50176
    v_mfma_f32_32x32x16_bf16 a[112:127], v[84:87], v[36:39], a[112:127]
    s_waitcnt lgkmcnt(10)
    ds_read_b64_tr_b16 v[64:65], v14 offset:49152
    ds_read_b64_tr_b16 v[66:67], v14 offset:50176
    s_add_u32 m0, s38, 3072
    s_add_u32 s40, s40, s35
    buffer_load_dwordx4 v3, s[20:23], s40 offen  lds
    v_mfma_f32_32x32x16_bf16 a[128:143], v[32:35], v[88:91], a[128:143]
    ds_read_b64_tr_b16 v[68:69], v15 offset:49152
    ds_read_b64_tr_b16 v[70:71], v15 offset:50176
    v_mfma_f32_32x32x16_bf16 a[192:207], v[36:39], v[88:91], a[192:207]
    s_add_u32 m0, s38, 16384
    s_mov_b32 s40, s34
    buffer_load_dwordx4 v3, s[24:27], s40 offen  lds
    v_mfma_f32_32x32x16_bf16 a[144:159], v[32:35], v[92:95], a[144:159]
    v_mfma_f32_32x32x16_bf16 a[208:223], v[36:39], v[92:95], a[208:223]
    s_add_u32 m0, s38, 17408
    s_add_u32 s40, s40, s35
    buffer_load_dwordx4 v3, s[24:27], s40 offen  lds
    v_mfma_f32_32x32x16_bf16 a[160:175], v[32:35], v[96:99], a[160:175]
    v_mfma_f32_32x32x16_bf16 a[224:239], v[36:39], v[96:99], a[224:239]
    s_add_u32 m0, s38, 18432
    s_add_u32 s40, s40, s35
    buffer_load_dwordx4 v3, s[24:27], s40 offen  lds
    v_mfma_f32_32x32x16_bf16 a[176:191], v[32:35], v[100:103], a[176:191]
    v_mfma_f32_32x32x16_bf16 a[240:255], v[36:39], v[100:103], a[240:255]
    s_add_u32 m0, s38, 19456
    s_add_u32 s40, s40, s35
    buffer_load_dwordx4 v3, s[24:27], s40 offen  lds
    s_add_u32 s33, s33, s36
    s_add_u32 s34, s34, s36
    v_mfma_f32_32x32x16_bf16 a[0:15], v[40:43], v[24:27], a[0:15]
    s_waitcnt lgkmcnt(10)
    ds_read_b128 v[32:35], v5 offset:0
    ds_read_b64_tr_b16 v[72:73], v8 offset:36864
    v_mfma_f32_32x32x16_bf16 a[64:79], v[40:43], v[28:31], a[64:79]
    ds_read_b64_tr_b16 v[74:75], v8 offset:37888
    ds_read_b128 v[36:39], v5 offset:4096
    s_add_u32 m0, s37, 0
    s_add_u32 s39, s32, 0
    buffer_load_dwordx4 v1, s[12:15], s39 offen  lds
    v_mfma_f32_32x32x16_bf16 a[16:31], v[44:47], v[24:27], a[16:31]
    s_waitcnt lgkmcnt(10)
    ds_read_b64_tr_b16 v[76:77], v9 offset:36864
    ds_read_b64_tr_b16 v[78:79], v9 offset:37888
    v_mfma_f32_32x32x16_bf16 a[80:95], v[44:47], v[28:31], a[80:95]
    ds_read_b64_tr_b16 v[80:81], v10 offset:36864
    ds_read_b64_tr_b16 v[82:83], v10 offset:37888
    s_add_u32 m0, s37, 1024
    s_add_u32 s39, s32, 10240
    buffer_load_dwordx4 v2, s[12:15], s39 offen  lds
    v_mfma_f32_32x32x16_bf16 a[32:47], v[48:51], v[24:27], a[32:47]
    s_waitcnt lgkmcnt(10)
    ds_read_b64_tr_b16 v[84:85], v11 offset:36864
    ds_read_b64_tr_b16 v[86:87], v11 offset:37888
    v_mfma_f32_32x32x16_bf16 a[96:111], v[48:51], v[28:31], a[96:111]
    ds_read_b64_tr_b16 v[88:89], v12 offset:53248
    ds_read_b64_tr_b16 v[90:91], v12 offset:54272
    s_add_u32 m0, s37, 2048
    s_add_u32 s39, s32, 20480
    buffer_load_dwordx4 v1, s[12:15], s39 offen  lds
    v_mfma_f32_32x32x16_bf16 a[48:63], v[52:55], v[24:27], a[48:63]
    s_waitcnt lgkmcnt(10)
    ds_read_b64_tr_b16 v[92:93], v13 offset:53248
    ds_read_b64_tr_b16 v[94:95], v13 offset:54272
    v_mfma_f32_32x32x16_bf16 a[112:127], v[52:55], v[28:31], a[112:127]
    ds_read_b64_tr_b16 v[96:97], v14 offset:53248
    ds_read_b64_tr_b16 v[98:99], v14 offset:54272
    s_add_u32 m0, s37, 3072
    s_add_u32 s39, s32, 30720
    buffer_load_dwordx4 v2, s[12:15], s39 offen  lds
    v_mfma_f32_32x32x16_bf16 a[128:143], v[24:27], v[56:59], a[128:143]
    s_waitcnt lgkmcnt(10)
    ds_read_b64_tr_b16 v[100:101], v15 offset:53248
    ds_read_b64_tr_b16 v[102:103], v15 offset:54272
    v_mfma_f32_32x32x16_bf16 a[192:207], v[28:31], v[56:59], a[192:207]
    s_add_u32 m0, s37, 4096
    s_add_u32 s39, s32, 40960
    buffer_load_dwordx4 v1, s[12:15], s39 offen  lds
    v_mfma_f32_32x32x16_bf16 a[144:159], v[24:27], v[60:63], a[144:159]
    v_mfma_f32_32x32x16_bf16 a[208:223], v[28:31], v[60:63], a[208:223]
    s_add_u32 m0, s37, 5120
    s_add_u32 s39, s32, 51200
    buffer_load_dwordx4 v2, s[12:15], s39 offen  lds
    v_mfma_f32_32x32x16_bf16 a[160:175], v[24:27], v[64:67], a[160:175]
    v_mfma_f32_32x32x16_bf16 a[224:239], v[28:31], v[64:67], a[224:239]
    s_add_u32 m0, s37, 6144
    s_add_u32 s39, s32, 61440
    buffer_load_dwordx4 v1, s[12:15], s39 offen  lds
    v_mfma_f32_32x32x16_bf16 a[176:191], v[24:27], v[68:71], a[176:191]
    v_mfma_f32_32x32x16_bf16 a[240:255], v[28:31], v[68:71], a[240:255]
    s_add_u32 m0, s37, 7168
    s_add_u32 s39, s32, 71680
    buffer_load_dwordx4 v2, s[12:15], s39 offen  lds
    s_add_u32 s32, s32, 128
    v_mfma_f32_32x32x16_bf16 a[0:15], v[72:75], v[32:35], a[0:15]
    ds_read_b128 v[24:27], v6 offset:0
    ds_read_b64_tr_b16 v[40:41], v8 offset:40960
    v_mfma_f32_32x32x16_bf16 a[64:79], v[72:75], v[36:39], a[64:79]
    s_waitcnt lgkmcnt(10)
    ds_read_b64_tr_b16 v[42:43], v8 offset:41984
    ds_read_b128 v[28:31], v6 offset:4096
    buffer_store_dwordx4 v[184:187], v21, s[88:91], s92 offen sc1
    s_add_u32 s92, s92, s93
    v_mfma_f32_32x32x16_bf16 a[16:31], v[76:79], v[32:35], a[16:31]
    ds_read_b64_tr_b16 v[44:45], v9 offset:40960
    ds_read_b64_tr_b16 v[46:47], v9 offset:41984
    v_mfma_f32_32x32x16_bf16 a[80:95], v[76:79], v[36:39], a[80:95]
    s_waitcnt lgkmcnt(10)
    ds_read_b64_tr_b16 v[48:49], v10 offset:40960
    ds_read_b64_tr_b16 v[50:51], v10 offset:41984
    v_mfma_f32_32x32x16_bf16 a[32:47], v[80:83], v[32:35], a[32:47]
    ds_read_b64_tr_b16 v[52:53], v11 offset:40960
    ds_read_b64_tr_b16 v[54:55], v11 offset:41984
    buffer_store_dwordx4 v[188:191], v21, s[88:91], s92 offen sc1
    s_add_u32 s92, s92, s94
    v_mfma_f32_32x32x16_bf16 a[96:111], v[80:83], v[36:39], a[96:111]
    s_waitcnt lgkmcnt(10)
    ds_read_b64_tr_b16 v[56:57], v12 offset:57344
    ds_read_b64_tr_b16 v[58:59], v12 offset:58368
    v_mfma_f32_32x32x16_bf16 a[48:63], v[84:87], v[32:35], a[48:63]
    ds_read_b64_tr_b16 v[60:61], v13 offset:57344
    ds_read_b64_tr_b16 v[62:63], v13 offset:58368
    v_mfma_f32_32x32x16_bf16 a[112:127], v[84:87], v[36:39], a[112:127]
    s_waitcnt lgkmcnt(10)
    ds_read_b64_tr_b16 v[64:65], v14 offset:57344
    ds_read_b64_tr_b16 v[66:67], v14 offset:58368
    buffer_store_dwordx4 v[192:195], v21, s[88:91], s92 offen sc1
    s_add_u32 s92, s92, s93
    v_mfma_f32_32x32x16_bf16 a[128:143], v[32:35], v[88:91], a[128:143]
    ds_read_b64_tr_b16 v[68:69], v15 offset:57344
    ds_read_b64_tr_b16 v[70:71], v15 offset:58368
    v_mfma_f32_32x32x16_bf16 a[192:207], v[36:39], v[88:91], a[192:207]
    v_mfma_f32_32x32x16_bf16 a[144:159], v[32:35], v[92:95], a[144:159]
    buffer_store_dwordx4 v[196:199], v21, s[88:91], s92 offen sc1
    s_add_u32 s92, s92, s95
    v_mfma_f32_32x32x16_bf16 a[208:223], v[36:39], v[92:95], a[208:223]
    v_mfma_f32_32x32x16_bf16 a[160:175], v[32:35], v[96:99], a[160:175]
    v_mfma_f32_32x32x16_bf16 a[224:239], v[36:39], v[96:99], a[224:239]
    v_mfma_f32_32x32x16_bf16 a[176:191], v[32:35], v[100:103], a[176:191]
    v_mfma_f32_32x32x16_bf16 a[240:255], v[36:39], v[100:103], a[240:255]
    v_mfma_f32_32x32x16_bf16 a[0:15], v[40:43], v[24:27], a[0:15]
    s_waitcnt lgkmcnt(10)
    ds_read_b128 v[32:35], v7 offset:0
    ds_read_b64_tr_b16 v[72:73], v8 offset:45056
    v_mfma_f32_32x32x16_bf16 a[64:79], v[40:43], v[28:31], a[64:79]
    ds_read_b64_tr_b16 v[74:75], v8 offset:46080
    ds_read_b128 v[36:39], v7 offset:4096
    v_mfma_f32_32x32x16_bf16 a[16:31], v[44:47], v[24:27], a[16:31]
    s_waitcnt lgkmcnt(10)
    ds_read_b64_tr_b16 v[76:77], v9 offset:45056
    ds_read_b64_tr_b16 v[78:79], v9 offset:46080
    v_mfma_f32_32x32x16_bf16 a[80:95], v[44:47], v[28:31], a[80:95]
    ds_read_b64_tr_b16 v[80:81], v10 offset:45056
    ds_read_b64_tr_b16 v[82:83], v10 offset:46080
    v_mfma_f32_32x32x16_bf16 a[32:47], v[48:51], v[24:27], a[32:47]
    s_waitcnt lgkmcnt(10)
    ds_read_b64_tr_b16 v[84:85], v11 offset:45056
    ds_read_b64_tr_b16 v[86:87], v11 offset:46080
    v_mfma_f32_32x32x16_bf16 a[96:111], v[48:51], v[28:31], a[96:111]
    ds_read_b64_tr_b16 v[88:89], v12 offset:61440
    ds_read_b64_tr_b16 v[90:91], v12 offset:62464
    v_mfma_f32_32x32x16_bf16 a[48:63], v[52:55], v[24:27], a[48:63]
    s_waitcnt lgkmcnt(10)
    ds_read_b64_tr_b16 v[92:93], v13 offset:61440
    ds_read_b64_tr_b16 v[94:95], v13 offset:62464
    v_mfma_f32_32x32x16_bf16 a[112:127], v[52:55], v[28:31], a[112:127]
    ds_read_b64_tr_b16 v[96:97], v14 offset:61440
    ds_read_b64_tr_b16 v[98:99], v14 offset:62464
    v_mfma_f32_32x32x16_bf16 a[128:143], v[24:27], v[56:59], a[128:143]
    s_waitcnt lgkmcnt(10)
    ds_read_b64_tr_b16 v[100:101], v15 offset:61440
    ds_read_b64_tr_b16 v[102:103], v15 offset:62464
    v_mfma_f32_32x32x16_bf16 a[192:207], v[28:31], v[56:59], a[192:207]
    v_mfma_f32_32x32x16_bf16 a[144:159], v[24:27], v[60:63], a[144:159]
    v_xor_b32 v4, 0x10000, v4
    v_xor_b32 v5, 0x10000, v5
    v_mfma_f32_32x32x16_bf16 a[208:223], v[28:31], v[60:63], a[208:223]
    v_xor_b32 v6, 0x10000, v6
    v_xor_b32 v7, 0x10000, v7
    v_mfma_f32_32x32x16_bf16 a[160:175], v[24:27], v[64:67], a[160:175]
    v_xor_b32 v8, 0x10000, v8
    v_xor_b32 v9, 0x10000, v9
    v_mfma_f32_32x32x16_bf16 a[224:239], v[28:31], v[64:67], a[224:239]
    v_xor_b32 v10, 0x10000, v10
    v_xor_b32 v11, 0x10000, v11
    v_mfma_f32_32x32x16_bf16 a[176:191], v[24:27], v[68:71], a[176:191]
    v_xor_b32 v12, 0x10000, v12
    v_xor_b32 v13, 0x10000, v13
    v_mfma_f32_32x32x16_bf16 a[240:255], v[28:31], v[68:71], a[240:255]
    v_xor_b32 v14, 0x10000, v14
    v_xor_b32 v15, 0x10000, v15
    s_waitcnt vmcnt(0) lgkmcnt(0)
    s_barrier
    v_mfma_f32_32x32x16_bf16 a[0:15], v[72:75], v[32:35], a[0:15]
    ds_read_b128 v[24:27], v4 offset:0
    ds_read_b64_tr_b16 v[40:41], v8 offset:32768
    v_mfma_f32_32x32x16_bf16 a[64:79], v[72:75], v[36:39], a[64:79]
    ds_read_b64_tr_b16 v[42:43], v8 offset:33792
    ds_read_b128 v[28:31], v4 offset:4096
    s_add_u32 m0, s38, 65536
    s_mov_b32 s40, s33
    buffer_load_dwordx4 v3, s[20:23], s40 offen  lds
    v_mfma_f32_32x32x16_bf16 a[16:31], v[76:79], v[32:35], a[16:31]
    ds_read_b64_tr_b16 v[44:45], v9 offset:32768
    ds_read_b64_tr_b16 v[46:47], v9 offset:33792
    v_mfma_f32_32x32x16_bf16 a[80:95], v[76:79], v[36:39], a[80:95]
    ds_read_b64_tr_b16 v[48:49], v10 offset:32768
    ds_read_b64_tr_b16 v[50:51], v10 offset:33792
    s_add_u32 m0, s38, 66560
    s_add_u32 s40, s40, s35
    buffer_load_dwordx4 v3, s[20:23], s40 offen  lds
    v_mfma_f32_32x32x16_bf16 a[32:47], v[80:83], v[32:35], a[32:47]
    ds_read_b64_tr_b16 v[52:53], v11 offset:32768
    ds_read_b64_tr_b16 v[54:55], v11 offset:33792
    v_mfma_f32_32x32x16_bf16 a[96:111], v[80:83], v[36:39], a[96:111]
    ds_read_b64_tr_b16 v[56:57], v12 offset:49152
    ds_read_b64_tr_b16 v[58:59], v12 offset:50176
    s_add_u32 m0, s38, 67584
    s_add_u32 s40, s40, s35
    buffer_load_dwordx4 v3, s[20:23], s40 offen  lds
    v_mfma_f32_32x32x16_bf16 a[48:63], v[84:87], v[32:35], a[48:63]
    ds_read_b64_tr_b16 v[60:61], v13 offset:49152
    ds_read_b64_tr_b16 v[62:63], v13 offset:50176
    v_mfma_f32_32x32x16_bf16 a[112:127], v[84:87], v[36:39], a[112:127]
    s_waitcnt lgkmcnt(10)
    ds_read_b64_tr_b16 v[64:65], v14 offset:49152
    ds_read_b64_tr_b16 v[66:67], v14 offset:50176
    s_add_u32 m0, s38, 68608
    s_add_u32 s40, s40, s35
    buffer_load_dwordx4 v3, s[20:23], s40 offen  lds
    v_mfma_f32_32x32x16_bf16 a[128:143], v[32:35], v[88:91], a[128:143]
    ds_read_b64_tr_b16 v[68:69], v15 offset:49152
    ds_read_b64_tr_b16 v[70:71], v15 offset:50176
    v_mfma_f32_32x32x16_bf16 a[192:207], v[36:39], v[88:91], a[192:207]
    s_add_u32 m0, s38, 81920
    s_mov_b32 s40, s34
    buffer_load_dwordx4 v3, s[24:27], s40 offen  lds
    v_mfma_f32_32x32x16_bf16 a[144:159], v[32:35], v[92:95], a[144:159]
    v_mfma_f32_32x32x16_bf16 a[208:223], v[36:39], v[92:95], a[208:223]
    s_add_u32 m0, s38, 82944
    s_add_u32 s40, s40, s35
    buffer_load_dwordx4 v3, s[24:27], s40 offen  lds
    v_mfma_f32_32x32x16_bf16 a[160:175], v[32:35], v[96:99], a[160:175]
    v_mfma_f32_32x32x16_bf16 a[224:239], v[36:39], v[96:99], a[224:239]
    s_add_u32 m0, s38, 83968
    s_add_u32 s40, s40, s35
    buffer_load_dwordx4 v3, s[24:27], s40 offen  lds
    v_mfma_f32_32x32x16_bf16 a[176:191], v[32:35], v[100:103], a[176:191]
    v_mfma_f32_32x32x16_bf16 a[240:255], v[36:39], v[100:103], a[240:255]
    s_add_u32 m0, s38, 84992
    s_add_u32 s40, s40, s35
    buffer_load_dwordx4 v3, s[24:27], s40 offen  lds
    s_add_u32 s33, s33, s36
    s_add_u32 s34, s34, s36
    v_mfma_f32_32x32x16_bf16 a[0:15], v[40:43], v[24:27], a[0:15]
    s_waitcnt lgkmcnt(10)
    ds_read_b128 v[32:35], v5 offset:0
    ds_read_b64_tr_b16 v[72:73], v8 offset:36864
    v_mfma_f32_32x32x16_bf16 a[64:79], v[40:43], v[28:31], a[64:79]
    ds_read_b64_tr_b16 v[74:75], v8 offset:37888
    ds_read_b128 v[36:39], v5 offset:4096
    s_add_u32 m0, s37, 65536
    s_add_u32 s39, s32, 0
    buffer_load_dwordx4 v1, s[12:15], s39 offen  lds
    v_mfma_f32_32x32x16_bf16 a[16:31], v[44:47], v[24:27], a[16:31]
    s_waitcnt lgkmcnt(10)
    ds_read_b64_tr_b16 v[76:77], v9 offset:36864
    ds_read_b64_tr_b16 v[78:79], v9 offset:37888
    v_mfma_f32_32x32x16_bf16 a[80:95], v[44:47], v[28:31], a[80:95]
    ds_read_b64_tr_b16 v[80:81], v10 offset:36864
    ds_read_b64_tr_b16 v[82:83], v10 offset:37888
    s_add_u32 m0, s37, 66560
    s_add_u32 s39, s32, 10240
    buffer_load_dwordx4 v2, s[12:15], s39 offen  lds
    v_mfma_f32_32x32x16_bf16 a[32:47], v[48:51], v[24:27], a[32:47]
    s_waitcnt lgkmcnt(10)
    ds_read_b64_tr_b16 v[84:85], v11 offset:36864
    ds_read_b64_tr_b16 v[86:87], v11 offset:37888
    v_mfma_f32_32x32x16_bf16 a[96:111], v[48:51], v[28:31], a[96:111]
    ds_read_b64_tr_b16 v[88:89], v12 offset:53248
    ds_read_b64_tr_b16 v[90:91], v12 offset:54272
    s_add_u32 m0, s37, 67584
    s_add_u32 s39, s32, 20480
    buffer_load_dwordx4 v1, s[12:15], s39 offen  lds
    v_mfma_f32_32x32x16_bf16 a[48:63], v[52:55], v[24:27], a[48:63]
    s_waitcnt lgkmcnt(10)
    ds_read_b64_tr_b16 v[92:93], v13 offset:53248
    ds_read_b64_tr_b16 v[94:95], v13 offset:54272
    v_mfma_f32_32x32x16_bf16 a[112:127], v[52:55], v[28:31], a[112:127]
    ds_read_b64_tr_b16 v[96:97], v14 offset:53248
    ds_read_b64_tr_b16 v[98:99], v14 offset:54272
    s_add_u32 m0, s37, 68608
    s_add_u32 s39, s32, 30720
    buffer_load_dwordx4 v2, s[12:15], s39 offen  lds
    v_mfma_f32_32x32x16_bf16 a[128:143], v[24:27], v[56:59], a[128:143]
    s_waitcnt lgkmcnt(10)
    ds_read_b64_tr_b16 v[100:101], v15 offset:53248
    ds_read_b64_tr_b16 v[102:103], v15 offset:54272
    v_mfma_f32_32x32x16_bf16 a[192:207], v[28:31], v[56:59], a[192:207]
    s_add_u32 m0, s37, 69632
    s_add_u32 s39, s32, 40960
    buffer_load_dwordx4 v1, s[12:15], s39 offen  lds
    v_mfma_f32_32x32x16_bf16 a[144:159], v[24:27], v[60:63], a[144:159]
    v_mfma_f32_32x32x16_bf16 a[208:223], v[28:31], v[60:63], a[208:223]
    s_add_u32 m0, s37, 70656
    s_add_u32 s39, s32, 51200
    buffer_load_dwordx4 v2, s[12:15], s39 offen  lds
    v_mfma_f32_32x32x16_bf16 a[160:175], v[24:27], v[64:67], a[160:175]
    v_mfma_f32_32x32x16_bf16 a[224:239], v[28:31], v[64:67], a[224:239]
    s_add_u32 m0, s37, 71680
    s_add_u32 s39, s32, 61440
    buffer_load_dwordx4 v1, s[12:15], s39 offen  lds
    v_mfma_f32_32x32x16_bf16 a[176:191], v[24:27], v[68:71], a[176:191]
    v_mfma_f32_32x32x16_bf16 a[240:255], v[28:31], v[68:71], a[240:255]
    s_add_u32 m0, s37, 72704
    s_add_u32 s39, s32, 71680
    buffer_load_dwordx4 v2, s[12:15], s39 offen  lds
    s_add_u32 s32, s32, 128
    v_mfma_f32_32x32x16_bf16 a[0:15], v[72:75], v[32:35], a[0:15]
    ds_read_b128 v[24:27], v6 offset:0
    ds_read_b64_tr_b16 v[40:41], v8 offset:40960
    v_mfma_f32_32x32x16_bf16 a[64:79], v[72:75], v[36:39], a[64:79]
    s_waitcnt lgkmcnt(10)
    ds_read_b64_tr_b16 v[42:43], v8 offset:41984
    ds_read_b128 v[28:31], v6 offset:4096
    buffer_store_dwordx4 v[200:203], v21, s[88:91], s92 offen sc1
    s_add_u32 s92, s92, s93
    v_mfma_f32_32x32x16_bf16 a[16:31], v[76:79], v[32:35], a[16:31]
    ds_read_b64_tr_b16 v[44:45], v9 offset:40960
    ds_read_b64_tr_b16 v[46:47], v9 offset:41984
    v_mfma_f32_32x32x16_bf16 a[80:95], v[76:79], v[36:39], a[80:95]
    s_waitcnt lgkmcnt(10)
    ds_read_b64_tr_b16 v[48:49], v10 offset:40960
    ds_read_b64_tr_b16 v[50:51], v10 offset:41984
    v_mfma_f32_32x32x16_bf16 a[32:47], v[80:83], v[32:35], a[32:47]
    ds_read_b64_tr_b16 v[52:53], v11 offset:40960
    ds_read_b64_tr_b16 v[54:55], v11 offset:41984
    buffer_store_dwordx4 v[204:207], v21, s[88:91], s92 offen sc1
    s_add_u32 s92, s92, s94
    v_mfma_f32_32x32x16_bf16 a[96:111], v[80:83], v[36:39], a[96:111]
    s_waitcnt lgkmcnt(10)
    ds_read_b64_tr_b16 v[56:57], v12 offset:57344
    ds_read_b64_tr_b16 v[58:59], v12 offset:58368
    v_mfma_f32_32x32x16_bf16 a[48:63], v[84:87], v[32:35], a[48:63]
    ds_read_b64_tr_b16 v[60:61], v13 offset:57344
    ds_read_b64_tr_b16 v[62:63], v13 offset:58368
    v_mfma_f32_32x32x16_bf16 a[112:127], v[84:87], v[36:39], a[112:127]
    s_waitcnt lgkmcnt(10)
    ds_read_b64_tr_b16 v[64:65], v14 offset:57344
    ds_read_b64_tr_b16 v[66:67], v14 offset:58368
    buffer_store_dwordx4 v[208:211], v21, s[88:91], s92 offen sc1
    s_add_u32 s92, s92, s93
    v_mfma_f32_32x32x16_bf16 a[128:143], v[32:35], v[88:91], a[128:143]
    ds_read_b64_tr_b16 v[68:69], v15 offset:57344
    ds_read_b64_tr_b16 v[70:71], v15 offset:58368
    v_mfma_f32_32x32x16_bf16 a[192:207], v[36:39], v[88:91], a[192:207]
    v_mfma_f32_32x32x16_bf16 a[144:159], v[32:35], v[92:95], a[144:159]
    buffer_store_dwordx4 v[212:215], v21, s[88:91], s92 offen sc1
    s_add_u32 s92, s92, s94
    v_mfma_f32_32x32x16_bf16 a[208:223], v[36:39], v[92:95], a[208:223]
    v_mfma_f32_32x32x16_bf16 a[160:175], v[32:35], v[96:99], a[160:175]
    v_mfma_f32_32x32x16_bf16 a[224:239], v[36:39], v[96:99], a[224:239]
    v_mfma_f32_32x32x16_bf16 a[176:191], v[32:35], v[100:103], a[176:191]
    v_mfma_f32_32x32x16_bf16 a[240:255], v[36:39], v[100:103], a[240:255]
    v_mfma_f32_32x32x16_bf16 a[0:15], v[40:43], v[24:27], a[0:15]
    s_waitcnt lgkmcnt(10)
    ds_read_b128 v[32:35], v7 offset:0
    ds_read_b64_tr_b16 v[72:73], v8 offset:45056
    v_mfma_f32_32x32x16_bf16 a[64:79], v[40:43], v[28:31], a[64:79]
    ds_read_b64_tr_b16 v[74:75], v8 offset:46080
    ds_read_b128 v[36:39], v7 offset:4096
    v_mfma_f32_32x32x16_bf16 a[16:31], v[44:47], v[24:27], a[16:31]
    s_waitcnt lgkmcnt(10)
    ds_read_b64_tr_b16 v[76:77], v9 offset:45056
    ds_read_b64_tr_b16 v[78:79], v9 offset:46080
    v_mfma_f32_32x32x16_bf16 a[80:95], v[44:47], v[28:31], a[80:95]
    ds_read_b64_tr_b16 v[80:81], v10 offset:45056
    ds_read_b64_tr_b16 v[82:83], v10 offset:46080
    v_mfma_f32_32x32x16_bf16 a[32:47], v[48:51], v[24:27], a[32:47]
    s_waitcnt lgkmcnt(10)
    ds_read_b64_tr_b16 v[84:85], v11 offset:45056
    ds_read_b64_tr_b16 v[86:87], v11 offset:46080
    v_mfma_f32_32x32x16_bf16 a[96:111], v[48:51], v[28:31], a[96:111]
    ds_read_b64_tr_b16 v[88:89], v12 offset:61440
    ds_read_b64_tr_b16 v[90:91], v12 offset:62464
    v_mfma_f32_32x32x16_bf16 a[48:63], v[52:55], v[24:27], a[48:63]
    s_waitcnt lgkmcnt(10)
    ds_read_b64_tr_b16 v[92:93], v13 offset:61440
    ds_read_b64_tr_b16 v[94:95], v13 offset:62464
    v_mfma_f32_32x32x16_bf16 a[112:127], v[52:55], v[28:31], a[112:127]
    ds_read_b64_tr_b16 v[96:97], v14 offset:61440
    ds_read_b64_tr_b16 v[98:99], v14 offset:62464
    v_mfma_f32_32x32x16_bf16 a[128:143], v[24:27], v[56:59], a[128:143]
    s_waitcnt lgkmcnt(10)
    ds_read_b64_tr_b16 v[100:101], v15 offset:61440
    ds_read_b64_tr_b16 v[102:103], v15 offset:62464
    v_mfma_f32_32x32x16_bf16 a[192:207], v[28:31], v[56:59], a[192:207]
    v_mfma_f32_32x32x16_bf16 a[144:159], v[24:27], v[60:63], a[144:159]
    v_xor_b32 v4, 0x10000, v4
    v_xor_b32 v5, 0x10000, v5
    v_mfma_f32_32x32x16_bf16 a[208:223], v[28:31], v[60:63], a[208:223]
    v_xor_b32 v6, 0x10000, v6
    v_xor_b32 v7, 0x10000, v7
    v_mfma_f32_32x32x16_bf16 a[160:175], v[24:27], v[64:67], a[160:175]
    v_xor_b32 v8, 0x10000, v8
    v_xor_b32 v9, 0x10000, v9
    v_mfma_f32_32x32x16_bf16 a[224:239], v[28:31], v[64:67], a[224:239]
    v_xor_b32 v10, 0x10000, v10
    v_xor_b32 v11, 0x10000, v11
    v_mfma_f32_32x32x16_bf16 a[176:191], v[24:27], v[68:71], a[176:191]
    v_xor_b32 v12, 0x10000, v12
    v_xor_b32 v13, 0x10000, v13
    v_mfma_f32_32x32x16_bf16 a[240:255], v[28:31], v[68:71], a[240:255]
    v_xor_b32 v14, 0x10000, v14
    v_xor_b32 v15, 0x10000, v15
    s_waitcnt vmcnt(0) lgkmcnt(0)
    s_barrier
    v_mfma_f32_32x32x16_bf16 a[0:15], v[72:75], v[32:35], a[0:15]
    ds_read_b128 v[24:27], v4 offset:0
    ds_read_b64_tr_b16 v[40:41], v8 offset:32768
    v_mfma_f32_32x32x16_bf16 a[64:79], v[72:75], v[36:39], a[64:79]
    ds_read_b64_tr_b16 v[42:43], v8 offset:33792
    ds_read_b128 v[28:31], v4 offset:4096
    s_add_u32 m0, s38, 0
    s_mov_b32 s40, s33
    buffer_load_dwordx4 v3, s[20:23], s40 offen  lds
    v_mfma_f32_32x32x16_bf16 a[16:31], v[76:79], v[32:35], a[16:31]
    ds_read_b64_tr_b16 v[44:45], v9 offset:32768
    ds_read_b64_tr_b16 v[46:47], v9 offset:33792
    v_mfma_f32_32x32x16_bf16 a[80:95], v[76:79], v[36:39], a[80:95]
    ds_read_b64_tr_b16 v[48:49], v10 offset:32768
    ds_read_b64_tr_b16 v[50:51], v10 offset:33792
    s_add_u32 m0, s38, 1024
    s_add_u32 s40, s40, s35
    buffer_load_dwordx4 v3, s[20:23], s40 offen  lds
    v_mfma_f32_32x32x16_bf16 a[32:47], v[80:83], v[32:35], a[32:47]
    ds_read_b64_tr_b16 v[52:53], v11 offset:32768
    ds_read_b64_tr_b16 v[54:55], v11 offset:33792
    v_mfma_f32_32x32x16_bf16 a[96:111], v[80:83], v[36:39], a[96:111]
    ds_read_b64_tr_b16 v[56:57], v12 offset:49152
    ds_read_b64_tr_b16 v[58:59], v12 offset:50176
    s_add_u32 m0, s38, 2048
    s_add_u32 s40, s40, s35
    buffer_load_dwordx4 v3, s[20:23], s40 offen  lds
    v_mfma_f32_32x32x16_bf16 a[48:63], v[84:87], v[32:35], a[48:63]
    ds_read_b64_tr_b16 v[60:61], v13 offset:49152
    ds_read_b64_tr_b16 v[62:63], v13 offset:50176
    v_mfma_f32_32x32x16_bf16 a[112:127], v[84:87], v[36:39], a[112:127]
    s_waitcnt lgkmcnt(10)
    ds_read_b64_tr_b16 v[64:65], v14 offset:49152
    ds_read_b64_tr_b16 v[66:67], v14 offset:50176
    s_add_u32 m0, s38, 3072
    s_add_u32 s40, s40, s35
    buffer_load_dwordx4 v3, s[20:23], s40 offen  lds
    v_mfma_f32_32x32x16_bf16 a[128:143], v[32:35], v[88:91], a[128:143]
    ds_read_b64_tr_b16 v[68:69], v15 offset:49152
    ds_read_b64_tr_b16 v[70:71], v15 offset:50176
    v_mfma_f32_32x32x16_bf16 a[192:207], v[36:39], v[88:91], a[192:207]
    s_add_u32 m0, s38, 16384
    s_mov_b32 s40, s34
    buffer_load_dwordx4 v3, s[24:27], s40 offen  lds
    v_mfma_f32_32x32x16_bf16 a[144:159], v[32:35], v[92:95], a[144:159]
    v_mfma_f32_32x32x16_bf16 a[208:223], v[36:39], v[92:95], a[208:223]
    s_add_u32 m0, s38, 17408
    s_add_u32 s40, s40, s35
    buffer_load_dwordx4 v3, s[24:27], s40 offen  lds
    v_mfma_f32_32x32x16_bf16 a[160:175], v[32:35], v[96:99], a[160:175]
    v_mfma_f32_32x32x16_bf16 a[224:239], v[36:39], v[96:99], a[224:239]
    s_add_u32 m0, s38, 18432
    s_add_u32 s40, s40, s35
    buffer_load_dwordx4 v3, s[24:27], s40 offen  lds
    v_mfma_f32_32x32x16_bf16 a[176:191], v[32:35], v[100:103], a[176:191]
    v_mfma_f32_32x32x16_bf16 a[240:255], v[36:39], v[100:103], a[240:255]
    s_add_u32 m0, s38, 19456
    s_add_u32 s40, s40, s35
    buffer_load_dwordx4 v3, s[24:27], s40 offen  lds
    s_add_u32 s33, s33, s36
    s_add_u32 s34, s34, s36
    v_mfma_f32_32x32x16_bf16 a[0:15], v[40:43], v[24:27], a[0:15]
    s_waitcnt lgkmcnt(10)
    ds_read_b128 v[32:35], v5 offset:0
    ds_read_b64_tr_b16 v[72:73], v8 offset:36864
    v_mfma_f32_32x32x16_bf16 a[64:79], v[40:43], v[28:31], a[64:79]
    ds_read_b64_tr_b16 v[74:75], v8 offset:37888
    ds_read_b128 v[36:39], v5 offset:4096
    s_add_u32 m0, s37, 0
    s_add_u32 s39, s32, 0
    buffer_load_dwordx4 v1, s[12:15], s39 offen  lds
    v_mfma_f32_32x32x16_bf16 a[16:31], v[44:47], v[24:27], a[16:31]
    s_waitcnt lgkmcnt(10)
    ds_read_b64_tr_b16 v[76:77], v9 offset:36864
    ds_read_b64_tr_b16 v[78:79], v9 offset:37888
    v_mfma_f32_32x32x16_bf16 a[80:95], v[44:47], v[28:31], a[80:95]
    ds_read_b64_tr_b16 v[80:81], v10 offset:36864
    ds_read_b64_tr_b16 v[82:83], v10 offset:37888
    s_add_u32 m0, s37, 1024
    s_add_u32 s39, s32, 10240
    buffer_load_dwordx4 v2, s[12:15], s39 offen  lds
    v_mfma_f32_32x32x16_bf16 a[32:47], v[48:51], v[24:27], a[32:47]
    s_waitcnt lgkmcnt(10)
    ds_read_b64_tr_b16 v[84:85], v11 offset:36864
    ds_read_b64_tr_b16 v[86:87], v11 offset:37888
    v_mfma_f32_32x32x16_bf16 a[96:111], v[48:51], v[28:31], a[96:111]
    ds_read_b64_tr_b16 v[88:89], v12 offset:53248
    ds_read_b64_tr_b16 v[90:91], v12 offset:54272
    s_add_u32 m0, s37, 2048
    s_add_u32 s39, s32, 20480
    buffer_load_dwordx4 v1, s[12:15], s39 offen  lds
    v_mfma_f32_32x32x16_bf16 a[48:63], v[52:55], v[24:27], a[48:63]
    s_waitcnt lgkmcnt(10)
    ds_read_b64_tr_b16 v[92:93], v13 offset:53248
    ds_read_b64_tr_b16 v[94:95], v13 offset:54272
    v_mfma_f32_32x32x16_bf16 a[112:127], v[52:55], v[28:31], a[112:127]
    ds_read_b64_tr_b16 v[96:97], v14 offset:53248
    ds_read_b64_tr_b16 v[98:99], v14 offset:54272
    s_add_u32 m0, s37, 3072
    s_add_u32 s39, s32, 30720
    buffer_load_dwordx4 v2, s[12:15], s39 offen  lds
    v_mfma_f32_32x32x16_bf16 a[128:143], v[24:27], v[56:59], a[128:143]
    s_waitcnt lgkmcnt(10)
    ds_read_b64_tr_b16 v[100:101], v15 offset:53248
    ds_read_b64_tr_b16 v[102:103], v15 offset:54272
    v_mfma_f32_32x32x16_bf16 a[192:207], v[28:31], v[56:59], a[192:207]
    s_add_u32 m0, s37, 4096
    s_add_u32 s39, s32, 40960
    buffer_load_dwordx4 v1, s[12:15], s39 offen  lds
    v_mfma_f32_32x32x16_bf16 a[144:159], v[24:27], v[60:63], a[144:159]
    v_mfma_f32_32x32x16_bf16 a[208:223], v[28:31], v[60:63], a[208:223]
    s_add_u32 m0, s37, 5120
    s_add_u32 s39, s32, 51200
    buffer_load_dwordx4 v2, s[12:15], s39 offen  lds
    v_mfma_f32_32x32x16_bf16 a[160:175], v[24:27], v[64:67], a[160:175]
    v_mfma_f32_32x32x16_bf16 a[224:239], v[28:31], v[64:67], a[224:239]
    s_add_u32 m0, s37, 6144
    s_add_u32 s39, s32, 61440
    buffer_load_dwordx4 v1, s[12:15], s39 offen  lds
    v_mfma_f32_32x32x16_bf16 a[176:191], v[24:27], v[68:71], a[176:191]
    v_mfma_f32_32x32x16_bf16 a[240:255], v[28:31], v[68:71], a[240:255]
    s_add_u32 m0, s37, 7168
    s_add_u32 s39, s32, 71680
    buffer_load_dwordx4 v2, s[12:15], s39 offen  lds
    s_add_u32 s32, s32, 128
    v_mfma_f32_32x32x16_bf16 a[0:15], v[72:75], v[32:35], a[0:15]
    ds_read_b128 v[24:27], v6 offset:0
    ds_read_b64_tr_b16 v[40:41], v8 offset:40960
    v_mfma_f32_32x32x16_bf16 a[64:79], v[72:75], v[36:39], a[64:79]
    s_waitcnt lgkmcnt(10)
    ds_read_b64_tr_b16 v[42:43], v8 offset:41984
    ds_read_b128 v[28:31], v6 offset:4096
    buffer_store_dwordx4 v[216:219], v21, s[88:91], s92 offen sc1
    s_add_u32 s92, s92, s93
    v_mfma_f32_32x32x16_bf16 a[16:31], v[76:79], v[32:35], a[16:31]
    ds_read_b64_tr_b16 v[44:45], v9 offset:40960
    ds_read_b64_tr_b16 v[46:47], v9 offset:41984
    v_mfma_f32_32x32x16_bf16 a[80:95], v[76:79], v[36:39], a[80:95]
    s_waitcnt lgkmcnt(10)
    ds_read_b64_tr_b16 v[48:49], v10 offset:40960
    ds_read_b64_tr_b16 v[50:51], v10 offset:41984
    v_mfma_f32_32x32x16_bf16 a[32:47], v[80:83], v[32:35], a[32:47]
    ds_read_b64_tr_b16 v[52:53], v11 offset:40960
    ds_read_b64_tr_b16 v[54:55], v11 offset:41984
    buffer_store_dwordx4 v[220:223], v21, s[88:91], s92 offen sc1
    s_add_u32 s92, s92, s94
    v_mfma_f32_32x32x16_bf16 a[96:111], v[80:83], v[36:39], a[96:111]
    s_waitcnt lgkmcnt(10)
    ds_read_b64_tr_b16 v[56:57], v12 offset:57344
    ds_read_b64_tr_b16 v[58:59], v12 offset:58368
    v_mfma_f32_32x32x16_bf16 a[48:63], v[84:87], v[32:35], a[48:63]
    ds_read_b64_tr_b16 v[60:61], v13 offset:57344
    ds_read_b64_tr_b16 v[62:63], v13 offset:58368
    v_mfma_f32_32x32x16_bf16 a[112:127], v[84:87], v[36:39], a[112:127]
    s_waitcnt lgkmcnt(10)
    ds_read_b64_tr_b16 v[64:65], v14 offset:57344
    ds_read_b64_tr_b16 v[66:67], v14 offset:58368
    buffer_store_dwordx4 v[224:227], v21, s[88:91], s92 offen sc1
    s_add_u32 s92, s92, s93
    v_mfma_f32_32x32x16_bf16 a[128:143], v[32:35], v[88:91], a[128:143]
    ds_read_b64_tr_b16 v[68:69], v15 offset:57344
    ds_read_b64_tr_b16 v[70:71], v15 offset:58368
    v_mfma_f32_32x32x16_bf16 a[192:207], v[36:39], v[88:91], a[192:207]
    v_mfma_f32_32x32x16_bf16 a[144:159], v[32:35], v[92:95], a[144:159]
    buffer_store_dwordx4 v[228:231], v21, s[88:91], s92 offen sc1
    s_add_u32 s92, s92, s96
    v_mfma_f32_32x32x16_bf16 a[208:223], v[36:39], v[92:95], a[208:223]
    v_mfma_f32_32x32x16_bf16 a[160:175], v[32:35], v[96:99], a[160:175]
    v_mfma_f32_32x32x16_bf16 a[224:239], v[36:39], v[96:99], a[224:239]
    v_mfma_f32_32x32x16_bf16 a[176:191], v[32:35], v[100:103], a[176:191]
    v_mfma_f32_32x32x16_bf16 a[240:255], v[36:39], v[100:103], a[240:255]
    v_mfma_f32_32x32x16_bf16 a[0:15], v[40:43], v[24:27], a[0:15]
    s_waitcnt lgkmcnt(10)
    ds_read_b128 v[32:35], v7 offset:0
    ds_read_b64_tr_b16 v[72:73], v8 offset:45056
    v_mfma_f32_32x32x16_bf16 a[64:79], v[40:43], v[28:31], a[64:79]
    ds_read_b64_tr_b16 v[74:75], v8 offset:46080
    ds_read_b128 v[36:39], v7 offset:4096
    v_mfma_f32_32x32x16_bf16 a[16:31], v[44:47], v[24:27], a[16:31]
    s_waitcnt lgkmcnt(10)
    ds_read_b64_tr_b16 v[76:77], v9 offset:45056
    ds_read_b64_tr_b16 v[78:79], v9 offset:46080
    v_mfma_f32_32x32x16_bf16 a[80:95], v[44:47], v[28:31], a[80:95]
    ds_read_b64_tr_b16 v[80:81], v10 offset:45056
    ds_read_b64_tr_b16 v[82:83], v10 offset:46080
    v_mfma_f32_32x32x16_bf16 a[32:47], v[48:51], v[24:27], a[32:47]
    s_waitcnt lgkmcnt(10)
    ds_read_b64_tr_b16 v[84:85], v11 offset:45056
    ds_read_b64_tr_b16 v[86:87], v11 offset:46080
    v_mfma_f32_32x32x16_bf16 a[96:111], v[48:51], v[28:31], a[96:111]
    ds_read_b64_tr_b16 v[88:89], v12 offset:61440
    ds_read_b64_tr_b16 v[90:91], v12 offset:62464
    v_mfma_f32_32x32x16_bf16 a[48:63], v[52:55], v[24:27], a[48:63]
    s_waitcnt lgkmcnt(10)
    ds_read_b64_tr_b16 v[92:93], v13 offset:61440
    ds_read_b64_tr_b16 v[94:95], v13 offset:62464
    v_mfma_f32_32x32x16_bf16 a[112:127], v[52:55], v[28:31], a[112:127]
    ds_read_b64_tr_b16 v[96:97], v14 offset:61440
    ds_read_b64_tr_b16 v[98:99], v14 offset:62464
    v_mfma_f32_32x32x16_bf16 a[128:143], v[24:27], v[56:59], a[128:143]
    s_waitcnt lgkmcnt(10)
    ds_read_b64_tr_b16 v[100:101], v15 offset:61440
    ds_read_b64_tr_b16 v[102:103], v15 offset:62464
    v_mfma_f32_32x32x16_bf16 a[192:207], v[28:31], v[56:59], a[192:207]
    v_mfma_f32_32x32x16_bf16 a[144:159], v[24:27], v[60:63], a[144:159]
    v_xor_b32 v4, 0x10000, v4
    v_xor_b32 v5, 0x10000, v5
    v_mfma_f32_32x32x16_bf16 a[208:223], v[28:31], v[60:63], a[208:223]
    v_xor_b32 v6, 0x10000, v6
    v_xor_b32 v7, 0x10000, v7
    v_mfma_f32_32x32x16_bf16 a[160:175], v[24:27], v[64:67], a[160:175]
    v_xor_b32 v8, 0x10000, v8
    v_xor_b32 v9, 0x10000, v9
    v_mfma_f32_32x32x16_bf16 a[224:239], v[28:31], v[64:67], a[224:239]
    v_xor_b32 v10, 0x10000, v10
    v_xor_b32 v11, 0x10000, v11
    v_mfma_f32_32x32x16_bf16 a[176:191], v[24:27], v[68:71], a[176:191]
    v_xor_b32 v12, 0x10000, v12
    v_xor_b32 v13, 0x10000, v13
    v_mfma_f32_32x32x16_bf16 a[240:255], v[28:31], v[68:71], a[240:255]
    v_xor_b32 v14, 0x10000, v14
    v_xor_b32 v15, 0x10000, v15
    s_waitcnt vmcnt(0) lgkmcnt(0)
    s_barrier
    s_cmp_lg_u32 s17, 0
    s_cbranch_scc1 L_ps_gtn
    v_mov_b32 v22, s62
    s_mov_b64 exec, 1
    buffer_atomic_add v22, off, s[8:11], s61
    s_mov_b64 exec, -1
L_ps_gtn:
    s_mov_b32 s90, 0
    s_mov_b32 s62, 0
    v_mfma_f32_32x32x16_bf16 a[0:15], v[72:75], v[32:35], a[0:15]
    ds_read_b128 v[24:27], v4 offset:0
    ds_read_b64_tr_b16 v[40:41], v8 offset:32768
    v_mfma_f32_32x32x16_bf16 a[64:79], v[72:75], v[36:39], a[64:79]
    ds_read_b64_tr_b16 v[42:43], v8 offset:33792
    ds_read_b128 v[28:31], v4 offset:4096
    s_add_u32 m0, s38, 65536
    s_mov_b32 s40, s33
    buffer_load_dwordx4 v3, s[20:23], s40 offen  lds
    v_mfma_f32_32x32x16_bf16 a[16:31], v[76:79], v[32:35], a[16:31]
    ds_read_b64_tr_b16 v[44:45], v9 offset:32768
    ds_read_b64_tr_b16 v[46:47], v9 offset:33792
    v_mfma_f32_32x32x16_bf16 a[80:95], v[76:79], v[36:39], a[80:95]
    ds_read_b64_tr_b16 v[48:49], v10 offset:32768
    ds_read_b64_tr_b16 v[50:51], v10 offset:33792
    s_add_u32 m0, s38, 66560
    s_add_u32 s40, s40, s35
    buffer_load_dwordx4 v3, s[20:23], s40 offen  lds
    v_mfma_f32_32x32x16_bf16 a[32:47], v[80:83], v[32:35], a[32:47]
    ds_read_b64_tr_b16 v[52:53], v11 offset:32768
    ds_read_b64_tr_b16 v[54:55], v11 offset:33792
    v_mfma_f32_32x32x16_bf16 a[96:111], v[80:83], v[36:39], a[96:111]
    ds_read_b64_tr_b16 v[56:57], v12 offset:49152
    ds_read_b64_tr_b16 v[58:59], v12 offset:50176
    s_add_u32 m0, s38, 67584
    s_add_u32 s40, s40, s35
    buffer_load_dwordx4 v3, s[20:23], s40 offen  lds
    v_mfma_f32_32x32x16_bf16 a[48:63], v[84:87], v[32:35], a[48:63]
    ds_read_b64_tr_b16 v[60:61], v13 offset:49152
    ds_read_b64_tr_b16 v[62:63], v13 offset:50176
    v_mfma_f32_32x32x16_bf16 a[112:127], v[84:87], v[36:39], a[112:127]
    s_waitcnt lgkmcnt(10)
    ds_read_b64_tr_b16 v[64:65], v14 offset:49152
    ds_read_b64_tr_b16 v[66:67], v14 offset:50176
    s_add_u32 m0, s38, 68608
    s_add_u32 s40, s40, s35
    buffer_load_dwordx4 v3, s[20:23], s40 offen  lds
    v_mfma_f32_32x32x16_bf16 a[128:143], v[32:35], v[88:91], a[128:143]
    ds_read_b64_tr_b16 v[68:69], v15 offset:49152
    ds_read_b64_tr_b16 v[70:71], v15 offset:50176
    v_mfma_f32_32x32x16_bf16 a[192:207], v[36:39], v[88:91], a[192:207]
    s_add_u32 m0, s38, 81920
    s_mov_b32 s40, s34
    buffer_load_dwordx4 v3, s[24:27], s40 offen  lds
    v_mfma_f32_32x32x16_bf16 a[144:159], v[32:35], v[92:95], a[144:159]
    v_mfma_f32_32x32x16_bf16 a[208:223], v[36:39], v[92:95], a[208:223]
    s_add_u32 m0, s38, 82944
    s_add_u32 s40, s40, s35
    buffer_load_dwordx4 v3, s[24:27], s40 offen  lds
    v_mfma_f32_32x32x16_bf16 a[160:175], v[32:35], v[96:99], a[160:175]
    v_mfma_f32_32x32x16_bf16 a[224:239], v[36:39], v[96:99], a[224:239]
    s_add_u32 m0, s38, 83968
    s_add_u32 s40, s40, s35
    buffer_load_dwordx4 v3, s[24:27], s40 offen  lds
    v_mfma_f32_32x32x16_bf16 a[176:191], v[32:35], v[100:103], a[176:191]
    v_mfma_f32_32x32x16_bf16 a[240:255], v[36:39], v[100:103], a[240:255]
    s_add_u32 m0, s38, 84992
    s_add_u32 s40, s40, s35
    buffer_load_dwordx4 v3, s[24:27], s40 offen  lds
    s_add_u32 s33, s33, s36
    s_add_u32 s34, s34, s36
    v_mfma_f32_32x32x16_bf16 a[0:15], v[40:43], v[24:27], a[0:15]
    s_waitcnt lgkmcnt(10)
    ds_read_b128 v[32:35], v5 offset:0
    ds_read_b64_tr_b16 v[72:73], v8 offset:36864
    v_mfma_f32_32x32x16_bf16 a[64:79], v[40:43], v[28:31], a[64:79]
    ds_read_b64_tr_b16 v[74:75], v8 offset:37888
    ds_read_b128 v[36:39], v5 offset:4096
    s_add_u32 m0, s37, 65536
    s_add_u32 s39, s32, 0
    buffer_load_dwordx4 v1, s[12:15], s39 offen  lds
    v_mfma_f32_32x32x16_bf16 a[16:31], v[44:47], v[24:27], a[16:31]
    s_waitcnt lgkmcnt(10)
    ds_read_b64_tr_b16 v[76:77], v9 offset:36864
    ds_read_b64_tr_b16 v[78:79], v9 offset:37888
    v_mfma_f32_32x32x16_bf16 a[80:95], v[44:47], v[28:31], a[80:95]
    ds_read_b64_tr_b16 v[80:81], v10 offset:36864
    ds_read_b64_tr_b16 v[82:83], v10 offset:37888
    s_add_u32 m0, s37, 66560
    s_add_u32 s39, s32, 10240
    buffer_load_dwordx4 v2, s[12:15], s39 offen  lds
    v_mfma_f32_32x32x16_bf16 a[32:47], v[48:51], v[24:27], a[32:47]
    s_waitcnt lgkmcnt(10)
    ds_read_b64_tr_b16 v[84:85], v11 offset:36864
    ds_read_b64_tr_b16 v[86:87], v11 offset:37888
    v_mfma_f32_32x32x16_bf16 a[96:111], v[48:51], v[28:31], a[96:111]
    ds_read_b64_tr_b16 v[88:89], v12 offset:53248
    ds_read_b64_tr_b16 v[90:91], v12 offset:54272
    s_add_u32 m0, s37, 67584
    s_add_u32 s39, s32, 20480
    buffer_load_dwordx4 v1, s[12:15], s39 offen  lds
    v_mfma_f32_32x32x16_bf16 a[48:63], v[52:55], v[24:27], a[48:63]
    s_waitcnt lgkmcnt(10)
    ds_read_b64_tr_b16 v[92:93], v13 offset:53248
    ds_read_b64_tr_b16 v[94:95], v13 offset:54272
    v_mfma_f32_32x32x16_bf16 a[112:127], v[52:55], v[28:31], a[112:127]
    ds_read_b64_tr_b16 v[96:97], v14 offset:53248
    ds_read_b64_tr_b16 v[98:99], v14 offset:54272
    s_add_u32 m0, s37, 68608
    s_add_u32 s39, s32, 30720
    buffer_load_dwordx4 v2, s[12:15], s39 offen  lds
    v_mfma_f32_32x32x16_bf16 a[128:143], v[24:27], v[56:59], a[128:143]
    s_waitcnt lgkmcnt(10)
    ds_read_b64_tr_b16 v[100:101], v15 offset:53248
    ds_read_b64_tr_b16 v[102:103], v15 offset:54272
    v_mfma_f32_32x32x16_bf16 a[192:207], v[28:31], v[56:59], a[192:207]
    s_add_u32 m0, s37, 69632
    s_add_u32 s39, s32, 40960
    buffer_load_dwordx4 v1, s[12:15], s39 offen  lds
    v_mfma_f32_32x32x16_bf16 a[144:159], v[24:27], v[60:63], a[144:159]
    v_mfma_f32_32x32x16_bf16 a[208:223], v[28:31], v[60:63], a[208:223]
    s_add_u32 m0, s37, 70656
    s_add_u32 s39, s32, 51200
    buffer_load_dwordx4 v2, s[12:15], s39 offen  lds
    v_mfma_f32_32x32x16_bf16 a[160:175], v[24:27], v[64:67], a[160:175]
    v_mfma_f32_32x32x16_bf16 a[224:239], v[28:31], v[64:67], a[224:239]
    s_add_u32 m0, s37, 71680
    s_add_u32 s39, s32, 61440
    buffer_load_dwordx4 v1, s[12:15], s39 offen  lds
    v_mfma_f32_32x32x16_bf16 a[176:191], v[24:27], v[68:71], a[176:191]
    v_mfma_f32_32x32x16_bf16 a[240:255], v[28:31], v[68:71], a[240:255]
    s_add_u32 m0, s37, 72704
    s_add_u32 s39, s32, 71680
    buffer_load_dwordx4 v2, s[12:15], s39 offen  lds
    s_add_u32 s32, s32, 128
    v_mfma_f32_32x32x16_bf16 a[0:15], v[72:75], v[32:35], a[0:15]
    ds_read_b128 v[24:27], v6 offset:0
    ds_read_b64_tr_b16 v[40:41], v8 offset:40960
    v_mfma_f32_32x32x16_bf16 a[64:79], v[72:75], v[36:39], a[64:79]
    s_waitcnt lgkmcnt(10)
    ds_read_b64_tr_b16 v[42:43], v8 offset:41984
    ds_read_b128 v[28:31], v6 offset:4096
    v_mfma_f32_32x32x16_bf16 a[16:31], v[76:79], v[32:35], a[16:31]
    ds_read_b64_tr_b16 v[44:45], v9 offset:40960
    ds_read_b64_tr_b16 v[46:47], v9 offset:41984
    v_mfma_f32_32x32x16_bf16 a[80:95], v[76:79], v[36:39], a[80:95]
    s_waitcnt lgkmcnt(10)
    ds_read_b64_tr_b16 v[48:49], v10 offset:40960
    ds_read_b64_tr_b16 v[50:51], v10 offset:41984
    v_mfma_f32_32x32x16_bf16 a[32:47], v[80:83], v[32:35], a[32:47]
    ds_read_b64_tr_b16 v[52:53], v11 offset:40960
    ds_read_b64_tr_b16 v[54:55], v11 offset:41984
    v_mfma_f32_32x32x16_bf16 a[96:111], v[80:83], v[36:39], a[96:111]
    s_waitcnt lgkmcnt(10)
    ds_read_b64_tr_b16 v[56:57], v12 offset:57344
    ds_read_b64_tr_b16 v[58:59], v12 offset:58368
    v_mfma_f32_32x32x16_bf16 a[48:63], v[84:87], v[32:35], a[48:63]
    ds_read_b64_tr_b16 v[60:61], v13 offset:57344
    ds_read_b64_tr_b16 v[62:63], v13 offset:58368
    v_mfma_f32_32x32x16_bf16 a[112:127], v[84:87], v[36:39], a[112:127]
    s_waitcnt lgkmcnt(10)
    ds_read_b64_tr_b16 v[64:65], v14 offset:57344
    ds_read_b64_tr_b16 v[66:67], v14 offset:58368
    v_mfma_f32_32x32x16_bf16 a[128:143], v[32:35], v[88:91], a[128:143]
    ds_read_b64_tr_b16 v[68:69], v15 offset:57344
    ds_read_b64_tr_b16 v[70:71], v15 offset:58368
    v_mfma_f32_32x32x16_bf16 a[192:207], v[36:39], v[88:91], a[192:207]
    v_mfma_f32_32x32x16_bf16 a[144:159], v[32:35], v[92:95], a[144:159]
    v_mfma_f32_32x32x16_bf16 a[208:223], v[36:39], v[92:95], a[208:223]
    v_mfma_f32_32x32x16_bf16 a[160:175], v[32:35], v[96:99], a[160:175]
    v_mfma_f32_32x32x16_bf16 a[224:239], v[36:39], v[96:99], a[224:239]
    v_mfma_f32_32x32x16_bf16 a[176:191], v[32:35], v[100:103], a[176:191]
    v_mfma_f32_32x32x16_bf16 a[240:255], v[36:39], v[100:103], a[240:255]
    v_mfma_f32_32x32x16_bf16 a[0:15], v[40:43], v[24:27], a[0:15]
    s_waitcnt lgkmcnt(10)
    ds_read_b128 v[32:35], v7 offset:0
    ds_read_b64_tr_b16 v[72:73], v8 offset:45056
    v_mfma_f32_32x32x16_bf16 a[64:79], v[40:43], v[28:31], a[64:79]
    ds_read_b64_tr_b16 v[74:75], v8 offset:46080
    ds_read_b128 v[36:39], v7 offset:4096
    v_mfma_f32_32x32x16_bf16 a[16:31], v[44:47], v[24:27], a[16:31]
    s_waitcnt lgkmcnt(10)
    ds_read_b64_tr_b16 v[76:77], v9 offset:45056
    ds_read_b64_tr_b16 v[78:79], v9 offset:46080
    v_mfma_f32_32x32x16_bf16 a[80:95], v[44:47], v[28:31], a[80:95]
    ds_read_b64_tr_b16 v[80:81], v10 offset:45056
    ds_read_b64_tr_b16 v[82:83], v10 offset:46080
    v_mfma_f32_32x32x16_bf16 a[32:47], v[48:51], v[24:27], a[32:47]
    s_waitcnt lgkmcnt(10)
    ds_read_b64_tr_b16 v[84:85], v11 offset:45056
    ds_read_b64_tr_b16 v[86:87], v11 offset:46080
    v_mfma_f32_32x32x16_bf16 a[96:111], v[48:51], v[28:31], a[96:111]
    ds_read_b64_tr_b16 v[88:89], v12 offset:61440
    ds_read_b64_tr_b16 v[90:91], v12 offset:62464
    v_mfma_f32_32x32x16_bf16 a[48:63], v[52:55], v[24:27], a[48:63]
    s_waitcnt lgkmcnt(10)
    ds_read_b64_tr_b16 v[92:93], v13 offset:61440
    ds_read_b64_tr_b16 v[94:95], v13 offset:62464
    v_mfma_f32_32x32x16_bf16 a[112:127], v[52:55], v[28:31], a[112:127]
    ds_read_b64_tr_b16 v[96:97], v14 offset:61440
    ds_read_b64_tr_b16 v[98:99], v14 offset:62464
    v_mfma_f32_32x32x16_bf16 a[128:143], v[24:27], v[56:59], a[128:143]
    s_waitcnt lgkmcnt(10)
    ds_read_b64_tr_b16 v[100:101], v15 offset:61440
    ds_read_b64_tr_b16 v[102:103], v15 offset:62464
    v_mfma_f32_32x32x16_bf16 a[192:207], v[28:31], v[56:59], a[192:207]
    v_mfma_f32_32x32x16_bf16 a[144:159], v[24:27], v[60:63], a[144:159]
    v_xor_b32 v4, 0x10000, v4
    v_xor_b32 v5, 0x10000, v5
    v_mfma_f32_32x32x16_bf16 a[208:223], v[28:31], v[60:63], a[208:223]
    v_xor_b32 v6, 0x10000, v6
    v_xor_b32 v7, 0x10000, v7
    v_mfma_f32_32x32x16_bf16 a[160:175], v[24:27], v[64:67], a[160:175]
    v_xor_b32 v8, 0x10000, v8
    v_xor_b32 v9, 0x10000, v9
    v_mfma_f32_32x32x16_bf16 a[224:239], v[28:31], v[64:67], a[224:239]
    v_xor_b32 v10, 0x10000, v10
    v_xor_b32 v11, 0x10000, v11
    v_mfma_f32_32x32x16_bf16 a[176:191], v[24:27], v[68:71], a[176:191]
    v_xor_b32 v12, 0x10000, v12
    v_xor_b32 v13, 0x10000, v13
    v_mfma_f32_32x32x16_bf16 a[240:255], v[28:31], v[68:71], a[240:255]
    v_xor_b32 v14, 0x10000, v14
    v_xor_b32 v15, 0x10000, v15
    s_waitcnt vmcnt(0) lgkmcnt(0)
    s_barrier
    v_mfma_f32_32x32x16_bf16 a[0:15], v[72:75], v[32:35], a[0:15]
    ds_read_b128 v[24:27], v4 offset:0
    ds_read_b64_tr_b16 v[40:41], v8 offset:32768
    v_mfma_f32_32x32x16_bf16 a[64:79], v[72:75], v[36:39], a[64:79]
    ds_read_b64_tr_b16 v[42:43], v8 offset:33792
    ds_read_b128 v[28:31], v4 offset:4096
    v_mfma_f32_32x32x16_bf16 a[16:31], v[76:79], v[32:35], a[16:31]
    ds_read_b64_tr_b16 v[44:45], v9 offset:32768
    ds_read_b64_tr_b16 v[46:47], v9 offset:33792
    v_mfma_f32_32x32x16_bf16 a[80:95], v[76:79], v[36:39], a[80:95]
    ds_read_b64_tr_b16 v[48:49], v10 offset:32768
    ds_read_b64_tr_b16 v[50:51], v10 offset:33792
    v_mfma_f32_32x32x16_bf16 a[32:47], v[80:83], v[32:35], a[32:47]
    ds_read_b64_tr_b16 v[52:53], v11 offset:32768
    ds_read_b64_tr_b16 v[54:55], v11 offset:33792
    v_mfma_f32_32x32x16_bf16 a[96:111], v[80:83], v[36:39], a[96:111]
    ds_read_b64_tr_b16 v[56:57], v12 offset:49152
    ds_read_b64_tr_b16 v[58:59], v12 offset:50176
    v_mfma_f32_32x32x16_bf16 a[48:63], v[84:87], v[32:35], a[48:63]
    ds_read_b64_tr_b16 v[60:61], v13 offset:49152
    ds_read_b64_tr_b16 v[62:63], v13 offset:50176
    v_mfma_f32_32x32x16_bf16 a[112:127], v[84:87], v[36:39], a[112:127]
    s_waitcnt lgkmcnt(10)
    ds_read_b64_tr_b16 v[64:65], v14 offset:49152
    ds_read_b64_tr_b16 v[66:67], v14 offset:50176
    v_mfma_f32_32x32x16_bf16 a[128:143], v[32:35], v[88:91], a[128:143]
    ds_read_b64_tr_b16 v[68:69], v15 offset:49152
    ds_read_b64_tr_b16 v[70:71], v15 offset:50176
    v_mfma_f32_32x32x16_bf16 a[192:207], v[36:39], v[88:91], a[192:207]
    v_mfma_f32_32x32x16_bf16 a[144:159], v[32:35], v[92:95], a[144:159]
    v_mfma_f32_32x32x16_bf16 a[208:223], v[36:39], v[92:95], a[208:223]
    v_mfma_f32_32x32x16_bf16 a[160:175], v[32:35], v[96:99], a[160:175]
    v_mfma_f32_32x32x16_bf16 a[224:239], v[36:39], v[96:99], a[224:239]
    v_mfma_f32_32x32x16_bf16 a[176:191], v[32:35], v[100:103], a[176:191]
    v_mfma_f32_32x32x16_bf16 a[240:255], v[36:39], v[100:103], a[240:255]
    v_mfma_f32_32x32x16_bf16 a[0:15], v[40:43], v[24:27], a[0:15]
    s_waitcnt lgkmcnt(10)
    ds_read_b128 v[32:35], v5 offset:0
    ds_read_b64_tr_b16 v[72:73], v8 offset:36864
    v_mfma_f32_32x32x16_bf16 a[64:79], v[40:43], v[28:31], a[64:79]
    ds_read_b64_tr_b16 v[74:75], v8 offset:37888
    ds_read_b128 v[36:39], v5 offset:4096
    v_mfma_f32_32x32x16_bf16 a[16:31], v[44:47], v[24:27], a[16:31]
    s_waitcnt lgkmcnt(10)
    ds_read_b64_tr_b16 v[76:77], v9 offset:36864
    ds_read_b64_tr_b16 v[78:79], v9 offset:37888
    v_mfma_f32_32x32x16_bf16 a[80:95], v[44:47], v[28:31], a[80:95]
    ds_read_b64_tr_b16 v[80:81], v10 offset:36864
    ds_read_b64_tr_b16 v[82:83], v10 offset:37888
    v_mfma_f32_32x32x16_bf16 a[32:47], v[48:51], v[24:27], a[32:47]
    s_waitcnt lgkmcnt(10)
    ds_read_b64_tr_b16 v[84:85], v11 offset:36864
    ds_read_b64_tr_b16 v[86:87], v11 offset:37888
    v_mfma_f32_32x32x16_bf16 a[96:111], v[48:51], v[28:31], a[96:111]
    ds_read_b64_tr_b16 v[88:89], v12 offset:53248
    ds_read_b64_tr_b16 v[90:91], v12 offset:54272
    v_mfma_f32_32x32x16_bf16 a[48:63], v[52:55], v[24:27], a[48:63]
    s_waitcnt lgkmcnt(10)
    ds_read_b64_tr_b16 v[92:93], v13 offset:53248
    ds_read_b64_tr_b16 v[94:95], v13 offset:54272
    v_mfma_f32_32x32x16_bf16 a[112:127], v[52:55], v[28:31], a[112:127]
    ds_read_b64_tr_b16 v[96:97], v14 offset:53248
    ds_read_b64_tr_b16 v[98:99], v14 offset:54272
    v_mfma_f32_32x32x16_bf16 a[128:143], v[24:27], v[56:59], a[128:143]
    s_waitcnt lgkmcnt(10)
    ds_read_b64_tr_b16 v[100:101], v15 offset:53248
    ds_read_b64_tr_b16 v[102:103], v15 offset:54272
    v_mfma_f32_32x32x16_bf16 a[192:207], v[28:31], v[56:59], a[192:207]
    v_mfma_f32_32x32x16_bf16 a[144:159], v[24:27], v[60:63], a[144:159]
    v_mfma_f32_32x32x16_bf16 a[208:223], v[28:31], v[60:63], a[208:223]
    v_mfma_f32_32x32x16_bf16 a[160:175], v[24:27], v[64:67], a[160:175]
    v_mfma_f32_32x32x16_bf16 a[224:239], v[28:31], v[64:67], a[224:239]
    v_mfma_f32_32x32x16_bf16 a[176:191], v[24:27], v[68:71], a[176:191]
    v_mfma_f32_32x32x16_bf16 a[240:255], v[28:31], v[68:71], a[240:255]
    v_mfma_f32_32x32x16_bf16 a[0:15], v[72:75], v[32:35], a[0:15]
    ds_read_b128 v[24:27], v6 offset:0
    ds_read_b64_tr_b16 v[40:41], v8 offset:40960
    v_mfma_f32_32x32x16_bf16 a[64:79], v[72:75], v[36:39], a[64:79]
    s_waitcnt lgkmcnt(10)
    ds_read_b64_tr_b16 v[42:43], v8 offset:41984
    ds_read_b128 v[28:31], v6 offset:4096
    v_mfma_f32_32x32x16_bf16 a[16:31], v[76:79], v[32:35], a[16:31]
    ds_read_b64_tr_b16 v[44:45], v9 offset:40960
    ds_read_b64_tr_b16 v[46:47], v9 offset:41984
    v_mfma_f32_32x32x16_bf16 a[80:95], v[76:79], v[36:39], a[80:95]
    s_waitcnt lgkmcnt(10)
    ds_read_b64_tr_b16 v[48:49], v10 offset:40960
    ds_read_b64_tr_b16 v[50:51], v10 offset:41984
    v_mfma_f32_32x32x16_bf16 a[32:47], v[80:83], v[32:35], a[32:47]
    ds_read_b64_tr_b16 v[52:53], v11 offset:40960
    ds_read_b64_tr_b16 v[54:55], v11 offset:41984
    v_mfma_f32_32x32x16_bf16 a[96:111], v[80:83], v[36:39], a[96:111]
    s_waitcnt lgkmcnt(10)
    ds_read_b64_tr_b16 v[56:57], v12 offset:57344
    ds_read_b64_tr_b16 v[58:59], v12 offset:58368
    v_mfma_f32_32x32x16_bf16 a[48:63], v[84:87], v[32:35], a[48:63]
    ds_read_b64_tr_b16 v[60:61], v13 offset:57344
    ds_read_b64_tr_b16 v[62:63], v13 offset:58368
    v_mfma_f32_32x32x16_bf16 a[112:127], v[84:87], v[36:39], a[112:127]
    s_waitcnt lgkmcnt(10)
    ds_read_b64_tr_b16 v[64:65], v14 offset:57344
    ds_read_b64_tr_b16 v[66:67], v14 offset:58368
    v_mfma_f32_32x32x16_bf16 a[128:143], v[32:35], v[88:91], a[128:143]
    ds_read_b64_tr_b16 v[68:69], v15 offset:57344
    ds_read_b64_tr_b16 v[70:71], v15 offset:58368
    v_mfma_f32_32x32x16_bf16 a[192:207], v[36:39], v[88:91], a[192:207]
    v_mfma_f32_32x32x16_bf16 a[144:159], v[32:35], v[92:95], a[144:159]
    v_mfma_f32_32x32x16_bf16 a[208:223], v[36:39], v[92:95], a[208:223]
    v_mfma_f32_32x32x16_bf16 a[160:175], v[32:35], v[96:99], a[160:175]
    v_mfma_f32_32x32x16_bf16 a[224:239], v[36:39], v[96:99], a[224:239]
    v_mfma_f32_32x32x16_bf16 a[176:191], v[32:35], v[100:103], a[176:191]
    v_mfma_f32_32x32x16_bf16 a[240:255], v[36:39], v[100:103], a[240:255]
    v_mfma_f32_32x32x16_bf16 a[0:15], v[40:43], v[24:27], a[0:15]
    s_waitcnt lgkmcnt(10)
    ds_read_b128 v[32:35], v7 offset:0
    ds_read_b64_tr_b16 v[72:73], v8 offset:45056
    v_mfma_f32_32x32x16_bf16 a[64:79], v[40:43], v[28:31], a[64:79]
    ds_read_b64_tr_b16 v[74:75], v8 offset:46080
    ds_read_b128 v[36:39], v7 offset:4096
    v_mfma_f32_32x32x16_bf16 a[16:31], v[44:47], v[24:27], a[16:31]
    s_waitcnt lgkmcnt(10)
    ds_read_b64_tr_b16 v[76:77], v9 offset:45056
    ds_read_b64_tr_b16 v[78:79], v9 offset:46080
    v_mfma_f32_32x32x16_bf16 a[80:95], v[44:47], v[28:31], a[80:95]
    ds_read_b64_tr_b16 v[80:81], v10 offset:45056
    ds_read_b64_tr_b16 v[82:83], v10 offset:46080
    v_mfma_f32_32x32x16_bf16 a[32:47], v[48:51], v[24:27], a[32:47]
    s_waitcnt lgkmcnt(10)
    ds_read_b64_tr_b16 v[84:85], v11 offset:45056
    ds_read_b64_tr_b16 v[86:87], v11 offset:46080
    v_mfma_f32_32x32x16_bf16 a[96:111], v[48:51], v[28:31], a[96:111]
    ds_read_b64_tr_b16 v[88:89], v12 offset:61440
    ds_read_b64_tr_b16 v[90:91], v12 offset:62464
    v_mfma_f32_32x32x16_bf16 a[48:63], v[52:55], v[24:27], a[48:63]
    s_waitcnt lgkmcnt(10)
    ds_read_b64_tr_b16 v[92:93], v13 offset:61440
    ds_read_b64_tr_b16 v[94:95], v13 offset:62464
    v_mfma_f32_32x32x16_bf16 a[112:127], v[52:55], v[28:31], a[112:127]
    ds_read_b64_tr_b16 v[96:97], v14 offset:61440
    ds_read_b64_tr_b16 v[98:99], v14 offset:62464
    v_mfma_f32_32x32x16_bf16 a[128:143], v[24:27], v[56:59], a[128:143]
    s_waitcnt lgkmcnt(10)
    ds_read_b64_tr_b16 v[100:101], v15 offset:61440
    ds_read_b64_tr_b16 v[102:103], v15 offset:62464
    v_mfma_f32_32x32x16_bf16 a[192:207], v[28:31], v[56:59], a[192:207]
    v_mfma_f32_32x32x16_bf16 a[144:159], v[24:27], v[60:63], a[144:159]
    v_xor_b32 v4, 0x10000, v4
    v_xor_b32 v5, 0x10000, v5
    v_mfma_f32_32x32x16_bf16 a[208:223], v[28:31], v[60:63], a[208:223]
    v_xor_b32 v6, 0x10000, v6
    v_xor_b32 v7, 0x10000, v7
    v_mfma_f32_32x32x16_bf16 a[160:175], v[24:27], v[64:67], a[160:175]
    v_xor_b32 v8, 0x10000, v8
    v_xor_b32 v9, 0x10000, v9
    v_mfma_f32_32x32x16_bf16 a[224:239], v[28:31], v[64:67], a[224:239]
    v_xor_b32 v10, 0x10000, v10
    v_xor_b32 v11, 0x10000, v11
    v_mfma_f32_32x32x16_bf16 a[176:191], v[24:27], v[68:71], a[176:191]
    v_xor_b32 v12, 0x10000, v12
    v_xor_b32 v13, 0x10000, v13
    v_mfma_f32_32x32x16_bf16 a[240:255], v[28:31], v[68:71], a[240:255]
    v_xor_b32 v14, 0x10000, v14
    v_xor_b32 v15, 0x10000, v15
    v_mfma_f32_32x32x16_bf16 a[0:15], v[72:75], v[32:35], a[0:15]
    v_mfma_f32_32x32x16_bf16 a[64:79], v[72:75], v[36:39], a[64:79]
    v_mfma_f32_32x32x16_bf16 a[16:31], v[76:79], v[32:35], a[16:31]
    v_mfma_f32_32x32x16_bf16 a[80:95], v[76:79], v[36:39], a[80:95]
    s_waitcnt lgkmcnt(10)
    v_mfma_f32_32x32x16_bf16 a[32:47], v[80:83], v[32:35], a[32:47]
    v_mfma_f32_32x32x16_bf16 a[96:111], v[80:83], v[36:39], a[96:111]
    s_waitcnt lgkmcnt(8)
    v_mfma_f32_32x32x16_bf16 a[48:63], v[84:87], v[32:35], a[48:63]
    v_mfma_f32_32x32x16_bf16 a[112:127], v[84:87], v[36:39], a[112:127]
    s_waitcnt lgkmcnt(6)
    v_mfma_f32_32x32x16_bf16 a[128:143], v[32:35], v[88:91], a[128:143]
    v_mfma_f32_32x32x16_bf16 a[192:207], v[36:39], v[88:91], a[192:207]
    s_waitcnt lgkmcnt(4)
    v_mfma_f32_32x32x16_bf16 a[144:159], v[32:35], v[92:95], a[144:159]
    v_mfma_f32_32x32x16_bf16 a[208:223], v[36:39], v[92:95], a[208:223]
    s_waitcnt lgkmcnt(2)
    v_mfma_f32_32x32x16_bf16 a[160:175], v[32:35], v[96:99], a[160:175]
    v_mfma_f32_32x32x16_bf16 a[224:239], v[36:39], v[96:99], a[224:239]
    s_waitcnt lgkmcnt(0)
    v_mfma_f32_32x32x16_bf16 a[176:191], v[32:35], v[100:103], a[176:191]
    v_mfma_f32_32x32x16_bf16 a[240:255], v[36:39], v[100:103], a[240:255]
    s_barrier
    s_branch L_task
L_half:
    s_mov_b32 s20, s80
    s_mov_b32 s21, s81
    s_mov_b32 s24, s82
    s_mov_b32 s25, s83
    s_mov_b32 s12, s74
    s_mov_b32 s13, s75
    s_mov_b32 s14, 2621440
    s_mov_b32 s22, 5242880
    s_mov_b32 s26, 5242880
    s_movk_i32 s60, 8192
    s_mov_b32 s52, 40960
L_half2:
    s_lshl_b32 s33, s59, 8
    s_mov_b32 s34, s33
    s_mul_i32 s32, s58, 163840
    s_lshl_b32 s53, s58, 2
    s_add_u32 s53, s53, s17
    s_lshl_b32 s43, s53, 19
    s_lshl_b32 s54, s59, 14
    s_add_u32 s43, s43, s54
    s_add_u32 s43, s43, 13631488
    s_mul_i32 s39, s17, s52
    s_add_u32 s32, s32, s39
    s_lshl_b32 s35, s60, 2
    s_lshl_b32 s36, s60, 6
    v_lshrrev_b32 v16, 4, v0
    s_lshl_b32 s39, s17, 4
    v_add_u32 v17, s39, v16
    v_mul_lo_u32 v17, v17, s60
    v_lshlrev_b32 v16, 2, v16
    v_and_b32 v18, 15, v0
    v_xor_b32 v16, v16, v18
    v_lshl_add_u32 v3, v16, 4, v17
    s_add_u32 m0, s38, 0
    s_mov_b32 s40, s33
    buffer_load_dwordx4 v3, s[20:23], s40 offen  lds
    s_add_u32 m0, s38, 1024
    s_add_u32 s40, s40, s35
    buffer_load_dwordx4 v3, s[20:23], s40 offen  lds
    s_add_u32 m0, s38, 2048
    s_add_u32 s40, s40, s35
    buffer_load_dwordx4 v3, s[20:23], s40 offen  lds
    s_add_u32 m0, s38, 3072
    s_add_u32 s40, s40, s35
    buffer_load_dwordx4 v3, s[20:23], s40 offen  lds
    s_add_u32 m0, s38, 16384
    s_mov_b32 s40, s34
    buffer_load_dwordx4 v3, s[24:27], s40 offen  lds
    s_add_u32 m0, s38, 17408
    s_add_u32 s40, s40, s35
    buffer_load_dwordx4 v3, s[24:27], s40 offen  lds
    s_add_u32 m0, s38, 18432
    s_add_u32 s40, s40, s35
    buffer_load_dwordx4 v3, s[24:27], s40 offen  lds
    s_add_u32 m0, s38, 19456
    s_add_u32 s40, s40, s35
    buffer_load_dwordx4 v3, s[24:27], s40 offen  lds
    s_add_u32 s33, s33, s36
    s_add_u32 s34, s34, s36
    s_add_u32 m0, s37, 0
    s_add_u32 s39, s32, 0
    buffer_load_dwordx4 v1, s[12:15], s39 offen  lds
    s_add_u32 m0, s37, 1024
    s_add_u32 s39, s32, 10240
    buffer_load_dwordx4 v2, s[12:15], s39 offen  lds
    s_add_u32 m0, s37, 2048
    s_add_u32 s39, s32, 20480
    buffer_load_dwordx4 v1, s[12:15], s39 offen  lds
    s_add_u32 m0, s37, 3072
    s_add_u32 s39, s32, 30720
    buffer_load_dwordx4 v2, s[12:15], s39 offen  lds
    s_add_u32 s32, s32, 128
    s_add_u32 m0, s38, 65536
    s_mov_b32 s40, s33
    buffer_load_dwordx4 v3, s[20:23], s40 offen  lds
    s_add_u32 m0, s38, 66560
    s_add_u32 s40, s40, s35
    buffer_load_dwordx4 v3, s[20:23], s40 offen  lds
    s_add_u32 m0, s38, 67584
    s_add_u32 s40, s40, s35
    buffer_load_dwordx4 v3, s[20:23], s40 offen  lds
    s_add_u32 m0, s38, 68608
    s_add_u32 s40, s40, s35
    buffer_load_dwordx4 v3, s[20:23], s40 offen  lds
    s_add_u32 m0, s38, 81920
    s_mov_b32 s40, s34
    buffer_load_dwordx4 v3, s[24:27], s40 offen  lds
    s_add_u32 m0, s38, 82944
    s_add_u32 s40, s40, s35
    buffer_load_dwordx4 v3, s[24:27], s40 offen  lds
    s_add_u32 m0, s38, 83968
    s_add_u32 s40, s40, s35
    buffer_load_dwordx4 v3, s[24:27], s40 offen  lds
    s_add_u32 m0, s38, 84992
    s_add_u32 s40, s40, s35
    buffer_load_dwordx4 v3, s[24:27], s40 offen  lds
    s_add_u32 s33, s33, s36
    s_add_u32 s34, s34, s36
    s_waitcnt vmcnt(8)
    s_barrier
    ds_read_b128 v[24:27], v4 offset:0
    ds_read_b64_tr_b16 v[40:41], v8 offset:32768
    ds_read_b64_tr_b16 v[42:43], v8 offset:33792
    ds_read_b64_tr_b16 v[44:45], v9 offset:32768
    ds_read_b64_tr_b16 v[46:47], v9 offset:33792
    ds_read_b64_tr_b16 v[48:49], v10 offset:32768
    ds_read_b64_tr_b16 v[50:51], v10 offset:33792
    ds_read_b64_tr_b16 v[52:53], v11 offset:32768
    ds_read_b64_tr_b16 v[54:55], v11 offset:33792
    ds_read_b64_tr_b16 v[56:57], v12 offset:49152
    ds_read_b64_tr_b16 v[58:59], v12 offset:50176
    ds_read_b64_tr_b16 v[60:61], v13 offset:49152
    ds_read_b64_tr_b16 v[62:63], v13 offset:50176
    ds_read_b64_tr_b16 v[64:65], v14 offset:49152
    s_waitcnt lgkmcnt(10)
    ds_read_b64_tr_b16 v[66:67], v14 offset:50176
    ds_read_b64_tr_b16 v[68:69], v15 offset:49152
    ds_read_b64_tr_b16 v[70:71], v15 offset:50176
    v_mfma_f32_32x32x16_bf16 a[0:15], v[40:43], v[24:27], 0
    ds_read_b128 v[32:35], v5 offset:0
    s_waitcnt lgkmcnt(10)
    ds_read_b64_tr_b16 v[72:73], v8 offset:36864
    ds_read_b64_tr_b16 v[74:75], v8 offset:37888
    s_add_u32 m0, s37, 65536
    s_add_u32 s39, s32, 0
    buffer_load_dwordx4 v1, s[12:15], s39 offen  lds
    v_mfma_f32_32x32x16_bf16 a[16:31], v[44:47], v[24:27], 0
    ds_read_b64_tr_b16 v[76:77], v9 offset:36864
    ds_read_b64_tr_b16 v[78:79], v9 offset:37888
    s_waitcnt lgkmcnt(10)
    ds_read_b64_tr_b16 v[80:81], v10 offset:36864
    s_add_u32 m0, s37, 66560
    s_add_u32 s39, s32, 10240
    buffer_load_dwordx4 v2, s[12:15], s39 offen  lds
    v_mfma_f32_32x32x16_bf16 a[32:47], v[48:51], v[24:27], 0
    ds_read_b64_tr_b16 v[82:83], v10 offset:37888
    ds_read_b64_tr_b16 v[84:85], v11 offset:36864
    ds_read_b64_tr_b16 v[86:87], v11 offset:37888
    s_add_u32 m0, s37, 67584
    s_add_u32 s39, s32, 20480
    buffer_load_dwordx4 v1, s[12:15], s39 offen  lds
    v_mfma_f32_32x32x16_bf16 a[48:63], v[52:55], v[24:27], 0
    s_waitcnt lgkmcnt(10)
    ds_read_b64_tr_b16 v[88:89], v12 offset:53248
    ds_read_b64_tr_b16 v[90:91], v12 offset:54272
    ds_read_b64_tr_b16 v[92:93], v13 offset:53248
    s_add_u32 m0, s37, 68608
    s_add_u32 s39, s32, 30720
    buffer_load_dwordx4 v2, s[12:15], s39 offen  lds
    s_add_u32 s32, s32, 128
    v_mfma_f32_32x32x16_bf16 a[128:143], v[24:27], v[56:59], 0
    ds_read_b64_tr_b16 v[94:95], v13 offset:54272
    s_waitcnt lgkmcnt(10)
    ds_read_b64_tr_b16 v[96:97], v14 offset:53248
    ds_read_b64_tr_b16 v[98:99], v14 offset:54272
    v_mfma_f32_32x32x16_bf16 a[144:159], v[24:27], v[60:63], 0
    ds_read_b64_tr_b16 v[100:101], v15 offset:53248
    ds_read_b64_tr_b16 v[102:103], v15 offset:54272
    v_mfma_f32_32x32x16_bf16 a[160:175], v[24:27], v[64:67], 0
    v_mfma_f32_32x32x16_bf16 a[176:191], v[24:27], v[68:71], 0
    s_mov_b32 s42, 0
    s_waitcnt lgkmcnt(0)
    s_branch L_gh_in
    .p2align 6
L_gh_loop:
    v_mfma_f32_32x32x16_bf16 a[0:15], v[40:43], v[24:27], a[0:15]
    ds_read_b128 v[32:35], v5 offset:0
    s_waitcnt lgkmcnt(10)
    ds_read_b64_tr_b16 v[72:73], v8 offset:36864
    ds_read_b64_tr_b16 v[74:75], v8 offset:37888
    s_add_u32 m0, s37, 65536
    s_add_u32 s39, s32, 0
    buffer_load_dwordx4 v1, s[12:15], s39 offen  lds
    v_mfma_f32_32x32x16_bf16 a[16:31], v[44:47], v[24:27], a[16:31]
    ds_read_b64_tr_b16 v[76:77], v9 offset:36864
    ds_read_b64_tr_b16 v[78:79], v9 offset:37888
    s_waitcnt lgkmcnt(10)
    ds_read_b64_tr_b16 v[80:81], v10 offset:36864
    s_add_u32 m0, s37, 66560
    s_add_u32 s39, s32, 10240
    buffer_load_dwordx4 v2, s[12:15], s39 offen  lds
    v_mfma_f32_32x32x16_bf16 a[32:47], v[48:51], v[24:27], a[32:47]
    ds_read_b64_tr_b16 v[82:83], v10 offset:37888
    ds_read_b64_tr_b16 v[84:85], v11 offset:36864
    ds_read_b64_tr_b16 v[86:87], v11 offset:37888
    s_add_u32 m0, s37, 67584
    s_add_u32 s39, s32, 20480
    buffer_load_dwordx4 v1, s[12:15], s39 offen  lds
    v_mfma_f32_32x32x16_bf16 a[48:63], v[52:55], v[24:27], a[48:63]
    s_waitcnt lgkmcnt(10)
    ds_read_b64_tr_b16 v[88:89], v12 offset:53248
    ds_read_b64_tr_b16 v[90:91], v12 offset:54272
    ds_read_b64_tr_b16 v[92:93], v13 offset:53248
    s_add_u32 m0, s37, 68608
    s_add_u32 s39, s32, 30720
    buffer_load_dwordx4 v2, s[12:15], s39 offen  lds
    s_add_u32 s32, s32, 128
    v_mfma_f32_32x32x16_bf16 a[128:143], v[24:27], v[56:59], a[128:143]
    ds_read_b64_tr_b16 v[94:95], v13 offset:54272
    s_waitcnt lgkmcnt(10)
    ds_read_b64_tr_b16 v[96:97], v14 offset:53248
    ds_read_b64_tr_b16 v[98:99], v14 offset:54272
    v_mfma_f32_32x32x16_bf16 a[144:159], v[24:27], v[60:63], a[144:159]
    ds_read_b64_tr_b16 v[100:101], v15 offset:53248
    ds_read_b64_tr_b16 v[102:103], v15 offset:54272
    v_mfma_f32_32x32x16_bf16 a[160:175], v[24:27], v[64:67], a[160:175]
    v_mfma_f32_32x32x16_bf16 a[176:191], v[24:27], v[68:71], a[176:191]
L_gh_in:
    v_mfma_f32_32x32x16_bf16 a[0:15], v[72:75], v[32:35], a[0:15]
    s_waitcnt lgkmcnt(10)
    ds_read_b128 v[24:27], v6 offset:0
    ds_read_b64_tr_b16 v[40:41], v8 offset:40960
    ds_read_b64_tr_b16 v[42:43], v8 offset:41984
    v_mfma_f32_32x32x16_bf16 a[16:31], v[76:79], v[32:35], a[16:31]
    ds_read_b64_tr_b16 v[44:45], v9 offset:40960
    s_waitcnt lgkmcnt(10)
    ds_read_b64_tr_b16 v[46:47], v9 offset:41984
    ds_read_b64_tr_b16 v[48:49], v10 offset:40960
    v_mfma_f32_32x32x16_bf16 a[32:47], v[80:83], v[32:35], a[32:47]
    ds_read_b64_tr_b16 v[50:51], v10 offset:41984
    ds_read_b64_tr_b16 v[52:53], v11 offset:40960
    s_waitcnt lgkmcnt(10)
    ds_read_b64_tr_b16 v[54:55], v11 offset:41984
    v_mfma_f32_32x32x16_bf16 a[48:63], v[84:87], v[32:35], a[48:63]
    ds_read_b64_tr_b16 v[56:57], v12 offset:57344
    ds_read_b64_tr_b16 v[58:59], v12 offset:58368
    ds_read_b64_tr_b16 v[60:61], v13 offset:57344
    v_mfma_f32_32x32x16_bf16 a[128:143], v[32:35], v[88:91], a[128:143]
    s_waitcnt lgkmcnt(10)
    ds_read_b64_tr_b16 v[62:63], v13 offset:58368
    ds_read_b64_tr_b16 v[64:65], v14 offset:57344
    ds_read_b64_tr_b16 v[66:67], v14 offset:58368
    v_mfma_f32_32x32x16_bf16 a[144:159], v[32:35], v[92:95], a[144:159]
    ds_read_b64_tr_b16 v[68:69], v15 offset:57344
    s_waitcnt lgkmcnt(10)
    ds_read_b64_tr_b16 v[70:71], v15 offset:58368
    v_mfma_f32_32x32x16_bf16 a[160:175], v[32:35], v[96:99], a[160:175]
    v_mfma_f32_32x32x16_bf16 a[176:191], v[32:35], v[100:103], a[176:191]
    v_mfma_f32_32x32x16_bf16 a[0:15], v[40:43], v[24:27], a[0:15]
    ds_read_b128 v[32:35], v7 offset:0
    ds_read_b64_tr_b16 v[72:73], v8 offset:45056
    ds_read_b64_tr_b16 v[74:75], v8 offset:46080
    v_mfma_f32_32x32x16_bf16 a[16:31], v[44:47], v[24:27], a[16:31]
    s_waitcnt lgkmcnt(10)
    ds_read_b64_tr_b16 v[76:77], v9 offset:45056
    ds_read_b64_tr_b16 v[78:79], v9 offset:46080
    ds_read_b64_tr_b16 v[80:81], v10 offset:45056
    v_mfma_f32_32x32x16_bf16 a[32:47], v[48:51], v[24:27], a[32:47]
    ds_read_b64_tr_b16 v[82:83], v10 offset:46080
    s_waitcnt lgkmcnt(10)
    ds_read_b64_tr_b16 v[84:85], v11 offset:45056
    ds_read_b64_tr_b16 v[86:87], v11 offset:46080
    v_mfma_f32_32x32x16_bf16 a[48:63], v[52:55], v[24:27], a[48:63]
    ds_read_b64_tr_b16 v[88:89], v12 offset:61440
    ds_read_b64_tr_b16 v[90:91], v12 offset:62464
    s_waitcnt lgkmcnt(10)
    ds_read_b64_tr_b16 v[92:93], v13 offset:61440
    v_mfma_f32_32x32x16_bf16 a[128:143], v[24:27], v[56:59], a[128:143]
    ds_read_b64_tr_b16 v[94:95], v13 offset:62464
    ds_read_b64_tr_b16 v[96:97], v14 offset:61440
    ds_read_b64_tr_b16 v[98:99], v14 offset:62464
    v_mfma_f32_32x32x16_bf16 a[144:159], v[24:27], v[60:63], a[144:159]
    s_waitcnt lgkmcnt(10)
    ds_read_b64_tr_b16 v[100:101], v15 offset:61440
    ds_read_b64_tr_b16 v[102:103], v15 offset:62464
    v_mfma_f32_32x32x16_bf16 a[160:175], v[24:27], v[64:67], a[160:175]
    v_xor_b32 v4, 0x10000, v4
    v_xor_b32 v5, 0x10000, v5
    v_xor_b32 v6, 0x10000, v6
    v_xor_b32 v7, 0x10000, v7
    v_xor_b32 v8, 0x10000, v8
    v_xor_b32 v9, 0x10000, v9
    v_mfma_f32_32x32x16_bf16 a[176:191], v[24:27], v[68:71], a[176:191]
    v_xor_b32 v10, 0x10000, v10
    v_xor_b32 v11, 0x10000, v11
    v_xor_b32 v12, 0x10000, v12
    v_xor_b32 v13, 0x10000, v13
    v_xor_b32 v14, 0x10000, v14
    v_xor_b32 v15, 0x10000, v15
    s_waitcnt vmcnt(0) lgkmcnt(0)
    s_barrier
    v_mfma_f32_32x32x16_bf16 a[0:15], v[72:75], v[32:35], a[0:15]
    ds_read_b128 v[24:27], v4 offset:0
    ds_read_b64_tr_b16 v[40:41], v8 offset:32768
    ds_read_b64_tr_b16 v[42:43], v8 offset:33792
    s_add_u32 m0, s38, 0
    s_mov_b32 s40, s33
    buffer_load_dwordx4 v3, s[20:23], s40 offen  lds
    v_mfma_f32_32x32x16_bf16 a[16:31], v[76:79], v[32:35], a[16:31]
    ds_read_b64_tr_b16 v[44:45], v9 offset:32768
    ds_read_b64_tr_b16 v[46:47], v9 offset:33792
    ds_read_b64_tr_b16 v[48:49], v10 offset:32768
    s_add_u32 m0, s38, 1024
    s_add_u32 s40, s40, s35
    buffer_load_dwordx4 v3, s[20:23], s40 offen  lds
    v_mfma_f32_32x32x16_bf16 a[32:47], v[80:83], v[32:35], a[32:47]
    ds_read_b64_tr_b16 v[50:51], v10 offset:33792
    ds_read_b64_tr_b16 v[52:53], v11 offset:32768
    ds_read_b64_tr_b16 v[54:55], v11 offset:33792
    s_add_u32 m0, s38, 2048
    s_add_u32 s40, s40, s35
    buffer_load_dwordx4 v3, s[20:23], s40 offen  lds
    v_mfma_f32_32x32x16_bf16 a[48:63], v[84:87], v[32:35], a[48:63]
    ds_read_b64_tr_b16 v[56:57], v12 offset:49152
    ds_read_b64_tr_b16 v[58:59], v12 offset:50176
    ds_read_b64_tr_b16 v[60:61], v13 offset:49152
    s_add_u32 m0, s38, 3072
    s_add_u32 s40, s40, s35
    buffer_load_dwordx4 v3, s[20:23], s40 offen  lds
    v_mfma_f32_32x32x16_bf16 a[128:143], v[32:35], v[88:91], a[128:143]
    ds_read_b64_tr_b16 v[62:63], v13 offset:50176
    ds_read_b64_tr_b16 v[64:65], v14 offset:49152
    s_waitcnt lgkmcnt(10)
    ds_read_b64_tr_b16 v[66:67], v14 offset:50176
    s_add_u32 m0, s38, 16384
    s_mov_b32 s40, s34
    buffer_load_dwordx4 v3, s[24:27], s40 offen  lds
    v_mfma_f32_32x32x16_bf16 a[144:159], v[32:35], v[92:95], a[144:159]
    ds_read_b64_tr_b16 v[68:69], v15 offset:49152
    ds_read_b64_tr_b16 v[70:71], v15 offset:50176
    s_add_u32 m0, s38, 17408
    s_add_u32 s40, s40, s35
    buffer_load_dwordx4 v3, s[24:27], s40 offen  lds
    v_mfma_f32_32x32x16_bf16 a[160:175], v[32:35], v[96:99], a[160:175]
    s_add_u32 m0, s38, 18432
    s_add_u32 s40, s40, s35
    buffer_load_dwordx4 v3, s[24:27], s40 offen  lds
    v_mfma_f32_32x32x16_bf16 a[176:191], v[32:35], v[100:103], a[176:191]
    s_add_u32 m0, s38, 19456
    s_add_u32 s40, s40, s35
    buffer_load_dwordx4 v3, s[24:27], s40 offen  lds
    s_add_u32 s33, s33, s36
    s_add_u32 s34, s34, s36
    v_mfma_f32_32x32x16_bf16 a[0:15], v[40:43], v[24:27], a[0:15]
    ds_read_b128 v[32:35], v5 offset:0
    s_waitcnt lgkmcnt(10)
    ds_read_b64_tr_b16 v[72:73], v8 offset:36864
    ds_read_b64_tr_b16 v[74:75], v8 offset:37888
    s_add_u32 m0, s37, 0
    s_add_u32 s39, s32, 0
    buffer_load_dwordx4 v1, s[12:15], s39 offen  lds
    v_mfma_f32_32x32x16_bf16 a[16:31], v[44:47], v[24:27], a[16:31]
    ds_read_b64_tr_b16 v[76:77], v9 offset:36864
    ds_read_b64_tr_b16 v[78:79], v9 offset:37888
    s_waitcnt lgkmcnt(10)
    ds_read_b64_tr_b16 v[80:81], v10 offset:36864
    s_add_u32 m0, s37, 1024
    s_add_u32 s39, s32, 10240
    buffer_load_dwordx4 v2, s[12:15], s39 offen  lds
    v_mfma_f32_32x32x16_bf16 a[32:47], v[48:51], v[24:27], a[32:47]
    ds_read_b64_tr_b16 v[82:83], v10 offset:37888
    ds_read_b64_tr_b16 v[84:85], v11 offset:36864
    ds_read_b64_tr_b16 v[86:87], v11 offset:37888
    s_add_u32 m0, s37, 2048
    s_add_u32 s39, s32, 20480
    buffer_load_dwordx4 v1, s[12:15], s39 offen  lds
    v_mfma_f32_32x32x16_bf16 a[48:63], v[52:55], v[24:27], a[48:63]
    s_waitcnt lgkmcnt(10)
    ds_read_b64_tr_b16 v[88:89], v12 offset:53248
    ds_read_b64_tr_b16 v[90:91], v12 offset:54272
    ds_read_b64_tr_b16 v[92:93], v13 offset:53248
    s_add_u32 m0, s37, 3072
    s_add_u32 s39, s32, 30720
    buffer_load_dwordx4 v2, s[12:15], s39 offen  lds
    s_add_u32 s32, s32, 128
    v_mfma_f32_32x32x16_bf16 a[128:143], v[24:27], v[56:59], a[128:143]
    ds_read_b64_tr_b16 v[94:95], v13 offset:54272
    s_waitcnt lgkmcnt(10)
    ds_read_b64_tr_b16 v[96:97], v14 offset:53248
    ds_read_b64_tr_b16 v[98:99], v14 offset:54272
    v_mfma_f32_32x32x16_bf16 a[144:159], v[24:27], v[60:63], a[144:159]
    ds_read_b64_tr_b16 v[100:101], v15 offset:53248
    ds_read_b64_tr_b16 v[102:103], v15 offset:54272
    v_mfma_f32_32x32x16_bf16 a[160:175], v[24:27], v[64:67], a[160:175]
    v_mfma_f32_32x32x16_bf16 a[176:191], v[24:27], v[68:71], a[176:191]
    v_mfma_f32_32x32x16_bf16 a[0:15], v[72:75], v[32:35], a[0:15]
    s_waitcnt lgkmcnt(10)
    ds_read_b128 v[24:27], v6 offset:0
    ds_read_b64_tr_b16 v[40:41], v8 offset:40960
    ds_read_b64_tr_b16 v[42:43], v8 offset:41984
    v_mfma_f32_32x32x16_bf16 a[16:31], v[76:79], v[32:35], a[16:31]
    ds_read_b64_tr_b16 v[44:45], v9 offset:40960
    s_waitcnt lgkmcnt(10)
    ds_read_b64_tr_b16 v[46:47], v9 offset:41984
    ds_read_b64_tr_b16 v[48:49], v10 offset:40960
    v_mfma_f32_32x32x16_bf16 a[32:47], v[80:83], v[32:35], a[32:47]
    ds_read_b64_tr_b16 v[50:51], v10 offset:41984
    ds_read_b64_tr_b16 v[52:53], v11 offset:40960
    s_waitcnt lgkmcnt(10)
    ds_read_b64_tr_b16 v[54:55], v11 offset:41984
    v_mfma_f32_32x32x16_bf16 a[48:63], v[84:87], v[32:35], a[48:63]
    ds_read_b64_tr_b16 v[56:57], v12 offset:57344
    ds_read_b64_tr_b16 v[58:59], v12 offset:58368
    ds_read_b64_tr_b16 v[60:61], v13 offset:57344
    v_mfma_f32_32x32x16_bf16 a[128:143], v[32:35], v[88:91], a[128:143]
    s_waitcnt lgkmcnt(10)
    ds_read_b64_tr_b16 v[62:63], v13 offset:58368
    ds_read_b64_tr_b16 v[64:65], v14 offset:57344
    ds_read_b64_tr_b16 v[66:67], v14 offset:58368
    v_mfma_f32_32x32x16_bf16 a[144:159], v[32:35], v[92:95], a[144:159]
    ds_read_b64_tr_b16 v[68:69], v15 offset:57344
    s_waitcnt lgkmcnt(10)
    ds_read_b64_tr_b16 v[70:71], v15 offset:58368
    v_mfma_f32_32x32x16_bf16 a[160:175], v[32:35], v[96:99], a[160:175]
    v_mfma_f32_32x32x16_bf16 a[176:191], v[32:35], v[100:103], a[176:191]
    v_mfma_f32_32x32x16_bf16 a[0:15], v[40:43], v[24:27], a[0:15]
    ds_read_b128 v[32:35], v7 offset:0
    ds_read_b64_tr_b16 v[72:73], v8 offset:45056
    ds_read_b64_tr_b16 v[74:75], v8 offset:46080
    v_mfma_f32_32x32x16_bf16 a[16:31], v[44:47], v[24:27], a[16:31]
    s_waitcnt lgkmcnt(10)
    ds_read_b64_tr_b16 v[76:77], v9 offset:45056
    ds_read_b64_tr_b16 v[78:79], v9 offset:46080
    ds_read_b64_tr_b16 v[80:81], v10 offset:45056
    v_mfma_f32_32x32x16_bf16 a[32:47], v[48:51], v[24:27], a[32:47]
    ds_read_b64_tr_b16 v[82:83], v10 offset:46080
    s_waitcnt lgkmcnt(10)
    ds_read_b64_tr_b16 v[84:85], v11 offset:45056
    ds_read_b64_tr_b16 v[86:87], v11 offset:46080
    v_mfma_f32_32x32x16_bf16 a[48:63], v[52:55], v[24:27], a[48:63]
    ds_read_b64_tr_b16 v[88:89], v12 offset:61440
    ds_read_b64_tr_b16 v[90:91], v12 offset:62464
    s_waitcnt lgkmcnt(10)
    ds_read_b64_tr_b16 v[92:93], v13 offset:61440
    v_mfma_f32_32x32x16_bf16 a[128:143], v[24:27], v[56:59], a[128:143]
    ds_read_b64_tr_b16 v[94:95], v13 offset:62464
    ds_read_b64_tr_b16 v[96:97], v14 offset:61440
    ds_read_b64_tr_b16 v[98:99], v14 offset:62464
    v_mfma_f32_32x32x16_bf16 a[144:159], v[24:27], v[60:63], a[144:159]
    s_waitcnt lgkmcnt(10)
    ds_read_b64_tr_b16 v[100:101], v15 offset:61440
    ds_read_b64_tr_b16 v[102:103], v15 offset:62464
    v_mfma_f32_32x32x16_bf16 a[160:175], v[24:27], v[64:67], a[160:175]
    v_xor_b32 v4, 0x10000, v4
    v_xor_b32 v5, 0x10000, v5
    v_xor_b32 v6, 0x10000, v6
    v_xor_b32 v7, 0x10000, v7
    v_xor_b32 v8, 0x10000, v8
    v_xor_b32 v9, 0x10000, v9
    v_mfma_f32_32x32x16_bf16 a[176:191], v[24:27], v[68:71], a[176:191]
    v_xor_b32 v10, 0x10000, v10
    v_xor_b32 v11, 0x10000, v11
    v_xor_b32 v12, 0x10000, v12
    v_xor_b32 v13, 0x10000, v13
    v_xor_b32 v14, 0x10000, v14
    v_xor_b32 v15, 0x10000, v15
    s_waitcnt vmcnt(0) lgkmcnt(0)
    s_barrier
    v_mfma_f32_32x32x16_bf16 a[0:15], v[72:75], v[32:35], a[0:15]
    ds_read_b128 v[24:27], v4 offset:0
    ds_read_b64_tr_b16 v[40:41], v8 offset:32768
    ds_read_b64_tr_b16 v[42:43], v8 offset:33792
    s_add_u32 m0, s38, 65536
    s_mov_b32 s40, s33
    buffer_load_dwordx4 v3, s[20:23], s40 offen  lds
    v_mfma_f32_32x32x16_bf16 a[16:31], v[76:79], v[32:35], a[16:31]
    ds_read_b64_tr_b16 v[44:45], v9 offset:32768
    ds_read_b64_tr_b16 v[46:47], v9 offset:33792
    ds_read_b64_tr_b16 v[48:49], v10 offset:32768
    s_add_u32 m0, s38, 66560
    s_add_u32 s40, s40, s35
    buffer_load_dwordx4 v3, s[20:23], s40 offen  lds
    v_mfma_f32_32x32x16_bf16 a[32:47], v[80:83], v[32:35], a[32:47]
    ds_read_b64_tr_b16 v[50:51], v10 offset:33792
    ds_read_b64_tr_b16 v[52:53], v11 offset:32768
    ds_read_b64_tr_b16 v[54:55], v11 offset:33792
    s_add_u32 m0, s38, 67584
    s_add_u32 s40, s40, s35
    buffer_load_dwordx4 v3, s[20:23], s40 offen  lds
    v_mfma_f32_32x32x16_bf16 a[48:63], v[84:87], v[32:35], a[48:63]
    ds_read_b64_tr_b16 v[56:57], v12 offset:49152
    ds_read_b64_tr_b16 v[58:59], v12 offset:50176
    ds_read_b64_tr_b16 v[60:61], v13 offset:49152
    s_add_u32 m0, s38, 68608
    s_add_u32 s40, s40, s35
    buffer_load_dwordx4 v3, s[20:23], s40 offen  lds
    v_mfma_f32_32x32x16_bf16 a[128:143], v[32:35], v[88:91], a[128:143]
    ds_read_b64_tr_b16 v[62:63], v13 offset:50176
    ds_read_b64_tr_b16 v[64:65], v14 offset:49152
    s_waitcnt lgkmcnt(10)
    ds_read_b64_tr_b16 v[66:67], v14 offset:50176
    s_add_u32 m0, s38, 81920
    s_mov_b32 s40, s34
    buffer_load_dwordx4 v3, s[24:27], s40 offen  lds
    v_mfma_f32_32x32x16_bf16 a[144:159], v[32:35], v[92:95], a[144:159]
    ds_read_b64_tr_b16 v[68:69], v15 offset:49152
    ds_read_b64_tr_b16 v[70:71], v15 offset:50176
    s_add_u32 m0, s38, 82944
    s_add_u32 s40, s40, s35
    buffer_load_dwordx4 v3, s[24:27], s40 offen  lds
    v_mfma_f32_32x32x16_bf16 a[160:175], v[32:35], v[96:99], a[160:175]
    s_add_u32 m0, s38, 83968
    s_add_u32 s40, s40, s35
    buffer_load_dwordx4 v3, s[24:27], s40 offen  lds
    v_mfma_f32_32x32x16_bf16 a[176:191], v[32:35], v[100:103], a[176:191]
    s_add_u32 m0, s38, 84992
    s_add_u32 s40, s40, s35
    buffer_load_dwordx4 v3, s[24:27], s40 offen  lds
    s_add_u32 s33, s33, s36
    s_add_u32 s34, s34, s36
    s_add_u32 s42, s42, 1
    s_cmp_lt_u32 s42, 4
    s_cbranch_scc1 L_gh_loop
    s_waitcnt lgkmcnt(0)
    v_mfma_f32_32x32x16_bf16 a[0:15], v[40:43], v[24:27], a[0:15]
    ds_read_b128 v[32:35], v5 offset:0
    ds_read_b64_tr_b16 v[72:73], v8 offset:36864
    ds_read_b64_tr_b16 v[74:75], v8 offset:37888
    s_add_u32 m0, s37, 65536
    s_add_u32 s39, s32, 0
    buffer_load_dwordx4 v1, s[12:15], s39 offen  lds
    v_mfma_f32_32x32x16_bf16 a[16:31], v[44:47], v[24:27], a[16:31]
    ds_read_b64_tr_b16 v[76:77], v9 offset:36864
    ds_read_b64_tr_b16 v[78:79], v9 offset:37888
    ds_read_b64_tr_b16 v[80:81], v10 offset:36864
    s_add_u32 m0, s37, 66560
    s_add_u32 s39, s32, 10240
    buffer_load_dwordx4 v2, s[12:15], s39 offen  lds
    v_mfma_f32_32x32x16_bf16 a[32:47], v[48:51], v[24:27], a[32:47]
    ds_read_b64_tr_b16 v[82:83], v10 offset:37888
    ds_read_b64_tr_b16 v[84:85], v11 offset:36864
    ds_read_b64_tr_b16 v[86:87], v11 offset:37888
    s_add_u32 m0, s37, 67584
    s_add_u32 s39, s32, 20480
    buffer_load_dwordx4 v1, s[12:15], s39 offen  lds
    v_mfma_f32_32x32x16_bf16 a[48:63], v[52:55], v[24:27], a[48:63]
    ds_read_b64_tr_b16 v[88:89], v12 offset:53248
    ds_read_b64_tr_b16 v[90:91], v12 offset:54272
    ds_read_b64_tr_b16 v[92:93], v13 offset:53248
    s_add_u32 m0, s37, 68608
    s_add_u32 s39, s32, 30720
    buffer_load_dwordx4 v2, s[12:15], s39 offen  lds
    s_add_u32 s32, s32, 128
    v_mfma_f32_32x32x16_bf16 a[128:143], v[24:27], v[56:59], a[128:143]
    ds_read_b64_tr_b16 v[94:95], v13 offset:54272
    ds_read_b64_tr_b16 v[96:97], v14 offset:53248
    s_waitcnt lgkmcnt(10)
    ds_read_b64_tr_b16 v[98:99], v14 offset:54272
    v_mfma_f32_32x32x16_bf16 a[144:159], v[24:27], v[60:63], a[144:159]
    ds_read_b64_tr_b16 v[100:101], v15 offset:53248
    ds_read_b64_tr_b16 v[102:103], v15 offset:54272
    v_mfma_f32_32x32x16_bf16 a[160:175], v[24:27], v[64:67], a[160:175]
    v_mfma_f32_32x32x16_bf16 a[176:191], v[24:27], v[68:71], a[176:191]
    v_mfma_f32_32x32x16_bf16 a[0:15], v[72:75], v[32:35], a[0:15]
    ds_read_b128 v[24:27], v6 offset:0
    s_waitcnt lgkmcnt(10)
    ds_read_b64_tr_b16 v[40:41], v8 offset:40960
    ds_read_b64_tr_b16 v[42:43], v8 offset:41984
    v_mfma_f32_32x32x16_bf16 a[16:31], v[76:79], v[32:35], a[16:31]
    ds_read_b64_tr_b16 v[44:45], v9 offset:40960
    ds_read_b64_tr_b16 v[46:47], v9 offset:41984
    s_waitcnt lgkmcnt(10)
    ds_read_b64_tr_b16 v[48:49], v10 offset:40960
    v_mfma_f32_32x32x16_bf16 a[32:47], v[80:83], v[32:35], a[32:47]
    ds_read_b64_tr_b16 v[50:51], v10 offset:41984
    ds_read_b64_tr_b16 v[52:53], v11 offset:40960
    ds_read_b64_tr_b16 v[54:55], v11 offset:41984
    v_mfma_f32_32x32x16_bf16 a[48:63], v[84:87], v[32:35], a[48:63]
    s_waitcnt lgkmcnt(10)
    ds_read_b64_tr_b16 v[56:57], v12 offset:57344
    ds_read_b64_tr_b16 v[58:59], v12 offset:58368
    ds_read_b64_tr_b16 v[60:61], v13 offset:57344
    v_mfma_f32_32x32x16_bf16 a[128:143], v[32:35], v[88:91], a[128:143]
    ds_read_b64_tr_b16 v[62:63], v13 offset:58368
    s_waitcnt lgkmcnt(10)
    ds_read_b64_tr_b16 v[64:65], v14 offset:57344
    ds_read_b64_tr_b16 v[66:67], v14 offset:58368
    v_mfma_f32_32x32x16_bf16 a[144:159], v[32:35], v[92:95], a[144:159]
    ds_read_b64_tr_b16 v[68:69], v15 offset:57344
    ds_read_b64_tr_b16 v[70:71], v15 offset:58368
    v_mfma_f32_32x32x16_bf16 a[160:175], v[32:35], v[96:99], a[160:175]
    v_mfma_f32_32x32x16_bf16 a[176:191], v[32:35], v[100:103], a[176:191]
    v_mfma_f32_32x32x16_bf16 a[0:15], v[40:43], v[24:27], a[0:15]
    s_waitcnt lgkmcnt(10)
    ds_read_b128 v[32:35], v7 offset:0
    ds_read_b64_tr_b16 v[72:73], v8 offset:45056
    ds_read_b64_tr_b16 v[74:75], v8 offset:46080
    v_mfma_f32_32x32x16_bf16 a[16:31], v[44:47], v[24:27], a[16:31]
    ds_read_b64_tr_b16 v[76:77], v9 offset:45056
    s_waitcnt lgkmcnt(10)
    ds_read_b64_tr_b16 v[78:79], v9 offset:46080
    ds_read_b64_tr_b16 v[80:81], v10 offset:45056
    v_mfma_f32_32x32x16_bf16 a[32:47], v[48:51], v[24:27], a[32:47]
    ds_read_b64_tr_b16 v[82:83], v10 offset:46080
    ds_read_b64_tr_b16 v[84:85], v11 offset:45056
    s_waitcnt lgkmcnt(10)
    ds_read_b64_tr_b16 v[86:87], v11 offset:46080
    v_mfma_f32_32x32x16_bf16 a[48:63], v[52:55], v[24:27], a[48:63]
    ds_read_b64_tr_b16 v[88:89], v12 offset:61440
    ds_read_b64_tr_b16 v[90:91], v12 offset:62464
    ds_read_b64_tr_b16 v[92:93], v13 offset:61440
    v_mfma_f32_32x32x16_bf16 a[128:143], v[24:27], v[56:59], a[128:143]
    s_waitcnt lgkmcnt(10)
    ds_read_b64_tr_b16 v[94:95], v13 offset:62464
    ds_read_b64_tr_b16 v[96:97], v14 offset:61440
    ds_read_b64_tr_b16 v[98:99], v14 offset:62464
    v_mfma_f32_32x32x16_bf16 a[144:159], v[24:27], v[60:63], a[144:159]
    ds_read_b64_tr_b16 v[100:101], v15 offset:61440
    s_waitcnt lgkmcnt(10)
    ds_read_b64_tr_b16 v[102:103], v15 offset:62464
    v_mfma_f32_32x32x16_bf16 a[160:175], v[24:27], v[64:67], a[160:175]
    v_xor_b32 v4, 0x10000, v4
    v_xor_b32 v5, 0x10000, v5
    v_xor_b32 v6, 0x10000, v6
    v_xor_b32 v7, 0x10000, v7
    v_xor_b32 v8, 0x10000, v8
    v_xor_b32 v9, 0x10000, v9
    v_mfma_f32_32x32x16_bf16 a[176:191], v[24:27], v[68:71], a[176:191]
    v_xor_b32 v10, 0x10000, v10
    v_xor_b32 v11, 0x10000, v11
    v_xor_b32 v12, 0x10000, v12
    v_xor_b32 v13, 0x10000, v13
    v_xor_b32 v14, 0x10000, v14
    v_xor_b32 v15, 0x10000, v15
    s_waitcnt vmcnt(0) lgkmcnt(0)
    s_barrier
    v_mfma_f32_32x32x16_bf16 a[0:15], v[72:75], v[32:35], a[0:15]
    ds_read_b128 v[24:27], v4 offset:0
    ds_read_b64_tr_b16 v[40:41], v8 offset:32768
    ds_read_b64_tr_b16 v[42:43], v8 offset:33792
    v_mfma_f32_32x32x16_bf16 a[16:31], v[76:79], v[32:35], a[16:31]
    ds_read_b64_tr_b16 v[44:45], v9 offset:32768
    ds_read_b64_tr_b16 v[46:47], v9 offset:33792
    ds_read_b64_tr_b16 v[48:49], v10 offset:32768
    v_mfma_f32_32x32x16_bf16 a[32:47], v[80:83], v[32:35], a[32:47]
    ds_read_b64_tr_b16 v[50:51], v10 offset:33792
    ds_read_b64_tr_b16 v[52:53], v11 offset:32768
    ds_read_b64_tr_b16 v[54:55], v11 offset:33792
    v_mfma_f32_32x32x16_bf16 a[48:63], v[84:87], v[32:35], a[48:63]
    ds_read_b64_tr_b16 v[56:57], v12 offset:49152
    ds_read_b64_tr_b16 v[58:59], v12 offset:50176
    ds_read_b64_tr_b16 v[60:61], v13 offset:49152
    v_mfma_f32_32x32x16_bf16 a[128:143], v[32:35], v[88:91], a[128:143]
    ds_read_b64_tr_b16 v[62:63], v13 offset:50176
    ds_read_b64_tr_b16 v[64:65], v14 offset:49152
    s_waitcnt lgkmcnt(10)
    ds_read_b64_tr_b16 v[66:67], v14 offset:50176
    v_mfma_f32_32x32x16_bf16 a[144:159], v[32:35], v[92:95], a[144:159]
    ds_read_b64_tr_b16 v[68:69], v15 offset:49152
    ds_read_b64_tr_b16 v[70:71], v15 offset:50176
    v_mfma_f32_32x32x16_bf16 a[160:175], v[32:35], v[96:99], a[160:175]
    v_mfma_f32_32x32x16_bf16 a[176:191], v[32:35], v[100:103], a[176:191]
    v_mfma_f32_32x32x16_bf16 a[0:15], v[40:43], v[24:27], a[0:15]
    ds_read_b128 v[32:35], v5 offset:0
    s_waitcnt lgkmcnt(10)
    ds_read_b64_tr_b16 v[72:73], v8 offset:36864
    ds_read_b64_tr_b16 v[74:75], v8 offset:37888
    v_mfma_f32_32x32x16_bf16 a[16:31], v[44:47], v[24:27], a[16:31]
    ds_read_b64_tr_b16 v[76:77], v9 offset:36864
    ds_read_b64_tr_b16 v[78:79], v9 offset:37888
    s_waitcnt lgkmcnt(10)
    ds_read_b64_tr_b16 v[80:81], v10 offset:36864
    v_mfma_f32_32x32x16_bf16 a[32:47], v[48:51], v[24:27], a[32:47]
    ds_read_b64_tr_b16 v[82:83], v10 offset:37888
    ds_read_b64_tr_b16 v[84:85], v11 offset:36864
    ds_read_b64_tr_b16 v[86:87], v11 offset:37888
    v_mfma_f32_32x32x16_bf16 a[48:63], v[52:55], v[24:27], a[48:63]
    s_waitcnt lgkmcnt(10)
    ds_read_b64_tr_b16 v[88:89], v12 offset:53248
    ds_read_b64_tr_b16 v[90:91], v12 offset:54272
    ds_read_b64_tr_b16 v[92:93], v13 offset:53248
    v_mfma_f32_32x32x16_bf16 a[128:143], v[24:27], v[56:59], a[128:143]
    ds_read_b64_tr_b16 v[94:95], v13 offset:54272
    s_waitcnt lgkmcnt(10)
    ds_read_b64_tr_b16 v[96:97], v14 offset:53248
    ds_read_b64_tr_b16 v[98:99], v14 offset:54272
    v_mfma_f32_32x32x16_bf16 a[144:159], v[24:27], v[60:63], a[144:159]
    ds_read_b64_tr_b16 v[100:101], v15 offset:53248
    ds_read_b64_tr_b16 v[102:103], v15 offset:54272
    v_mfma_f32_32x32x16_bf16 a[160:175], v[24:27], v[64:67], a[160:175]
    v_mfma_f32_32x32x16_bf16 a[176:191], v[24:27], v[68:71], a[176:191]
    v_mfma_f32_32x32x16_bf16 a[0:15], v[72:75], v[32:35], a[0:15]
    s_waitcnt lgkmcnt(10)
    ds_read_b128 v[24:27], v6 offset:0
    ds_read_b64_tr_b16 v[40:41], v8 offset:40960
    ds_read_b64_tr_b16 v[42:43], v8 offset:41984
    v_mfma_f32_32x32x16_bf16 a[16:31], v[76:79], v[32:35], a[16:31]
    ds_read_b64_tr_b16 v[44:45], v9 offset:40960
    s_waitcnt lgkmcnt(10)
    ds_read_b64_tr_b16 v[46:47], v9 offset:41984
    ds_read_b64_tr_b16 v[48:49], v10 offset:40960
    v_mfma_f32_32x32x16_bf16 a[32:47], v[80:83], v[32:35], a[32:47]
    ds_read_b64_tr_b16 v[50:51], v10 offset:41984
    ds_read_b64_tr_b16 v[52:53], v11 offset:40960
    s_waitcnt lgkmcnt(10)
    ds_read_b64_tr_b16 v[54:55], v11 offset:41984
    v_mfma_f32_32x32x16_bf16 a[48:63], v[84:87], v[32:35], a[48:63]
    ds_read_b64_tr_b16 v[56:57], v12 offset:57344
    ds_read_b64_tr_b16 v[58:59], v12 offset:58368
    ds_read_b64_tr_b16 v[60:61], v13 offset:57344
    v_mfma_f32_32x32x16_bf16 a[128:143], v[32:35], v[88:91], a[128:143]
    s_waitcnt lgkmcnt(10)
    ds_read_b64_tr_b16 v[62:63], v13 offset:58368
    ds_read_b64_tr_b16 v[64:65], v14 offset:57344
    ds_read_b64_tr_b16 v[66:67], v14 offset:58368
    v_mfma_f32_32x32x16_bf16 a[144:159], v[32:35], v[92:95], a[144:159]
    ds_read_b64_tr_b16 v[68:69], v15 offset:57344
    s_waitcnt lgkmcnt(10)
    ds_read_b64_tr_b16 v[70:71], v15 offset:58368
    v_mfma_f32_32x32x16_bf16 a[160:175], v[32:35], v[96:99], a[160:175]
    v_mfma_f32_32x32x16_bf16 a[176:191], v[32:35], v[100:103], a[176:191]
    v_mfma_f32_32x32x16_bf16 a[0:15], v[40:43], v[24:27], a[0:15]
    ds_read_b128 v[32:35], v7 offset:0
    ds_read_b64_tr_b16 v[72:73], v8 offset:45056
    ds_read_b64_tr_b16 v[74:75], v8 offset:46080
    v_mfma_f32_32x32x16_bf16 a[16:31], v[44:47], v[24:27], a[16:31]
    s_waitcnt lgkmcnt(10)
    ds_read_b64_tr_b16 v[76:77], v9 offset:45056
    ds_read_b64_tr_b16 v[78:79], v9 offset:46080
    ds_read_b64_tr_b16 v[80:81], v10 offset:45056
    v_mfma_f32_32x32x16_bf16 a[32:47], v[48:51], v[24:27], a[32:47]
    ds_read_b64_tr_b16 v[82:83], v10 offset:46080
    s_waitcnt lgkmcnt(10)
    ds_read_b64_tr_b16 v[84:85], v11 offset:45056
    ds_read_b64_tr_b16 v[86:87], v11 offset:46080
    v_mfma_f32_32x32x16_bf16 a[48:63], v[52:55], v[24:27], a[48:63]
    ds_read_b64_tr_b16 v[88:89], v12 offset:61440
    ds_read_b64_tr_b16 v[90:91], v12 offset:62464
    s_waitcnt lgkmcnt(10)
    ds_read_b64_tr_b16 v[92:93], v13 offset:61440
    v_mfma_f32_32x32x16_bf16 a[128:143], v[24:27], v[56:59], a[128:143]
    ds_read_b64_tr_b16 v[94:95], v13 offset:62464
    ds_read_b64_tr_b16 v[96:97], v14 offset:61440
    ds_read_b64_tr_b16 v[98:99], v14 offset:62464
    v_mfma_f32_32x32x16_bf16 a[144:159], v[24:27], v[60:63], a[144:159]
    s_waitcnt lgkmcnt(10)
    ds_read_b64_tr_b16 v[100:101], v15 offset:61440
    ds_read_b64_tr_b16 v[102:103], v15 offset:62464
    v_mfma_f32_32x32x16_bf16 a[160:175], v[24:27], v[64:67], a[160:175]
    v_xor_b32 v4, 0x10000, v4
    v_xor_b32 v5, 0x10000, v5
    v_xor_b32 v6, 0x10000, v6
    v_xor_b32 v7, 0x10000, v7
    v_xor_b32 v8, 0x10000, v8
    v_xor_b32 v9, 0x10000, v9
    v_mfma_f32_32x32x16_bf16 a[176:191], v[24:27], v[68:71], a[176:191]
    v_xor_b32 v10, 0x10000, v10
    v_xor_b32 v11, 0x10000, v11
    v_xor_b32 v12, 0x10000, v12
    v_xor_b32 v13, 0x10000, v13
    v_xor_b32 v14, 0x10000, v14
    v_xor_b32 v15, 0x10000, v15
    v_mfma_f32_32x32x16_bf16 a[0:15], v[72:75], v[32:35], a[0:15]
    v_mfma_f32_32x32x16_bf16 a[16:31], v[76:79], v[32:35], a[16:31]
    s_waitcnt lgkmcnt(10)
    v_mfma_f32_32x32x16_bf16 a[32:47], v[80:83], v[32:35], a[32:47]
    s_waitcnt lgkmcnt(8)
    v_mfma_f32_32x32x16_bf16 a[48:63], v[84:87], v[32:35], a[48:63]
    s_waitcnt lgkmcnt(6)
    v_mfma_f32_32x32x16_bf16 a[128:143], v[32:35], v[88:91], a[128:143]
    s_waitcnt lgkmcnt(4)
    v_mfma_f32_32x32x16_bf16 a[144:159], v[32:35], v[92:95], a[144:159]
    s_waitcnt lgkmcnt(2)
    v_mfma_f32_32x32x16_bf16 a[160:175], v[32:35], v[96:99], a[160:175]
    s_waitcnt lgkmcnt(0)
    v_mfma_f32_32x32x16_bf16 a[176:191], v[32:35], v[100:103], a[176:191]
    v_bfe_u32 v17, v0, 3, 1
    v_lshlrev_b32 v18, 10, v17
    v_bfe_u32 v17, v0, 4, 1
    v_lshl_add_u32 v18, v17, 7, v18
    v_bfe_u32 v17, v0, 2, 1
    v_lshl_add_u32 v18, v17, 6, v18
    v_and_b32 v17, 3, v0
    v_lshl_add_u32 v18, v17, 4, v18
    v_lshrrev_b32 v17, 5, v0
    v_lshl_add_u32 v18, v17, 8, v18
    v_and_b32 v17, 1, v0
    v_lshlrev_b32 v19, 10, v17
    v_bfe_u32 v17, v0, 1, 4
    v_lshl_add_u32 v19, v17, 4, v19
    v_lshrrev_b32 v17, 5, v0
    v_lshl_add_u32 v19, v17, 8, v19
    v_accvgpr_read_b32 v136, a0
    v_accvgpr_read_b32 v137, a1
    v_accvgpr_read_b32 v138, a2
    v_accvgpr_read_b32 v139, a3
    v_accvgpr_read_b32 v140, a4
    v_accvgpr_read_b32 v141, a5
    v_accvgpr_read_b32 v142, a6
    v_accvgpr_read_b32 v143, a7
    v_accvgpr_read_b32 v144, a8
    v_accvgpr_read_b32 v145, a9
    v_accvgpr_read_b32 v146, a10
    v_accvgpr_read_b32 v147, a11
    v_accvgpr_read_b32 v148, a12
    v_accvgpr_read_b32 v149, a13
    v_accvgpr_read_b32 v150, a14
    v_accvgpr_read_b32 v151, a15
    v_cvt_pk_bf16_f32 v104, v136, v137
    v_cvt_pk_bf16_f32 v105, v138, v139
    v_cvt_pk_bf16_f32 v106, v140, v141
    v_cvt_pk_bf16_f32 v107, v142, v143
    v_cvt_pk_bf16_f32 v108, v144, v145
    v_cvt_pk_bf16_f32 v109, v146, v147
    v_cvt_pk_bf16_f32 v110, v148, v149
    v_cvt_pk_bf16_f32 v111, v150, v151
    s_add_u32 s39, s43, 0
    buffer_store_dwordx4 v[104:107], v18, s[4:7], s39 offen offset:0 sc1
    buffer_store_dwordx4 v[108:111], v18, s[4:7], s39 offen offset:512 sc1
    v_accvgpr_read_b32 v136, a16
    v_accvgpr_read_b32 v137, a17
    v_accvgpr_read_b32 v138, a18
    v_accvgpr_read_b32 v139, a19
    v_accvgpr_read_b32 v140, a20
    v_accvgpr_read_b32 v141, a21
    v_accvgpr_read_b32 v142, a22
    v_accvgpr_read_b32 v143, a23
    v_accvgpr_read_b32 v144, a24
    v_accvgpr_read_b32 v145, a25
    v_accvgpr_read_b32 v146, a26
    v_accvgpr_read_b32 v147, a27
    v_accvgpr_read_b32 v148, a28
    v_accvgpr_read_b32 v149, a29
    v_accvgpr_read_b32 v150, a30
    v_accvgpr_read_b32 v151, a31
    v_cvt_pk_bf16_f32 v112, v136, v137
    v_cvt_pk_bf16_f32 v113, v138, v139
    v_cvt_pk_bf16_f32 v114, v140, v141
    v_cvt_pk_bf16_f32 v115, v142, v143
    v_cvt_pk_bf16_f32 v116, v144, v145
    v_cvt_pk_bf16_f32 v117, v146, v147
    v_cvt_pk_bf16_f32 v118, v148, v149
    v_cvt_pk_bf16_f32 v119, v150, v151
    s_add_u32 s39, s43, 4096
    buffer_store_dwordx4 v[112:115], v18, s[4:7], s39 offen offset:0 sc1
    buffer_store_dwordx4 v[116:119], v18, s[4:7], s39 offen offset:512 sc1
    v_accvgpr_read_b32 v136, a32
    v_accvgpr_read_b32 v137, a33
    v_accvgpr_read_b32 v138, a34
    v_accvgpr_read_b32 v139, a35
    v_accvgpr_read_b32 v140, a36
    v_accvgpr_read_b32 v141, a37
    v_accvgpr_read_b32 v142, a38
    v_accvgpr_read_b32 v143, a39
    v_accvgpr_read_b32 v144, a40
    v_accvgpr_read_b32 v145, a41
    v_accvgpr_read_b32 v146, a42
    v_accvgpr_read_b32 v147, a43
    v_accvgpr_read_b32 v148, a44
    v_accvgpr_read_b32 v149, a45
    v_accvgpr_read_b32 v150, a46
    v_accvgpr_read_b32 v151, a47
    v_cvt_pk_bf16_f32 v120, v136, v137
    v_cvt_pk_bf16_f32 v121, v138, v139
    v_cvt_pk_bf16_f32 v122, v140, v141
    v_cvt_pk_bf16_f32 v123, v142, v143
    v_cvt_pk_bf16_f32 v124, v144, v145
    v_cvt_pk_bf16_f32 v125, v146, v147
    v_cvt_pk_bf16_f32 v126, v148, v149
    v_cvt_pk_bf16_f32 v127, v150, v151
    s_add_u32 s39, s43, 8192
    buffer_store_dwordx4 v[120:123], v18, s[4:7], s39 offen offset:0 sc1
    buffer_store_dwordx4 v[124:127], v18, s[4:7], s39 offen offset:512 sc1
    v_accvgpr_read_b32 v136, a48
    v_accvgpr_read_b32 v137, a49
    v_accvgpr_read_b32 v138, a50
    v_accvgpr_read_b32 v139, a51
    v_accvgpr_read_b32 v140, a52
    v_accvgpr_read_b32 v141, a53
    v_accvgpr_read_b32 v142, a54
    v_accvgpr_read_b32 v143, a55
    v_accvgpr_read_b32 v144, a56
    v_accvgpr_read_b32 v145, a57
    v_accvgpr_read_b32 v146, a58
    v_accvgpr_read_b32 v147, a59
    v_accvgpr_read_b32 v148, a60
    v_accvgpr_read_b32 v149, a61
    v_accvgpr_read_b32 v150, a62
    v_accvgpr_read_b32 v151, a63
    v_cvt_pk_bf16_f32 v128, v136, v137
    v_cvt_pk_bf16_f32 v129, v138, v139
    v_cvt_pk_bf16_f32 v130, v140, v141
    v_cvt_pk_bf16_f32 v131, v142, v143
    v_cvt_pk_bf16_f32 v132, v144, v145
    v_cvt_pk_bf16_f32 v133, v146, v147
    v_cvt_pk_bf16_f32 v134, v148, v149
    v_cvt_pk_bf16_f32 v135, v150, v151
    s_add_u32 s39, s43, 12288
    buffer_store_dwordx4 v[128:131], v18, s[4:7], s39 offen offset:0 sc1
    buffer_store_dwordx4 v[132:135], v18, s[4:7], s39 offen offset:512 sc1
    v_accvgpr_read_b32 v136, a128
    v_accvgpr_read_b32 v137, a129
    v_accvgpr_read_b32 v138, a130
    v_accvgpr_read_b32 v139, a131
    v_accvgpr_read_b32 v140, a132
    v_accvgpr_read_b32 v141, a133
    v_accvgpr_read_b32 v142, a134
    v_accvgpr_read_b32 v143, a135
    v_accvgpr_read_b32 v144, a136
    v_accvgpr_read_b32 v145, a137
    v_accvgpr_read_b32 v146, a138
    v_accvgpr_read_b32 v147, a139
    v_accvgpr_read_b32 v148, a140
    v_accvgpr_read_b32 v149, a141
    v_accvgpr_read_b32 v150, a142
    v_accvgpr_read_b32 v151, a143
    v_cvt_pk_bf16_f32 v104, v136, v137
    v_cvt_pk_bf16_f32 v105, v138, v139
    v_cvt_pk_bf16_f32 v106, v140, v141
    v_cvt_pk_bf16_f32 v107, v142, v143
    v_cvt_pk_bf16_f32 v108, v144, v145
    v_cvt_pk_bf16_f32 v109, v146, v147
    v_cvt_pk_bf16_f32 v110, v148, v149
    v_cvt_pk_bf16_f32 v111, v150, v151
    s_add_u32 s39, s43, 2048
    buffer_store_dwordx4 v[104:107], v19, s[4:7], s39 offen offset:0 sc1
    buffer_store_dwordx4 v[108:111], v19, s[4:7], s39 offen offset:512 sc1
    v_accvgpr_read_b32 v136, a144
    v_accvgpr_read_b32 v137, a145
    v_accvgpr_read_b32 v138, a146
    v_accvgpr_read_b32 v139, a147
    v_accvgpr_read_b32 v140, a148
    v_accvgpr_read_b32 v141, a149
    v_accvgpr_read_b32 v142, a150
    v_accvgpr_read_b32 v143, a151
    v_accvgpr_read_b32 v144, a152
    v_accvgpr_read_b32 v145, a153
    v_accvgpr_read_b32 v146, a154
    v_accvgpr_read_b32 v147, a155
    v_accvgpr_read_b32 v148, a156
    v_accvgpr_read_b32 v149, a157
    v_accvgpr_read_b32 v150, a158
    v_accvgpr_read_b32 v151, a159
    v_cvt_pk_bf16_f32 v112, v136, v137
    v_cvt_pk_bf16_f32 v113, v138, v139
    v_cvt_pk_bf16_f32 v114, v140, v141
    v_cvt_pk_bf16_f32 v115, v142, v143
    v_cvt_pk_bf16_f32 v116, v144, v145
    v_cvt_pk_bf16_f32 v117, v146, v147
    v_cvt_pk_bf16_f32 v118, v148, v149
    v_cvt_pk_bf16_f32 v119, v150, v151
    s_add_u32 s39, s43, 6144
    buffer_store_dwordx4 v[112:115], v19, s[4:7], s39 offen offset:0 sc1
    buffer_store_dwordx4 v[116:119], v19, s[4:7], s39 offen offset:512 sc1
    v_accvgpr_read_b32 v136, a160
    v_accvgpr_read_b32 v137, a161
    v_accvgpr_read_b32 v138, a162
    v_accvgpr_read_b32 v139, a163
    v_accvgpr_read_b32 v140, a164
    v_accvgpr_read_b32 v141, a165
    v_accvgpr_read_b32 v142, a166
    v_accvgpr_read_b32 v143, a167
    v_accvgpr_read_b32 v144, a168
    v_accvgpr_read_b32 v145, a169
    v_accvgpr_read_b32 v146, a170
    v_accvgpr_read_b32 v147, a171
    v_accvgpr_read_b32 v148, a172
    v_accvgpr_read_b32 v149, a173
    v_accvgpr_read_b32 v150, a174
    v_accvgpr_read_b32 v151, a175
    v_cvt_pk_bf16_f32 v120, v136, v137
    v_cvt_pk_bf16_f32 v121, v138, v139
    v_cvt_pk_bf16_f32 v122, v140, v141
    v_cvt_pk_bf16_f32 v123, v142, v143
    v_cvt_pk_bf16_f32 v124, v144, v145
    v_cvt_pk_bf16_f32 v125, v146, v147
    v_cvt_pk_bf16_f32 v126, v148, v149
    v_cvt_pk_bf16_f32 v127, v150, v151
    s_add_u32 s39, s43, 10240
    buffer_store_dwordx4 v[120:123], v19, s[4:7], s39 offen offset:0 sc1
    buffer_store_dwordx4 v[124:127], v19, s[4:7], s39 offen offset:512 sc1
    v_accvgpr_read_b32 v136, a176
    v_accvgpr_read_b32 v137, a177
    v_accvgpr_read_b32 v138, a178
    v_accvgpr_read_b32 v139, a179
    v_accvgpr_read_b32 v140, a180
    v_accvgpr_read_b32 v141, a181
    v_accvgpr_read_b32 v142, a182
    v_accvgpr_read_b32 v143, a183
    v_accvgpr_read_b32 v144, a184
    v_accvgpr_read_b32 v145, a185
    v_accvgpr_read_b32 v146, a186
    v_accvgpr_read_b32 v147, a187
    v_accvgpr_read_b32 v148, a188
    v_accvgpr_read_b32 v149, a189
    v_accvgpr_read_b32 v150, a190
    v_accvgpr_read_b32 v151, a191
    v_cvt_pk_bf16_f32 v128, v136, v137
    v_cvt_pk_bf16_f32 v129, v138, v139
    v_cvt_pk_bf16_f32 v130, v140, v141
    v_cvt_pk_bf16_f32 v131, v142, v143
    v_cvt_pk_bf16_f32 v132, v144, v145
    v_cvt_pk_bf16_f32 v133, v146, v147
    v_cvt_pk_bf16_f32 v134, v148, v149
    v_cvt_pk_bf16_f32 v135, v150, v151
    s_add_u32 s39, s43, 14336
    buffer_store_dwordx4 v[128:131], v19, s[4:7], s39 offen offset:0 sc1
    buffer_store_dwordx4 v[132:135], v19, s[4:7], s39 offen offset:512 sc1
    s_cmp_eq_u32 s58, 0
    s_cselect_b32 s51, 112, 40
    s_waitcnt vmcnt(0)
    s_barrier
    s_cmp_lg_u32 s17, 0
    s_cbranch_scc1 L_sig_half
    v_mov_b32 v251, 1
    s_mov_b64 exec, 1
    buffer_atomic_add v251, off, s[8:11], s51 offset:0
    s_mov_b64 exec, -1
L_sig_half:
    s_mov_b32 s49, 9
    s_mov_b32 s48, 1
    s_branch L_task
L_after:
    s_lshl_b32 s50, s47, 5
    s_add_u32 s50, s50, s16
    s_cmp_eq_u32 s47, 4
    s_cbranch_scc1 L_doT2
    s_cmp_eq_u32 s47, 5
    s_cbranch_scc1 L_doT3
    s_cmp_eq_u32 s55, 4
    s_cbranch_scc1 L_wend
L_doT5:
L_pap:
    buffer_load_dword v251, off, s[8:11], 0 offset:72 sc1
    s_add_u32 s19, s19, 1
    s_cmp_gt_u32 s19, 3000000
    s_cbranch_scc1 L_wend2
    s_waitcnt vmcnt(0)
    v_readfirstlane_b32 s39, v251
    s_nop 0
    s_cmp_eq_u32 s39, 32
    s_cbranch_scc1 L_pap_ok
    s_sleep 16
    s_branch L_pap
L_pap_ok:
    s_lshl_b32 s55, s50, 4
    s_lshl_b32 s56, s17, 2
    s_add_u32 s55, s55, s56
    v_lshlrev_b32 v1, 4, v0
    v_and_b32 v220, 31, v0
    v_mul_u32_u24 v2, 40, v220
    v_lshrrev_b32 v220, 5, v0
    v_cmp_eq_u32 vcc, 0, v220
    v_lshl_add_u32 v221, v220, 4, v2
    s_mul_i32 s39, s55, 1280
    s_add_u32 s39, s39, 83886080
    s_mov_b32 s50, 92274688
    buffer_load_dwordx4 v[8:11], v221, s[4:7], s39 offen offset:0 sc1
    buffer_load_dwordx2 v[12:13], v2, s[4:7], s39 offen offset:32 sc1
    buffer_load_dwordx4 v[16:19], v221, s[4:7], s39 offen offset:1280 sc1
    buffer_load_dwordx2 v[20:21], v2, s[4:7], s39 offen offset:1312 sc1
    buffer_load_dwordx4 v[24:27], v221, s[4:7], s39 offen offset:2560 sc1
    buffer_load_dwordx2 v[28:29], v2, s[4:7], s39 offen offset:2592 sc1
    buffer_load_dwordx4 v[32:35], v221, s[4:7], s39 offen offset:3840 sc1
    buffer_load_dwordx2 v[36:37], v2, s[4:7], s39 offen offset:3872 sc1
    s_waitcnt vmcnt(6)
    v_cndmask_b32 v12, 0, v12, vcc
    v_cndmask_b32 v13, 0, v13, vcc
    v_mov_b32 v14, 0
    v_mov_b32 v15, 0
    s_waitcnt vmcnt(4)
    v_cndmask_b32 v20, 0, v20, vcc
    v_cndmask_b32 v21, 0, v21, vcc
    v_mov_b32 v22, 0
    v_mov_b32 v23, 0
    s_waitcnt vmcnt(2)
    v_cndmask_b32 v28, 0, v28, vcc
    v_cndmask_b32 v29, 0, v29, vcc
    v_mov_b32 v30, 0
    v_mov_b32 v31, 0
    s_waitcnt vmcnt(0)
    v_cndmask_b32 v36, 0, v36, vcc
    v_cndmask_b32 v37, 0, v37, vcc
    v_mov_b32 v38, 0
    v_mov_b32 v39, 0
    s_mov_b32 s52, 1
    s_waitcnt vmcnt(0)
L_t5_again:
    s_mov_b32 s50, 92274688
    buffer_load_dwordx4 v[168:171], v1, s[4:7], s50 offen offset:0 sc1
    buffer_load_dwordx4 v[172:175], v1, s[4:7], s50 offen offset:1024 sc1
    s_add_u32 s50, s50, 4096
    buffer_load_dwordx4 v[184:187], v1, s[4:7], s50 offen offset:0 sc1
    buffer_load_dwordx4 v[188:191], v1, s[4:7], s50 offen offset:1024 sc1
    s_add_u32 s50, s50, 4096
    v_mov_b32 v216, 0xff800000
    v_mov_b32 v217, 0xff800000
    v_mov_b32 v218, 0xff800000
    v_mov_b32 v219, 0xff800000
    v_mov_b32 v136, 0xff800000
    v_mov_b32 v137, 0xff800000
    v_mov_b32 v138, 0xff800000
    v_mov_b32 v139, 0xff800000
    v_mov_b32 v140, 0xff800000
    v_mov_b32 v141, 0xff800000
    v_mov_b32 v142, 0xff800000
    v_mov_b32 v143, 0xff800000
    v_mov_b32 v144, 0xff800000
    v_mov_b32 v145, 0xff800000
    v_mov_b32 v146, 0xff800000
    v_mov_b32 v147, 0xff800000
    v_mov_b32 v148, 0xff800000
    v_mov_b32 v149, 0xff800000
    v_mov_b32 v150, 0xff800000
    v_mov_b32 v151, 0xff800000
    s_mov_b32 s51, 0
    s_waitcnt vmcnt(0)
    .p2align 6
L_t5_p1:
    s_waitcnt vmcnt(3)
    v_mfma_f32_32x32x16_bf16 v[104:119], v[168:171], v[8:11], 0
    s_min_u32 s50, s50, 92532736
    buffer_load_dwordx4 v[200:203], v1, s[4:7], s50 offen offset:0 sc1
    buffer_load_dwordx4 v[204:207], v1, s[4:7], s50 offen offset:1024 sc1
    s_add_u32 s50, s50, 4096
    s_waitcnt vmcnt(4)
    v_mfma_f32_32x32x16_bf16 v[104:119], v[172:175], v[12:15], v[104:119]
    v_max3_f32 v219, v219, v136, v137
    v_max3_f32 v219, v219, v138, v139
    v_max3_f32 v219, v219, v140, v141
    v_max3_f32 v219, v219, v142, v143
    v_max3_f32 v219, v219, v144, v145
    v_max3_f32 v219, v219, v146, v147
    v_max3_f32 v219, v219, v148, v149
    v_max3_f32 v219, v219, v150, v151
    v_mfma_f32_32x32x16_bf16 v[120:135], v[168:171], v[16:19], 0
    v_mfma_f32_32x32x16_bf16 v[120:135], v[172:175], v[20:23], v[120:135]
    v_max3_f32 v216, v216, v104, v105
    v_max3_f32 v216, v216, v106, v107
    v_max3_f32 v216, v216, v108, v109
    v_max3_f32 v216, v216, v110, v111
    v_max3_f32 v216, v216, v112, v113
    v_max3_f32 v216, v216, v114, v115
    v_max3_f32 v216, v216, v116, v117
    v_max3_f32 v216, v216, v118, v119
    v_mfma_f32_32x32x16_bf16 v[136:151], v[168:171], v[24:27], 0
    v_mfma_f32_32x32x16_bf16 v[136:151], v[172:175], v[28:31], v[136:151]
    v_max3_f32 v217, v217, v120, v121
    v_max3_f32 v217, v217, v122, v123
    v_max3_f32 v217, v217, v124, v125
    v_max3_f32 v217, v217, v126, v127
    v_max3_f32 v217, v217, v128, v129
    v_max3_f32 v217, v217, v130, v131
    v_max3_f32 v217, v217, v132, v133
    v_max3_f32 v217, v217, v134, v135
    v_mfma_f32_32x32x16_bf16 v[104:119], v[168:171], v[32:35], 0
    v_mfma_f32_32x32x16_bf16 v[104:119], v[172:175], v[36:39], v[104:119]
    v_max3_f32 v218, v218, v136, v137
    v_max3_f32 v218, v218, v138, v139
    v_max3_f32 v218, v218, v140, v141
    v_max3_f32 v218, v218, v142, v143
    v_max3_f32 v218, v218, v144, v145
    v_max3_f32 v218, v218, v146, v147
    v_max3_f32 v218, v218, v148, v149
    v_max3_f32 v218, v218, v150, v151
    s_waitcnt vmcnt(3)
    v_mfma_f32_32x32x16_bf16 v[120:135], v[184:187], v[8:11], 0
    s_min_u32 s50, s50, 92532736
    buffer_load_dwordx4 v[168:171], v1, s[4:7], s50 offen offset:0 sc1
    buffer_load_dwordx4 v[172:175], v1, s[4:7], s50 offen offset:1024 sc1
    s_add_u32 s50, s50, 4096
    s_waitcnt vmcnt(4)
    v_mfma_f32_32x32x16_bf16 v[120:135], v[188:191], v[12:15], v[120:135]
    v_max3_f32 v219, v219, v104, v105
    v_max3_f32 v219, v219, v106, v107
    v_max3_f32 v219, v219, v108, v109
    v_max3_f32 v219, v219, v110, v111
    v_max3_f32 v219, v219, v112, v113
    v_max3_f32 v219, v219, v114, v115
    v_max3_f32 v219, v219, v116, v117
    v_max3_f32 v219, v219, v118, v119
    v_mfma_f32_32x32x16_bf16 v[136:151], v[184:187], v[16:19], 0
    v_mfma_f32_32x32x16_bf16 v[136:151], v[188:191], v[20:23], v[136:151]
    v_max3_f32 v216, v216, v120, v121
    v_max3_f32 v216, v216, v122, v123
    v_max3_f32 v216, v216, v124, v125
    v_max3_f32 v216, v216, v126, v127
    v_max3_f32 v216, v216, v128, v129
    v_max3_f32 v216, v216, v130, v131
    v_max3_f32 v216, v216, v132, v133
    v_max3_f32 v216, v216, v134, v135
    v_mfma_f32_32x32x16_bf16 v[104:119], v[184:187], v[24:27], 0
    v_mfma_f32_32x32x16_bf16 v[104:119], v[188:191], v[28:31], v[104:119]
    v_max3_f32 v217, v217, v136, v137
    v_max3_f32 v217, v217, v138, v139
    v_max3_f32 v217, v217, v140, v141
    v_max3_f32 v217, v217, v142, v143
    v_max3_f32 v217, v217, v144, v145
    v_max3_f32 v217, v217, v146, v147
    v_max3_f32 v217, v217, v148, v149
    v_max3_f32 v217, v217, v150, v151
    v_mfma_f32_32x32x16_bf16 v[120:135], v[184:187], v[32:35], 0
    v_mfma_f32_32x32x16_bf16 v[120:135], v[188:191], v[36:39], v[120:135]
    v_max3_f32 v218, v218, v104, v105
    v_max3_f32 v218, v218, v106, v107
    v_max3_f32 v218, v218, v108, v109
    v_max3_f32 v218, v218, v110, v111
    v_max3_f32 v218, v218, v112, v113
    v_max3_f32 v218, v218, v114, v115
    v_max3_f32 v218, v218, v116, v117
    v_max3_f32 v218, v218, v118, v119
    s_waitcnt vmcnt(3)
    v_mfma_f32_32x32x16_bf16 v[136:151], v[200:203], v[8:11], 0
    s_min_u32 s50, s50, 92532736
    buffer_load_dwordx4 v[184:187], v1, s[4:7], s50 offen offset:0 sc1
    buffer_load_dwordx4 v[188:191], v1, s[4:7], s50 offen offset:1024 sc1
    s_add_u32 s50, s50, 4096
    s_waitcnt vmcnt(4)
    v_mfma_f32_32x32x16_bf16 v[136:151], v[204:207], v[12:15], v[136:151]
    v_max3_f32 v219, v219, v120, v121
    v_max3_f32 v219, v219, v122, v123
    v_max3_f32 v219, v219, v124, v125
    v_max3_f32 v219, v219, v126, v127
    v_max3_f32 v219, v219, v128, v129
    v_max3_f32 v219, v219, v130, v131
    v_max3_f32 v219, v219, v132, v133
    v_max3_f32 v219, v219, v134, v135
    v_mfma_f32_32x32x16_bf16 v[104:119], v[200:203], v[16:19], 0
    v_mfma_f32_32x32x16_bf16 v[104:119], v[204:207], v[20:23], v[104:119]
    v_max3_f32 v216, v216, v136, v137
    v_max3_f32 v216, v216, v138, v139
    v_max3_f32 v216, v216, v140, v141
    v_max3_f32 v216, v216, v142, v143
    v_max3_f32 v216, v216, v144, v145
    v_max3_f32 v216, v216, v146, v147
    v_max3_f32 v216, v216, v148, v149
    v_max3_f32 v216, v216, v150, v151
    v_mfma_f32_32x32x16_bf16 v[120:135], v[200:203], v[24:27], 0
    v_mfma_f32_32x32x16_bf16 v[120:135], v[204:207], v[28:31], v[120:135]
    v_max3_f32 v217, v217, v104, v105
    v_max3_f32 v217, v217, v106, v107
    v_max3_f32 v217, v217, v108, v109
    v_max3_f32 v217, v217, v110, v111
    v_max3_f32 v217, v217, v112, v113
    v_max3_f32 v217, v217, v114, v115
    v_max3_f32 v217, v217, v116, v117
    v_max3_f32 v217, v217, v118, v119
    v_mfma_f32_32x32x16_bf16 v[136:151], v[200:203], v[32:35], 0
    v_mfma_f32_32x32x16_bf16 v[136:151], v[204:207], v[36:39], v[136:151]
    v_max3_f32 v218, v218, v120, v121
    v_max3_f32 v218, v218, v122, v123
    v_max3_f32 v218, v218, v124, v125
    v_max3_f32 v218, v218, v126, v127
    v_max3_f32 v218, v218, v128, v129
    v_max3_f32 v218, v218, v130, v131
    v_max3_f32 v218, v218, v132, v133
    v_max3_f32 v218, v218, v134, v135
    s_add_u32 s51, s51, 1
    s_cmp_lt_u32 s51, s52
    s_cbranch_scc1 L_t5_p1
    s_nop 7
    s_nop 7
    v_max3_f32 v219, v219, v136, v137
    v_max3_f32 v219, v219, v138, v139
    v_max3_f32 v219, v219, v140, v141
    v_max3_f32 v219, v219, v142, v143
    v_max3_f32 v219, v219, v144, v145
    v_max3_f32 v219, v219, v146, v147
    v_max3_f32 v219, v219, v148, v149
    v_max3_f32 v219, v219, v150, v151
    s_mov_b32 s50, 92274688
    s_waitcnt vmcnt(0)
    buffer_load_dwordx4 v[168:171], v1, s[4:7], s50 offen offset:0 sc1
    buffer_load_dwordx4 v[172:175], v1, s[4:7], s50 offen offset:1024 sc1
    buffer_load_dwordx4 v[176:179], v1, s[4:7], s50 offen offset:2048 sc1
    buffer_load_dwordx4 v[180:183], v1, s[4:7], s50 offen offset:3072 sc1
    s_add_u32 s50, s50, 4096
    buffer_load_dwordx4 v[184:187], v1, s[4:7], s50 offen offset:0 sc1
    buffer_load_dwordx4 v[188:191], v1, s[4:7], s50 offen offset:1024 sc1
    buffer_load_dwordx4 v[192:195], v1, s[4:7], s50 offen offset:2048 sc1
    buffer_load_dwordx4 v[196:199], v1, s[4:7], s50 offen offset:3072 sc1
    s_add_u32 s50, s50, 4096
    v_mov_b32 v220, v216
    s_nop 1
    v_permlane32_swap_b32 v220, v216
    v_max_f32 v220, v220, v216
    v_sub_f32 v40, 0, v220
    v_sub_f32 v41, 0, v220
    v_sub_f32 v42, 0, v220
    v_sub_f32 v43, 0, v220
    v_sub_f32 v44, 0, v220
    v_sub_f32 v45, 0, v220
    v_sub_f32 v46, 0, v220
    v_sub_f32 v47, 0, v220
    v_sub_f32 v48, 0, v220
    v_sub_f32 v49, 0, v220
    v_sub_f32 v50, 0, v220
    v_sub_f32 v51, 0, v220
    v_sub_f32 v52, 0, v220
    v_sub_f32 v53, 0, v220
    v_sub_f32 v54, 0, v220
    v_sub_f32 v55, 0, v220
    v_accvgpr_write_b32 a0, 0
    v_accvgpr_write_b32 a1, 0
    v_accvgpr_write_b32 a2, 0
    v_accvgpr_write_b32 a3, 0
    v_accvgpr_write_b32 a4, 0
    v_accvgpr_write_b32 a5, 0
    v_accvgpr_write_b32 a6, 0
    v_accvgpr_write_b32 a7, 0
    v_accvgpr_write_b32 a8, 0
    v_accvgpr_write_b32 a9, 0
    v_accvgpr_write_b32 a10, 0
    v_accvgpr_write_b32 a11, 0
    v_accvgpr_write_b32 a12, 0
    v_accvgpr_write_b32 a13, 0
    v_accvgpr_write_b32 a14, 0
    v_accvgpr_write_b32 a15, 0
    v_mov_b32 v220, v217
    s_nop 1
    v_permlane32_swap_b32 v220, v217
    v_max_f32 v220, v220, v217
    v_sub_f32 v56, 0, v220
    v_sub_f32 v57, 0, v220
    v_sub_f32 v58, 0, v220
    v_sub_f32 v59, 0, v220
    v_sub_f32 v60, 0, v220
    v_sub_f32 v61, 0, v220
    v_sub_f32 v62, 0, v220
    v_sub_f32 v63, 0, v220
    v_sub_f32 v64, 0, v220
    v_sub_f32 v65, 0, v220
    v_sub_f32 v66, 0, v220
    v_sub_f32 v67, 0, v220
    v_sub_f32 v68, 0, v220
    v_sub_f32 v69, 0, v220
    v_sub_f32 v70, 0, v220
    v_sub_f32 v71, 0, v220
    v_accvgpr_write_b32 a16, 0
    v_accvgpr_write_b32 a17, 0
    v_accvgpr_write_b32 a18, 0
    v_accvgpr_write_b32 a19, 0
    v_accvgpr_write_b32 a20, 0
    v_accvgpr_write_b32 a21, 0
    v_accvgpr_write_b32 a22, 0
    v_accvgpr_write_b32 a23, 0
    v_accvgpr_write_b32 a24, 0
    v_accvgpr_write_b32 a25, 0
    v_accvgpr_write_b32 a26, 0
    v_accvgpr_write_b32 a27, 0
    v_accvgpr_write_b32 a28, 0
    v_accvgpr_write_b32 a29, 0
    v_accvgpr_write_b32 a30, 0
    v_accvgpr_write_b32 a31, 0
    v_mov_b32 v220, v218
    s_nop 1
    v_permlane32_swap_b32 v220, v218
    v_max_f32 v220, v220, v218
    v_sub_f32 v72, 0, v220
    v_sub_f32 v73, 0, v220
    v_sub_f32 v74, 0, v220
    v_sub_f32 v75, 0, v220
    v_sub_f32 v76, 0, v220
    v_sub_f32 v77, 0, v220
    v_sub_f32 v78, 0, v220
    v_sub_f32 v79, 0, v220
    v_sub_f32 v80, 0, v220
    v_sub_f32 v81, 0, v220
    v_sub_f32 v82, 0, v220
    v_sub_f32 v83, 0, v220
    v_sub_f32 v84, 0, v220
    v_sub_f32 v85, 0, v220
    v_sub_f32 v86, 0, v220
    v_sub_f32 v87, 0, v220
    v_accvgpr_write_b32 a32, 0
    v_accvgpr_write_b32 a33, 0
    v_accvgpr_write_b32 a34, 0
    v_accvgpr_write_b32 a35, 0
    v_accvgpr_write_b32 a36, 0
    v_accvgpr_write_b32 a37, 0
    v_accvgpr_write_b32 a38, 0
    v_accvgpr_write_b32 a39, 0
    v_accvgpr_write_b32 a40, 0
    v_accvgpr_write_b32 a41, 0
    v_accvgpr_write_b32 a42, 0
    v_accvgpr_write_b32 a43, 0
    v_accvgpr_write_b32 a44, 0
    v_accvgpr_write_b32 a45, 0
    v_accvgpr_write_b32 a46, 0
    v_accvgpr_write_b32 a47, 0
    v_mov_b32 v220, v219
    s_nop 1
    v_permlane32_swap_b32 v220, v219
    v_max_f32 v220, v220, v219
    v_sub_f32 v88, 0, v220
    v_sub_f32 v89, 0, v220
    v_sub_f32 v90, 0, v220
    v_sub_f32 v91, 0, v220
    v_sub_f32 v92, 0, v220
    v_sub_f32 v93, 0, v220
    v_sub_f32 v94, 0, v220
    v_sub_f32 v95, 0, v220
    v_sub_f32 v96, 0, v220
    v_sub_f32 v97, 0, v220
    v_sub_f32 v98, 0, v220
    v_sub_f32 v99, 0, v220
    v_sub_f32 v100, 0, v220
    v_sub_f32 v101, 0, v220
    v_sub_f32 v102, 0, v220
    v_sub_f32 v103, 0, v220
    v_accvgpr_write_b32 a48, 0
    v_accvgpr_write_b32 a49, 0
    v_accvgpr_write_b32 a50, 0
    v_accvgpr_write_b32 a51, 0
    v_accvgpr_write_b32 a52, 0
    v_accvgpr_write_b32 a53, 0
    v_accvgpr_write_b32 a54, 0
    v_accvgpr_write_b32 a55, 0
    v_accvgpr_write_b32 a56, 0
    v_accvgpr_write_b32 a57, 0
    v_accvgpr_write_b32 a58, 0
    v_accvgpr_write_b32 a59, 0
    v_accvgpr_write_b32 a60, 0
    v_accvgpr_write_b32 a61, 0
    v_accvgpr_write_b32 a62, 0
    v_accvgpr_write_b32 a63, 0
    v_mov_b32 v164, 0
    v_mov_b32 v165, 0
    v_mov_b32 v166, 0
    v_mov_b32 v167, 0
    v_mov_b32 v212, 0
    v_mov_b32 v213, 0
    v_mov_b32 v214, 0
    v_mov_b32 v215, 0
    s_waitcnt vmcnt(7)
    v_mfma_f32_32x32x16_bf16 v[104:119], v[168:171], v[8:11], v[40:55]
    s_waitcnt vmcnt(6)
    v_mfma_f32_32x32x16_bf16 v[104:119], v[172:175], v[12:15], v[104:119]
    s_mov_b32 s51, 0
    s_waitcnt vmcnt(0)
    s_nop 7
    s_nop 7
    .p2align 6
L_t5_p2:
    v_exp_f32 v104, v104
    v_mfma_f32_32x32x16_bf16 a[48:63], v[212:215], v[164:167], a[48:63]
    s_min_u32 s50, s50, 92532736
    buffer_load_dwordx4 v[200:203], v1, s[4:7], s50 offen offset:0 sc1
    buffer_load_dwordx4 v[204:207], v1, s[4:7], s50 offen offset:1024 sc1
    buffer_load_dwordx4 v[208:211], v1, s[4:7], s50 offen offset:2048 sc1
    buffer_load_dwordx4 v[212:215], v1, s[4:7], s50 offen offset:3072 sc1
    s_add_u32 s50, s50, 4096
    v_exp_f32 v105, v105
    v_exp_f32 v106, v106
    v_exp_f32 v107, v107
    v_mfma_f32_32x32x16_bf16 v[120:135], v[168:171], v[16:19], v[56:71]
    v_cvt_pk_bf16_f32 v152, v104, v105
    v_exp_f32 v108, v108
    v_cvt_pk_bf16_f32 v153, v106, v107
    v_exp_f32 v109, v109
    v_mfma_f32_32x32x16_bf16 v[120:135], v[172:175], v[20:23], v[120:135]
    v_exp_f32 v110, v110
    v_exp_f32 v111, v111
    v_cvt_pk_bf16_f32 v154, v108, v109
    v_exp_f32 v112, v112
    v_cvt_pk_bf16_f32 v155, v110, v111
    v_exp_f32 v113, v113
    v_exp_f32 v114, v114
    s_waitcnt vmcnt(9)
    v_mfma_f32_32x32x16_bf16 a[0:15], v[176:179], v[152:155], a[0:15]
    v_exp_f32 v115, v115
    v_cvt_pk_bf16_f32 v156, v112, v113
    v_exp_f32 v116, v116
    v_cvt_pk_bf16_f32 v157, v114, v115
    v_exp_f32 v117, v117
    v_exp_f32 v118, v118
    v_exp_f32 v119, v119
    v_cvt_pk_bf16_f32 v158, v116, v117
    v_cvt_pk_bf16_f32 v159, v118, v119
    v_exp_f32 v120, v120
    s_waitcnt vmcnt(8)
    v_mfma_f32_32x32x16_bf16 a[0:15], v[180:183], v[156:159], a[0:15]
    v_exp_f32 v121, v121
    v_exp_f32 v122, v122
    v_exp_f32 v123, v123
    v_mfma_f32_32x32x16_bf16 v[104:119], v[168:171], v[24:27], v[72:87]
    v_cvt_pk_bf16_f32 v160, v120, v121
    v_exp_f32 v124, v124
    v_cvt_pk_bf16_f32 v161, v122, v123
    v_exp_f32 v125, v125
    v_mfma_f32_32x32x16_bf16 v[104:119], v[172:175], v[28:31], v[104:119]
    v_exp_f32 v126, v126
    v_exp_f32 v127, v127
    v_cvt_pk_bf16_f32 v162, v124, v125
    v_exp_f32 v128, v128
    v_cvt_pk_bf16_f32 v163, v126, v127
    v_exp_f32 v129, v129
    v_exp_f32 v130, v130
    v_mfma_f32_32x32x16_bf16 a[16:31], v[176:179], v[160:163], a[16:31]
    v_exp_f32 v131, v131
    v_cvt_pk_bf16_f32 v164, v128, v129
    v_exp_f32 v132, v132
    v_cvt_pk_bf16_f32 v165, v130, v131
    v_exp_f32 v133, v133
    v_exp_f32 v134, v134
    v_exp_f32 v135, v135
    v_cvt_pk_bf16_f32 v166, v132, v133
    v_cvt_pk_bf16_f32 v167, v134, v135
    v_exp_f32 v104, v104
    s_nop 0
    v_mfma_f32_32x32x16_bf16 a[16:31], v[180:183], v[164:167], a[16:31]
    v_exp_f32 v105, v105
    v_exp_f32 v106, v106
    v_exp_f32 v107, v107
    v_mfma_f32_32x32x16_bf16 v[120:135], v[168:171], v[32:35], v[88:103]
    v_cvt_pk_bf16_f32 v152, v104, v105
    v_exp_f32 v108, v108
    v_cvt_pk_bf16_f32 v153, v106, v107
    v_exp_f32 v109, v109
    v_mfma_f32_32x32x16_bf16 v[120:135], v[172:175], v[36:39], v[120:135]
    v_exp_f32 v110, v110
    v_exp_f32 v111, v111
    v_cvt_pk_bf16_f32 v154, v108, v109
    v_exp_f32 v112, v112
    v_cvt_pk_bf16_f32 v155, v110, v111
    v_exp_f32 v113, v113
    v_exp_f32 v114, v114
    v_mfma_f32_32x32x16_bf16 a[32:47], v[176:179], v[152:155], a[32:47]
    v_exp_f32 v115, v115
    v_cvt_pk_bf16_f32 v156, v112, v113
    v_exp_f32 v116, v116
    v_cvt_pk_bf16_f32 v157, v114, v115
    v_exp_f32 v117, v117
    v_exp_f32 v118, v118
    v_exp_f32 v119, v119
    v_cvt_pk_bf16_f32 v158, v116, v117
    v_cvt_pk_bf16_f32 v159, v118, v119
    v_exp_f32 v120, v120
    s_nop 0
    v_mfma_f32_32x32x16_bf16 a[32:47], v[180:183], v[156:159], a[32:47]
    v_exp_f32 v121, v121
    v_exp_f32 v122, v122
    v_exp_f32 v123, v123
    s_waitcnt vmcnt(7)
    v_mfma_f32_32x32x16_bf16 v[104:119], v[184:187], v[8:11], v[40:55]
    v_cvt_pk_bf16_f32 v160, v120, v121
    v_exp_f32 v124, v124
    v_cvt_pk_bf16_f32 v161, v122, v123
    v_exp_f32 v125, v125
    s_waitcnt vmcnt(6)
    v_mfma_f32_32x32x16_bf16 v[104:119], v[188:191], v[12:15], v[104:119]
    v_exp_f32 v126, v126
    v_exp_f32 v127, v127
    v_cvt_pk_bf16_f32 v162, v124, v125
    v_exp_f32 v128, v128
    v_cvt_pk_bf16_f32 v163, v126, v127
    v_exp_f32 v129, v129
    v_exp_f32 v130, v130
    v_mfma_f32_32x32x16_bf16 a[48:63], v[176:179], v[160:163], a[48:63]
    v_exp_f32 v131, v131
    v_cvt_pk_bf16_f32 v164, v128, v129
    v_exp_f32 v132, v132
    v_cvt_pk_bf16_f32 v165, v130, v131
    v_exp_f32 v133, v133
    v_exp_f32 v134, v134
    v_exp_f32 v135, v135
    v_cvt_pk_bf16_f32 v166, v132, v133
    v_cvt_pk_bf16_f32 v167, v134, v135
    v_exp_f32 v104, v104
    s_nop 0
    v_mfma_f32_32x32x16_bf16 a[48:63], v[180:183], v[164:167], a[48:63]
    s_min_u32 s50, s50, 92532736
    buffer_load_dwordx4 v[168:171], v1, s[4:7], s50 offen offset:0 sc1
    buffer_load_dwordx4 v[172:175], v1, s[4:7], s50 offen offset:1024 sc1
    buffer_load_dwordx4 v[176:179], v1, s[4:7], s50 offen offset:2048 sc1
    buffer_load_dwordx4 v[180:183], v1, s[4:7], s50 offen offset:3072 sc1
    s_add_u32 s50, s50, 4096
    v_exp_f32 v105, v105
    v_exp_f32 v106, v106
    v_exp_f32 v107, v107
    v_mfma_f32_32x32x16_bf16 v[120:135], v[184:187], v[16:19], v[56:71]
    v_cvt_pk_bf16_f32 v152, v104, v105
    v_exp_f32 v108, v108
    v_cvt_pk_bf16_f32 v153, v106, v107
    v_exp_f32 v109, v109
    v_mfma_f32_32x32x16_bf16 v[120:135], v[188:191], v[20:23], v[120:135]
    v_exp_f32 v110, v110
    v_exp_f32 v111, v111
    v_cvt_pk_bf16_f32 v154, v108, v109
    v_exp_f32 v112, v112
    v_cvt_pk_bf16_f32 v155, v110, v111
    v_exp_f32 v113, v113
    v_exp_f32 v114, v114
    s_waitcnt vmcnt(9)
    v_mfma_f32_32x32x16_bf16 a[0:15], v[192:195], v[152:155], a[0:15]
    v_exp_f32 v115, v115
    v_cvt_pk_bf16_f32 v156, v112, v113
    v_exp_f32 v116, v116
    v_cvt_pk_bf16_f32 v157, v114, v115
    v_exp_f32 v117, v117
    v_exp_f32 v118, v118
    v_exp_f32 v119, v119
    v_cvt_pk_bf16_f32 v158, v116, v117
    v_cvt_pk_bf16_f32 v159, v118, v119
    v_exp_f32 v120, v120
    s_waitcnt vmcnt(8)
    v_mfma_f32_32x32x16_bf16 a[0:15], v[196:199], v[156:159], a[0:15]
    v_exp_f32 v121, v121
    v_exp_f32 v122, v122
    v_exp_f32 v123, v123
    v_mfma_f32_32x32x16_bf16 v[104:119], v[184:187], v[24:27], v[72:87]
    v_cvt_pk_bf16_f32 v160, v120, v121
    v_exp_f32 v124, v124
    v_cvt_pk_bf16_f32 v161, v122, v123
    v_exp_f32 v125, v125
    v_mfma_f32_32x32x16_bf16 v[104:119], v[188:191], v[28:31], v[104:119]
    v_exp_f32 v126, v126
    v_exp_f32 v127, v127
    v_cvt_pk_bf16_f32 v162, v124, v125
    v_exp_f32 v128, v128
    v_cvt_pk_bf16_f32 v163, v126, v127
    v_exp_f32 v129, v129
    v_exp_f32 v130, v130
    v_mfma_f32_32x32x16_bf16 a[16:31], v[192:195], v[160:163], a[16:31]
    v_exp_f32 v131, v131
    v_cvt_pk_bf16_f32 v164, v128, v129
    v_exp_f32 v132, v132
    v_cvt_pk_bf16_f32 v165, v130, v131
    v_exp_f32 v133, v133
    v_exp_f32 v134, v134
    v_exp_f32 v135, v135
    v_cvt_pk_bf16_f32 v166, v132, v133
    v_cvt_pk_bf16_f32 v167, v134, v135
    v_exp_f32 v104, v104
    s_nop 0
    v_mfma_f32_32x32x16_bf16 a[16:31], v[196:199], v[164:167], a[16:31]
    v_exp_f32 v105, v105
    v_exp_f32 v106, v106
    v_exp_f32 v107, v107
    v_mfma_f32_32x32x16_bf16 v[120:135], v[184:187], v[32:35], v[88:103]
    v_cvt_pk_bf16_f32 v152, v104, v105
    v_exp_f32 v108, v108
    v_cvt_pk_bf16_f32 v153, v106, v107
    v_exp_f32 v109, v109
    v_mfma_f32_32x32x16_bf16 v[120:135], v[188:191], v[36:39], v[120:135]
    v_exp_f32 v110, v110
    v_exp_f32 v111, v111
    v_cvt_pk_bf16_f32 v154, v108, v109
    v_exp_f32 v112, v112
    v_cvt_pk_bf16_f32 v155, v110, v111
    v_exp_f32 v113, v113
    v_exp_f32 v114, v114
    v_mfma_f32_32x32x16_bf16 a[32:47], v[192:195], v[152:155], a[32:47]
    v_exp_f32 v115, v115
    v_cvt_pk_bf16_f32 v156, v112, v113
    v_exp_f32 v116, v116
    v_cvt_pk_bf16_f32 v157, v114, v115
    v_exp_f32 v117, v117
    v_exp_f32 v118, v118
    v_exp_f32 v119, v119
    v_cvt_pk_bf16_f32 v158, v116, v117
    v_cvt_pk_bf16_f32 v159, v118, v119
    v_exp_f32 v120, v120
    s_nop 0
    v_mfma_f32_32x32x16_bf16 a[32:47], v[196:199], v[156:159], a[32:47]
    v_exp_f32 v121, v121
    v_exp_f32 v122, v122
    v_exp_f32 v123, v123
    s_waitcnt vmcnt(7)
    v_mfma_f32_32x32x16_bf16 v[104:119], v[200:203], v[8:11], v[40:55]
    v_cvt_pk_bf16_f32 v160, v120, v121
    v_exp_f32 v124, v124
    v_cvt_pk_bf16_f32 v161, v122, v123
    v_exp_f32 v125, v125
    s_waitcnt vmcnt(6)
    v_mfma_f32_32x32x16_bf16 v[104:119], v[204:207], v[12:15], v[104:119]
    v_exp_f32 v126, v126
    v_exp_f32 v127, v127
    v_cvt_pk_bf16_f32 v162, v124, v125
    v_exp_f32 v128, v128
    v_cvt_pk_bf16_f32 v163, v126, v127
    v_exp_f32 v129, v129
    v_exp_f32 v130, v130
    v_mfma_f32_32x32x16_bf16 a[48:63], v[192:195], v[160:163], a[48:63]
    v_exp_f32 v131, v131
    v_cvt_pk_bf16_f32 v164, v128, v129
    v_exp_f32 v132, v132
    v_cvt_pk_bf16_f32 v165, v130, v131
    v_exp_f32 v133, v133
    v_exp_f32 v134, v134
    v_exp_f32 v135, v135
    v_cvt_pk_bf16_f32 v166, v132, v133
    v_cvt_pk_bf16_f32 v167, v134, v135
    v_exp_f32 v104, v104
    s_nop 0
    v_mfma_f32_32x32x16_bf16 a[48:63], v[196:199], v[164:167], a[48:63]
    s_min_u32 s50, s50, 92532736
    buffer_load_dwordx4 v[184:187], v1, s[4:7], s50 offen offset:0 sc1
    buffer_load_dwordx4 v[188:191], v1, s[4:7], s50 offen offset:1024 sc1
    buffer_load_dwordx4 v[192:195], v1, s[4:7], s50 offen offset:2048 sc1
    buffer_load_dwordx4 v[196:199], v1, s[4:7], s50 offen offset:3072 sc1
    s_add_u32 s50, s50, 4096
    v_exp_f32 v105, v105
    v_exp_f32 v106, v106
    v_exp_f32 v107, v107
    v_mfma_f32_32x32x16_bf16 v[120:135], v[200:203], v[16:19], v[56:71]
    v_cvt_pk_bf16_f32 v152, v104, v105
    v_exp_f32 v108, v108
    v_cvt_pk_bf16_f32 v153, v106, v107
    v_exp_f32 v109, v109
    v_mfma_f32_32x32x16_bf16 v[120:135], v[204:207], v[20:23], v[120:135]
    v_exp_f32 v110, v110
    v_exp_f32 v111, v111
    v_cvt_pk_bf16_f32 v154, v108, v109
    v_exp_f32 v112, v112
    v_cvt_pk_bf16_f32 v155, v110, v111
    v_exp_f32 v113, v113
    v_exp_f32 v114, v114
    s_waitcnt vmcnt(9)
    v_mfma_f32_32x32x16_bf16 a[0:15], v[208:211], v[152:155], a[0:15]
    v_exp_f32 v115, v115
    v_cvt_pk_bf16_f32 v156, v112, v113
    v_exp_f32 v116, v116
    v_cvt_pk_bf16_f32 v157, v114, v115
    v_exp_f32 v117, v117
    v_exp_f32 v118, v118
    v_exp_f32 v119, v119
    v_cvt_pk_bf16_f32 v158, v116, v117
    v_cvt_pk_bf16_f32 v159, v118, v119
    v_exp_f32 v120, v120
    s_waitcnt vmcnt(8)
    v_mfma_f32_32x32x16_bf16 a[0:15], v[212:215], v[156:159], a[0:15]
    v_exp_f32 v121, v121
    v_exp_f32 v122, v122
    v_exp_f32 v123, v123
    v_mfma_f32_32x32x16_bf16 v[104:119], v[200:203], v[24:27], v[72:87]
    v_cvt_pk_bf16_f32 v160, v120, v121
    v_exp_f32 v124, v124
    v_cvt_pk_bf16_f32 v161, v122, v123
    v_exp_f32 v125, v125
    v_mfma_f32_32x32x16_bf16 v[104:119], v[204:207], v[28:31], v[104:119]
    v_exp_f32 v126, v126
    v_exp_f32 v127, v127
    v_cvt_pk_bf16_f32 v162, v124, v125
    v_exp_f32 v128, v128
    v_cvt_pk_bf16_f32 v163, v126, v127
    v_exp_f32 v129, v129
    v_exp_f32 v130, v130
    v_mfma_f32_32x32x16_bf16 a[16:31], v[208:211], v[160:163], a[16:31]
    v_exp_f32 v131, v131
    v_cvt_pk_bf16_f32 v164, v128, v129
    v_exp_f32 v132, v132
    v_cvt_pk_bf16_f32 v165, v130, v131
    v_exp_f32 v133, v133
    v_exp_f32 v134, v134
    v_exp_f32 v135, v135
    v_cvt_pk_bf16_f32 v166, v132, v133
    v_cvt_pk_bf16_f32 v167, v134, v135
    v_exp_f32 v104, v104
    s_nop 0
    v_mfma_f32_32x32x16_bf16 a[16:31], v[212:215], v[164:167], a[16:31]
    v_exp_f32 v105, v105
    v_exp_f32 v106, v106
    v_exp_f32 v107, v107
    v_mfma_f32_32x32x16_bf16 v[120:135], v[200:203], v[32:35], v[88:103]
    v_cvt_pk_bf16_f32 v152, v104, v105
    v_exp_f32 v108, v108
    v_cvt_pk_bf16_f32 v153, v106, v107
    v_exp_f32 v109, v109
    v_mfma_f32_32x32x16_bf16 v[120:135], v[204:207], v[36:39], v[120:135]
    v_exp_f32 v110, v110
    v_exp_f32 v111, v111
    v_cvt_pk_bf16_f32 v154, v108, v109
    v_exp_f32 v112, v112
    v_cvt_pk_bf16_f32 v155, v110, v111
    v_exp_f32 v113, v113
    v_exp_f32 v114, v114
    v_mfma_f32_32x32x16_bf16 a[32:47], v[208:211], v[152:155], a[32:47]
    v_exp_f32 v115, v115
    v_cvt_pk_bf16_f32 v156, v112, v113
    v_exp_f32 v116, v116
    v_cvt_pk_bf16_f32 v157, v114, v115
    v_exp_f32 v117, v117
    v_exp_f32 v118, v118
    v_exp_f32 v119, v119
    v_cvt_pk_bf16_f32 v158, v116, v117
    v_cvt_pk_bf16_f32 v159, v118, v119
    v_exp_f32 v120, v120
    s_nop 0
    v_mfma_f32_32x32x16_bf16 a[32:47], v[212:215], v[156:159], a[32:47]
    v_exp_f32 v121, v121
    v_exp_f32 v122, v122
    v_exp_f32 v123, v123
    s_waitcnt vmcnt(7)
    v_mfma_f32_32x32x16_bf16 v[104:119], v[168:171], v[8:11], v[40:55]
    v_cvt_pk_bf16_f32 v160, v120, v121
    v_exp_f32 v124, v124
    v_cvt_pk_bf16_f32 v161, v122, v123
    v_exp_f32 v125, v125
    s_waitcnt vmcnt(6)
    v_mfma_f32_32x32x16_bf16 v[104:119], v[172:175], v[12:15], v[104:119]
    v_exp_f32 v126, v126
    v_exp_f32 v127, v127
    v_cvt_pk_bf16_f32 v162, v124, v125
    v_exp_f32 v128, v128
    v_cvt_pk_bf16_f32 v163, v126, v127
    v_exp_f32 v129, v129
    v_exp_f32 v130, v130
    v_mfma_f32_32x32x16_bf16 a[48:63], v[208:211], v[160:163], a[48:63]
    v_exp_f32 v131, v131
    v_cvt_pk_bf16_f32 v164, v128, v129
    v_exp_f32 v132, v132
    v_cvt_pk_bf16_f32 v165, v130, v131
    v_exp_f32 v133, v133
    v_exp_f32 v134, v134
    v_exp_f32 v135, v135
    v_cvt_pk_bf16_f32 v166, v132, v133
    v_cvt_pk_bf16_f32 v167, v134, v135
    s_add_u32 s51, s51, 1
    s_cmp_lt_u32 s51, 21
    s_cbranch_scc1 L_t5_p2
    s_waitcnt vmcnt(0)
    s_nop 7
    v_exp_f32 v104, v104
    v_mfma_f32_32x32x16_bf16 a[48:63], v[212:215], v[164:167], a[48:63]
    v_exp_f32 v105, v105
    v_exp_f32 v106, v106
    v_exp_f32 v107, v107
    v_mfma_f32_32x32x16_bf16 v[120:135], v[168:171], v[16:19], v[56:71]
    v_cvt_pk_bf16_f32 v152, v104, v105
    v_exp_f32 v108, v108
    v_cvt_pk_bf16_f32 v153, v106, v107
    v_exp_f32 v109, v109
    v_mfma_f32_32x32x16_bf16 v[120:135], v[172:175], v[20:23], v[120:135]
    v_exp_f32 v110, v110
    v_exp_f32 v111, v111
    v_cvt_pk_bf16_f32 v154, v108, v109
    v_exp_f32 v112, v112
    v_cvt_pk_bf16_f32 v155, v110, v111
    v_exp_f32 v113, v113
    v_exp_f32 v114, v114
    v_mfma_f32_32x32x16_bf16 a[0:15], v[176:179], v[152:155], a[0:15]
    v_exp_f32 v115, v115
    v_cvt_pk_bf16_f32 v156, v112, v113
    v_exp_f32 v116, v116
    v_cvt_pk_bf16_f32 v157, v114, v115
    v_exp_f32 v117, v117
    v_exp_f32 v118, v118
    v_exp_f32 v119, v119
    v_cvt_pk_bf16_f32 v158, v116, v117
    v_cvt_pk_bf16_f32 v159, v118, v119
    v_exp_f32 v120, v120
    s_nop 0
    v_mfma_f32_32x32x16_bf16 a[0:15], v[180:183], v[156:159], a[0:15]
    v_exp_f32 v121, v121
    v_exp_f32 v122, v122
    v_exp_f32 v123, v123
    v_mfma_f32_32x32x16_bf16 v[104:119], v[168:171], v[24:27], v[72:87]
    v_cvt_pk_bf16_f32 v160, v120, v121
    v_exp_f32 v124, v124
    v_cvt_pk_bf16_f32 v161, v122, v123
    v_exp_f32 v125, v125
    v_mfma_f32_32x32x16_bf16 v[104:119], v[172:175], v[28:31], v[104:119]
    v_exp_f32 v126, v126
    v_exp_f32 v127, v127
    v_cvt_pk_bf16_f32 v162, v124, v125
    v_exp_f32 v128, v128
    v_cvt_pk_bf16_f32 v163, v126, v127
    v_exp_f32 v129, v129
    v_exp_f32 v130, v130
    v_mfma_f32_32x32x16_bf16 a[16:31], v[176:179], v[160:163], a[16:31]
    v_exp_f32 v131, v131
    v_cvt_pk_bf16_f32 v164, v128, v129
    v_exp_f32 v132, v132
    v_cvt_pk_bf16_f32 v165, v130, v131
    v_exp_f32 v133, v133
    v_exp_f32 v134, v134
    v_exp_f32 v135, v135
    v_cvt_pk_bf16_f32 v166, v132, v133
    v_cvt_pk_bf16_f32 v167, v134, v135
    v_exp_f32 v104, v104
    s_nop 0
    v_mfma_f32_32x32x16_bf16 a[16:31], v[180:183], v[164:167], a[16:31]
    v_exp_f32 v105, v105
    v_exp_f32 v106, v106
    v_exp_f32 v107, v107
    v_mfma_f32_32x32x16_bf16 v[120:135], v[168:171], v[32:35], v[88:103]
    v_cvt_pk_bf16_f32 v152, v104, v105
    v_exp_f32 v108, v108
    v_cvt_pk_bf16_f32 v153, v106, v107
    v_exp_f32 v109, v109
    v_mfma_f32_32x32x16_bf16 v[120:135], v[172:175], v[36:39], v[120:135]
    v_exp_f32 v110, v110
    v_exp_f32 v111, v111
    v_cvt_pk_bf16_f32 v154, v108, v109
    v_exp_f32 v112, v112
    v_cvt_pk_bf16_f32 v155, v110, v111
    v_exp_f32 v113, v113
    v_exp_f32 v114, v114
    v_mfma_f32_32x32x16_bf16 a[32:47], v[176:179], v[152:155], a[32:47]
    v_exp_f32 v115, v115
    v_cvt_pk_bf16_f32 v156, v112, v113
    v_exp_f32 v116, v116
    v_cvt_pk_bf16_f32 v157, v114, v115
    v_exp_f32 v117, v117
    v_exp_f32 v118, v118
    v_exp_f32 v119, v119
    v_cvt_pk_bf16_f32 v158, v116, v117
    v_cvt_pk_bf16_f32 v159, v118, v119
    v_exp_f32 v120, v120
    s_nop 0
    v_mfma_f32_32x32x16_bf16 a[32:47], v[180:183], v[156:159], a[32:47]
    v_exp_f32 v121, v121
    v_exp_f32 v122, v122
    v_exp_f32 v123, v123
    v_cvt_pk_bf16_f32 v160, v120, v121
    v_exp_f32 v124, v124
    v_cvt_pk_bf16_f32 v161, v122, v123
    v_exp_f32 v125, v125
    v_exp_f32 v126, v126
    v_exp_f32 v127, v127
    v_cvt_pk_bf16_f32 v162, v124, v125
    v_exp_f32 v128, v128
    v_cvt_pk_bf16_f32 v163, v126, v127
    v_exp_f32 v129, v129
    v_exp_f32 v130, v130
    v_mfma_f32_32x32x16_bf16 a[48:63], v[176:179], v[160:163], a[48:63]
    v_exp_f32 v131, v131
    v_cvt_pk_bf16_f32 v164, v128, v129
    v_exp_f32 v132, v132
    v_cvt_pk_bf16_f32 v165, v130, v131
    v_exp_f32 v133, v133
    v_exp_f32 v134, v134
    v_exp_f32 v135, v135
    v_cvt_pk_bf16_f32 v166, v132, v133
    v_cvt_pk_bf16_f32 v167, v134, v135
    s_nop 1
    v_mfma_f32_32x32x16_bf16 a[48:63], v[180:183], v[164:167], a[48:63]
    s_mov_b32 s53, 1317011456
    v_accvgpr_read_b32 v220, a8
    v_accvgpr_read_b32 v221, a24
    v_accvgpr_read_b32 v222, a40
    s_nop 7
    v_accvgpr_read_b32 v223, a56
    v_max3_f32 v224, v220, v221, v222
    v_add_f32 v220, v220, v221
    v_add_f32 v222, v222, v223
    v_max_f32 v224, v224, v223
    v_add_f32 v220, v220, v222
    v_cmp_ngt_f32 s[56:57], s53, v224
    v_cmp_u_f32 s[60:61], v220, v220
    s_nop 0
    s_or_b64 s[56:57], s[56:57], s[60:61]
    s_cbranch_scc0 L_t5_fine
    s_cmp_eq_u32 s52, 22
    s_cbranch_scc1 L_t5_fine
    s_mov_b32 s52, 22
    s_branch L_t5_again
L_t5_fine:
    v_lshrrev_b32 v220, 5, v0
    v_lshl_add_u32 v221, v220, 3, v2
    v_mov_b32 v222, 0x7ffffff0
    v_cndmask_b32 v222, v222, v2, vcc
    s_mul_i32 s39, s55, 1280
    s_add_u32 s39, s39, 88080384
    v_accvgpr_read_b32 v104, a0
    v_accvgpr_read_b32 v105, a1
    v_accvgpr_read_b32 v106, a2
    v_accvgpr_read_b32 v107, a3
    v_accvgpr_read_b32 v108, a4
    v_accvgpr_read_b32 v109, a5
    v_accvgpr_read_b32 v110, a6
    v_accvgpr_read_b32 v111, a7
    v_accvgpr_read_b32 v112, a8
    v_accvgpr_read_b32 v113, a9
    v_accvgpr_read_b32 v114, a10
    v_accvgpr_read_b32 v115, a11
    v_mov_b32 v223, v112
    v_mov_b32 v224, v112
    s_nop 1
    v_permlane32_swap_b32 v223, v224
    v_rcp_f32 v224, v224
    s_nop 0
    v_mul_f32 v104, v104, v224
    v_mul_f32 v105, v105, v224
    v_mul_f32 v106, v106, v224
    v_mul_f32 v107, v107, v224
    v_mul_f32 v108, v108, v224
    v_mul_f32 v109, v109, v224
    v_mul_f32 v110, v110, v224
    v_mul_f32 v111, v111, v224
    v_mul_f32 v112, v112, v224
    v_mul_f32 v113, v113, v224
    v_mul_f32 v114, v114, v224
    v_mul_f32 v115, v115, v224
    v_cvt_pk_bf16_f32 v152, v104, v105
    v_cvt_pk_bf16_f32 v153, v106, v107
    v_cvt_pk_bf16_f32 v154, v108, v109
    v_cvt_pk_bf16_f32 v155, v110, v111
    v_cvt_pk_bf16_f32 v156, v112, v113
    v_cvt_pk_bf16_f32 v157, v114, v115
    buffer_store_dwordx2 v[152:153], v221, s[4:7], s39 offen offset:0 sc1
    buffer_store_dwordx2 v[154:155], v221, s[4:7], s39 offen offset:16 sc1
    buffer_store_dwordx2 v[156:157], v222, s[4:7], s39 offen offset:32 sc1
    v_accvgpr_read_b32 v120, a16
    v_accvgpr_read_b32 v121, a17
    v_accvgpr_read_b32 v122, a18
    v_accvgpr_read_b32 v123, a19
    v_accvgpr_read_b32 v124, a20
    v_accvgpr_read_b32 v125, a21
    v_accvgpr_read_b32 v126, a22
    v_accvgpr_read_b32 v127, a23
    v_accvgpr_read_b32 v128, a24
    v_accvgpr_read_b32 v129, a25
    v_accvgpr_read_b32 v130, a26
    v_accvgpr_read_b32 v131, a27
    v_mov_b32 v223, v128
    v_mov_b32 v224, v128
    s_nop 1
    v_permlane32_swap_b32 v223, v224
    v_rcp_f32 v224, v224
    s_nop 0
    v_mul_f32 v120, v120, v224
    v_mul_f32 v121, v121, v224
    v_mul_f32 v122, v122, v224
    v_mul_f32 v123, v123, v224
    v_mul_f32 v124, v124, v224
    v_mul_f32 v125, v125, v224
    v_mul_f32 v126, v126, v224
    v_mul_f32 v127, v127, v224
    v_mul_f32 v128, v128, v224
    v_mul_f32 v129, v129, v224
    v_mul_f32 v130, v130, v224
    v_mul_f32 v131, v131, v224
    v_cvt_pk_bf16_f32 v160, v120, v121
    v_cvt_pk_bf16_f32 v161, v122, v123
    v_cvt_pk_bf16_f32 v162, v124, v125
    v_cvt_pk_bf16_f32 v163, v126, v127
    v_cvt_pk_bf16_f32 v164, v128, v129
    v_cvt_pk_bf16_f32 v165, v130, v131
    buffer_store_dwordx2 v[160:161], v221, s[4:7], s39 offen offset:1280 sc1
    buffer_store_dwordx2 v[162:163], v221, s[4:7], s39 offen offset:1296 sc1
    buffer_store_dwordx2 v[164:165], v222, s[4:7], s39 offen offset:1312 sc1
    v_accvgpr_read_b32 v104, a32
    v_accvgpr_read_b32 v105, a33
    v_accvgpr_read_b32 v106, a34
    v_accvgpr_read_b32 v107, a35
    v_accvgpr_read_b32 v108, a36
    v_accvgpr_read_b32 v109, a37
    v_accvgpr_read_b32 v110, a38
    v_accvgpr_read_b32 v111, a39
    v_accvgpr_read_b32 v112, a40
    v_accvgpr_read_b32 v113, a41
    v_accvgpr_read_b32 v114, a42
    v_accvgpr_read_b32 v115, a43
    v_mov_b32 v223, v112
    v_mov_b32 v224, v112
    s_nop 1
    v_permlane32_swap_b32 v223, v224
    v_rcp_f32 v224, v224
    s_nop 0
    v_mul_f32 v104, v104, v224
    v_mul_f32 v105, v105, v224
    v_mul_f32 v106, v106, v224
    v_mul_f32 v107, v107, v224
    v_mul_f32 v108, v108, v224
    v_mul_f32 v109, v109, v224
    v_mul_f32 v110, v110, v224
    v_mul_f32 v111, v111, v224
    v_mul_f32 v112, v112, v224
    v_mul_f32 v113, v113, v224
    v_mul_f32 v114, v114, v224
    v_mul_f32 v115, v115, v224
    v_cvt_pk_bf16_f32 v152, v104, v105
    v_cvt_pk_bf16_f32 v153, v106, v107
    v_cvt_pk_bf16_f32 v154, v108, v109
    v_cvt_pk_bf16_f32 v155, v110, v111
    v_cvt_pk_bf16_f32 v156, v112, v113
    v_cvt_pk_bf16_f32 v157, v114, v115
    buffer_store_dwordx2 v[152:153], v221, s[4:7], s39 offen offset:2560 sc1
    buffer_store_dwordx2 v[154:155], v221, s[4:7], s39 offen offset:2576 sc1
    buffer_store_dwordx2 v[156:157], v222, s[4:7], s39 offen offset:2592 sc1
    v_accvgpr_read_b32 v120, a48
    v_accvgpr_read_b32 v121, a49
    v_accvgpr_read_b32 v122, a50
    v_accvgpr_read_b32 v123, a51
    v_accvgpr_read_b32 v124, a52
    v_accvgpr_read_b32 v125, a53
    v_accvgpr_read_b32 v126, a54
    v_accvgpr_read_b32 v127, a55
    v_accvgpr_read_b32 v128, a56
    v_accvgpr_read_b32 v129, a57
    v_accvgpr_read_b32 v130, a58
    v_accvgpr_read_b32 v131, a59
    v_mov_b32 v223, v128
    v_mov_b32 v224, v128
    s_nop 1
    v_permlane32_swap_b32 v223, v224
    v_rcp_f32 v224, v224
    s_nop 0
    v_mul_f32 v120, v120, v224
    v_mul_f32 v121, v121, v224
    v_mul_f32 v122, v122, v224
    v_mul_f32 v123, v123, v224
    v_mul_f32 v124, v124, v224
    v_mul_f32 v125, v125, v224
    v_mul_f32 v126, v126, v224
    v_mul_f32 v127, v127, v224
    v_mul_f32 v128, v128, v224
    v_mul_f32 v129, v129, v224
    v_mul_f32 v130, v130, v224
    v_mul_f32 v131, v131, v224
    v_cvt_pk_bf16_f32 v160, v120, v121
    v_cvt_pk_bf16_f32 v161, v122, v123
    v_cvt_pk_bf16_f32 v162, v124, v125
    v_cvt_pk_bf16_f32 v163, v126, v127
    v_cvt_pk_bf16_f32 v164, v128, v129
    v_cvt_pk_bf16_f32 v165, v130, v131
    buffer_store_dwordx2 v[160:161], v221, s[4:7], s39 offen offset:3840 sc1
    buffer_store_dwordx2 v[162:163], v221, s[4:7], s39 offen offset:3856 sc1
    buffer_store_dwordx2 v[164:165], v222, s[4:7], s39 offen offset:3872 sc1
    s_lshr_b32 s51, s55, 8
    s_lshl_b32 s51, s51, 2
    s_waitcnt vmcnt(0)
    s_barrier
    s_cmp_lg_u32 s17, 0
    s_cbranch_scc1 L_sig_t5
    v_mov_b32 v251, 1
    s_mov_b64 exec, 1
    buffer_atomic_add v251, off, s[8:11], s51 offset:80
    s_mov_b64 exec, -1
L_sig_t5:
    s_cmp_ge_u32 s16, 26
    s_cbranch_scc1 L_taskAO
L_doT3:
    s_mov_b32 s59, s16
    s_add_u32 s58, s47, 1
    s_cmp_eq_u32 s47, 5
    s_cselect_b32 s58, 0, s58
    s_cmp_lt_u32 s16, 20
    s_cbranch_scc1 L_doT3b
    s_cmp_eq_u32 s47, 5
    s_cbranch_scc1 L_wend
    s_cmp_ge_u32 s16, 25
    s_cbranch_scc1 L_wend
    s_mul_i32 s59, s47, 5
    s_add_u32 s59, s59, s16
    s_sub_u32 s59, s59, 20
    s_mov_b32 s58, 5
L_doT3b:
    s_mov_b32 s20, s84
    s_mov_b32 s21, s85
    s_mov_b32 s22, 5242880
    s_mov_b32 s19, 0
L_prd3:
    buffer_load_dword v251, off, s[8:11], 0 offset:32 sc1
    s_add_u32 s19, s19, 1
    s_cmp_gt_u32 s19, 3000000
    s_cbranch_scc1 L_wend2
    s_waitcnt vmcnt(0)
    v_readfirstlane_b32 s39, v251
    s_nop 0
    s_cmp_eq_u32 s39, 64
    s_cbranch_scc1 L_prd3_ok
    s_sleep 16
    s_branch L_prd3
L_prd3_ok:
    v_lshlrev_b32 v1, 4, v0
    v_lshrrev_b32 v244, 2, v0
    v_mul_u32_u24 v244, 1280, v244
    v_and_b32 v245, 3, v0
    v_lshl_add_u32 v244, v245, 4, v244
    v_lshrrev_b32 v246, 4, v0
    v_bfe_u32 v247, v0, 2, 2
    v_lshl_add_u32 v2, v246, 3, v247
    v_lshlrev_b32 v2, 6, v2
    v_lshl_add_u32 v2, v245, 4, v2
    s_lshl_b32 s52, s17, 15
    v_add_u32 v2, s52, v2
    v_lshl_add_u32 v3, v247, 3, v245
    v_mul_u32_u24 v3, 2560, v3
    v_lshl_add_u32 v3, v246, 4, v3
    s_mul_i32 s51, s17, 1310720
    s_lshl_b32 s40, s59, 6
    s_add_u32 s51, s51, s40
    s_add_u32 m0, s52, 0
    s_add_u32 s51, s51, 0
    buffer_load_dwordx4 v244, s[20:23], s51 offen lds
    s_add_u32 m0, s52, 1024
    s_add_u32 s51, s51, 20480
    buffer_load_dwordx4 v244, s[20:23], s51 offen lds
    s_add_u32 m0, s52, 2048
    s_add_u32 s51, s51, 20480
    buffer_load_dwordx4 v244, s[20:23], s51 offen lds
    s_add_u32 m0, s52, 3072
    s_add_u32 s51, s51, 20480
    buffer_load_dwordx4 v244, s[20:23], s51 offen lds
    s_add_u32 m0, s52, 4096
    s_add_u32 s51, s51, 20480
    buffer_load_dwordx4 v244, s[20:23], s51 offen lds
    s_add_u32 m0, s52, 5120
    s_add_u32 s51, s51, 20480
    buffer_load_dwordx4 v244, s[20:23], s51 offen lds
    s_add_u32 m0, s52, 6144
    s_add_u32 s51, s51, 20480
    buffer_load_dwordx4 v244, s[20:23], s51 offen lds
    s_add_u32 m0, s52, 7168
    s_add_u32 s51, s51, 20480
    buffer_load_dwordx4 v244, s[20:23], s51 offen lds
    s_add_u32 m0, s52, 8192
    s_add_u32 s51, s51, 20480
    buffer_load_dwordx4 v244, s[20:23], s51 offen lds
    s_add_u32 m0, s52, 9216
    s_add_u32 s51, s51, 20480
    buffer_load_dwordx4 v244, s[20:23], s51 offen lds
    s_add_u32 m0, s52, 10240
    s_add_u32 s51, s51, 20480
    buffer_load_dwordx4 v244, s[20:23], s51 offen lds
    s_add_u32 m0, s52, 11264
    s_add_u32 s51, s51, 20480
    buffer_load_dwordx4 v244, s[20:23], s51 offen lds
    s_add_u32 m0, s52, 12288
    s_add_u32 s51, s51, 20480
    buffer_load_dwordx4 v244, s[20:23], s51 offen lds
    s_add_u32 m0, s52, 13312
    s_add_u32 s51, s51, 20480
    buffer_load_dwordx4 v244, s[20:23], s51 offen lds
    s_add_u32 m0, s52, 14336
    s_add_u32 s51, s51, 20480
    buffer_load_dwordx4 v244, s[20:23], s51 offen lds
    s_add_u32 m0, s52, 15360
    s_add_u32 s51, s51, 20480
    buffer_load_dwordx4 v244, s[20:23], s51 offen lds
    s_add_u32 m0, s52, 16384
    s_add_u32 s51, s51, 20480
    buffer_load_dwordx4 v244, s[20:23], s51 offen lds
    s_add_u32 m0, s52, 17408
    s_add_u32 s51, s51, 20480
    buffer_load_dwordx4 v244, s[20:23], s51 offen lds
    s_add_u32 m0, s52, 18432
    s_add_u32 s51, s51, 20480
    buffer_load_dwordx4 v244, s[20:23], s51 offen lds
    s_add_u32 m0, s52, 19456
    s_add_u32 s51, s51, 20480
    buffer_load_dwordx4 v244, s[20:23], s51 offen lds
    s_add_u32 m0, s52, 20480
    s_add_u32 s51, s51, 20480
    buffer_load_dwordx4 v244, s[20:23], s51 offen lds
    s_add_u32 m0, s52, 21504
    s_add_u32 s51, s51, 20480
    buffer_load_dwordx4 v244, s[20:23], s51 offen lds
    s_add_u32 m0, s52, 22528
    s_add_u32 s51, s51, 20480
    buffer_load_dwordx4 v244, s[20:23], s51 offen lds
    s_add_u32 m0, s52, 23552
    s_add_u32 s51, s51, 20480
    buffer_load_dwordx4 v244, s[20:23], s51 offen lds
    s_add_u32 m0, s52, 24576
    s_add_u32 s51, s51, 20480
    buffer_load_dwordx4 v244, s[20:23], s51 offen lds
    s_add_u32 m0, s52, 25600
    s_add_u32 s51, s51, 20480
    buffer_load_dwordx4 v244, s[20:23], s51 offen lds
    s_add_u32 m0, s52, 26624
    s_add_u32 s51, s51, 20480
    buffer_load_dwordx4 v244, s[20:23], s51 offen lds
    s_add_u32 m0, s52, 27648
    s_add_u32 s51, s51, 20480
    buffer_load_dwordx4 v244, s[20:23], s51 offen lds
    s_add_u32 m0, s52, 28672
    s_add_u32 s51, s51, 20480
    buffer_load_dwordx4 v244, s[20:23], s51 offen lds
    s_add_u32 m0, s52, 29696
    s_add_u32 s51, s51, 20480
    buffer_load_dwordx4 v244, s[20:23], s51 offen lds
    s_add_u32 m0, s52, 30720
    s_add_u32 s51, s51, 20480
    buffer_load_dwordx4 v244, s[20:23], s51 offen lds
    s_add_u32 m0, s52, 31744
    s_add_u32 s51, s51, 20480
    buffer_load_dwordx4 v244, s[20:23], s51 offen lds
    s_waitcnt vmcnt(30)
    ds_read_b64_tr_b16 a[0:1], v2 offset:0
    ds_read_b64_tr_b16 a[2:3], v2 offset:256
    ds_read_b64_tr_b16 a[4:5], v2 offset:8
    ds_read_b64_tr_b16 a[6:7], v2 offset:264
    s_waitcnt vmcnt(28)
    ds_read_b64_tr_b16 a[8:9], v2 offset:2048
    ds_read_b64_tr_b16 a[10:11], v2 offset:2304
    ds_read_b64_tr_b16 a[12:13], v2 offset:2056
    ds_read_b64_tr_b16 a[14:15], v2 offset:2312
    s_waitcnt vmcnt(26)
    ds_read_b64_tr_b16 a[16:17], v2 offset:4096
    ds_read_b64_tr_b16 a[18:19], v2 offset:4352
    ds_read_b64_tr_b16 a[20:21], v2 offset:4104
    ds_read_b64_tr_b16 a[22:23], v2 offset:4360
    s_waitcnt vmcnt(24)
    ds_read_b64_tr_b16 a[24:25], v2 offset:6144
    ds_read_b64_tr_b16 a[26:27], v2 offset:6400
    s_waitcnt lgkmcnt(10)
    ds_read_b64_tr_b16 a[28:29], v2 offset:6152
    ds_read_b64_tr_b16 a[30:31], v2 offset:6408
    s_waitcnt vmcnt(22)
    ds_read_b64_tr_b16 a[32:33], v2 offset:8192
    ds_read_b64_tr_b16 a[34:35], v2 offset:8448
    s_waitcnt lgkmcnt(10)
    ds_read_b64_tr_b16 a[36:37], v2 offset:8200
    ds_read_b64_tr_b16 a[38:39], v2 offset:8456
    s_waitcnt vmcnt(20)
    ds_read_b64_tr_b16 a[40:41], v2 offset:10240
    ds_read_b64_tr_b16 a[42:43], v2 offset:10496
    s_waitcnt lgkmcnt(10)
    ds_read_b64_tr_b16 a[44:45], v2 offset:10248
    ds_read_b64_tr_b16 a[46:47], v2 offset:10504
    s_waitcnt vmcnt(18)
    ds_read_b64_tr_b16 a[48:49], v2 offset:12288
    ds_read_b64_tr_b16 a[50:51], v2 offset:12544
    s_waitcnt lgkmcnt(10)
    ds_read_b64_tr_b16 a[52:53], v2 offset:12296
    ds_read_b64_tr_b16 a[54:55], v2 offset:12552
    s_waitcnt vmcnt(16)
    ds_read_b64_tr_b16 a[56:57], v2 offset:14336
    ds_read_b64_tr_b16 a[58:59], v2 offset:14592
    s_waitcnt lgkmcnt(10)
    ds_read_b64_tr_b16 a[60:61], v2 offset:14344
    ds_read_b64_tr_b16 a[62:63], v2 offset:14600
    s_waitcnt vmcnt(14)
    ds_read_b64_tr_b16 a[64:65], v2 offset:16384
    ds_read_b64_tr_b16 a[66:67], v2 offset:16640
    s_waitcnt lgkmcnt(10)
    ds_read_b64_tr_b16 a[68:69], v2 offset:16392
    ds_read_b64_tr_b16 a[70:71], v2 offset:16648
    s_waitcnt vmcnt(12)
    ds_read_b64_tr_b16 a[72:73], v2 offset:18432
    ds_read_b64_tr_b16 a[74:75], v2 offset:18688
    s_waitcnt lgkmcnt(10)
    ds_read_b64_tr_b16 a[76:77], v2 offset:18440
    ds_read_b64_tr_b16 a[78:79], v2 offset:18696
    s_waitcnt vmcnt(10)
    ds_read_b64_tr_b16 a[80:81], v2 offset:20480
    ds_read_b64_tr_b16 a[82:83], v2 offset:20736
    s_waitcnt lgkmcnt(10)
    ds_read_b64_tr_b16 a[84:85], v2 offset:20488
    ds_read_b64_tr_b16 a[86:87], v2 offset:20744
    s_waitcnt vmcnt(8)
    ds_read_b64_tr_b16 a[88:89], v2 offset:22528
    ds_read_b64_tr_b16 a[90:91], v2 offset:22784
    s_waitcnt lgkmcnt(10)
    ds_read_b64_tr_b16 a[92:93], v2 offset:22536
    ds_read_b64_tr_b16 a[94:95], v2 offset:22792
    s_waitcnt vmcnt(6)
    ds_read_b64_tr_b16 a[96:97], v2 offset:24576
    ds_read_b64_tr_b16 a[98:99], v2 offset:24832
    s_waitcnt lgkmcnt(10)
    ds_read_b64_tr_b16 a[100:101], v2 offset:24584
    ds_read_b64_tr_b16 a[102:103], v2 offset:24840
    s_waitcnt vmcnt(4)
    ds_read_b64_tr_b16 a[104:105], v2 offset:26624
    ds_read_b64_tr_b16 a[106:107], v2 offset:26880
    s_waitcnt lgkmcnt(10)
    ds_read_b64_tr_b16 a[108:109], v2 offset:26632
    ds_read_b64_tr_b16 a[110:111], v2 offset:26888
    s_waitcnt vmcnt(2)
    ds_read_b64_tr_b16 a[112:113], v2 offset:28672
    ds_read_b64_tr_b16 a[114:115], v2 offset:28928
    s_waitcnt lgkmcnt(10)
    ds_read_b64_tr_b16 a[116:117], v2 offset:28680
    ds_read_b64_tr_b16 a[118:119], v2 offset:28936
    s_waitcnt vmcnt(0)
    ds_read_b64_tr_b16 a[120:121], v2 offset:30720
    ds_read_b64_tr_b16 a[122:123], v2 offset:30976
    s_waitcnt lgkmcnt(10)
    ds_read_b64_tr_b16 a[124:125], v2 offset:30728
    ds_read_b64_tr_b16 a[126:127], v2 offset:30984
    s_waitcnt lgkmcnt(0)
    s_add_u32 m0, s52, 0
    s_add_u32 s51, s51, 20480
    buffer_load_dwordx4 v244, s[20:23], s51 offen lds
    s_add_u32 m0, s52, 1024
    s_add_u32 s51, s51, 20480
    buffer_load_dwordx4 v244, s[20:23], s51 offen lds
    s_add_u32 m0, s52, 2048
    s_add_u32 s51, s51, 20480
    buffer_load_dwordx4 v244, s[20:23], s51 offen lds
    s_add_u32 m0, s52, 3072
    s_add_u32 s51, s51, 20480
    buffer_load_dwordx4 v244, s[20:23], s51 offen lds
    s_add_u32 m0, s52, 4096
    s_add_u32 s51, s51, 20480
    buffer_load_dwordx4 v244, s[20:23], s51 offen lds
    s_add_u32 m0, s52, 5120
    s_add_u32 s51, s51, 20480
    buffer_load_dwordx4 v244, s[20:23], s51 offen lds
    s_add_u32 m0, s52, 6144
    s_add_u32 s51, s51, 20480
    buffer_load_dwordx4 v244, s[20:23], s51 offen lds
    s_add_u32 m0, s52, 7168
    s_add_u32 s51, s51, 20480
    buffer_load_dwordx4 v244, s[20:23], s51 offen lds
    s_add_u32 m0, s52, 8192
    s_add_u32 s51, s51, 20480
    buffer_load_dwordx4 v244, s[20:23], s51 offen lds
    s_add_u32 m0, s52, 9216
    s_add_u32 s51, s51, 20480
    buffer_load_dwordx4 v244, s[20:23], s51 offen lds
    s_add_u32 m0, s52, 10240
    s_add_u32 s51, s51, 20480
    buffer_load_dwordx4 v244, s[20:23], s51 offen lds
    s_add_u32 m0, s52, 11264
    s_add_u32 s51, s51, 20480
    buffer_load_dwordx4 v244, s[20:23], s51 offen lds
    s_add_u32 m0, s52, 12288
    s_add_u32 s51, s51, 20480
    buffer_load_dwordx4 v244, s[20:23], s51 offen lds
    s_add_u32 m0, s52, 13312
    s_add_u32 s51, s51, 20480
    buffer_load_dwordx4 v244, s[20:23], s51 offen lds
    s_add_u32 m0, s52, 14336
    s_add_u32 s51, s51, 20480
    buffer_load_dwordx4 v244, s[20:23], s51 offen lds
    s_add_u32 m0, s52, 15360
    s_add_u32 s51, s51, 20480
    buffer_load_dwordx4 v244, s[20:23], s51 offen lds
    s_add_u32 m0, s52, 16384
    s_add_u32 s51, s51, 20480
    buffer_load_dwordx4 v244, s[20:23], s51 offen lds
    s_add_u32 m0, s52, 17408
    s_add_u32 s51, s51, 20480
    buffer_load_dwordx4 v244, s[20:23], s51 offen lds
    s_add_u32 m0, s52, 18432
    s_add_u32 s51, s51, 20480
    buffer_load_dwordx4 v244, s[20:23], s51 offen lds
    s_add_u32 m0, s52, 19456
    s_add_u32 s51, s51, 20480
    buffer_load_dwordx4 v244, s[20:23], s51 offen lds
    s_add_u32 m0, s52, 20480
    s_add_u32 s51, s51, 20480
    buffer_load_dwordx4 v244, s[20:23], s51 offen lds
    s_add_u32 m0, s52, 21504
    s_add_u32 s51, s51, 20480
    buffer_load_dwordx4 v244, s[20:23], s51 offen lds
    s_add_u32 m0, s52, 22528
    s_add_u32 s51, s51, 20480
    buffer_load_dwordx4 v244, s[20:23], s51 offen lds
    s_add_u32 m0, s52, 23552
    s_add_u32 s51, s51, 20480
    buffer_load_dwordx4 v244, s[20:23], s51 offen lds
    s_add_u32 m0, s52, 24576
    s_add_u32 s51, s51, 20480
    buffer_load_dwordx4 v244, s[20:23], s51 offen lds
    s_add_u32 m0, s52, 25600
    s_add_u32 s51, s51, 20480
    buffer_load_dwordx4 v244, s[20:23], s51 offen lds
    s_add_u32 m0, s52, 26624
    s_add_u32 s51, s51, 20480
    buffer_load_dwordx4 v244, s[20:23], s51 offen lds
    s_add_u32 m0, s52, 27648
    s_add_u32 s51, s51, 20480
    buffer_load_dwordx4 v244, s[20:23], s51 offen lds
    s_add_u32 m0, s52, 28672
    s_add_u32 s51, s51, 20480
    buffer_load_dwordx4 v244, s[20:23], s51 offen lds
    s_add_u32 m0, s52, 29696
    s_add_u32 s51, s51, 20480
    buffer_load_dwordx4 v244, s[20:23], s51 offen lds
    s_add_u32 m0, s52, 30720
    s_add_u32 s51, s51, 20480
    buffer_load_dwordx4 v244, s[20:23], s51 offen lds
    s_add_u32 m0, s52, 31744
    s_add_u32 s51, s51, 20480
    buffer_load_dwordx4 v244, s[20:23], s51 offen lds
    s_waitcnt vmcnt(30)
    ds_read_b64_tr_b16 a[128:129], v2 offset:0
    ds_read_b64_tr_b16 a[130:131], v2 offset:256
    ds_read_b64_tr_b16 a[132:133], v2 offset:8
    ds_read_b64_tr_b16 a[134:135], v2 offset:264
    s_waitcnt vmcnt(28)
    ds_read_b64_tr_b16 a[136:137], v2 offset:2048
    ds_read_b64_tr_b16 a[138:139], v2 offset:2304
    ds_read_b64_tr_b16 a[140:141], v2 offset:2056
    ds_read_b64_tr_b16 a[142:143], v2 offset:2312
    s_waitcnt vmcnt(26)
    ds_read_b64_tr_b16 a[144:145], v2 offset:4096
    ds_read_b64_tr_b16 a[146:147], v2 offset:4352
    ds_read_b64_tr_b16 a[148:149], v2 offset:4104
    ds_read_b64_tr_b16 a[150:151], v2 offset:4360
    s_waitcnt vmcnt(24)
    ds_read_b64_tr_b16 a[152:153], v2 offset:6144
    ds_read_b64_tr_b16 a[154:155], v2 offset:6400
    s_waitcnt lgkmcnt(10)
    ds_read_b64_tr_b16 a[156:157], v2 offset:6152
    ds_read_b64_tr_b16 a[158:159], v2 offset:6408
    s_waitcnt vmcnt(22)
    ds_read_b64_tr_b16 a[160:161], v2 offset:8192
    ds_read_b64_tr_b16 a[162:163], v2 offset:8448
    s_waitcnt lgkmcnt(10)
    ds_read_b64_tr_b16 a[164:165], v2 offset:8200
    ds_read_b64_tr_b16 a[166:167], v2 offset:8456
    s_waitcnt vmcnt(20)
    ds_read_b64_tr_b16 a[168:169], v2 offset:10240
    ds_read_b64_tr_b16 a[170:171], v2 offset:10496
    s_waitcnt lgkmcnt(10)
    ds_read_b64_tr_b16 a[172:173], v2 offset:10248
    ds_read_b64_tr_b16 a[174:175], v2 offset:10504
    s_waitcnt vmcnt(18)
    ds_read_b64_tr_b16 a[176:177], v2 offset:12288
    ds_read_b64_tr_b16 a[178:179], v2 offset:12544
    s_waitcnt lgkmcnt(10)
    ds_read_b64_tr_b16 a[180:181], v2 offset:12296
    ds_read_b64_tr_b16 a[182:183], v2 offset:12552
    s_waitcnt vmcnt(16)
    ds_read_b64_tr_b16 a[184:185], v2 offset:14336
    ds_read_b64_tr_b16 a[186:187], v2 offset:14592
    s_waitcnt lgkmcnt(10)
    ds_read_b64_tr_b16 a[188:189], v2 offset:14344
    ds_read_b64_tr_b16 a[190:191], v2 offset:14600
    s_waitcnt vmcnt(14)
    ds_read_b64_tr_b16 a[192:193], v2 offset:16384
    ds_read_b64_tr_b16 a[194:195], v2 offset:16640
    s_waitcnt lgkmcnt(10)
    ds_read_b64_tr_b16 a[196:197], v2 offset:16392
    ds_read_b64_tr_b16 a[198:199], v2 offset:16648
    s_waitcnt vmcnt(12)
    ds_read_b64_tr_b16 a[200:201], v2 offset:18432
    ds_read_b64_tr_b16 a[202:203], v2 offset:18688
    s_waitcnt lgkmcnt(10)
    ds_read_b64_tr_b16 a[204:205], v2 offset:18440
    ds_read_b64_tr_b16 a[206:207], v2 offset:18696
    s_waitcnt vmcnt(10)
    ds_read_b64_tr_b16 a[208:209], v2 offset:20480
    ds_read_b64_tr_b16 a[210:211], v2 offset:20736
    s_waitcnt lgkmcnt(10)
    ds_read_b64_tr_b16 a[212:213], v2 offset:20488
    ds_read_b64_tr_b16 a[214:215], v2 offset:20744
    s_waitcnt vmcnt(8)
    ds_read_b64_tr_b16 a[216:217], v2 offset:22528
    ds_read_b64_tr_b16 a[218:219], v2 offset:22784
    s_waitcnt lgkmcnt(10)
    ds_read_b64_tr_b16 a[220:221], v2 offset:22536
    ds_read_b64_tr_b16 a[222:223], v2 offset:22792
    s_waitcnt vmcnt(6)
    ds_read_b64_tr_b16 a[224:225], v2 offset:24576
    ds_read_b64_tr_b16 a[226:227], v2 offset:24832
    s_waitcnt lgkmcnt(10)
    ds_read_b64_tr_b16 a[228:229], v2 offset:24584
    ds_read_b64_tr_b16 a[230:231], v2 offset:24840
    s_waitcnt vmcnt(4)
    ds_read_b64_tr_b16 a[232:233], v2 offset:26624
    ds_read_b64_tr_b16 a[234:235], v2 offset:26880
    s_waitcnt lgkmcnt(10)
    ds_read_b64_tr_b16 a[236:237], v2 offset:26632
    ds_read_b64_tr_b16 a[238:239], v2 offset:26888
    s_waitcnt vmcnt(2)
    ds_read_b64_tr_b16 a[240:241], v2 offset:28672
    ds_read_b64_tr_b16 a[242:243], v2 offset:28928
    s_waitcnt lgkmcnt(10)
    ds_read_b64_tr_b16 a[244:245], v2 offset:28680
    ds_read_b64_tr_b16 a[246:247], v2 offset:28936
    s_waitcnt vmcnt(0)
    ds_read_b64_tr_b16 a[248:249], v2 offset:30720
    ds_read_b64_tr_b16 a[250:251], v2 offset:30976
    s_waitcnt lgkmcnt(10)
    ds_read_b64_tr_b16 a[252:253], v2 offset:30728
    ds_read_b64_tr_b16 a[254:255], v2 offset:30984
    s_waitcnt lgkmcnt(0)
    s_add_u32 s50, s58, 18
    s_cmp_eq_u32 s58, 0
    s_cselect_b32 s50, 0, s50
    s_lshl_b32 s40, s17, 11
    v_add_u32 v2, s40, v1
    s_barrier
L_t3:
    s_lshl_b32 s51, s50, 17
    s_lshl_b32 s40, s17, 15
    s_add_u32 s51, s51, s40
    s_add_u32 s51, s51, 67108864
    s_cmp_lg_u32 s17, 0
    s_cbranch_scc1 L_t3_go
    s_lshr_b32 s40, s50, 1
    s_lshl_b32 s41, s40, 7
    s_add_u32 s41, s41, 532480
L_t3_p:
    buffer_load_dword v245, off, s[4:7], s41 offset:0 sc1
    s_add_u32 s19, s19, 1
    s_cmp_gt_u32 s19, 3000000
    s_cbranch_scc1 L_wend2
    s_waitcnt vmcnt(0)
    v_readfirstlane_b32 s39, v245
    s_nop 0
    s_cmp_eq_u32 s39, 32
    s_cbranch_scc1 L_t3_p_ok
    s_sleep 6
    s_branch L_t3_p
L_t3_p_ok:
L_t3_go:
    s_barrier
    buffer_load_dwordx4 v[8:11], v1, s[4:7], s51 offen offset:0 sc1
    buffer_load_dwordx4 v[12:15], v1, s[4:7], s51 offen offset:1024 sc1
    buffer_load_dwordx4 v[16:19], v1, s[4:7], s51 offen offset:2048 sc1
    buffer_load_dwordx4 v[20:23], v1, s[4:7], s51 offen offset:3072 sc1
    s_add_u32 s51, s51, 4096
    buffer_load_dwordx4 v[24:27], v1, s[4:7], s51 offen offset:0 sc1
    buffer_load_dwordx4 v[28:31], v1, s[4:7], s51 offen offset:1024 sc1
    buffer_load_dwordx4 v[32:35], v1, s[4:7], s51 offen offset:2048 sc1
    buffer_load_dwordx4 v[36:39], v1, s[4:7], s51 offen offset:3072 sc1
    s_add_u32 s51, s51, 4096
    buffer_load_dwordx4 v[40:43], v1, s[4:7], s51 offen offset:0 sc1
    buffer_load_dwordx4 v[44:47], v1, s[4:7], s51 offen offset:1024 sc1
    buffer_load_dwordx4 v[48:51], v1, s[4:7], s51 offen offset:2048 sc1
    buffer_load_dwordx4 v[52:55], v1, s[4:7], s51 offen offset:3072 sc1
    s_add_u32 s51, s51, 4096
    buffer_load_dwordx4 v[56:59], v1, s[4:7], s51 offen offset:0 sc1
    buffer_load_dwordx4 v[60:63], v1, s[4:7], s51 offen offset:1024 sc1
    buffer_load_dwordx4 v[64:67], v1, s[4:7], s51 offen offset:2048 sc1
    buffer_load_dwordx4 v[68:71], v1, s[4:7], s51 offen offset:3072 sc1
    s_add_u32 s51, s51, 4096
    buffer_load_dwordx4 v[72:75], v1, s[4:7], s51 offen offset:0 sc1
    buffer_load_dwordx4 v[76:79], v1, s[4:7], s51 offen offset:1024 sc1
    buffer_load_dwordx4 v[80:83], v1, s[4:7], s51 offen offset:2048 sc1
    buffer_load_dwordx4 v[84:87], v1, s[4:7], s51 offen offset:3072 sc1
    s_add_u32 s51, s51, 4096
    buffer_load_dwordx4 v[88:91], v1, s[4:7], s51 offen offset:0 sc1
    buffer_load_dwordx4 v[92:95], v1, s[4:7], s51 offen offset:1024 sc1
    buffer_load_dwordx4 v[96:99], v1, s[4:7], s51 offen offset:2048 sc1
    buffer_load_dwordx4 v[100:103], v1, s[4:7], s51 offen offset:3072 sc1
    s_add_u32 s51, s51, 4096
    buffer_load_dwordx4 v[104:107], v1, s[4:7], s51 offen offset:0 sc1
    buffer_load_dwordx4 v[108:111], v1, s[4:7], s51 offen offset:1024 sc1
    buffer_load_dwordx4 v[112:115], v1, s[4:7], s51 offen offset:2048 sc1
    buffer_load_dwordx4 v[116:119], v1, s[4:7], s51 offen offset:3072 sc1
    s_add_u32 s51, s51, 4096
    buffer_load_dwordx4 v[120:123], v1, s[4:7], s51 offen offset:0 sc1
    buffer_load_dwordx4 v[124:127], v1, s[4:7], s51 offen offset:1024 sc1
    buffer_load_dwordx4 v[128:131], v1, s[4:7], s51 offen offset:2048 sc1
    buffer_load_dwordx4 v[132:135], v1, s[4:7], s51 offen offset:3072 sc1
    s_waitcnt vmcnt(31)
    v_mfma_f32_16x16x32_bf16 v[136:139], a[0:3], v[8:11], 0
    v_mfma_f32_16x16x32_bf16 v[140:143], a[4:7], v[8:11], 0
    s_waitcnt vmcnt(30)
    v_mfma_f32_16x16x32_bf16 v[136:139], a[8:11], v[12:15], v[136:139]
    v_mfma_f32_16x16x32_bf16 v[140:143], a[12:15], v[12:15], v[140:143]
    s_waitcnt vmcnt(29)
    v_mfma_f32_16x16x32_bf16 v[136:139], a[16:19], v[16:19], v[136:139]
    v_mfma_f32_16x16x32_bf16 v[140:143], a[20:23], v[16:19], v[140:143]
    s_waitcnt vmcnt(28)
    v_mfma_f32_16x16x32_bf16 v[136:139], a[24:27], v[20:23], v[136:139]
    v_mfma_f32_16x16x32_bf16 v[140:143], a[28:31], v[20:23], v[140:143]
    s_waitcnt vmcnt(27)
    v_mfma_f32_16x16x32_bf16 v[136:139], a[32:35], v[24:27], v[136:139]
    v_mfma_f32_16x16x32_bf16 v[140:143], a[36:39], v[24:27], v[140:143]
    s_waitcnt vmcnt(26)
    v_mfma_f32_16x16x32_bf16 v[136:139], a[40:43], v[28:31], v[136:139]
    v_mfma_f32_16x16x32_bf16 v[140:143], a[44:47], v[28:31], v[140:143]
    s_waitcnt vmcnt(25)
    v_mfma_f32_16x16x32_bf16 v[136:139], a[48:51], v[32:35], v[136:139]
    v_mfma_f32_16x16x32_bf16 v[140:143], a[52:55], v[32:35], v[140:143]
    s_waitcnt vmcnt(24)
    v_mfma_f32_16x16x32_bf16 v[136:139], a[56:59], v[36:39], v[136:139]
    v_mfma_f32_16x16x32_bf16 v[140:143], a[60:63], v[36:39], v[140:143]
    s_waitcnt vmcnt(23)
    v_mfma_f32_16x16x32_bf16 v[136:139], a[64:67], v[40:43], v[136:139]
    v_mfma_f32_16x16x32_bf16 v[140:143], a[68:71], v[40:43], v[140:143]
    s_waitcnt vmcnt(22)
    v_mfma_f32_16x16x32_bf16 v[136:139], a[72:75], v[44:47], v[136:139]
    v_mfma_f32_16x16x32_bf16 v[140:143], a[76:79], v[44:47], v[140:143]
    s_waitcnt vmcnt(21)
    v_mfma_f32_16x16x32_bf16 v[136:139], a[80:83], v[48:51], v[136:139]
    v_mfma_f32_16x16x32_bf16 v[140:143], a[84:87], v[48:51], v[140:143]
    s_waitcnt vmcnt(20)
    v_mfma_f32_16x16x32_bf16 v[136:139], a[88:91], v[52:55], v[136:139]
    v_mfma_f32_16x16x32_bf16 v[140:143], a[92:95], v[52:55], v[140:143]
    s_waitcnt vmcnt(19)
    v_mfma_f32_16x16x32_bf16 v[136:139], a[96:99], v[56:59], v[136:139]
    v_mfma_f32_16x16x32_bf16 v[140:143], a[100:103], v[56:59], v[140:143]
    s_waitcnt vmcnt(18)
    v_mfma_f32_16x16x32_bf16 v[136:139], a[104:107], v[60:63], v[136:139]
    v_mfma_f32_16x16x32_bf16 v[140:143], a[108:111], v[60:63], v[140:143]
    s_waitcnt vmcnt(17)
    v_mfma_f32_16x16x32_bf16 v[136:139], a[112:115], v[64:67], v[136:139]
    v_mfma_f32_16x16x32_bf16 v[140:143], a[116:119], v[64:67], v[140:143]
    s_waitcnt vmcnt(16)
    v_mfma_f32_16x16x32_bf16 v[136:139], a[120:123], v[68:71], v[136:139]
    v_mfma_f32_16x16x32_bf16 v[140:143], a[124:127], v[68:71], v[140:143]
    s_waitcnt vmcnt(15)
    v_mfma_f32_16x16x32_bf16 v[136:139], a[128:131], v[72:75], v[136:139]
    v_mfma_f32_16x16x32_bf16 v[140:143], a[132:135], v[72:75], v[140:143]
    s_waitcnt vmcnt(14)
    v_mfma_f32_16x16x32_bf16 v[136:139], a[136:139], v[76:79], v[136:139]
    v_mfma_f32_16x16x32_bf16 v[140:143], a[140:143], v[76:79], v[140:143]
    s_waitcnt vmcnt(13)
    v_mfma_f32_16x16x32_bf16 v[136:139], a[144:147], v[80:83], v[136:139]
    v_mfma_f32_16x16x32_bf16 v[140:143], a[148:151], v[80:83], v[140:143]
    s_waitcnt vmcnt(12)
    v_mfma_f32_16x16x32_bf16 v[136:139], a[152:155], v[84:87], v[136:139]
    v_mfma_f32_16x16x32_bf16 v[140:143], a[156:159], v[84:87], v[140:143]
    s_waitcnt vmcnt(11)
    v_mfma_f32_16x16x32_bf16 v[136:139], a[160:163], v[88:91], v[136:139]
    v_mfma_f32_16x16x32_bf16 v[140:143], a[164:167], v[88:91], v[140:143]
    s_waitcnt vmcnt(10)
    v_mfma_f32_16x16x32_bf16 v[136:139], a[168:171], v[92:95], v[136:139]
    v_mfma_f32_16x16x32_bf16 v[140:143], a[172:175], v[92:95], v[140:143]
    s_waitcnt vmcnt(9)
    v_mfma_f32_16x16x32_bf16 v[136:139], a[176:179], v[96:99], v[136:139]
    v_mfma_f32_16x16x32_bf16 v[140:143], a[180:183], v[96:99], v[140:143]
    s_waitcnt vmcnt(8)
    v_mfma_f32_16x16x32_bf16 v[136:139], a[184:187], v[100:103], v[136:139]
    v_mfma_f32_16x16x32_bf16 v[140:143], a[188:191], v[100:103], v[140:143]
    s_waitcnt vmcnt(7)
    v_mfma_f32_16x16x32_bf16 v[136:139], a[192:195], v[104:107], v[136:139]
    v_mfma_f32_16x16x32_bf16 v[140:143], a[196:199], v[104:107], v[140:143]
    s_waitcnt vmcnt(6)
    v_mfma_f32_16x16x32_bf16 v[136:139], a[200:203], v[108:111], v[136:139]
    v_mfma_f32_16x16x32_bf16 v[140:143], a[204:207], v[108:111], v[140:143]
    s_waitcnt vmcnt(5)
    v_mfma_f32_16x16x32_bf16 v[136:139], a[208:211], v[112:115], v[136:139]
    v_mfma_f32_16x16x32_bf16 v[140:143], a[212:215], v[112:115], v[140:143]
    s_waitcnt vmcnt(4)
    v_mfma_f32_16x16x32_bf16 v[136:139], a[216:219], v[116:119], v[136:139]
    v_mfma_f32_16x16x32_bf16 v[140:143], a[220:223], v[116:119], v[140:143]
    s_waitcnt vmcnt(3)
    v_mfma_f32_16x16x32_bf16 v[136:139], a[224:227], v[120:123], v[136:139]
    v_mfma_f32_16x16x32_bf16 v[140:143], a[228:231], v[120:123], v[140:143]
    s_waitcnt vmcnt(2)
    v_mfma_f32_16x16x32_bf16 v[136:139], a[232:235], v[124:127], v[136:139]
    v_mfma_f32_16x16x32_bf16 v[140:143], a[236:239], v[124:127], v[140:143]
    s_waitcnt vmcnt(1)
    v_mfma_f32_16x16x32_bf16 v[136:139], a[240:243], v[128:131], v[136:139]
    v_mfma_f32_16x16x32_bf16 v[140:143], a[244:247], v[128:131], v[140:143]
    s_waitcnt vmcnt(0)
    v_mfma_f32_16x16x32_bf16 v[136:139], a[248:251], v[132:135], v[136:139]
    v_mfma_f32_16x16x32_bf16 v[140:143], a[252:255], v[132:135], v[140:143]
    s_nop 3
    ds_write_b128 v2, v[136:139]
    s_nop 2
    ds_write_b128 v2, v[140:143] offset:1024
    s_waitcnt lgkmcnt(0)
    s_barrier
    s_cmp_lg_u32 s17, 0
    s_cbranch_scc1 L_t3_next
    ds_read_b128 v[144:147], v1 offset:2048
    ds_read_b128 v[148:151], v1 offset:3072
    ds_read_b128 v[152:155], v1 offset:4096
    ds_read_b128 v[156:159], v1 offset:5120
    ds_read_b128 v[160:163], v1 offset:6144
    ds_read_b128 v[164:167], v1 offset:7168
    s_lshr_b32 s40, s50, 1
    s_lshl_b32 s40, s40, 5
    s_and_b32 s41, s50, 1
    s_lshl_b32 s41, s41, 2
    s_add_u32 s40, s40, s41
    s_mul_i32 s53, s40, 2560
    s_lshl_b32 s40, s59, 6
    s_add_u32 s53, s53, s40
    s_waitcnt lgkmcnt(5)
    v_add_f32 v136, v136, v144
    v_add_f32 v137, v137, v145
    v_add_f32 v138, v138, v146
    v_add_f32 v139, v139, v147
    s_waitcnt lgkmcnt(4)
    v_add_f32 v140, v140, v148
    v_add_f32 v141, v141, v149
    v_add_f32 v142, v142, v150
    v_add_f32 v143, v143, v151
    s_waitcnt lgkmcnt(3)
    v_add_f32 v136, v136, v152
    v_add_f32 v137, v137, v153
    v_add_f32 v138, v138, v154
    v_add_f32 v139, v139, v155
    s_waitcnt lgkmcnt(2)
    v_add_f32 v140, v140, v156
    v_add_f32 v141, v141, v157
    v_add_f32 v142, v142, v158
    v_add_f32 v143, v143, v159
    s_waitcnt lgkmcnt(1)
    v_add_f32 v136, v136, v160
    v_add_f32 v137, v137, v161
    v_add_f32 v138, v138, v162
    v_add_f32 v139, v139, v163
    s_waitcnt lgkmcnt(0)
    v_add_f32 v140, v140, v164
    v_add_f32 v141, v141, v165
    v_add_f32 v142, v142, v166
    v_add_f32 v143, v143, v167
    v_cvt_pk_bf16_f32 v144, v136, v137
    v_cvt_pk_bf16_f32 v145, v138, v139
    v_cvt_pk_bf16_f32 v146, v140, v141
    v_cvt_pk_bf16_f32 v147, v142, v143
    buffer_store_dwordx4 v[144:147], v3, s[28:31], s53 offen offset:1280
    s_waitcnt lgkmcnt(0)
L_t3_next:
    s_cmp_lt_u32 s50, 18
    s_cselect_b32 s40, 1, 6
    s_add_u32 s50, s50, s40
    s_cmp_lt_u32 s50, 128
    s_cbranch_scc1 L_t3
    s_waitcnt vmcnt(0)
L_wend:
    s_waitcnt vmcnt(0)
    s_endpgm
L_doT2:
    s_mov_b32 s19, 0
L_prd2:
    buffer_load_dword v251, off, s[8:11], 0 offset:32 sc1
    s_add_u32 s19, s19, 1
    s_cmp_gt_u32 s19, 3000000
    s_cbranch_scc1 L_wend2
    s_waitcnt vmcnt(0)
    v_readfirstlane_b32 s39, v251
    s_nop 0
    s_cmp_eq_u32 s39, 64
    s_cbranch_scc1 L_prd2_ok
    s_sleep 16
    s_branch L_prd2
L_prd2_ok:
    v_lshlrev_b32 v1, 4, v0
    v_bfe_u32 v244, v0, 1, 1
    v_xor_b32 v244, 1, v244
    v_mul_u32_u24 v244, 40, v244
    v_add_u32 v2, v1, v244
    v_bfe_u32 v244, v0, 2, 2
    v_lshrrev_b32 v245, 4, v0
    v_sub_u32 v244, v244, v245
    v_lshlrev_b32 v244, 3, v244
    v_and_b32 v245, 3, v0
    v_add_u32 v244, v244, v245
    v_cmp_le_i32 s[60:61], -4, v244
    v_cmp_le_i32 s[62:63], -3, v244
    v_cmp_le_i32 s[64:65], -2, v244
    v_cmp_le_i32 s[66:67], -1, v244
    v_cmp_le_i32 s[68:69], 0, v244
    v_cmp_le_i32 s[70:71], 1, v244
    v_cmp_le_i32 s[72:73], 2, v244
    v_cmp_le_i32 s[74:75], 3, v244
    v_cmp_le_i32 s[76:77], 4, v244
    v_cmp_le_i32 s[78:79], 5, v244
    v_cmp_le_i32 s[80:81], 6, v244
    v_cmp_le_i32 s[82:83], 7, v244
    v_mov_b32 v168, 0x3f803f80
    v_mov_b32 v169, 0x3f803f80
    v_mov_b32 v170, 0x3f803f80
    v_mov_b32 v171, 0x3f803f80
    v_mov_b32 v161, 0
    v_mov_b32 v162, 0
    v_mov_b32 v165, 0
    v_mov_b32 v166, 0
    s_mov_b32 s55, 1040356334
    v_mov_b32 v247, 3492320863
    s_mov_b32 s50, s17
    s_and_b32 s57, s16, 3
    s_lshl_b32 s57, s57, 3
L_t2:
    s_lshl_b32 s40, s50, 5
    s_add_u32 s40, s40, s16
    s_lshl_b32 s51, s40, 13
    s_add_u32 s51, s51, 50331648
    s_lshl_b32 s52, s40, 14
    s_add_u32 s52, s52, 13631488
    s_lshl_b32 s53, s40, 12
    s_add_u32 s53, s53, 4325376
    s_lshl_b32 s54, s50, 18
    s_lshl_b32 s40, s16, 12
    s_add_u32 s54, s54, s40
    s_add_u32 s54, s54, 67108864
    s_lshr_b32 s41, s50, 3
    s_lshl_b32 s41, s41, 2
L_t2_pk:
    buffer_load_dword v245, off, s[8:11], s41 offset:40 sc1
    s_add_u32 s19, s19, 1
    s_cmp_gt_u32 s19, 3000000
    s_cbranch_scc1 L_wend2
    s_waitcnt vmcnt(0)
    v_readfirstlane_b32 s39, v245
    s_nop 0
    s_cmp_eq_u32 s39, 0x100020
    s_cbranch_scc1 L_t2_pk_ok
    s_sleep 16
    s_branch L_t2_pk
L_t2_pk_ok:
    buffer_load_dwordx4 v[8:11], v1, s[4:7], s51 offen offset:0 sc1
    buffer_load_dwordx4 v[12:15], v1, s[4:7], s51 offen offset:1024 sc1
    buffer_load_dwordx4 v[40:43], v1, s[4:7], s52 offen offset:0 sc1
    buffer_load_dwordx4 v[44:47], v1, s[4:7], s52 offen offset:1024 sc1
    buffer_load_dwordx4 v[72:75], v1, s[4:7], s52 offen offset:2048 sc1
    buffer_load_dwordx4 v[76:79], v1, s[4:7], s52 offen offset:3072 sc1
    s_add_u32 s52, s52, 4096
    buffer_load_dwordx4 v[16:19], v1, s[4:7], s51 offen offset:2048 sc1
    buffer_load_dwordx4 v[20:23], v1, s[4:7], s51 offen offset:3072 sc1
    buffer_load_dwordx4 v[48:51], v1, s[4:7], s52 offen offset:0 sc1
    buffer_load_dwordx4 v[52:55], v1, s[4:7], s52 offen offset:1024 sc1
    buffer_load_dwordx4 v[80:83], v1, s[4:7], s52 offen offset:2048 sc1
    buffer_load_dwordx4 v[84:87], v1, s[4:7], s52 offen offset:3072 sc1
    s_add_u32 s52, s52, 4096
    s_add_u32 s51, s51, 4096
    buffer_load_dwordx4 v[24:27], v1, s[4:7], s51 offen offset:0 sc1
    buffer_load_dwordx4 v[28:31], v1, s[4:7], s51 offen offset:1024 sc1
    buffer_load_dwordx4 v[56:59], v1, s[4:7], s52 offen offset:0 sc1
    buffer_load_dwordx4 v[60:63], v1, s[4:7], s52 offen offset:1024 sc1
    buffer_load_dwordx4 v[88:91], v1, s[4:7], s52 offen offset:2048 sc1
    buffer_load_dwordx4 v[92:95], v1, s[4:7], s52 offen offset:3072 sc1
    s_add_u32 s52, s52, 4096
    buffer_load_dwordx4 v[32:35], v1, s[4:7], s51 offen offset:2048 sc1
    buffer_load_dwordx4 v[36:39], v1, s[4:7], s51 offen offset:3072 sc1
    buffer_load_dwordx4 v[64:67], v1, s[4:7], s52 offen offset:0 sc1
    buffer_load_dwordx4 v[68:71], v1, s[4:7], s52 offen offset:1024 sc1
    buffer_load_dwordx4 v[96:99], v1, s[4:7], s52 offen offset:2048 sc1
    buffer_load_dwordx4 v[100:103], v1, s[4:7], s52 offen offset:3072 sc1
    s_add_u32 s52, s52, 4096
    s_waitcnt vmcnt(21)
    v_mfma_f32_16x16x32_bf16 v[128:131], v[40:43], v[8:11], 0
    s_waitcnt vmcnt(20)
    v_mfma_f32_16x16x32_bf16 v[132:135], v[44:47], v[8:11], 0
    v_mfma_f32_16x16x32_bf16 v[140:143], v[40:43], v[12:15], 0
    v_mfma_f32_16x16x32_bf16 v[144:147], v[44:47], v[12:15], 0
    s_waitcnt vmcnt(15)
    v_mfma_f32_16x16x32_bf16 v[128:131], v[48:51], v[16:19], v[128:131]
    s_waitcnt vmcnt(14)
    v_mfma_f32_16x16x32_bf16 v[132:135], v[52:55], v[16:19], v[132:135]
    v_mfma_f32_16x16x32_bf16 v[140:143], v[48:51], v[20:23], v[140:143]
    v_mfma_f32_16x16x32_bf16 v[144:147], v[52:55], v[20:23], v[144:147]
    s_waitcnt vmcnt(9)
    v_mfma_f32_16x16x32_bf16 v[128:131], v[56:59], v[24:27], v[128:131]
    s_waitcnt vmcnt(8)
    v_mfma_f32_16x16x32_bf16 v[132:135], v[60:63], v[24:27], v[132:135]
    v_mfma_f32_16x16x32_bf16 v[140:143], v[56:59], v[28:31], v[140:143]
    v_mfma_f32_16x16x32_bf16 v[144:147], v[60:63], v[28:31], v[144:147]
    s_waitcnt vmcnt(3)
    v_mfma_f32_16x16x32_bf16 v[128:131], v[64:67], v[32:35], v[128:131]
    s_waitcnt vmcnt(2)
    v_mfma_f32_16x16x32_bf16 v[132:135], v[68:71], v[32:35], v[132:135]
    v_mfma_f32_16x16x32_bf16 v[140:143], v[64:67], v[36:39], v[140:143]
    v_mfma_f32_16x16x32_bf16 v[144:147], v[68:71], v[36:39], v[144:147]
    s_lshl_b32 s41, s16, 7
    s_add_u32 s41, s41, 524288
L_t2_pc:
    buffer_load_dword v245, off, s[4:7], s41 offset:0 sc1
    s_add_u32 s19, s19, 1
    s_cmp_gt_u32 s19, 3000000
    s_cbranch_scc1 L_wend2
    s_waitcnt vmcnt(0)
    v_readfirstlane_b32 s39, v245
    s_nop 0
    s_cmp_gt_u32 s39, s50
    s_cbranch_scc1 L_t2_pc_ok
    s_sleep 6
    s_branch L_t2_pc
L_t2_pc_ok:
    buffer_load_dwordx4 v[104:107], v1, s[4:7], s53 offen offset:0 sc1
    buffer_load_dwordx4 v[108:111], v1, s[4:7], s53 offen offset:1024 sc1
    buffer_load_dwordx4 v[112:115], v1, s[4:7], s53 offen offset:2048 sc1
    buffer_load_dwordx4 v[116:119], v1, s[4:7], s53 offen offset:3072 sc1
    buffer_load_dwordx2 v[120:121], v2, s[4:7], s53 offen offset:0 sc1
    buffer_load_dwordx2 v[122:123], v2, s[4:7], s53 offen offset:1024 sc1
    buffer_load_dwordx2 v[124:125], v2, s[4:7], s53 offen offset:2048 sc1
    buffer_load_dwordx2 v[126:127], v2, s[4:7], s53 offen offset:3072 sc1
    v_cndmask_b32 v128, v247, v128, s[68:69]
    v_cndmask_b32 v129, v247, v129, s[70:71]
    v_cndmask_b32 v130, v247, v130, s[72:73]
    v_cndmask_b32 v131, v247, v131, s[74:75]
    v_cndmask_b32 v132, v247, v132, s[76:77]
    v_cndmask_b32 v133, v247, v133, s[78:79]
    v_cndmask_b32 v134, v247, v134, s[80:81]
    v_cndmask_b32 v135, v247, v135, s[82:83]
    v_cndmask_b32 v140, v247, v140, s[60:61]
    v_cndmask_b32 v141, v247, v141, s[62:63]
    v_cndmask_b32 v142, v247, v142, s[64:65]
    v_cndmask_b32 v143, v247, v143, s[66:67]
    v_cndmask_b32 v144, v247, v144, s[68:69]
    v_cndmask_b32 v145, v247, v145, s[70:71]
    v_cndmask_b32 v146, v247, v146, s[72:73]
    v_cndmask_b32 v147, v247, v147, s[74:75]
    s_waitcnt vmcnt(7)
    v_mfma_f32_16x16x32_bf16 v[136:139], v[104:107], v[8:11], 0
    v_mfma_f32_16x16x32_bf16 v[148:151], v[104:107], v[12:15], 0
    s_waitcnt vmcnt(6)
    v_mfma_f32_16x16x32_bf16 v[136:139], v[108:111], v[16:19], v[136:139]
    v_mfma_f32_16x16x32_bf16 v[148:151], v[108:111], v[20:23], v[148:151]
    s_waitcnt vmcnt(5)
    v_mfma_f32_16x16x32_bf16 v[136:139], v[112:115], v[24:27], v[136:139]
    v_mfma_f32_16x16x32_bf16 v[148:151], v[112:115], v[28:31], v[148:151]
    s_waitcnt vmcnt(4)
    v_mfma_f32_16x16x32_bf16 v[136:139], v[116:119], v[32:35], v[136:139]
    v_mfma_f32_16x16x32_bf16 v[148:151], v[116:119], v[36:39], v[148:151]
    v_max3_f32 v244, v128, v129, v130
    v_max3_f32 v244, v244, v131, v132
    v_max3_f32 v244, v244, v133, v134
    v_max3_f32 v244, v244, v135, v136
    v_max_f32 v245, v244, v137
    v_max_f32 v244, v244, v137
    s_nop 1
    v_permlane16_swap_b32 v244, v245
    v_max_f32 v246, v244, v245
    v_max_f32 v244, v244, v245
    s_nop 1
    v_permlane32_swap_b32 v244, v246
    v_max_f32 v244, v244, v246
    v_mul_f32 v244, s55, v244
    v_fma_f32 v128, v128, s55, -v244
    v_fma_f32 v129, v129, s55, -v244
    v_fma_f32 v130, v130, s55, -v244
    v_fma_f32 v131, v131, s55, -v244
    v_fma_f32 v132, v132, s55, -v244
    v_fma_f32 v133, v133, s55, -v244
    v_fma_f32 v134, v134, s55, -v244
    v_fma_f32 v135, v135, s55, -v244
    v_fma_f32 v136, v136, s55, -v244
    v_fma_f32 v137, v137, s55, -v244
    v_exp_f32 v128, v128
    v_exp_f32 v129, v129
    v_exp_f32 v130, v130
    v_exp_f32 v131, v131
    v_exp_f32 v132, v132
    v_exp_f32 v133, v133
    v_exp_f32 v134, v134
    v_exp_f32 v135, v135
    v_exp_f32 v136, v136
    v_exp_f32 v137, v137
    v_cvt_pk_bf16_f32 v152, v128, v129
    v_cvt_pk_bf16_f32 v153, v130, v131
    v_cvt_pk_bf16_f32 v154, v132, v133
    v_cvt_pk_bf16_f32 v155, v134, v135
    v_cvt_pk_bf16_f32 v160, v136, v137
    v_cvt_pk_bf16_f32 v163, v136, v137
    v_max3_f32 v244, v140, v141, v142
    v_max3_f32 v244, v244, v143, v144
    v_max3_f32 v244, v244, v145, v146
    v_max3_f32 v244, v244, v147, v148
    v_max_f32 v245, v244, v149
    v_max_f32 v244, v244, v149
    s_nop 1
    v_permlane16_swap_b32 v244, v245
    v_max_f32 v246, v244, v245
    v_max_f32 v244, v244, v245
    s_nop 1
    v_permlane32_swap_b32 v244, v246
    v_max_f32 v244, v244, v246
    v_mul_f32 v244, s55, v244
    v_fma_f32 v140, v140, s55, -v244
    v_fma_f32 v141, v141, s55, -v244
    v_fma_f32 v142, v142, s55, -v244
    v_fma_f32 v143, v143, s55, -v244
    v_fma_f32 v144, v144, s55, -v244
    v_fma_f32 v145, v145, s55, -v244
    v_fma_f32 v146, v146, s55, -v244
    v_fma_f32 v147, v147, s55, -v244
    v_fma_f32 v148, v148, s55, -v244
    v_fma_f32 v149, v149, s55, -v244
    v_exp_f32 v140, v140
    v_exp_f32 v141, v141
    v_exp_f32 v142, v142
    v_exp_f32 v143, v143
    v_exp_f32 v144, v144
    v_exp_f32 v145, v145
    v_exp_f32 v146, v146
    v_exp_f32 v147, v147
    v_exp_f32 v148, v148
    v_exp_f32 v149, v149
    v_cvt_pk_bf16_f32 v156, v140, v141
    v_cvt_pk_bf16_f32 v157, v142, v143
    v_cvt_pk_bf16_f32 v158, v144, v145
    v_cvt_pk_bf16_f32 v159, v146, v147
    v_cvt_pk_bf16_f32 v164, v148, v149
    v_cvt_pk_bf16_f32 v167, v148, v149
    v_mfma_f32_16x16x16_bf16 v[172:175], v[168:169], v[160:161], 0
    v_mfma_f32_16x16x16_bf16 v[176:179], v[168:169], v[164:165], 0
    s_waitcnt vmcnt(3)
    v_mfma_f32_16x16x16_bf16 v[180:183], v[120:121], v[160:161], 0
    v_mfma_f32_16x16x16_bf16 v[184:187], v[120:121], v[162:163], 0
    s_waitcnt vmcnt(2)
    v_mfma_f32_16x16x16_bf16 v[188:191], v[122:123], v[160:161], 0
    v_mfma_f32_16x16x16_bf16 v[192:195], v[122:123], v[162:163], 0
    s_waitcnt vmcnt(1)
    v_mfma_f32_16x16x16_bf16 v[196:199], v[124:125], v[160:161], 0
    v_mfma_f32_16x16x16_bf16 v[200:203], v[124:125], v[162:163], 0
    s_waitcnt vmcnt(0)
    v_mfma_f32_16x16x16_bf16 v[204:207], v[126:127], v[160:161], 0
    v_mfma_f32_16x16x16_bf16 v[208:211], v[126:127], v[162:163], 0
    v_mfma_f32_16x16x16_bf16 v[212:215], v[120:121], v[164:165], 0
    v_mfma_f32_16x16x16_bf16 v[216:219], v[120:121], v[166:167], 0
    v_mfma_f32_16x16x16_bf16 v[220:223], v[122:123], v[164:165], 0
    v_mfma_f32_16x16x16_bf16 v[224:227], v[122:123], v[166:167], 0
    v_mfma_f32_16x16x16_bf16 v[228:231], v[124:125], v[164:165], 0
    v_mfma_f32_16x16x16_bf16 v[232:235], v[124:125], v[166:167], 0
    v_mfma_f32_16x16x16_bf16 v[236:239], v[126:127], v[164:165], 0
    v_mfma_f32_16x16x16_bf16 v[240:243], v[126:127], v[166:167], 0
    v_mfma_f32_16x16x32_bf16 v[172:175], v[168:171], v[152:155], v[172:175]
    v_mfma_f32_16x16x32_bf16 v[176:179], v[168:171], v[156:159], v[176:179]
    v_mfma_f32_16x16x32_bf16 v[180:183], v[72:75], v[152:155], v[180:183]
    v_mfma_f32_16x16x32_bf16 v[184:187], v[76:79], v[152:155], v[184:187]
    v_mfma_f32_16x16x32_bf16 v[188:191], v[80:83], v[152:155], v[188:191]
    v_mfma_f32_16x16x32_bf16 v[192:195], v[84:87], v[152:155], v[192:195]
    v_mfma_f32_16x16x32_bf16 v[196:199], v[88:91], v[152:155], v[196:199]
    v_mfma_f32_16x16x32_bf16 v[200:203], v[92:95], v[152:155], v[200:203]
    v_mfma_f32_16x16x32_bf16 v[204:207], v[96:99], v[152:155], v[204:207]
    v_mfma_f32_16x16x32_bf16 v[208:211], v[100:103], v[152:155], v[208:211]
    v_mfma_f32_16x16x32_bf16 v[212:215], v[72:75], v[156:159], v[212:215]
    v_mfma_f32_16x16x32_bf16 v[216:219], v[76:79], v[156:159], v[216:219]
    v_mfma_f32_16x16x32_bf16 v[220:223], v[80:83], v[156:159], v[220:223]
    v_mfma_f32_16x16x32_bf16 v[224:227], v[84:87], v[156:159], v[224:227]
    v_mfma_f32_16x16x32_bf16 v[228:231], v[88:91], v[156:159], v[228:231]
    v_mfma_f32_16x16x32_bf16 v[232:235], v[92:95], v[156:159], v[232:235]
    v_mfma_f32_16x16x32_bf16 v[236:239], v[96:99], v[156:159], v[236:239]
    v_mfma_f32_16x16x32_bf16 v[240:243], v[100:103], v[156:159], v[240:243]
    v_rcp_f32 v244, v172
    v_rcp_f32 v245, v176
    v_mul_f32 v180, v180, v244
    v_mul_f32 v181, v181, v244
    v_mul_f32 v182, v182, v244
    v_mul_f32 v183, v183, v244
    v_mul_f32 v184, v184, v244
    v_mul_f32 v185, v185, v244
    v_mul_f32 v186, v186, v244
    v_mul_f32 v187, v187, v244
    v_cvt_pk_bf16_f32 v128, v180, v184
    v_cvt_pk_bf16_f32 v129, v181, v185
    v_cvt_pk_bf16_f32 v130, v182, v186
    v_cvt_pk_bf16_f32 v131, v183, v187
    buffer_store_dwordx4 v[128:131], v1, s[4:7], s54 offen offset:0 sc1
    v_mul_f32 v188, v188, v244
    v_mul_f32 v189, v189, v244
    v_mul_f32 v190, v190, v244
    v_mul_f32 v191, v191, v244
    v_mul_f32 v192, v192, v244
    v_mul_f32 v193, v193, v244
    v_mul_f32 v194, v194, v244
    v_mul_f32 v195, v195, v244
    v_cvt_pk_bf16_f32 v132, v188, v192
    v_cvt_pk_bf16_f32 v133, v189, v193
    v_cvt_pk_bf16_f32 v134, v190, v194
    v_cvt_pk_bf16_f32 v135, v191, v195
    buffer_store_dwordx4 v[132:135], v1, s[4:7], s54 offen offset:1024 sc1
    v_mul_f32 v196, v196, v244
    v_mul_f32 v197, v197, v244
    v_mul_f32 v198, v198, v244
    v_mul_f32 v199, v199, v244
    v_mul_f32 v200, v200, v244
    v_mul_f32 v201, v201, v244
    v_mul_f32 v202, v202, v244
    v_mul_f32 v203, v203, v244
    v_cvt_pk_bf16_f32 v136, v196, v200
    v_cvt_pk_bf16_f32 v137, v197, v201
    v_cvt_pk_bf16_f32 v138, v198, v202
    v_cvt_pk_bf16_f32 v139, v199, v203
    buffer_store_dwordx4 v[136:139], v1, s[4:7], s54 offen offset:2048 sc1
    v_mul_f32 v204, v204, v244
    v_mul_f32 v205, v205, v244
    v_mul_f32 v206, v206, v244
    v_mul_f32 v207, v207, v244
    v_mul_f32 v208, v208, v244
    v_mul_f32 v209, v209, v244
    v_mul_f32 v210, v210, v244
    v_mul_f32 v211, v211, v244
    v_cvt_pk_bf16_f32 v140, v204, v208
    v_cvt_pk_bf16_f32 v141, v205, v209
    v_cvt_pk_bf16_f32 v142, v206, v210
    v_cvt_pk_bf16_f32 v143, v207, v211
    buffer_store_dwordx4 v[140:143], v1, s[4:7], s54 offen offset:3072 sc1
    s_add_u32 s54, s54, 131072
    v_mul_f32 v212, v212, v245
    v_mul_f32 v213, v213, v245
    v_mul_f32 v214, v214, v245
    v_mul_f32 v215, v215, v245
    v_mul_f32 v216, v216, v245
    v_mul_f32 v217, v217, v245
    v_mul_f32 v218, v218, v245
    v_mul_f32 v219, v219, v245
    v_cvt_pk_bf16_f32 v144, v212, v216
    v_cvt_pk_bf16_f32 v145, v213, v217
    v_cvt_pk_bf16_f32 v146, v214, v218
    v_cvt_pk_bf16_f32 v147, v215, v219
    buffer_store_dwordx4 v[144:147], v1, s[4:7], s54 offen offset:0 sc1
    v_mul_f32 v220, v220, v245
    v_mul_f32 v221, v221, v245
    v_mul_f32 v222, v222, v245
    v_mul_f32 v223, v223, v245
    v_mul_f32 v224, v224, v245
    v_mul_f32 v225, v225, v245
    v_mul_f32 v226, v226, v245
    v_mul_f32 v227, v227, v245
    v_cvt_pk_bf16_f32 v148, v220, v224
    v_cvt_pk_bf16_f32 v149, v221, v225
    v_cvt_pk_bf16_f32 v150, v222, v226
    v_cvt_pk_bf16_f32 v151, v223, v227
    buffer_store_dwordx4 v[148:151], v1, s[4:7], s54 offen offset:1024 sc1
    v_mul_f32 v228, v228, v245
    v_mul_f32 v229, v229, v245
    v_mul_f32 v230, v230, v245
    v_mul_f32 v231, v231, v245
    v_mul_f32 v232, v232, v245
    v_mul_f32 v233, v233, v245
    v_mul_f32 v234, v234, v245
    v_mul_f32 v235, v235, v245
    v_cvt_pk_bf16_f32 v128, v228, v232
    v_cvt_pk_bf16_f32 v129, v229, v233
    v_cvt_pk_bf16_f32 v130, v230, v234
    v_cvt_pk_bf16_f32 v131, v231, v235
    buffer_store_dwordx4 v[128:131], v1, s[4:7], s54 offen offset:2048 sc1
    v_mul_f32 v236, v236, v245
    v_mul_f32 v237, v237, v245
    v_mul_f32 v238, v238, v245
    v_mul_f32 v239, v239, v245
    v_mul_f32 v240, v240, v245
    v_mul_f32 v241, v241, v245
    v_mul_f32 v242, v242, v245
    v_mul_f32 v243, v243, v245
    v_cvt_pk_bf16_f32 v132, v236, v240
    v_cvt_pk_bf16_f32 v133, v237, v241
    v_cvt_pk_bf16_f32 v134, v238, v242
    v_cvt_pk_bf16_f32 v135, v239, v243
    buffer_store_dwordx4 v[132:135], v1, s[4:7], s54 offen offset:3072 sc1
    s_lshl_b32 s41, s50, 7
    s_add_u32 s41, s41, 532480
    s_waitcnt vmcnt(0)
    v_mov_b32 v245, 1
    s_mov_b64 exec, 1
    buffer_atomic_add v245, off, s[4:7], s41 offset:0
    s_mov_b64 exec, -1
    s_waitcnt vmcnt(0)
    s_add_u32 s50, s50, 4
    s_cmp_lt_u32 s50, 64
    s_cbranch_scc1 L_t2
    s_waitcnt vmcnt(0)
    s_endpgm
L_wend2:
    s_endpgm
.section .rodata,"a"
.p2align 6
.amdhsa_kernel concat_heads__grouped_kv_mqa__memory_aug_recurrent_mem_tr__prompt_kernel
  .amdhsa_next_free_vgpr 512
  .amdhsa_next_free_sgpr 102
  .amdhsa_accum_offset 256
  .amdhsa_group_segment_fixed_size 0
  .amdhsa_kernarg_size 120
  .amdhsa_user_sgpr_count 2
  .amdhsa_user_sgpr_kernarg_segment_ptr 1
  .amdhsa_system_sgpr_workgroup_id_x 1
  .amdhsa_float_denorm_mode_32 3
.end_amdhsa_kernel
.text
```
